```python
import torch

def _softmax(x, axis=-1):
    return torch.softmax(x, dim=axis)
def _gelu(x):
    return torch.nn.functional.gelu(x, approximate="tanh")
def _silu(x):
    return torch.nn.functional.silu(x)
def _sigmoid(x):
    return torch.sigmoid(x)
def _layernorm(x, axis=-1, eps=1e-5):
    m = x.mean(dim=axis, keepdim=True)
    v = x.var(dim=axis, keepdim=True, unbiased=False)
    return (x - m) / torch.sqrt(v + eps)
def _scatter_add(tgt, idx, src, axis=0):
    return tgt.clone().index_add_(axis, idx, src)
def _segment_sum(src, seg, n):
    out = torch.zeros((n,) + src.shape[1:], dtype=src.dtype)
    return out.index_add_(0, seg, src)
def _pad(x, pw):
    flat = tuple(v for pair in reversed(pw) for v in pair)
    return torch.nn.functional.pad(x, flat)

kernel_name = 'recurrent_scan__spectral_gfnet__dense_activation_squared_relu__prompt'

def setup_inputs():

    _w = (lambda a: (lambda t: t.to(torch.bfloat16) if t.is_floating_point() else t)(torch.as_tensor(a)))
    def _A_setup():
        B, S, D = 1, 2048, 576
        Df = D // 2 + 1
        return {
            "x": _w((lambda *s: torch.randn(*s, dtype=torch.bfloat16) * 0.05)(B, S, D)),
            "w_r": _w((lambda *s: torch.randn(*s, dtype=torch.bfloat16) * 0.05)(S, Df) * 0.02),
            "w_i": _w((lambda *s: torch.randn(*s, dtype=torch.bfloat16) * 0.05)(S, Df) * 0.02),
        }
    _A_in = _A_setup()

    def _B_setup():
        B, S, D, F = 1, 2048, 576, 4608
        return {
            "x": _w((lambda *s: torch.randn(*s, dtype=torch.bfloat16) * 0.05)(B, S, D)),
            "w1": _w((lambda *s: torch.randn(*s, dtype=torch.bfloat16) * 0.05)(D, F)),
            "b1": _w((lambda *s: torch.randn(*s, dtype=torch.bfloat16) * 0.4)(F)),
            "w2": _w((lambda *s: torch.randn(*s, dtype=torch.bfloat16) * 0.05)(F, D)),
            "b2": _w((lambda *s: torch.randn(*s, dtype=torch.bfloat16) * 3.2)(D)),
        }
    _B_in = _B_setup()

    return {
        "A_x": _A_in["x"],
        "A_w_r": _A_in["w_r"],
        "A_w_i": _A_in["w_i"],
        "B_x": _B_in["x"],
        "B_w1": _B_in["w1"],
        "B_b1": _B_in["b1"],
        "B_w2": _B_in["w2"],
        "B_b2": _B_in["b2"],
    }

def reference(A_x, A_w_r, A_w_i, B_x, B_w1, B_b1, B_w2, B_b2):
    def _A_ref(x, w_r, w_i):
        B, S, D = x.shape
        X = (lambda x, axes=(-2,-1): torch.fft.rfft2(x.float(), dim=axes))(x, axes=(-2, -1))
        W = w_r + 1j * w_i
        X = X * W
        y = (lambda x, s, axes=(-2,-1): torch.fft.irfft2(x, s=s, dim=axes).to(torch.bfloat16))(X, (S, D), axes=(-2, -1))
        return y

    def _B_ref(x, w1, b1, w2, b2):
        h = torch.einsum("bsd,df->bsf", x, w1) + b1
        zero = torch.zeros_like(h)
        r = torch.where(h > zero, h, zero)
        h = r * r
        out = torch.einsum("bsf,fd->bsd", h, w2) + b2
        return out

    x = A_x
    xn = _layernorm(x, axis=-1)
    s = _A_ref(xn, A_w_r, A_w_i)
    g = _silu(_B_ref(xn, B_w1, B_b1, B_w2, B_b2))
    return x + s * g
```

```asm
; @launch grid=(256,1,1) block=(512,1,1) lds=163840
.amdgcn_target "amdgcn-amd-amdhsa--gfx950"
.text
.globl recurrent_scan__spectral_gfnet__dense_activation_squared_relu__prompt_kernel
.p2align 8
.type recurrent_scan__spectral_gfnet__dense_activation_squared_relu__prompt_kernel,@function
recurrent_scan__spectral_gfnet__dense_activation_squared_relu__prompt_kernel:
main_entry:
  s_cmp_ge_u32 s2, 256
  s_cbranch_scc1 L_exit
  s_getpc_b64 s[42:43]
  s_bfe_u32 s40, s2, 0x20003
  s_lshl_b32 s40, s40, 14
  v_subrev_u32 v131, 256, v0
  v_cmp_gt_u32 vcc, 0x80, v131
  v_lshlrev_b32 v131, 7, v131
  v_add_u32 v131, s40, v131
  v_min_u32 v131, CODE_BYTES, v131
  s_and_saveexec_b64 s[44:45], vcc
  s_cbranch_execz L_npf
  global_load_dword v131, v131, s[42:43]
L_npf:
  s_mov_b64 exec, s[44:45]
  v_mov_b32 v71, 0
  v_mov_b32 v242, 0
  v_mov_b32 v243, 0
  v_mov_b32 v244, 0
  v_mov_b32 v245, 0
  v_mov_b32 v246, 0
  v_mov_b32 v247, 0
  v_mov_b32 v250, 0
  v_mov_b32 v251, 0
  v_mov_b32 v4, 0
  s_load_dwordx2 s[4:5], s[0:1], 0
  s_load_dwordx2 s[8:9], s[0:1], 32
  s_load_dwordx2 s[12:13], s[0:1], 48
  s_load_dwordx2 s[16:17], s[0:1], 80
  s_load_dwordx2 s[20:21], s[0:1], 40
  s_load_dwordx2 s[32:33], s[0:1], 8
  s_load_dwordx2 s[36:37], s[0:1], 16
  s_load_dwordx2 s[64:65], s[0:1], 64
  s_load_dwordx2 s[68:69], s[0:1], 56
  s_load_dwordx2 s[72:73], s[0:1], 72
  v_lshrrev_b32 v1, 6, v0
  s_nop 0
  v_readfirstlane_b32 s24, v1
  s_mov_b32 s6, 2359296
  s_mov_b32 s7, 0x00020000
  s_mov_b32 s10, 5308416
  s_mov_b32 s11, 0x00020000
  s_mov_b32 s14, 5308416
  s_mov_b32 s15, 0x00020000
  s_mov_b32 s18, 268435456
  s_mov_b32 s19, 0x00020000
  s_mov_b32 s22, 9216
  s_mov_b32 s23, 0x00020000
  s_mov_b32 s34, 1183744
  s_mov_b32 s35, 0x00020000
  s_mov_b32 s38, 1183744
  s_mov_b32 s39, 0x00020000
  s_mov_b32 s66, 2359296
  s_mov_b32 s67, 0x00020000
  s_mov_b32 s70, 1152
  s_mov_b32 s71, 0x00020000
  s_and_b32 s40, s2, 6
  s_bfe_u32 s41, s2, 0x10003
  s_add_u32 s26, s40, s41
  s_and_b32 s40, s2, 1
  s_lshl_b32 s40, s40, 4
  s_lshr_b32 s41, s2, 4
  s_add_u32 s25, s40, s41
  s_and_b32 s40, s25, 15
  s_cmp_ge_u32 s40, 9
  s_cselect_b32 s41, 9, 0
  s_sub_u32 s40, s40, s41
  s_lshl_b32 s27, s40, 2
  s_mul_i32 s40, s25, 3
  s_add_u32 s40, s40, s26
  s_add_u32 s40, s40, 251
  s_cmp_lt_u32 s40, 296
  s_cselect_b32 s28, s40, -1
  s_cmp_lt_u32 s26, 5
  s_cselect_b32 s28, -1, s28
  s_waitcnt lgkmcnt(0)
  s_load_dword s29, s[16:17], 36864
  s_and_b32 s40, s24, 6
  s_cmp_eq_u32 s40, 4
  s_cbranch_scc1 L_helper
  v_and_b32 v2, 63, v0
  v_lshrrev_b32 v3, 3, v2
  v_mul_u32_u24 v3, 1152, v3
  v_and_b32 v4, 7, v2
  v_lshl_add_u32 v3, v4, 4, v3
  s_and_b32 s44, s26, 1
  s_lshl_b32 s44, s44, 2
  s_xor_b32 s44, s44, s24
  s_lshl_b32 s40, s25, 3
  s_add_u32 s41, s40, s44
  s_mul_i32 s41, s41, 9216
  buffer_load_dwordx4 v[64:67], v3, s[4:7], s41 offen offset:0
  buffer_load_dwordx4 v[68:71], v3, s[4:7], s41 offen offset:128
  buffer_load_dwordx4 v[72:75], v3, s[4:7], s41 offen offset:256
  buffer_load_dwordx4 v[76:79], v3, s[4:7], s41 offen offset:384
  buffer_load_dwordx4 v[80:83], v3, s[4:7], s41 offen offset:512
  buffer_load_dwordx4 v[84:87], v3, s[4:7], s41 offen offset:640
  buffer_load_dwordx4 v[88:91], v3, s[4:7], s41 offen offset:768
  buffer_load_dwordx4 v[92:95], v3, s[4:7], s41 offen offset:896
  buffer_load_dwordx4 v[96:99], v3, s[4:7], s41 offen offset:1024
  s_mov_b32 s45, 1
  s_cmp_ge_u32 s24, 2
  s_cbranch_scc1 L_l1
  s_mov_b32 s45, 2
  s_xor_b32 s41, s44, 4
  s_add_u32 s41, s40, s41
  s_mul_i32 s41, s41, 9216
  buffer_load_dwordx4 v[200:203], v3, s[4:7], s41 offen offset:0
  buffer_load_dwordx4 v[204:207], v3, s[4:7], s41 offen offset:128
  buffer_load_dwordx4 v[208:211], v3, s[4:7], s41 offen offset:256
  buffer_load_dwordx4 v[212:215], v3, s[4:7], s41 offen offset:384
  buffer_load_dwordx4 v[216:219], v3, s[4:7], s41 offen offset:512
  buffer_load_dwordx4 v[220:223], v3, s[4:7], s41 offen offset:640
  buffer_load_dwordx4 v[224:227], v3, s[4:7], s41 offen offset:768
  buffer_load_dwordx4 v[228:231], v3, s[4:7], s41 offen offset:896
  buffer_load_dwordx4 v[232:235], v3, s[4:7], s41 offen offset:1024
L_l1:
  s_cmp_ge_u32 s24, 4
  s_cbranch_scc1 L_l3
  v_and_b32 v5, 31, v0
  v_lshlrev_b32 v5, 1, v5
  s_lshr_b32 s40, s24, 1
  s_lshl_b32 s40, s40, 6
  s_mul_i32 s41, s26, 1152
  s_add_u32 s40, s40, s41
  buffer_load_ushort v180, v5, s[20:23], s40 offen offset:0
  buffer_load_ushort v181, v5, s[20:23], s40 offen offset:128
  buffer_load_ushort v182, v5, s[20:23], s40 offen offset:256
  buffer_load_ushort v183, v5, s[20:23], s40 offen offset:384
  buffer_load_ushort v184, v5, s[20:23], s40 offen offset:512
  buffer_load_ushort v185, v5, s[20:23], s40 offen offset:640
  buffer_load_ushort v186, v5, s[20:23], s40 offen offset:768
  buffer_load_ushort v187, v5, s[20:23], s40 offen offset:896
  buffer_load_ushort v188, v5, s[20:23], s40 offen offset:1024
  s_cmp_ge_u32 s24, 2
  s_cbranch_scc1 L_l4
  s_waitcnt vmcnt(18)
  s_branch L_l2
L_l3:
  s_waitcnt vmcnt(0)
L_l4:
  s_waitcnt vmcnt(9)
L_l2:
  v_and_b32 v2, 63, v0
  v_lshrrev_b32 v3, 3, v2
  v_and_b32 v4, 7, v2
  v_xor_b32 v3, v3, v4
  v_lshlrev_b32 v3, 4, v3
  v_lshrrev_b32 v5, 1, v4
  v_lshl_add_u32 v3, v5, 11, v3
  v_and_b32 v5, 1, v4
  v_lshl_add_u32 v3, v5, 9, v3
  s_lshr_b32 s40, s44, 2
  s_lshl_b32 s40, s40, 10
  s_and_b32 s41, s44, 3
  s_lshl_b32 s41, s41, 7
  s_add_u32 s40, s40, s41
  s_add_u32 s40, s40, 73728
  v_add_u32 v3, s40, v3
  v_add_u32 v4, 32768, v3
  v_lshlrev_b32 v100, 16, v64
  v_and_b32 v101, 0xffff0000, v64
  v_lshlrev_b32 v102, 16, v65
  v_and_b32 v103, 0xffff0000, v65
  v_lshlrev_b32 v104, 16, v66
  v_and_b32 v105, 0xffff0000, v66
  v_lshlrev_b32 v106, 16, v67
  v_and_b32 v107, 0xffff0000, v67
  v_lshlrev_b32 v108, 16, v68
  v_and_b32 v109, 0xffff0000, v68
  v_lshlrev_b32 v110, 16, v69
  v_and_b32 v111, 0xffff0000, v69
  v_lshlrev_b32 v112, 16, v70
  v_and_b32 v113, 0xffff0000, v70
  v_lshlrev_b32 v114, 16, v71
  v_and_b32 v115, 0xffff0000, v71
  v_lshlrev_b32 v116, 16, v72
  v_and_b32 v117, 0xffff0000, v72
  v_lshlrev_b32 v118, 16, v73
  v_and_b32 v119, 0xffff0000, v73
  v_lshlrev_b32 v120, 16, v74
  v_and_b32 v121, 0xffff0000, v74
  v_lshlrev_b32 v122, 16, v75
  v_and_b32 v123, 0xffff0000, v75
  v_lshlrev_b32 v124, 16, v76
  v_and_b32 v125, 0xffff0000, v76
  v_lshlrev_b32 v126, 16, v77
  v_and_b32 v127, 0xffff0000, v77
  v_lshlrev_b32 v128, 16, v78
  v_and_b32 v129, 0xffff0000, v78
  v_lshlrev_b32 v130, 16, v79
  v_and_b32 v131, 0xffff0000, v79
  v_lshlrev_b32 v132, 16, v80
  v_and_b32 v133, 0xffff0000, v80
  v_lshlrev_b32 v134, 16, v81
  v_and_b32 v135, 0xffff0000, v81
  v_lshlrev_b32 v136, 16, v82
  v_and_b32 v137, 0xffff0000, v82
  v_lshlrev_b32 v138, 16, v83
  v_and_b32 v139, 0xffff0000, v83
  v_lshlrev_b32 v140, 16, v84
  v_and_b32 v141, 0xffff0000, v84
  v_lshlrev_b32 v142, 16, v85
  v_and_b32 v143, 0xffff0000, v85
  v_lshlrev_b32 v144, 16, v86
  v_and_b32 v145, 0xffff0000, v86
  v_lshlrev_b32 v146, 16, v87
  v_and_b32 v147, 0xffff0000, v87
  v_lshlrev_b32 v148, 16, v88
  v_and_b32 v149, 0xffff0000, v88
  v_lshlrev_b32 v150, 16, v89
  v_and_b32 v151, 0xffff0000, v89
  v_lshlrev_b32 v152, 16, v90
  v_and_b32 v153, 0xffff0000, v90
  v_lshlrev_b32 v154, 16, v91
  v_and_b32 v155, 0xffff0000, v91
  v_lshlrev_b32 v156, 16, v92
  v_and_b32 v157, 0xffff0000, v92
  v_lshlrev_b32 v158, 16, v93
  v_and_b32 v159, 0xffff0000, v93
  v_lshlrev_b32 v160, 16, v94
  v_and_b32 v161, 0xffff0000, v94
  v_lshlrev_b32 v162, 16, v95
  v_and_b32 v163, 0xffff0000, v95
  v_lshlrev_b32 v164, 16, v96
  v_and_b32 v165, 0xffff0000, v96
  v_lshlrev_b32 v166, 16, v97
  v_and_b32 v167, 0xffff0000, v97
  v_lshlrev_b32 v168, 16, v98
  v_and_b32 v169, 0xffff0000, v98
  v_lshlrev_b32 v170, 16, v99
  v_and_b32 v171, 0xffff0000, v99
L_ln:
  v_pk_add_f32 v[6:7], v[100:101], v[102:103]
  v_pk_add_f32 v[8:9], v[104:105], v[106:107]
  v_pk_add_f32 v[6:7], v[6:7], v[108:109]
  v_pk_add_f32 v[8:9], v[8:9], v[110:111]
  v_pk_add_f32 v[6:7], v[6:7], v[112:113]
  v_pk_add_f32 v[8:9], v[8:9], v[114:115]
  v_pk_add_f32 v[6:7], v[6:7], v[116:117]
  v_pk_add_f32 v[8:9], v[8:9], v[118:119]
  v_pk_add_f32 v[6:7], v[6:7], v[120:121]
  v_pk_add_f32 v[8:9], v[8:9], v[122:123]
  v_pk_add_f32 v[6:7], v[6:7], v[124:125]
  v_pk_add_f32 v[8:9], v[8:9], v[126:127]
  v_pk_add_f32 v[6:7], v[6:7], v[128:129]
  v_pk_add_f32 v[8:9], v[8:9], v[130:131]
  v_pk_add_f32 v[6:7], v[6:7], v[132:133]
  v_pk_add_f32 v[8:9], v[8:9], v[134:135]
  v_pk_add_f32 v[6:7], v[6:7], v[136:137]
  v_pk_add_f32 v[8:9], v[8:9], v[138:139]
  v_pk_add_f32 v[6:7], v[6:7], v[140:141]
  v_pk_add_f32 v[8:9], v[8:9], v[142:143]
  v_pk_add_f32 v[6:7], v[6:7], v[144:145]
  v_pk_add_f32 v[8:9], v[8:9], v[146:147]
  v_pk_add_f32 v[6:7], v[6:7], v[148:149]
  v_pk_add_f32 v[8:9], v[8:9], v[150:151]
  v_pk_add_f32 v[6:7], v[6:7], v[152:153]
  v_pk_add_f32 v[8:9], v[8:9], v[154:155]
  v_pk_add_f32 v[6:7], v[6:7], v[156:157]
  v_pk_add_f32 v[8:9], v[8:9], v[158:159]
  v_pk_add_f32 v[6:7], v[6:7], v[160:161]
  v_pk_add_f32 v[8:9], v[8:9], v[162:163]
  v_pk_add_f32 v[6:7], v[6:7], v[164:165]
  v_pk_add_f32 v[8:9], v[8:9], v[166:167]
  v_pk_add_f32 v[6:7], v[6:7], v[168:169]
  v_pk_add_f32 v[8:9], v[8:9], v[170:171]
  v_pk_add_f32 v[6:7], v[6:7], v[8:9]
  v_add_f32 v6, v6, v7
  s_nop 1
  v_add_f32_dpp v6, v6, v6 quad_perm:[1,0,3,2] row_mask:0xf bank_mask:0xf
  s_nop 1
  v_add_f32_dpp v6, v6, v6 quad_perm:[2,3,0,1] row_mask:0xf bank_mask:0xf
  s_nop 1
  v_add_f32_dpp v6, v6, v6 row_half_mirror row_mask:0xf bank_mask:0xf
  v_mul_f32 v6, -0.001736111111111111, v6
  v_mov_b32 v7, v6
  v_pk_add_f32 v[100:101], v[100:101], v[6:7]
  v_pk_mul_f32 v[8:9], v[100:101], v[100:101]
  v_pk_add_f32 v[102:103], v[102:103], v[6:7]
  v_pk_mul_f32 v[10:11], v[102:103], v[102:103]
  v_pk_add_f32 v[104:105], v[104:105], v[6:7]
  v_pk_fma_f32 v[8:9], v[104:105], v[104:105], v[8:9]
  v_pk_add_f32 v[106:107], v[106:107], v[6:7]
  v_pk_fma_f32 v[10:11], v[106:107], v[106:107], v[10:11]
  v_pk_add_f32 v[108:109], v[108:109], v[6:7]
  v_pk_fma_f32 v[8:9], v[108:109], v[108:109], v[8:9]
  v_pk_add_f32 v[110:111], v[110:111], v[6:7]
  v_pk_fma_f32 v[10:11], v[110:111], v[110:111], v[10:11]
  v_pk_add_f32 v[112:113], v[112:113], v[6:7]
  v_pk_fma_f32 v[8:9], v[112:113], v[112:113], v[8:9]
  v_pk_add_f32 v[114:115], v[114:115], v[6:7]
  v_pk_fma_f32 v[10:11], v[114:115], v[114:115], v[10:11]
  v_pk_add_f32 v[116:117], v[116:117], v[6:7]
  v_pk_fma_f32 v[8:9], v[116:117], v[116:117], v[8:9]
  v_pk_add_f32 v[118:119], v[118:119], v[6:7]
  v_pk_fma_f32 v[10:11], v[118:119], v[118:119], v[10:11]
  v_pk_add_f32 v[120:121], v[120:121], v[6:7]
  v_pk_fma_f32 v[8:9], v[120:121], v[120:121], v[8:9]
  v_pk_add_f32 v[122:123], v[122:123], v[6:7]
  v_pk_fma_f32 v[10:11], v[122:123], v[122:123], v[10:11]
  v_pk_add_f32 v[124:125], v[124:125], v[6:7]
  v_pk_fma_f32 v[8:9], v[124:125], v[124:125], v[8:9]
  v_pk_add_f32 v[126:127], v[126:127], v[6:7]
  v_pk_fma_f32 v[10:11], v[126:127], v[126:127], v[10:11]
  v_pk_add_f32 v[128:129], v[128:129], v[6:7]
  v_pk_fma_f32 v[8:9], v[128:129], v[128:129], v[8:9]
  v_pk_add_f32 v[130:131], v[130:131], v[6:7]
  v_pk_fma_f32 v[10:11], v[130:131], v[130:131], v[10:11]
  v_pk_add_f32 v[132:133], v[132:133], v[6:7]
  v_pk_fma_f32 v[8:9], v[132:133], v[132:133], v[8:9]
  v_pk_add_f32 v[134:135], v[134:135], v[6:7]
  v_pk_fma_f32 v[10:11], v[134:135], v[134:135], v[10:11]
  v_pk_add_f32 v[136:137], v[136:137], v[6:7]
  v_pk_fma_f32 v[8:9], v[136:137], v[136:137], v[8:9]
  v_pk_add_f32 v[138:139], v[138:139], v[6:7]
  v_pk_fma_f32 v[10:11], v[138:139], v[138:139], v[10:11]
  v_pk_add_f32 v[140:141], v[140:141], v[6:7]
  v_pk_fma_f32 v[8:9], v[140:141], v[140:141], v[8:9]
  v_pk_add_f32 v[142:143], v[142:143], v[6:7]
  v_pk_fma_f32 v[10:11], v[142:143], v[142:143], v[10:11]
  v_pk_add_f32 v[144:145], v[144:145], v[6:7]
  v_pk_fma_f32 v[8:9], v[144:145], v[144:145], v[8:9]
  v_pk_add_f32 v[146:147], v[146:147], v[6:7]
  v_pk_fma_f32 v[10:11], v[146:147], v[146:147], v[10:11]
  v_pk_add_f32 v[148:149], v[148:149], v[6:7]
  v_pk_fma_f32 v[8:9], v[148:149], v[148:149], v[8:9]
  v_pk_add_f32 v[150:151], v[150:151], v[6:7]
  v_pk_fma_f32 v[10:11], v[150:151], v[150:151], v[10:11]
  v_pk_add_f32 v[152:153], v[152:153], v[6:7]
  v_pk_fma_f32 v[8:9], v[152:153], v[152:153], v[8:9]
  v_pk_add_f32 v[154:155], v[154:155], v[6:7]
  v_pk_fma_f32 v[10:11], v[154:155], v[154:155], v[10:11]
  v_pk_add_f32 v[156:157], v[156:157], v[6:7]
  v_pk_fma_f32 v[8:9], v[156:157], v[156:157], v[8:9]
  v_pk_add_f32 v[158:159], v[158:159], v[6:7]
  v_pk_fma_f32 v[10:11], v[158:159], v[158:159], v[10:11]
  v_pk_add_f32 v[160:161], v[160:161], v[6:7]
  v_pk_fma_f32 v[8:9], v[160:161], v[160:161], v[8:9]
  v_pk_add_f32 v[162:163], v[162:163], v[6:7]
  v_pk_fma_f32 v[10:11], v[162:163], v[162:163], v[10:11]
  v_pk_add_f32 v[164:165], v[164:165], v[6:7]
  v_pk_fma_f32 v[8:9], v[164:165], v[164:165], v[8:9]
  v_pk_add_f32 v[166:167], v[166:167], v[6:7]
  v_pk_fma_f32 v[10:11], v[166:167], v[166:167], v[10:11]
  v_pk_add_f32 v[168:169], v[168:169], v[6:7]
  v_pk_fma_f32 v[8:9], v[168:169], v[168:169], v[8:9]
  v_pk_add_f32 v[170:171], v[170:171], v[6:7]
  v_pk_fma_f32 v[10:11], v[170:171], v[170:171], v[10:11]
  v_pk_add_f32 v[8:9], v[8:9], v[10:11]
  v_add_f32 v8, v8, v9
  s_nop 1
  v_add_f32_dpp v8, v8, v8 quad_perm:[1,0,3,2] row_mask:0xf bank_mask:0xf
  s_nop 1
  v_add_f32_dpp v8, v8, v8 quad_perm:[2,3,0,1] row_mask:0xf bank_mask:0xf
  s_nop 1
  v_add_f32_dpp v8, v8, v8 row_half_mirror row_mask:0xf bank_mask:0xf
  v_mul_f32 v8, 0.001736111111111111, v8
  v_cvt_pk_bf16_f32 v7, v6, v6
  v_and_b32 v7, 0xffff0000, v7
  v_sub_f32 v6, v7, v6
  v_cvt_pk_bf16_f32 v8, v8, v8
  v_and_b32 v8, 0xffff0000, v8
  v_add_f32 v8, 1e-05, v8
  v_cvt_pk_bf16_f32 v8, v8, v8
  v_and_b32 v8, 0xffff0000, v8
  v_sqrt_f32 v8, v8
  s_nop 0
  v_cvt_pk_bf16_f32 v8, v8, v8
  v_and_b32 v8, 0xffff0000, v8
  v_rcp_f32 v8, v8
  s_nop 0
  v_mov_b32 v9, v8
  v_mul_f32 v6, v6, v8
  v_mov_b32 v7, v6
  v_pk_fma_f32 v[12:13], v[100:101], v[8:9], v[6:7]
  v_cvt_pk_bf16_f32 v64, v12, v13
  v_pk_fma_f32 v[14:15], v[102:103], v[8:9], v[6:7]
  v_cvt_pk_bf16_f32 v65, v14, v15
  v_pk_fma_f32 v[12:13], v[104:105], v[8:9], v[6:7]
  v_cvt_pk_bf16_f32 v66, v12, v13
  v_pk_fma_f32 v[14:15], v[106:107], v[8:9], v[6:7]
  v_cvt_pk_bf16_f32 v67, v14, v15
  ds_write_b128 v3, v[64:67] offset:0
  v_pk_fma_f32 v[12:13], v[108:109], v[8:9], v[6:7]
  v_cvt_pk_bf16_f32 v68, v12, v13
  v_pk_fma_f32 v[14:15], v[110:111], v[8:9], v[6:7]
  v_cvt_pk_bf16_f32 v69, v14, v15
  v_pk_fma_f32 v[12:13], v[112:113], v[8:9], v[6:7]
  v_cvt_pk_bf16_f32 v70, v12, v13
  v_pk_fma_f32 v[14:15], v[114:115], v[8:9], v[6:7]
  v_cvt_pk_bf16_f32 v71, v14, v15
  ds_write_b128 v3, v[68:71] offset:8192
  v_pk_fma_f32 v[12:13], v[116:117], v[8:9], v[6:7]
  v_cvt_pk_bf16_f32 v72, v12, v13
  v_pk_fma_f32 v[14:15], v[118:119], v[8:9], v[6:7]
  v_cvt_pk_bf16_f32 v73, v14, v15
  v_pk_fma_f32 v[12:13], v[120:121], v[8:9], v[6:7]
  v_cvt_pk_bf16_f32 v74, v12, v13
  v_pk_fma_f32 v[14:15], v[122:123], v[8:9], v[6:7]
  v_cvt_pk_bf16_f32 v75, v14, v15
  ds_write_b128 v3, v[72:75] offset:16384
  v_pk_fma_f32 v[12:13], v[124:125], v[8:9], v[6:7]
  v_cvt_pk_bf16_f32 v76, v12, v13
  v_pk_fma_f32 v[14:15], v[126:127], v[8:9], v[6:7]
  v_cvt_pk_bf16_f32 v77, v14, v15
  v_pk_fma_f32 v[12:13], v[128:129], v[8:9], v[6:7]
  v_cvt_pk_bf16_f32 v78, v12, v13
  v_pk_fma_f32 v[14:15], v[130:131], v[8:9], v[6:7]
  v_cvt_pk_bf16_f32 v79, v14, v15
  ds_write_b128 v3, v[76:79] offset:24576
  v_pk_fma_f32 v[12:13], v[132:133], v[8:9], v[6:7]
  v_cvt_pk_bf16_f32 v80, v12, v13
  v_pk_fma_f32 v[14:15], v[134:135], v[8:9], v[6:7]
  v_cvt_pk_bf16_f32 v81, v14, v15
  v_pk_fma_f32 v[12:13], v[136:137], v[8:9], v[6:7]
  v_cvt_pk_bf16_f32 v82, v12, v13
  v_pk_fma_f32 v[14:15], v[138:139], v[8:9], v[6:7]
  v_cvt_pk_bf16_f32 v83, v14, v15
  ds_write_b128 v4, v[80:83] offset:0
  v_pk_fma_f32 v[12:13], v[140:141], v[8:9], v[6:7]
  v_cvt_pk_bf16_f32 v84, v12, v13
  v_pk_fma_f32 v[14:15], v[142:143], v[8:9], v[6:7]
  v_cvt_pk_bf16_f32 v85, v14, v15
  v_pk_fma_f32 v[12:13], v[144:145], v[8:9], v[6:7]
  v_cvt_pk_bf16_f32 v86, v12, v13
  v_pk_fma_f32 v[14:15], v[146:147], v[8:9], v[6:7]
  v_cvt_pk_bf16_f32 v87, v14, v15
  ds_write_b128 v4, v[84:87] offset:8192
  v_pk_fma_f32 v[12:13], v[148:149], v[8:9], v[6:7]
  v_cvt_pk_bf16_f32 v88, v12, v13
  v_pk_fma_f32 v[14:15], v[150:151], v[8:9], v[6:7]
  v_cvt_pk_bf16_f32 v89, v14, v15
  v_pk_fma_f32 v[12:13], v[152:153], v[8:9], v[6:7]
  v_cvt_pk_bf16_f32 v90, v12, v13
  v_pk_fma_f32 v[14:15], v[154:155], v[8:9], v[6:7]
  v_cvt_pk_bf16_f32 v91, v14, v15
  ds_write_b128 v4, v[88:91] offset:16384
  v_pk_fma_f32 v[12:13], v[156:157], v[8:9], v[6:7]
  v_cvt_pk_bf16_f32 v92, v12, v13
  v_pk_fma_f32 v[14:15], v[158:159], v[8:9], v[6:7]
  v_cvt_pk_bf16_f32 v93, v14, v15
  v_pk_fma_f32 v[12:13], v[160:161], v[8:9], v[6:7]
  v_cvt_pk_bf16_f32 v94, v12, v13
  v_pk_fma_f32 v[14:15], v[162:163], v[8:9], v[6:7]
  v_cvt_pk_bf16_f32 v95, v14, v15
  ds_write_b128 v4, v[92:95] offset:24576
  v_pk_fma_f32 v[12:13], v[164:165], v[8:9], v[6:7]
  v_cvt_pk_bf16_f32 v96, v12, v13
  v_pk_fma_f32 v[14:15], v[166:167], v[8:9], v[6:7]
  v_cvt_pk_bf16_f32 v97, v14, v15
  v_pk_fma_f32 v[12:13], v[168:169], v[8:9], v[6:7]
  v_cvt_pk_bf16_f32 v98, v12, v13
  v_pk_fma_f32 v[14:15], v[170:171], v[8:9], v[6:7]
  v_cvt_pk_bf16_f32 v99, v14, v15
  ds_write_b128 v4, v[96:99] offset:32768
  s_sub_u32 s45, s45, 1
  s_cmp_eq_u32 s45, 0
  s_cbranch_scc1 L_lnd
  v_xor_b32 v3, 1024, v3
  v_xor_b32 v4, 1024, v4
  s_waitcnt vmcnt(0)
  v_lshlrev_b32 v100, 16, v200
  v_and_b32 v101, 0xffff0000, v200
  v_lshlrev_b32 v102, 16, v201
  v_and_b32 v103, 0xffff0000, v201
  v_lshlrev_b32 v104, 16, v202
  v_and_b32 v105, 0xffff0000, v202
  v_lshlrev_b32 v106, 16, v203
  v_and_b32 v107, 0xffff0000, v203
  v_lshlrev_b32 v108, 16, v204
  v_and_b32 v109, 0xffff0000, v204
  v_lshlrev_b32 v110, 16, v205
  v_and_b32 v111, 0xffff0000, v205
  v_lshlrev_b32 v112, 16, v206
  v_and_b32 v113, 0xffff0000, v206
  v_lshlrev_b32 v114, 16, v207
  v_and_b32 v115, 0xffff0000, v207
  v_lshlrev_b32 v116, 16, v208
  v_and_b32 v117, 0xffff0000, v208
  v_lshlrev_b32 v118, 16, v209
  v_and_b32 v119, 0xffff0000, v209
  v_lshlrev_b32 v120, 16, v210
  v_and_b32 v121, 0xffff0000, v210
  v_lshlrev_b32 v122, 16, v211
  v_and_b32 v123, 0xffff0000, v211
  v_lshlrev_b32 v124, 16, v212
  v_and_b32 v125, 0xffff0000, v212
  v_lshlrev_b32 v126, 16, v213
  v_and_b32 v127, 0xffff0000, v213
  v_lshlrev_b32 v128, 16, v214
  v_and_b32 v129, 0xffff0000, v214
  v_lshlrev_b32 v130, 16, v215
  v_and_b32 v131, 0xffff0000, v215
  v_lshlrev_b32 v132, 16, v216
  v_and_b32 v133, 0xffff0000, v216
  v_lshlrev_b32 v134, 16, v217
  v_and_b32 v135, 0xffff0000, v217
  v_lshlrev_b32 v136, 16, v218
  v_and_b32 v137, 0xffff0000, v218
  v_lshlrev_b32 v138, 16, v219
  v_and_b32 v139, 0xffff0000, v219
  v_lshlrev_b32 v140, 16, v220
  v_and_b32 v141, 0xffff0000, v220
  v_lshlrev_b32 v142, 16, v221
  v_and_b32 v143, 0xffff0000, v221
  v_lshlrev_b32 v144, 16, v222
  v_and_b32 v145, 0xffff0000, v222
  v_lshlrev_b32 v146, 16, v223
  v_and_b32 v147, 0xffff0000, v223
  v_lshlrev_b32 v148, 16, v224
  v_and_b32 v149, 0xffff0000, v224
  v_lshlrev_b32 v150, 16, v225
  v_and_b32 v151, 0xffff0000, v225
  v_lshlrev_b32 v152, 16, v226
  v_and_b32 v153, 0xffff0000, v226
  v_lshlrev_b32 v154, 16, v227
  v_and_b32 v155, 0xffff0000, v227
  v_lshlrev_b32 v156, 16, v228
  v_and_b32 v157, 0xffff0000, v228
  v_lshlrev_b32 v158, 16, v229
  v_and_b32 v159, 0xffff0000, v229
  v_lshlrev_b32 v160, 16, v230
  v_and_b32 v161, 0xffff0000, v230
  v_lshlrev_b32 v162, 16, v231
  v_and_b32 v163, 0xffff0000, v231
  v_lshlrev_b32 v164, 16, v232
  v_and_b32 v165, 0xffff0000, v232
  v_lshlrev_b32 v166, 16, v233
  v_and_b32 v167, 0xffff0000, v233
  v_lshlrev_b32 v168, 16, v234
  v_and_b32 v169, 0xffff0000, v234
  v_lshlrev_b32 v170, 16, v235
  v_and_b32 v171, 0xffff0000, v235
  s_branch L_ln
L_lnd:
  s_cmp_ge_u32 s24, 4
  s_cbranch_scc1 L_helper
  s_waitcnt lgkmcnt(0)
  s_add_u32 s29, s29, 1
L_mwave:
  s_and_b32 s30, s24, 1
  s_lshr_b32 s31, s24, 1
  v_and_b32 v240, 63, v0
  v_lshrrev_b32 v241, 5, v240
  v_bfe_u32 v242, v240, 2, 2
  v_mul_u32_u24 v243, 384, v242
  v_lshrrev_b32 v242, 1, v242
  v_xor_b32 v242, s31, v242
  v_lshl_add_u32 v243, v242, 6, v243
  v_bfe_u32 v242, v240, 4, 1
  v_lshl_add_u32 v243, v242, 5, v243
  v_and_b32 v242, 3, v240
  v_lshl_add_u32 v243, v242, 3, v243
  v_mul_u32_u24 v242, 36864, v241
  v_add_u32 v1, v242, v243
  v_lshlrev_b32 v4, 4, v240
  s_lshl_b32 s46, s30, 10
  s_add_u32 s46, s46, 73728
  v_add_u32 v5, s46, v4
  v_lshlrev_b32 v242, 4, v241
  v_xor_b32 v242, 0, v242
  v_xor_b32 v60, v242, v5
  v_lshlrev_b32 v242, 4, v241
  v_xor_b32 v242, 32, v242
  v_xor_b32 v61, v242, v5
  v_lshlrev_b32 v242, 4, v241
  v_xor_b32 v242, 64, v242
  v_xor_b32 v62, v242, v5
  v_lshlrev_b32 v242, 4, v241
  v_xor_b32 v242, 96, v242
  v_xor_b32 v63, v242, v5
  v_cmp_gt_u32 vcc, 32, v240
  v_mov_b32 v242, 0x3f80
  v_mov_b32 v17, 0
  v_mov_b32 v18, 0
  v_mov_b32 v19, 0
  v_cndmask_b32 v16, 0, v242, vcc
  s_waitcnt vmcnt(0)
  v_mov_b32 v24, v180
  v_mov_b32 v25, 0
  v_mov_b32 v26, 0
  v_mov_b32 v27, 0
  v_mov_b32 v28, v181
  v_mov_b32 v29, 0
  v_mov_b32 v30, 0
  v_mov_b32 v31, 0
  v_mov_b32 v32, v182
  v_mov_b32 v33, 0
  v_mov_b32 v34, 0
  v_mov_b32 v35, 0
  v_mov_b32 v36, v183
  v_mov_b32 v37, 0
  v_mov_b32 v38, 0
  v_mov_b32 v39, 0
  v_mov_b32 v40, v184
  v_mov_b32 v41, 0
  v_mov_b32 v42, 0
  v_mov_b32 v43, 0
  v_mov_b32 v44, v185
  v_mov_b32 v45, 0
  v_mov_b32 v46, 0
  v_mov_b32 v47, 0
  v_mov_b32 v48, v186
  v_mov_b32 v49, 0
  v_mov_b32 v50, 0
  v_mov_b32 v51, 0
  v_mov_b32 v52, v187
  v_mov_b32 v53, 0
  v_mov_b32 v54, 0
  v_mov_b32 v55, 0
  v_mov_b32 v56, v188
  v_mov_b32 v57, 0
  v_mov_b32 v58, 0
  v_mov_b32 v59, 0
  s_waitcnt lgkmcnt(0)
  s_barrier
  s_cmp_ge_u32 s26, 5
  s_cbranch_scc1 L_m_nop0
  s_mov_b32 s40, 0x05040100
  s_mov_b32 s41, 0x07060302
  s_cmp_eq_u32 s31, 0
  s_cselect_b32 s42, s40, s41
  s_lshl_b32 s46, s31, 10
  v_add_u32 v246, s46, v4
  v_add_u32 v247, 16384, v246
  v_add_u32 v248, 32768, v60
  v_add_u32 v249, 32768, v61
  v_add_u32 v250, 32768, v62
  v_add_u32 v251, 32768, v63
  ds_read_b128 v[64:67], v60 offset:0
  ds_read_b128 v[68:71], v61 offset:2048
  ds_read_b128 v[72:75], v62 offset:4096
  ds_read_b128 v[76:79], v63 offset:6144
  ds_read_b128 v[80:83], v246 offset:18432
  ds_read_b128 v[84:87], v246 offset:20480
  ds_read_b128 v[88:91], v60 offset:8192
  ds_read_b128 v[92:95], v61 offset:10240
  ds_read_b128 v[96:99], v62 offset:12288
  ds_read_b128 v[100:103], v63 offset:14336
  ds_read_b128 v[104:107], v246 offset:22528
  ds_read_b128 v[108:111], v246 offset:24576
  s_waitcnt lgkmcnt(6)
  v_perm_b32 v144, v66, v64, s42
  v_perm_b32 v145, v70, v68, s42
  v_perm_b32 v146, v74, v72, s42
  v_perm_b32 v147, v78, v76, s42
  v_perm_b32 v148, v67, v65, s42
  v_perm_b32 v149, v71, v69, s42
  v_perm_b32 v150, v75, v73, s42
  v_perm_b32 v151, v79, v77, s42
  ds_read_b128 v[112:115], v60 offset:16384
  ds_read_b128 v[116:119], v61 offset:18432
  ds_read_b128 v[120:123], v62 offset:20480
  ds_read_b128 v[124:127], v63 offset:22528
  ds_read_b128 v[128:131], v246 offset:26624
  ds_read_b128 v[132:135], v246 offset:28672
  v_mfma_f32_32x32x16_bf16 v[176:191], v[80:83], v[144:147], 0
  v_mfma_f32_32x32x16_bf16 v[192:207], v[84:87], v[148:151], 0
  s_waitcnt lgkmcnt(6)
  v_perm_b32 v152, v90, v88, s42
  v_perm_b32 v153, v94, v92, s42
  v_perm_b32 v154, v98, v96, s42
  v_perm_b32 v155, v102, v100, s42
  v_perm_b32 v156, v91, v89, s42
  v_perm_b32 v157, v95, v93, s42
  v_perm_b32 v158, v99, v97, s42
  v_perm_b32 v159, v103, v101, s42
  ds_read_b128 v[64:67], v60 offset:24576
  ds_read_b128 v[68:71], v61 offset:26624
  ds_read_b128 v[72:75], v62 offset:28672
  ds_read_b128 v[76:79], v63 offset:30720
  ds_read_b128 v[80:83], v246 offset:30720
  ds_read_b128 v[84:87], v246 offset:32768
  v_mfma_f32_32x32x16_bf16 v[176:191], v[104:107], v[152:155], v[176:191]
  v_mfma_f32_32x32x16_bf16 v[192:207], v[108:111], v[156:159], v[192:207]
  s_waitcnt lgkmcnt(6)
  v_perm_b32 v144, v114, v112, s42
  v_perm_b32 v145, v118, v116, s42
  v_perm_b32 v146, v122, v120, s42
  v_perm_b32 v147, v126, v124, s42
  v_perm_b32 v148, v115, v113, s42
  v_perm_b32 v149, v119, v117, s42
  v_perm_b32 v150, v123, v121, s42
  v_perm_b32 v151, v127, v125, s42
  ds_read_b128 v[88:91], v248 offset:0
  ds_read_b128 v[92:95], v249 offset:2048
  ds_read_b128 v[96:99], v250 offset:4096
  ds_read_b128 v[100:103], v251 offset:6144
  ds_read_b128 v[104:107], v246 offset:34816
  ds_read_b128 v[108:111], v246 offset:55296
  v_mfma_f32_32x32x16_bf16 v[176:191], v[128:131], v[144:147], v[176:191]
  v_mfma_f32_32x32x16_bf16 v[192:207], v[132:135], v[148:151], v[192:207]
  s_waitcnt lgkmcnt(6)
  v_perm_b32 v152, v66, v64, s42
  v_perm_b32 v153, v70, v68, s42
  v_perm_b32 v154, v74, v72, s42
  v_perm_b32 v155, v78, v76, s42
  v_perm_b32 v156, v67, v65, s42
  v_perm_b32 v157, v71, v69, s42
  v_perm_b32 v158, v75, v73, s42
  v_perm_b32 v159, v79, v77, s42
  ds_read_b128 v[112:115], v248 offset:8192
  ds_read_b128 v[116:119], v249 offset:10240
  ds_read_b128 v[120:123], v250 offset:12288
  ds_read_b128 v[124:127], v251 offset:14336
  ds_read_b128 v[128:131], v246 offset:57344
  ds_read_b128 v[132:135], v246 offset:59392
  v_mfma_f32_32x32x16_bf16 v[176:191], v[80:83], v[152:155], v[176:191]
  v_mfma_f32_32x32x16_bf16 v[192:207], v[84:87], v[156:159], v[192:207]
  s_waitcnt lgkmcnt(6)
  v_perm_b32 v144, v90, v88, s42
  v_perm_b32 v145, v94, v92, s42
  v_perm_b32 v146, v98, v96, s42
  v_perm_b32 v147, v102, v100, s42
  v_perm_b32 v148, v91, v89, s42
  v_perm_b32 v149, v95, v93, s42
  v_perm_b32 v150, v99, v97, s42
  v_perm_b32 v151, v103, v101, s42
  ds_read_b128 v[64:67], v248 offset:16384
  ds_read_b128 v[68:71], v249 offset:18432
  ds_read_b128 v[72:75], v250 offset:20480
  ds_read_b128 v[76:79], v251 offset:22528
  ds_read_b128 v[80:83], v247 offset:45056
  ds_read_b128 v[84:87], v247 offset:47104
  v_mfma_f32_32x32x16_bf16 v[176:191], v[104:107], v[144:147], v[176:191]
  v_mfma_f32_32x32x16_bf16 v[192:207], v[108:111], v[148:151], v[192:207]
  s_waitcnt lgkmcnt(6)
  v_perm_b32 v152, v114, v112, s42
  v_perm_b32 v153, v118, v116, s42
  v_perm_b32 v154, v122, v120, s42
  v_perm_b32 v155, v126, v124, s42
  v_perm_b32 v156, v115, v113, s42
  v_perm_b32 v157, v119, v117, s42
  v_perm_b32 v158, v123, v121, s42
  v_perm_b32 v159, v127, v125, s42
  ds_read_b128 v[88:91], v248 offset:24576
  ds_read_b128 v[92:95], v249 offset:26624
  ds_read_b128 v[96:99], v250 offset:28672
  ds_read_b128 v[100:103], v251 offset:30720
  ds_read_b128 v[104:107], v247 offset:49152
  ds_read_b128 v[108:111], v247 offset:51200
  v_mfma_f32_32x32x16_bf16 v[176:191], v[128:131], v[152:155], v[176:191]
  v_mfma_f32_32x32x16_bf16 v[192:207], v[132:135], v[156:159], v[192:207]
  s_waitcnt lgkmcnt(6)
  v_perm_b32 v144, v66, v64, s42
  v_perm_b32 v145, v70, v68, s42
  v_perm_b32 v146, v74, v72, s42
  v_perm_b32 v147, v78, v76, s42
  v_perm_b32 v148, v67, v65, s42
  v_perm_b32 v149, v71, v69, s42
  v_perm_b32 v150, v75, v73, s42
  v_perm_b32 v151, v79, v77, s42
  ds_read_b128 v[112:115], v248 offset:32768
  ds_read_b128 v[116:119], v249 offset:34816
  ds_read_b128 v[120:123], v250 offset:36864
  ds_read_b128 v[124:127], v251 offset:38912
  ds_read_b128 v[128:131], v247 offset:53248
  ds_read_b128 v[132:135], v247 offset:55296
  v_mfma_f32_32x32x16_bf16 v[176:191], v[80:83], v[144:147], v[176:191]
  v_mfma_f32_32x32x16_bf16 v[192:207], v[84:87], v[148:151], v[192:207]
  s_waitcnt lgkmcnt(6)
  v_perm_b32 v152, v90, v88, s42
  v_perm_b32 v153, v94, v92, s42
  v_perm_b32 v154, v98, v96, s42
  v_perm_b32 v155, v102, v100, s42
  v_perm_b32 v156, v91, v89, s42
  v_perm_b32 v157, v95, v93, s42
  v_perm_b32 v158, v99, v97, s42
  v_perm_b32 v159, v103, v101, s42
  s_nop 0
  v_mfma_f32_32x32x16_bf16 v[176:191], v[104:107], v[152:155], v[176:191]
  v_mfma_f32_32x32x16_bf16 v[192:207], v[108:111], v[156:159], v[192:207]
  s_waitcnt lgkmcnt(0)
  v_perm_b32 v144, v114, v112, s42
  v_perm_b32 v145, v118, v116, s42
  v_perm_b32 v146, v122, v120, s42
  v_perm_b32 v147, v126, v124, s42
  v_perm_b32 v148, v115, v113, s42
  v_perm_b32 v149, v119, v117, s42
  v_perm_b32 v150, v123, v121, s42
  v_perm_b32 v151, v127, v125, s42
  s_nop 0
  v_mfma_f32_32x32x16_bf16 v[176:191], v[128:131], v[144:147], v[176:191]
  v_mfma_f32_32x32x16_bf16 v[192:207], v[132:135], v[148:151], v[192:207]
  s_lshl_b32 s46, s24, 12
  s_add_u32 s46, s46, 147456
  v_add_u32 v246, s46, v4
  s_xor_b32 s46, s24, 2
  s_lshl_b32 s46, s46, 12
  s_add_u32 s46, s46, 147456
  v_add_u32 v247, s46, v4
  s_cmp_eq_u32 s31, 0
  s_cselect_b32 s40, 1.0, -1.0
  s_nop 7
  v_fma_f32 v80, -v192, s40, v176
  v_fma_f32 v81, -v193, s40, v177
  v_fma_f32 v82, -v194, s40, v178
  v_fma_f32 v83, -v195, s40, v179
  v_fma_f32 v84, -v196, s40, v180
  v_fma_f32 v85, -v197, s40, v181
  v_fma_f32 v86, -v198, s40, v182
  v_fma_f32 v87, -v199, s40, v183
  v_fma_f32 v88, -v200, s40, v184
  v_fma_f32 v89, -v201, s40, v185
  v_fma_f32 v90, -v202, s40, v186
  v_fma_f32 v91, -v203, s40, v187
  v_fma_f32 v92, -v204, s40, v188
  v_fma_f32 v93, -v205, s40, v189
  v_fma_f32 v94, -v206, s40, v190
  v_fma_f32 v95, -v207, s40, v191
  ds_write_b128 v246, v[80:83] offset:0
  ds_write_b128 v246, v[84:87] offset:1024
  ds_write_b128 v246, v[88:91] offset:2048
  ds_write_b128 v246, v[92:95] offset:3072
  v_fma_f32 v64, v192, s40, v176
  v_fma_f32 v65, v193, s40, v177
  v_fma_f32 v66, v194, s40, v178
  v_fma_f32 v67, v195, s40, v179
  v_fma_f32 v68, v196, s40, v180
  v_fma_f32 v69, v197, s40, v181
  v_fma_f32 v70, v198, s40, v182
  v_fma_f32 v71, v199, s40, v183
  v_fma_f32 v72, v200, s40, v184
  v_fma_f32 v73, v201, s40, v185
  v_fma_f32 v74, v202, s40, v186
  v_fma_f32 v75, v203, s40, v187
  v_fma_f32 v76, v204, s40, v188
  v_fma_f32 v77, v205, s40, v189
  v_fma_f32 v78, v206, s40, v190
  v_fma_f32 v79, v207, s40, v191
  s_lshl_b32 s46, s25, 6
  s_lshl_b32 s47, s30, 5
  s_add_u32 s46, s46, s47
  s_lshl_b32 s46, s46, 4
  v_and_b32 v243, 31, v240
  v_lshlrev_b32 v243, 4, v243
  v_add_u32 v243, s46, v243
  v_lshl_add_u32 v243, v241, 15, v243
  s_mul_i32 s46, s31, 1310720
  s_lshl_b32 s47, s26, 17
  s_add_u32 s48, s46, s47
  s_add_u32 s48, s48, 39845888
  s_waitcnt lgkmcnt(0)
  s_barrier
  ds_read_b128 v[96:99], v247 offset:0
  ds_read_b128 v[100:103], v247 offset:1024
  ds_read_b128 v[104:107], v247 offset:2048
  ds_read_b128 v[108:111], v247 offset:3072
  s_waitcnt lgkmcnt(0)
  s_cmp_eq_u32 s31, 0
  s_cbranch_scc0 L_x1b
  v_add_f32 v208, v64, v96
  v_add_f32 v209, v72, v104
  v_sub_f32 v210, v64, v96
  v_sub_f32 v211, v104, v72
  v_add_f32 v212, v65, v97
  v_add_f32 v213, v73, v105
  v_sub_f32 v214, v65, v97
  v_sub_f32 v215, v105, v73
  v_add_f32 v216, v66, v98
  v_add_f32 v217, v74, v106
  v_sub_f32 v218, v66, v98
  v_sub_f32 v219, v106, v74
  v_add_f32 v220, v67, v99
  v_add_f32 v221, v75, v107
  v_sub_f32 v222, v67, v99
  v_sub_f32 v223, v107, v75
  v_add_f32 v224, v68, v100
  v_add_f32 v225, v76, v108
  v_sub_f32 v226, v68, v100
  v_sub_f32 v227, v108, v76
  v_add_f32 v228, v69, v101
  v_add_f32 v229, v77, v109
  v_sub_f32 v230, v69, v101
  v_sub_f32 v231, v109, v77
  v_add_f32 v232, v70, v102
  v_add_f32 v233, v78, v110
  v_sub_f32 v234, v70, v102
  v_sub_f32 v235, v110, v78
  v_add_f32 v236, v71, v103
  v_add_f32 v237, v79, v111
  v_sub_f32 v238, v71, v103
  v_sub_f32 v239, v111, v79
  s_branch L_x1s
L_x1b:
  v_add_f32 v208, v96, v72
  v_sub_f32 v209, v104, v64
  v_sub_f32 v210, v96, v72
  v_add_f32_e64 v211, -v104, -v64
  v_add_f32 v212, v97, v73
  v_sub_f32 v213, v105, v65
  v_sub_f32 v214, v97, v73
  v_add_f32_e64 v215, -v105, -v65
  v_add_f32 v216, v98, v74
  v_sub_f32 v217, v106, v66
  v_sub_f32 v218, v98, v74
  v_add_f32_e64 v219, -v106, -v66
  v_add_f32 v220, v99, v75
  v_sub_f32 v221, v107, v67
  v_sub_f32 v222, v99, v75
  v_add_f32_e64 v223, -v107, -v67
  v_add_f32 v224, v100, v76
  v_sub_f32 v225, v108, v68
  v_sub_f32 v226, v100, v76
  v_add_f32_e64 v227, -v108, -v68
  v_add_f32 v228, v101, v77
  v_sub_f32 v229, v109, v69
  v_sub_f32 v230, v101, v77
  v_add_f32_e64 v231, -v109, -v69
  v_add_f32 v232, v102, v78
  v_sub_f32 v233, v110, v70
  v_sub_f32 v234, v102, v78
  v_add_f32_e64 v235, -v110, -v70
  v_add_f32 v236, v103, v79
  v_sub_f32 v237, v111, v71
  v_sub_f32 v238, v103, v79
  v_add_f32_e64 v239, -v111, -v71
L_x1s:
  v_cvt_pk_bf16_f32 v112, v208, v209
  v_cvt_pk_bf16_f32 v113, v212, v213
  v_cvt_pk_bf16_f32 v114, v216, v217
  v_cvt_pk_bf16_f32 v115, v220, v221
  s_add_u32 s50, s48, 0
  buffer_store_dwordx4 v[112:115], v243, s[16:19], s50 offen sc0 sc1
  v_cvt_pk_bf16_f32 v116, v210, v211
  v_cvt_pk_bf16_f32 v117, v214, v215
  v_cvt_pk_bf16_f32 v118, v218, v219
  v_cvt_pk_bf16_f32 v119, v222, v223
  s_add_u32 s50, s48, 655360
  buffer_store_dwordx4 v[116:119], v243, s[16:19], s50 offen sc0 sc1
  v_cvt_pk_bf16_f32 v120, v224, v225
  v_cvt_pk_bf16_f32 v121, v228, v229
  v_cvt_pk_bf16_f32 v122, v232, v233
  v_cvt_pk_bf16_f32 v123, v236, v237
  s_add_u32 s50, s48, 65536
  buffer_store_dwordx4 v[120:123], v243, s[16:19], s50 offen sc0 sc1
  v_cvt_pk_bf16_f32 v124, v226, v227
  v_cvt_pk_bf16_f32 v125, v230, v231
  v_cvt_pk_bf16_f32 v126, v234, v235
  v_cvt_pk_bf16_f32 v127, v238, v239
  s_add_u32 s50, s48, 720896
  buffer_store_dwordx4 v[124:127], v243, s[16:19], s50 offen sc0 sc1
  s_nop 1
L_x1e:
L_m_nop0:
  s_lshl_b32 s40, s27, 11
  v_mfma_f32_32x32x16_bf16 v[64:79], v[24:27], v[16:19], 0
  v_mfma_f32_32x32x16_bf16 v[80:95], v[28:31], v[16:19], 0
  v_mfma_f32_32x32x16_bf16 v[96:111], v[32:35], v[16:19], 0
  v_mfma_f32_32x32x16_bf16 v[112:127], v[36:39], v[16:19], 0
  v_mfma_f32_32x32x16_bf16 v[128:143], v[40:43], v[16:19], 0
  v_mfma_f32_32x32x16_bf16 v[144:159], v[44:47], v[16:19], 0
  v_mfma_f32_32x32x16_bf16 v[160:175], v[48:51], v[16:19], 0
  v_mfma_f32_32x32x16_bf16 v[176:191], v[52:55], v[16:19], 0
  v_mfma_f32_32x32x16_bf16 v[192:207], v[56:59], v[16:19], 0

  s_setprio 2
  s_barrier
  v_add_u32 v2, s40, v60
  ds_read_b128 v[8:11], v2 offset:0
  ds_read_b64_tr_b16 v[24:25], v1 offset:0
  ds_read_b64_tr_b16 v[26:27], v1 offset:1536
  ds_read_b64_tr_b16 v[28:29], v1 offset:128
  ds_read_b64_tr_b16 v[30:31], v1 offset:1664
  ds_read_b64_tr_b16 v[32:33], v1 offset:256
  ds_read_b64_tr_b16 v[34:35], v1 offset:1792
  ds_read_b64_tr_b16 v[36:37], v1 offset:3072
  ds_read_b64_tr_b16 v[38:39], v1 offset:4608
  ds_read_b64_tr_b16 v[40:41], v1 offset:3200
  ds_read_b64_tr_b16 v[42:43], v1 offset:4736
  ds_read_b64_tr_b16 v[44:45], v1 offset:3328
  ds_read_b64_tr_b16 v[46:47], v1 offset:4864
  s_waitcnt lgkmcnt(8)
  v_mfma_f32_32x32x16_bf16 v[64:79], v[24:27], v[8:11], v[64:79]
  ds_read_b64_tr_b16 v[48:49], v1 offset:6144
  ds_read_b64_tr_b16 v[50:51], v1 offset:7680
  v_mfma_f32_32x32x16_bf16 v[80:95], v[28:31], v[8:11], v[80:95]
  ds_read_b64_tr_b16 v[52:53], v1 offset:6272
  ds_read_b64_tr_b16 v[54:55], v1 offset:7808
  s_waitcnt lgkmcnt(8)
  v_mfma_f32_32x32x16_bf16 v[96:111], v[32:35], v[8:11], v[96:111]
  ds_read_b64_tr_b16 v[56:57], v1 offset:6400
  ds_read_b64_tr_b16 v[58:59], v1 offset:7936
  v_mfma_f32_32x32x16_bf16 v[112:127], v[36:39], v[8:11], v[112:127]
  ds_read_b64_tr_b16 v[24:25], v1 offset:9216
  ds_read_b64_tr_b16 v[26:27], v1 offset:10752
  v_add_u32 v2, s40, v61
  ds_read_b128 v[12:15], v2 offset:2048
  s_mov_b32 s45, 8
L_g1:
  s_waitcnt lgkmcnt(9)
  v_mfma_f32_32x32x16_bf16 v[128:143], v[40:43], v[8:11], v[128:143]
  ds_read_b64_tr_b16 v[28:29], v1 offset:9344
  ds_read_b64_tr_b16 v[30:31], v1 offset:10880
  v_mfma_f32_32x32x16_bf16 v[144:159], v[44:47], v[8:11], v[144:159]
  ds_read_b64_tr_b16 v[32:33], v1 offset:9472
  ds_read_b64_tr_b16 v[34:35], v1 offset:11008
  s_waitcnt lgkmcnt(9)
  v_mfma_f32_32x32x16_bf16 v[160:175], v[48:51], v[8:11], v[160:175]
  ds_read_b64_tr_b16 v[36:37], v1 offset:12288
  ds_read_b64_tr_b16 v[38:39], v1 offset:13824
  v_mfma_f32_32x32x16_bf16 v[176:191], v[52:55], v[8:11], v[176:191]
  ds_read_b64_tr_b16 v[40:41], v1 offset:12416
  ds_read_b64_tr_b16 v[42:43], v1 offset:13952
  s_waitcnt lgkmcnt(11)
  v_mfma_f32_32x32x16_bf16 v[192:207], v[56:59], v[8:11], v[192:207]
  ds_read_b64_tr_b16 v[44:45], v1 offset:12544
  ds_read_b64_tr_b16 v[46:47], v1 offset:14080
  s_barrier
  s_waitcnt lgkmcnt(8)
  v_mfma_f32_32x32x16_bf16 v[64:79], v[24:27], v[12:15], v[64:79]
  ds_read_b64_tr_b16 v[48:49], v1 offset:15360
  ds_read_b64_tr_b16 v[50:51], v1 offset:16896
  v_mfma_f32_32x32x16_bf16 v[80:95], v[28:31], v[12:15], v[80:95]
  ds_read_b64_tr_b16 v[52:53], v1 offset:15488
  ds_read_b64_tr_b16 v[54:55], v1 offset:17024
  s_waitcnt lgkmcnt(8)
  v_mfma_f32_32x32x16_bf16 v[96:111], v[32:35], v[12:15], v[96:111]
  ds_read_b64_tr_b16 v[56:57], v1 offset:15616
  ds_read_b64_tr_b16 v[58:59], v1 offset:17152
  v_mfma_f32_32x32x16_bf16 v[112:127], v[36:39], v[12:15], v[112:127]
  ds_read_b64_tr_b16 v[24:25], v1 offset:18432
  ds_read_b64_tr_b16 v[26:27], v1 offset:19968
  v_add_u32 v2, s40, v62
  ds_read_b128 v[8:11], v2 offset:4096
  s_waitcnt lgkmcnt(9)
  v_mfma_f32_32x32x16_bf16 v[128:143], v[40:43], v[12:15], v[128:143]
  ds_read_b64_tr_b16 v[28:29], v1 offset:18560
  ds_read_b64_tr_b16 v[30:31], v1 offset:20096
  v_mfma_f32_32x32x16_bf16 v[144:159], v[44:47], v[12:15], v[144:159]
  ds_read_b64_tr_b16 v[32:33], v1 offset:18688
  ds_read_b64_tr_b16 v[34:35], v1 offset:20224
  s_waitcnt lgkmcnt(9)
  v_mfma_f32_32x32x16_bf16 v[160:175], v[48:51], v[12:15], v[160:175]
  ds_read_b64_tr_b16 v[36:37], v1 offset:21504
  ds_read_b64_tr_b16 v[38:39], v1 offset:23040
  v_mfma_f32_32x32x16_bf16 v[176:191], v[52:55], v[12:15], v[176:191]
  ds_read_b64_tr_b16 v[40:41], v1 offset:21632
  ds_read_b64_tr_b16 v[42:43], v1 offset:23168
  s_waitcnt lgkmcnt(11)
  v_mfma_f32_32x32x16_bf16 v[192:207], v[56:59], v[12:15], v[192:207]
  ds_read_b64_tr_b16 v[44:45], v1 offset:21760
  ds_read_b64_tr_b16 v[46:47], v1 offset:23296
  s_barrier
  s_waitcnt lgkmcnt(8)
  v_mfma_f32_32x32x16_bf16 v[64:79], v[24:27], v[8:11], v[64:79]
  ds_read_b64_tr_b16 v[48:49], v1 offset:24576
  ds_read_b64_tr_b16 v[50:51], v1 offset:26112
  v_mfma_f32_32x32x16_bf16 v[80:95], v[28:31], v[8:11], v[80:95]
  ds_read_b64_tr_b16 v[52:53], v1 offset:24704
  ds_read_b64_tr_b16 v[54:55], v1 offset:26240
  s_waitcnt lgkmcnt(8)
  v_mfma_f32_32x32x16_bf16 v[96:111], v[32:35], v[8:11], v[96:111]
  ds_read_b64_tr_b16 v[56:57], v1 offset:24832
  ds_read_b64_tr_b16 v[58:59], v1 offset:26368
  v_mfma_f32_32x32x16_bf16 v[112:127], v[36:39], v[8:11], v[112:127]
  ds_read_b64_tr_b16 v[24:25], v1 offset:27648
  ds_read_b64_tr_b16 v[26:27], v1 offset:29184
  v_add_u32 v2, s40, v63
  ds_read_b128 v[12:15], v2 offset:6144
  s_waitcnt lgkmcnt(9)
  v_mfma_f32_32x32x16_bf16 v[128:143], v[40:43], v[8:11], v[128:143]
  ds_read_b64_tr_b16 v[28:29], v1 offset:27776
  ds_read_b64_tr_b16 v[30:31], v1 offset:29312
  v_mfma_f32_32x32x16_bf16 v[144:159], v[44:47], v[8:11], v[144:159]
  ds_read_b64_tr_b16 v[32:33], v1 offset:27904
  ds_read_b64_tr_b16 v[34:35], v1 offset:29440
  s_waitcnt lgkmcnt(9)
  v_mfma_f32_32x32x16_bf16 v[160:175], v[48:51], v[8:11], v[160:175]
  ds_read_b64_tr_b16 v[36:37], v1 offset:30720
  ds_read_b64_tr_b16 v[38:39], v1 offset:32256
  v_mfma_f32_32x32x16_bf16 v[176:191], v[52:55], v[8:11], v[176:191]
  ds_read_b64_tr_b16 v[40:41], v1 offset:30848
  ds_read_b64_tr_b16 v[42:43], v1 offset:32384
  s_waitcnt lgkmcnt(11)
  v_mfma_f32_32x32x16_bf16 v[192:207], v[56:59], v[8:11], v[192:207]
  ds_read_b64_tr_b16 v[44:45], v1 offset:30976
  ds_read_b64_tr_b16 v[46:47], v1 offset:32512
  s_barrier
  s_waitcnt lgkmcnt(8)
  v_mfma_f32_32x32x16_bf16 v[64:79], v[24:27], v[12:15], v[64:79]
  ds_read_b64_tr_b16 v[48:49], v1 offset:33792
  ds_read_b64_tr_b16 v[50:51], v1 offset:35328
  v_mfma_f32_32x32x16_bf16 v[80:95], v[28:31], v[12:15], v[80:95]
  ds_read_b64_tr_b16 v[52:53], v1 offset:33920
  ds_read_b64_tr_b16 v[54:55], v1 offset:35456
  s_add_u32 s40, s40, 8192
  s_cmp_eq_u32 s40, 73728
  s_cselect_b32 s40, 0, s40
  s_waitcnt lgkmcnt(8)
  v_mfma_f32_32x32x16_bf16 v[96:111], v[32:35], v[12:15], v[96:111]
  ds_read_b64_tr_b16 v[56:57], v1 offset:34048
  ds_read_b64_tr_b16 v[58:59], v1 offset:35584
  v_mfma_f32_32x32x16_bf16 v[112:127], v[36:39], v[12:15], v[112:127]
  ds_read_b64_tr_b16 v[24:25], v1 offset:0
  ds_read_b64_tr_b16 v[26:27], v1 offset:1536
  v_add_u32 v2, s40, v60
  ds_read_b128 v[8:11], v2 offset:0
  s_waitcnt lgkmcnt(9)
  v_mfma_f32_32x32x16_bf16 v[128:143], v[40:43], v[12:15], v[128:143]
  ds_read_b64_tr_b16 v[28:29], v1 offset:128
  ds_read_b64_tr_b16 v[30:31], v1 offset:1664
  v_mfma_f32_32x32x16_bf16 v[144:159], v[44:47], v[12:15], v[144:159]
  ds_read_b64_tr_b16 v[32:33], v1 offset:256
  ds_read_b64_tr_b16 v[34:35], v1 offset:1792
  s_waitcnt lgkmcnt(9)
  v_mfma_f32_32x32x16_bf16 v[160:175], v[48:51], v[12:15], v[160:175]
  ds_read_b64_tr_b16 v[36:37], v1 offset:3072
  ds_read_b64_tr_b16 v[38:39], v1 offset:4608
  v_mfma_f32_32x32x16_bf16 v[176:191], v[52:55], v[12:15], v[176:191]
  ds_read_b64_tr_b16 v[40:41], v1 offset:3200
  ds_read_b64_tr_b16 v[42:43], v1 offset:4736
  s_waitcnt lgkmcnt(11)
  v_mfma_f32_32x32x16_bf16 v[192:207], v[56:59], v[12:15], v[192:207]
  ds_read_b64_tr_b16 v[44:45], v1 offset:3328
  ds_read_b64_tr_b16 v[46:47], v1 offset:4864
  s_waitcnt vmcnt(0)
  s_barrier
  s_waitcnt lgkmcnt(8)
  v_mfma_f32_32x32x16_bf16 v[64:79], v[24:27], v[8:11], v[64:79]
  ds_read_b64_tr_b16 v[48:49], v1 offset:6144
  ds_read_b64_tr_b16 v[50:51], v1 offset:7680
  v_mfma_f32_32x32x16_bf16 v[80:95], v[28:31], v[8:11], v[80:95]
  ds_read_b64_tr_b16 v[52:53], v1 offset:6272
  ds_read_b64_tr_b16 v[54:55], v1 offset:7808
  s_waitcnt lgkmcnt(8)
  v_mfma_f32_32x32x16_bf16 v[96:111], v[32:35], v[8:11], v[96:111]
  ds_read_b64_tr_b16 v[56:57], v1 offset:6400
  ds_read_b64_tr_b16 v[58:59], v1 offset:7936
  v_mfma_f32_32x32x16_bf16 v[112:127], v[36:39], v[8:11], v[112:127]
  s_sub_u32 s45, s45, 1
  s_cmp_lg_u32 s45, 0
  ds_read_b64_tr_b16 v[24:25], v1 offset:9216
  ds_read_b64_tr_b16 v[26:27], v1 offset:10752
  v_add_u32 v2, s40, v61
  ds_read_b128 v[12:15], v2 offset:2048
  s_cbranch_scc1 L_g1
  s_waitcnt lgkmcnt(9)
  v_mfma_f32_32x32x16_bf16 v[128:143], v[40:43], v[8:11], v[128:143]
  ds_read_b64_tr_b16 v[28:29], v1 offset:9344
  ds_read_b64_tr_b16 v[30:31], v1 offset:10880
  v_mfma_f32_32x32x16_bf16 v[144:159], v[44:47], v[8:11], v[144:159]
  ds_read_b64_tr_b16 v[32:33], v1 offset:9472
  ds_read_b64_tr_b16 v[34:35], v1 offset:11008
  s_waitcnt lgkmcnt(9)
  v_mfma_f32_32x32x16_bf16 v[160:175], v[48:51], v[8:11], v[160:175]
  ds_read_b64_tr_b16 v[36:37], v1 offset:12288
  ds_read_b64_tr_b16 v[38:39], v1 offset:13824
  v_mfma_f32_32x32x16_bf16 v[176:191], v[52:55], v[8:11], v[176:191]
  ds_read_b64_tr_b16 v[40:41], v1 offset:12416
  ds_read_b64_tr_b16 v[42:43], v1 offset:13952
  s_waitcnt lgkmcnt(11)
  v_mfma_f32_32x32x16_bf16 v[192:207], v[56:59], v[8:11], v[192:207]
  ds_read_b64_tr_b16 v[44:45], v1 offset:12544
  ds_read_b64_tr_b16 v[46:47], v1 offset:14080
  s_barrier
  s_waitcnt lgkmcnt(8)
  v_mfma_f32_32x32x16_bf16 v[64:79], v[24:27], v[12:15], v[64:79]
  ds_read_b64_tr_b16 v[48:49], v1 offset:15360
  ds_read_b64_tr_b16 v[50:51], v1 offset:16896
  v_mfma_f32_32x32x16_bf16 v[80:95], v[28:31], v[12:15], v[80:95]
  ds_read_b64_tr_b16 v[52:53], v1 offset:15488
  ds_read_b64_tr_b16 v[54:55], v1 offset:17024
  s_waitcnt lgkmcnt(8)
  v_mfma_f32_32x32x16_bf16 v[96:111], v[32:35], v[12:15], v[96:111]
  ds_read_b64_tr_b16 v[56:57], v1 offset:15616
  ds_read_b64_tr_b16 v[58:59], v1 offset:17152
  v_mfma_f32_32x32x16_bf16 v[112:127], v[36:39], v[12:15], v[112:127]
  ds_read_b64_tr_b16 v[24:25], v1 offset:18432
  ds_read_b64_tr_b16 v[26:27], v1 offset:19968
  v_add_u32 v2, s40, v62
  ds_read_b128 v[8:11], v2 offset:4096
  s_waitcnt lgkmcnt(9)
  v_mfma_f32_32x32x16_bf16 v[128:143], v[40:43], v[12:15], v[128:143]
  ds_read_b64_tr_b16 v[28:29], v1 offset:18560
  ds_read_b64_tr_b16 v[30:31], v1 offset:20096
  v_mfma_f32_32x32x16_bf16 v[144:159], v[44:47], v[12:15], v[144:159]
  ds_read_b64_tr_b16 v[32:33], v1 offset:18688
  ds_read_b64_tr_b16 v[34:35], v1 offset:20224
  s_waitcnt lgkmcnt(9)
  v_mfma_f32_32x32x16_bf16 v[160:175], v[48:51], v[12:15], v[160:175]
  ds_read_b64_tr_b16 v[36:37], v1 offset:21504
  ds_read_b64_tr_b16 v[38:39], v1 offset:23040
  v_mfma_f32_32x32x16_bf16 v[176:191], v[52:55], v[12:15], v[176:191]
  ds_read_b64_tr_b16 v[40:41], v1 offset:21632
  ds_read_b64_tr_b16 v[42:43], v1 offset:23168
  s_waitcnt lgkmcnt(11)
  v_mfma_f32_32x32x16_bf16 v[192:207], v[56:59], v[12:15], v[192:207]
  ds_read_b64_tr_b16 v[44:45], v1 offset:21760
  ds_read_b64_tr_b16 v[46:47], v1 offset:23296
  s_barrier
  s_waitcnt lgkmcnt(8)
  v_mfma_f32_32x32x16_bf16 v[64:79], v[24:27], v[8:11], v[64:79]
  ds_read_b64_tr_b16 v[48:49], v1 offset:24576
  ds_read_b64_tr_b16 v[50:51], v1 offset:26112
  v_mfma_f32_32x32x16_bf16 v[80:95], v[28:31], v[8:11], v[80:95]
  ds_read_b64_tr_b16 v[52:53], v1 offset:24704
  ds_read_b64_tr_b16 v[54:55], v1 offset:26240
  s_waitcnt lgkmcnt(8)
  v_mfma_f32_32x32x16_bf16 v[96:111], v[32:35], v[8:11], v[96:111]
  ds_read_b64_tr_b16 v[56:57], v1 offset:24832
  ds_read_b64_tr_b16 v[58:59], v1 offset:26368
  v_mfma_f32_32x32x16_bf16 v[112:127], v[36:39], v[8:11], v[112:127]
  ds_read_b64_tr_b16 v[24:25], v1 offset:27648
  ds_read_b64_tr_b16 v[26:27], v1 offset:29184
  v_add_u32 v2, s40, v63
  ds_read_b128 v[12:15], v2 offset:6144
  s_waitcnt lgkmcnt(9)
  v_mfma_f32_32x32x16_bf16 v[128:143], v[40:43], v[8:11], v[128:143]
  ds_read_b64_tr_b16 v[28:29], v1 offset:27776
  ds_read_b64_tr_b16 v[30:31], v1 offset:29312
  v_mfma_f32_32x32x16_bf16 v[144:159], v[44:47], v[8:11], v[144:159]
  ds_read_b64_tr_b16 v[32:33], v1 offset:27904
  ds_read_b64_tr_b16 v[34:35], v1 offset:29440
  s_waitcnt lgkmcnt(9)
  v_mfma_f32_32x32x16_bf16 v[160:175], v[48:51], v[8:11], v[160:175]
  ds_read_b64_tr_b16 v[36:37], v1 offset:30720
  ds_read_b64_tr_b16 v[38:39], v1 offset:32256
  v_mfma_f32_32x32x16_bf16 v[176:191], v[52:55], v[8:11], v[176:191]
  ds_read_b64_tr_b16 v[40:41], v1 offset:30848
  ds_read_b64_tr_b16 v[42:43], v1 offset:32384
  s_waitcnt lgkmcnt(11)
  v_mfma_f32_32x32x16_bf16 v[192:207], v[56:59], v[8:11], v[192:207]
  ds_read_b64_tr_b16 v[44:45], v1 offset:30976
  ds_read_b64_tr_b16 v[46:47], v1 offset:32512
  s_barrier
  s_waitcnt lgkmcnt(8)
  v_mfma_f32_32x32x16_bf16 v[64:79], v[24:27], v[12:15], v[64:79]
  ds_read_b64_tr_b16 v[48:49], v1 offset:33792
  ds_read_b64_tr_b16 v[50:51], v1 offset:35328
  v_mfma_f32_32x32x16_bf16 v[80:95], v[28:31], v[12:15], v[80:95]
  ds_read_b64_tr_b16 v[52:53], v1 offset:33920
  ds_read_b64_tr_b16 v[54:55], v1 offset:35456
  s_add_u32 s40, s40, 8192
  s_cmp_eq_u32 s40, 73728
  s_cselect_b32 s40, 0, s40
  s_waitcnt lgkmcnt(8)
  v_mfma_f32_32x32x16_bf16 v[96:111], v[32:35], v[12:15], v[96:111]
  ds_read_b64_tr_b16 v[56:57], v1 offset:34048
  ds_read_b64_tr_b16 v[58:59], v1 offset:35584
  v_mfma_f32_32x32x16_bf16 v[112:127], v[36:39], v[12:15], v[112:127]
  s_waitcnt lgkmcnt(6)
  v_mfma_f32_32x32x16_bf16 v[128:143], v[40:43], v[12:15], v[128:143]
  v_mfma_f32_32x32x16_bf16 v[144:159], v[44:47], v[12:15], v[144:159]
  s_waitcnt lgkmcnt(2)
  v_mfma_f32_32x32x16_bf16 v[160:175], v[48:51], v[12:15], v[160:175]
  v_mfma_f32_32x32x16_bf16 v[176:191], v[52:55], v[12:15], v[176:191]
  s_waitcnt lgkmcnt(0)
  v_mfma_f32_32x32x16_bf16 v[192:207], v[56:59], v[12:15], v[192:207]
  s_barrier
  s_lshl_b32 s46, s31, 12
  v_add_u32 v243, s46, v5
  v_add_u32 v246, 32768, v243
  v_mul_f32_e64 v64, v64, |v64|
  v_mul_f32_e64 v65, v65, |v65|
  v_mul_f32_e64 v66, v66, |v66|
  v_mul_f32_e64 v67, v67, |v67|
  v_mul_f32_e64 v68, v68, |v68|
  v_mul_f32_e64 v69, v69, |v69|
  v_mul_f32_e64 v70, v70, |v70|
  v_mul_f32_e64 v71, v71, |v71|
  v_mul_f32_e64 v72, v72, |v72|
  v_mul_f32_e64 v73, v73, |v73|
  v_mul_f32_e64 v74, v74, |v74|
  v_mul_f32_e64 v75, v75, |v75|
  v_mul_f32_e64 v76, v76, |v76|
  v_mul_f32_e64 v77, v77, |v77|
  v_mul_f32_e64 v78, v78, |v78|
  v_mul_f32_e64 v79, v79, |v79|
  v_cvt_pk_bf16_f32 v248, v64, v65
  v_cvt_pk_bf16_f32 v249, v66, v67
  v_cvt_pk_bf16_f32 v250, v68, v69
  v_cvt_pk_bf16_f32 v251, v70, v71
  v_cvt_pk_bf16_f32 v252, v72, v73
  v_cvt_pk_bf16_f32 v253, v74, v75
  v_cvt_pk_bf16_f32 v254, v76, v77
  v_cvt_pk_bf16_f32 v255, v78, v79
  v_pk_max_i16 v248, v248, 0
  v_pk_max_i16 v249, v249, 0
  v_pk_max_i16 v250, v250, 0
  v_pk_max_i16 v251, v251, 0
  v_pk_max_i16 v252, v252, 0
  v_pk_max_i16 v253, v253, 0
  v_pk_max_i16 v254, v254, 0
  v_pk_max_i16 v255, v255, 0
  ds_write_b128 v243, v[248:251] offset:0
  ds_write_b128 v243, v[252:255] offset:2048
  v_mul_f32_e64 v80, v80, |v80|
  v_mul_f32_e64 v81, v81, |v81|
  v_mul_f32_e64 v82, v82, |v82|
  v_mul_f32_e64 v83, v83, |v83|
  v_mul_f32_e64 v84, v84, |v84|
  v_mul_f32_e64 v85, v85, |v85|
  v_mul_f32_e64 v86, v86, |v86|
  v_mul_f32_e64 v87, v87, |v87|
  v_mul_f32_e64 v88, v88, |v88|
  v_mul_f32_e64 v89, v89, |v89|
  v_mul_f32_e64 v90, v90, |v90|
  v_mul_f32_e64 v91, v91, |v91|
  v_mul_f32_e64 v92, v92, |v92|
  v_mul_f32_e64 v93, v93, |v93|
  v_mul_f32_e64 v94, v94, |v94|
  v_mul_f32_e64 v95, v95, |v95|
  v_cvt_pk_bf16_f32 v248, v80, v81
  v_cvt_pk_bf16_f32 v249, v82, v83
  v_cvt_pk_bf16_f32 v250, v84, v85
  v_cvt_pk_bf16_f32 v251, v86, v87
  v_cvt_pk_bf16_f32 v252, v88, v89
  v_cvt_pk_bf16_f32 v253, v90, v91
  v_cvt_pk_bf16_f32 v254, v92, v93
  v_cvt_pk_bf16_f32 v255, v94, v95
  v_pk_max_i16 v248, v248, 0
  v_pk_max_i16 v249, v249, 0
  v_pk_max_i16 v250, v250, 0
  v_pk_max_i16 v251, v251, 0
  v_pk_max_i16 v252, v252, 0
  v_pk_max_i16 v253, v253, 0
  v_pk_max_i16 v254, v254, 0
  v_pk_max_i16 v255, v255, 0
  ds_write_b128 v243, v[248:251] offset:8192
  ds_write_b128 v243, v[252:255] offset:10240
  v_mul_f32_e64 v96, v96, |v96|
  v_mul_f32_e64 v97, v97, |v97|
  v_mul_f32_e64 v98, v98, |v98|
  v_mul_f32_e64 v99, v99, |v99|
  v_mul_f32_e64 v100, v100, |v100|
  v_mul_f32_e64 v101, v101, |v101|
  v_mul_f32_e64 v102, v102, |v102|
  v_mul_f32_e64 v103, v103, |v103|
  v_mul_f32_e64 v104, v104, |v104|
  v_mul_f32_e64 v105, v105, |v105|
  v_mul_f32_e64 v106, v106, |v106|
  v_mul_f32_e64 v107, v107, |v107|
  v_mul_f32_e64 v108, v108, |v108|
  v_mul_f32_e64 v109, v109, |v109|
  v_mul_f32_e64 v110, v110, |v110|
  v_mul_f32_e64 v111, v111, |v111|
  v_cvt_pk_bf16_f32 v248, v96, v97
  v_cvt_pk_bf16_f32 v249, v98, v99
  v_cvt_pk_bf16_f32 v250, v100, v101
  v_cvt_pk_bf16_f32 v251, v102, v103
  v_cvt_pk_bf16_f32 v252, v104, v105
  v_cvt_pk_bf16_f32 v253, v106, v107
  v_cvt_pk_bf16_f32 v254, v108, v109
  v_cvt_pk_bf16_f32 v255, v110, v111
  v_pk_max_i16 v248, v248, 0
  v_pk_max_i16 v249, v249, 0
  v_pk_max_i16 v250, v250, 0
  v_pk_max_i16 v251, v251, 0
  v_pk_max_i16 v252, v252, 0
  v_pk_max_i16 v253, v253, 0
  v_pk_max_i16 v254, v254, 0
  v_pk_max_i16 v255, v255, 0
  ds_write_b128 v243, v[248:251] offset:16384
  ds_write_b128 v243, v[252:255] offset:18432
  v_mul_f32_e64 v112, v112, |v112|
  v_mul_f32_e64 v113, v113, |v113|
  v_mul_f32_e64 v114, v114, |v114|
  v_mul_f32_e64 v115, v115, |v115|
  v_mul_f32_e64 v116, v116, |v116|
  v_mul_f32_e64 v117, v117, |v117|
  v_mul_f32_e64 v118, v118, |v118|
  v_mul_f32_e64 v119, v119, |v119|
  v_mul_f32_e64 v120, v120, |v120|
  v_mul_f32_e64 v121, v121, |v121|
  v_mul_f32_e64 v122, v122, |v122|
  v_mul_f32_e64 v123, v123, |v123|
  v_mul_f32_e64 v124, v124, |v124|
  v_mul_f32_e64 v125, v125, |v125|
  v_mul_f32_e64 v126, v126, |v126|
  v_mul_f32_e64 v127, v127, |v127|
  v_cvt_pk_bf16_f32 v248, v112, v113
  v_cvt_pk_bf16_f32 v249, v114, v115
  v_cvt_pk_bf16_f32 v250, v116, v117
  v_cvt_pk_bf16_f32 v251, v118, v119
  v_cvt_pk_bf16_f32 v252, v120, v121
  v_cvt_pk_bf16_f32 v253, v122, v123
  v_cvt_pk_bf16_f32 v254, v124, v125
  v_cvt_pk_bf16_f32 v255, v126, v127
  v_pk_max_i16 v248, v248, 0
  v_pk_max_i16 v249, v249, 0
  v_pk_max_i16 v250, v250, 0
  v_pk_max_i16 v251, v251, 0
  v_pk_max_i16 v252, v252, 0
  v_pk_max_i16 v253, v253, 0
  v_pk_max_i16 v254, v254, 0
  v_pk_max_i16 v255, v255, 0
  ds_write_b128 v243, v[248:251] offset:24576
  ds_write_b128 v243, v[252:255] offset:26624
  s_barrier
  v_mul_f32_e64 v128, v128, |v128|
  v_mul_f32_e64 v129, v129, |v129|
  v_mul_f32_e64 v130, v130, |v130|
  v_mul_f32_e64 v131, v131, |v131|
  v_mul_f32_e64 v132, v132, |v132|
  v_mul_f32_e64 v133, v133, |v133|
  v_mul_f32_e64 v134, v134, |v134|
  v_mul_f32_e64 v135, v135, |v135|
  v_mul_f32_e64 v136, v136, |v136|
  v_mul_f32_e64 v137, v137, |v137|
  v_mul_f32_e64 v138, v138, |v138|
  v_mul_f32_e64 v139, v139, |v139|
  v_mul_f32_e64 v140, v140, |v140|
  v_mul_f32_e64 v141, v141, |v141|
  v_mul_f32_e64 v142, v142, |v142|
  v_mul_f32_e64 v143, v143, |v143|
  v_cvt_pk_bf16_f32 v248, v128, v129
  v_cvt_pk_bf16_f32 v249, v130, v131
  v_cvt_pk_bf16_f32 v250, v132, v133
  v_cvt_pk_bf16_f32 v251, v134, v135
  v_cvt_pk_bf16_f32 v252, v136, v137
  v_cvt_pk_bf16_f32 v253, v138, v139
  v_cvt_pk_bf16_f32 v254, v140, v141
  v_cvt_pk_bf16_f32 v255, v142, v143
  v_pk_max_i16 v248, v248, 0
  v_pk_max_i16 v249, v249, 0
  v_pk_max_i16 v250, v250, 0
  v_pk_max_i16 v251, v251, 0
  v_pk_max_i16 v252, v252, 0
  v_pk_max_i16 v253, v253, 0
  v_pk_max_i16 v254, v254, 0
  v_pk_max_i16 v255, v255, 0
  ds_write_b128 v246, v[248:251] offset:0
  ds_write_b128 v246, v[252:255] offset:2048
  v_mul_f32_e64 v144, v144, |v144|
  v_mul_f32_e64 v145, v145, |v145|
  v_mul_f32_e64 v146, v146, |v146|
  v_mul_f32_e64 v147, v147, |v147|
  v_mul_f32_e64 v148, v148, |v148|
  v_mul_f32_e64 v149, v149, |v149|
  v_mul_f32_e64 v150, v150, |v150|
  v_mul_f32_e64 v151, v151, |v151|
  v_mul_f32_e64 v152, v152, |v152|
  v_mul_f32_e64 v153, v153, |v153|
  v_mul_f32_e64 v154, v154, |v154|
  v_mul_f32_e64 v155, v155, |v155|
  v_mul_f32_e64 v156, v156, |v156|
  v_mul_f32_e64 v157, v157, |v157|
  v_mul_f32_e64 v158, v158, |v158|
  v_mul_f32_e64 v159, v159, |v159|
  v_cvt_pk_bf16_f32 v248, v144, v145
  v_cvt_pk_bf16_f32 v249, v146, v147
  v_cvt_pk_bf16_f32 v250, v148, v149
  v_cvt_pk_bf16_f32 v251, v150, v151
  v_cvt_pk_bf16_f32 v252, v152, v153
  v_cvt_pk_bf16_f32 v253, v154, v155
  v_cvt_pk_bf16_f32 v254, v156, v157
  v_cvt_pk_bf16_f32 v255, v158, v159
  v_pk_max_i16 v248, v248, 0
  v_pk_max_i16 v249, v249, 0
  v_pk_max_i16 v250, v250, 0
  v_pk_max_i16 v251, v251, 0
  v_pk_max_i16 v252, v252, 0
  v_pk_max_i16 v253, v253, 0
  v_pk_max_i16 v254, v254, 0
  v_pk_max_i16 v255, v255, 0
  ds_write_b128 v246, v[248:251] offset:8192
  ds_write_b128 v246, v[252:255] offset:10240
  v_mul_f32_e64 v160, v160, |v160|
  v_mul_f32_e64 v161, v161, |v161|
  v_mul_f32_e64 v162, v162, |v162|
  v_mul_f32_e64 v163, v163, |v163|
  v_mul_f32_e64 v164, v164, |v164|
  v_mul_f32_e64 v165, v165, |v165|
  v_mul_f32_e64 v166, v166, |v166|
  v_mul_f32_e64 v167, v167, |v167|
  v_mul_f32_e64 v168, v168, |v168|
  v_mul_f32_e64 v169, v169, |v169|
  v_mul_f32_e64 v170, v170, |v170|
  v_mul_f32_e64 v171, v171, |v171|
  v_mul_f32_e64 v172, v172, |v172|
  v_mul_f32_e64 v173, v173, |v173|
  v_mul_f32_e64 v174, v174, |v174|
  v_mul_f32_e64 v175, v175, |v175|
  v_cvt_pk_bf16_f32 v248, v160, v161
  v_cvt_pk_bf16_f32 v249, v162, v163
  v_cvt_pk_bf16_f32 v250, v164, v165
  v_cvt_pk_bf16_f32 v251, v166, v167
  v_cvt_pk_bf16_f32 v252, v168, v169
  v_cvt_pk_bf16_f32 v253, v170, v171
  v_cvt_pk_bf16_f32 v254, v172, v173
  v_cvt_pk_bf16_f32 v255, v174, v175
  v_pk_max_i16 v248, v248, 0
  v_pk_max_i16 v249, v249, 0
  v_pk_max_i16 v250, v250, 0
  v_pk_max_i16 v251, v251, 0
  v_pk_max_i16 v252, v252, 0
  v_pk_max_i16 v253, v253, 0
  v_pk_max_i16 v254, v254, 0
  v_pk_max_i16 v255, v255, 0
  ds_write_b128 v246, v[248:251] offset:16384
  ds_write_b128 v246, v[252:255] offset:18432
  v_mul_f32_e64 v176, v176, |v176|
  v_mul_f32_e64 v177, v177, |v177|
  v_mul_f32_e64 v178, v178, |v178|
  v_mul_f32_e64 v179, v179, |v179|
  v_mul_f32_e64 v180, v180, |v180|
  v_mul_f32_e64 v181, v181, |v181|
  v_mul_f32_e64 v182, v182, |v182|
  v_mul_f32_e64 v183, v183, |v183|
  v_mul_f32_e64 v184, v184, |v184|
  v_mul_f32_e64 v185, v185, |v185|
  v_mul_f32_e64 v186, v186, |v186|
  v_mul_f32_e64 v187, v187, |v187|
  v_mul_f32_e64 v188, v188, |v188|
  v_mul_f32_e64 v189, v189, |v189|
  v_mul_f32_e64 v190, v190, |v190|
  v_mul_f32_e64 v191, v191, |v191|
  v_cvt_pk_bf16_f32 v248, v176, v177
  v_cvt_pk_bf16_f32 v249, v178, v179
  v_cvt_pk_bf16_f32 v250, v180, v181
  v_cvt_pk_bf16_f32 v251, v182, v183
  v_cvt_pk_bf16_f32 v252, v184, v185
  v_cvt_pk_bf16_f32 v253, v186, v187
  v_cvt_pk_bf16_f32 v254, v188, v189
  v_cvt_pk_bf16_f32 v255, v190, v191
  v_pk_max_i16 v248, v248, 0
  v_pk_max_i16 v249, v249, 0
  v_pk_max_i16 v250, v250, 0
  v_pk_max_i16 v251, v251, 0
  v_pk_max_i16 v252, v252, 0
  v_pk_max_i16 v253, v253, 0
  v_pk_max_i16 v254, v254, 0
  v_pk_max_i16 v255, v255, 0
  ds_write_b128 v246, v[248:251] offset:24576
  ds_write_b128 v246, v[252:255] offset:26624
  v_mul_f32_e64 v192, v192, |v192|
  v_mul_f32_e64 v193, v193, |v193|
  v_mul_f32_e64 v194, v194, |v194|
  v_mul_f32_e64 v195, v195, |v195|
  v_mul_f32_e64 v196, v196, |v196|
  v_mul_f32_e64 v197, v197, |v197|
  v_mul_f32_e64 v198, v198, |v198|
  v_mul_f32_e64 v199, v199, |v199|
  v_mul_f32_e64 v200, v200, |v200|
  v_mul_f32_e64 v201, v201, |v201|
  v_mul_f32_e64 v202, v202, |v202|
  v_mul_f32_e64 v203, v203, |v203|
  v_mul_f32_e64 v204, v204, |v204|
  v_mul_f32_e64 v205, v205, |v205|
  v_mul_f32_e64 v206, v206, |v206|
  v_mul_f32_e64 v207, v207, |v207|
  v_cvt_pk_bf16_f32 v248, v192, v193
  v_cvt_pk_bf16_f32 v249, v194, v195
  v_cvt_pk_bf16_f32 v250, v196, v197
  v_cvt_pk_bf16_f32 v251, v198, v199
  v_cvt_pk_bf16_f32 v252, v200, v201
  v_cvt_pk_bf16_f32 v253, v202, v203
  v_cvt_pk_bf16_f32 v254, v204, v205
  v_cvt_pk_bf16_f32 v255, v206, v207
  v_pk_max_i16 v248, v248, 0
  v_pk_max_i16 v249, v249, 0
  v_pk_max_i16 v250, v250, 0
  v_pk_max_i16 v251, v251, 0
  v_pk_max_i16 v252, v252, 0
  v_pk_max_i16 v253, v253, 0
  v_pk_max_i16 v254, v254, 0
  v_pk_max_i16 v255, v255, 0
  ds_write_b128 v246, v[248:251] offset:32768
  ds_write_b128 v246, v[252:255] offset:34816
  s_lshl_b32 s47, s2, 2
  s_add_u32 s47, s47, s24
  s_mul_i32 s47, s47, 18432
  s_add_u32 s47, s47, 20971520
  s_lshl_b32 s40, s27, 11
  v_add_u32 v2, s40, v5
  s_waitcnt lgkmcnt(0)
  s_barrier
  s_cmp_lt_i32 s28, 0
  s_cbranch_scc1 L_m_nx
  s_barrier
  s_barrier
  s_barrier
L_m_nx:
  ds_read_b128 v[8:11], v2 offset:0
  ds_read_b128 v[12:15], v2 offset:2048
  ds_read_b64_tr_b16 v[24:25], v1 offset:0
  ds_read_b64_tr_b16 v[26:27], v1 offset:1536
  ds_read_b64_tr_b16 v[28:29], v1 offset:128
  ds_read_b64_tr_b16 v[30:31], v1 offset:1664
  ds_read_b64_tr_b16 v[32:33], v1 offset:256
  ds_read_b64_tr_b16 v[34:35], v1 offset:1792
  ds_read_b64_tr_b16 v[36:37], v1 offset:3072
  ds_read_b64_tr_b16 v[38:39], v1 offset:4608
  ds_read_b64_tr_b16 v[40:41], v1 offset:3200
  ds_read_b64_tr_b16 v[42:43], v1 offset:4736
  ds_read_b64_tr_b16 v[44:45], v1 offset:3328
  ds_read_b64_tr_b16 v[46:47], v1 offset:4864
  s_waitcnt lgkmcnt(8)
  v_mfma_f32_32x32x16_bf16 v[64:79], v[24:27], v[8:11], 0
  ds_read_b64_tr_b16 v[48:49], v1 offset:6144
  ds_read_b64_tr_b16 v[50:51], v1 offset:7680
  v_mfma_f32_32x32x16_bf16 v[80:95], v[28:31], v[8:11], 0
  ds_read_b64_tr_b16 v[52:53], v1 offset:6272
  ds_read_b64_tr_b16 v[54:55], v1 offset:7808
  ds_read_b128 v[16:19], v2 offset:4096
  s_waitcnt lgkmcnt(9)
  v_mfma_f32_32x32x16_bf16 v[96:111], v[32:35], v[8:11], 0
  ds_read_b64_tr_b16 v[56:57], v1 offset:6400
  ds_read_b64_tr_b16 v[58:59], v1 offset:7936
  v_mfma_f32_32x32x16_bf16 v[64:79], v[36:39], v[12:15], v[64:79]
  ds_read_b64_tr_b16 v[24:25], v1 offset:9216
  ds_read_b64_tr_b16 v[26:27], v1 offset:10752
  s_waitcnt lgkmcnt(9)
  v_mfma_f32_32x32x16_bf16 v[80:95], v[40:43], v[12:15], v[80:95]
  ds_read_b64_tr_b16 v[28:29], v1 offset:9344
  ds_read_b64_tr_b16 v[30:31], v1 offset:10880
  ds_read_b128 v[20:23], v2 offset:6144
  v_mfma_f32_32x32x16_bf16 v[96:111], v[44:47], v[12:15], v[96:111]
  ds_read_b64_tr_b16 v[32:33], v1 offset:9472
  ds_read_b64_tr_b16 v[34:35], v1 offset:11008
  s_waitcnt lgkmcnt(9)
  v_mfma_f32_32x32x16_bf16 v[64:79], v[48:51], v[16:19], v[64:79]
  ds_read_b64_tr_b16 v[36:37], v1 offset:12288
  ds_read_b64_tr_b16 v[38:39], v1 offset:13824
  s_add_u32 s40, s40, 8192
  s_cmp_eq_u32 s40, 73728
  s_cselect_b32 s40, 0, s40
  v_mfma_f32_32x32x16_bf16 v[80:95], v[52:55], v[16:19], v[80:95]
  ds_read_b64_tr_b16 v[40:41], v1 offset:12416
  ds_read_b64_tr_b16 v[42:43], v1 offset:13952
  v_add_u32 v2, s40, v5
  ds_read_b128 v[8:11], v2 offset:0
  s_waitcnt lgkmcnt(12)
  v_mfma_f32_32x32x16_bf16 v[96:111], v[56:59], v[16:19], v[96:111]
  ds_read_b64_tr_b16 v[44:45], v1 offset:12544
  ds_read_b64_tr_b16 v[46:47], v1 offset:14080
  s_barrier
  s_waitcnt lgkmcnt(9)
  v_mfma_f32_32x32x16_bf16 v[64:79], v[24:27], v[20:23], v[64:79]
  ds_read_b64_tr_b16 v[48:49], v1 offset:15360
  ds_read_b64_tr_b16 v[50:51], v1 offset:16896
  v_mfma_f32_32x32x16_bf16 v[80:95], v[28:31], v[20:23], v[80:95]
  ds_read_b64_tr_b16 v[52:53], v1 offset:15488
  ds_read_b64_tr_b16 v[54:55], v1 offset:17024
  ds_read_b128 v[12:15], v2 offset:2048
  s_waitcnt lgkmcnt(7)
  v_mfma_f32_32x32x16_bf16 v[96:111], v[32:35], v[20:23], v[96:111]
  ds_read_b64_tr_b16 v[56:57], v1 offset:15616
  ds_read_b64_tr_b16 v[58:59], v1 offset:17152
  v_mfma_f32_32x32x16_bf16 v[64:79], v[36:39], v[8:11], v[64:79]
  ds_read_b64_tr_b16 v[24:25], v1 offset:18432
  ds_read_b64_tr_b16 v[26:27], v1 offset:19968
  s_waitcnt lgkmcnt(9)
  v_mfma_f32_32x32x16_bf16 v[80:95], v[40:43], v[8:11], v[80:95]
  ds_read_b64_tr_b16 v[28:29], v1 offset:18560
  ds_read_b64_tr_b16 v[30:31], v1 offset:20096
  ds_read_b128 v[16:19], v2 offset:4096
  v_mfma_f32_32x32x16_bf16 v[96:111], v[44:47], v[8:11], v[96:111]
  ds_read_b64_tr_b16 v[32:33], v1 offset:18688
  ds_read_b64_tr_b16 v[34:35], v1 offset:20224
  s_waitcnt lgkmcnt(9)
  v_mfma_f32_32x32x16_bf16 v[64:79], v[48:51], v[12:15], v[64:79]
  ds_read_b64_tr_b16 v[36:37], v1 offset:21504
  ds_read_b64_tr_b16 v[38:39], v1 offset:23040
  v_mfma_f32_32x32x16_bf16 v[80:95], v[52:55], v[12:15], v[80:95]
  ds_read_b64_tr_b16 v[40:41], v1 offset:21632
  ds_read_b64_tr_b16 v[42:43], v1 offset:23168
  ds_read_b128 v[20:23], v2 offset:6144
  s_waitcnt lgkmcnt(12)
  v_mfma_f32_32x32x16_bf16 v[96:111], v[56:59], v[12:15], v[96:111]
  ds_read_b64_tr_b16 v[44:45], v1 offset:21760
  ds_read_b64_tr_b16 v[46:47], v1 offset:23296
  s_barrier
  s_waitcnt lgkmcnt(9)
  v_mfma_f32_32x32x16_bf16 v[64:79], v[24:27], v[16:19], v[64:79]
  ds_read_b64_tr_b16 v[48:49], v1 offset:24576
  ds_read_b64_tr_b16 v[50:51], v1 offset:26112
  s_add_u32 s40, s40, 8192
  s_cmp_eq_u32 s40, 73728
  s_cselect_b32 s40, 0, s40
  v_mfma_f32_32x32x16_bf16 v[80:95], v[28:31], v[16:19], v[80:95]
  ds_read_b64_tr_b16 v[52:53], v1 offset:24704
  ds_read_b64_tr_b16 v[54:55], v1 offset:26240
  v_add_u32 v2, s40, v5
  ds_read_b128 v[8:11], v2 offset:0
  s_waitcnt lgkmcnt(7)
  v_mfma_f32_32x32x16_bf16 v[96:111], v[32:35], v[16:19], v[96:111]
  ds_read_b64_tr_b16 v[56:57], v1 offset:24832
  ds_read_b64_tr_b16 v[58:59], v1 offset:26368
  v_mfma_f32_32x32x16_bf16 v[64:79], v[36:39], v[20:23], v[64:79]
  ds_read_b64_tr_b16 v[24:25], v1 offset:27648
  ds_read_b64_tr_b16 v[26:27], v1 offset:29184
  s_waitcnt lgkmcnt(9)
  v_mfma_f32_32x32x16_bf16 v[80:95], v[40:43], v[20:23], v[80:95]
  ds_read_b64_tr_b16 v[28:29], v1 offset:27776
  ds_read_b64_tr_b16 v[30:31], v1 offset:29312
  ds_read_b128 v[12:15], v2 offset:2048
  v_mfma_f32_32x32x16_bf16 v[96:111], v[44:47], v[20:23], v[96:111]
  ds_read_b64_tr_b16 v[32:33], v1 offset:27904
  ds_read_b64_tr_b16 v[34:35], v1 offset:29440
  s_waitcnt lgkmcnt(9)
  v_mfma_f32_32x32x16_bf16 v[64:79], v[48:51], v[8:11], v[64:79]
  ds_read_b64_tr_b16 v[36:37], v1 offset:30720
  ds_read_b64_tr_b16 v[38:39], v1 offset:32256
  v_mfma_f32_32x32x16_bf16 v[80:95], v[52:55], v[8:11], v[80:95]
  ds_read_b64_tr_b16 v[40:41], v1 offset:30848
  ds_read_b64_tr_b16 v[42:43], v1 offset:32384
  ds_read_b128 v[16:19], v2 offset:4096
  s_waitcnt lgkmcnt(12)
  v_mfma_f32_32x32x16_bf16 v[96:111], v[56:59], v[8:11], v[96:111]
  ds_read_b64_tr_b16 v[44:45], v1 offset:30976
  ds_read_b64_tr_b16 v[46:47], v1 offset:32512
  s_barrier
  s_waitcnt lgkmcnt(9)
  v_mfma_f32_32x32x16_bf16 v[64:79], v[24:27], v[12:15], v[64:79]
  ds_read_b64_tr_b16 v[48:49], v1 offset:33792
  ds_read_b64_tr_b16 v[50:51], v1 offset:35328
  v_mfma_f32_32x32x16_bf16 v[80:95], v[28:31], v[12:15], v[80:95]
  ds_read_b64_tr_b16 v[52:53], v1 offset:33920
  ds_read_b64_tr_b16 v[54:55], v1 offset:35456
  ds_read_b128 v[20:23], v2 offset:6144
  s_waitcnt lgkmcnt(7)
  v_mfma_f32_32x32x16_bf16 v[96:111], v[32:35], v[12:15], v[96:111]
  ds_read_b64_tr_b16 v[56:57], v1 offset:34048
  ds_read_b64_tr_b16 v[58:59], v1 offset:35584
  v_mfma_f32_32x32x16_bf16 v[64:79], v[36:39], v[16:19], v[64:79]
  ds_read_b64_tr_b16 v[24:25], v1 offset:0
  ds_read_b64_tr_b16 v[26:27], v1 offset:1536
  s_add_u32 s40, s40, 8192
  s_cmp_eq_u32 s40, 73728
  s_cselect_b32 s40, 0, s40
  s_waitcnt lgkmcnt(9)
  v_mfma_f32_32x32x16_bf16 v[80:95], v[40:43], v[16:19], v[80:95]
  ds_read_b64_tr_b16 v[28:29], v1 offset:128
  ds_read_b64_tr_b16 v[30:31], v1 offset:1664
  v_add_u32 v2, s40, v5
  ds_read_b128 v[8:11], v2 offset:0
  v_mfma_f32_32x32x16_bf16 v[96:111], v[44:47], v[16:19], v[96:111]
  ds_read_b64_tr_b16 v[32:33], v1 offset:256
  ds_read_b64_tr_b16 v[34:35], v1 offset:1792
  s_waitcnt lgkmcnt(9)
  v_mfma_f32_32x32x16_bf16 v[64:79], v[48:51], v[20:23], v[64:79]
  ds_read_b64_tr_b16 v[36:37], v1 offset:3072
  ds_read_b64_tr_b16 v[38:39], v1 offset:4608
  v_mfma_f32_32x32x16_bf16 v[80:95], v[52:55], v[20:23], v[80:95]
  ds_read_b64_tr_b16 v[40:41], v1 offset:3200
  ds_read_b64_tr_b16 v[42:43], v1 offset:4736
  ds_read_b128 v[12:15], v2 offset:2048
  s_waitcnt lgkmcnt(12)
  v_mfma_f32_32x32x16_bf16 v[96:111], v[56:59], v[20:23], v[96:111]
  ds_read_b64_tr_b16 v[44:45], v1 offset:3328
  ds_read_b64_tr_b16 v[46:47], v1 offset:4864
  s_barrier
  s_waitcnt lgkmcnt(9)
  v_mfma_f32_32x32x16_bf16 v[64:79], v[24:27], v[8:11], v[64:79]
  ds_read_b64_tr_b16 v[48:49], v1 offset:6144
  ds_read_b64_tr_b16 v[50:51], v1 offset:7680
  v_mfma_f32_32x32x16_bf16 v[80:95], v[28:31], v[8:11], v[80:95]
  ds_read_b64_tr_b16 v[52:53], v1 offset:6272
  ds_read_b64_tr_b16 v[54:55], v1 offset:7808
  ds_read_b128 v[16:19], v2 offset:4096
  s_waitcnt lgkmcnt(7)
  v_mfma_f32_32x32x16_bf16 v[96:111], v[32:35], v[8:11], v[96:111]
  ds_read_b64_tr_b16 v[56:57], v1 offset:6400
  ds_read_b64_tr_b16 v[58:59], v1 offset:7936
  v_mfma_f32_32x32x16_bf16 v[64:79], v[36:39], v[12:15], v[64:79]
  ds_read_b64_tr_b16 v[24:25], v1 offset:9216
  ds_read_b64_tr_b16 v[26:27], v1 offset:10752
  s_waitcnt lgkmcnt(9)
  v_mfma_f32_32x32x16_bf16 v[80:95], v[40:43], v[12:15], v[80:95]
  ds_read_b64_tr_b16 v[28:29], v1 offset:9344
  ds_read_b64_tr_b16 v[30:31], v1 offset:10880
  ds_read_b128 v[20:23], v2 offset:6144
  v_mfma_f32_32x32x16_bf16 v[96:111], v[44:47], v[12:15], v[96:111]
  ds_read_b64_tr_b16 v[32:33], v1 offset:9472
  ds_read_b64_tr_b16 v[34:35], v1 offset:11008
  s_waitcnt lgkmcnt(9)
  v_mfma_f32_32x32x16_bf16 v[64:79], v[48:51], v[16:19], v[64:79]
  ds_read_b64_tr_b16 v[36:37], v1 offset:12288
  ds_read_b64_tr_b16 v[38:39], v1 offset:13824
  s_add_u32 s40, s40, 8192
  s_cmp_eq_u32 s40, 73728
  s_cselect_b32 s40, 0, s40
  v_mfma_f32_32x32x16_bf16 v[80:95], v[52:55], v[16:19], v[80:95]
  ds_read_b64_tr_b16 v[40:41], v1 offset:12416
  ds_read_b64_tr_b16 v[42:43], v1 offset:13952
  v_add_u32 v2, s40, v5
  ds_read_b128 v[8:11], v2 offset:0
  s_waitcnt lgkmcnt(12)
  v_mfma_f32_32x32x16_bf16 v[96:111], v[56:59], v[16:19], v[96:111]
  ds_read_b64_tr_b16 v[44:45], v1 offset:12544
  ds_read_b64_tr_b16 v[46:47], v1 offset:14080
  s_barrier
  s_waitcnt lgkmcnt(9)
  v_mfma_f32_32x32x16_bf16 v[64:79], v[24:27], v[20:23], v[64:79]
  ds_read_b64_tr_b16 v[48:49], v1 offset:15360
  ds_read_b64_tr_b16 v[50:51], v1 offset:16896
  v_mfma_f32_32x32x16_bf16 v[80:95], v[28:31], v[20:23], v[80:95]
  ds_read_b64_tr_b16 v[52:53], v1 offset:15488
  ds_read_b64_tr_b16 v[54:55], v1 offset:17024
  ds_read_b128 v[12:15], v2 offset:2048
  s_waitcnt lgkmcnt(7)
  v_mfma_f32_32x32x16_bf16 v[96:111], v[32:35], v[20:23], v[96:111]
  ds_read_b64_tr_b16 v[56:57], v1 offset:15616
  ds_read_b64_tr_b16 v[58:59], v1 offset:17152
  v_mfma_f32_32x32x16_bf16 v[64:79], v[36:39], v[8:11], v[64:79]
  ds_read_b64_tr_b16 v[24:25], v1 offset:18432
  ds_read_b64_tr_b16 v[26:27], v1 offset:19968
  s_waitcnt lgkmcnt(9)
  v_mfma_f32_32x32x16_bf16 v[80:95], v[40:43], v[8:11], v[80:95]
  ds_read_b64_tr_b16 v[28:29], v1 offset:18560
  ds_read_b64_tr_b16 v[30:31], v1 offset:20096
  ds_read_b128 v[16:19], v2 offset:4096
  v_mfma_f32_32x32x16_bf16 v[96:111], v[44:47], v[8:11], v[96:111]
  ds_read_b64_tr_b16 v[32:33], v1 offset:18688
  ds_read_b64_tr_b16 v[34:35], v1 offset:20224
  s_waitcnt lgkmcnt(9)
  v_mfma_f32_32x32x16_bf16 v[64:79], v[48:51], v[12:15], v[64:79]
  ds_read_b64_tr_b16 v[36:37], v1 offset:21504
  ds_read_b64_tr_b16 v[38:39], v1 offset:23040
  v_mfma_f32_32x32x16_bf16 v[80:95], v[52:55], v[12:15], v[80:95]
  ds_read_b64_tr_b16 v[40:41], v1 offset:21632
  ds_read_b64_tr_b16 v[42:43], v1 offset:23168
  ds_read_b128 v[20:23], v2 offset:6144
  s_waitcnt lgkmcnt(12)
  v_mfma_f32_32x32x16_bf16 v[96:111], v[56:59], v[12:15], v[96:111]
  ds_read_b64_tr_b16 v[44:45], v1 offset:21760
  ds_read_b64_tr_b16 v[46:47], v1 offset:23296
  s_barrier
  s_waitcnt lgkmcnt(9)
  v_mfma_f32_32x32x16_bf16 v[64:79], v[24:27], v[16:19], v[64:79]
  ds_read_b64_tr_b16 v[48:49], v1 offset:24576
  ds_read_b64_tr_b16 v[50:51], v1 offset:26112
  s_add_u32 s40, s40, 8192
  s_cmp_eq_u32 s40, 73728
  s_cselect_b32 s40, 0, s40
  v_mfma_f32_32x32x16_bf16 v[80:95], v[28:31], v[16:19], v[80:95]
  ds_read_b64_tr_b16 v[52:53], v1 offset:24704
  ds_read_b64_tr_b16 v[54:55], v1 offset:26240
  v_add_u32 v2, s40, v5
  ds_read_b128 v[8:11], v2 offset:0
  s_waitcnt lgkmcnt(7)
  v_mfma_f32_32x32x16_bf16 v[96:111], v[32:35], v[16:19], v[96:111]
  ds_read_b64_tr_b16 v[56:57], v1 offset:24832
  ds_read_b64_tr_b16 v[58:59], v1 offset:26368
  v_mfma_f32_32x32x16_bf16 v[64:79], v[36:39], v[20:23], v[64:79]
  ds_read_b64_tr_b16 v[24:25], v1 offset:27648
  ds_read_b64_tr_b16 v[26:27], v1 offset:29184
  s_waitcnt lgkmcnt(9)
  v_mfma_f32_32x32x16_bf16 v[80:95], v[40:43], v[20:23], v[80:95]
  ds_read_b64_tr_b16 v[28:29], v1 offset:27776
  ds_read_b64_tr_b16 v[30:31], v1 offset:29312
  ds_read_b128 v[12:15], v2 offset:2048
  v_mfma_f32_32x32x16_bf16 v[96:111], v[44:47], v[20:23], v[96:111]
  ds_read_b64_tr_b16 v[32:33], v1 offset:27904
  ds_read_b64_tr_b16 v[34:35], v1 offset:29440
  s_waitcnt lgkmcnt(9)
  v_mfma_f32_32x32x16_bf16 v[64:79], v[48:51], v[8:11], v[64:79]
  ds_read_b64_tr_b16 v[36:37], v1 offset:30720
  ds_read_b64_tr_b16 v[38:39], v1 offset:32256
  v_mfma_f32_32x32x16_bf16 v[80:95], v[52:55], v[8:11], v[80:95]
  ds_read_b64_tr_b16 v[40:41], v1 offset:30848
  ds_read_b64_tr_b16 v[42:43], v1 offset:32384
  ds_read_b128 v[16:19], v2 offset:4096
  s_waitcnt lgkmcnt(12)
  v_mfma_f32_32x32x16_bf16 v[96:111], v[56:59], v[8:11], v[96:111]
  ds_read_b64_tr_b16 v[44:45], v1 offset:30976
  ds_read_b64_tr_b16 v[46:47], v1 offset:32512
  s_barrier
  s_waitcnt lgkmcnt(9)
  v_mfma_f32_32x32x16_bf16 v[64:79], v[24:27], v[12:15], v[64:79]
  ds_read_b64_tr_b16 v[48:49], v1 offset:33792
  ds_read_b64_tr_b16 v[50:51], v1 offset:35328
  v_mfma_f32_32x32x16_bf16 v[80:95], v[28:31], v[12:15], v[80:95]
  ds_read_b64_tr_b16 v[52:53], v1 offset:33920
  ds_read_b64_tr_b16 v[54:55], v1 offset:35456
  ds_read_b128 v[20:23], v2 offset:6144
  s_waitcnt lgkmcnt(7)
  v_mfma_f32_32x32x16_bf16 v[96:111], v[32:35], v[12:15], v[96:111]
  ds_read_b64_tr_b16 v[56:57], v1 offset:34048
  ds_read_b64_tr_b16 v[58:59], v1 offset:35584
  v_mfma_f32_32x32x16_bf16 v[64:79], v[36:39], v[16:19], v[64:79]
  ds_read_b64_tr_b16 v[24:25], v1 offset:0
  ds_read_b64_tr_b16 v[26:27], v1 offset:1536
  s_add_u32 s40, s40, 8192
  s_cmp_eq_u32 s40, 73728
  s_cselect_b32 s40, 0, s40
  s_waitcnt lgkmcnt(9)
  v_mfma_f32_32x32x16_bf16 v[80:95], v[40:43], v[16:19], v[80:95]
  ds_read_b64_tr_b16 v[28:29], v1 offset:128
  ds_read_b64_tr_b16 v[30:31], v1 offset:1664
  v_add_u32 v2, s40, v5
  ds_read_b128 v[8:11], v2 offset:0
  v_mfma_f32_32x32x16_bf16 v[96:111], v[44:47], v[16:19], v[96:111]
  ds_read_b64_tr_b16 v[32:33], v1 offset:256
  ds_read_b64_tr_b16 v[34:35], v1 offset:1792
  s_waitcnt lgkmcnt(9)
  v_mfma_f32_32x32x16_bf16 v[64:79], v[48:51], v[20:23], v[64:79]
  ds_read_b64_tr_b16 v[36:37], v1 offset:3072
  ds_read_b64_tr_b16 v[38:39], v1 offset:4608
  v_mfma_f32_32x32x16_bf16 v[80:95], v[52:55], v[20:23], v[80:95]
  ds_read_b64_tr_b16 v[40:41], v1 offset:3200
  ds_read_b64_tr_b16 v[42:43], v1 offset:4736
  ds_read_b128 v[12:15], v2 offset:2048
  s_waitcnt lgkmcnt(12)
  v_mfma_f32_32x32x16_bf16 v[96:111], v[56:59], v[20:23], v[96:111]
  ds_read_b64_tr_b16 v[44:45], v1 offset:3328
  ds_read_b64_tr_b16 v[46:47], v1 offset:4864
  s_barrier
  s_waitcnt lgkmcnt(9)
  v_mfma_f32_32x32x16_bf16 v[64:79], v[24:27], v[8:11], v[64:79]
  ds_read_b64_tr_b16 v[48:49], v1 offset:6144
  ds_read_b64_tr_b16 v[50:51], v1 offset:7680
  v_mfma_f32_32x32x16_bf16 v[80:95], v[28:31], v[8:11], v[80:95]
  ds_read_b64_tr_b16 v[52:53], v1 offset:6272
  ds_read_b64_tr_b16 v[54:55], v1 offset:7808
  ds_read_b128 v[16:19], v2 offset:4096
  s_waitcnt lgkmcnt(7)
  v_mfma_f32_32x32x16_bf16 v[96:111], v[32:35], v[8:11], v[96:111]
  ds_read_b64_tr_b16 v[56:57], v1 offset:6400
  ds_read_b64_tr_b16 v[58:59], v1 offset:7936
  v_mfma_f32_32x32x16_bf16 v[64:79], v[36:39], v[12:15], v[64:79]
  ds_read_b64_tr_b16 v[24:25], v1 offset:9216
  ds_read_b64_tr_b16 v[26:27], v1 offset:10752
  s_waitcnt lgkmcnt(9)
  v_mfma_f32_32x32x16_bf16 v[80:95], v[40:43], v[12:15], v[80:95]
  ds_read_b64_tr_b16 v[28:29], v1 offset:9344
  ds_read_b64_tr_b16 v[30:31], v1 offset:10880
  ds_read_b128 v[20:23], v2 offset:6144
  v_mfma_f32_32x32x16_bf16 v[96:111], v[44:47], v[12:15], v[96:111]
  ds_read_b64_tr_b16 v[32:33], v1 offset:9472
  ds_read_b64_tr_b16 v[34:35], v1 offset:11008
  s_waitcnt lgkmcnt(9)
  v_mfma_f32_32x32x16_bf16 v[64:79], v[48:51], v[16:19], v[64:79]
  ds_read_b64_tr_b16 v[36:37], v1 offset:12288
  ds_read_b64_tr_b16 v[38:39], v1 offset:13824
  s_add_u32 s40, s40, 8192
  s_cmp_eq_u32 s40, 73728
  s_cselect_b32 s40, 0, s40
  v_mfma_f32_32x32x16_bf16 v[80:95], v[52:55], v[16:19], v[80:95]
  ds_read_b64_tr_b16 v[40:41], v1 offset:12416
  ds_read_b64_tr_b16 v[42:43], v1 offset:13952
  v_add_u32 v2, s40, v5
  ds_read_b128 v[8:11], v2 offset:0
  s_waitcnt lgkmcnt(12)
  v_mfma_f32_32x32x16_bf16 v[96:111], v[56:59], v[16:19], v[96:111]
  ds_read_b64_tr_b16 v[44:45], v1 offset:12544
  ds_read_b64_tr_b16 v[46:47], v1 offset:14080
  s_barrier
  s_waitcnt lgkmcnt(9)
  v_mfma_f32_32x32x16_bf16 v[64:79], v[24:27], v[20:23], v[64:79]
  ds_read_b64_tr_b16 v[48:49], v1 offset:15360
  ds_read_b64_tr_b16 v[50:51], v1 offset:16896
  v_mfma_f32_32x32x16_bf16 v[80:95], v[28:31], v[20:23], v[80:95]
  ds_read_b64_tr_b16 v[52:53], v1 offset:15488
  ds_read_b64_tr_b16 v[54:55], v1 offset:17024
  ds_read_b128 v[12:15], v2 offset:2048
  s_waitcnt lgkmcnt(7)
  v_mfma_f32_32x32x16_bf16 v[96:111], v[32:35], v[20:23], v[96:111]
  ds_read_b64_tr_b16 v[56:57], v1 offset:15616
  ds_read_b64_tr_b16 v[58:59], v1 offset:17152
  v_mfma_f32_32x32x16_bf16 v[64:79], v[36:39], v[8:11], v[64:79]
  ds_read_b64_tr_b16 v[24:25], v1 offset:18432
  ds_read_b64_tr_b16 v[26:27], v1 offset:19968
  s_waitcnt lgkmcnt(9)
  v_mfma_f32_32x32x16_bf16 v[80:95], v[40:43], v[8:11], v[80:95]
  ds_read_b64_tr_b16 v[28:29], v1 offset:18560
  ds_read_b64_tr_b16 v[30:31], v1 offset:20096
  ds_read_b128 v[16:19], v2 offset:4096
  v_mfma_f32_32x32x16_bf16 v[96:111], v[44:47], v[8:11], v[96:111]
  ds_read_b64_tr_b16 v[32:33], v1 offset:18688
  ds_read_b64_tr_b16 v[34:35], v1 offset:20224
  s_waitcnt lgkmcnt(9)
  v_mfma_f32_32x32x16_bf16 v[64:79], v[48:51], v[12:15], v[64:79]
  ds_read_b64_tr_b16 v[36:37], v1 offset:21504
  ds_read_b64_tr_b16 v[38:39], v1 offset:23040
  v_mfma_f32_32x32x16_bf16 v[80:95], v[52:55], v[12:15], v[80:95]
  ds_read_b64_tr_b16 v[40:41], v1 offset:21632
  ds_read_b64_tr_b16 v[42:43], v1 offset:23168
  ds_read_b128 v[20:23], v2 offset:6144
  s_waitcnt lgkmcnt(12)
  v_mfma_f32_32x32x16_bf16 v[96:111], v[56:59], v[12:15], v[96:111]
  ds_read_b64_tr_b16 v[44:45], v1 offset:21760
  ds_read_b64_tr_b16 v[46:47], v1 offset:23296
  s_barrier
  s_waitcnt lgkmcnt(9)
  v_mfma_f32_32x32x16_bf16 v[64:79], v[24:27], v[16:19], v[64:79]
  ds_read_b64_tr_b16 v[48:49], v1 offset:24576
  ds_read_b64_tr_b16 v[50:51], v1 offset:26112
  s_add_u32 s40, s40, 8192
  s_cmp_eq_u32 s40, 73728
  s_cselect_b32 s40, 0, s40
  v_mfma_f32_32x32x16_bf16 v[80:95], v[28:31], v[16:19], v[80:95]
  ds_read_b64_tr_b16 v[52:53], v1 offset:24704
  ds_read_b64_tr_b16 v[54:55], v1 offset:26240
  v_add_u32 v2, s40, v5
  ds_read_b128 v[8:11], v2 offset:0
  s_waitcnt lgkmcnt(7)
  v_mfma_f32_32x32x16_bf16 v[96:111], v[32:35], v[16:19], v[96:111]
  ds_read_b64_tr_b16 v[56:57], v1 offset:24832
  ds_read_b64_tr_b16 v[58:59], v1 offset:26368
  v_mfma_f32_32x32x16_bf16 v[64:79], v[36:39], v[20:23], v[64:79]
  ds_read_b64_tr_b16 v[24:25], v1 offset:27648
  ds_read_b64_tr_b16 v[26:27], v1 offset:29184
  s_waitcnt lgkmcnt(9)
  v_mfma_f32_32x32x16_bf16 v[80:95], v[40:43], v[20:23], v[80:95]
  ds_read_b64_tr_b16 v[28:29], v1 offset:27776
  ds_read_b64_tr_b16 v[30:31], v1 offset:29312
  ds_read_b128 v[12:15], v2 offset:2048
  v_mfma_f32_32x32x16_bf16 v[96:111], v[44:47], v[20:23], v[96:111]
  ds_read_b64_tr_b16 v[32:33], v1 offset:27904
  ds_read_b64_tr_b16 v[34:35], v1 offset:29440
  s_waitcnt lgkmcnt(9)
  v_mfma_f32_32x32x16_bf16 v[64:79], v[48:51], v[8:11], v[64:79]
  ds_read_b64_tr_b16 v[36:37], v1 offset:30720
  ds_read_b64_tr_b16 v[38:39], v1 offset:32256
  v_mfma_f32_32x32x16_bf16 v[80:95], v[52:55], v[8:11], v[80:95]
  ds_read_b64_tr_b16 v[40:41], v1 offset:30848
  ds_read_b64_tr_b16 v[42:43], v1 offset:32384
  ds_read_b128 v[16:19], v2 offset:4096
  s_waitcnt lgkmcnt(12)
  v_mfma_f32_32x32x16_bf16 v[96:111], v[56:59], v[8:11], v[96:111]
  ds_read_b64_tr_b16 v[44:45], v1 offset:30976
  ds_read_b64_tr_b16 v[46:47], v1 offset:32512
  s_barrier
  s_waitcnt lgkmcnt(9)
  v_mfma_f32_32x32x16_bf16 v[64:79], v[24:27], v[12:15], v[64:79]
  ds_read_b64_tr_b16 v[48:49], v1 offset:33792
  ds_read_b64_tr_b16 v[50:51], v1 offset:35328
  v_mfma_f32_32x32x16_bf16 v[80:95], v[28:31], v[12:15], v[80:95]
  ds_read_b64_tr_b16 v[52:53], v1 offset:33920
  ds_read_b64_tr_b16 v[54:55], v1 offset:35456
  ds_read_b128 v[20:23], v2 offset:6144
  s_waitcnt lgkmcnt(7)
  v_mfma_f32_32x32x16_bf16 v[96:111], v[32:35], v[12:15], v[96:111]
  ds_read_b64_tr_b16 v[56:57], v1 offset:34048
  ds_read_b64_tr_b16 v[58:59], v1 offset:35584
  v_mfma_f32_32x32x16_bf16 v[64:79], v[36:39], v[16:19], v[64:79]
  ds_read_b64_tr_b16 v[24:25], v1 offset:0
  ds_read_b64_tr_b16 v[26:27], v1 offset:1536
  s_add_u32 s40, s40, 8192
  s_cmp_eq_u32 s40, 73728
  s_cselect_b32 s40, 0, s40
  s_waitcnt lgkmcnt(9)
  v_mfma_f32_32x32x16_bf16 v[80:95], v[40:43], v[16:19], v[80:95]
  ds_read_b64_tr_b16 v[28:29], v1 offset:128
  ds_read_b64_tr_b16 v[30:31], v1 offset:1664
  v_add_u32 v2, s40, v5
  ds_read_b128 v[8:11], v2 offset:0
  v_mfma_f32_32x32x16_bf16 v[96:111], v[44:47], v[16:19], v[96:111]
  ds_read_b64_tr_b16 v[32:33], v1 offset:256
  ds_read_b64_tr_b16 v[34:35], v1 offset:1792
  s_waitcnt lgkmcnt(9)
  v_mfma_f32_32x32x16_bf16 v[64:79], v[48:51], v[20:23], v[64:79]
  ds_read_b64_tr_b16 v[36:37], v1 offset:3072
  ds_read_b64_tr_b16 v[38:39], v1 offset:4608
  v_mfma_f32_32x32x16_bf16 v[80:95], v[52:55], v[20:23], v[80:95]
  ds_read_b64_tr_b16 v[40:41], v1 offset:3200
  ds_read_b64_tr_b16 v[42:43], v1 offset:4736
  ds_read_b128 v[12:15], v2 offset:2048
  s_waitcnt lgkmcnt(12)
  v_mfma_f32_32x32x16_bf16 v[96:111], v[56:59], v[20:23], v[96:111]
  ds_read_b64_tr_b16 v[44:45], v1 offset:3328
  ds_read_b64_tr_b16 v[46:47], v1 offset:4864
  s_barrier
  s_waitcnt lgkmcnt(9)
  v_mfma_f32_32x32x16_bf16 v[112:127], v[24:27], v[8:11], 0
  ds_read_b64_tr_b16 v[48:49], v1 offset:6144
  ds_read_b64_tr_b16 v[50:51], v1 offset:7680
  v_mfma_f32_32x32x16_bf16 v[128:143], v[28:31], v[8:11], 0
  ds_read_b64_tr_b16 v[52:53], v1 offset:6272
  ds_read_b64_tr_b16 v[54:55], v1 offset:7808
  ds_read_b128 v[16:19], v2 offset:4096
  s_waitcnt lgkmcnt(7)
  v_mfma_f32_32x32x16_bf16 v[144:159], v[32:35], v[8:11], 0
  ds_read_b64_tr_b16 v[56:57], v1 offset:6400
  ds_read_b64_tr_b16 v[58:59], v1 offset:7936
  v_mfma_f32_32x32x16_bf16 v[112:127], v[36:39], v[12:15], v[112:127]
  ds_read_b64_tr_b16 v[24:25], v1 offset:9216
  ds_read_b64_tr_b16 v[26:27], v1 offset:10752
  s_waitcnt lgkmcnt(9)
  v_mfma_f32_32x32x16_bf16 v[128:143], v[40:43], v[12:15], v[128:143]
  ds_read_b64_tr_b16 v[28:29], v1 offset:9344
  ds_read_b64_tr_b16 v[30:31], v1 offset:10880
  ds_read_b128 v[20:23], v2 offset:6144
  v_mfma_f32_32x32x16_bf16 v[144:159], v[44:47], v[12:15], v[144:159]
  ds_read_b64_tr_b16 v[32:33], v1 offset:9472
  ds_read_b64_tr_b16 v[34:35], v1 offset:11008
  s_waitcnt lgkmcnt(9)
  v_mfma_f32_32x32x16_bf16 v[112:127], v[48:51], v[16:19], v[112:127]
  ds_read_b64_tr_b16 v[36:37], v1 offset:12288
  ds_read_b64_tr_b16 v[38:39], v1 offset:13824
  s_add_u32 s40, s40, 8192
  s_cmp_eq_u32 s40, 73728
  s_cselect_b32 s40, 0, s40
  v_mfma_f32_32x32x16_bf16 v[128:143], v[52:55], v[16:19], v[128:143]
  ds_read_b64_tr_b16 v[40:41], v1 offset:12416
  ds_read_b64_tr_b16 v[42:43], v1 offset:13952
  v_add_u32 v2, s40, v5
  ds_read_b128 v[8:11], v2 offset:0
  s_waitcnt lgkmcnt(12)
  v_mfma_f32_32x32x16_bf16 v[144:159], v[56:59], v[16:19], v[144:159]
  ds_read_b64_tr_b16 v[44:45], v1 offset:12544
  ds_read_b64_tr_b16 v[46:47], v1 offset:14080
  s_barrier
  s_waitcnt lgkmcnt(9)
  v_mfma_f32_32x32x16_bf16 v[112:127], v[24:27], v[20:23], v[112:127]
  ds_read_b64_tr_b16 v[48:49], v1 offset:15360
  ds_read_b64_tr_b16 v[50:51], v1 offset:16896
  v_mfma_f32_32x32x16_bf16 v[128:143], v[28:31], v[20:23], v[128:143]
  ds_read_b64_tr_b16 v[52:53], v1 offset:15488
  ds_read_b64_tr_b16 v[54:55], v1 offset:17024
  ds_read_b128 v[12:15], v2 offset:2048
  s_waitcnt lgkmcnt(7)
  v_mfma_f32_32x32x16_bf16 v[144:159], v[32:35], v[20:23], v[144:159]
  ds_read_b64_tr_b16 v[56:57], v1 offset:15616
  ds_read_b64_tr_b16 v[58:59], v1 offset:17152
  v_mfma_f32_32x32x16_bf16 v[112:127], v[36:39], v[8:11], v[112:127]
  ds_read_b64_tr_b16 v[24:25], v1 offset:18432
  ds_read_b64_tr_b16 v[26:27], v1 offset:19968
  s_waitcnt lgkmcnt(9)
  v_mfma_f32_32x32x16_bf16 v[128:143], v[40:43], v[8:11], v[128:143]
  ds_read_b64_tr_b16 v[28:29], v1 offset:18560
  ds_read_b64_tr_b16 v[30:31], v1 offset:20096
  ds_read_b128 v[16:19], v2 offset:4096
  v_mfma_f32_32x32x16_bf16 v[144:159], v[44:47], v[8:11], v[144:159]
  ds_read_b64_tr_b16 v[32:33], v1 offset:18688
  ds_read_b64_tr_b16 v[34:35], v1 offset:20224
  s_waitcnt lgkmcnt(9)
  v_mfma_f32_32x32x16_bf16 v[112:127], v[48:51], v[12:15], v[112:127]
  ds_read_b64_tr_b16 v[36:37], v1 offset:21504
  ds_read_b64_tr_b16 v[38:39], v1 offset:23040
  v_mfma_f32_32x32x16_bf16 v[128:143], v[52:55], v[12:15], v[128:143]
  ds_read_b64_tr_b16 v[40:41], v1 offset:21632
  ds_read_b64_tr_b16 v[42:43], v1 offset:23168
  ds_read_b128 v[20:23], v2 offset:6144
  s_waitcnt lgkmcnt(12)
  v_mfma_f32_32x32x16_bf16 v[144:159], v[56:59], v[12:15], v[144:159]
  ds_read_b64_tr_b16 v[44:45], v1 offset:21760
  ds_read_b64_tr_b16 v[46:47], v1 offset:23296
  s_barrier
  s_waitcnt lgkmcnt(9)
  v_mfma_f32_32x32x16_bf16 v[112:127], v[24:27], v[16:19], v[112:127]
  ds_read_b64_tr_b16 v[48:49], v1 offset:24576
  ds_read_b64_tr_b16 v[50:51], v1 offset:26112
  s_add_u32 s40, s40, 8192
  s_cmp_eq_u32 s40, 73728
  s_cselect_b32 s40, 0, s40
  v_mfma_f32_32x32x16_bf16 v[128:143], v[28:31], v[16:19], v[128:143]
  ds_read_b64_tr_b16 v[52:53], v1 offset:24704
  ds_read_b64_tr_b16 v[54:55], v1 offset:26240
  v_add_u32 v2, s40, v5
  ds_read_b128 v[8:11], v2 offset:0
  s_waitcnt lgkmcnt(7)
  v_mfma_f32_32x32x16_bf16 v[144:159], v[32:35], v[16:19], v[144:159]
  ds_read_b64_tr_b16 v[56:57], v1 offset:24832
  ds_read_b64_tr_b16 v[58:59], v1 offset:26368
  v_cvt_pk_bf16_f32 v208, v64, v65
  v_cvt_pk_bf16_f32 v209, v66, v67
  v_mfma_f32_32x32x16_bf16 v[112:127], v[36:39], v[20:23], v[112:127]
  ds_read_b64_tr_b16 v[24:25], v1 offset:27648
  ds_read_b64_tr_b16 v[26:27], v1 offset:29184
  s_waitcnt lgkmcnt(9)
  v_mfma_f32_32x32x16_bf16 v[128:143], v[40:43], v[20:23], v[128:143]
  ds_read_b64_tr_b16 v[28:29], v1 offset:27776
  ds_read_b64_tr_b16 v[30:31], v1 offset:29312
  ds_read_b128 v[12:15], v2 offset:2048
  v_mfma_f32_32x32x16_bf16 v[144:159], v[44:47], v[20:23], v[144:159]
  ds_read_b64_tr_b16 v[32:33], v1 offset:27904
  ds_read_b64_tr_b16 v[34:35], v1 offset:29440
  v_cvt_pk_bf16_f32 v210, v68, v69
  v_cvt_pk_bf16_f32 v211, v70, v71
  s_waitcnt lgkmcnt(9)
  v_mfma_f32_32x32x16_bf16 v[112:127], v[48:51], v[8:11], v[112:127]
  ds_read_b64_tr_b16 v[36:37], v1 offset:30720
  ds_read_b64_tr_b16 v[38:39], v1 offset:32256
  v_mfma_f32_32x32x16_bf16 v[128:143], v[52:55], v[8:11], v[128:143]
  ds_read_b64_tr_b16 v[40:41], v1 offset:30848
  ds_read_b64_tr_b16 v[42:43], v1 offset:32384
  ds_read_b128 v[16:19], v2 offset:4096
  s_waitcnt lgkmcnt(12)
  v_mfma_f32_32x32x16_bf16 v[144:159], v[56:59], v[8:11], v[144:159]
  ds_read_b64_tr_b16 v[44:45], v1 offset:30976
  ds_read_b64_tr_b16 v[46:47], v1 offset:32512
  s_barrier
  s_waitcnt lgkmcnt(9)
  v_mfma_f32_32x32x16_bf16 v[112:127], v[24:27], v[12:15], v[112:127]
  ds_read_b64_tr_b16 v[48:49], v1 offset:33792
  ds_read_b64_tr_b16 v[50:51], v1 offset:35328
  v_mfma_f32_32x32x16_bf16 v[128:143], v[28:31], v[12:15], v[128:143]
  ds_read_b64_tr_b16 v[52:53], v1 offset:33920
  ds_read_b64_tr_b16 v[54:55], v1 offset:35456
  ds_read_b128 v[20:23], v2 offset:6144
  s_waitcnt lgkmcnt(7)
  v_mfma_f32_32x32x16_bf16 v[144:159], v[32:35], v[12:15], v[144:159]
  ds_read_b64_tr_b16 v[56:57], v1 offset:34048
  ds_read_b64_tr_b16 v[58:59], v1 offset:35584
  s_nop 1
  v_permlane32_swap_b32 v208, v210
  v_permlane32_swap_b32 v209, v211
  buffer_store_dwordx4 v[208:211], v4, s[16:19], s47 offen sc0 sc1
  s_add_u32 s47, s47, 1024
  v_mfma_f32_32x32x16_bf16 v[112:127], v[36:39], v[16:19], v[112:127]
  ds_read_b64_tr_b16 v[24:25], v1 offset:0
  ds_read_b64_tr_b16 v[26:27], v1 offset:1536
  s_add_u32 s40, s40, 8192
  s_cmp_eq_u32 s40, 73728
  s_cselect_b32 s40, 0, s40
  s_waitcnt lgkmcnt(9)
  v_mfma_f32_32x32x16_bf16 v[128:143], v[40:43], v[16:19], v[128:143]
  ds_read_b64_tr_b16 v[28:29], v1 offset:128
  ds_read_b64_tr_b16 v[30:31], v1 offset:1664
  v_add_u32 v2, s40, v5
  ds_read_b128 v[8:11], v2 offset:0
  v_mfma_f32_32x32x16_bf16 v[144:159], v[44:47], v[16:19], v[144:159]
  ds_read_b64_tr_b16 v[32:33], v1 offset:256
  ds_read_b64_tr_b16 v[34:35], v1 offset:1792
  v_cvt_pk_bf16_f32 v212, v72, v73
  v_cvt_pk_bf16_f32 v213, v74, v75
  s_waitcnt lgkmcnt(9)
  v_mfma_f32_32x32x16_bf16 v[112:127], v[48:51], v[20:23], v[112:127]
  ds_read_b64_tr_b16 v[36:37], v1 offset:3072
  ds_read_b64_tr_b16 v[38:39], v1 offset:4608
  v_mfma_f32_32x32x16_bf16 v[128:143], v[52:55], v[20:23], v[128:143]
  ds_read_b64_tr_b16 v[40:41], v1 offset:3200
  ds_read_b64_tr_b16 v[42:43], v1 offset:4736
  ds_read_b128 v[12:15], v2 offset:2048
  s_waitcnt lgkmcnt(12)
  v_mfma_f32_32x32x16_bf16 v[144:159], v[56:59], v[20:23], v[144:159]
  ds_read_b64_tr_b16 v[44:45], v1 offset:3328
  ds_read_b64_tr_b16 v[46:47], v1 offset:4864
  s_barrier
  s_waitcnt lgkmcnt(9)
  v_mfma_f32_32x32x16_bf16 v[112:127], v[24:27], v[8:11], v[112:127]
  ds_read_b64_tr_b16 v[48:49], v1 offset:6144
  ds_read_b64_tr_b16 v[50:51], v1 offset:7680
  v_mfma_f32_32x32x16_bf16 v[128:143], v[28:31], v[8:11], v[128:143]
  ds_read_b64_tr_b16 v[52:53], v1 offset:6272
  ds_read_b64_tr_b16 v[54:55], v1 offset:7808
  ds_read_b128 v[16:19], v2 offset:4096
  s_waitcnt lgkmcnt(7)
  v_mfma_f32_32x32x16_bf16 v[144:159], v[32:35], v[8:11], v[144:159]
  ds_read_b64_tr_b16 v[56:57], v1 offset:6400
  ds_read_b64_tr_b16 v[58:59], v1 offset:7936
  v_cvt_pk_bf16_f32 v214, v76, v77
  v_cvt_pk_bf16_f32 v215, v78, v79
  v_mfma_f32_32x32x16_bf16 v[112:127], v[36:39], v[12:15], v[112:127]
  ds_read_b64_tr_b16 v[24:25], v1 offset:9216
  ds_read_b64_tr_b16 v[26:27], v1 offset:10752
  s_waitcnt lgkmcnt(9)
  v_mfma_f32_32x32x16_bf16 v[128:143], v[40:43], v[12:15], v[128:143]
  ds_read_b64_tr_b16 v[28:29], v1 offset:9344
  ds_read_b64_tr_b16 v[30:31], v1 offset:10880
  ds_read_b128 v[20:23], v2 offset:6144
  v_mfma_f32_32x32x16_bf16 v[144:159], v[44:47], v[12:15], v[144:159]
  ds_read_b64_tr_b16 v[32:33], v1 offset:9472
  ds_read_b64_tr_b16 v[34:35], v1 offset:11008
  s_nop 1
  v_permlane32_swap_b32 v212, v214
  v_permlane32_swap_b32 v213, v215
  buffer_store_dwordx4 v[212:215], v4, s[16:19], s47 offen sc0 sc1
  s_add_u32 s47, s47, 1024
  s_waitcnt lgkmcnt(9)
  v_mfma_f32_32x32x16_bf16 v[112:127], v[48:51], v[16:19], v[112:127]
  ds_read_b64_tr_b16 v[36:37], v1 offset:12288
  ds_read_b64_tr_b16 v[38:39], v1 offset:13824
  s_add_u32 s40, s40, 8192
  s_cmp_eq_u32 s40, 73728
  s_cselect_b32 s40, 0, s40
  v_mfma_f32_32x32x16_bf16 v[128:143], v[52:55], v[16:19], v[128:143]
  ds_read_b64_tr_b16 v[40:41], v1 offset:12416
  ds_read_b64_tr_b16 v[42:43], v1 offset:13952
  v_add_u32 v2, s40, v5
  ds_read_b128 v[8:11], v2 offset:0
  s_waitcnt lgkmcnt(12)
  v_mfma_f32_32x32x16_bf16 v[144:159], v[56:59], v[16:19], v[144:159]
  ds_read_b64_tr_b16 v[44:45], v1 offset:12544
  ds_read_b64_tr_b16 v[46:47], v1 offset:14080
  s_barrier
  s_waitcnt lgkmcnt(9)
  v_mfma_f32_32x32x16_bf16 v[112:127], v[24:27], v[20:23], v[112:127]
  ds_read_b64_tr_b16 v[48:49], v1 offset:15360
  ds_read_b64_tr_b16 v[50:51], v1 offset:16896
  v_mfma_f32_32x32x16_bf16 v[128:143], v[28:31], v[20:23], v[128:143]
  ds_read_b64_tr_b16 v[52:53], v1 offset:15488
  ds_read_b64_tr_b16 v[54:55], v1 offset:17024
  ds_read_b128 v[12:15], v2 offset:2048
  s_waitcnt lgkmcnt(7)
  v_mfma_f32_32x32x16_bf16 v[144:159], v[32:35], v[20:23], v[144:159]
  ds_read_b64_tr_b16 v[56:57], v1 offset:15616
  ds_read_b64_tr_b16 v[58:59], v1 offset:17152
  v_cvt_pk_bf16_f32 v216, v80, v81
  v_cvt_pk_bf16_f32 v217, v82, v83
  v_mfma_f32_32x32x16_bf16 v[112:127], v[36:39], v[8:11], v[112:127]
  ds_read_b64_tr_b16 v[24:25], v1 offset:18432
  ds_read_b64_tr_b16 v[26:27], v1 offset:19968
  s_waitcnt lgkmcnt(9)
  v_mfma_f32_32x32x16_bf16 v[128:143], v[40:43], v[8:11], v[128:143]
  ds_read_b64_tr_b16 v[28:29], v1 offset:18560
  ds_read_b64_tr_b16 v[30:31], v1 offset:20096
  ds_read_b128 v[16:19], v2 offset:4096
  v_mfma_f32_32x32x16_bf16 v[144:159], v[44:47], v[8:11], v[144:159]
  ds_read_b64_tr_b16 v[32:33], v1 offset:18688
  ds_read_b64_tr_b16 v[34:35], v1 offset:20224
  v_cvt_pk_bf16_f32 v218, v84, v85
  v_cvt_pk_bf16_f32 v219, v86, v87
  s_waitcnt lgkmcnt(9)
  v_mfma_f32_32x32x16_bf16 v[112:127], v[48:51], v[12:15], v[112:127]
  ds_read_b64_tr_b16 v[36:37], v1 offset:21504
  ds_read_b64_tr_b16 v[38:39], v1 offset:23040
  v_mfma_f32_32x32x16_bf16 v[128:143], v[52:55], v[12:15], v[128:143]
  ds_read_b64_tr_b16 v[40:41], v1 offset:21632
  ds_read_b64_tr_b16 v[42:43], v1 offset:23168
  ds_read_b128 v[20:23], v2 offset:6144
  s_waitcnt lgkmcnt(12)
  v_mfma_f32_32x32x16_bf16 v[144:159], v[56:59], v[12:15], v[144:159]
  ds_read_b64_tr_b16 v[44:45], v1 offset:21760
  ds_read_b64_tr_b16 v[46:47], v1 offset:23296
  s_barrier
  s_waitcnt lgkmcnt(9)
  v_mfma_f32_32x32x16_bf16 v[112:127], v[24:27], v[16:19], v[112:127]
  ds_read_b64_tr_b16 v[48:49], v1 offset:24576
  ds_read_b64_tr_b16 v[50:51], v1 offset:26112
  s_add_u32 s40, s40, 8192
  s_cmp_eq_u32 s40, 73728
  s_cselect_b32 s40, 0, s40
  v_mfma_f32_32x32x16_bf16 v[128:143], v[28:31], v[16:19], v[128:143]
  ds_read_b64_tr_b16 v[52:53], v1 offset:24704
  ds_read_b64_tr_b16 v[54:55], v1 offset:26240
  v_add_u32 v2, s40, v5
  ds_read_b128 v[8:11], v2 offset:0
  s_waitcnt lgkmcnt(7)
  v_mfma_f32_32x32x16_bf16 v[144:159], v[32:35], v[16:19], v[144:159]
  ds_read_b64_tr_b16 v[56:57], v1 offset:24832
  ds_read_b64_tr_b16 v[58:59], v1 offset:26368
  s_nop 1
  v_permlane32_swap_b32 v216, v218
  v_permlane32_swap_b32 v217, v219
  buffer_store_dwordx4 v[216:219], v4, s[16:19], s47 offen sc0 sc1
  s_add_u32 s47, s47, 1024
  v_mfma_f32_32x32x16_bf16 v[112:127], v[36:39], v[20:23], v[112:127]
  ds_read_b64_tr_b16 v[24:25], v1 offset:27648
  ds_read_b64_tr_b16 v[26:27], v1 offset:29184
  s_waitcnt lgkmcnt(9)
  v_mfma_f32_32x32x16_bf16 v[128:143], v[40:43], v[20:23], v[128:143]
  ds_read_b64_tr_b16 v[28:29], v1 offset:27776
  ds_read_b64_tr_b16 v[30:31], v1 offset:29312
  ds_read_b128 v[12:15], v2 offset:2048
  v_mfma_f32_32x32x16_bf16 v[144:159], v[44:47], v[20:23], v[144:159]
  ds_read_b64_tr_b16 v[32:33], v1 offset:27904
  ds_read_b64_tr_b16 v[34:35], v1 offset:29440
  v_cvt_pk_bf16_f32 v220, v88, v89
  v_cvt_pk_bf16_f32 v221, v90, v91
  s_waitcnt lgkmcnt(9)
  v_mfma_f32_32x32x16_bf16 v[112:127], v[48:51], v[8:11], v[112:127]
  ds_read_b64_tr_b16 v[36:37], v1 offset:30720
  ds_read_b64_tr_b16 v[38:39], v1 offset:32256
  v_mfma_f32_32x32x16_bf16 v[128:143], v[52:55], v[8:11], v[128:143]
  ds_read_b64_tr_b16 v[40:41], v1 offset:30848
  ds_read_b64_tr_b16 v[42:43], v1 offset:32384
  ds_read_b128 v[16:19], v2 offset:4096
  s_waitcnt lgkmcnt(12)
  v_mfma_f32_32x32x16_bf16 v[144:159], v[56:59], v[8:11], v[144:159]
  ds_read_b64_tr_b16 v[44:45], v1 offset:30976
  ds_read_b64_tr_b16 v[46:47], v1 offset:32512
  s_barrier
  s_waitcnt lgkmcnt(9)
  v_mfma_f32_32x32x16_bf16 v[112:127], v[24:27], v[12:15], v[112:127]
  ds_read_b64_tr_b16 v[48:49], v1 offset:33792
  ds_read_b64_tr_b16 v[50:51], v1 offset:35328
  v_mfma_f32_32x32x16_bf16 v[128:143], v[28:31], v[12:15], v[128:143]
  ds_read_b64_tr_b16 v[52:53], v1 offset:33920
  ds_read_b64_tr_b16 v[54:55], v1 offset:35456
  ds_read_b128 v[20:23], v2 offset:6144
  s_waitcnt lgkmcnt(7)
  v_mfma_f32_32x32x16_bf16 v[144:159], v[32:35], v[12:15], v[144:159]
  ds_read_b64_tr_b16 v[56:57], v1 offset:34048
  ds_read_b64_tr_b16 v[58:59], v1 offset:35584
  v_cvt_pk_bf16_f32 v222, v92, v93
  v_cvt_pk_bf16_f32 v223, v94, v95
  v_mfma_f32_32x32x16_bf16 v[112:127], v[36:39], v[16:19], v[112:127]
  ds_read_b64_tr_b16 v[24:25], v1 offset:0
  ds_read_b64_tr_b16 v[26:27], v1 offset:1536
  s_add_u32 s40, s40, 8192
  s_cmp_eq_u32 s40, 73728
  s_cselect_b32 s40, 0, s40
  s_waitcnt lgkmcnt(9)
  v_mfma_f32_32x32x16_bf16 v[128:143], v[40:43], v[16:19], v[128:143]
  ds_read_b64_tr_b16 v[28:29], v1 offset:128
  ds_read_b64_tr_b16 v[30:31], v1 offset:1664
  v_add_u32 v2, s40, v5
  ds_read_b128 v[8:11], v2 offset:0
  v_mfma_f32_32x32x16_bf16 v[144:159], v[44:47], v[16:19], v[144:159]
  ds_read_b64_tr_b16 v[32:33], v1 offset:256
  ds_read_b64_tr_b16 v[34:35], v1 offset:1792
  s_nop 1
  v_permlane32_swap_b32 v220, v222
  v_permlane32_swap_b32 v221, v223
  buffer_store_dwordx4 v[220:223], v4, s[16:19], s47 offen sc0 sc1
  s_add_u32 s47, s47, 1024
  s_waitcnt lgkmcnt(9)
  v_mfma_f32_32x32x16_bf16 v[112:127], v[48:51], v[20:23], v[112:127]
  ds_read_b64_tr_b16 v[36:37], v1 offset:3072
  ds_read_b64_tr_b16 v[38:39], v1 offset:4608
  v_mfma_f32_32x32x16_bf16 v[128:143], v[52:55], v[20:23], v[128:143]
  ds_read_b64_tr_b16 v[40:41], v1 offset:3200
  ds_read_b64_tr_b16 v[42:43], v1 offset:4736
  ds_read_b128 v[12:15], v2 offset:2048
  s_waitcnt lgkmcnt(12)
  v_mfma_f32_32x32x16_bf16 v[144:159], v[56:59], v[20:23], v[144:159]
  ds_read_b64_tr_b16 v[44:45], v1 offset:3328
  ds_read_b64_tr_b16 v[46:47], v1 offset:4864
  s_barrier
  s_waitcnt lgkmcnt(9)
  v_mfma_f32_32x32x16_bf16 v[112:127], v[24:27], v[8:11], v[112:127]
  ds_read_b64_tr_b16 v[48:49], v1 offset:6144
  ds_read_b64_tr_b16 v[50:51], v1 offset:7680
  v_mfma_f32_32x32x16_bf16 v[128:143], v[28:31], v[8:11], v[128:143]
  ds_read_b64_tr_b16 v[52:53], v1 offset:6272
  ds_read_b64_tr_b16 v[54:55], v1 offset:7808
  ds_read_b128 v[16:19], v2 offset:4096
  s_waitcnt lgkmcnt(7)
  v_mfma_f32_32x32x16_bf16 v[144:159], v[32:35], v[8:11], v[144:159]
  ds_read_b64_tr_b16 v[56:57], v1 offset:6400
  ds_read_b64_tr_b16 v[58:59], v1 offset:7936
  v_cvt_pk_bf16_f32 v224, v96, v97
  v_cvt_pk_bf16_f32 v225, v98, v99
  v_mfma_f32_32x32x16_bf16 v[112:127], v[36:39], v[12:15], v[112:127]
  ds_read_b64_tr_b16 v[24:25], v1 offset:9216
  ds_read_b64_tr_b16 v[26:27], v1 offset:10752
  s_waitcnt lgkmcnt(9)
  v_mfma_f32_32x32x16_bf16 v[128:143], v[40:43], v[12:15], v[128:143]
  ds_read_b64_tr_b16 v[28:29], v1 offset:9344
  ds_read_b64_tr_b16 v[30:31], v1 offset:10880
  ds_read_b128 v[20:23], v2 offset:6144
  v_mfma_f32_32x32x16_bf16 v[144:159], v[44:47], v[12:15], v[144:159]
  ds_read_b64_tr_b16 v[32:33], v1 offset:9472
  ds_read_b64_tr_b16 v[34:35], v1 offset:11008
  v_cvt_pk_bf16_f32 v226, v100, v101
  v_cvt_pk_bf16_f32 v227, v102, v103
  s_waitcnt lgkmcnt(9)
  v_mfma_f32_32x32x16_bf16 v[112:127], v[48:51], v[16:19], v[112:127]
  ds_read_b64_tr_b16 v[36:37], v1 offset:12288
  ds_read_b64_tr_b16 v[38:39], v1 offset:13824
  s_add_u32 s40, s40, 8192
  s_cmp_eq_u32 s40, 73728
  s_cselect_b32 s40, 0, s40
  v_mfma_f32_32x32x16_bf16 v[128:143], v[52:55], v[16:19], v[128:143]
  ds_read_b64_tr_b16 v[40:41], v1 offset:12416
  ds_read_b64_tr_b16 v[42:43], v1 offset:13952
  v_add_u32 v2, s40, v5
  ds_read_b128 v[8:11], v2 offset:0
  s_waitcnt lgkmcnt(12)
  v_mfma_f32_32x32x16_bf16 v[144:159], v[56:59], v[16:19], v[144:159]
  ds_read_b64_tr_b16 v[44:45], v1 offset:12544
  ds_read_b64_tr_b16 v[46:47], v1 offset:14080
  s_barrier
  s_waitcnt lgkmcnt(9)
  v_mfma_f32_32x32x16_bf16 v[112:127], v[24:27], v[20:23], v[112:127]
  ds_read_b64_tr_b16 v[48:49], v1 offset:15360
  ds_read_b64_tr_b16 v[50:51], v1 offset:16896
  v_mfma_f32_32x32x16_bf16 v[128:143], v[28:31], v[20:23], v[128:143]
  ds_read_b64_tr_b16 v[52:53], v1 offset:15488
  ds_read_b64_tr_b16 v[54:55], v1 offset:17024
  ds_read_b128 v[12:15], v2 offset:2048
  s_waitcnt lgkmcnt(7)
  v_mfma_f32_32x32x16_bf16 v[144:159], v[32:35], v[20:23], v[144:159]
  ds_read_b64_tr_b16 v[56:57], v1 offset:15616
  ds_read_b64_tr_b16 v[58:59], v1 offset:17152
  s_nop 1
  v_permlane32_swap_b32 v224, v226
  v_permlane32_swap_b32 v225, v227
  buffer_store_dwordx4 v[224:227], v4, s[16:19], s47 offen sc0 sc1
  s_add_u32 s47, s47, 1024
  v_mfma_f32_32x32x16_bf16 v[112:127], v[36:39], v[8:11], v[112:127]
  ds_read_b64_tr_b16 v[24:25], v1 offset:18432
  ds_read_b64_tr_b16 v[26:27], v1 offset:19968
  s_waitcnt lgkmcnt(9)
  v_mfma_f32_32x32x16_bf16 v[128:143], v[40:43], v[8:11], v[128:143]
  ds_read_b64_tr_b16 v[28:29], v1 offset:18560
  ds_read_b64_tr_b16 v[30:31], v1 offset:20096
  ds_read_b128 v[16:19], v2 offset:4096
  v_mfma_f32_32x32x16_bf16 v[144:159], v[44:47], v[8:11], v[144:159]
  ds_read_b64_tr_b16 v[32:33], v1 offset:18688
  ds_read_b64_tr_b16 v[34:35], v1 offset:20224
  v_cvt_pk_bf16_f32 v228, v104, v105
  v_cvt_pk_bf16_f32 v229, v106, v107
  s_waitcnt lgkmcnt(9)
  v_mfma_f32_32x32x16_bf16 v[112:127], v[48:51], v[12:15], v[112:127]
  ds_read_b64_tr_b16 v[36:37], v1 offset:21504
  ds_read_b64_tr_b16 v[38:39], v1 offset:23040
  v_mfma_f32_32x32x16_bf16 v[128:143], v[52:55], v[12:15], v[128:143]
  ds_read_b64_tr_b16 v[40:41], v1 offset:21632
  ds_read_b64_tr_b16 v[42:43], v1 offset:23168
  ds_read_b128 v[20:23], v2 offset:6144
  s_waitcnt lgkmcnt(12)
  v_mfma_f32_32x32x16_bf16 v[144:159], v[56:59], v[12:15], v[144:159]
  ds_read_b64_tr_b16 v[44:45], v1 offset:21760
  ds_read_b64_tr_b16 v[46:47], v1 offset:23296
  s_barrier
  s_waitcnt lgkmcnt(9)
  v_mfma_f32_32x32x16_bf16 v[112:127], v[24:27], v[16:19], v[112:127]
  ds_read_b64_tr_b16 v[48:49], v1 offset:24576
  ds_read_b64_tr_b16 v[50:51], v1 offset:26112
  s_add_u32 s40, s40, 8192
  s_cmp_eq_u32 s40, 73728
  s_cselect_b32 s40, 0, s40
  v_mfma_f32_32x32x16_bf16 v[128:143], v[28:31], v[16:19], v[128:143]
  ds_read_b64_tr_b16 v[52:53], v1 offset:24704
  ds_read_b64_tr_b16 v[54:55], v1 offset:26240
  v_add_u32 v2, s40, v5
  ds_read_b128 v[8:11], v2 offset:0
  s_waitcnt lgkmcnt(7)
  v_mfma_f32_32x32x16_bf16 v[144:159], v[32:35], v[16:19], v[144:159]
  ds_read_b64_tr_b16 v[56:57], v1 offset:24832
  ds_read_b64_tr_b16 v[58:59], v1 offset:26368
  v_cvt_pk_bf16_f32 v230, v108, v109
  v_cvt_pk_bf16_f32 v231, v110, v111
  v_mfma_f32_32x32x16_bf16 v[112:127], v[36:39], v[20:23], v[112:127]
  ds_read_b64_tr_b16 v[24:25], v1 offset:27648
  ds_read_b64_tr_b16 v[26:27], v1 offset:29184
  s_waitcnt lgkmcnt(9)
  v_mfma_f32_32x32x16_bf16 v[128:143], v[40:43], v[20:23], v[128:143]
  ds_read_b64_tr_b16 v[28:29], v1 offset:27776
  ds_read_b64_tr_b16 v[30:31], v1 offset:29312
  ds_read_b128 v[12:15], v2 offset:2048
  v_mfma_f32_32x32x16_bf16 v[144:159], v[44:47], v[20:23], v[144:159]
  ds_read_b64_tr_b16 v[32:33], v1 offset:27904
  ds_read_b64_tr_b16 v[34:35], v1 offset:29440
  s_nop 1
  v_permlane32_swap_b32 v228, v230
  v_permlane32_swap_b32 v229, v231
  buffer_store_dwordx4 v[228:231], v4, s[16:19], s47 offen sc0 sc1
  s_add_u32 s47, s47, 1024
  s_waitcnt lgkmcnt(9)
  v_mfma_f32_32x32x16_bf16 v[112:127], v[48:51], v[8:11], v[112:127]
  ds_read_b64_tr_b16 v[36:37], v1 offset:30720
  ds_read_b64_tr_b16 v[38:39], v1 offset:32256
  v_mfma_f32_32x32x16_bf16 v[128:143], v[52:55], v[8:11], v[128:143]
  ds_read_b64_tr_b16 v[40:41], v1 offset:30848
  ds_read_b64_tr_b16 v[42:43], v1 offset:32384
  ds_read_b128 v[16:19], v2 offset:4096
  s_waitcnt lgkmcnt(12)
  v_mfma_f32_32x32x16_bf16 v[144:159], v[56:59], v[8:11], v[144:159]
  ds_read_b64_tr_b16 v[44:45], v1 offset:30976
  ds_read_b64_tr_b16 v[46:47], v1 offset:32512
  s_barrier
  s_waitcnt lgkmcnt(9)
  v_mfma_f32_32x32x16_bf16 v[112:127], v[24:27], v[12:15], v[112:127]
  ds_read_b64_tr_b16 v[48:49], v1 offset:33792
  ds_read_b64_tr_b16 v[50:51], v1 offset:35328
  v_mfma_f32_32x32x16_bf16 v[128:143], v[28:31], v[12:15], v[128:143]
  ds_read_b64_tr_b16 v[52:53], v1 offset:33920
  ds_read_b64_tr_b16 v[54:55], v1 offset:35456
  ds_read_b128 v[20:23], v2 offset:6144
  s_waitcnt lgkmcnt(7)
  v_mfma_f32_32x32x16_bf16 v[144:159], v[32:35], v[12:15], v[144:159]
  ds_read_b64_tr_b16 v[56:57], v1 offset:34048
  ds_read_b64_tr_b16 v[58:59], v1 offset:35584
  v_mfma_f32_32x32x16_bf16 v[112:127], v[36:39], v[16:19], v[112:127]
  ds_read_b64_tr_b16 v[24:25], v1 offset:0
  ds_read_b64_tr_b16 v[26:27], v1 offset:1536
  s_add_u32 s40, s40, 8192
  s_cmp_eq_u32 s40, 73728
  s_cselect_b32 s40, 0, s40
  s_waitcnt lgkmcnt(9)
  v_mfma_f32_32x32x16_bf16 v[128:143], v[40:43], v[16:19], v[128:143]
  ds_read_b64_tr_b16 v[28:29], v1 offset:128
  ds_read_b64_tr_b16 v[30:31], v1 offset:1664
  v_add_u32 v2, s40, v5
  ds_read_b128 v[8:11], v2 offset:0
  v_mfma_f32_32x32x16_bf16 v[144:159], v[44:47], v[16:19], v[144:159]
  ds_read_b64_tr_b16 v[32:33], v1 offset:256
  ds_read_b64_tr_b16 v[34:35], v1 offset:1792
  s_waitcnt lgkmcnt(9)
  v_mfma_f32_32x32x16_bf16 v[112:127], v[48:51], v[20:23], v[112:127]
  ds_read_b64_tr_b16 v[36:37], v1 offset:3072
  ds_read_b64_tr_b16 v[38:39], v1 offset:4608
  v_mfma_f32_32x32x16_bf16 v[128:143], v[52:55], v[20:23], v[128:143]
  ds_read_b64_tr_b16 v[40:41], v1 offset:3200
  ds_read_b64_tr_b16 v[42:43], v1 offset:4736
  ds_read_b128 v[12:15], v2 offset:2048
  s_waitcnt lgkmcnt(12)
  v_mfma_f32_32x32x16_bf16 v[144:159], v[56:59], v[20:23], v[144:159]
  ds_read_b64_tr_b16 v[44:45], v1 offset:3328
  ds_read_b64_tr_b16 v[46:47], v1 offset:4864
  s_barrier
  s_waitcnt lgkmcnt(9)
  v_mfma_f32_32x32x16_bf16 v[160:175], v[24:27], v[8:11], 0
  ds_read_b64_tr_b16 v[48:49], v1 offset:6144
  ds_read_b64_tr_b16 v[50:51], v1 offset:7680
  v_mfma_f32_32x32x16_bf16 v[176:191], v[28:31], v[8:11], 0
  ds_read_b64_tr_b16 v[52:53], v1 offset:6272
  ds_read_b64_tr_b16 v[54:55], v1 offset:7808
  ds_read_b128 v[16:19], v2 offset:4096
  s_waitcnt lgkmcnt(7)
  v_mfma_f32_32x32x16_bf16 v[192:207], v[32:35], v[8:11], 0
  ds_read_b64_tr_b16 v[56:57], v1 offset:6400
  ds_read_b64_tr_b16 v[58:59], v1 offset:7936
  v_mfma_f32_32x32x16_bf16 v[160:175], v[36:39], v[12:15], v[160:175]
  ds_read_b64_tr_b16 v[24:25], v1 offset:9216
  ds_read_b64_tr_b16 v[26:27], v1 offset:10752
  s_waitcnt lgkmcnt(9)
  v_mfma_f32_32x32x16_bf16 v[176:191], v[40:43], v[12:15], v[176:191]
  ds_read_b64_tr_b16 v[28:29], v1 offset:9344
  ds_read_b64_tr_b16 v[30:31], v1 offset:10880
  ds_read_b128 v[20:23], v2 offset:6144
  v_mfma_f32_32x32x16_bf16 v[192:207], v[44:47], v[12:15], v[192:207]
  ds_read_b64_tr_b16 v[32:33], v1 offset:9472
  ds_read_b64_tr_b16 v[34:35], v1 offset:11008
  s_waitcnt lgkmcnt(9)
  v_mfma_f32_32x32x16_bf16 v[160:175], v[48:51], v[16:19], v[160:175]
  ds_read_b64_tr_b16 v[36:37], v1 offset:12288
  ds_read_b64_tr_b16 v[38:39], v1 offset:13824
  s_add_u32 s40, s40, 8192
  s_cmp_eq_u32 s40, 73728
  s_cselect_b32 s40, 0, s40
  v_mfma_f32_32x32x16_bf16 v[176:191], v[52:55], v[16:19], v[176:191]
  ds_read_b64_tr_b16 v[40:41], v1 offset:12416
  ds_read_b64_tr_b16 v[42:43], v1 offset:13952
  v_add_u32 v2, s40, v5
  ds_read_b128 v[8:11], v2 offset:0
  s_waitcnt lgkmcnt(12)
  v_mfma_f32_32x32x16_bf16 v[192:207], v[56:59], v[16:19], v[192:207]
  ds_read_b64_tr_b16 v[44:45], v1 offset:12544
  ds_read_b64_tr_b16 v[46:47], v1 offset:14080
  s_barrier
  s_waitcnt lgkmcnt(9)
  v_mfma_f32_32x32x16_bf16 v[160:175], v[24:27], v[20:23], v[160:175]
  ds_read_b64_tr_b16 v[48:49], v1 offset:15360
  ds_read_b64_tr_b16 v[50:51], v1 offset:16896
  v_mfma_f32_32x32x16_bf16 v[176:191], v[28:31], v[20:23], v[176:191]
  ds_read_b64_tr_b16 v[52:53], v1 offset:15488
  ds_read_b64_tr_b16 v[54:55], v1 offset:17024
  ds_read_b128 v[12:15], v2 offset:2048
  s_waitcnt lgkmcnt(7)
  v_mfma_f32_32x32x16_bf16 v[192:207], v[32:35], v[20:23], v[192:207]
  ds_read_b64_tr_b16 v[56:57], v1 offset:15616
  ds_read_b64_tr_b16 v[58:59], v1 offset:17152
  v_mfma_f32_32x32x16_bf16 v[160:175], v[36:39], v[8:11], v[160:175]
  ds_read_b64_tr_b16 v[24:25], v1 offset:18432
  ds_read_b64_tr_b16 v[26:27], v1 offset:19968
  s_waitcnt lgkmcnt(9)
  v_mfma_f32_32x32x16_bf16 v[176:191], v[40:43], v[8:11], v[176:191]
  ds_read_b64_tr_b16 v[28:29], v1 offset:18560
  ds_read_b64_tr_b16 v[30:31], v1 offset:20096
  ds_read_b128 v[16:19], v2 offset:4096
  v_mfma_f32_32x32x16_bf16 v[192:207], v[44:47], v[8:11], v[192:207]
  ds_read_b64_tr_b16 v[32:33], v1 offset:18688
  ds_read_b64_tr_b16 v[34:35], v1 offset:20224
  s_waitcnt lgkmcnt(9)
  v_mfma_f32_32x32x16_bf16 v[160:175], v[48:51], v[12:15], v[160:175]
  ds_read_b64_tr_b16 v[36:37], v1 offset:21504
  ds_read_b64_tr_b16 v[38:39], v1 offset:23040
  v_mfma_f32_32x32x16_bf16 v[176:191], v[52:55], v[12:15], v[176:191]
  ds_read_b64_tr_b16 v[40:41], v1 offset:21632
  ds_read_b64_tr_b16 v[42:43], v1 offset:23168
  ds_read_b128 v[20:23], v2 offset:6144
  s_waitcnt lgkmcnt(12)
  v_mfma_f32_32x32x16_bf16 v[192:207], v[56:59], v[12:15], v[192:207]
  ds_read_b64_tr_b16 v[44:45], v1 offset:21760
  ds_read_b64_tr_b16 v[46:47], v1 offset:23296
  s_barrier
  s_waitcnt lgkmcnt(9)
  v_mfma_f32_32x32x16_bf16 v[160:175], v[24:27], v[16:19], v[160:175]
  ds_read_b64_tr_b16 v[48:49], v1 offset:24576
  ds_read_b64_tr_b16 v[50:51], v1 offset:26112
  s_add_u32 s40, s40, 8192
  s_cmp_eq_u32 s40, 73728
  s_cselect_b32 s40, 0, s40
  v_mfma_f32_32x32x16_bf16 v[176:191], v[28:31], v[16:19], v[176:191]
  ds_read_b64_tr_b16 v[52:53], v1 offset:24704
  ds_read_b64_tr_b16 v[54:55], v1 offset:26240
  v_add_u32 v2, s40, v5
  ds_read_b128 v[8:11], v2 offset:0
  s_waitcnt lgkmcnt(7)
  v_mfma_f32_32x32x16_bf16 v[192:207], v[32:35], v[16:19], v[192:207]
  ds_read_b64_tr_b16 v[56:57], v1 offset:24832
  ds_read_b64_tr_b16 v[58:59], v1 offset:26368
  v_cvt_pk_bf16_f32 v208, v112, v113
  v_cvt_pk_bf16_f32 v209, v114, v115
  v_mfma_f32_32x32x16_bf16 v[160:175], v[36:39], v[20:23], v[160:175]
  ds_read_b64_tr_b16 v[24:25], v1 offset:27648
  ds_read_b64_tr_b16 v[26:27], v1 offset:29184
  s_waitcnt lgkmcnt(9)
  v_mfma_f32_32x32x16_bf16 v[176:191], v[40:43], v[20:23], v[176:191]
  ds_read_b64_tr_b16 v[28:29], v1 offset:27776
  ds_read_b64_tr_b16 v[30:31], v1 offset:29312
  ds_read_b128 v[12:15], v2 offset:2048
  v_mfma_f32_32x32x16_bf16 v[192:207], v[44:47], v[20:23], v[192:207]
  ds_read_b64_tr_b16 v[32:33], v1 offset:27904
  ds_read_b64_tr_b16 v[34:35], v1 offset:29440
  v_cvt_pk_bf16_f32 v210, v116, v117
  v_cvt_pk_bf16_f32 v211, v118, v119
  s_waitcnt lgkmcnt(9)
  v_mfma_f32_32x32x16_bf16 v[160:175], v[48:51], v[8:11], v[160:175]
  ds_read_b64_tr_b16 v[36:37], v1 offset:30720
  ds_read_b64_tr_b16 v[38:39], v1 offset:32256
  v_mfma_f32_32x32x16_bf16 v[176:191], v[52:55], v[8:11], v[176:191]
  ds_read_b64_tr_b16 v[40:41], v1 offset:30848
  ds_read_b64_tr_b16 v[42:43], v1 offset:32384
  ds_read_b128 v[16:19], v2 offset:4096
  s_waitcnt lgkmcnt(12)
  v_mfma_f32_32x32x16_bf16 v[192:207], v[56:59], v[8:11], v[192:207]
  ds_read_b64_tr_b16 v[44:45], v1 offset:30976
  ds_read_b64_tr_b16 v[46:47], v1 offset:32512
  s_barrier
  s_waitcnt lgkmcnt(9)
  v_mfma_f32_32x32x16_bf16 v[160:175], v[24:27], v[12:15], v[160:175]
  ds_read_b64_tr_b16 v[48:49], v1 offset:33792
  ds_read_b64_tr_b16 v[50:51], v1 offset:35328
  v_mfma_f32_32x32x16_bf16 v[176:191], v[28:31], v[12:15], v[176:191]
  ds_read_b64_tr_b16 v[52:53], v1 offset:33920
  ds_read_b64_tr_b16 v[54:55], v1 offset:35456
  ds_read_b128 v[20:23], v2 offset:6144
  s_waitcnt lgkmcnt(7)
  v_mfma_f32_32x32x16_bf16 v[192:207], v[32:35], v[12:15], v[192:207]
  ds_read_b64_tr_b16 v[56:57], v1 offset:34048
  ds_read_b64_tr_b16 v[58:59], v1 offset:35584
  s_nop 1
  v_permlane32_swap_b32 v208, v210
  v_permlane32_swap_b32 v209, v211
  buffer_store_dwordx4 v[208:211], v4, s[16:19], s47 offen sc0 sc1
  s_add_u32 s47, s47, 1024
  v_mfma_f32_32x32x16_bf16 v[160:175], v[36:39], v[16:19], v[160:175]
  ds_read_b64_tr_b16 v[24:25], v1 offset:0
  ds_read_b64_tr_b16 v[26:27], v1 offset:1536
  s_add_u32 s40, s40, 8192
  s_cmp_eq_u32 s40, 73728
  s_cselect_b32 s40, 0, s40
  s_waitcnt lgkmcnt(9)
  v_mfma_f32_32x32x16_bf16 v[176:191], v[40:43], v[16:19], v[176:191]
  ds_read_b64_tr_b16 v[28:29], v1 offset:128
  ds_read_b64_tr_b16 v[30:31], v1 offset:1664
  v_add_u32 v2, s40, v5
  ds_read_b128 v[8:11], v2 offset:0
  v_mfma_f32_32x32x16_bf16 v[192:207], v[44:47], v[16:19], v[192:207]
  ds_read_b64_tr_b16 v[32:33], v1 offset:256
  ds_read_b64_tr_b16 v[34:35], v1 offset:1792
  v_cvt_pk_bf16_f32 v212, v120, v121
  v_cvt_pk_bf16_f32 v213, v122, v123
  s_waitcnt lgkmcnt(9)
  v_mfma_f32_32x32x16_bf16 v[160:175], v[48:51], v[20:23], v[160:175]
  ds_read_b64_tr_b16 v[36:37], v1 offset:3072
  ds_read_b64_tr_b16 v[38:39], v1 offset:4608
  v_mfma_f32_32x32x16_bf16 v[176:191], v[52:55], v[20:23], v[176:191]
  ds_read_b64_tr_b16 v[40:41], v1 offset:3200
  ds_read_b64_tr_b16 v[42:43], v1 offset:4736
  ds_read_b128 v[12:15], v2 offset:2048
  s_waitcnt lgkmcnt(12)
  v_mfma_f32_32x32x16_bf16 v[192:207], v[56:59], v[20:23], v[192:207]
  ds_read_b64_tr_b16 v[44:45], v1 offset:3328
  ds_read_b64_tr_b16 v[46:47], v1 offset:4864
  s_barrier
  s_waitcnt lgkmcnt(9)
  v_mfma_f32_32x32x16_bf16 v[160:175], v[24:27], v[8:11], v[160:175]
  ds_read_b64_tr_b16 v[48:49], v1 offset:6144
  ds_read_b64_tr_b16 v[50:51], v1 offset:7680
  v_mfma_f32_32x32x16_bf16 v[176:191], v[28:31], v[8:11], v[176:191]
  ds_read_b64_tr_b16 v[52:53], v1 offset:6272
  ds_read_b64_tr_b16 v[54:55], v1 offset:7808
  ds_read_b128 v[16:19], v2 offset:4096
  s_waitcnt lgkmcnt(7)
  v_mfma_f32_32x32x16_bf16 v[192:207], v[32:35], v[8:11], v[192:207]
  ds_read_b64_tr_b16 v[56:57], v1 offset:6400
  ds_read_b64_tr_b16 v[58:59], v1 offset:7936
  v_cvt_pk_bf16_f32 v214, v124, v125
  v_cvt_pk_bf16_f32 v215, v126, v127
  v_mfma_f32_32x32x16_bf16 v[160:175], v[36:39], v[12:15], v[160:175]
  ds_read_b64_tr_b16 v[24:25], v1 offset:9216
  ds_read_b64_tr_b16 v[26:27], v1 offset:10752
  s_waitcnt lgkmcnt(9)
  v_mfma_f32_32x32x16_bf16 v[176:191], v[40:43], v[12:15], v[176:191]
  ds_read_b64_tr_b16 v[28:29], v1 offset:9344
  ds_read_b64_tr_b16 v[30:31], v1 offset:10880
  ds_read_b128 v[20:23], v2 offset:6144
  v_mfma_f32_32x32x16_bf16 v[192:207], v[44:47], v[12:15], v[192:207]
  ds_read_b64_tr_b16 v[32:33], v1 offset:9472
  ds_read_b64_tr_b16 v[34:35], v1 offset:11008
  s_nop 1
  v_permlane32_swap_b32 v212, v214
  v_permlane32_swap_b32 v213, v215
  buffer_store_dwordx4 v[212:215], v4, s[16:19], s47 offen sc0 sc1
  s_add_u32 s47, s47, 1024
  s_waitcnt lgkmcnt(9)
  v_mfma_f32_32x32x16_bf16 v[160:175], v[48:51], v[16:19], v[160:175]
  ds_read_b64_tr_b16 v[36:37], v1 offset:12288
  ds_read_b64_tr_b16 v[38:39], v1 offset:13824
  s_add_u32 s40, s40, 8192
  s_cmp_eq_u32 s40, 73728
  s_cselect_b32 s40, 0, s40
  v_mfma_f32_32x32x16_bf16 v[176:191], v[52:55], v[16:19], v[176:191]
  ds_read_b64_tr_b16 v[40:41], v1 offset:12416
  ds_read_b64_tr_b16 v[42:43], v1 offset:13952
  v_add_u32 v2, s40, v5
  ds_read_b128 v[8:11], v2 offset:0
  s_waitcnt lgkmcnt(12)
  v_mfma_f32_32x32x16_bf16 v[192:207], v[56:59], v[16:19], v[192:207]
  ds_read_b64_tr_b16 v[44:45], v1 offset:12544
  ds_read_b64_tr_b16 v[46:47], v1 offset:14080
  s_barrier
  s_waitcnt lgkmcnt(9)
  v_mfma_f32_32x32x16_bf16 v[160:175], v[24:27], v[20:23], v[160:175]
  ds_read_b64_tr_b16 v[48:49], v1 offset:15360
  ds_read_b64_tr_b16 v[50:51], v1 offset:16896
  v_mfma_f32_32x32x16_bf16 v[176:191], v[28:31], v[20:23], v[176:191]
  ds_read_b64_tr_b16 v[52:53], v1 offset:15488
  ds_read_b64_tr_b16 v[54:55], v1 offset:17024
  ds_read_b128 v[12:15], v2 offset:2048
  s_waitcnt lgkmcnt(7)
  v_mfma_f32_32x32x16_bf16 v[192:207], v[32:35], v[20:23], v[192:207]
  ds_read_b64_tr_b16 v[56:57], v1 offset:15616
  ds_read_b64_tr_b16 v[58:59], v1 offset:17152
  v_cvt_pk_bf16_f32 v216, v128, v129
  v_cvt_pk_bf16_f32 v217, v130, v131
  v_mfma_f32_32x32x16_bf16 v[160:175], v[36:39], v[8:11], v[160:175]
  ds_read_b64_tr_b16 v[24:25], v1 offset:18432
  ds_read_b64_tr_b16 v[26:27], v1 offset:19968
  s_waitcnt lgkmcnt(9)
  v_mfma_f32_32x32x16_bf16 v[176:191], v[40:43], v[8:11], v[176:191]
  ds_read_b64_tr_b16 v[28:29], v1 offset:18560
  ds_read_b64_tr_b16 v[30:31], v1 offset:20096
  ds_read_b128 v[16:19], v2 offset:4096
  v_mfma_f32_32x32x16_bf16 v[192:207], v[44:47], v[8:11], v[192:207]
  ds_read_b64_tr_b16 v[32:33], v1 offset:18688
  ds_read_b64_tr_b16 v[34:35], v1 offset:20224
  v_cvt_pk_bf16_f32 v218, v132, v133
  v_cvt_pk_bf16_f32 v219, v134, v135
  s_waitcnt lgkmcnt(9)
  v_mfma_f32_32x32x16_bf16 v[160:175], v[48:51], v[12:15], v[160:175]
  ds_read_b64_tr_b16 v[36:37], v1 offset:21504
  ds_read_b64_tr_b16 v[38:39], v1 offset:23040
  v_mfma_f32_32x32x16_bf16 v[176:191], v[52:55], v[12:15], v[176:191]
  ds_read_b64_tr_b16 v[40:41], v1 offset:21632
  ds_read_b64_tr_b16 v[42:43], v1 offset:23168
  ds_read_b128 v[20:23], v2 offset:6144
  s_waitcnt lgkmcnt(12)
  v_mfma_f32_32x32x16_bf16 v[192:207], v[56:59], v[12:15], v[192:207]
  ds_read_b64_tr_b16 v[44:45], v1 offset:21760
  ds_read_b64_tr_b16 v[46:47], v1 offset:23296
  s_barrier
  s_waitcnt lgkmcnt(9)
  v_mfma_f32_32x32x16_bf16 v[160:175], v[24:27], v[16:19], v[160:175]
  ds_read_b64_tr_b16 v[48:49], v1 offset:24576
  ds_read_b64_tr_b16 v[50:51], v1 offset:26112
  s_add_u32 s40, s40, 8192
  s_cmp_eq_u32 s40, 73728
  s_cselect_b32 s40, 0, s40
  v_mfma_f32_32x32x16_bf16 v[176:191], v[28:31], v[16:19], v[176:191]
  ds_read_b64_tr_b16 v[52:53], v1 offset:24704
  ds_read_b64_tr_b16 v[54:55], v1 offset:26240
  v_add_u32 v2, s40, v5
  ds_read_b128 v[8:11], v2 offset:0
  s_waitcnt lgkmcnt(7)
  v_mfma_f32_32x32x16_bf16 v[192:207], v[32:35], v[16:19], v[192:207]
  ds_read_b64_tr_b16 v[56:57], v1 offset:24832
  ds_read_b64_tr_b16 v[58:59], v1 offset:26368
  s_nop 1
  v_permlane32_swap_b32 v216, v218
  v_permlane32_swap_b32 v217, v219
  buffer_store_dwordx4 v[216:219], v4, s[16:19], s47 offen sc0 sc1
  s_add_u32 s47, s47, 1024
  v_mfma_f32_32x32x16_bf16 v[160:175], v[36:39], v[20:23], v[160:175]
  ds_read_b64_tr_b16 v[24:25], v1 offset:27648
  ds_read_b64_tr_b16 v[26:27], v1 offset:29184
  s_waitcnt lgkmcnt(9)
  v_mfma_f32_32x32x16_bf16 v[176:191], v[40:43], v[20:23], v[176:191]
  ds_read_b64_tr_b16 v[28:29], v1 offset:27776
  ds_read_b64_tr_b16 v[30:31], v1 offset:29312
  ds_read_b128 v[12:15], v2 offset:2048
  v_mfma_f32_32x32x16_bf16 v[192:207], v[44:47], v[20:23], v[192:207]
  ds_read_b64_tr_b16 v[32:33], v1 offset:27904
  ds_read_b64_tr_b16 v[34:35], v1 offset:29440
  v_cvt_pk_bf16_f32 v220, v136, v137
  v_cvt_pk_bf16_f32 v221, v138, v139
  s_waitcnt lgkmcnt(9)
  v_mfma_f32_32x32x16_bf16 v[160:175], v[48:51], v[8:11], v[160:175]
  ds_read_b64_tr_b16 v[36:37], v1 offset:30720
  ds_read_b64_tr_b16 v[38:39], v1 offset:32256
  v_mfma_f32_32x32x16_bf16 v[176:191], v[52:55], v[8:11], v[176:191]
  ds_read_b64_tr_b16 v[40:41], v1 offset:30848
  ds_read_b64_tr_b16 v[42:43], v1 offset:32384
  ds_read_b128 v[16:19], v2 offset:4096
  s_waitcnt lgkmcnt(12)
  v_mfma_f32_32x32x16_bf16 v[192:207], v[56:59], v[8:11], v[192:207]
  ds_read_b64_tr_b16 v[44:45], v1 offset:30976
  ds_read_b64_tr_b16 v[46:47], v1 offset:32512
  s_barrier
  s_waitcnt lgkmcnt(9)
  v_mfma_f32_32x32x16_bf16 v[160:175], v[24:27], v[12:15], v[160:175]
  ds_read_b64_tr_b16 v[48:49], v1 offset:33792
  ds_read_b64_tr_b16 v[50:51], v1 offset:35328
  v_mfma_f32_32x32x16_bf16 v[176:191], v[28:31], v[12:15], v[176:191]
  ds_read_b64_tr_b16 v[52:53], v1 offset:33920
  ds_read_b64_tr_b16 v[54:55], v1 offset:35456
  ds_read_b128 v[20:23], v2 offset:6144
  s_waitcnt lgkmcnt(7)
  v_mfma_f32_32x32x16_bf16 v[192:207], v[32:35], v[12:15], v[192:207]
  ds_read_b64_tr_b16 v[56:57], v1 offset:34048
  ds_read_b64_tr_b16 v[58:59], v1 offset:35584
  v_cvt_pk_bf16_f32 v222, v140, v141
  v_cvt_pk_bf16_f32 v223, v142, v143
  v_mfma_f32_32x32x16_bf16 v[160:175], v[36:39], v[16:19], v[160:175]
  ds_read_b64_tr_b16 v[24:25], v1 offset:0
  ds_read_b64_tr_b16 v[26:27], v1 offset:1536
  s_add_u32 s40, s40, 8192
  s_cmp_eq_u32 s40, 73728
  s_cselect_b32 s40, 0, s40
  s_waitcnt lgkmcnt(9)
  v_mfma_f32_32x32x16_bf16 v[176:191], v[40:43], v[16:19], v[176:191]
  ds_read_b64_tr_b16 v[28:29], v1 offset:128
  ds_read_b64_tr_b16 v[30:31], v1 offset:1664
  v_add_u32 v2, s40, v5
  ds_read_b128 v[8:11], v2 offset:0
  v_mfma_f32_32x32x16_bf16 v[192:207], v[44:47], v[16:19], v[192:207]
  ds_read_b64_tr_b16 v[32:33], v1 offset:256
  ds_read_b64_tr_b16 v[34:35], v1 offset:1792
  s_nop 1
  v_permlane32_swap_b32 v220, v222
  v_permlane32_swap_b32 v221, v223
  buffer_store_dwordx4 v[220:223], v4, s[16:19], s47 offen sc0 sc1
  s_add_u32 s47, s47, 1024
  s_waitcnt lgkmcnt(9)
  v_mfma_f32_32x32x16_bf16 v[160:175], v[48:51], v[20:23], v[160:175]
  ds_read_b64_tr_b16 v[36:37], v1 offset:3072
  ds_read_b64_tr_b16 v[38:39], v1 offset:4608
  v_mfma_f32_32x32x16_bf16 v[176:191], v[52:55], v[20:23], v[176:191]
  ds_read_b64_tr_b16 v[40:41], v1 offset:3200
  ds_read_b64_tr_b16 v[42:43], v1 offset:4736
  ds_read_b128 v[12:15], v2 offset:2048
  s_waitcnt lgkmcnt(12)
  v_mfma_f32_32x32x16_bf16 v[192:207], v[56:59], v[20:23], v[192:207]
  ds_read_b64_tr_b16 v[44:45], v1 offset:3328
  ds_read_b64_tr_b16 v[46:47], v1 offset:4864
  s_barrier
  s_waitcnt lgkmcnt(9)
  v_mfma_f32_32x32x16_bf16 v[160:175], v[24:27], v[8:11], v[160:175]
  ds_read_b64_tr_b16 v[48:49], v1 offset:6144
  ds_read_b64_tr_b16 v[50:51], v1 offset:7680
  v_mfma_f32_32x32x16_bf16 v[176:191], v[28:31], v[8:11], v[176:191]
  ds_read_b64_tr_b16 v[52:53], v1 offset:6272
  ds_read_b64_tr_b16 v[54:55], v1 offset:7808
  ds_read_b128 v[16:19], v2 offset:4096
  s_waitcnt lgkmcnt(7)
  v_mfma_f32_32x32x16_bf16 v[192:207], v[32:35], v[8:11], v[192:207]
  ds_read_b64_tr_b16 v[56:57], v1 offset:6400
  ds_read_b64_tr_b16 v[58:59], v1 offset:7936
  v_cvt_pk_bf16_f32 v224, v144, v145
  v_cvt_pk_bf16_f32 v225, v146, v147
  v_mfma_f32_32x32x16_bf16 v[160:175], v[36:39], v[12:15], v[160:175]
  ds_read_b64_tr_b16 v[24:25], v1 offset:9216
  ds_read_b64_tr_b16 v[26:27], v1 offset:10752
  s_waitcnt lgkmcnt(9)
  v_mfma_f32_32x32x16_bf16 v[176:191], v[40:43], v[12:15], v[176:191]
  ds_read_b64_tr_b16 v[28:29], v1 offset:9344
  ds_read_b64_tr_b16 v[30:31], v1 offset:10880
  ds_read_b128 v[20:23], v2 offset:6144
  v_mfma_f32_32x32x16_bf16 v[192:207], v[44:47], v[12:15], v[192:207]
  ds_read_b64_tr_b16 v[32:33], v1 offset:9472
  ds_read_b64_tr_b16 v[34:35], v1 offset:11008
  v_cvt_pk_bf16_f32 v226, v148, v149
  v_cvt_pk_bf16_f32 v227, v150, v151
  s_waitcnt lgkmcnt(9)
  v_mfma_f32_32x32x16_bf16 v[160:175], v[48:51], v[16:19], v[160:175]
  ds_read_b64_tr_b16 v[36:37], v1 offset:12288
  ds_read_b64_tr_b16 v[38:39], v1 offset:13824
  s_add_u32 s40, s40, 8192
  s_cmp_eq_u32 s40, 73728
  s_cselect_b32 s40, 0, s40
  v_mfma_f32_32x32x16_bf16 v[176:191], v[52:55], v[16:19], v[176:191]
  ds_read_b64_tr_b16 v[40:41], v1 offset:12416
  ds_read_b64_tr_b16 v[42:43], v1 offset:13952
  v_add_u32 v2, s40, v5
  ds_read_b128 v[8:11], v2 offset:0
  s_waitcnt lgkmcnt(12)
  v_mfma_f32_32x32x16_bf16 v[192:207], v[56:59], v[16:19], v[192:207]
  ds_read_b64_tr_b16 v[44:45], v1 offset:12544
  ds_read_b64_tr_b16 v[46:47], v1 offset:14080
  s_barrier
  s_waitcnt lgkmcnt(9)
  v_mfma_f32_32x32x16_bf16 v[160:175], v[24:27], v[20:23], v[160:175]
  ds_read_b64_tr_b16 v[48:49], v1 offset:15360
  ds_read_b64_tr_b16 v[50:51], v1 offset:16896
  v_mfma_f32_32x32x16_bf16 v[176:191], v[28:31], v[20:23], v[176:191]
  ds_read_b64_tr_b16 v[52:53], v1 offset:15488
  ds_read_b64_tr_b16 v[54:55], v1 offset:17024
  ds_read_b128 v[12:15], v2 offset:2048
  s_waitcnt lgkmcnt(7)
  v_mfma_f32_32x32x16_bf16 v[192:207], v[32:35], v[20:23], v[192:207]
  ds_read_b64_tr_b16 v[56:57], v1 offset:15616
  ds_read_b64_tr_b16 v[58:59], v1 offset:17152
  s_nop 1
  v_permlane32_swap_b32 v224, v226
  v_permlane32_swap_b32 v225, v227
  buffer_store_dwordx4 v[224:227], v4, s[16:19], s47 offen sc0 sc1
  s_add_u32 s47, s47, 1024
  v_mfma_f32_32x32x16_bf16 v[160:175], v[36:39], v[8:11], v[160:175]
  ds_read_b64_tr_b16 v[24:25], v1 offset:18432
  ds_read_b64_tr_b16 v[26:27], v1 offset:19968
  s_waitcnt lgkmcnt(9)
  v_mfma_f32_32x32x16_bf16 v[176:191], v[40:43], v[8:11], v[176:191]
  ds_read_b64_tr_b16 v[28:29], v1 offset:18560
  ds_read_b64_tr_b16 v[30:31], v1 offset:20096
  ds_read_b128 v[16:19], v2 offset:4096
  v_mfma_f32_32x32x16_bf16 v[192:207], v[44:47], v[8:11], v[192:207]
  ds_read_b64_tr_b16 v[32:33], v1 offset:18688
  ds_read_b64_tr_b16 v[34:35], v1 offset:20224
  v_cvt_pk_bf16_f32 v228, v152, v153
  v_cvt_pk_bf16_f32 v229, v154, v155
  s_waitcnt lgkmcnt(9)
  v_mfma_f32_32x32x16_bf16 v[160:175], v[48:51], v[12:15], v[160:175]
  ds_read_b64_tr_b16 v[36:37], v1 offset:21504
  ds_read_b64_tr_b16 v[38:39], v1 offset:23040
  v_mfma_f32_32x32x16_bf16 v[176:191], v[52:55], v[12:15], v[176:191]
  ds_read_b64_tr_b16 v[40:41], v1 offset:21632
  ds_read_b64_tr_b16 v[42:43], v1 offset:23168
  ds_read_b128 v[20:23], v2 offset:6144
  s_waitcnt lgkmcnt(12)
  v_mfma_f32_32x32x16_bf16 v[192:207], v[56:59], v[12:15], v[192:207]
  ds_read_b64_tr_b16 v[44:45], v1 offset:21760
  ds_read_b64_tr_b16 v[46:47], v1 offset:23296
  s_barrier
  s_waitcnt lgkmcnt(9)
  v_mfma_f32_32x32x16_bf16 v[160:175], v[24:27], v[16:19], v[160:175]
  ds_read_b64_tr_b16 v[48:49], v1 offset:24576
  ds_read_b64_tr_b16 v[50:51], v1 offset:26112
  s_add_u32 s40, s40, 8192
  s_cmp_eq_u32 s40, 73728
  s_cselect_b32 s40, 0, s40
  v_mfma_f32_32x32x16_bf16 v[176:191], v[28:31], v[16:19], v[176:191]
  ds_read_b64_tr_b16 v[52:53], v1 offset:24704
  ds_read_b64_tr_b16 v[54:55], v1 offset:26240
  v_add_u32 v2, s40, v5
  ds_read_b128 v[8:11], v2 offset:0
  s_waitcnt lgkmcnt(7)
  v_mfma_f32_32x32x16_bf16 v[192:207], v[32:35], v[16:19], v[192:207]
  ds_read_b64_tr_b16 v[56:57], v1 offset:24832
  ds_read_b64_tr_b16 v[58:59], v1 offset:26368
  v_cvt_pk_bf16_f32 v230, v156, v157
  v_cvt_pk_bf16_f32 v231, v158, v159
  v_mfma_f32_32x32x16_bf16 v[160:175], v[36:39], v[20:23], v[160:175]
  ds_read_b64_tr_b16 v[24:25], v1 offset:27648
  ds_read_b64_tr_b16 v[26:27], v1 offset:29184
  s_waitcnt lgkmcnt(9)
  v_mfma_f32_32x32x16_bf16 v[176:191], v[40:43], v[20:23], v[176:191]
  ds_read_b64_tr_b16 v[28:29], v1 offset:27776
  ds_read_b64_tr_b16 v[30:31], v1 offset:29312
  ds_read_b128 v[12:15], v2 offset:2048
  v_mfma_f32_32x32x16_bf16 v[192:207], v[44:47], v[20:23], v[192:207]
  ds_read_b64_tr_b16 v[32:33], v1 offset:27904
  ds_read_b64_tr_b16 v[34:35], v1 offset:29440
  s_nop 1
  v_permlane32_swap_b32 v228, v230
  v_permlane32_swap_b32 v229, v231
  buffer_store_dwordx4 v[228:231], v4, s[16:19], s47 offen sc0 sc1
  s_add_u32 s47, s47, 1024
  s_waitcnt lgkmcnt(9)
  v_mfma_f32_32x32x16_bf16 v[160:175], v[48:51], v[8:11], v[160:175]
  ds_read_b64_tr_b16 v[36:37], v1 offset:30720
  ds_read_b64_tr_b16 v[38:39], v1 offset:32256
  v_mfma_f32_32x32x16_bf16 v[176:191], v[52:55], v[8:11], v[176:191]
  ds_read_b64_tr_b16 v[40:41], v1 offset:30848
  ds_read_b64_tr_b16 v[42:43], v1 offset:32384
  ds_read_b128 v[16:19], v2 offset:4096
  s_waitcnt lgkmcnt(12)
  v_mfma_f32_32x32x16_bf16 v[192:207], v[56:59], v[8:11], v[192:207]
  ds_read_b64_tr_b16 v[44:45], v1 offset:30976
  ds_read_b64_tr_b16 v[46:47], v1 offset:32512
  s_barrier
  s_waitcnt lgkmcnt(9)
  v_mfma_f32_32x32x16_bf16 v[160:175], v[24:27], v[12:15], v[160:175]
  ds_read_b64_tr_b16 v[48:49], v1 offset:33792
  ds_read_b64_tr_b16 v[50:51], v1 offset:35328
  v_mfma_f32_32x32x16_bf16 v[176:191], v[28:31], v[12:15], v[176:191]
  ds_read_b64_tr_b16 v[52:53], v1 offset:33920
  ds_read_b64_tr_b16 v[54:55], v1 offset:35456
  ds_read_b128 v[20:23], v2 offset:6144
  s_waitcnt lgkmcnt(7)
  v_mfma_f32_32x32x16_bf16 v[192:207], v[32:35], v[12:15], v[192:207]
  ds_read_b64_tr_b16 v[56:57], v1 offset:34048
  ds_read_b64_tr_b16 v[58:59], v1 offset:35584
  v_mfma_f32_32x32x16_bf16 v[160:175], v[36:39], v[16:19], v[160:175]
  s_add_u32 s40, s40, 8192
  s_cmp_eq_u32 s40, 73728
  s_cselect_b32 s40, 0, s40
  s_waitcnt lgkmcnt(7)
  v_mfma_f32_32x32x16_bf16 v[176:191], v[40:43], v[16:19], v[176:191]
  v_mfma_f32_32x32x16_bf16 v[192:207], v[44:47], v[16:19], v[192:207]
  s_waitcnt lgkmcnt(2)
  v_mfma_f32_32x32x16_bf16 v[160:175], v[48:51], v[20:23], v[160:175]
  v_mfma_f32_32x32x16_bf16 v[176:191], v[52:55], v[20:23], v[176:191]
  s_waitcnt lgkmcnt(0)
  v_mfma_f32_32x32x16_bf16 v[192:207], v[56:59], v[20:23], v[192:207]
  s_nop 7
  s_nop 3
  v_cvt_pk_bf16_f32 v208, v160, v161
  v_cvt_pk_bf16_f32 v209, v162, v163
  v_cvt_pk_bf16_f32 v210, v164, v165
  v_cvt_pk_bf16_f32 v211, v166, v167
  s_nop 1
  v_permlane32_swap_b32 v208, v210
  v_permlane32_swap_b32 v209, v211
  buffer_store_dwordx4 v[208:211], v4, s[16:19], s47 offen sc0 sc1
  s_add_u32 s47, s47, 1024
  v_cvt_pk_bf16_f32 v212, v168, v169
  v_cvt_pk_bf16_f32 v213, v170, v171
  v_cvt_pk_bf16_f32 v214, v172, v173
  v_cvt_pk_bf16_f32 v215, v174, v175
  s_nop 1
  v_permlane32_swap_b32 v212, v214
  v_permlane32_swap_b32 v213, v215
  buffer_store_dwordx4 v[212:215], v4, s[16:19], s47 offen sc0 sc1
  s_add_u32 s47, s47, 1024
  v_cvt_pk_bf16_f32 v216, v176, v177
  v_cvt_pk_bf16_f32 v217, v178, v179
  v_cvt_pk_bf16_f32 v218, v180, v181
  v_cvt_pk_bf16_f32 v219, v182, v183
  s_nop 1
  v_permlane32_swap_b32 v216, v218
  v_permlane32_swap_b32 v217, v219
  buffer_store_dwordx4 v[216:219], v4, s[16:19], s47 offen sc0 sc1
  s_add_u32 s47, s47, 1024
  v_cvt_pk_bf16_f32 v220, v184, v185
  v_cvt_pk_bf16_f32 v221, v186, v187
  v_cvt_pk_bf16_f32 v222, v188, v189
  v_cvt_pk_bf16_f32 v223, v190, v191
  s_nop 1
  v_permlane32_swap_b32 v220, v222
  v_permlane32_swap_b32 v221, v223
  buffer_store_dwordx4 v[220:223], v4, s[16:19], s47 offen sc0 sc1
  s_add_u32 s47, s47, 1024
  v_cvt_pk_bf16_f32 v224, v192, v193
  v_cvt_pk_bf16_f32 v225, v194, v195
  v_cvt_pk_bf16_f32 v226, v196, v197
  v_cvt_pk_bf16_f32 v227, v198, v199
  s_nop 1
  v_permlane32_swap_b32 v224, v226
  v_permlane32_swap_b32 v225, v227
  buffer_store_dwordx4 v[224:227], v4, s[16:19], s47 offen sc0 sc1
  s_add_u32 s47, s47, 1024
  v_cvt_pk_bf16_f32 v228, v200, v201
  v_cvt_pk_bf16_f32 v229, v202, v203
  v_cvt_pk_bf16_f32 v230, v204, v205
  v_cvt_pk_bf16_f32 v231, v206, v207
  s_nop 1
  v_permlane32_swap_b32 v228, v230
  v_permlane32_swap_b32 v229, v231
  buffer_store_dwordx4 v[228:231], v4, s[16:19], s47 offen sc0 sc1
  s_add_u32 s47, s47, 1024
  s_branch L_tail
L_helper:
  s_sub_u32 s30, s24, 4
  v_and_b32 v240, 63, v0
  v_and_b32 v1, 255, v0
  s_mov_b32 s96, 1060439283
  s_mov_b32 s97, s96
  s_lshr_b32 s40, s2, 5
  s_lshl_b32 s40, s40, 3
  s_and_b32 s41, s2, 7
  s_add_u32 s40, s40, s41
  s_lshl_b32 s40, s40, 2
  s_bfe_u32 s41, s2, 0x20003
  s_add_u32 s40, s40, s41
  s_mov_b32 s56, 0
  s_mov_b32 s57, s40
  s_sub_u32 s58, s40, 76
  s_cmp_ge_u32 s40, 76
  s_cselect_b32 s56, 1, s56
  s_cselect_b32 s57, s58, s57
  s_sub_u32 s58, s40, 152
  s_cmp_ge_u32 s40, 152
  s_cselect_b32 s56, 2, s56
  s_cselect_b32 s57, s58, s57
  s_sub_u32 s58, s40, 224
  s_cmp_ge_u32 s40, 224
  s_cselect_b32 s56, 3, s56
  s_cselect_b32 s57, s58, s57
  s_min_u32 s57, s57, 72
  s_cmp_eq_u32 s56, 3
  s_cselect_b32 s58, 1, 0
  s_max_u32 s57, s57, s58
  s_mov_b32 s61, s57
  s_sub_u32 s58, 288, s57
  s_cmp_eq_u32 s56, 1
  s_cselect_b32 s61, s58, s61
  s_add_u32 s58, s57, 144
  s_cmp_eq_u32 s56, 2
  s_cselect_b32 s61, s58, s61
  s_sub_u32 s58, 144, s57
  s_cmp_eq_u32 s56, 3
  s_cselect_b32 s61, s58, s61
  s_mul_i32 s58, s56, 20
  s_lshr_b32 s59, s57, 2
  s_add_u32 s58, s58, s59
  s_lshl_b32 s58, s58, 15
  s_and_b32 s59, s57, 3
  s_lshl_b32 s59, s59, 2
  s_add_u32 s58, s58, s59
  s_add_u32 s98, s58, 39845888
  s_cmp_lt_i32 s28, 0
  s_cbranch_scc1 L_nsd
  s_mov_b32 s40, s28
  s_mov_b32 s56, 0
  s_mov_b32 s57, s40
  s_sub_u32 s58, s40, 76
  s_cmp_ge_u32 s40, 76
  s_cselect_b32 s56, 1, s56
  s_cselect_b32 s57, s58, s57
  s_sub_u32 s58, s40, 152
  s_cmp_ge_u32 s40, 152
  s_cselect_b32 s56, 2, s56
  s_cselect_b32 s57, s58, s57
  s_sub_u32 s58, s40, 224
  s_cmp_ge_u32 s40, 224
  s_cselect_b32 s56, 3, s56
  s_cselect_b32 s57, s58, s57
  s_min_u32 s57, s57, 72
  s_cmp_eq_u32 s56, 3
  s_cselect_b32 s58, 1, 0
  s_max_u32 s57, s57, s58
  s_mov_b32 s28, s57
  s_sub_u32 s58, 288, s57
  s_cmp_eq_u32 s56, 1
  s_cselect_b32 s28, s58, s28
  s_add_u32 s58, s57, 144
  s_cmp_eq_u32 s56, 2
  s_cselect_b32 s28, s58, s28
  s_sub_u32 s58, 144, s57
  s_cmp_eq_u32 s56, 3
  s_cselect_b32 s28, s58, s28
  s_mul_i32 s58, s56, 20
  s_lshr_b32 s59, s57, 2
  s_add_u32 s58, s58, s59
  s_lshl_b32 s58, s58, 15
  s_and_b32 s59, s57, 3
  s_lshl_b32 s59, s59, 2
  s_add_u32 s58, s58, s59
  s_add_u32 s99, s58, 39845888
L_nsd:
  s_waitcnt lgkmcnt(0)
  s_add_u32 s29, s29, 1
  s_sub_u32 s31, s24, 4
  v_and_b32 v240, 63, v0
  v_add_u32 v248, 0, v240
  v_cvt_f32_u32 v251, v248
  v_add_f32 v251, 0.5, v251
  v_mul_f32 v251, 0.041666666666666664, v251
  v_cvt_u32_f32 v249, v251
  v_mul_u32_u24 v251, 24, v249
  v_sub_u32 v250, v248, v251
  v_bfe_u32 v251, v249, 1, 1
  v_lshlrev_b32 v251, 2, v251
  v_xor_b32 v250, v250, v251
  v_lshlrev_b32 v250, 4, v250
  v_mul_u32_u24 v251, 9216, v249
  v_add_u32 v242, v250, v251
  v_and_b32 v251, 3, v249
  v_bfe_u32 v252, v249, 2, 1
  v_lshl_add_u32 v251, v252, 3, v251
  v_mul_u32_u24 v251, 1152, v251
  v_add_u32 v245, v250, v251
  v_add_u32 v248, 64, v240
  v_cvt_f32_u32 v251, v248
  v_add_f32 v251, 0.5, v251
  v_mul_f32 v251, 0.041666666666666664, v251
  v_cvt_u32_f32 v249, v251
  v_mul_u32_u24 v251, 24, v249
  v_sub_u32 v250, v248, v251
  v_bfe_u32 v251, v249, 1, 1
  v_lshlrev_b32 v251, 2, v251
  v_xor_b32 v250, v250, v251
  v_lshlrev_b32 v250, 4, v250
  v_subrev_u32 v250, 1024, v250
  v_mul_u32_u24 v251, 9216, v249
  v_add_u32 v243, v250, v251
  v_and_b32 v251, 3, v249
  v_bfe_u32 v252, v249, 2, 1
  v_lshl_add_u32 v251, v252, 3, v251
  v_mul_u32_u24 v251, 1152, v251
  v_add_u32 v246, v250, v251
  v_add_u32 v248, 128, v240
  v_cvt_f32_u32 v251, v248
  v_add_f32 v251, 0.5, v251
  v_mul_f32 v251, 0.041666666666666664, v251
  v_cvt_u32_f32 v249, v251
  v_mul_u32_u24 v251, 24, v249
  v_sub_u32 v250, v248, v251
  v_bfe_u32 v251, v249, 1, 1
  v_lshlrev_b32 v251, 2, v251
  v_xor_b32 v250, v250, v251
  v_lshlrev_b32 v250, 4, v250
  v_subrev_u32 v250, 2048, v250
  v_mul_u32_u24 v251, 9216, v249
  v_add_u32 v244, v250, v251
  v_and_b32 v251, 3, v249
  v_bfe_u32 v252, v249, 2, 1
  v_lshl_add_u32 v251, v252, 3, v251
  v_mul_u32_u24 v251, 1152, v251
  v_add_u32 v247, v250, v251
  s_mul_i32 s53, s26, 1152
  s_mul_i32 s47, s31, 73728
  s_add_u32 s53, s53, s47
  s_mul_i32 s47, s27, 147456
  s_add_u32 s52, s53, s47
  s_sub_u32 s48, 36, s27
  s_mul_i32 s50, s31, 36864
  s_mov_b32 s51, s50
  s_add_u32 s49, s50, 36864
  s_cmp_ge_u32 s30, 2
  s_cbranch_scc1 L_h_w0
  v_lshlrev_b32 v44, 3, v1
  v_add_u32 v44, 147456, v44
  v_lshrrev_b32 v96, 5, v1
  v_lshlrev_b32 v96, 11, v96
  v_add_u32 v96, 147456, v96
  v_and_b32 v97, 31, v1
  v_lshlrev_b32 v97, 3, v97
  v_add_u32 v45, v96, v97
  v_xor_b32 v46, 0, v45
  v_xor_b32 v47, 32, v45
  v_xor_b32 v48, 64, v45
  v_xor_b32 v49, 96, v45
  v_xor_b32 v50, 128, v45
  v_xor_b32 v51, 160, v45
  v_xor_b32 v52, 192, v45
  v_xor_b32 v53, 224, v45
  v_bfe_u32 v98, v1, 2, 3
  v_mul_u32_u24 v99, 288, v98
  v_and_b32 v100, 3, v1
  v_lshlrev_b32 v101, 3, v100
  v_add3_u32 v99, v96, v99, v101
  v_xor_b32 v54, 0, v99
  v_xor_b32 v55, 32, v99
  v_xor_b32 v56, 64, v99
  v_xor_b32 v57, 96, v99
  v_xor_b32 v58, 128, v99
  v_xor_b32 v59, 160, v99
  v_xor_b32 v60, 192, v99
  v_xor_b32 v61, 224, v99
  v_lshlrev_b32 v99, 8, v98
  v_add_u32 v99, v96, v99
  v_lshlrev_b32 v98, 5, v98
  v_lshlrev_b32 v101, 6, v100
  v_xor_b32 v98, v98, v101
  v_add_u32 v99, v99, v98
  v_add_u32 v101, 0, v100
  v_and_b32 v101, 3, v101
  v_lshl_add_u32 v62, v101, 3, v99
  v_xor_b32 v66, 32, v62
  v_add_u32 v101, 1, v100
  v_and_b32 v101, 3, v101
  v_lshl_add_u32 v63, v101, 3, v99
  v_xor_b32 v67, 32, v63
  v_add_u32 v101, 2, v100
  v_and_b32 v101, 3, v101
  v_lshl_add_u32 v64, v101, 3, v99
  v_xor_b32 v68, 32, v64
  v_add_u32 v101, 3, v100
  v_and_b32 v101, 3, v101
  v_lshl_add_u32 v65, v101, 3, v99
  v_xor_b32 v69, 32, v65
  v_and_b32 v96, 255, v1
  v_cvt_f32_u32 v96, v96
  v_mul_f32 v97, 0.00048828125, v96
  v_cos_f32 v2, v97
  v_sin_f32 v3, v97
  v_mul_f32 v97, 0.0009765625, v96
  v_cos_f32 v4, v97
  v_sin_f32 v5, v97
  v_mul_f32 v97, 0.00146484375, v96
  v_cos_f32 v6, v97
  v_sin_f32 v7, v97
  v_mul_f32 v97, 0.001953125, v96
  v_cos_f32 v8, v97
  v_sin_f32 v9, v97
  v_mul_f32 v97, 0.00244140625, v96
  v_cos_f32 v10, v97
  v_sin_f32 v11, v97
  v_mul_f32 v97, 0.0029296875, v96
  v_cos_f32 v12, v97
  v_sin_f32 v13, v97
  v_mul_f32 v97, 0.00341796875, v96
  v_cos_f32 v14, v97
  v_sin_f32 v15, v97
  v_and_b32 v96, 31, v1
  v_cvt_f32_u32 v96, v96
  v_mul_f32 v97, 0.00390625, v96
  v_cos_f32 v16, v97
  v_sin_f32 v17, v97
  v_mul_f32 v97, 0.0078125, v96
  v_cos_f32 v18, v97
  v_sin_f32 v19, v97
  v_mul_f32 v97, 0.01171875, v96
  v_cos_f32 v20, v97
  v_sin_f32 v21, v97
  v_mul_f32 v97, 0.015625, v96
  v_cos_f32 v22, v97
  v_sin_f32 v23, v97
  v_mul_f32 v97, 0.01953125, v96
  v_cos_f32 v24, v97
  v_sin_f32 v25, v97
  v_mul_f32 v97, 0.0234375, v96
  v_cos_f32 v26, v97
  v_sin_f32 v27, v97
  v_mul_f32 v97, 0.02734375, v96
  v_cos_f32 v28, v97
  v_sin_f32 v29, v97
  v_and_b32 v96, 3, v1
  v_cvt_f32_u32 v96, v96
  v_mul_f32 v97, 0.03125, v96
  v_cos_f32 v30, v97
  v_sin_f32 v31, v97
  v_mul_f32 v97, 0.0625, v96
  v_cos_f32 v32, v97
  v_sin_f32 v33, v97
  v_mul_f32 v97, 0.09375, v96
  v_cos_f32 v34, v97
  v_sin_f32 v35, v97
  v_mul_f32 v97, 0.125, v96
  v_cos_f32 v36, v97
  v_sin_f32 v37, v97
  v_mul_f32 v97, 0.15625, v96
  v_cos_f32 v38, v97
  v_sin_f32 v39, v97
  v_mul_f32 v97, 0.1875, v96
  v_cos_f32 v40, v97
  v_sin_f32 v41, v97
  v_mul_f32 v97, 0.21875, v96
  v_cos_f32 v42, v97
  v_sin_f32 v43, v97
  v_lshlrev_b32 v70, 3, v1
  v_lshrrev_b32 v96, 4, v1
  v_mul_u32_u24 v96, 18496, v96
  v_and_b32 v97, 15, v1
  v_lshl_add_u32 v71, v97, 2, v96
  s_cmp_ge_u32 s26, 5
  s_cbranch_scc1 L_nowt
  s_getpc_b64 s[44:45]
  s_add_u32 s44, s44, tw_tab@rel32@lo+4
  s_addc_u32 s45, s45, tw_tab@rel32@hi+12
  s_mov_b32 s46, 184320
  s_mov_b32 s47, 0x00020000
  s_mul_i32 s40, s26, 36864
  s_mul_i32 s41, s31, 18432
  s_add_u32 s40, s40, s41
  s_mul_i32 s41, s31, 36864
  s_add_u32 s41, s41, 18432
  v_lshlrev_b32 v248, 4, v240
  s_mov_b32 m0, s41
  s_add_u32 s41, s41, 3072
  buffer_load_dwordx4 v248, s[44:47], s40 offen offset:0 lds
  buffer_load_dwordx4 v248, s[44:47], s40 offen offset:1024 lds
  buffer_load_dwordx4 v248, s[44:47], s40 offen offset:2048 lds
  s_add_u32 s40, s40, 3072
  s_mov_b32 m0, s41
  s_add_u32 s41, s41, 3072
  buffer_load_dwordx4 v248, s[44:47], s40 offen offset:0 lds
  buffer_load_dwordx4 v248, s[44:47], s40 offen offset:1024 lds
  buffer_load_dwordx4 v248, s[44:47], s40 offen offset:2048 lds
  s_add_u32 s40, s40, 3072
  s_mov_b32 m0, s41
  s_add_u32 s41, s41, 3072
  buffer_load_dwordx4 v248, s[44:47], s40 offen offset:0 lds
  buffer_load_dwordx4 v248, s[44:47], s40 offen offset:1024 lds
  buffer_load_dwordx4 v248, s[44:47], s40 offen offset:2048 lds
  s_add_u32 s40, s40, 3072
  s_mov_b32 m0, s41
  s_add_u32 s41, s41, 3072
  buffer_load_dwordx4 v248, s[44:47], s40 offen offset:0 lds
  buffer_load_dwordx4 v248, s[44:47], s40 offen offset:1024 lds
  buffer_load_dwordx4 v248, s[44:47], s40 offen offset:2048 lds
  s_add_u32 s40, s40, 3072
  s_mov_b32 m0, s41
  s_add_u32 s41, s41, 3072
  buffer_load_dwordx4 v248, s[44:47], s40 offen offset:0 lds
  buffer_load_dwordx4 v248, s[44:47], s40 offen offset:1024 lds
  buffer_load_dwordx4 v248, s[44:47], s40 offen offset:2048 lds
  s_add_u32 s40, s40, 3072
  s_mov_b32 m0, s41
  s_add_u32 s41, s41, 3072
  buffer_load_dwordx4 v248, s[44:47], s40 offen offset:0 lds
  buffer_load_dwordx4 v248, s[44:47], s40 offen offset:1024 lds
  buffer_load_dwordx4 v248, s[44:47], s40 offen offset:2048 lds
  s_add_u32 s40, s40, 3072
L_nowt:
  s_call_b64 s[62:63], L_ld1
  s_call_b64 s[62:63], L_ld1
  s_cmp_lt_u32 s26, 5
  s_cbranch_scc1 L_spf
  s_call_b64 s[62:63], L_ld1
  s_branch L_spf1
L_spf:
  v_mov_b32 v232, v240
  v_cvt_f32_u32 v235, v232
  v_add_f32 v235, 0.5, v235
  v_mul_f32 v235, 0.1111111111111111, v235
  v_cvt_u32_f32 v233, v235
  v_mul_u32_u24 v235, 9, v233
  v_sub_u32 v234, v232, v235
  v_and_b32 v235, 7, v233
  v_lshrrev_b32 v233, 3, v233
  v_lshl_add_u32 v233, v233, 4, v235
  v_mul_u32_u24 v233, 9216, v233
  v_lshl_add_u32 v233, v234, 7, v233
  buffer_load_dword v131, v233, s[8:11], s52 offen
  v_add_u32 v232, 64, v232
  v_cvt_f32_u32 v235, v232
  v_add_f32 v235, 0.5, v235
  v_mul_f32 v235, 0.1111111111111111, v235
  v_cvt_u32_f32 v233, v235
  v_mul_u32_u24 v235, 9, v233
  v_sub_u32 v234, v232, v235
  v_and_b32 v235, 7, v233
  v_lshrrev_b32 v233, 3, v233
  v_lshl_add_u32 v233, v233, 4, v235
  v_mul_u32_u24 v233, 9216, v233
  v_lshl_add_u32 v233, v234, 7, v233
  buffer_load_dword v131, v233, s[8:11], s52 offen
  v_add_u32 v232, 64, v232
  v_cvt_f32_u32 v235, v232
  v_add_f32 v235, 0.5, v235
  v_mul_f32 v235, 0.1111111111111111, v235
  v_cvt_u32_f32 v233, v235
  v_mul_u32_u24 v235, 9, v233
  v_sub_u32 v234, v232, v235
  v_and_b32 v235, 7, v233
  v_lshrrev_b32 v233, 3, v233
  v_lshl_add_u32 v233, v233, 4, v235
  v_mul_u32_u24 v233, 9216, v233
  v_lshl_add_u32 v233, v234, 7, v233
  buffer_load_dword v131, v233, s[8:11], s52 offen
  v_add_u32 v232, 64, v232
  s_branch L_spf2
L_spf1:
  v_mov_b32 v232, v240
  v_cvt_f32_u32 v235, v232
  v_add_f32 v235, 0.5, v235
  v_mul_f32 v235, 0.1111111111111111, v235
  v_cvt_u32_f32 v233, v235
  v_mul_u32_u24 v235, 9, v233
  v_sub_u32 v234, v232, v235
  v_and_b32 v235, 7, v233
  v_lshrrev_b32 v233, 3, v233
  v_lshl_add_u32 v233, v233, 4, v235
  v_mul_u32_u24 v233, 9216, v233
  v_lshl_add_u32 v233, v234, 7, v233
  buffer_load_dword v131, v233, s[8:11], s52 offen
  v_add_u32 v232, 64, v232
  v_cvt_f32_u32 v235, v232
  v_add_f32 v235, 0.5, v235
  v_mul_f32 v235, 0.1111111111111111, v235
  v_cvt_u32_f32 v233, v235
  v_mul_u32_u24 v235, 9, v233
  v_sub_u32 v234, v232, v235
  v_and_b32 v235, 7, v233
  v_lshrrev_b32 v233, 3, v233
  v_lshl_add_u32 v233, v233, 4, v235
  v_mul_u32_u24 v233, 9216, v233
  v_lshl_add_u32 v233, v234, 7, v233
  buffer_load_dword v131, v233, s[8:11], s52 offen
  v_add_u32 v232, 64, v232
L_spf2:
  s_cmp_ge_u32 s26, 5
  s_cbranch_scc1 L_h_c0
  s_waitcnt vmcnt(21)
  s_branch L_h_c0
L_h_w0:
L_h_c0:
  s_waitcnt lgkmcnt(0)
  s_barrier
  s_mov_b32 s43, s2
  s_cmp_ge_i32 s28, 0
  s_cbranch_scc1 L_h_c3
L_wt:
  s_lshr_b32 s40, s43, 5
  s_bfe_u32 s41, s43, 0x30002
  s_lshl_b32 s41, s41, 3
  s_add_u32 s40, s40, s41
  s_and_b32 s41, s43, 3
  s_lshl_b32 s41, s41, 7
  s_add_u32 s40, s40, s41
  s_mul_i32 s40, s40, 578
  v_lshrrev_b32 v241, 5, v240
  v_mul_u32_u24 v241, 36992, v241
  v_and_b32 v248, 31, v240
  v_lshl_add_u32 v241, v248, 1, v241
  s_add_u32 s41, s30, 0
  s_min_u32 s41, s41, 9
  s_lshl_b32 s41, s41, 6
  s_add_u32 s41, s41, s40
  buffer_load_ushort v140, v241, s[32:35], s41 offen
  buffer_load_ushort v144, v241, s[36:39], s41 offen
  s_add_u32 s41, s41, 295936
  buffer_load_ushort v141, v241, s[32:35], s41 offen
  buffer_load_ushort v145, v241, s[36:39], s41 offen
  s_add_u32 s41, s41, 295936
  buffer_load_ushort v142, v241, s[32:35], s41 offen
  buffer_load_ushort v146, v241, s[36:39], s41 offen
  s_add_u32 s41, s41, 295936
  buffer_load_ushort v143, v241, s[32:35], s41 offen
  buffer_load_ushort v147, v241, s[36:39], s41 offen
  s_add_u32 s41, s41, 295936
  s_add_u32 s41, s30, 4
  s_min_u32 s41, s41, 9
  s_lshl_b32 s41, s41, 6
  s_add_u32 s41, s41, s40
  buffer_load_ushort v148, v241, s[32:35], s41 offen
  buffer_load_ushort v152, v241, s[36:39], s41 offen
  s_add_u32 s41, s41, 295936
  buffer_load_ushort v149, v241, s[32:35], s41 offen
  buffer_load_ushort v153, v241, s[36:39], s41 offen
  s_add_u32 s41, s41, 295936
  buffer_load_ushort v150, v241, s[32:35], s41 offen
  buffer_load_ushort v154, v241, s[36:39], s41 offen
  s_add_u32 s41, s41, 295936
  buffer_load_ushort v151, v241, s[32:35], s41 offen
  buffer_load_ushort v155, v241, s[36:39], s41 offen
  s_add_u32 s41, s41, 295936
  s_add_u32 s41, s30, 8
  s_min_u32 s41, s41, 9
  s_lshl_b32 s41, s41, 6
  s_add_u32 s41, s41, s40
  buffer_load_ushort v156, v241, s[32:35], s41 offen
  buffer_load_ushort v160, v241, s[36:39], s41 offen
  s_add_u32 s41, s41, 295936
  buffer_load_ushort v157, v241, s[32:35], s41 offen
  buffer_load_ushort v161, v241, s[36:39], s41 offen
  s_add_u32 s41, s41, 295936
  buffer_load_ushort v158, v241, s[32:35], s41 offen
  buffer_load_ushort v162, v241, s[36:39], s41 offen
  s_add_u32 s41, s41, 295936
  buffer_load_ushort v159, v241, s[32:35], s41 offen
  buffer_load_ushort v163, v241, s[36:39], s41 offen
  s_add_u32 s41, s41, 295936
  s_cmp_ge_u32 s26, 5
  s_cbranch_scc1 L_h_np0
  s_barrier
L_h_np0:
  s_mul_i32 s40, s43, 10240
  s_add_u32 s40, s40, 45088768
  v_lshrrev_b32 v241, 5, v240
  v_lshlrev_b32 v241, 4, v241
  v_and_b32 v248, 31, v240
  v_lshl_add_u32 v241, v248, 5, v241
  s_waitcnt vmcnt(0)
  v_lshl_or_b32 v140, v144, 16, v140
  v_lshl_or_b32 v141, v145, 16, v141
  v_lshl_or_b32 v142, v146, 16, v142
  v_lshl_or_b32 v143, v147, 16, v143
  s_add_u32 s41, s30, 0
  s_min_u32 s41, s41, 9
  s_lshl_b32 s41, s41, 10
  s_add_u32 s41, s41, s40
  buffer_store_dwordx4 v[140:143], v241, s[16:19], s41 offen sc0 sc1
  v_lshl_or_b32 v148, v152, 16, v148
  v_lshl_or_b32 v149, v153, 16, v149
  v_lshl_or_b32 v150, v154, 16, v150
  v_lshl_or_b32 v151, v155, 16, v151
  s_add_u32 s41, s30, 4
  s_min_u32 s41, s41, 9
  s_lshl_b32 s41, s41, 10
  s_add_u32 s41, s41, s40
  buffer_store_dwordx4 v[148:151], v241, s[16:19], s41 offen sc0 sc1
  v_lshl_or_b32 v156, v160, 16, v156
  v_lshl_or_b32 v157, v161, 16, v157
  v_lshl_or_b32 v158, v162, 16, v158
  v_lshl_or_b32 v159, v163, 16, v159
  s_add_u32 s41, s30, 8
  s_min_u32 s41, s41, 9
  s_lshl_b32 s41, s41, 10
  s_add_u32 s41, s41, s40
  buffer_store_dwordx4 v[156:159], v241, s[16:19], s41 offen sc0 sc1
  s_cmp_lg_u32 s43, s2
  s_cbranch_scc1 L_h_c3
  s_mul_i32 s42, s25, 3
  s_add_u32 s42, s42, s26
  s_sub_u32 s42, s42, 45
  s_cmp_lt_u32 s26, 5
  s_cselect_b32 s42, 99, s42
  s_cmp_lt_u32 s42, 40
  s_cbranch_scc0 L_h_c3
  s_mul_i32 s43, s42, 43
  s_lshr_b32 s43, s43, 7
  s_mul_i32 s44, s43, 3
  s_sub_u32 s44, s42, s44
  s_add_u32 s44, s44, 5
  s_lshl_b32 s43, s43, 4
  s_and_b32 s45, s44, 1
  s_lshl_b32 s45, s45, 3
  s_add_u32 s43, s43, s45
  s_and_b32 s44, s44, 6
  s_add_u32 s43, s43, s44
  s_nop 1
  s_branch L_wt
L_h_c3:
  s_cmp_ge_u32 s26, 5
  s_cbranch_scc1 L_h_c4
  s_cmp_ge_u32 s30, 2
  s_cbranch_scc1 L_h_c4
  s_call_b64 s[62:63], L_ld1
L_h_c4:
  s_cmp_lt_u32 s30, 2
  s_cbranch_scc1 L_h_c5
  s_sub_u32 s31, s24, 6
L_h_c5:
  s_cmp_lt_i32 s28, 0
  s_cbranch_scc1 L_b0
  s_waitcnt vmcnt(9)
L_b0:
  s_barrier
  s_cmp_ge_u32 s30, 2
  s_cbranch_scc1 L_npr
  s_setprio 3
L_npr:
  s_cmp_ge_u32 s30, 2
  s_cbranch_scc1 L_wk1
  s_mov_b32 s45, 32
L_hg1:
  s_mov_b32 m0, s51
  s_add_u32 s51, s51, 3072
  buffer_load_dwordx4 v242, s[8:11], s52 offen offset:0 lds
  buffer_load_dwordx4 v243, s[8:11], s52 offen offset:1024 lds
  buffer_load_dwordx4 v244, s[8:11], s52 offen offset:2048 lds
  s_add_u32 s52, s52, 384
  s_mov_b32 m0, s51
  s_add_u32 s51, s51, 3072
  buffer_load_dwordx4 v242, s[8:11], s52 offen offset:0 lds
  buffer_load_dwordx4 v243, s[8:11], s52 offen offset:1024 lds
  buffer_load_dwordx4 v244, s[8:11], s52 offen offset:2048 lds
  s_add_u32 s52, s52, 384
  s_mov_b32 m0, s51
  s_add_u32 s51, s51, 3072
  buffer_load_dwordx4 v242, s[8:11], s52 offen offset:0 lds
  buffer_load_dwordx4 v243, s[8:11], s52 offen offset:1024 lds
  buffer_load_dwordx4 v244, s[8:11], s52 offen offset:2048 lds
  s_add_u32 s52, s52, 146688
  s_sub_u32 s48, s48, 1
  s_cmp_eq_u32 s48, 0
  s_cselect_b32 s52, s53, s52
  s_cmp_eq_u32 s51, s49
  s_cselect_b32 s51, s50, s51
  s_waitcnt vmcnt(9)
  s_barrier
  s_sub_u32 s45, s45, 1
  s_cmp_lg_u32 s45, 0
  s_cbranch_scc1 L_hg1
  s_branch L_j32
L_wk1:
  s_and_b32 s56, s26, 1
  s_mul_i32 s56, s56, 72
  v_and_b32 v102, 15, v240
  v_add_u32 v102, s56, v102
  v_cvt_f32_u32 v102, v102
  v_lshrrev_b32 v103, 5, v240
  v_lshlrev_b32 v103, 4, v103
  v_add_u32 v103, s31, v103
  v_cvt_f32_u32 v103, v103
  v_bfe_u32 v104, v240, 4, 1
  v_cvt_f32_u32 v104, v104
  v_mul_f32 v104, 0.25, v104
  v_add_f32 v105, 0.0, v102
  v_mul_f32 v105, 0.001736111111111111, v105
  v_fma_f32 v106, v105, v103, v104
  v_mul_f32 v108, 32.0, v105
  v_cos_f32 v108, v108
  v_fmamk_f32 v110, v105, 0, v106
  v_fmamk_f32 v118, v105, 3254779904, v106
  v_fmamk_f32 v111, v105, 1073741824, v106
  v_fmamk_f32 v119, v105, 3253731328, v106
  v_fmamk_f32 v112, v105, 1082130432, v106
  v_fmamk_f32 v120, v105, 3252682752, v106
  v_fmamk_f32 v113, v105, 1086324736, v106
  v_fmamk_f32 v121, v105, 3251634176, v106
  v_fmamk_f32 v114, v105, 1090519040, v106
  v_fmamk_f32 v122, v105, 3250585600, v106
  v_fmamk_f32 v115, v105, 1092616192, v106
  v_fmamk_f32 v123, v105, 3249537024, v106
  v_fmamk_f32 v116, v105, 1094713344, v106
  v_fmamk_f32 v124, v105, 3248488448, v106
  s_barrier
  v_fmamk_f32 v117, v105, 1096810496, v106
  v_fmamk_f32 v125, v105, 3247439872, v106
  v_add_f32 v108, v108, v108
  v_cos_f32 v110, v110
  v_cos_f32 v111, v111
  v_cos_f32 v112, v112
  v_cos_f32 v113, v113
  v_cos_f32 v114, v114
  v_cos_f32 v115, v115
  v_cos_f32 v116, v116
  v_cos_f32 v117, v117
  v_cos_f32 v118, v118
  v_cos_f32 v119, v119
  v_cos_f32 v120, v120
  v_cos_f32 v121, v121
  v_cos_f32 v122, v122
  v_cos_f32 v123, v123
  v_cos_f32 v124, v124
  s_barrier
  v_cos_f32 v125, v125
  v_cmp_eq_f32 vcc, 0, v103
  v_mul_f32 v107, 0.5, v110
  s_nop 0
  v_cndmask_b32 v107, v110, v107, vcc
  v_cvt_pk_bf16_f32 v132, v107, v111
  v_cvt_pk_bf16_f32 v133, v112, v113
  v_cvt_pk_bf16_f32 v134, v114, v115
  v_cvt_pk_bf16_f32 v135, v116, v117
  v_fma_f32 v118, v108, v110, -v118
  v_fma_f32 v119, v108, v111, -v119
  v_fma_f32 v120, v108, v112, -v120
  v_fma_f32 v121, v108, v113, -v121
  v_fma_f32 v122, v108, v114, -v122
  v_fma_f32 v123, v108, v115, -v123
  v_fma_f32 v124, v108, v116, -v124
  v_fma_f32 v125, v108, v117, -v125
  v_cvt_pk_bf16_f32 v136, v118, v119
  v_cvt_pk_bf16_f32 v137, v120, v121
  v_cvt_pk_bf16_f32 v138, v122, v123
  v_cvt_pk_bf16_f32 v139, v124, v125
  v_fma_f32 v110, v108, v118, -v110
  v_fma_f32 v111, v108, v119, -v111
  v_fma_f32 v112, v108, v120, -v112
  v_fma_f32 v113, v108, v121, -v113
  v_fma_f32 v114, v108, v122, -v114
  v_fma_f32 v115, v108, v123, -v115
  v_fma_f32 v116, v108, v124, -v116
  v_fma_f32 v117, v108, v125, -v117
  v_cvt_pk_bf16_f32 v140, v110, v111
  v_cvt_pk_bf16_f32 v141, v112, v113
  s_barrier
  v_cvt_pk_bf16_f32 v142, v114, v115
  v_cvt_pk_bf16_f32 v143, v116, v117
  v_fma_f32 v118, v108, v110, -v118
  v_fma_f32 v119, v108, v111, -v119
  v_fma_f32 v120, v108, v112, -v120
  v_fma_f32 v121, v108, v113, -v121
  v_fma_f32 v122, v108, v114, -v122
  v_fma_f32 v123, v108, v115, -v123
  v_fma_f32 v124, v108, v116, -v124
  v_fma_f32 v125, v108, v117, -v125
  v_cvt_pk_bf16_f32 v144, v118, v119
  v_cvt_pk_bf16_f32 v145, v120, v121
  v_cvt_pk_bf16_f32 v146, v122, v123
  v_cvt_pk_bf16_f32 v147, v124, v125
  v_fma_f32 v110, v108, v118, -v110
  v_fma_f32 v111, v108, v119, -v111
  v_fma_f32 v112, v108, v120, -v112
  v_fma_f32 v113, v108, v121, -v113
  v_fma_f32 v114, v108, v122, -v114
  v_fma_f32 v115, v108, v123, -v115
  v_fma_f32 v116, v108, v124, -v116
  v_fma_f32 v117, v108, v125, -v117
  v_cvt_pk_bf16_f32 v148, v110, v111
  v_cvt_pk_bf16_f32 v149, v112, v113
  v_cvt_pk_bf16_f32 v150, v114, v115
  v_cvt_pk_bf16_f32 v151, v116, v117
  v_fma_f32 v118, v108, v110, -v118
  v_fma_f32 v119, v108, v111, -v119
  v_fma_f32 v120, v108, v112, -v120
  v_fma_f32 v121, v108, v113, -v121
  v_fma_f32 v122, v108, v114, -v122
  v_fma_f32 v123, v108, v115, -v123
  s_barrier
  v_fma_f32 v124, v108, v116, -v124
  v_fma_f32 v125, v108, v117, -v125
  v_cvt_pk_bf16_f32 v152, v118, v119
  v_cvt_pk_bf16_f32 v153, v120, v121
  v_cvt_pk_bf16_f32 v154, v122, v123
  v_cvt_pk_bf16_f32 v155, v124, v125
  v_fma_f32 v110, v108, v118, -v110
  v_fma_f32 v111, v108, v119, -v111
  v_fma_f32 v112, v108, v120, -v112
  v_fma_f32 v113, v108, v121, -v113
  v_fma_f32 v114, v108, v122, -v114
  v_fma_f32 v115, v108, v123, -v115
  v_fma_f32 v116, v108, v124, -v116
  v_fma_f32 v117, v108, v125, -v117
  v_cvt_pk_bf16_f32 v156, v110, v111
  v_cvt_pk_bf16_f32 v157, v112, v113
  v_cvt_pk_bf16_f32 v158, v114, v115
  v_cvt_pk_bf16_f32 v159, v116, v117
  v_fma_f32 v118, v108, v110, -v118
  v_fma_f32 v119, v108, v111, -v119
  v_fma_f32 v120, v108, v112, -v120
  v_fma_f32 v121, v108, v113, -v121
  v_fma_f32 v122, v108, v114, -v122
  v_fma_f32 v123, v108, v115, -v123
  v_fma_f32 v124, v108, v116, -v124
  v_fma_f32 v125, v108, v117, -v125
  v_cvt_pk_bf16_f32 v160, v118, v119
  v_cvt_pk_bf16_f32 v161, v120, v121
  v_cvt_pk_bf16_f32 v162, v122, v123
  v_cvt_pk_bf16_f32 v163, v124, v125
  v_fma_f32 v110, v108, v118, -v110
  v_fma_f32 v111, v108, v119, -v111
  s_barrier
  v_fma_f32 v112, v108, v120, -v112
  v_fma_f32 v113, v108, v121, -v113
  v_fma_f32 v114, v108, v122, -v114
  v_fma_f32 v115, v108, v123, -v115
  v_fma_f32 v116, v108, v124, -v116
  v_fma_f32 v117, v108, v125, -v117
  v_cvt_pk_bf16_f32 v164, v110, v111
  v_cvt_pk_bf16_f32 v165, v112, v113
  v_cvt_pk_bf16_f32 v166, v114, v115
  v_cvt_pk_bf16_f32 v167, v116, v117
  s_waitcnt vmcnt(0)
  s_barrier
  s_barrier
  s_cmp_lg_u32 s30, 2
  s_cbranch_scc1 L_nb1
  s_lshl_b32 s55, s2, 2
  s_add_u32 s55, s55, 458752
  v_mov_b32 v254, 0
  v_mov_b32 v255, s29
  s_mov_b64 exec, 1
  buffer_store_dword v255, v254, s[16:19], s55 offen sc0 sc1
  s_mov_b64 exec, -1
L_nb1:
  s_and_b32 s56, s26, 1
  s_mul_i32 s56, s56, 72
  v_and_b32 v102, 15, v240
  v_add_u32 v102, s56, v102
  v_cvt_f32_u32 v102, v102
  v_lshrrev_b32 v103, 5, v240
  v_lshlrev_b32 v103, 4, v103
  v_add_u32 v103, s31, v103
  v_cvt_f32_u32 v103, v103
  v_bfe_u32 v104, v240, 4, 1
  v_cvt_f32_u32 v104, v104
  v_mul_f32 v104, 0.25, v104
  v_add_f32 v105, 16.0, v102
  v_mul_f32 v105, 0.001736111111111111, v105
  v_fma_f32 v106, v105, v103, v104
  v_mul_f32 v108, 32.0, v105
  v_cos_f32 v108, v108
  v_fmamk_f32 v110, v105, 0, v106
  v_fmamk_f32 v118, v105, 3254779904, v106
  v_fmamk_f32 v111, v105, 1073741824, v106
  v_fmamk_f32 v119, v105, 3253731328, v106
  s_barrier
  v_fmamk_f32 v112, v105, 1082130432, v106
  v_fmamk_f32 v120, v105, 3252682752, v106
  v_fmamk_f32 v113, v105, 1086324736, v106
  v_fmamk_f32 v121, v105, 3251634176, v106
  v_fmamk_f32 v114, v105, 1090519040, v106
  v_fmamk_f32 v122, v105, 3250585600, v106
  v_fmamk_f32 v115, v105, 1092616192, v106
  v_fmamk_f32 v123, v105, 3249537024, v106
  v_fmamk_f32 v116, v105, 1094713344, v106
  v_fmamk_f32 v124, v105, 3248488448, v106
  v_fmamk_f32 v117, v105, 1096810496, v106
  v_fmamk_f32 v125, v105, 3247439872, v106
  v_add_f32 v108, v108, v108
  v_cos_f32 v110, v110
  v_cos_f32 v111, v111
  v_cos_f32 v112, v112
  v_cos_f32 v113, v113
  v_cos_f32 v114, v114
  v_cos_f32 v115, v115
  v_cos_f32 v116, v116
  v_cos_f32 v117, v117
  v_cos_f32 v118, v118
  v_cos_f32 v119, v119
  s_barrier
  v_cos_f32 v120, v120
  v_cos_f32 v121, v121
  v_cos_f32 v122, v122
  v_cos_f32 v123, v123
  v_cos_f32 v124, v124
  v_cos_f32 v125, v125
  v_cmp_eq_f32 vcc, 0, v103
  v_mul_f32 v107, 0.5, v110
  s_nop 0
  v_cndmask_b32 v107, v110, v107, vcc
  v_cvt_pk_bf16_f32 v168, v107, v111
  v_cvt_pk_bf16_f32 v169, v112, v113
  v_cvt_pk_bf16_f32 v170, v114, v115
  v_cvt_pk_bf16_f32 v171, v116, v117
  v_fma_f32 v118, v108, v110, -v118
  v_fma_f32 v119, v108, v111, -v119
  v_fma_f32 v120, v108, v112, -v120
  v_fma_f32 v121, v108, v113, -v121
  v_fma_f32 v122, v108, v114, -v122
  v_fma_f32 v123, v108, v115, -v123
  v_fma_f32 v124, v108, v116, -v124
  v_fma_f32 v125, v108, v117, -v125
  v_cvt_pk_bf16_f32 v172, v118, v119
  v_cvt_pk_bf16_f32 v173, v120, v121
  v_cvt_pk_bf16_f32 v174, v122, v123
  v_cvt_pk_bf16_f32 v175, v124, v125
  s_barrier
  v_fma_f32 v110, v108, v118, -v110
  v_fma_f32 v111, v108, v119, -v111
  v_fma_f32 v112, v108, v120, -v112
  v_fma_f32 v113, v108, v121, -v113
  v_fma_f32 v114, v108, v122, -v114
  v_fma_f32 v115, v108, v123, -v115
  v_fma_f32 v116, v108, v124, -v116
  v_fma_f32 v117, v108, v125, -v117
  v_cvt_pk_bf16_f32 v176, v110, v111
  v_cvt_pk_bf16_f32 v177, v112, v113
  v_cvt_pk_bf16_f32 v178, v114, v115
  v_cvt_pk_bf16_f32 v179, v116, v117
  v_fma_f32 v118, v108, v110, -v118
  v_fma_f32 v119, v108, v111, -v119
  v_fma_f32 v120, v108, v112, -v120
  v_fma_f32 v121, v108, v113, -v121
  v_fma_f32 v122, v108, v114, -v122
  v_fma_f32 v123, v108, v115, -v123
  v_fma_f32 v124, v108, v116, -v124
  v_fma_f32 v125, v108, v117, -v125
  v_cvt_pk_bf16_f32 v180, v118, v119
  v_cvt_pk_bf16_f32 v181, v120, v121
  v_cvt_pk_bf16_f32 v182, v122, v123
  v_cvt_pk_bf16_f32 v183, v124, v125
  v_fma_f32 v110, v108, v118, -v110
  v_fma_f32 v111, v108, v119, -v111
  v_fma_f32 v112, v108, v120, -v112
  v_fma_f32 v113, v108, v121, -v113
  v_fma_f32 v114, v108, v122, -v114
  v_fma_f32 v115, v108, v123, -v115
  v_fma_f32 v116, v108, v124, -v116
  v_fma_f32 v117, v108, v125, -v117
  s_barrier
  v_cvt_pk_bf16_f32 v184, v110, v111
  v_cvt_pk_bf16_f32 v185, v112, v113
  v_cvt_pk_bf16_f32 v186, v114, v115
  v_cvt_pk_bf16_f32 v187, v116, v117
  v_fma_f32 v118, v108, v110, -v118
  v_fma_f32 v119, v108, v111, -v119
  v_fma_f32 v120, v108, v112, -v120
  v_fma_f32 v121, v108, v113, -v121
  v_fma_f32 v122, v108, v114, -v122
  v_fma_f32 v123, v108, v115, -v123
  v_fma_f32 v124, v108, v116, -v124
  v_fma_f32 v125, v108, v117, -v125
  v_cvt_pk_bf16_f32 v188, v118, v119
  v_cvt_pk_bf16_f32 v189, v120, v121
  v_cvt_pk_bf16_f32 v190, v122, v123
  v_cvt_pk_bf16_f32 v191, v124, v125
  v_fma_f32 v110, v108, v118, -v110
  v_fma_f32 v111, v108, v119, -v111
  v_fma_f32 v112, v108, v120, -v112
  v_fma_f32 v113, v108, v121, -v113
  v_fma_f32 v114, v108, v122, -v114
  v_fma_f32 v115, v108, v123, -v115
  v_fma_f32 v116, v108, v124, -v116
  v_fma_f32 v117, v108, v125, -v117
  v_cvt_pk_bf16_f32 v192, v110, v111
  v_cvt_pk_bf16_f32 v193, v112, v113
  v_cvt_pk_bf16_f32 v194, v114, v115
  v_cvt_pk_bf16_f32 v195, v116, v117
  v_fma_f32 v118, v108, v110, -v118
  v_fma_f32 v119, v108, v111, -v119
  v_fma_f32 v120, v108, v112, -v120
  v_fma_f32 v121, v108, v113, -v121
  s_barrier
  v_fma_f32 v122, v108, v114, -v122
  v_fma_f32 v123, v108, v115, -v123
  v_fma_f32 v124, v108, v116, -v124
  v_fma_f32 v125, v108, v117, -v125
  v_cvt_pk_bf16_f32 v196, v118, v119
  v_cvt_pk_bf16_f32 v197, v120, v121
  v_cvt_pk_bf16_f32 v198, v122, v123
  v_cvt_pk_bf16_f32 v199, v124, v125
  v_fma_f32 v110, v108, v118, -v110
  v_fma_f32 v111, v108, v119, -v111
  v_fma_f32 v112, v108, v120, -v112
  v_fma_f32 v113, v108, v121, -v113
  v_fma_f32 v114, v108, v122, -v114
  v_fma_f32 v115, v108, v123, -v115
  v_fma_f32 v116, v108, v124, -v116
  v_fma_f32 v117, v108, v125, -v117
  v_cvt_pk_bf16_f32 v200, v110, v111
  v_cvt_pk_bf16_f32 v201, v112, v113
  v_cvt_pk_bf16_f32 v202, v114, v115
  v_cvt_pk_bf16_f32 v203, v116, v117
  v_add_f32 v105, 32.0, v102
  v_mul_f32 v105, 0.001736111111111111, v105
  v_fma_f32 v106, v105, v103, v104
  v_mul_f32 v108, 32.0, v105
  v_cos_f32 v108, v108
  v_fmamk_f32 v110, v105, 0, v106
  v_fmamk_f32 v118, v105, 3254779904, v106
  v_fmamk_f32 v111, v105, 1073741824, v106
  v_fmamk_f32 v119, v105, 3253731328, v106
  v_fmamk_f32 v112, v105, 1082130432, v106
  v_fmamk_f32 v120, v105, 3252682752, v106
  s_barrier
  v_fmamk_f32 v113, v105, 1086324736, v106
  v_fmamk_f32 v121, v105, 3251634176, v106
  v_fmamk_f32 v114, v105, 1090519040, v106
  v_fmamk_f32 v122, v105, 3250585600, v106
  v_fmamk_f32 v115, v105, 1092616192, v106
  v_fmamk_f32 v123, v105, 3249537024, v106
  v_fmamk_f32 v116, v105, 1094713344, v106
  v_fmamk_f32 v124, v105, 3248488448, v106
  v_fmamk_f32 v117, v105, 1096810496, v106
  v_fmamk_f32 v125, v105, 3247439872, v106
  v_add_f32 v108, v108, v108
  v_cos_f32 v110, v110
  v_cos_f32 v111, v111
  v_cos_f32 v112, v112
  v_cos_f32 v113, v113
  v_cos_f32 v114, v114
  v_cos_f32 v115, v115
  v_cos_f32 v116, v116
  v_cos_f32 v117, v117
  v_cos_f32 v118, v118
  v_cos_f32 v119, v119
  v_cos_f32 v120, v120
  s_barrier
  v_cos_f32 v121, v121
  v_cos_f32 v122, v122
  v_cos_f32 v123, v123
  v_cos_f32 v124, v124
  v_cos_f32 v125, v125
  v_cmp_eq_f32 vcc, 0, v103
  v_mul_f32 v107, 0.5, v110
  s_nop 0
  v_cndmask_b32 v107, v110, v107, vcc
  v_cvt_pk_bf16_f32 v204, v107, v111
  v_cvt_pk_bf16_f32 v205, v112, v113
  v_cvt_pk_bf16_f32 v206, v114, v115
  v_cvt_pk_bf16_f32 v207, v116, v117
  v_fma_f32 v118, v108, v110, -v118
  v_fma_f32 v119, v108, v111, -v119
  v_fma_f32 v120, v108, v112, -v120
  v_fma_f32 v121, v108, v113, -v121
  v_fma_f32 v122, v108, v114, -v122
  v_fma_f32 v123, v108, v115, -v123
  v_fma_f32 v124, v108, v116, -v124
  v_fma_f32 v125, v108, v117, -v125
  v_cvt_pk_bf16_f32 v208, v118, v119
  v_cvt_pk_bf16_f32 v209, v120, v121
  v_cvt_pk_bf16_f32 v210, v122, v123
  v_cvt_pk_bf16_f32 v211, v124, v125
  v_fma_f32 v110, v108, v118, -v110
  v_fma_f32 v111, v108, v119, -v111
  s_barrier
  v_fma_f32 v112, v108, v120, -v112
  v_fma_f32 v113, v108, v121, -v113
  v_fma_f32 v114, v108, v122, -v114
  v_fma_f32 v115, v108, v123, -v115
  v_fma_f32 v116, v108, v124, -v116
  v_fma_f32 v117, v108, v125, -v117
  v_cvt_pk_bf16_f32 v212, v110, v111
  v_cvt_pk_bf16_f32 v213, v112, v113
  v_cvt_pk_bf16_f32 v214, v114, v115
  v_cvt_pk_bf16_f32 v215, v116, v117
  v_fma_f32 v118, v108, v110, -v118
  v_fma_f32 v119, v108, v111, -v119
  v_fma_f32 v120, v108, v112, -v120
  v_fma_f32 v121, v108, v113, -v121
  v_fma_f32 v122, v108, v114, -v122
  v_fma_f32 v123, v108, v115, -v123
  v_fma_f32 v124, v108, v116, -v124
  v_fma_f32 v125, v108, v117, -v125
  v_cvt_pk_bf16_f32 v216, v118, v119
  v_cvt_pk_bf16_f32 v217, v120, v121
  v_cvt_pk_bf16_f32 v218, v122, v123
  v_cvt_pk_bf16_f32 v219, v124, v125
  v_fma_f32 v110, v108, v118, -v110
  v_fma_f32 v111, v108, v119, -v111
  v_fma_f32 v112, v108, v120, -v112
  v_fma_f32 v113, v108, v121, -v113
  v_fma_f32 v114, v108, v122, -v114
  v_fma_f32 v115, v108, v123, -v115
  v_fma_f32 v116, v108, v124, -v116
  v_fma_f32 v117, v108, v125, -v117
  v_cvt_pk_bf16_f32 v220, v110, v111
  v_cvt_pk_bf16_f32 v221, v112, v113
  s_barrier
  v_cvt_pk_bf16_f32 v222, v114, v115
  v_cvt_pk_bf16_f32 v223, v116, v117
  v_fma_f32 v118, v108, v110, -v118
  v_fma_f32 v119, v108, v111, -v119
  v_fma_f32 v120, v108, v112, -v120
  v_fma_f32 v121, v108, v113, -v121
  v_fma_f32 v122, v108, v114, -v122
  v_fma_f32 v123, v108, v115, -v123
  v_fma_f32 v124, v108, v116, -v124
  v_fma_f32 v125, v108, v117, -v125
  v_cvt_pk_bf16_f32 v224, v118, v119
  v_cvt_pk_bf16_f32 v225, v120, v121
  v_cvt_pk_bf16_f32 v226, v122, v123
  v_cvt_pk_bf16_f32 v227, v124, v125
  v_fma_f32 v110, v108, v118, -v110
  v_fma_f32 v111, v108, v119, -v111
  v_fma_f32 v112, v108, v120, -v112
  v_fma_f32 v113, v108, v121, -v113
  v_fma_f32 v114, v108, v122, -v114
  v_fma_f32 v115, v108, v123, -v115
  v_fma_f32 v116, v108, v124, -v116
  v_fma_f32 v117, v108, v125, -v117
  v_cvt_pk_bf16_f32 v228, v110, v111
  v_cvt_pk_bf16_f32 v229, v112, v113
  v_cvt_pk_bf16_f32 v230, v114, v115
  v_cvt_pk_bf16_f32 v231, v116, v117
  v_fma_f32 v118, v108, v110, -v118
  v_fma_f32 v119, v108, v111, -v119
  v_fma_f32 v120, v108, v112, -v120
  v_fma_f32 v121, v108, v113, -v121
  v_fma_f32 v122, v108, v114, -v122
  v_fma_f32 v123, v108, v115, -v123
  s_barrier
  v_fma_f32 v124, v108, v116, -v124
  v_fma_f32 v125, v108, v117, -v125
  v_cvt_pk_bf16_f32 v232, v118, v119
  v_cvt_pk_bf16_f32 v233, v120, v121
  v_cvt_pk_bf16_f32 v234, v122, v123
  v_cvt_pk_bf16_f32 v235, v124, v125
  v_fma_f32 v110, v108, v118, -v110
  v_fma_f32 v111, v108, v119, -v111
  v_fma_f32 v112, v108, v120, -v112
  v_fma_f32 v113, v108, v121, -v113
  v_fma_f32 v114, v108, v122, -v114
  v_fma_f32 v115, v108, v123, -v115
  v_fma_f32 v116, v108, v124, -v116
  v_fma_f32 v117, v108, v125, -v117
  v_cvt_pk_bf16_f32 v236, v110, v111
  v_cvt_pk_bf16_f32 v237, v112, v113
  v_cvt_pk_bf16_f32 v238, v114, v115
  v_cvt_pk_bf16_f32 v239, v116, v117
  v_lshlrev_b32 v44, 3, v1
  v_add_u32 v44, 147456, v44
  v_lshrrev_b32 v96, 5, v1
  v_lshlrev_b32 v96, 11, v96
  v_add_u32 v96, 147456, v96
  v_and_b32 v97, 31, v1
  v_lshlrev_b32 v97, 3, v97
  v_add_u32 v45, v96, v97
  v_xor_b32 v46, 0, v45
  v_xor_b32 v47, 32, v45
  v_xor_b32 v48, 64, v45
  v_xor_b32 v49, 96, v45
  v_xor_b32 v50, 128, v45
  v_xor_b32 v51, 160, v45
  s_barrier
  v_xor_b32 v52, 192, v45
  v_xor_b32 v53, 224, v45
  v_bfe_u32 v98, v1, 2, 3
  v_mul_u32_u24 v99, 288, v98
  v_and_b32 v100, 3, v1
  v_lshlrev_b32 v101, 3, v100
  v_add3_u32 v99, v96, v99, v101
  v_xor_b32 v54, 0, v99
  v_xor_b32 v55, 32, v99
  v_xor_b32 v56, 64, v99
  v_xor_b32 v57, 96, v99
  v_xor_b32 v58, 128, v99
  v_xor_b32 v59, 160, v99
  v_xor_b32 v60, 192, v99
  v_xor_b32 v61, 224, v99
  v_lshlrev_b32 v99, 8, v98
  v_add_u32 v99, v96, v99
  v_lshlrev_b32 v98, 5, v98
  v_lshlrev_b32 v101, 6, v100
  v_xor_b32 v98, v98, v101
  v_add_u32 v99, v99, v98
  v_add_u32 v101, 0, v100
  v_and_b32 v101, 3, v101
  v_lshl_add_u32 v62, v101, 3, v99
  v_xor_b32 v66, 32, v62
  v_add_u32 v101, 1, v100
  v_and_b32 v101, 3, v101
  v_lshl_add_u32 v63, v101, 3, v99
  v_xor_b32 v67, 32, v63
  v_add_u32 v101, 2, v100
  v_and_b32 v101, 3, v101
  v_lshl_add_u32 v64, v101, 3, v99
  s_barrier
  v_xor_b32 v68, 32, v64
  v_add_u32 v101, 3, v100
  v_and_b32 v101, 3, v101
  v_lshl_add_u32 v65, v101, 3, v99
  v_xor_b32 v69, 32, v65
  v_and_b32 v96, 255, v1
  v_cvt_f32_u32 v96, v96
  v_mul_f32 v97, 0.00048828125, v96
  v_cos_f32 v2, v97
  v_sin_f32 v3, v97
  v_mul_f32 v97, 0.0009765625, v96
  v_cos_f32 v4, v97
  v_sin_f32 v5, v97
  v_mul_f32 v97, 0.00146484375, v96
  v_cos_f32 v6, v97
  v_sin_f32 v7, v97
  v_mul_f32 v97, 0.001953125, v96
  v_cos_f32 v8, v97
  v_sin_f32 v9, v97
  v_mul_f32 v97, 0.00244140625, v96
  v_cos_f32 v10, v97
  v_sin_f32 v11, v97
  s_barrier
  v_mul_f32 v97, 0.0029296875, v96
  v_cos_f32 v12, v97
  v_sin_f32 v13, v97
  v_mul_f32 v97, 0.00341796875, v96
  v_cos_f32 v14, v97
  v_sin_f32 v15, v97
  v_and_b32 v96, 31, v1
  v_cvt_f32_u32 v96, v96
  v_mul_f32 v97, 0.00390625, v96
  v_cos_f32 v16, v97
  v_sin_f32 v17, v97
  v_mul_f32 v97, 0.0078125, v96
  v_cos_f32 v18, v97
  v_sin_f32 v19, v97
  v_mul_f32 v97, 0.01171875, v96
  v_cos_f32 v20, v97
  v_sin_f32 v21, v97
  v_mul_f32 v97, 0.015625, v96
  v_cos_f32 v22, v97
  v_sin_f32 v23, v97
  s_barrier
  v_mul_f32 v97, 0.01953125, v96
  v_cos_f32 v24, v97
  v_sin_f32 v25, v97
  v_mul_f32 v97, 0.0234375, v96
  v_cos_f32 v26, v97
  v_sin_f32 v27, v97
  v_mul_f32 v97, 0.02734375, v96
  v_cos_f32 v28, v97
  v_sin_f32 v29, v97
  v_and_b32 v96, 3, v1
  v_cvt_f32_u32 v96, v96
  v_mul_f32 v97, 0.03125, v96
  v_cos_f32 v30, v97
  v_sin_f32 v31, v97
  v_mul_f32 v97, 0.0625, v96
  v_cos_f32 v32, v97
  v_sin_f32 v33, v97
  v_mul_f32 v97, 0.09375, v96
  v_cos_f32 v34, v97
  v_sin_f32 v35, v97
  s_barrier
  v_mul_f32 v97, 0.125, v96
  v_cos_f32 v36, v97
  v_sin_f32 v37, v97
  v_mul_f32 v97, 0.15625, v96
  v_cos_f32 v38, v97
  v_sin_f32 v39, v97
  v_mul_f32 v97, 0.1875, v96
  v_cos_f32 v40, v97
  v_sin_f32 v41, v97
  v_mul_f32 v97, 0.21875, v96
  v_cos_f32 v42, v97
  v_sin_f32 v43, v97
  v_lshlrev_b32 v70, 3, v1
  v_lshrrev_b32 v96, 4, v1
  v_mul_u32_u24 v96, 18496, v96
  v_and_b32 v97, 15, v1
  v_lshl_add_u32 v71, v97, 2, v96
  s_barrier
  s_barrier
  s_barrier
  s_barrier
  s_barrier
  s_barrier
  s_barrier
  s_barrier
  s_barrier
  s_barrier
L_j32:
  s_cmp_ge_u32 s30, 2
  s_cbranch_scc1 L_skb32
  s_call_b64 s[62:63], L_ld1
L_skb32:
  s_cmp_lg_u32 s30, 2
  s_cbranch_scc1 L_np1
  v_lshlrev_b32 v96, 4, v240
  s_mov_b32 s55, 0
  s_mov_b32 s56, 458752
L_poll1:
  buffer_load_dwordx4 v[98:101], v96, s[16:19], s56 offen sc0 sc1
  s_waitcnt vmcnt(0)
  v_xor_b32 v98, s29, v98
  v_xor_b32 v99, s29, v99
  v_xor_b32 v100, s29, v100
  v_xor_b32 v101, s29, v101
  v_or_b32 v98, v98, v99
  v_or3_b32 v98, v98, v100, v101
  v_cmp_ne_u32 vcc, 0, v98
  s_add_u32 s55, s55, 1
  s_cmp_gt_u32 s55, 100000
  s_cbranch_scc1 L_poll1_ok
  s_cmp_eq_u64 vcc, 0
  s_cbranch_scc1 L_poll1_ok
  s_sleep 4
  s_branch L_poll1
L_poll1_ok:
L_np1:
  s_waitcnt vmcnt(9)
  s_barrier
  s_mul_i32 s53, s26, 663552
  s_mul_i32 s47, s31, 4608
  s_add_u32 s53, s53, s47
  s_add_u32 s53, s53, 0
  s_mul_i32 s47, s27, 18432
  s_add_u32 s52, s53, s47
  s_sub_u32 s48, 36, s27
  s_waitcnt vmcnt(0)
  v_lshlrev_b32 v70, 4, v1
  s_mov_b32 s56, s98
  buffer_load_dword v102, v70, s[16:19], s56 offen
  s_add_u32 s56, s56, 4096
  buffer_load_dword v104, v70, s[16:19], s56 offen
  s_add_u32 s56, s56, 4096
  buffer_load_dword v106, v70, s[16:19], s56 offen
  s_add_u32 s56, s56, 4096
  buffer_load_dword v108, v70, s[16:19], s56 offen
  s_add_u32 s56, s56, 4096
  buffer_load_dword v110, v70, s[16:19], s56 offen
  s_add_u32 s56, s56, 4096
  buffer_load_dword v112, v70, s[16:19], s56 offen
  s_add_u32 s56, s56, 4096
  buffer_load_dword v114, v70, s[16:19], s56 offen
  s_add_u32 s56, s56, 4096
  buffer_load_dword v116, v70, s[16:19], s56 offen
  s_add_u32 s56, s56, 4096
  v_mul_u32_u24 v96, 10240, v1
  s_lshl_b32 s56, s61, 5
  s_add_u32 s56, s56, 45088768
  buffer_load_dwordx4 v[72:75], v96, s[16:19], s56 offen
  buffer_load_dwordx4 v[76:79], v96, s[16:19], s56 offen offset:16
  s_cmp_lt_i32 s28, 0
  s_cbranch_scc1 L_nx1
  v_lshlrev_b32 v70, 4, v1
  s_mov_b32 s56, s99
  buffer_load_dword v248, v70, s[16:19], s56 offen
  s_add_u32 s56, s56, 4096
  buffer_load_dword v249, v70, s[16:19], s56 offen
  s_add_u32 s56, s56, 4096
  buffer_load_dword v250, v70, s[16:19], s56 offen
  s_add_u32 s56, s56, 4096
  buffer_load_dword v251, v70, s[16:19], s56 offen
  s_add_u32 s56, s56, 4096
  buffer_load_dword v252, v70, s[16:19], s56 offen
  s_add_u32 s56, s56, 4096
  buffer_load_dword v253, v70, s[16:19], s56 offen
  s_add_u32 s56, s56, 4096
  buffer_load_dword v254, v70, s[16:19], s56 offen
  s_add_u32 s56, s56, 4096
  buffer_load_dword v255, v70, s[16:19], s56 offen
  s_add_u32 s56, s56, 4096
L_nx1:
  s_cmp_ge_u32 s30, 2
  s_cbranch_scc1 L_skb33
  s_call_b64 s[62:63], L_ld2
L_skb33:
  s_barrier
  s_cmp_ge_u32 s30, 2
  s_cbranch_scc1 L_skb34
  s_call_b64 s[62:63], L_ld2
L_skb34:
  s_barrier
  s_cmp_ge_u32 s30, 2
  s_cbranch_scc1 L_skb35
  s_call_b64 s[62:63], L_ld2
L_skb35:
  s_barrier
  s_cmp_lt_u32 s30, 2
  s_cbranch_scc1 L_wl27
  s_waitcnt vmcnt(0)
  s_and_b32 s40, s25, 15
  s_lshl_b32 s40, s40, 1
  s_add_u32 s40, s40, s31
  s_lshl_b32 s40, s40, 6
  v_add_u32 v96, s40, v240
  s_mul_i32 s40, s26, 663552
  v_min_u32 v97, 5183, v96
  v_lshlrev_b32 v97, 7, v97
  buffer_load_dword v98, v97, s[12:15], s40 offen
  v_add_u32 v96, 2048, v96
  v_min_u32 v97, 5183, v96
  v_lshlrev_b32 v97, 7, v97
  buffer_load_dword v98, v97, s[12:15], s40 offen
  v_add_u32 v96, 2048, v96
  v_min_u32 v97, 5183, v96
  v_lshlrev_b32 v97, 7, v97
  buffer_load_dword v98, v97, s[12:15], s40 offen
  v_add_u32 v96, 2048, v96
L_wl27:
  s_waitcnt vmcnt(27)
  s_mov_b32 s60, 0
L_fft:
  v_and_b32 v103, 0xffff0000, v102
  v_lshlrev_b32 v102, 16, v102
  v_and_b32 v105, 0xffff0000, v104
  v_lshlrev_b32 v104, 16, v104
  v_and_b32 v107, 0xffff0000, v106
  v_lshlrev_b32 v106, 16, v106
  v_and_b32 v109, 0xffff0000, v108
  v_lshlrev_b32 v108, 16, v108
  v_and_b32 v111, 0xffff0000, v110
  v_lshlrev_b32 v110, 16, v110
  v_and_b32 v113, 0xffff0000, v112
  v_lshlrev_b32 v112, 16, v112
  v_and_b32 v115, 0xffff0000, v114
  v_lshlrev_b32 v114, 16, v114
  v_and_b32 v117, 0xffff0000, v116
  v_lshlrev_b32 v116, 16, v116
  v_pk_add_f32 v[118:119], v[102:103], v[110:111] op_sel:[0,0] op_sel_hi:[1,1] neg_lo:[0,0] neg_hi:[0,0]
  v_pk_add_f32 v[120:121], v[102:103], v[110:111] op_sel:[0,0] op_sel_hi:[1,1] neg_lo:[0,1] neg_hi:[0,1]
  v_pk_add_f32 v[122:123], v[104:105], v[112:113] op_sel:[0,0] op_sel_hi:[1,1] neg_lo:[0,0] neg_hi:[0,0]
  v_pk_add_f32 v[126:127], v[106:107], v[114:115] op_sel:[0,0] op_sel_hi:[1,1] neg_lo:[0,0] neg_hi:[0,0]
  v_pk_add_f32 v[102:103], v[108:109], v[116:117] op_sel:[0,0] op_sel_hi:[1,1] neg_lo:[0,0] neg_hi:[0,0]
  v_pk_add_f32 v[124:125], v[104:105], v[112:113] op_sel:[0,0] op_sel_hi:[1,1] neg_lo:[0,1] neg_hi:[0,1]
  v_pk_add_f32 v[110:111], v[108:109], v[116:117] op_sel:[0,0] op_sel_hi:[1,1] neg_lo:[0,1] neg_hi:[0,1]
  v_pk_add_f32 v[128:129], v[106:107], v[114:115] op_sel:[0,0] op_sel_hi:[1,1] neg_lo:[0,1] neg_hi:[0,1]
  v_pk_add_f32 v[106:107], v[118:119], v[126:127] op_sel:[0,0] op_sel_hi:[1,1] neg_lo:[0,0] neg_hi:[0,0]
  v_pk_add_f32 v[108:109], v[122:123], v[102:103] op_sel:[0,0] op_sel_hi:[1,1] neg_lo:[0,0] neg_hi:[0,0]
  v_pk_add_f32 v[104:105], v[124:125], v[124:125] op_sel:[0,1] op_sel_hi:[1,0] neg_lo:[0,0] neg_hi:[0,1]
  v_pk_add_f32 v[112:113], v[110:111], v[110:111] op_sel:[0,1] op_sel_hi:[1,0] neg_lo:[0,0] neg_hi:[0,1]
  v_pk_add_f32 v[114:115], v[118:119], v[126:127] op_sel:[0,0] op_sel_hi:[1,1] neg_lo:[0,1] neg_hi:[0,1]
  v_pk_add_f32 v[116:117], v[122:123], v[102:103] op_sel:[0,0] op_sel_hi:[1,1] neg_lo:[0,1] neg_hi:[0,1]
  v_pk_add_f32 v[124:125], v[106:107], v[108:109] op_sel:[0,0] op_sel_hi:[1,1] neg_lo:[0,0] neg_hi:[0,0]
  v_pk_add_f32 v[110:111], v[106:107], v[108:109] op_sel:[0,0] op_sel_hi:[1,1] neg_lo:[0,1] neg_hi:[0,1]
  v_pk_add_f32 v[122:123], v[120:121], v[128:129] op_sel:[0,1] op_sel_hi:[1,0] neg_lo:[0,0] neg_hi:[0,1]
  v_pk_add_f32 v[102:103], v[120:121], v[128:129] op_sel:[0,1] op_sel_hi:[1,0] neg_lo:[0,1] neg_hi:[0,0]
  v_pk_add_f32 v[106:107], v[104:105], v[112:113] op_sel:[0,1] op_sel_hi:[1,0] neg_lo:[0,0] neg_hi:[0,1]
  v_pk_add_f32 v[108:109], v[104:105], v[112:113] op_sel:[0,1] op_sel_hi:[1,0] neg_lo:[0,1] neg_hi:[0,0]
  v_pk_add_f32 v[118:119], v[114:115], v[116:117] op_sel:[0,1] op_sel_hi:[1,0] neg_lo:[0,0] neg_hi:[0,1]
  v_pk_add_f32 v[126:127], v[114:115], v[116:117] op_sel:[0,1] op_sel_hi:[1,0] neg_lo:[0,1] neg_hi:[0,0]
  v_pk_fma_f32 v[114:115], v[106:107], s[96:97], v[122:123] op_sel:[0,0,0] op_sel_hi:[1,1,1] neg_lo:[0,0,0] neg_hi:[0,0,0]
  v_pk_fma_f32 v[116:117], v[106:107], s[96:97], v[122:123] op_sel:[0,0,0] op_sel_hi:[1,1,1] neg_lo:[1,0,0] neg_hi:[1,0,0]
  v_pk_fma_f32 v[120:121], v[108:109], s[96:97], v[102:103] op_sel:[1,0,0] op_sel_hi:[0,1,1] neg_lo:[0,0,0] neg_hi:[1,0,0]
  v_pk_fma_f32 v[128:129], v[108:109], s[96:97], v[102:103] op_sel:[1,0,0] op_sel_hi:[0,1,1] neg_lo:[1,0,0] neg_hi:[0,0,0]
  ds_write_b64 v44, v[124:125] offset:0
  v_pk_mul_f32 v[104:105], v[114:115], v[2:3] op_sel:[0,0] op_sel_hi:[1,0] neg_lo:[0,0] neg_hi:[0,0]
  v_pk_mul_f32 v[112:113], v[118:119], v[4:5] op_sel:[0,0] op_sel_hi:[1,0] neg_lo:[0,0] neg_hi:[0,0]
  v_pk_mul_f32 v[122:123], v[120:121], v[6:7] op_sel:[0,0] op_sel_hi:[1,0] neg_lo:[0,0] neg_hi:[0,0]
  v_pk_mul_f32 v[106:107], v[110:111], v[8:9] op_sel:[0,0] op_sel_hi:[1,0] neg_lo:[0,0] neg_hi:[0,0]
  v_pk_mul_f32 v[102:103], v[116:117], v[10:11] op_sel:[0,0] op_sel_hi:[1,0] neg_lo:[0,0] neg_hi:[0,0]
  v_pk_mul_f32 v[108:109], v[126:127], v[12:13] op_sel:[0,0] op_sel_hi:[1,0] neg_lo:[0,0] neg_hi:[0,0]
  v_pk_mul_f32 v[124:125], v[128:129], v[14:15] op_sel:[0,0] op_sel_hi:[1,0] neg_lo:[0,0] neg_hi:[0,0]
  v_pk_fma_f32 v[104:105], v[114:115], v[2:3], v[104:105] op_sel:[1,1,0] op_sel_hi:[0,1,1] neg_lo:[0,0,0] neg_hi:[1,0,0]
  v_pk_fma_f32 v[112:113], v[118:119], v[4:5], v[112:113] op_sel:[1,1,0] op_sel_hi:[0,1,1] neg_lo:[0,0,0] neg_hi:[1,0,0]
  v_pk_fma_f32 v[122:123], v[120:121], v[6:7], v[122:123] op_sel:[1,1,0] op_sel_hi:[0,1,1] neg_lo:[0,0,0] neg_hi:[1,0,0]
  v_pk_fma_f32 v[106:107], v[110:111], v[8:9], v[106:107] op_sel:[1,1,0] op_sel_hi:[0,1,1] neg_lo:[0,0,0] neg_hi:[1,0,0]
  v_pk_fma_f32 v[102:103], v[116:117], v[10:11], v[102:103] op_sel:[1,1,0] op_sel_hi:[0,1,1] neg_lo:[0,0,0] neg_hi:[1,0,0]
  v_pk_fma_f32 v[108:109], v[126:127], v[12:13], v[108:109] op_sel:[1,1,0] op_sel_hi:[0,1,1] neg_lo:[0,0,0] neg_hi:[1,0,0]
  v_pk_fma_f32 v[124:125], v[128:129], v[14:15], v[124:125] op_sel:[1,1,0] op_sel_hi:[0,1,1] neg_lo:[0,0,0] neg_hi:[1,0,0]
  ds_write_b64 v44, v[104:105] offset:2048
  ds_write_b64 v44, v[112:113] offset:4096
  ds_write_b64 v44, v[122:123] offset:6144
  ds_write_b64 v44, v[106:107] offset:8192
  ds_write_b64 v44, v[102:103] offset:10240
  ds_write_b64 v44, v[108:109] offset:12288
  ds_write_b64 v44, v[124:125] offset:14336
  s_waitcnt lgkmcnt(0)
  s_barrier
  ds_read_b64 v[114:115], v45 offset:0
  ds_read_b64 v[104:105], v45 offset:256
  ds_read_b64 v[118:119], v45 offset:512
  ds_read_b64 v[112:113], v45 offset:768
  ds_read_b64 v[120:121], v45 offset:1024
  ds_read_b64 v[122:123], v45 offset:1280
  ds_read_b64 v[110:111], v45 offset:1536
  ds_read_b64 v[106:107], v45 offset:1792
  s_waitcnt lgkmcnt(0)
  v_pk_add_f32 v[116:117], v[114:115], v[120:121] op_sel:[0,0] op_sel_hi:[1,1] neg_lo:[0,0] neg_hi:[0,0]
  v_pk_add_f32 v[102:103], v[114:115], v[120:121] op_sel:[0,0] op_sel_hi:[1,1] neg_lo:[0,1] neg_hi:[0,1]
  v_pk_add_f32 v[126:127], v[104:105], v[122:123] op_sel:[0,0] op_sel_hi:[1,1] neg_lo:[0,0] neg_hi:[0,0]
  v_pk_add_f32 v[128:129], v[118:119], v[110:111] op_sel:[0,0] op_sel_hi:[1,1] neg_lo:[0,0] neg_hi:[0,0]
  v_pk_add_f32 v[114:115], v[112:113], v[106:107] op_sel:[0,0] op_sel_hi:[1,1] neg_lo:[0,0] neg_hi:[0,0]
  v_pk_add_f32 v[108:109], v[104:105], v[122:123] op_sel:[0,0] op_sel_hi:[1,1] neg_lo:[0,1] neg_hi:[0,1]
  v_pk_add_f32 v[120:121], v[112:113], v[106:107] op_sel:[0,0] op_sel_hi:[1,1] neg_lo:[0,1] neg_hi:[0,1]
  v_pk_add_f32 v[124:125], v[118:119], v[110:111] op_sel:[0,0] op_sel_hi:[1,1] neg_lo:[0,1] neg_hi:[0,1]
  v_pk_add_f32 v[118:119], v[116:117], v[128:129] op_sel:[0,0] op_sel_hi:[1,1] neg_lo:[0,0] neg_hi:[0,0]
  v_pk_add_f32 v[112:113], v[126:127], v[114:115] op_sel:[0,0] op_sel_hi:[1,1] neg_lo:[0,0] neg_hi:[0,0]
  v_pk_add_f32 v[104:105], v[108:109], v[108:109] op_sel:[0,1] op_sel_hi:[1,0] neg_lo:[0,0] neg_hi:[0,1]
  v_pk_add_f32 v[122:123], v[120:121], v[120:121] op_sel:[0,1] op_sel_hi:[1,0] neg_lo:[0,0] neg_hi:[0,1]
  v_pk_add_f32 v[110:111], v[116:117], v[128:129] op_sel:[0,0] op_sel_hi:[1,1] neg_lo:[0,1] neg_hi:[0,1]
  v_pk_add_f32 v[106:107], v[126:127], v[114:115] op_sel:[0,0] op_sel_hi:[1,1] neg_lo:[0,1] neg_hi:[0,1]
  v_pk_add_f32 v[108:109], v[118:119], v[112:113] op_sel:[0,0] op_sel_hi:[1,1] neg_lo:[0,0] neg_hi:[0,0]
  v_pk_add_f32 v[120:121], v[118:119], v[112:113] op_sel:[0,0] op_sel_hi:[1,1] neg_lo:[0,1] neg_hi:[0,1]
  v_pk_add_f32 v[126:127], v[102:103], v[124:125] op_sel:[0,1] op_sel_hi:[1,0] neg_lo:[0,0] neg_hi:[0,1]
  v_pk_add_f32 v[114:115], v[102:103], v[124:125] op_sel:[0,1] op_sel_hi:[1,0] neg_lo:[0,1] neg_hi:[0,0]
  v_pk_add_f32 v[118:119], v[104:105], v[122:123] op_sel:[0,1] op_sel_hi:[1,0] neg_lo:[0,0] neg_hi:[0,1]
  v_pk_add_f32 v[112:113], v[104:105], v[122:123] op_sel:[0,1] op_sel_hi:[1,0] neg_lo:[0,1] neg_hi:[0,0]
  v_pk_add_f32 v[116:117], v[110:111], v[106:107] op_sel:[0,1] op_sel_hi:[1,0] neg_lo:[0,0] neg_hi:[0,1]
  v_pk_add_f32 v[128:129], v[110:111], v[106:107] op_sel:[0,1] op_sel_hi:[1,0] neg_lo:[0,1] neg_hi:[0,0]
  v_pk_fma_f32 v[110:111], v[118:119], s[96:97], v[126:127] op_sel:[0,0,0] op_sel_hi:[1,1,1] neg_lo:[0,0,0] neg_hi:[0,0,0]
  v_pk_fma_f32 v[106:107], v[118:119], s[96:97], v[126:127] op_sel:[0,0,0] op_sel_hi:[1,1,1] neg_lo:[1,0,0] neg_hi:[1,0,0]
  v_pk_fma_f32 v[102:103], v[112:113], s[96:97], v[114:115] op_sel:[1,0,0] op_sel_hi:[0,1,1] neg_lo:[0,0,0] neg_hi:[1,0,0]
  v_pk_fma_f32 v[124:125], v[112:113], s[96:97], v[114:115] op_sel:[1,0,0] op_sel_hi:[0,1,1] neg_lo:[1,0,0] neg_hi:[0,0,0]
  ds_write_b64 v46, v[108:109] offset:0
  v_pk_mul_f32 v[104:105], v[110:111], v[16:17] op_sel:[0,0] op_sel_hi:[1,0] neg_lo:[0,0] neg_hi:[0,0]
  v_pk_mul_f32 v[122:123], v[116:117], v[18:19] op_sel:[0,0] op_sel_hi:[1,0] neg_lo:[0,0] neg_hi:[0,0]
  v_pk_mul_f32 v[126:127], v[102:103], v[20:21] op_sel:[0,0] op_sel_hi:[1,0] neg_lo:[0,0] neg_hi:[0,0]
  v_pk_mul_f32 v[118:119], v[120:121], v[22:23] op_sel:[0,0] op_sel_hi:[1,0] neg_lo:[0,0] neg_hi:[0,0]
  v_pk_mul_f32 v[114:115], v[106:107], v[24:25] op_sel:[0,0] op_sel_hi:[1,0] neg_lo:[0,0] neg_hi:[0,0]
  v_pk_mul_f32 v[112:113], v[128:129], v[26:27] op_sel:[0,0] op_sel_hi:[1,0] neg_lo:[0,0] neg_hi:[0,0]
  v_pk_mul_f32 v[108:109], v[124:125], v[28:29] op_sel:[0,0] op_sel_hi:[1,0] neg_lo:[0,0] neg_hi:[0,0]
  v_pk_fma_f32 v[104:105], v[110:111], v[16:17], v[104:105] op_sel:[1,1,0] op_sel_hi:[0,1,1] neg_lo:[0,0,0] neg_hi:[1,0,0]
  v_pk_fma_f32 v[122:123], v[116:117], v[18:19], v[122:123] op_sel:[1,1,0] op_sel_hi:[0,1,1] neg_lo:[0,0,0] neg_hi:[1,0,0]
  v_pk_fma_f32 v[126:127], v[102:103], v[20:21], v[126:127] op_sel:[1,1,0] op_sel_hi:[0,1,1] neg_lo:[0,0,0] neg_hi:[1,0,0]
  v_pk_fma_f32 v[118:119], v[120:121], v[22:23], v[118:119] op_sel:[1,1,0] op_sel_hi:[0,1,1] neg_lo:[0,0,0] neg_hi:[1,0,0]
  v_pk_fma_f32 v[114:115], v[106:107], v[24:25], v[114:115] op_sel:[1,1,0] op_sel_hi:[0,1,1] neg_lo:[0,0,0] neg_hi:[1,0,0]
  v_pk_fma_f32 v[112:113], v[128:129], v[26:27], v[112:113] op_sel:[1,1,0] op_sel_hi:[0,1,1] neg_lo:[0,0,0] neg_hi:[1,0,0]
  v_pk_fma_f32 v[108:109], v[124:125], v[28:29], v[108:109] op_sel:[1,1,0] op_sel_hi:[0,1,1] neg_lo:[0,0,0] neg_hi:[1,0,0]
  ds_write_b64 v47, v[104:105] offset:256
  ds_write_b64 v48, v[122:123] offset:512
  ds_write_b64 v49, v[126:127] offset:768
  ds_write_b64 v50, v[118:119] offset:1024
  ds_write_b64 v51, v[114:115] offset:1280
  ds_write_b64 v52, v[112:113] offset:1536
  ds_write_b64 v53, v[108:109] offset:1792
  ds_read_b64 v[110:111], v54 offset:0
  ds_read_b64 v[104:105], v55 offset:0
  ds_read_b64 v[116:117], v56 offset:0
  ds_read_b64 v[122:123], v57 offset:0
  ds_read_b64 v[102:103], v58 offset:0
  ds_read_b64 v[126:127], v59 offset:0
  ds_read_b64 v[120:121], v60 offset:0
  ds_read_b64 v[118:119], v61 offset:0
  s_waitcnt lgkmcnt(0)
  v_pk_add_f32 v[106:107], v[110:111], v[102:103] op_sel:[0,0] op_sel_hi:[1,1] neg_lo:[0,0] neg_hi:[0,0]
  v_pk_add_f32 v[114:115], v[110:111], v[102:103] op_sel:[0,0] op_sel_hi:[1,1] neg_lo:[0,1] neg_hi:[0,1]
  v_pk_add_f32 v[128:129], v[104:105], v[126:127] op_sel:[0,0] op_sel_hi:[1,1] neg_lo:[0,0] neg_hi:[0,0]
  v_pk_add_f32 v[124:125], v[116:117], v[120:121] op_sel:[0,0] op_sel_hi:[1,1] neg_lo:[0,0] neg_hi:[0,0]
  v_pk_add_f32 v[110:111], v[122:123], v[118:119] op_sel:[0,0] op_sel_hi:[1,1] neg_lo:[0,0] neg_hi:[0,0]
  v_pk_add_f32 v[112:113], v[104:105], v[126:127] op_sel:[0,0] op_sel_hi:[1,1] neg_lo:[0,1] neg_hi:[0,1]
  v_pk_add_f32 v[102:103], v[122:123], v[118:119] op_sel:[0,0] op_sel_hi:[1,1] neg_lo:[0,1] neg_hi:[0,1]
  v_pk_add_f32 v[108:109], v[116:117], v[120:121] op_sel:[0,0] op_sel_hi:[1,1] neg_lo:[0,1] neg_hi:[0,1]
  v_pk_add_f32 v[116:117], v[106:107], v[124:125] op_sel:[0,0] op_sel_hi:[1,1] neg_lo:[0,0] neg_hi:[0,0]
  v_pk_add_f32 v[122:123], v[128:129], v[110:111] op_sel:[0,0] op_sel_hi:[1,1] neg_lo:[0,0] neg_hi:[0,0]
  v_pk_add_f32 v[104:105], v[112:113], v[112:113] op_sel:[0,1] op_sel_hi:[1,0] neg_lo:[0,0] neg_hi:[0,1]
  v_pk_add_f32 v[126:127], v[102:103], v[102:103] op_sel:[0,1] op_sel_hi:[1,0] neg_lo:[0,0] neg_hi:[0,1]
  v_pk_add_f32 v[120:121], v[106:107], v[124:125] op_sel:[0,0] op_sel_hi:[1,1] neg_lo:[0,1] neg_hi:[0,1]
  v_pk_add_f32 v[118:119], v[128:129], v[110:111] op_sel:[0,0] op_sel_hi:[1,1] neg_lo:[0,1] neg_hi:[0,1]
  v_pk_add_f32 v[112:113], v[116:117], v[122:123] op_sel:[0,0] op_sel_hi:[1,1] neg_lo:[0,0] neg_hi:[0,0]
  v_pk_add_f32 v[102:103], v[116:117], v[122:123] op_sel:[0,0] op_sel_hi:[1,1] neg_lo:[0,1] neg_hi:[0,1]
  v_pk_add_f32 v[128:129], v[114:115], v[108:109] op_sel:[0,1] op_sel_hi:[1,0] neg_lo:[0,0] neg_hi:[0,1]
  v_pk_add_f32 v[110:111], v[114:115], v[108:109] op_sel:[0,1] op_sel_hi:[1,0] neg_lo:[0,1] neg_hi:[0,0]
  v_pk_add_f32 v[116:117], v[104:105], v[126:127] op_sel:[0,1] op_sel_hi:[1,0] neg_lo:[0,0] neg_hi:[0,1]
  v_pk_add_f32 v[122:123], v[104:105], v[126:127] op_sel:[0,1] op_sel_hi:[1,0] neg_lo:[0,1] neg_hi:[0,0]
  v_pk_add_f32 v[106:107], v[120:121], v[118:119] op_sel:[0,1] op_sel_hi:[1,0] neg_lo:[0,0] neg_hi:[0,1]
  v_pk_add_f32 v[124:125], v[120:121], v[118:119] op_sel:[0,1] op_sel_hi:[1,0] neg_lo:[0,1] neg_hi:[0,0]
  v_pk_fma_f32 v[120:121], v[116:117], s[96:97], v[128:129] op_sel:[0,0,0] op_sel_hi:[1,1,1] neg_lo:[0,0,0] neg_hi:[0,0,0]
  v_pk_fma_f32 v[118:119], v[116:117], s[96:97], v[128:129] op_sel:[0,0,0] op_sel_hi:[1,1,1] neg_lo:[1,0,0] neg_hi:[1,0,0]
  v_pk_fma_f32 v[114:115], v[122:123], s[96:97], v[110:111] op_sel:[1,0,0] op_sel_hi:[0,1,1] neg_lo:[0,0,0] neg_hi:[1,0,0]
  v_pk_fma_f32 v[108:109], v[122:123], s[96:97], v[110:111] op_sel:[1,0,0] op_sel_hi:[0,1,1] neg_lo:[1,0,0] neg_hi:[0,0,0]
  ds_write_b64 v54, v[112:113] offset:0
  v_pk_mul_f32 v[104:105], v[120:121], v[30:31] op_sel:[0,0] op_sel_hi:[1,0] neg_lo:[0,0] neg_hi:[0,0]
  v_pk_mul_f32 v[126:127], v[106:107], v[32:33] op_sel:[0,0] op_sel_hi:[1,0] neg_lo:[0,0] neg_hi:[0,0]
  v_pk_mul_f32 v[128:129], v[114:115], v[34:35] op_sel:[0,0] op_sel_hi:[1,0] neg_lo:[0,0] neg_hi:[0,0]
  v_pk_mul_f32 v[116:117], v[102:103], v[36:37] op_sel:[0,0] op_sel_hi:[1,0] neg_lo:[0,0] neg_hi:[0,0]
  v_pk_mul_f32 v[110:111], v[118:119], v[38:39] op_sel:[0,0] op_sel_hi:[1,0] neg_lo:[0,0] neg_hi:[0,0]
  v_pk_mul_f32 v[122:123], v[124:125], v[40:41] op_sel:[0,0] op_sel_hi:[1,0] neg_lo:[0,0] neg_hi:[0,0]
  v_pk_mul_f32 v[112:113], v[108:109], v[42:43] op_sel:[0,0] op_sel_hi:[1,0] neg_lo:[0,0] neg_hi:[0,0]
  v_pk_fma_f32 v[104:105], v[120:121], v[30:31], v[104:105] op_sel:[1,1,0] op_sel_hi:[0,1,1] neg_lo:[0,0,0] neg_hi:[1,0,0]
  v_pk_fma_f32 v[126:127], v[106:107], v[32:33], v[126:127] op_sel:[1,1,0] op_sel_hi:[0,1,1] neg_lo:[0,0,0] neg_hi:[1,0,0]
  v_pk_fma_f32 v[128:129], v[114:115], v[34:35], v[128:129] op_sel:[1,1,0] op_sel_hi:[0,1,1] neg_lo:[0,0,0] neg_hi:[1,0,0]
  v_pk_fma_f32 v[116:117], v[102:103], v[36:37], v[116:117] op_sel:[1,1,0] op_sel_hi:[0,1,1] neg_lo:[0,0,0] neg_hi:[1,0,0]
  v_pk_fma_f32 v[110:111], v[118:119], v[38:39], v[110:111] op_sel:[1,1,0] op_sel_hi:[0,1,1] neg_lo:[0,0,0] neg_hi:[1,0,0]
  v_pk_fma_f32 v[122:123], v[124:125], v[40:41], v[122:123] op_sel:[1,1,0] op_sel_hi:[0,1,1] neg_lo:[0,0,0] neg_hi:[1,0,0]
  v_pk_fma_f32 v[112:113], v[108:109], v[42:43], v[112:113] op_sel:[1,1,0] op_sel_hi:[0,1,1] neg_lo:[0,0,0] neg_hi:[1,0,0]
  ds_write_b64 v55, v[104:105] offset:0
  ds_write_b64 v56, v[126:127] offset:0
  ds_write_b64 v57, v[128:129] offset:0
  ds_write_b64 v58, v[116:117] offset:0
  ds_write_b64 v59, v[110:111] offset:0
  ds_write_b64 v60, v[122:123] offset:0
  ds_write_b64 v61, v[112:113] offset:0
  ds_read_b64 v[120:121], v62 offset:0
  ds_read_b64 v[104:105], v63 offset:0
  ds_read_b64 v[106:107], v64 offset:0
  ds_read_b64 v[126:127], v65 offset:0
  ds_read_b64 v[114:115], v66 offset:0
  ds_read_b64 v[128:129], v67 offset:0
  ds_read_b64 v[102:103], v68 offset:0
  ds_read_b64 v[116:117], v69 offset:0
  s_waitcnt lgkmcnt(0)
  s_cmp_eq_u32 s60, 0
  s_cbranch_scc1 L_nww
  s_waitcnt vmcnt(0)
L_nww:
  v_and_b32 v81, 0xffff0000, v72
  v_lshlrev_b32 v80, 16, v72
  v_and_b32 v83, 0xffff0000, v73
  v_lshlrev_b32 v82, 16, v73
  v_and_b32 v85, 0xffff0000, v74
  v_lshlrev_b32 v84, 16, v74
  v_and_b32 v87, 0xffff0000, v75
  v_lshlrev_b32 v86, 16, v75
  v_and_b32 v89, 0xffff0000, v76
  v_lshlrev_b32 v88, 16, v76
  v_and_b32 v91, 0xffff0000, v77
  v_lshlrev_b32 v90, 16, v77
  v_and_b32 v93, 0xffff0000, v78
  v_lshlrev_b32 v92, 16, v78
  v_and_b32 v95, 0xffff0000, v79
  v_lshlrev_b32 v94, 16, v79
  v_pk_add_f32 v[118:119], v[120:121], v[106:107] op_sel:[0,0] op_sel_hi:[1,1] neg_lo:[0,0] neg_hi:[0,0]
  v_pk_add_f32 v[110:111], v[120:121], v[106:107] op_sel:[0,0] op_sel_hi:[1,1] neg_lo:[0,1] neg_hi:[0,1]
  v_pk_add_f32 v[124:125], v[104:105], v[126:127] op_sel:[0,0] op_sel_hi:[1,1] neg_lo:[0,0] neg_hi:[0,0]
  v_pk_add_f32 v[122:123], v[104:105], v[126:127] op_sel:[0,0] op_sel_hi:[1,1] neg_lo:[0,1] neg_hi:[0,1]
  v_pk_add_f32 v[108:109], v[118:119], v[124:125] op_sel:[0,0] op_sel_hi:[1,1] neg_lo:[0,0] neg_hi:[0,0]
  v_pk_add_f32 v[112:113], v[118:119], v[124:125] op_sel:[0,0] op_sel_hi:[1,1] neg_lo:[0,1] neg_hi:[0,1]
  v_pk_add_f32 v[120:121], v[110:111], v[122:123] op_sel:[0,1] op_sel_hi:[1,0] neg_lo:[0,0] neg_hi:[0,1]
  v_pk_add_f32 v[106:107], v[110:111], v[122:123] op_sel:[0,1] op_sel_hi:[1,0] neg_lo:[0,1] neg_hi:[0,0]
  v_pk_mul_f32 v[104:105], v[108:109], v[80:81] op_sel:[0,0] op_sel_hi:[1,0] neg_lo:[0,0] neg_hi:[0,0]
  v_pk_mul_f32 v[126:127], v[120:121], v[82:83] op_sel:[0,0] op_sel_hi:[1,0] neg_lo:[0,0] neg_hi:[0,0]
  v_pk_mul_f32 v[118:119], v[112:113], v[84:85] op_sel:[0,0] op_sel_hi:[1,0] neg_lo:[0,0] neg_hi:[0,0]
  v_pk_mul_f32 v[124:125], v[106:107], v[86:87] op_sel:[0,0] op_sel_hi:[1,0] neg_lo:[0,0] neg_hi:[0,0]
  v_pk_fma_f32 v[104:105], v[108:109], v[80:81], v[104:105] op_sel:[1,1,0] op_sel_hi:[0,1,1] neg_lo:[1,0,0] neg_hi:[0,0,0]
  v_pk_fma_f32 v[126:127], v[120:121], v[82:83], v[126:127] op_sel:[1,1,0] op_sel_hi:[0,1,1] neg_lo:[1,0,0] neg_hi:[0,0,0]
  v_pk_fma_f32 v[118:119], v[112:113], v[84:85], v[118:119] op_sel:[1,1,0] op_sel_hi:[0,1,1] neg_lo:[1,0,0] neg_hi:[0,0,0]
  v_pk_fma_f32 v[124:125], v[106:107], v[86:87], v[124:125] op_sel:[1,1,0] op_sel_hi:[0,1,1] neg_lo:[1,0,0] neg_hi:[0,0,0]
  v_pk_add_f32 v[110:111], v[104:105], v[118:119] op_sel:[0,0] op_sel_hi:[1,1] neg_lo:[0,0] neg_hi:[0,0]
  v_pk_add_f32 v[122:123], v[104:105], v[118:119] op_sel:[0,0] op_sel_hi:[1,1] neg_lo:[0,1] neg_hi:[0,1]
  v_pk_add_f32 v[108:109], v[126:127], v[124:125] op_sel:[0,0] op_sel_hi:[1,1] neg_lo:[0,0] neg_hi:[0,0]
  v_pk_add_f32 v[120:121], v[126:127], v[124:125] op_sel:[0,0] op_sel_hi:[1,1] neg_lo:[0,1] neg_hi:[0,1]
  v_pk_add_f32 v[126:127], v[114:115], v[102:103] op_sel:[0,0] op_sel_hi:[1,1] neg_lo:[0,0] neg_hi:[0,0]
  v_pk_add_f32 v[112:113], v[110:111], v[108:109] op_sel:[0,0] op_sel_hi:[1,1] neg_lo:[0,0] neg_hi:[0,0]
  v_pk_add_f32 v[106:107], v[110:111], v[108:109] op_sel:[0,0] op_sel_hi:[1,1] neg_lo:[0,1] neg_hi:[0,1]
  v_pk_add_f32 v[104:105], v[122:123], v[120:121] op_sel:[0,1] op_sel_hi:[1,0] neg_lo:[0,1] neg_hi:[0,0]
  v_pk_add_f32 v[124:125], v[114:115], v[102:103] op_sel:[0,0] op_sel_hi:[1,1] neg_lo:[0,1] neg_hi:[0,1]
  v_pk_add_f32 v[110:111], v[128:129], v[116:117] op_sel:[0,0] op_sel_hi:[1,1] neg_lo:[0,0] neg_hi:[0,0]
  v_pk_add_f32 v[108:109], v[128:129], v[116:117] op_sel:[0,0] op_sel_hi:[1,1] neg_lo:[0,1] neg_hi:[0,1]
  v_pk_add_f32 v[118:119], v[122:123], v[120:121] op_sel:[0,1] op_sel_hi:[1,0] neg_lo:[0,0] neg_hi:[0,1]
  ds_write_b64 v62, v[112:113] offset:0
  ds_write_b64 v63, v[104:105] offset:0
  v_pk_add_f32 v[122:123], v[126:127], v[110:111] op_sel:[0,0] op_sel_hi:[1,1] neg_lo:[0,0] neg_hi:[0,0]
  v_pk_add_f32 v[120:121], v[126:127], v[110:111] op_sel:[0,0] op_sel_hi:[1,1] neg_lo:[0,1] neg_hi:[0,1]
  v_pk_add_f32 v[112:113], v[124:125], v[108:109] op_sel:[0,1] op_sel_hi:[1,0] neg_lo:[0,0] neg_hi:[0,1]
  v_pk_add_f32 v[104:105], v[124:125], v[108:109] op_sel:[0,1] op_sel_hi:[1,0] neg_lo:[0,1] neg_hi:[0,0]
  ds_write_b64 v64, v[106:107] offset:0
  ds_write_b64 v65, v[118:119] offset:0
  v_pk_mul_f32 v[106:107], v[122:123], v[88:89] op_sel:[0,0] op_sel_hi:[1,0] neg_lo:[0,0] neg_hi:[0,0]
  v_pk_mul_f32 v[118:119], v[112:113], v[90:91] op_sel:[0,0] op_sel_hi:[1,0] neg_lo:[0,0] neg_hi:[0,0]
  v_pk_mul_f32 v[114:115], v[120:121], v[92:93] op_sel:[0,0] op_sel_hi:[1,0] neg_lo:[0,0] neg_hi:[0,0]
  v_pk_mul_f32 v[102:103], v[104:105], v[94:95] op_sel:[0,0] op_sel_hi:[1,0] neg_lo:[0,0] neg_hi:[0,0]
  v_pk_fma_f32 v[106:107], v[122:123], v[88:89], v[106:107] op_sel:[1,1,0] op_sel_hi:[0,1,1] neg_lo:[1,0,0] neg_hi:[0,0,0]
  v_pk_fma_f32 v[118:119], v[112:113], v[90:91], v[118:119] op_sel:[1,1,0] op_sel_hi:[0,1,1] neg_lo:[1,0,0] neg_hi:[0,0,0]
  v_pk_fma_f32 v[114:115], v[120:121], v[92:93], v[114:115] op_sel:[1,1,0] op_sel_hi:[0,1,1] neg_lo:[1,0,0] neg_hi:[0,0,0]
  v_pk_fma_f32 v[102:103], v[104:105], v[94:95], v[102:103] op_sel:[1,1,0] op_sel_hi:[0,1,1] neg_lo:[1,0,0] neg_hi:[0,0,0]
  v_pk_add_f32 v[128:129], v[106:107], v[114:115] op_sel:[0,0] op_sel_hi:[1,1] neg_lo:[0,0] neg_hi:[0,0]
  v_pk_add_f32 v[116:117], v[106:107], v[114:115] op_sel:[0,0] op_sel_hi:[1,1] neg_lo:[0,1] neg_hi:[0,1]
  v_pk_add_f32 v[126:127], v[118:119], v[102:103] op_sel:[0,0] op_sel_hi:[1,1] neg_lo:[0,0] neg_hi:[0,0]
  v_pk_add_f32 v[110:111], v[118:119], v[102:103] op_sel:[0,0] op_sel_hi:[1,1] neg_lo:[0,1] neg_hi:[0,1]
  v_pk_add_f32 v[124:125], v[128:129], v[126:127] op_sel:[0,0] op_sel_hi:[1,1] neg_lo:[0,0] neg_hi:[0,0]
  v_pk_add_f32 v[108:109], v[128:129], v[126:127] op_sel:[0,0] op_sel_hi:[1,1] neg_lo:[0,1] neg_hi:[0,1]
  v_pk_add_f32 v[122:123], v[116:117], v[110:111] op_sel:[0,1] op_sel_hi:[1,0] neg_lo:[0,1] neg_hi:[0,0]
  v_pk_add_f32 v[112:113], v[116:117], v[110:111] op_sel:[0,1] op_sel_hi:[1,0] neg_lo:[0,0] neg_hi:[0,1]
  ds_write_b64 v66, v[124:125] offset:0
  ds_write_b64 v67, v[122:123] offset:0
  ds_write_b64 v68, v[108:109] offset:0
  ds_write_b64 v69, v[112:113] offset:0
  s_cmp_eq_u32 s60, 1
  s_cbranch_scc1 L_nw2
  s_cmp_lt_i32 s28, 0
  s_cbranch_scc1 L_nw2
  v_mul_u32_u24 v96, 10240, v1
  s_lshl_b32 s56, s28, 5
  s_add_u32 s56, s56, 45088768
  buffer_load_dwordx4 v[72:75], v96, s[16:19], s56 offen
  buffer_load_dwordx4 v[76:79], v96, s[16:19], s56 offen offset:16
L_nw2:
  ds_read_b64 v[120:121], v54 offset:0
  ds_read_b64 v[104:105], v55 offset:0
  ds_read_b64 v[106:107], v56 offset:0
  ds_read_b64 v[114:115], v57 offset:0
  ds_read_b64 v[118:119], v58 offset:0
  ds_read_b64 v[102:103], v59 offset:0
  ds_read_b64 v[128:129], v60 offset:0
  ds_read_b64 v[126:127], v61 offset:0
  s_waitcnt lgkmcnt(0)
  v_pk_mul_f32 v[116:117], v[104:105], v[30:31] op_sel:[0,0] op_sel_hi:[1,0] neg_lo:[0,0] neg_hi:[0,0]
  v_pk_mul_f32 v[122:123], v[118:119], v[36:37] op_sel:[0,0] op_sel_hi:[1,0] neg_lo:[0,0] neg_hi:[0,0]
  v_pk_mul_f32 v[110:111], v[106:107], v[32:33] op_sel:[0,0] op_sel_hi:[1,0] neg_lo:[0,0] neg_hi:[0,0]
  v_pk_fma_f32 v[116:117], v[104:105], v[30:31], v[116:117] op_sel:[1,1,0] op_sel_hi:[0,1,1] neg_lo:[1,0,0] neg_hi:[0,0,0]
  v_pk_mul_f32 v[124:125], v[114:115], v[34:35] op_sel:[0,0] op_sel_hi:[1,0] neg_lo:[0,0] neg_hi:[0,0]
  v_pk_mul_f32 v[108:109], v[102:103], v[38:39] op_sel:[0,0] op_sel_hi:[1,0] neg_lo:[0,0] neg_hi:[0,0]
  v_pk_mul_f32 v[112:113], v[128:129], v[40:41] op_sel:[0,0] op_sel_hi:[1,0] neg_lo:[0,0] neg_hi:[0,0]
  v_pk_mul_f32 v[104:105], v[126:127], v[42:43] op_sel:[0,0] op_sel_hi:[1,0] neg_lo:[0,0] neg_hi:[0,0]
  v_pk_fma_f32 v[122:123], v[118:119], v[36:37], v[122:123] op_sel:[1,1,0] op_sel_hi:[0,1,1] neg_lo:[1,0,0] neg_hi:[0,0,0]
  v_pk_fma_f32 v[110:111], v[106:107], v[32:33], v[110:111] op_sel:[1,1,0] op_sel_hi:[0,1,1] neg_lo:[1,0,0] neg_hi:[0,0,0]
  v_pk_fma_f32 v[124:125], v[114:115], v[34:35], v[124:125] op_sel:[1,1,0] op_sel_hi:[0,1,1] neg_lo:[1,0,0] neg_hi:[0,0,0]
  v_pk_fma_f32 v[108:109], v[102:103], v[38:39], v[108:109] op_sel:[1,1,0] op_sel_hi:[0,1,1] neg_lo:[1,0,0] neg_hi:[0,0,0]
  v_pk_fma_f32 v[112:113], v[128:129], v[40:41], v[112:113] op_sel:[1,1,0] op_sel_hi:[0,1,1] neg_lo:[1,0,0] neg_hi:[0,0,0]
  v_pk_fma_f32 v[104:105], v[126:127], v[42:43], v[104:105] op_sel:[1,1,0] op_sel_hi:[0,1,1] neg_lo:[1,0,0] neg_hi:[0,0,0]
  v_pk_add_f32 v[106:107], v[120:121], v[122:123] op_sel:[0,0] op_sel_hi:[1,1] neg_lo:[0,0] neg_hi:[0,0]
  v_pk_add_f32 v[114:115], v[120:121], v[122:123] op_sel:[0,0] op_sel_hi:[1,1] neg_lo:[0,1] neg_hi:[0,1]
  v_pk_add_f32 v[118:119], v[116:117], v[108:109] op_sel:[0,0] op_sel_hi:[1,1] neg_lo:[0,0] neg_hi:[0,0]
  v_pk_add_f32 v[128:129], v[110:111], v[112:113] op_sel:[0,0] op_sel_hi:[1,1] neg_lo:[0,0] neg_hi:[0,0]
  v_pk_add_f32 v[120:121], v[124:125], v[104:105] op_sel:[0,0] op_sel_hi:[1,1] neg_lo:[0,0] neg_hi:[0,0]
  v_pk_add_f32 v[102:103], v[116:117], v[108:109] op_sel:[0,0] op_sel_hi:[1,1] neg_lo:[0,1] neg_hi:[0,1]
  v_pk_add_f32 v[122:123], v[124:125], v[104:105] op_sel:[0,0] op_sel_hi:[1,1] neg_lo:[0,1] neg_hi:[0,1]
  v_pk_add_f32 v[126:127], v[110:111], v[112:113] op_sel:[0,0] op_sel_hi:[1,1] neg_lo:[0,1] neg_hi:[0,1]
  v_pk_add_f32 v[110:111], v[106:107], v[128:129] op_sel:[0,0] op_sel_hi:[1,1] neg_lo:[0,0] neg_hi:[0,0]
  v_pk_add_f32 v[124:125], v[118:119], v[120:121] op_sel:[0,0] op_sel_hi:[1,1] neg_lo:[0,0] neg_hi:[0,0]
  v_pk_add_f32 v[116:117], v[102:103], v[102:103] op_sel:[0,1] op_sel_hi:[1,0] neg_lo:[0,1] neg_hi:[0,0]
  v_pk_add_f32 v[108:109], v[122:123], v[122:123] op_sel:[0,1] op_sel_hi:[1,0] neg_lo:[0,1] neg_hi:[0,0]
  v_pk_add_f32 v[112:113], v[106:107], v[128:129] op_sel:[0,0] op_sel_hi:[1,1] neg_lo:[0,1] neg_hi:[0,1]
  v_pk_add_f32 v[104:105], v[118:119], v[120:121] op_sel:[0,0] op_sel_hi:[1,1] neg_lo:[0,1] neg_hi:[0,1]
  v_pk_add_f32 v[102:103], v[110:111], v[124:125] op_sel:[0,0] op_sel_hi:[1,1] neg_lo:[0,0] neg_hi:[0,0]
  v_pk_add_f32 v[122:123], v[110:111], v[124:125] op_sel:[0,0] op_sel_hi:[1,1] neg_lo:[0,1] neg_hi:[0,1]
  v_pk_add_f32 v[118:119], v[114:115], v[126:127] op_sel:[0,1] op_sel_hi:[1,0] neg_lo:[0,1] neg_hi:[0,0]
  v_pk_add_f32 v[120:121], v[114:115], v[126:127] op_sel:[0,1] op_sel_hi:[1,0] neg_lo:[0,0] neg_hi:[0,1]
  v_pk_add_f32 v[110:111], v[116:117], v[108:109] op_sel:[0,1] op_sel_hi:[1,0] neg_lo:[0,1] neg_hi:[0,0]
  v_pk_add_f32 v[124:125], v[116:117], v[108:109] op_sel:[0,1] op_sel_hi:[1,0] neg_lo:[0,0] neg_hi:[0,1]
  v_pk_add_f32 v[106:107], v[112:113], v[104:105] op_sel:[0,1] op_sel_hi:[1,0] neg_lo:[0,1] neg_hi:[0,0]
  v_pk_add_f32 v[128:129], v[112:113], v[104:105] op_sel:[0,1] op_sel_hi:[1,0] neg_lo:[0,0] neg_hi:[0,1]
  v_pk_fma_f32 v[112:113], v[110:111], s[96:97], v[118:119] op_sel:[0,0,0] op_sel_hi:[1,1,1] neg_lo:[0,0,0] neg_hi:[0,0,0]
  v_pk_fma_f32 v[104:105], v[110:111], s[96:97], v[118:119] op_sel:[0,0,0] op_sel_hi:[1,1,1] neg_lo:[1,0,0] neg_hi:[1,0,0]
  v_pk_fma_f32 v[114:115], v[124:125], s[96:97], v[120:121] op_sel:[1,0,0] op_sel_hi:[0,1,1] neg_lo:[1,0,0] neg_hi:[0,0,0]
  v_pk_fma_f32 v[126:127], v[124:125], s[96:97], v[120:121] op_sel:[1,0,0] op_sel_hi:[0,1,1] neg_lo:[0,0,0] neg_hi:[1,0,0]
  ds_write_b64 v54, v[102:103] offset:0
  ds_write_b64 v55, v[112:113] offset:0
  ds_write_b64 v56, v[106:107] offset:0
  ds_write_b64 v57, v[114:115] offset:0
  ds_write_b64 v58, v[122:123] offset:0
  ds_write_b64 v59, v[104:105] offset:0
  ds_write_b64 v60, v[128:129] offset:0
  ds_write_b64 v61, v[126:127] offset:0
  ds_read_b64 v[116:117], v46 offset:0
  ds_read_b64 v[108:109], v47 offset:256
  ds_read_b64 v[118:119], v48 offset:512
  ds_read_b64 v[110:111], v49 offset:768
  ds_read_b64 v[120:121], v50 offset:1024
  ds_read_b64 v[124:125], v51 offset:1280
  ds_read_b64 v[102:103], v52 offset:1536
  ds_read_b64 v[112:113], v53 offset:1792
  s_waitcnt lgkmcnt(0)
  v_pk_mul_f32 v[106:107], v[108:109], v[16:17] op_sel:[0,0] op_sel_hi:[1,0] neg_lo:[0,0] neg_hi:[0,0]
  v_pk_mul_f32 v[104:105], v[120:121], v[22:23] op_sel:[0,0] op_sel_hi:[1,0] neg_lo:[0,0] neg_hi:[0,0]
  v_pk_mul_f32 v[114:115], v[118:119], v[18:19] op_sel:[0,0] op_sel_hi:[1,0] neg_lo:[0,0] neg_hi:[0,0]
  v_pk_fma_f32 v[106:107], v[108:109], v[16:17], v[106:107] op_sel:[1,1,0] op_sel_hi:[0,1,1] neg_lo:[1,0,0] neg_hi:[0,0,0]
  v_pk_mul_f32 v[122:123], v[110:111], v[20:21] op_sel:[0,0] op_sel_hi:[1,0] neg_lo:[0,0] neg_hi:[0,0]
  v_pk_mul_f32 v[128:129], v[124:125], v[24:25] op_sel:[0,0] op_sel_hi:[1,0] neg_lo:[0,0] neg_hi:[0,0]
  v_pk_mul_f32 v[126:127], v[102:103], v[26:27] op_sel:[0,0] op_sel_hi:[1,0] neg_lo:[0,0] neg_hi:[0,0]
  v_pk_mul_f32 v[108:109], v[112:113], v[28:29] op_sel:[0,0] op_sel_hi:[1,0] neg_lo:[0,0] neg_hi:[0,0]
  v_pk_fma_f32 v[104:105], v[120:121], v[22:23], v[104:105] op_sel:[1,1,0] op_sel_hi:[0,1,1] neg_lo:[1,0,0] neg_hi:[0,0,0]
  v_pk_fma_f32 v[114:115], v[118:119], v[18:19], v[114:115] op_sel:[1,1,0] op_sel_hi:[0,1,1] neg_lo:[1,0,0] neg_hi:[0,0,0]
  v_pk_fma_f32 v[122:123], v[110:111], v[20:21], v[122:123] op_sel:[1,1,0] op_sel_hi:[0,1,1] neg_lo:[1,0,0] neg_hi:[0,0,0]
  v_pk_fma_f32 v[128:129], v[124:125], v[24:25], v[128:129] op_sel:[1,1,0] op_sel_hi:[0,1,1] neg_lo:[1,0,0] neg_hi:[0,0,0]
  v_pk_fma_f32 v[126:127], v[102:103], v[26:27], v[126:127] op_sel:[1,1,0] op_sel_hi:[0,1,1] neg_lo:[1,0,0] neg_hi:[0,0,0]
  v_pk_fma_f32 v[108:109], v[112:113], v[28:29], v[108:109] op_sel:[1,1,0] op_sel_hi:[0,1,1] neg_lo:[1,0,0] neg_hi:[0,0,0]
  v_pk_add_f32 v[118:119], v[116:117], v[104:105] op_sel:[0,0] op_sel_hi:[1,1] neg_lo:[0,0] neg_hi:[0,0]
  v_pk_add_f32 v[110:111], v[116:117], v[104:105] op_sel:[0,0] op_sel_hi:[1,1] neg_lo:[0,1] neg_hi:[0,1]
  v_pk_add_f32 v[120:121], v[106:107], v[128:129] op_sel:[0,0] op_sel_hi:[1,1] neg_lo:[0,0] neg_hi:[0,0]
  v_pk_add_f32 v[102:103], v[114:115], v[126:127] op_sel:[0,0] op_sel_hi:[1,1] neg_lo:[0,0] neg_hi:[0,0]
  v_pk_add_f32 v[116:117], v[122:123], v[108:109] op_sel:[0,0] op_sel_hi:[1,1] neg_lo:[0,0] neg_hi:[0,0]
  v_pk_add_f32 v[124:125], v[106:107], v[128:129] op_sel:[0,0] op_sel_hi:[1,1] neg_lo:[0,1] neg_hi:[0,1]
  v_pk_add_f32 v[104:105], v[122:123], v[108:109] op_sel:[0,0] op_sel_hi:[1,1] neg_lo:[0,1] neg_hi:[0,1]
  v_pk_add_f32 v[112:113], v[114:115], v[126:127] op_sel:[0,0] op_sel_hi:[1,1] neg_lo:[0,1] neg_hi:[0,1]
  v_pk_add_f32 v[114:115], v[118:119], v[102:103] op_sel:[0,0] op_sel_hi:[1,1] neg_lo:[0,0] neg_hi:[0,0]
  v_pk_add_f32 v[122:123], v[120:121], v[116:117] op_sel:[0,0] op_sel_hi:[1,1] neg_lo:[0,0] neg_hi:[0,0]
  v_pk_add_f32 v[106:107], v[124:125], v[124:125] op_sel:[0,1] op_sel_hi:[1,0] neg_lo:[0,1] neg_hi:[0,0]
  v_pk_add_f32 v[128:129], v[104:105], v[104:105] op_sel:[0,1] op_sel_hi:[1,0] neg_lo:[0,1] neg_hi:[0,0]
  v_pk_add_f32 v[126:127], v[118:119], v[102:103] op_sel:[0,0] op_sel_hi:[1,1] neg_lo:[0,1] neg_hi:[0,1]
  v_pk_add_f32 v[108:109], v[120:121], v[116:117] op_sel:[0,0] op_sel_hi:[1,1] neg_lo:[0,1] neg_hi:[0,1]
  v_pk_add_f32 v[124:125], v[114:115], v[122:123] op_sel:[0,0] op_sel_hi:[1,1] neg_lo:[0,0] neg_hi:[0,0]
  v_pk_add_f32 v[104:105], v[114:115], v[122:123] op_sel:[0,0] op_sel_hi:[1,1] neg_lo:[0,1] neg_hi:[0,1]
  v_pk_add_f32 v[120:121], v[110:111], v[112:113] op_sel:[0,1] op_sel_hi:[1,0] neg_lo:[0,1] neg_hi:[0,0]
  v_pk_add_f32 v[116:117], v[110:111], v[112:113] op_sel:[0,1] op_sel_hi:[1,0] neg_lo:[0,0] neg_hi:[0,1]
  v_pk_add_f32 v[114:115], v[106:107], v[128:129] op_sel:[0,1] op_sel_hi:[1,0] neg_lo:[0,1] neg_hi:[0,0]
  v_pk_add_f32 v[122:123], v[106:107], v[128:129] op_sel:[0,1] op_sel_hi:[1,0] neg_lo:[0,0] neg_hi:[0,1]
  v_pk_add_f32 v[118:119], v[126:127], v[108:109] op_sel:[0,1] op_sel_hi:[1,0] neg_lo:[0,1] neg_hi:[0,0]
  v_pk_add_f32 v[102:103], v[126:127], v[108:109] op_sel:[0,1] op_sel_hi:[1,0] neg_lo:[0,0] neg_hi:[0,1]
  v_pk_fma_f32 v[126:127], v[114:115], s[96:97], v[120:121] op_sel:[0,0,0] op_sel_hi:[1,1,1] neg_lo:[0,0,0] neg_hi:[0,0,0]
  v_pk_fma_f32 v[108:109], v[114:115], s[96:97], v[120:121] op_sel:[0,0,0] op_sel_hi:[1,1,1] neg_lo:[1,0,0] neg_hi:[1,0,0]
  v_pk_fma_f32 v[110:111], v[122:123], s[96:97], v[116:117] op_sel:[1,0,0] op_sel_hi:[0,1,1] neg_lo:[1,0,0] neg_hi:[0,0,0]
  v_pk_fma_f32 v[112:113], v[122:123], s[96:97], v[116:117] op_sel:[1,0,0] op_sel_hi:[0,1,1] neg_lo:[0,0,0] neg_hi:[1,0,0]
  ds_write_b64 v45, v[124:125] offset:0
  ds_write_b64 v45, v[126:127] offset:256
  ds_write_b64 v45, v[118:119] offset:512
  ds_write_b64 v45, v[110:111] offset:768
  ds_write_b64 v45, v[104:105] offset:1024
  ds_write_b64 v45, v[108:109] offset:1280
  ds_write_b64 v45, v[102:103] offset:1536
  ds_write_b64 v45, v[112:113] offset:1792
  s_waitcnt lgkmcnt(0)
  s_cmp_ge_u32 s30, 2
  s_cbranch_scc1 L_nlw
  s_cmp_eq_u32 s60, 1
  s_cbranch_scc1 L_nlw
  s_waitcnt vmcnt(2)
L_nlw:
  s_barrier
  ds_read_b64 v[106:107], v44 offset:0
  ds_read_b64 v[128:129], v44 offset:2048
  ds_read_b64 v[120:121], v44 offset:4096
  ds_read_b64 v[114:115], v44 offset:6144
  ds_read_b64 v[116:117], v44 offset:8192
  ds_read_b64 v[122:123], v44 offset:10240
  ds_read_b64 v[124:125], v44 offset:12288
  ds_read_b64 v[126:127], v44 offset:14336
  s_waitcnt lgkmcnt(0)
  v_pk_mul_f32 v[118:119], v[128:129], v[2:3] op_sel:[0,0] op_sel_hi:[1,0] neg_lo:[0,0] neg_hi:[0,0]
  v_pk_mul_f32 v[108:109], v[116:117], v[8:9] op_sel:[0,0] op_sel_hi:[1,0] neg_lo:[0,0] neg_hi:[0,0]
  v_pk_mul_f32 v[110:111], v[120:121], v[4:5] op_sel:[0,0] op_sel_hi:[1,0] neg_lo:[0,0] neg_hi:[0,0]
  v_pk_fma_f32 v[118:119], v[128:129], v[2:3], v[118:119] op_sel:[1,1,0] op_sel_hi:[0,1,1] neg_lo:[1,0,0] neg_hi:[0,0,0]
  v_pk_mul_f32 v[104:105], v[114:115], v[6:7] op_sel:[0,0] op_sel_hi:[1,0] neg_lo:[0,0] neg_hi:[0,0]
  v_pk_mul_f32 v[102:103], v[122:123], v[10:11] op_sel:[0,0] op_sel_hi:[1,0] neg_lo:[0,0] neg_hi:[0,0]
  v_pk_mul_f32 v[112:113], v[124:125], v[12:13] op_sel:[0,0] op_sel_hi:[1,0] neg_lo:[0,0] neg_hi:[0,0]
  v_pk_mul_f32 v[128:129], v[126:127], v[14:15] op_sel:[0,0] op_sel_hi:[1,0] neg_lo:[0,0] neg_hi:[0,0]
  v_pk_fma_f32 v[108:109], v[116:117], v[8:9], v[108:109] op_sel:[1,1,0] op_sel_hi:[0,1,1] neg_lo:[1,0,0] neg_hi:[0,0,0]
  v_pk_fma_f32 v[110:111], v[120:121], v[4:5], v[110:111] op_sel:[1,1,0] op_sel_hi:[0,1,1] neg_lo:[1,0,0] neg_hi:[0,0,0]
  v_pk_fma_f32 v[104:105], v[114:115], v[6:7], v[104:105] op_sel:[1,1,0] op_sel_hi:[0,1,1] neg_lo:[1,0,0] neg_hi:[0,0,0]
  v_pk_fma_f32 v[102:103], v[122:123], v[10:11], v[102:103] op_sel:[1,1,0] op_sel_hi:[0,1,1] neg_lo:[1,0,0] neg_hi:[0,0,0]
  v_pk_fma_f32 v[112:113], v[124:125], v[12:13], v[112:113] op_sel:[1,1,0] op_sel_hi:[0,1,1] neg_lo:[1,0,0] neg_hi:[0,0,0]
  v_pk_fma_f32 v[128:129], v[126:127], v[14:15], v[128:129] op_sel:[1,1,0] op_sel_hi:[0,1,1] neg_lo:[1,0,0] neg_hi:[0,0,0]
  v_pk_add_f32 v[120:121], v[106:107], v[108:109] op_sel:[0,0] op_sel_hi:[1,1] neg_lo:[0,0] neg_hi:[0,0]
  v_pk_add_f32 v[114:115], v[106:107], v[108:109] op_sel:[0,0] op_sel_hi:[1,1] neg_lo:[0,1] neg_hi:[0,1]
  v_pk_add_f32 v[116:117], v[118:119], v[102:103] op_sel:[0,0] op_sel_hi:[1,1] neg_lo:[0,0] neg_hi:[0,0]
  v_pk_add_f32 v[124:125], v[110:111], v[112:113] op_sel:[0,0] op_sel_hi:[1,1] neg_lo:[0,0] neg_hi:[0,0]
  v_pk_add_f32 v[106:107], v[104:105], v[128:129] op_sel:[0,0] op_sel_hi:[1,1] neg_lo:[0,0] neg_hi:[0,0]
  v_pk_add_f32 v[122:123], v[118:119], v[102:103] op_sel:[0,0] op_sel_hi:[1,1] neg_lo:[0,1] neg_hi:[0,1]
  v_pk_add_f32 v[108:109], v[104:105], v[128:129] op_sel:[0,0] op_sel_hi:[1,1] neg_lo:[0,1] neg_hi:[0,1]
  v_pk_add_f32 v[126:127], v[110:111], v[112:113] op_sel:[0,0] op_sel_hi:[1,1] neg_lo:[0,1] neg_hi:[0,1]
  v_pk_add_f32 v[110:111], v[120:121], v[124:125] op_sel:[0,0] op_sel_hi:[1,1] neg_lo:[0,0] neg_hi:[0,0]
  v_pk_add_f32 v[104:105], v[116:117], v[106:107] op_sel:[0,0] op_sel_hi:[1,1] neg_lo:[0,0] neg_hi:[0,0]
  v_pk_add_f32 v[118:119], v[122:123], v[122:123] op_sel:[0,1] op_sel_hi:[1,0] neg_lo:[0,1] neg_hi:[0,0]
  v_pk_add_f32 v[102:103], v[108:109], v[108:109] op_sel:[0,1] op_sel_hi:[1,0] neg_lo:[0,1] neg_hi:[0,0]
  v_pk_add_f32 v[112:113], v[120:121], v[124:125] op_sel:[0,0] op_sel_hi:[1,1] neg_lo:[0,1] neg_hi:[0,1]
  v_pk_add_f32 v[128:129], v[116:117], v[106:107] op_sel:[0,0] op_sel_hi:[1,1] neg_lo:[0,1] neg_hi:[0,1]
  v_pk_add_f32 v[122:123], v[110:111], v[104:105] op_sel:[0,0] op_sel_hi:[1,1] neg_lo:[0,0] neg_hi:[0,0]
  v_pk_add_f32 v[108:109], v[110:111], v[104:105] op_sel:[0,0] op_sel_hi:[1,1] neg_lo:[0,1] neg_hi:[0,1]
  v_pk_add_f32 v[116:117], v[114:115], v[126:127] op_sel:[0,1] op_sel_hi:[1,0] neg_lo:[0,1] neg_hi:[0,0]
  v_pk_add_f32 v[106:107], v[114:115], v[126:127] op_sel:[0,1] op_sel_hi:[1,0] neg_lo:[0,0] neg_hi:[0,1]
  v_pk_add_f32 v[110:111], v[118:119], v[102:103] op_sel:[0,1] op_sel_hi:[1,0] neg_lo:[0,1] neg_hi:[0,0]
  v_pk_add_f32 v[104:105], v[118:119], v[102:103] op_sel:[0,1] op_sel_hi:[1,0] neg_lo:[0,0] neg_hi:[0,1]
  v_pk_add_f32 v[120:121], v[112:113], v[128:129] op_sel:[0,1] op_sel_hi:[1,0] neg_lo:[0,1] neg_hi:[0,0]
  v_pk_add_f32 v[124:125], v[112:113], v[128:129] op_sel:[0,1] op_sel_hi:[1,0] neg_lo:[0,0] neg_hi:[0,1]
  v_pk_fma_f32 v[112:113], v[110:111], s[96:97], v[116:117] op_sel:[0,0,0] op_sel_hi:[1,1,1] neg_lo:[0,0,0] neg_hi:[0,0,0]
  v_pk_fma_f32 v[128:129], v[110:111], s[96:97], v[116:117] op_sel:[0,0,0] op_sel_hi:[1,1,1] neg_lo:[1,0,0] neg_hi:[1,0,0]
  v_pk_fma_f32 v[114:115], v[104:105], s[96:97], v[106:107] op_sel:[1,0,0] op_sel_hi:[0,1,1] neg_lo:[1,0,0] neg_hi:[0,0,0]
  v_pk_fma_f32 v[126:127], v[104:105], s[96:97], v[106:107] op_sel:[1,0,0] op_sel_hi:[0,1,1] neg_lo:[0,0,0] neg_hi:[1,0,0]
  v_cvt_pk_bf16_f32 v122, v122, v123
  v_cvt_pk_bf16_f32 v112, v112, v113
  v_cvt_pk_bf16_f32 v120, v120, v121
  v_cvt_pk_bf16_f32 v114, v114, v115
  v_cvt_pk_bf16_f32 v108, v108, v109
  v_cvt_pk_bf16_f32 v128, v128, v129
  v_cvt_pk_bf16_f32 v124, v124, v125
  v_cvt_pk_bf16_f32 v126, v126, v127
  s_lshl_b32 s56, s61, 6
  s_add_u32 s56, s56, 48234496
  buffer_store_dword v122, v71, s[16:19], s56 offen sc0 sc1
  s_add_u32 s56, s56, 295936
  buffer_store_dword v112, v71, s[16:19], s56 offen sc0 sc1
  s_add_u32 s56, s56, 295936
  buffer_store_dword v120, v71, s[16:19], s56 offen sc0 sc1
  s_add_u32 s56, s56, 295936
  buffer_store_dword v114, v71, s[16:19], s56 offen sc0 sc1
  s_add_u32 s56, s56, 295936
  buffer_store_dword v108, v71, s[16:19], s56 offen sc0 sc1
  s_add_u32 s56, s56, 295936
  buffer_store_dword v128, v71, s[16:19], s56 offen sc0 sc1
  s_add_u32 s56, s56, 295936
  buffer_store_dword v124, v71, s[16:19], s56 offen sc0 sc1
  s_add_u32 s56, s56, 295936
  buffer_store_dword v126, v71, s[16:19], s56 offen sc0 sc1
  s_cmp_eq_u32 s60, 1
  s_cbranch_scc1 L_fftd
  s_cmp_lt_i32 s28, 0
  s_cbranch_scc1 L_fftd
  s_mov_b32 s61, s28
  s_mov_b32 s60, 1
  v_mov_b32 v102, v248
  v_mov_b32 v104, v249
  v_mov_b32 v106, v250
  v_mov_b32 v108, v251
  v_mov_b32 v110, v252
  v_mov_b32 v112, v253
  v_mov_b32 v114, v254
  v_mov_b32 v116, v255
  s_barrier
  s_branch L_fft
L_fftd:
  s_cmp_ge_u32 s30, 2
  s_cbranch_scc1 L_wk2
  s_mov_b32 s45, 9
L_hl0:
  s_mov_b32 m0, s51
  s_add_u32 s51, s51, 3072
  buffer_load_dwordx4 v245, s[12:15], s52 offen offset:0 lds
  buffer_load_dwordx4 v246, s[12:15], s52 offen offset:1024 lds
  buffer_load_dwordx4 v247, s[12:15], s52 offen offset:2048 lds
  s_add_u32 s52, s52, 18432
  s_sub_u32 s48, s48, 1
  s_cmp_eq_u32 s48, 0
  s_cselect_b32 s52, s53, s52
  s_mov_b32 m0, s51
  s_add_u32 s51, s51, 3072
  buffer_load_dwordx4 v245, s[12:15], s52 offen offset:0 lds
  buffer_load_dwordx4 v246, s[12:15], s52 offen offset:1024 lds
  buffer_load_dwordx4 v247, s[12:15], s52 offen offset:2048 lds
  s_add_u32 s52, s52, 18432
  s_sub_u32 s48, s48, 1
  s_cmp_eq_u32 s48, 0
  s_cselect_b32 s52, s53, s52
  s_mov_b32 m0, s51
  s_add_u32 s51, s51, 3072
  buffer_load_dwordx4 v245, s[12:15], s52 offen offset:0 lds
  buffer_load_dwordx4 v246, s[12:15], s52 offen offset:1024 lds
  buffer_load_dwordx4 v247, s[12:15], s52 offen offset:2048 lds
  s_add_u32 s52, s52, 18432
  s_sub_u32 s48, s48, 1
  s_cmp_eq_u32 s48, 0
  s_cselect_b32 s52, s53, s52
  s_cmp_eq_u32 s51, s49
  s_cselect_b32 s51, s50, s51
  s_waitcnt vmcnt(9)
  s_barrier
  s_sub_u32 s45, s45, 1
  s_cmp_lg_u32 s45, 0
  s_cbranch_scc1 L_hl0
  s_mul_i32 s53, s26, 663552
  s_mul_i32 s47, s31, 4608
  s_add_u32 s53, s53, s47
  s_add_u32 s53, s53, 384
  s_mul_i32 s47, s27, 18432
  s_add_u32 s52, s53, s47
  s_sub_u32 s48, 36, s27
  s_mov_b32 s45, 12
L_hl1:
  s_mov_b32 m0, s51
  s_add_u32 s51, s51, 3072
  buffer_load_dwordx4 v245, s[12:15], s52 offen offset:0 lds
  buffer_load_dwordx4 v246, s[12:15], s52 offen offset:1024 lds
  buffer_load_dwordx4 v247, s[12:15], s52 offen offset:2048 lds
  s_add_u32 s52, s52, 18432
  s_sub_u32 s48, s48, 1
  s_cmp_eq_u32 s48, 0
  s_cselect_b32 s52, s53, s52
  s_mov_b32 m0, s51
  s_add_u32 s51, s51, 3072
  buffer_load_dwordx4 v245, s[12:15], s52 offen offset:0 lds
  buffer_load_dwordx4 v246, s[12:15], s52 offen offset:1024 lds
  buffer_load_dwordx4 v247, s[12:15], s52 offen offset:2048 lds
  s_add_u32 s52, s52, 18432
  s_sub_u32 s48, s48, 1
  s_cmp_eq_u32 s48, 0
  s_cselect_b32 s52, s53, s52
  s_mov_b32 m0, s51
  s_add_u32 s51, s51, 3072
  buffer_load_dwordx4 v245, s[12:15], s52 offen offset:0 lds
  buffer_load_dwordx4 v246, s[12:15], s52 offen offset:1024 lds
  buffer_load_dwordx4 v247, s[12:15], s52 offen offset:2048 lds
  s_add_u32 s52, s52, 18432
  s_sub_u32 s48, s48, 1
  s_cmp_eq_u32 s48, 0
  s_cselect_b32 s52, s53, s52
  s_cmp_eq_u32 s51, s49
  s_cselect_b32 s51, s50, s51
  s_waitcnt vmcnt(9)
  s_barrier
  s_sub_u32 s45, s45, 1
  s_cmp_lg_u32 s45, 0
  s_cbranch_scc1 L_hl1
  s_mul_i32 s53, s26, 663552
  s_mul_i32 s47, s31, 4608
  s_add_u32 s53, s53, s47
  s_add_u32 s53, s53, 768
  s_mul_i32 s47, s27, 18432
  s_add_u32 s52, s53, s47
  s_sub_u32 s48, 36, s27
  s_mov_b32 s45, 12
L_hl2:
  s_mov_b32 m0, s51
  s_add_u32 s51, s51, 3072
  buffer_load_dwordx4 v245, s[12:15], s52 offen offset:0 lds
  buffer_load_dwordx4 v246, s[12:15], s52 offen offset:1024 lds
  buffer_load_dwordx4 v247, s[12:15], s52 offen offset:2048 lds
  s_add_u32 s52, s52, 18432
  s_sub_u32 s48, s48, 1
  s_cmp_eq_u32 s48, 0
  s_cselect_b32 s52, s53, s52
  s_mov_b32 m0, s51
  s_add_u32 s51, s51, 3072
  buffer_load_dwordx4 v245, s[12:15], s52 offen offset:0 lds
  buffer_load_dwordx4 v246, s[12:15], s52 offen offset:1024 lds
  buffer_load_dwordx4 v247, s[12:15], s52 offen offset:2048 lds
  s_add_u32 s52, s52, 18432
  s_sub_u32 s48, s48, 1
  s_cmp_eq_u32 s48, 0
  s_cselect_b32 s52, s53, s52
  s_mov_b32 m0, s51
  s_add_u32 s51, s51, 3072
  buffer_load_dwordx4 v245, s[12:15], s52 offen offset:0 lds
  buffer_load_dwordx4 v246, s[12:15], s52 offen offset:1024 lds
  buffer_load_dwordx4 v247, s[12:15], s52 offen offset:2048 lds
  s_add_u32 s52, s52, 18432
  s_sub_u32 s48, s48, 1
  s_cmp_eq_u32 s48, 0
  s_cselect_b32 s52, s53, s52
  s_cmp_eq_u32 s51, s49
  s_cselect_b32 s51, s50, s51
  s_waitcnt vmcnt(9)
  s_barrier
  s_sub_u32 s45, s45, 1
  s_cmp_lg_u32 s45, 0
  s_cbranch_scc1 L_hl2
  s_waitcnt vmcnt(0)
  s_barrier
  s_barrier
  s_branch L_tail
L_wk2:
  s_waitcnt vmcnt(0)
  s_barrier
  s_barrier
  s_cmp_lg_u32 s30, 2
  s_cbranch_scc1 L_nb2
  s_lshl_b32 s55, s2, 2
  s_add_u32 s55, s55, 459776
  v_mov_b32 v2, 0
  v_mov_b32 v3, s29
  s_mov_b64 exec, 1
  buffer_store_dword v3, v2, s[16:19], s55 offen sc0 sc1
  s_mov_b64 exec, -1
L_nb2:
  s_and_b32 s56, s26, 1
  s_mul_i32 s56, s56, 72
  v_and_b32 v8, 15, v240
  v_add_u32 v8, s56, v8
  v_cvt_f32_u32 v8, v8
  v_lshrrev_b32 v9, 5, v240
  v_lshlrev_b32 v9, 4, v9
  v_add_u32 v9, s31, v9
  v_cvt_f32_u32 v9, v9
  v_bfe_u32 v10, v240, 4, 1
  v_cvt_f32_u32 v10, v10
  v_mul_f32 v10, 0.25, v10
  v_add_f32 v11, 48.0, v8
  v_mul_f32 v11, 0.001736111111111111, v11
  v_fma_f32 v12, v11, v9, v10
  v_mul_f32 v14, 32.0, v11
  v_cos_f32 v14, v14
  v_fmamk_f32 v16, v11, 0, v12
  v_fmamk_f32 v24, v11, 3254779904, v12
  v_fmamk_f32 v17, v11, 1073741824, v12
  v_fmamk_f32 v25, v11, 3253731328, v12
  s_barrier
  v_fmamk_f32 v18, v11, 1082130432, v12
  v_fmamk_f32 v26, v11, 3252682752, v12
  v_fmamk_f32 v19, v11, 1086324736, v12
  v_fmamk_f32 v27, v11, 3251634176, v12
  v_fmamk_f32 v20, v11, 1090519040, v12
  v_fmamk_f32 v28, v11, 3250585600, v12
  v_fmamk_f32 v21, v11, 1092616192, v12
  v_fmamk_f32 v29, v11, 3249537024, v12
  v_fmamk_f32 v22, v11, 1094713344, v12
  v_fmamk_f32 v30, v11, 3248488448, v12
  v_fmamk_f32 v23, v11, 1096810496, v12
  v_fmamk_f32 v31, v11, 3247439872, v12
  v_add_f32 v14, v14, v14
  v_cos_f32 v16, v16
  v_cos_f32 v17, v17
  v_cos_f32 v18, v18
  v_cos_f32 v19, v19
  v_cos_f32 v20, v20
  v_cos_f32 v21, v21
  v_cos_f32 v22, v22
  v_cos_f32 v23, v23
  v_cos_f32 v24, v24
  v_cos_f32 v25, v25
  s_barrier
  v_cos_f32 v26, v26
  v_cos_f32 v27, v27
  v_cos_f32 v28, v28
  v_cos_f32 v29, v29
  v_cos_f32 v30, v30
  v_cos_f32 v31, v31
  v_cmp_eq_f32 vcc, 0, v9
  v_mul_f32 v13, 0.5, v16
  s_nop 0
  v_cndmask_b32 v13, v16, v13, vcc
  v_cvt_pk_bf16_f32 v60, v13, v17
  v_cvt_pk_bf16_f32 v61, v18, v19
  v_cvt_pk_bf16_f32 v62, v20, v21
  v_cvt_pk_bf16_f32 v63, v22, v23
  v_fma_f32 v24, v14, v16, -v24
  v_fma_f32 v25, v14, v17, -v25
  v_fma_f32 v26, v14, v18, -v26
  v_fma_f32 v27, v14, v19, -v27
  v_fma_f32 v28, v14, v20, -v28
  v_fma_f32 v29, v14, v21, -v29
  v_fma_f32 v30, v14, v22, -v30
  v_fma_f32 v31, v14, v23, -v31
  v_cvt_pk_bf16_f32 v64, v24, v25
  v_cvt_pk_bf16_f32 v65, v26, v27
  v_cvt_pk_bf16_f32 v66, v28, v29
  v_cvt_pk_bf16_f32 v67, v30, v31
  s_barrier
  v_fma_f32 v16, v14, v24, -v16
  v_fma_f32 v17, v14, v25, -v17
  v_fma_f32 v18, v14, v26, -v18
  v_fma_f32 v19, v14, v27, -v19
  v_fma_f32 v20, v14, v28, -v20
  v_fma_f32 v21, v14, v29, -v21
  v_fma_f32 v22, v14, v30, -v22
  v_fma_f32 v23, v14, v31, -v23
  v_cvt_pk_bf16_f32 v68, v16, v17
  v_cvt_pk_bf16_f32 v69, v18, v19
  v_cvt_pk_bf16_f32 v70, v20, v21
  v_cvt_pk_bf16_f32 v71, v22, v23
  v_fma_f32 v24, v14, v16, -v24
  v_fma_f32 v25, v14, v17, -v25
  v_fma_f32 v26, v14, v18, -v26
  v_fma_f32 v27, v14, v19, -v27
  v_fma_f32 v28, v14, v20, -v28
  v_fma_f32 v29, v14, v21, -v29
  v_fma_f32 v30, v14, v22, -v30
  v_fma_f32 v31, v14, v23, -v31
  v_cvt_pk_bf16_f32 v72, v24, v25
  v_cvt_pk_bf16_f32 v73, v26, v27
  v_cvt_pk_bf16_f32 v74, v28, v29
  v_cvt_pk_bf16_f32 v75, v30, v31
  v_fma_f32 v16, v14, v24, -v16
  v_fma_f32 v17, v14, v25, -v17
  v_fma_f32 v18, v14, v26, -v18
  v_fma_f32 v19, v14, v27, -v19
  v_fma_f32 v20, v14, v28, -v20
  v_fma_f32 v21, v14, v29, -v21
  v_fma_f32 v22, v14, v30, -v22
  v_fma_f32 v23, v14, v31, -v23
  s_barrier
  v_cvt_pk_bf16_f32 v76, v16, v17
  v_cvt_pk_bf16_f32 v77, v18, v19
  v_cvt_pk_bf16_f32 v78, v20, v21
  v_cvt_pk_bf16_f32 v79, v22, v23
  v_fma_f32 v24, v14, v16, -v24
  v_fma_f32 v25, v14, v17, -v25
  v_fma_f32 v26, v14, v18, -v26
  v_fma_f32 v27, v14, v19, -v27
  v_fma_f32 v28, v14, v20, -v28
  v_fma_f32 v29, v14, v21, -v29
  v_fma_f32 v30, v14, v22, -v30
  v_fma_f32 v31, v14, v23, -v31
  v_cvt_pk_bf16_f32 v80, v24, v25
  v_cvt_pk_bf16_f32 v81, v26, v27
  v_cvt_pk_bf16_f32 v82, v28, v29
  v_cvt_pk_bf16_f32 v83, v30, v31
  v_fma_f32 v16, v14, v24, -v16
  v_fma_f32 v17, v14, v25, -v17
  v_fma_f32 v18, v14, v26, -v18
  v_fma_f32 v19, v14, v27, -v19
  v_fma_f32 v20, v14, v28, -v20
  v_fma_f32 v21, v14, v29, -v21
  v_fma_f32 v22, v14, v30, -v22
  v_fma_f32 v23, v14, v31, -v23
  v_cvt_pk_bf16_f32 v84, v16, v17
  v_cvt_pk_bf16_f32 v85, v18, v19
  v_cvt_pk_bf16_f32 v86, v20, v21
  v_cvt_pk_bf16_f32 v87, v22, v23
  v_fma_f32 v24, v14, v16, -v24
  v_fma_f32 v25, v14, v17, -v25
  v_fma_f32 v26, v14, v18, -v26
  v_fma_f32 v27, v14, v19, -v27
  s_barrier
  v_fma_f32 v28, v14, v20, -v28
  v_fma_f32 v29, v14, v21, -v29
  v_fma_f32 v30, v14, v22, -v30
  v_fma_f32 v31, v14, v23, -v31
  v_cvt_pk_bf16_f32 v88, v24, v25
  v_cvt_pk_bf16_f32 v89, v26, v27
  v_cvt_pk_bf16_f32 v90, v28, v29
  v_cvt_pk_bf16_f32 v91, v30, v31
  v_fma_f32 v16, v14, v24, -v16
  v_fma_f32 v17, v14, v25, -v17
  v_fma_f32 v18, v14, v26, -v18
  v_fma_f32 v19, v14, v27, -v19
  v_fma_f32 v20, v14, v28, -v20
  v_fma_f32 v21, v14, v29, -v21
  v_fma_f32 v22, v14, v30, -v22
  v_fma_f32 v23, v14, v31, -v23
  v_cvt_pk_bf16_f32 v92, v16, v17
  v_cvt_pk_bf16_f32 v93, v18, v19
  v_cvt_pk_bf16_f32 v94, v20, v21
  v_cvt_pk_bf16_f32 v95, v22, v23
  v_add_f32 v11, 64.0, v8
  v_mul_f32 v11, 0.001736111111111111, v11
  v_fma_f32 v12, v11, v9, v10
  v_mul_f32 v14, 32.0, v11
  v_cos_f32 v14, v14
  v_fmamk_f32 v16, v11, 0, v12
  v_fmamk_f32 v24, v11, 3254779904, v12
  v_fmamk_f32 v17, v11, 1073741824, v12
  v_fmamk_f32 v25, v11, 3253731328, v12
  v_fmamk_f32 v18, v11, 1082130432, v12
  v_fmamk_f32 v26, v11, 3252682752, v12
  s_barrier
  v_fmamk_f32 v19, v11, 1086324736, v12
  v_fmamk_f32 v27, v11, 3251634176, v12
  v_fmamk_f32 v20, v11, 1090519040, v12
  v_fmamk_f32 v28, v11, 3250585600, v12
  v_fmamk_f32 v21, v11, 1092616192, v12
  v_fmamk_f32 v29, v11, 3249537024, v12
  v_fmamk_f32 v22, v11, 1094713344, v12
  v_fmamk_f32 v30, v11, 3248488448, v12
  v_fmamk_f32 v23, v11, 1096810496, v12
  v_fmamk_f32 v31, v11, 3247439872, v12
  v_add_f32 v14, v14, v14
  v_cos_f32 v16, v16
  v_cos_f32 v17, v17
  v_cos_f32 v18, v18
  v_cos_f32 v19, v19
  v_cos_f32 v20, v20
  v_cos_f32 v21, v21
  v_cos_f32 v22, v22
  v_cos_f32 v23, v23
  v_cos_f32 v24, v24
  v_cos_f32 v25, v25
  v_cos_f32 v26, v26
  s_barrier
  v_cos_f32 v27, v27
  v_cos_f32 v28, v28
  v_cos_f32 v29, v29
  v_cos_f32 v30, v30
  v_cos_f32 v31, v31
  v_cmp_eq_f32 vcc, 0, v9
  v_mul_f32 v13, 0.5, v16
  s_nop 0
  v_cndmask_b32 v13, v16, v13, vcc
  v_cvt_pk_bf16_f32 v96, v13, v17
  v_cvt_pk_bf16_f32 v97, v18, v19
  v_cvt_pk_bf16_f32 v98, v20, v21
  v_cvt_pk_bf16_f32 v99, v22, v23
  v_fma_f32 v24, v14, v16, -v24
  v_fma_f32 v25, v14, v17, -v25
  v_fma_f32 v26, v14, v18, -v26
  v_fma_f32 v27, v14, v19, -v27
  v_fma_f32 v28, v14, v20, -v28
  v_fma_f32 v29, v14, v21, -v29
  v_fma_f32 v30, v14, v22, -v30
  v_fma_f32 v31, v14, v23, -v31
  v_cvt_pk_bf16_f32 v100, v24, v25
  v_cvt_pk_bf16_f32 v101, v26, v27
  v_cvt_pk_bf16_f32 v102, v28, v29
  v_cvt_pk_bf16_f32 v103, v30, v31
  v_fma_f32 v16, v14, v24, -v16
  v_fma_f32 v17, v14, v25, -v17
  s_barrier
  v_fma_f32 v18, v14, v26, -v18
  v_fma_f32 v19, v14, v27, -v19
  v_fma_f32 v20, v14, v28, -v20
  v_fma_f32 v21, v14, v29, -v21
  v_fma_f32 v22, v14, v30, -v22
  v_fma_f32 v23, v14, v31, -v23
  v_cvt_pk_bf16_f32 v104, v16, v17
  v_cvt_pk_bf16_f32 v105, v18, v19
  v_cvt_pk_bf16_f32 v106, v20, v21
  v_cvt_pk_bf16_f32 v107, v22, v23
  v_fma_f32 v24, v14, v16, -v24
  v_fma_f32 v25, v14, v17, -v25
  v_fma_f32 v26, v14, v18, -v26
  v_fma_f32 v27, v14, v19, -v27
  v_fma_f32 v28, v14, v20, -v28
  v_fma_f32 v29, v14, v21, -v29
  v_fma_f32 v30, v14, v22, -v30
  v_fma_f32 v31, v14, v23, -v31
  v_cvt_pk_bf16_f32 v108, v24, v25
  v_cvt_pk_bf16_f32 v109, v26, v27
  v_cvt_pk_bf16_f32 v110, v28, v29
  v_cvt_pk_bf16_f32 v111, v30, v31
  v_fma_f32 v16, v14, v24, -v16
  v_fma_f32 v17, v14, v25, -v17
  v_fma_f32 v18, v14, v26, -v18
  v_fma_f32 v19, v14, v27, -v19
  v_fma_f32 v20, v14, v28, -v20
  v_fma_f32 v21, v14, v29, -v21
  v_fma_f32 v22, v14, v30, -v22
  v_fma_f32 v23, v14, v31, -v23
  v_cvt_pk_bf16_f32 v112, v16, v17
  v_cvt_pk_bf16_f32 v113, v18, v19
  s_barrier
  v_cvt_pk_bf16_f32 v114, v20, v21
  v_cvt_pk_bf16_f32 v115, v22, v23
  v_fma_f32 v24, v14, v16, -v24
  v_fma_f32 v25, v14, v17, -v25
  v_fma_f32 v26, v14, v18, -v26
  v_fma_f32 v27, v14, v19, -v27
  v_fma_f32 v28, v14, v20, -v28
  v_fma_f32 v29, v14, v21, -v29
  v_fma_f32 v30, v14, v22, -v30
  v_fma_f32 v31, v14, v23, -v31
  v_cvt_pk_bf16_f32 v116, v24, v25
  v_cvt_pk_bf16_f32 v117, v26, v27
  v_cvt_pk_bf16_f32 v118, v28, v29
  v_cvt_pk_bf16_f32 v119, v30, v31
  v_fma_f32 v16, v14, v24, -v16
  v_fma_f32 v17, v14, v25, -v17
  v_fma_f32 v18, v14, v26, -v18
  v_fma_f32 v19, v14, v27, -v19
  v_fma_f32 v20, v14, v28, -v20
  v_fma_f32 v21, v14, v29, -v21
  v_fma_f32 v22, v14, v30, -v22
  v_fma_f32 v23, v14, v31, -v23
  v_cvt_pk_bf16_f32 v120, v16, v17
  v_cvt_pk_bf16_f32 v121, v18, v19
  v_cvt_pk_bf16_f32 v122, v20, v21
  v_cvt_pk_bf16_f32 v123, v22, v23
  v_fma_f32 v24, v14, v16, -v24
  v_fma_f32 v25, v14, v17, -v25
  v_fma_f32 v26, v14, v18, -v26
  v_fma_f32 v27, v14, v19, -v27
  v_fma_f32 v28, v14, v20, -v28
  v_fma_f32 v29, v14, v21, -v29
  s_barrier
  v_fma_f32 v30, v14, v22, -v30
  v_fma_f32 v31, v14, v23, -v31
  v_cvt_pk_bf16_f32 v124, v24, v25
  v_cvt_pk_bf16_f32 v125, v26, v27
  v_cvt_pk_bf16_f32 v126, v28, v29
  v_cvt_pk_bf16_f32 v127, v30, v31
  v_fma_f32 v16, v14, v24, -v16
  v_fma_f32 v17, v14, v25, -v17
  v_fma_f32 v18, v14, v26, -v18
  v_fma_f32 v19, v14, v27, -v19
  v_fma_f32 v20, v14, v28, -v20
  v_fma_f32 v21, v14, v29, -v21
  v_fma_f32 v22, v14, v30, -v22
  v_fma_f32 v23, v14, v31, -v23
  v_cvt_pk_bf16_f32 v128, v16, v17
  v_cvt_pk_bf16_f32 v129, v18, v19
  v_cvt_pk_bf16_f32 v130, v20, v21
  v_cvt_pk_bf16_f32 v131, v22, v23
  s_barrier
  s_barrier
  s_barrier
  s_barrier
  s_barrier
  s_barrier
  s_barrier
  v_lshlrev_b32 v2, 4, v240
  s_mov_b32 s55, 0
  s_mov_b32 s56, 459776
L_poll2:
  buffer_load_dwordx4 v[4:7], v2, s[16:19], s56 offen sc0 sc1
  s_waitcnt vmcnt(0)
  v_xor_b32 v4, s29, v4
  v_xor_b32 v5, s29, v5
  v_xor_b32 v6, s29, v6
  v_xor_b32 v7, s29, v7
  v_or_b32 v4, v4, v5
  v_or3_b32 v4, v4, v6, v7
  v_cmp_ne_u32 vcc, 0, v4
  s_add_u32 s55, s55, 1
  s_cmp_gt_u32 s55, 100000
  s_cbranch_scc1 L_poll2_ok
  s_cmp_eq_u64 vcc, 0
  s_cbranch_scc1 L_poll2_ok
  s_sleep 4
  s_branch L_poll2
L_poll2_ok:
  s_lshl_b32 s40, s25, 2
  s_lshr_b32 s41, s26, 1
  s_add_u32 s40, s40, s41
  s_mul_i32 s40, s40, 18496
  s_add_u32 s40, s40, 48234496
  s_lshl_b32 s41, s31, 6
  s_add_u32 s40, s40, s41
  v_lshrrev_b32 v2, 2, v240
  v_lshlrev_b32 v2, 7, v2
  v_and_b32 v3, 3, v240
  v_lshl_add_u32 v2, v3, 4, v2
  s_lshl_b32 s42, s31, 13
  s_add_u32 s42, s42, 147456
  s_add_u32 m0, s42, 0
  s_add_u32 s41, s40, 0
  buffer_load_dwordx4 v2, s[16:19], s41 offen lds
  s_add_u32 m0, s42, 1024
  s_add_u32 s41, s40, 2048
  buffer_load_dwordx4 v2, s[16:19], s41 offen lds
  s_add_u32 m0, s42, 2048
  s_add_u32 s41, s40, 4096
  buffer_load_dwordx4 v2, s[16:19], s41 offen lds
  s_add_u32 m0, s42, 3072
  s_add_u32 s41, s40, 6144
  buffer_load_dwordx4 v2, s[16:19], s41 offen lds
  s_add_u32 m0, s42, 4096
  s_add_u32 s41, s40, 8192
  buffer_load_dwordx4 v2, s[16:19], s41 offen lds
  s_add_u32 m0, s42, 5120
  s_add_u32 s41, s40, 10240
  buffer_load_dwordx4 v2, s[16:19], s41 offen lds
  s_add_u32 m0, s42, 6144
  s_add_u32 s41, s40, 12288
  buffer_load_dwordx4 v2, s[16:19], s41 offen lds
  s_add_u32 m0, s42, 7168
  s_add_u32 s41, s40, 14336
  buffer_load_dwordx4 v2, s[16:19], s41 offen lds
  v_lshrrev_b32 v3, 5, v240
  v_lshlrev_b32 v3, 10, v3
  v_and_b32 v4, 31, v240
  v_lshl_add_u32 v3, v4, 1, v3
  s_add_u32 s41, s40, 16384
  buffer_load_ushort v8, v3, s[16:19], s41 offen offset:0
  buffer_load_ushort v9, v3, s[16:19], s41 offen offset:128
  buffer_load_ushort v10, v3, s[16:19], s41 offen offset:256
  buffer_load_ushort v11, v3, s[16:19], s41 offen offset:384
  buffer_load_ushort v12, v3, s[16:19], s41 offen offset:512
  buffer_load_ushort v13, v3, s[16:19], s41 offen offset:640
  buffer_load_ushort v14, v3, s[16:19], s41 offen offset:768
  buffer_load_ushort v15, v3, s[16:19], s41 offen offset:896
  s_barrier
  v_lshrrev_b32 v2, 5, v240
  v_lshlrev_b32 v2, 3, v2
  v_bfe_u32 v3, v240, 2, 2
  v_add_u32 v2, v2, v3
  v_lshlrev_b32 v2, 6, v2
  v_bfe_u32 v3, v240, 4, 1
  v_lshlrev_b32 v3, 5, v3
  v_and_b32 v4, 3, v240
  v_lshlrev_b32 v4, 3, v4
  v_add3_u32 v2, v2, v3, v4
  v_add_u32 v2, s42, v2
  s_barrier
  s_barrier
  s_waitcnt vmcnt(0)
  ds_read_b64_tr_b16 v[24:25], v2 offset:0
  ds_read_b64_tr_b16 v[26:27], v2 offset:256
  ds_read_b64_tr_b16 v[28:29], v2 offset:1024
  ds_read_b64_tr_b16 v[30:31], v2 offset:1280
  ds_read_b64_tr_b16 v[32:33], v2 offset:2048
  ds_read_b64_tr_b16 v[34:35], v2 offset:2304
  ds_read_b64_tr_b16 v[36:37], v2 offset:3072
  ds_read_b64_tr_b16 v[38:39], v2 offset:3328
  ds_read_b64_tr_b16 v[40:41], v2 offset:4096
  ds_read_b64_tr_b16 v[42:43], v2 offset:4352
  s_waitcnt lgkmcnt(0)
  ds_read_b64_tr_b16 v[44:45], v2 offset:5120
  ds_read_b64_tr_b16 v[46:47], v2 offset:5376
  ds_read_b64_tr_b16 v[48:49], v2 offset:6144
  ds_read_b64_tr_b16 v[50:51], v2 offset:6400
  ds_read_b64_tr_b16 v[52:53], v2 offset:7168
  ds_read_b64_tr_b16 v[54:55], v2 offset:7424
  v_lshl_or_b32 v56, v9, 16, v8
  v_lshl_or_b32 v57, v11, 16, v10
  v_lshl_or_b32 v58, v13, 16, v12
  v_lshl_or_b32 v59, v15, 16, v14
  v_and_b32 v2, 1, v240
  v_cmp_eq_u32 s[58:59], 0, v2
  v_mov_b32 v3, -1.0
  v_mov_b32 v4, 1.0
  v_cndmask_b32 v3, v3, v4, s[58:59]
  s_waitcnt lgkmcnt(0)
  v_mfma_f32_32x32x16_bf16 v[8:23], v[132:135], v[24:27], 0
  v_mfma_f32_32x32x16_bf16 v[8:23], v[136:139], v[28:31], v[8:23]
  v_mfma_f32_32x32x16_bf16 v[8:23], v[140:143], v[32:35], v[8:23]
  s_barrier
  v_mfma_f32_32x32x16_bf16 v[8:23], v[144:147], v[36:39], v[8:23]
  v_mfma_f32_32x32x16_bf16 v[8:23], v[148:151], v[40:43], v[8:23]
  v_mfma_f32_32x32x16_bf16 v[8:23], v[152:155], v[44:47], v[8:23]
  v_mfma_f32_32x32x16_bf16 v[8:23], v[156:159], v[48:51], v[8:23]
  v_mfma_f32_32x32x16_bf16 v[8:23], v[160:163], v[52:55], v[8:23]
  v_mfma_f32_32x32x16_bf16 v[8:23], v[164:167], v[56:59], v[8:23]
  s_barrier
  v_mfma_f32_32x32x16_bf16 v[132:147], v[168:171], v[24:27], 0
  v_mfma_f32_32x32x16_bf16 v[132:147], v[172:175], v[28:31], v[132:147]
  v_mfma_f32_32x32x16_bf16 v[132:147], v[176:179], v[32:35], v[132:147]
  v_mfma_f32_32x32x16_bf16 v[132:147], v[180:183], v[36:39], v[132:147]
  v_mfma_f32_32x32x16_bf16 v[132:147], v[184:187], v[40:43], v[132:147]
  v_mfma_f32_32x32x16_bf16 v[132:147], v[188:191], v[44:47], v[132:147]
  s_barrier
  v_mfma_f32_32x32x16_bf16 v[132:147], v[192:195], v[48:51], v[132:147]
  v_mfma_f32_32x32x16_bf16 v[132:147], v[196:199], v[52:55], v[132:147]
  v_mfma_f32_32x32x16_bf16 v[132:147], v[200:203], v[56:59], v[132:147]
  s_nop 2
  v_cndmask_b32 v8, v16, v8, s[58:59]
  v_cndmask_b32 v9, v17, v9, s[58:59]
  v_cndmask_b32 v10, v18, v10, s[58:59]
  v_cndmask_b32 v11, v19, v11, s[58:59]
  v_cndmask_b32 v12, v20, v12, s[58:59]
  v_cndmask_b32 v13, v21, v13, s[58:59]
  v_cndmask_b32 v14, v22, v14, s[58:59]
  v_cndmask_b32 v15, v23, v15, s[58:59]
  v_mul_f32 v148, v3, v8
  v_mul_f32 v149, v3, v9
  v_mul_f32 v150, v3, v10
  v_mul_f32 v151, v3, v11
  v_mul_f32 v152, v3, v12
  v_mul_f32 v153, v3, v13
  v_mul_f32 v154, v3, v14
  v_mul_f32 v155, v3, v15
  v_add_f32_dpp v148, v8, v148 quad_perm:[1,0,3,2] row_mask:0xf bank_mask:0xf
  v_add_f32_dpp v149, v9, v149 quad_perm:[1,0,3,2] row_mask:0xf bank_mask:0xf
  v_add_f32_dpp v150, v10, v150 quad_perm:[1,0,3,2] row_mask:0xf bank_mask:0xf
  v_add_f32_dpp v151, v11, v151 quad_perm:[1,0,3,2] row_mask:0xf bank_mask:0xf
  v_add_f32_dpp v152, v12, v152 quad_perm:[1,0,3,2] row_mask:0xf bank_mask:0xf
  v_add_f32_dpp v153, v13, v153 quad_perm:[1,0,3,2] row_mask:0xf bank_mask:0xf
  v_add_f32_dpp v154, v14, v154 quad_perm:[1,0,3,2] row_mask:0xf bank_mask:0xf
  s_barrier
  v_add_f32_dpp v155, v15, v155 quad_perm:[1,0,3,2] row_mask:0xf bank_mask:0xf
  v_mfma_f32_32x32x16_bf16 v[168:183], v[204:207], v[24:27], 0
  v_mfma_f32_32x32x16_bf16 v[168:183], v[208:211], v[28:31], v[168:183]
  v_mfma_f32_32x32x16_bf16 v[168:183], v[212:215], v[32:35], v[168:183]
  v_mfma_f32_32x32x16_bf16 v[168:183], v[216:219], v[36:39], v[168:183]
  v_mfma_f32_32x32x16_bf16 v[168:183], v[220:223], v[40:43], v[168:183]
  v_mfma_f32_32x32x16_bf16 v[168:183], v[224:227], v[44:47], v[168:183]
  s_barrier
  v_mfma_f32_32x32x16_bf16 v[168:183], v[228:231], v[48:51], v[168:183]
  v_mfma_f32_32x32x16_bf16 v[168:183], v[232:235], v[52:55], v[168:183]
  v_mfma_f32_32x32x16_bf16 v[168:183], v[236:239], v[56:59], v[168:183]
  s_nop 2
  v_cndmask_b32 v132, v140, v132, s[58:59]
  v_cndmask_b32 v133, v141, v133, s[58:59]
  v_cndmask_b32 v134, v142, v134, s[58:59]
  v_cndmask_b32 v135, v143, v135, s[58:59]
  v_cndmask_b32 v136, v144, v136, s[58:59]
  v_cndmask_b32 v137, v145, v137, s[58:59]
  v_cndmask_b32 v138, v146, v138, s[58:59]
  v_cndmask_b32 v139, v147, v139, s[58:59]
  v_mul_f32 v184, v3, v132
  v_mul_f32 v185, v3, v133
  v_mul_f32 v186, v3, v134
  v_mul_f32 v187, v3, v135
  v_mul_f32 v188, v3, v136
  v_mul_f32 v189, v3, v137
  v_mul_f32 v190, v3, v138
  v_mul_f32 v191, v3, v139
  v_add_f32_dpp v184, v132, v184 quad_perm:[1,0,3,2] row_mask:0xf bank_mask:0xf
  v_add_f32_dpp v185, v133, v185 quad_perm:[1,0,3,2] row_mask:0xf bank_mask:0xf
  v_add_f32_dpp v186, v134, v186 quad_perm:[1,0,3,2] row_mask:0xf bank_mask:0xf
  v_add_f32_dpp v187, v135, v187 quad_perm:[1,0,3,2] row_mask:0xf bank_mask:0xf
  v_add_f32_dpp v188, v136, v188 quad_perm:[1,0,3,2] row_mask:0xf bank_mask:0xf
  v_add_f32_dpp v189, v137, v189 quad_perm:[1,0,3,2] row_mask:0xf bank_mask:0xf
  v_add_f32_dpp v190, v138, v190 quad_perm:[1,0,3,2] row_mask:0xf bank_mask:0xf
  s_barrier
  v_add_f32_dpp v191, v139, v191 quad_perm:[1,0,3,2] row_mask:0xf bank_mask:0xf
  v_mfma_f32_32x32x16_bf16 v[204:219], v[60:63], v[24:27], 0
  v_mfma_f32_32x32x16_bf16 v[204:219], v[64:67], v[28:31], v[204:219]
  v_mfma_f32_32x32x16_bf16 v[204:219], v[68:71], v[32:35], v[204:219]
  v_mfma_f32_32x32x16_bf16 v[204:219], v[72:75], v[36:39], v[204:219]
  v_mfma_f32_32x32x16_bf16 v[204:219], v[76:79], v[40:43], v[204:219]
  v_mfma_f32_32x32x16_bf16 v[204:219], v[80:83], v[44:47], v[204:219]
  s_barrier
  v_mfma_f32_32x32x16_bf16 v[204:219], v[84:87], v[48:51], v[204:219]
  v_mfma_f32_32x32x16_bf16 v[204:219], v[88:91], v[52:55], v[204:219]
  v_mfma_f32_32x32x16_bf16 v[204:219], v[92:95], v[56:59], v[204:219]
  s_nop 2
  v_cndmask_b32 v168, v176, v168, s[58:59]
  v_cndmask_b32 v169, v177, v169, s[58:59]
  v_cndmask_b32 v170, v178, v170, s[58:59]
  v_cndmask_b32 v171, v179, v171, s[58:59]
  v_cndmask_b32 v172, v180, v172, s[58:59]
  v_cndmask_b32 v173, v181, v173, s[58:59]
  v_cndmask_b32 v174, v182, v174, s[58:59]
  v_cndmask_b32 v175, v183, v175, s[58:59]
  v_mul_f32 v220, v3, v168
  v_mul_f32 v221, v3, v169
  v_mul_f32 v222, v3, v170
  v_mul_f32 v223, v3, v171
  v_mul_f32 v224, v3, v172
  v_mul_f32 v225, v3, v173
  v_mul_f32 v226, v3, v174
  v_mul_f32 v227, v3, v175
  v_add_f32_dpp v220, v168, v220 quad_perm:[1,0,3,2] row_mask:0xf bank_mask:0xf
  v_add_f32_dpp v221, v169, v221 quad_perm:[1,0,3,2] row_mask:0xf bank_mask:0xf
  v_add_f32_dpp v222, v170, v222 quad_perm:[1,0,3,2] row_mask:0xf bank_mask:0xf
  v_add_f32_dpp v223, v171, v223 quad_perm:[1,0,3,2] row_mask:0xf bank_mask:0xf
  v_add_f32_dpp v224, v172, v224 quad_perm:[1,0,3,2] row_mask:0xf bank_mask:0xf
  v_add_f32_dpp v225, v173, v225 quad_perm:[1,0,3,2] row_mask:0xf bank_mask:0xf
  v_add_f32_dpp v226, v174, v226 quad_perm:[1,0,3,2] row_mask:0xf bank_mask:0xf
  s_barrier
  v_add_f32_dpp v227, v175, v227 quad_perm:[1,0,3,2] row_mask:0xf bank_mask:0xf
  v_mfma_f32_32x32x16_bf16 v[60:75], v[96:99], v[24:27], 0
  v_mfma_f32_32x32x16_bf16 v[60:75], v[100:103], v[28:31], v[60:75]
  v_mfma_f32_32x32x16_bf16 v[60:75], v[104:107], v[32:35], v[60:75]
  v_mfma_f32_32x32x16_bf16 v[60:75], v[108:111], v[36:39], v[60:75]
  v_mfma_f32_32x32x16_bf16 v[60:75], v[112:115], v[40:43], v[60:75]
  v_mfma_f32_32x32x16_bf16 v[60:75], v[116:119], v[44:47], v[60:75]
  s_barrier
  v_mfma_f32_32x32x16_bf16 v[60:75], v[120:123], v[48:51], v[60:75]
  v_mfma_f32_32x32x16_bf16 v[60:75], v[124:127], v[52:55], v[60:75]
  v_mfma_f32_32x32x16_bf16 v[60:75], v[128:131], v[56:59], v[60:75]
  s_nop 2
  v_cndmask_b32 v204, v212, v204, s[58:59]
  v_cndmask_b32 v205, v213, v205, s[58:59]
  v_cndmask_b32 v206, v214, v206, s[58:59]
  v_cndmask_b32 v207, v215, v207, s[58:59]
  v_cndmask_b32 v208, v216, v208, s[58:59]
  v_cndmask_b32 v209, v217, v209, s[58:59]
  v_cndmask_b32 v210, v218, v210, s[58:59]
  v_cndmask_b32 v211, v219, v211, s[58:59]
  v_mul_f32 v76, v3, v204
  v_mul_f32 v77, v3, v205
  v_mul_f32 v78, v3, v206
  v_mul_f32 v79, v3, v207
  v_mul_f32 v80, v3, v208
  v_mul_f32 v81, v3, v209
  v_mul_f32 v82, v3, v210
  v_mul_f32 v83, v3, v211
  v_add_f32_dpp v76, v204, v76 quad_perm:[1,0,3,2] row_mask:0xf bank_mask:0xf
  v_add_f32_dpp v77, v205, v77 quad_perm:[1,0,3,2] row_mask:0xf bank_mask:0xf
  v_add_f32_dpp v78, v206, v78 quad_perm:[1,0,3,2] row_mask:0xf bank_mask:0xf
  v_add_f32_dpp v79, v207, v79 quad_perm:[1,0,3,2] row_mask:0xf bank_mask:0xf
  v_add_f32_dpp v80, v208, v80 quad_perm:[1,0,3,2] row_mask:0xf bank_mask:0xf
  v_add_f32_dpp v81, v209, v81 quad_perm:[1,0,3,2] row_mask:0xf bank_mask:0xf
  v_add_f32_dpp v82, v210, v82 quad_perm:[1,0,3,2] row_mask:0xf bank_mask:0xf
  s_barrier
  v_add_f32_dpp v83, v211, v83 quad_perm:[1,0,3,2] row_mask:0xf bank_mask:0xf
  v_bfe_u32 v4, v240, 1, 4
  v_mul_u32_u24 v4, 416, v4
  v_mul_u32_u24 v5, 9216, v2
  s_mul_i32 s56, s31, 36864
  v_add3_u32 v4, v4, v5, s56
  v_add_u32 v4, 9216, v4
  v_lshrrev_b32 v5, 5, v240
  v_lshlrev_b32 v5, 4, v5
  v_sub_u32 v6, 0x180, v5
  v_cndmask_b32 v5, v6, v5, s[58:59]
  v_add_u32 v4, v4, v5
  v_mov_b32 v5, -4
  v_mov_b32 v6, 4
  v_cndmask_b32 v5, v5, v6, s[58:59]
  v_cndmask_b32 v60, v68, v60, s[58:59]
  v_cndmask_b32 v61, v69, v61, s[58:59]
  v_cndmask_b32 v62, v70, v62, s[58:59]
  v_cndmask_b32 v63, v71, v63, s[58:59]
  v_cndmask_b32 v64, v72, v64, s[58:59]
  v_cndmask_b32 v65, v73, v65, s[58:59]
  v_cndmask_b32 v66, v74, v66, s[58:59]
  v_cndmask_b32 v67, v75, v67, s[58:59]
  v_mul_f32 v112, v3, v60
  v_mul_f32 v113, v3, v61
  v_mul_f32 v114, v3, v62
  v_mul_f32 v115, v3, v63
  v_mul_f32 v116, v3, v64
  v_mul_f32 v117, v3, v65
  v_mul_f32 v118, v3, v66
  v_mul_f32 v119, v3, v67
  v_add_f32_dpp v112, v60, v112 quad_perm:[1,0,3,2] row_mask:0xf bank_mask:0xf
  v_add_f32_dpp v113, v61, v113 quad_perm:[1,0,3,2] row_mask:0xf bank_mask:0xf
  v_add_f32_dpp v114, v62, v114 quad_perm:[1,0,3,2] row_mask:0xf bank_mask:0xf
  v_add_f32_dpp v115, v63, v115 quad_perm:[1,0,3,2] row_mask:0xf bank_mask:0xf
  v_add_f32_dpp v116, v64, v116 quad_perm:[1,0,3,2] row_mask:0xf bank_mask:0xf
  v_add_f32_dpp v117, v65, v117 quad_perm:[1,0,3,2] row_mask:0xf bank_mask:0xf
  v_add_f32_dpp v118, v66, v118 quad_perm:[1,0,3,2] row_mask:0xf bank_mask:0xf
  v_add_f32_dpp v119, v67, v119 quad_perm:[1,0,3,2] row_mask:0xf bank_mask:0xf
  v_mad_i32_i24 v156, v5, 0, v4
  v_mad_i32_i24 v157, v5, 1, v4
  v_mad_i32_i24 v158, v5, 2, v4
  v_mad_i32_i24 v159, v5, 3, v4
  v_mad_i32_i24 v160, v5, 8, v4
  v_mad_i32_i24 v161, v5, 9, v4
  v_mad_i32_i24 v162, v5, 10, v4
  v_mad_i32_i24 v163, v5, 11, v4
  v_lshl_add_u32 v4, v5, 4, v4
  s_barrier
  v_mad_i32_i24 v192, v5, 0, v4
  v_mad_i32_i24 v193, v5, 1, v4
  v_mad_i32_i24 v194, v5, 2, v4
  v_mad_i32_i24 v195, v5, 3, v4
  v_mad_i32_i24 v196, v5, 8, v4
  v_mad_i32_i24 v197, v5, 9, v4
  v_mad_i32_i24 v198, v5, 10, v4
  v_mad_i32_i24 v199, v5, 11, v4
  v_lshl_add_u32 v4, v5, 4, v4
  v_mad_i32_i24 v228, v5, 0, v4
  v_mad_i32_i24 v229, v5, 1, v4
  v_mad_i32_i24 v230, v5, 2, v4
  v_mad_i32_i24 v231, v5, 3, v4
  v_mad_i32_i24 v232, v5, 8, v4
  v_mad_i32_i24 v233, v5, 9, v4
  v_mad_i32_i24 v234, v5, 10, v4
  v_mad_i32_i24 v235, v5, 11, v4
  v_lshl_add_u32 v4, v5, 4, v4
  v_mad_i32_i24 v84, v5, 0, v4
  v_mad_i32_i24 v85, v5, 1, v4
  v_mad_i32_i24 v86, v5, 2, v4
  v_mad_i32_i24 v87, v5, 3, v4
  v_mad_i32_i24 v88, v5, 8, v4
  v_mad_i32_i24 v89, v5, 9, v4
  v_mad_i32_i24 v90, v5, 10, v4
  v_mad_i32_i24 v91, v5, 11, v4
  v_lshl_add_u32 v4, v5, 4, v4
  v_mad_i32_i24 v120, v5, 0, v4
  v_mad_i32_i24 v121, v5, 1, v4
  v_mad_i32_i24 v122, v5, 2, v4
  v_mad_i32_i24 v123, v5, 3, v4
  v_mad_i32_i24 v124, v5, 8, v4
  v_mad_i32_i24 v125, v5, 9, v4
  v_mad_i32_i24 v126, v5, 10, v4
  v_mad_i32_i24 v127, v5, 11, v4
  v_lshl_add_u32 v4, v5, 4, v4
  s_barrier
  s_barrier
  ds_write_b32 v156, v148
  ds_write_b32 v157, v149
  ds_write_b32 v158, v150
  ds_write_b32 v159, v151
  ds_write_b32 v160, v152
  ds_write_b32 v161, v153
  ds_write_b32 v162, v154
  ds_write_b32 v163, v155
  ds_write_b32 v192, v184
  ds_write_b32 v193, v185
  ds_write_b32 v194, v186
  ds_write_b32 v195, v187
  ds_write_b32 v196, v188
  ds_write_b32 v197, v189
  ds_write_b32 v198, v190
  ds_write_b32 v199, v191
  ds_write_b32 v228, v220
  ds_write_b32 v229, v221
  ds_write_b32 v230, v222
  ds_write_b32 v231, v223
  ds_write_b32 v232, v224
  ds_write_b32 v233, v225
  ds_write_b32 v234, v226
  ds_write_b32 v235, v227
  ds_write_b32 v84, v76
  ds_write_b32 v85, v77
  ds_write_b32 v86, v78
  ds_write_b32 v87, v79
  ds_write_b32 v88, v80
  ds_write_b32 v89, v81
  ds_write_b32 v90, v82
  ds_write_b32 v91, v83
  ds_write_b32 v120, v112
  ds_write_b32 v121, v113
  ds_write_b32 v122, v114
  ds_write_b32 v123, v115
  ds_write_b32 v124, v116
  ds_write_b32 v125, v117
  ds_write_b32 v126, v118
  ds_write_b32 v127, v119
  s_branch L_tail
L_ld1:
  s_mov_b32 m0, s51
  s_add_u32 s51, s51, 3072
  buffer_load_dwordx4 v242, s[8:11], s52 offen offset:0 lds
  buffer_load_dwordx4 v243, s[8:11], s52 offen offset:1024 lds
  buffer_load_dwordx4 v244, s[8:11], s52 offen offset:2048 lds
  s_add_u32 s52, s52, 384
  s_mov_b32 m0, s51
  s_add_u32 s51, s51, 3072
  buffer_load_dwordx4 v242, s[8:11], s52 offen offset:0 lds
  buffer_load_dwordx4 v243, s[8:11], s52 offen offset:1024 lds
  buffer_load_dwordx4 v244, s[8:11], s52 offen offset:2048 lds
  s_add_u32 s52, s52, 384
  s_mov_b32 m0, s51
  s_add_u32 s51, s51, 3072
  buffer_load_dwordx4 v242, s[8:11], s52 offen offset:0 lds
  buffer_load_dwordx4 v243, s[8:11], s52 offen offset:1024 lds
  buffer_load_dwordx4 v244, s[8:11], s52 offen offset:2048 lds
  s_add_u32 s52, s52, 146688
  s_sub_u32 s48, s48, 1
  s_cmp_eq_u32 s48, 0
  s_cselect_b32 s52, s53, s52
  s_cmp_eq_u32 s51, s49
  s_cselect_b32 s51, s50, s51
  s_setpc_b64 s[62:63]
L_ld2:
  s_mov_b32 m0, s51
  s_add_u32 s51, s51, 3072
  buffer_load_dwordx4 v245, s[12:15], s52 offen offset:0 lds
  buffer_load_dwordx4 v246, s[12:15], s52 offen offset:1024 lds
  buffer_load_dwordx4 v247, s[12:15], s52 offen offset:2048 lds
  s_add_u32 s52, s52, 18432
  s_sub_u32 s48, s48, 1
  s_cmp_eq_u32 s48, 0
  s_cselect_b32 s52, s53, s52
  s_mov_b32 m0, s51
  s_add_u32 s51, s51, 3072
  buffer_load_dwordx4 v245, s[12:15], s52 offen offset:0 lds
  buffer_load_dwordx4 v246, s[12:15], s52 offen offset:1024 lds
  buffer_load_dwordx4 v247, s[12:15], s52 offen offset:2048 lds
  s_add_u32 s52, s52, 18432
  s_sub_u32 s48, s48, 1
  s_cmp_eq_u32 s48, 0
  s_cselect_b32 s52, s53, s52
  s_mov_b32 m0, s51
  s_add_u32 s51, s51, 3072
  buffer_load_dwordx4 v245, s[12:15], s52 offen offset:0 lds
  buffer_load_dwordx4 v246, s[12:15], s52 offen offset:1024 lds
  buffer_load_dwordx4 v247, s[12:15], s52 offen offset:2048 lds
  s_add_u32 s52, s52, 18432
  s_sub_u32 s48, s48, 1
  s_cmp_eq_u32 s48, 0
  s_cselect_b32 s52, s53, s52
  s_cmp_eq_u32 s51, s49
  s_cselect_b32 s51, s50, s51
  s_setpc_b64 s[62:63]
L_tail:
  s_and_b32 s55, s26, 1
  s_cmp_eq_u32 s55, 0
  s_cselect_b32 s42, 0, 144
  s_cselect_b32 s43, 9, 18
  s_cselect_b32 s44, 27, 99
  s_lshl_b32 s40, s25, 2
  s_lshr_b32 s41, s26, 1
  s_add_u32 s40, s40, s41
  s_mul_i32 s46, s40, 18432
  s_mul_i32 s47, s40, 18496
  s_add_u32 s47, s47, 48252928
  s_mov_b32 s48, 904105529
  s_mov_b32 s49, 3216550459
  s_and_b32 s40, s25, 15
  s_lshl_b32 s40, s40, 4
  s_lshr_b32 s41, s25, 4
  s_add_u32 s40, s40, s41
  v_bfe_u32 v2, v240, 1, 1
  v_lshlrev_b32 v2, 3, v2
  v_bfe_u32 v3, v240, 2, 2
  v_lshl_add_u32 v2, v3, 1, v2
  v_add_u32 v2, s40, v2
  v_lshlrev_b32 v2, 9, v2
  v_and_b32 v3, 1, v240
  v_lshl_add_u32 v2, v3, 8, v2
  s_lshr_b32 s41, s26, 2
  s_lshl_b32 s50, s41, 7
  s_add_u32 s50, s50, 2097152
  s_mul_i32 s40, s40, 73728
  s_mul_i32 s41, s41, 18432
  s_add_u32 s40, s40, s41
  s_bfe_u32 s41, s26, 0x10001
  s_lshl_b32 s41, s41, 8
  s_add_u32 s40, s40, s41
  s_add_u32 s51, s40, 20971520
  s_mov_b32 s52, s24
  s_mov_b32 s53, 0
L_tl:
  v_and_b32 v4, 15, v240
  v_lshrrev_b32 v5, 4, v240
  s_lshl_b32 s40, s52, 2
  v_add_u32 v5, s40, v5
  v_mov_b32 v7, 0x120
  v_cmp_le_u32 vcc, s43, v5
  s_nop 1
  v_cndmask_b32 v6, 0, 1, vcc
  v_cmp_le_u32 vcc, s44, v5
  s_nop 1
  v_addc_co_u32 v6, vcc, 0, v6, vcc
  v_lshlrev_b32 v8, 4, v5
  v_add_u32 v8, s42, v8
  v_mad_u32_u24 v8, v6, v7, v8
  buffer_load_dwordx4 v[100:103], v8, s[68:71], 0 offen
  v_mul_u32_u24 v9, 1152, v4
  v_add_u32 v115, v8, v9
  buffer_load_dwordx4 v[104:107], v115, s[4:7], s46 offen
  v_lshlrev_b32 v9, 2, v4
  buffer_load_dword v108, v9, s[16:19], s47 offen
  v_lshrrev_b32 v9, 4, v8
  v_bfe_u32 v10, v9, 2, 1
  v_mul_u32_u24 v10, 36864, v10
  v_lshrrev_b32 v11, 3, v9
  v_lshl_add_u32 v10, v11, 11, v10
  v_and_b32 v11, 3, v9
  v_lshl_add_u32 v10, v11, 9, v10
  v_lshl_add_u32 v114, v4, 4, v10
  v_cvt_f32_u32 v6, v5
  v_add_f32 v6, 0.5, v6
  v_mul_f32 v6, 0.1111111111111111, v6
  v_cvt_u32_f32 v6, v6
  v_mul_u32_u24 v7, 9, v6
  v_sub_u32 v7, v5, v7
  v_and_b32 v8, 1, v6
  v_mul_u32_u24 v9, 416, v4
  v_lshl_add_u32 v9, v7, 5, v9
  v_mul_u32_u24 v8, 9312, v8
  v_add_u32 v113, v9, v8
  v_add_u32 v8, 1, v6
  v_and_b32 v8, 2, v8
  v_lshlrev_b32 v8, 30, v8
  v_xor_b32 v112, 1.0, v8
  s_cmp_lg_u32 s53, 0
  s_cbranch_scc1 L_t2
  s_cmp_ge_u32 s24, 4
  s_cbranch_scc1 L_t1
  s_lshl_b32 s40, s2, 9
  s_lshl_b32 s41, s24, 7
  s_add_u32 s40, s40, s41
  s_add_u32 s40, s40, 2097152
  v_mov_b32 v6, s29
  v_mov_b32 v7, 0
  s_waitcnt vmcnt(3)
  s_mov_b64 exec, 1
  buffer_store_dword v6, v7, s[16:19], s40 offen sc0 sc1
  s_mov_b64 exec, -1
L_t1:
  s_cmp_lg_u32 s24, 5
  s_cbranch_scc1 L_t3
  s_mov_b32 s55, 0
  s_mov_b64 exec, 0xffff
L_pf:
  buffer_load_dword v3, v2, s[16:19], s50 offen sc0 sc1
  s_waitcnt vmcnt(0)
  v_cmp_ne_u32 vcc, s29, v3
  s_add_u32 s55, s55, 1
  s_cmp_gt_u32 s55, 100000
  s_cbranch_scc1 L_t4
  s_cmp_eq_u64 vcc, 0
  s_cbranch_scc1 L_t4
  s_mov_b64 exec, vcc
  s_sleep 3
  s_branch L_pf
L_t4:
  s_mov_b64 exec, -1
L_t3:
  s_waitcnt lgkmcnt(0)
  s_barrier
L_t2:
  s_add_u32 s40, s51, 0
  buffer_load_dwordx4 v[64:67], v114, s[16:19], s40 offen
  s_add_u32 s40, s51, 589824
  buffer_load_dwordx4 v[68:71], v114, s[16:19], s40 offen
  s_add_u32 s40, s51, 147456
  buffer_load_dwordx4 v[72:75], v114, s[16:19], s40 offen
  s_add_u32 s40, s51, 737280
  buffer_load_dwordx4 v[76:79], v114, s[16:19], s40 offen
  s_add_u32 s40, s51, 294912
  buffer_load_dwordx4 v[80:83], v114, s[16:19], s40 offen
  s_add_u32 s40, s51, 884736
  buffer_load_dwordx4 v[84:87], v114, s[16:19], s40 offen
  s_add_u32 s40, s51, 442368
  buffer_load_dwordx4 v[88:91], v114, s[16:19], s40 offen
  s_add_u32 s40, s51, 1032192
  buffer_load_dwordx4 v[92:95], v114, s[16:19], s40 offen
  ds_read_b128 v[40:43], v113 offset:9216
  ds_read_b128 v[44:47], v113 offset:9232
  ds_read_b128 v[48:51], v113 offset:46080
  ds_read_b128 v[52:55], v113 offset:46096
  s_waitcnt vmcnt(8)
  v_lshlrev_b32 v32, 16, v100
  v_and_b32 v33, 0xffff0000, v100
  v_lshlrev_b32 v16, 16, v104
  v_and_b32 v17, 0xffff0000, v104
  v_lshlrev_b32 v34, 16, v101
  v_and_b32 v35, 0xffff0000, v101
  v_lshlrev_b32 v18, 16, v105
  v_and_b32 v19, 0xffff0000, v105
  v_lshlrev_b32 v36, 16, v102
  v_and_b32 v37, 0xffff0000, v102
  v_lshlrev_b32 v20, 16, v106
  v_and_b32 v21, 0xffff0000, v106
  v_lshlrev_b32 v38, 16, v103
  v_and_b32 v39, 0xffff0000, v103
  v_lshlrev_b32 v22, 16, v107
  v_and_b32 v23, 0xffff0000, v107
  v_lshlrev_b32 v62, 16, v108
  v_mul_f32 v62, 0.5, v62
  s_waitcnt lgkmcnt(0)
  v_fma_f32 v40, v48, v112, v40
  v_fma_f32 v41, v49, v112, v41
  v_fma_f32 v42, v50, v112, v42
  v_fma_f32 v43, v51, v112, v43
  v_fma_f32 v44, v52, v112, v44
  v_fma_f32 v45, v53, v112, v45
  v_fma_f32 v46, v54, v112, v46
  v_fma_f32 v47, v55, v112, v47
  v_add_f32 v40, v40, v62
  v_sub_f32 v41, v41, v62
  v_add_f32 v42, v42, v62
  v_sub_f32 v43, v43, v62
  v_add_f32 v44, v44, v62
  v_sub_f32 v45, v45, v62
  v_add_f32 v46, v46, v62
  v_sub_f32 v47, v47, v62
  v_mul_f32 v40, s48, v40
  v_mul_f32 v41, s48, v41
  v_mul_f32 v42, s48, v42
  v_mul_f32 v43, s48, v43
  v_mul_f32 v44, s48, v44
  v_mul_f32 v45, s48, v45
  v_mul_f32 v46, s48, v46
  v_mul_f32 v47, s48, v47
  s_waitcnt vmcnt(7)
  v_lshlrev_b32 v8, 16, v64
  v_and_b32 v9, 0xffff0000, v64
  v_pk_add_f32 v[32:33], v[32:33], v[8:9]
  v_lshlrev_b32 v10, 16, v65
  v_and_b32 v11, 0xffff0000, v65
  v_pk_add_f32 v[34:35], v[34:35], v[10:11]
  v_lshlrev_b32 v8, 16, v66
  v_and_b32 v9, 0xffff0000, v66
  v_pk_add_f32 v[36:37], v[36:37], v[8:9]
  v_lshlrev_b32 v10, 16, v67
  v_and_b32 v11, 0xffff0000, v67
  v_pk_add_f32 v[38:39], v[38:39], v[10:11]
  s_waitcnt vmcnt(6)
  v_lshlrev_b32 v8, 16, v68
  v_and_b32 v9, 0xffff0000, v68
  v_pk_add_f32 v[32:33], v[32:33], v[8:9]
  v_lshlrev_b32 v10, 16, v69
  v_and_b32 v11, 0xffff0000, v69
  v_pk_add_f32 v[34:35], v[34:35], v[10:11]
  v_lshlrev_b32 v8, 16, v70
  v_and_b32 v9, 0xffff0000, v70
  v_pk_add_f32 v[36:37], v[36:37], v[8:9]
  v_lshlrev_b32 v10, 16, v71
  v_and_b32 v11, 0xffff0000, v71
  v_pk_add_f32 v[38:39], v[38:39], v[10:11]
  s_waitcnt vmcnt(5)
  v_lshlrev_b32 v8, 16, v72
  v_and_b32 v9, 0xffff0000, v72
  v_pk_add_f32 v[32:33], v[32:33], v[8:9]
  v_lshlrev_b32 v10, 16, v73
  v_and_b32 v11, 0xffff0000, v73
  v_pk_add_f32 v[34:35], v[34:35], v[10:11]
  v_lshlrev_b32 v8, 16, v74
  v_and_b32 v9, 0xffff0000, v74
  v_pk_add_f32 v[36:37], v[36:37], v[8:9]
  v_lshlrev_b32 v10, 16, v75
  v_and_b32 v11, 0xffff0000, v75
  v_pk_add_f32 v[38:39], v[38:39], v[10:11]
  s_waitcnt vmcnt(4)
  v_lshlrev_b32 v8, 16, v76
  v_and_b32 v9, 0xffff0000, v76
  v_pk_add_f32 v[32:33], v[32:33], v[8:9]
  v_lshlrev_b32 v10, 16, v77
  v_and_b32 v11, 0xffff0000, v77
  v_pk_add_f32 v[34:35], v[34:35], v[10:11]
  v_lshlrev_b32 v8, 16, v78
  v_and_b32 v9, 0xffff0000, v78
  v_pk_add_f32 v[36:37], v[36:37], v[8:9]
  v_lshlrev_b32 v10, 16, v79
  v_and_b32 v11, 0xffff0000, v79
  v_pk_add_f32 v[38:39], v[38:39], v[10:11]
  s_waitcnt vmcnt(3)
  v_lshlrev_b32 v8, 16, v80
  v_and_b32 v9, 0xffff0000, v80
  v_pk_add_f32 v[32:33], v[32:33], v[8:9]
  v_lshlrev_b32 v10, 16, v81
  v_and_b32 v11, 0xffff0000, v81
  v_pk_add_f32 v[34:35], v[34:35], v[10:11]
  v_lshlrev_b32 v8, 16, v82
  v_and_b32 v9, 0xffff0000, v82
  v_pk_add_f32 v[36:37], v[36:37], v[8:9]
  v_lshlrev_b32 v10, 16, v83
  v_and_b32 v11, 0xffff0000, v83
  v_pk_add_f32 v[38:39], v[38:39], v[10:11]
  s_waitcnt vmcnt(2)
  v_lshlrev_b32 v8, 16, v84
  v_and_b32 v9, 0xffff0000, v84
  v_pk_add_f32 v[32:33], v[32:33], v[8:9]
  v_lshlrev_b32 v10, 16, v85
  v_and_b32 v11, 0xffff0000, v85
  v_pk_add_f32 v[34:35], v[34:35], v[10:11]
  v_lshlrev_b32 v8, 16, v86
  v_and_b32 v9, 0xffff0000, v86
  v_pk_add_f32 v[36:37], v[36:37], v[8:9]
  v_lshlrev_b32 v10, 16, v87
  v_and_b32 v11, 0xffff0000, v87
  v_pk_add_f32 v[38:39], v[38:39], v[10:11]
  s_waitcnt vmcnt(1)
  v_lshlrev_b32 v8, 16, v88
  v_and_b32 v9, 0xffff0000, v88
  v_pk_add_f32 v[32:33], v[32:33], v[8:9]
  v_lshlrev_b32 v10, 16, v89
  v_and_b32 v11, 0xffff0000, v89
  v_pk_add_f32 v[34:35], v[34:35], v[10:11]
  v_lshlrev_b32 v8, 16, v90
  v_and_b32 v9, 0xffff0000, v90
  v_pk_add_f32 v[36:37], v[36:37], v[8:9]
  v_lshlrev_b32 v10, 16, v91
  v_and_b32 v11, 0xffff0000, v91
  v_pk_add_f32 v[38:39], v[38:39], v[10:11]
  s_waitcnt vmcnt(0)
  v_lshlrev_b32 v8, 16, v92
  v_and_b32 v9, 0xffff0000, v92
  v_pk_add_f32 v[32:33], v[32:33], v[8:9]
  v_lshlrev_b32 v10, 16, v93
  v_and_b32 v11, 0xffff0000, v93
  v_pk_add_f32 v[34:35], v[34:35], v[10:11]
  v_lshlrev_b32 v8, 16, v94
  v_and_b32 v9, 0xffff0000, v94
  v_pk_add_f32 v[36:37], v[36:37], v[8:9]
  v_lshlrev_b32 v10, 16, v95
  v_and_b32 v11, 0xffff0000, v95
  v_pk_add_f32 v[38:39], v[38:39], v[10:11]
  v_mul_f32 v48, s49, v32
  v_mul_f32 v49, s49, v33
  v_mul_f32 v50, s49, v34
  v_mul_f32 v51, s49, v35
  v_mul_f32 v52, s49, v36
  v_mul_f32 v53, s49, v37
  v_mul_f32 v54, s49, v38
  v_mul_f32 v55, s49, v39
  v_exp_f32 v48, v48
  v_exp_f32 v49, v49
  v_exp_f32 v50, v50
  v_exp_f32 v51, v51
  v_exp_f32 v52, v52
  v_exp_f32 v53, v53
  v_exp_f32 v54, v54
  v_exp_f32 v55, v55
  v_add_f32 v48, 1.0, v48
  v_add_f32 v49, 1.0, v49
  v_add_f32 v50, 1.0, v50
  v_add_f32 v51, 1.0, v51
  v_add_f32 v52, 1.0, v52
  v_add_f32 v53, 1.0, v53
  v_add_f32 v54, 1.0, v54
  v_add_f32 v55, 1.0, v55
  v_rcp_f32 v48, v48
  v_rcp_f32 v49, v49
  v_rcp_f32 v50, v50
  v_rcp_f32 v51, v51
  v_rcp_f32 v52, v52
  v_rcp_f32 v53, v53
  v_rcp_f32 v54, v54
  v_rcp_f32 v55, v55
  v_mul_f32 v40, v40, v32
  v_mul_f32 v41, v41, v33
  v_mul_f32 v42, v42, v34
  v_mul_f32 v43, v43, v35
  v_mul_f32 v44, v44, v36
  v_mul_f32 v45, v45, v37
  v_mul_f32 v46, v46, v38
  v_mul_f32 v47, v47, v39
  v_fma_f32 v16, v40, v48, v16
  v_fma_f32 v17, v41, v49, v17
  v_fma_f32 v18, v42, v50, v18
  v_fma_f32 v19, v43, v51, v19
  v_fma_f32 v20, v44, v52, v20
  v_fma_f32 v21, v45, v53, v21
  v_fma_f32 v22, v46, v54, v22
  v_fma_f32 v23, v47, v55, v23
  v_cvt_pk_bf16_f32 v56, v16, v17
  v_cvt_pk_bf16_f32 v57, v18, v19
  v_cvt_pk_bf16_f32 v58, v20, v21
  v_cvt_pk_bf16_f32 v59, v22, v23
  buffer_store_dwordx4 v[56:59], v115, s[64:67], s46 offen
  s_cmp_lg_u32 s52, 4
  s_cbranch_scc1 L_f2e
  s_mov_b32 s52, 8
  s_mov_b32 s53, 1
  s_branch L_tl
L_f2e:
  s_or_b32 s40, s2, s24
  s_cmp_lg_u32 s40, 0
  s_cbranch_scc1 L_noe
  v_mov_b32 v2, s29
  v_mov_b32 v3, 0
  s_mov_b32 s41, 36864
  s_mov_b64 exec, 1
  buffer_store_dword v2, v3, s[16:19], s41 offen
  s_mov_b64 exec, -1
L_noe:
  s_endpgm
L_exit:
  s_endpgm
code_end:
  .set CODE_BYTES, code_end-main_entry-64
.section .rodata,"a"
.p2align 6
.amdhsa_kernel recurrent_scan__spectral_gfnet__dense_activation_squared_relu__prompt_kernel
  .amdhsa_next_free_vgpr 256
  .amdhsa_next_free_sgpr 100
  .amdhsa_accum_offset 256
  .amdhsa_group_segment_fixed_size 0
  .amdhsa_kernarg_size 88
  .amdhsa_user_sgpr_count 2
  .amdhsa_user_sgpr_kernarg_segment_ptr 1
  .amdhsa_system_sgpr_workgroup_id_x 1
.end_amdhsa_kernel
.section .rodata,"a"
.p2align 8
tw_tab:
.quad 0x3f803f803f803f80,0x3f803f803f803f80,0x3f7a3f7c3f803f80,0x3f583f5e3f6d3f71,0x3f683f713f7f3f80,0x3ed83f003f353f44,0x3f4b3f5e3f7e3f80,0xbe06248d3ec43f00
.quad 0x3f253f443f7c3f80,0xbf25bf00248d3e32,0x3eec3f253f7a3f80,0xbf74bf5ebec4be32,0x3e853f003f773f80,0xbf77bf80bf35bf00,0x3d333eaf3f743f80,0xbf2dbf5ebf6dbf44
.quad 0xbe323e323f713f80,0xbe32bf00bf80bf71,0xbec4248d3f6d3f80,0x3ec4a554bf6dbf80,0xbf13be323f683f80,0x3f523f00bf35bf71,0xbf3dbeaf3f633f80,0x3f803f5ebec4bf44
.quad 0xbf5ebf003f5e3f80,0x3f5e3f80a554bf00,0xbf74bf253f583f80,0x3eec3f5e3ec4be32,0xbf7fbf443f523f80,0xbdb23f003f353e32,0xbf7ebf5e3f4b3f80,0xbf1c248d3f6d3f00
.quad 0x8000800080008000,0x8000800080008000,0xbe5ebe32bd338000,0xbf0abf00bec4beaf,0xbed8beafbdb28000,0xbf68bf5ebf35bf25,0xbf1cbf00be068000,0xbf7ebf80bf6dbf5e
.quad 0xbf44bf25be328000,0xbf44bf5ebf80bf7c,0xbf63bf44be5e8000,0xbe9abf00bf6dbf7c,0xbf77bf5ebe858000,0x3e85a50dbf35bf5e,0xbf80bf71be9a8000,0x3f3d3f00bec4bf25
.quad 0xbf7cbf7cbeaf8000,0x3f7c3f5ea50dbeaf,0xbf6dbf80bec48000,0x3f6d3f803ec4a50d,0xbf52bf7cbed88000,0x3f133f5e3f353eaf,0xbf2dbf71beec8000,0x3d333f003f6d3f25
.quad 0xbf00bf5ebf008000,0xbf0080003f803f5e,0xbe9abf44bf0a8000,0xbf63bf003f6d3f7c,0xbdb2bf25bf138000,0xbf7fbf5e3f353f7c,0x3e06bf00bf1c8000,0xbf4bbf803ec43f5e
.quad 0x3f803f803f803f80,0x3f803f803f803f80,0x3f743f773f7e3f7f,0x3f4b3f523f633f68,0x3f523f5e3f773f7c,0x3e853eaf3f133f25,0x3f1c3f353f6d3f77,0xbec4be853e063e85
.quad 0x3eaf3f003f5e3f71,0xbf5ebf44beafbe32,0x3d333e853f4b3f68,0xbf7ebf7fbf3dbf13,0xbe85248d3f353f5e,0xbf35bf5ebf77bf5e,0xbf0abe853f1c3f52,0xbe06bed8bf7abf7f
.quad 0xbf44bf003f003f44,0x3f003e32bf44bf71,0xbf6dbf353ec43f35,0x3f6d3f35bec4bf35,0xbf7fbf5e3e853f25,0x3f773f7c3db2beaf,0xbf7abf773e063f13,0x3f1c3f683f0a3db2
.quad 0xbf5ebf80248d3f00,0x248d3f003f5e3f00,0xbf2dbf77be063ed8,0xbf1cbdb23f803f52,0xbed8bf5ebe853eaf,0xbf77bf253f683f7c,0xbe06bf35bec43e85,0xbf6dbf773f1c3f77
.quad 0x8000800080008000,0x8000800080008000,0xbe9abe85be06bdb2,0xbf1cbf13beecbed8,0xbf13bf00be85be32,0xbf77bf71bf52bf44,0xbf4bbf35bec4be85,0xbf6dbf77bf7ebf77
.quad 0xbf71bf5ebf00beaf,0xbf00bf25bf71bf7c,0xbf80bf77bf1cbed8,0x3e06bdb2bf2dbf52,0xbf77bf80bf35bf00,0x3f353f00be85bf00,0xbf58bf77bf4bbf13,0x3f7e3f683e5ebdb2
.quad 0xbf25bf5ebf5ebf25,0x3f5e3f7c3f253eaf,0xbec4bf35bf6dbf35,0x3ec43f353f6d3f35,0xbdb2bf00bf77bf44,0xbe853e323f7f3f71,0x3e5ebe85bf7ebf52,0xbf4bbed83f583f7f
.quad 0x3f00a50dbf80bf5e,0xbf80bf5e3f003f5e,0x3f3d3e85bf7ebf68,0xbf4bbf7f3d333f13,0x3f683f00bf77bf71,0xbe85bf44bed83e32,0x3f7e3f35bf6dbf77,0x3ec4be85bf4bbe85
.quad 0x3f803f803f803f80,0x3f803f803f803f80,0x3f793f7c3f803f80,0x3f563f5c3f6b3f70,0x3f663f6f3f7e3f80,0x3ece3ef63f313f40,0x3f463f593f7d3f80,0xbe27bd063eb43ef1
.quad 0x3f1c3f3d3f7a3f80,0xbf2dbf0abd333e06,0x3ed33f1a3f773f80,0xbf78bf64beddbe69,0x3e483ee23f723f7f,0xbf72bf7fbf40bf0e,0xbd063e8a3f6e3f7f,0xbf1ebf53bf73bf50
.quad 0xbe853db23f683f7f,0xbdb2bed8bf7fbf77,0xbef1bdc93f623f7f,0x3ef13dc9bf62bf7f,0xbf29be8f3f5b3f7e,0x3f603f17bf20bf66,0xbf50bee73f533f7e,0x3f7f3f6bbe8abf2f
.quad 0xbf6dbf1c3f4b3f7e,0x3f4b3f7e3e06bec4,0xbf7dbf3f3f423f7d,0x3eaa3f493f02bd06,0xbf7fbf5b3f393f7d,0xbe733eba3f4e3ea5,0xbf75bf703f2f3f7d,0xbf3bbe273f793f22
.quad 0x8000800080008000,0x8000800080008000,0xbe69be3dbd5fbc33,0xbf0cbf02bec9beb4,0xbee2bebabddfbcb3,0xbf6abf60bf39bf29,0xbf22bf07be27bd06,0xbf7dbf80bf70bf62
.quad 0xbf4bbf2dbe5ebd33,0xbf3dbf58bf80bf7e,0xbf69bf4dbe8abd5f,0xbe7ebee7bf67bf79,0xbf7bbf66bea5bd86,0x3ea53d86bf29bf55,0xbf80bf77bebfbd9c,0x3f493f11be9fbf15
.quad 0xbf77bf7fbed8bdb2,0x3f7f3f683db2be85,0xbf62bf7fbef1bdc9,0x3f623f7f3ef13dc9,0xbf40bf76bf05bddf,0x3ef63f4e3f483ee2,0xbf15bf64bf11bdf5,0xbd9c3ec93f773f3b
.quad 0xbec4bf4bbf1cbe06,0xbf1cbe063f7e3f6d,0xbe27bf2bbf27be11,0xbf72bf1e3f5c3f80,0x3d86bf05bf31be1c,0xbf79bf6f3f173f72,0x3e95beb4bf3bbe27,0xbf2fbf7d3e693f46
.quad 0x3f803f803f803f80,0x3f803f803f803f80,0x3f733f773f7d3f7f,0x3f493f503f623f67,0x3f4e3f5b3f763f7b,0x3e733ea53f0e3f20,0x3f153f2f3f693f75,0xbed3be953dc93e69
.quad 0x3e9a3eec3f583f6d,0xbf63bf4bbec4be5e,0xbc333e533f423f62,0xbf7cbf80bf46bf1e,0xbea5bd863f293f55,0xbf29bf55bf7bbf66,0xbf1abeaa3f0c3f46,0xbd5fbeb4bf75bf80
.quad 0xbf52bf133ed83f35,0x3f133e85bf35bf68,0xbf75bf463e953f22,0x3f753f46be95bf22,0xbf80bf6a3e1c3f0e,0x3f6f3f7f3e48be73,0xbf72bf7d3c333ef1,0x3f023f593f223e53
.quad 0xbf4bbf7ebe063ec4,0xbe063ec43f6d3f1c,0xbf11bf6bbe8a3e95,0xbf37be693f7f3f64,0xbe8fbf48bece3e48,0xbf7ebf403f553f80,0x3d06bf15bf073dc9,0xbf59bf7f3ef13f69
.quad 0x8000800080008000,0x8000800080008000,0xbe9fbe8abe11bdc9,0xbf1ebf15bef1bedd,0xbf17bf05be8fbe48,0xbf79bf72bf55bf48,0xbf50bf3bbed3be95,0xbf69bf75bf7fbf79
.quad 0xbf74bf63bf0abec4,0xbeecbf1cbf6dbf7a,0xbf80bf7bbf27bef1,0x3e3dbd06bf22bf49,0xbf72bf7fbf40bf0e,0x3f403f0ebe48bee2,0xbf4dbf72bf56bf22,0x3f803f703e95bc33
.quad 0xbf13bf52bf68bf35,0x3f523f773f353ed8,0xbe95bf22bf75bf46,0x3e953f223f753f46,0x3cb3becebf7dbf55,0xbeba3d863f7b3f79,0x3eaabe11bf80bf62,0xbf5cbf073f463f7b
.quad 0x3f1c3e06bf7ebf6d,0xbf7ebf6d3ec43f4b,0x3f533ec9bf77bf75,0xbf33bf79bdc93ee7,0x3f763f20bf6abf7b,0xbddfbf29bf0e3cb3,0x3f803f50bf59bf7f,0x3f07bdc9bf62bed3
.quad 0x3f803f803f803f80,0x3f803f803f803f80,0x3f793f7b3f7f3f80,0x3f553f5b3f6a3f6f,0x3f633f6d3f7e3f80,0x3ec43eec3f2d3f3d,0x3f403f553f7b3f7f,0xbe48bd863ea53ee2
.quad 0x3f133f353f773f7f,0xbf35bf13bdb23db2,0x3eba3f0e3f723f7e,0xbf7bbf6abef6be8f,0x3e063ec43f6d3f7e,0xbf6dbf7ebf4bbf1c,0xbddf3e483f663f7d,0xbf0ebf48bf79bf5b
.quad 0xbeaf248d3f5e3f7c,0xa554beafbf7cbf7c,0xbf0ebe483f553f7b,0x3f0e3e48bf55bf7b,0xbf3dbec43f4b3f7a,0x3f6d3f2dbf0abf58,0xbf60bf0e3f403f79,0x3f7b3f76be1cbf17
.quad 0xbf77bf353f353f77,0x3f353f773e85be85,0xbf80bf553f293f76,0x3e483f313f203ddf,0xbf7abf6d3f1c3f74,0xbec43e5e3f633eec,0xbf66bf7b3f0e3f72,0xbf55bea53f7f3f40
.quad 0x8000800080008000,0x8000800080008000,0xbe73be48bd86bcb3,0xbf0ebf05becebeba,0xbeecbec4be06bd33,0xbf6dbf63bf3dbf2d,0xbf29bf0ebe48bd86,0xbf7bbf7fbf72bf66
.quad 0xbf52bf35be85bdb2,0xbf35bf52bf7fbf7f,0xbf6fbf55bea5bddf,0xbe48becebf60bf76,0xbf7ebf6dbec4be06,0x3ec43e06bf1cbf4b,0xbf7ebf7bbee2be1c,0x3f553f20be73bf05
.quad 0xbf71bf80bf00be32,0x3f803f713e32be32,0xbf55bf7bbf0ebe48,0x3f553f7b3f0e3e48,0xbf2dbf6dbf1cbe5e,0x3ec43f3d3f583f0a,0xbef6bf55bf29be73,0xbe483e8f3f7d3f4e
.quad 0xbe85bf35bf35be85,0xbf35be853f773f77,0xbcb3bf0ebf40be8f,0xbf7bbf393f483f7e,0x3e5ebec4bf4bbe9a,0xbf6dbf7a3eec3f63,0x3ee2be48bf55bea5,0xbf0ebf723d863f29
.quad 0x3f803f803f803f80,0x3f803f803f803f80,0x3f723f763f7d3f7e,0x3f483f4e3f603f66,0x3f4b3f583f743f7a,0x3e5e3e9a3f0a3f1c,0x3f0e3f293f663f72,0xbee2bea53d863e48
.quad 0x3e853ed83f523f68,0xbf68bf52bed8be85,0xbd863e1c3f393f5b,0xbf79bf80bf4ebf29,0xbec4be063f1c3f4b,0xbf1cbf4bbf7ebf6d,0xbf29bece3ef63f39,0x3cb3be8fbf6fbf7f
.quad 0xbf5ebf253eaf3f25,0x3f253eafbf25bf5e,0xbf7bbf553e483f0e,0x3f7b3f55be48bf0e,0xbf7ebf743d333eec,0x3f633f803e9abe06,0xbf66bf80bddf3eba,0x3ece3f483f393ea5
.quad 0xbf35bf77be853e85,0xbe853e853f773f35,0xbee2bf5bbece3e1c,0xbf4ebeba3f793f72,0xbe06bf2dbf0a3d33,0xbf80bf583f3d3f7e,0x3e48bee2bf29bd86,0xbf40bf7f3ea53f55
.quad 0x8000800080008000,0x8000800080008000,0xbea5be8fbe1cbddf,0xbf20bf17bef6bee2,0xbf1cbf0abe9abe5e,0xbf7abf74bf58bf4b,0xbf55bf40bee2bea5,0xbf66bf72bf7fbf7b
.quad 0xbf77bf68bf13bed8,0xbed8bf13bf68bf77,0xbf7fbf7dbf31bf05,0x3e733cb3bf17bf40,0xbf6dbf7ebf4bbf1c,0x3f4b3f1cbe06bec4,0xbf40bf6abf60bf31,0x3f803f763eba3d86
.quad 0xbf00bf44bf71bf44,0x3f443f713f443f00,0xbe48bf0ebf7bbf55,0x3e483f0e3f7b3f55,0x3e06be9abf80bf63,0xbeecbd333f743f7e,0x3ee2bcb3bf7ebf6f,0xbf6abf203f313f72
.quad 0x3f353e85bf77bf77,0xbf77bf773e853f35,0x3f663f05bf6abf7d,0xbf17bf6fbe733ea5,0x3f7e3f3dbf58bf80,0x3d33bf0abf2dbe06,0x3f7b3f66bf40bf7f,0x3f293d86bf72bf0e
.quad 0x3f803f803f803f80,0x3f803f803f803f80,0x3f783f7b3f7f3f80,0x3f533f593f693f6e,0x3f603f6a3f7d3f7f,0x3eba3ee23f293f39,0x3f3b3f503f793f7f,0xbe69bdc93e953ed3
.quad 0x3f0a3f2d3f743f7e,0xbf3dbf1cbe063d33,0x3e9f3f023f6e3f7d,0xbf7dbf70bf07beaa,0x3d863ea53f663f7b,0xbf66bf7bbf55bf29,0xbe3d3df53f5c3f79,0xbefbbf3bbf7dbf64
.quad 0xbed8bdb23f523f77,0x3db2be85bf77bf7f,0xbf22be953f463f75,0x3f223e95bf46bf75,0xbf4ebef63f393f72,0x3f763f40bee2bf48,0xbf6ebf273f2b3f70,0x3f733f7dbd06befb
.quad 0xbf7ebf4b3f1c3f6d,0x3f1c3f6d3ec4be06,0xbf7ebf673f0c3f69,0x3d5f3f153f3b3e7e,0xbf6fbf793ef63f66,0xbf053d863f723f17,0xbf50bf803ed33f62,0xbf69bef13f7f3f59
.quad 0x8000800080008000,0x8000800080008000,0xbe7ebe53bd9cbd06,0xbf11bf07bed3bebf,0xbef6becebe1cbd86,0xbf6fbf66bf40bf31,0xbf2fbf15be69bdc9,0xbf79bf7fbf75bf69
.quad 0xbf58bf3dbe9abe06,0xbf2dbf4bbf7ebf80,0xbf73bf5cbebfbe27,0xbe11beb4bf59bf72,0xbf7fbf72bee2be48,0x3ee23e48bf0ebf40,0xbf7cbf7ebf02be69,0x3f5f3f2fbe27bee7
.quad 0xbf68bf7fbf13be85,0x3f7f3f773e85bdb2,0xbf46bf75bf22be95,0x3f463f753f223e95,0xbf17bf60bf31bea5,0x3e8f3f293f663f20,0xbebfbf42bf3fbeb4,0xbe9f3e273f803f5f
.quad 0xbe06bf1cbf4bbec4,0xbf4bbec43f6d3f7e,0x3df5beddbf56bed3,0xbf80bf503f2f3f78,0x3ebabe73bf60bee2,0xbf5bbf7f3ea53f4e,0x3f15bd06bf69bef1,0xbed3bf62bdc93f07
.quad 0x3f803f803f803f80,0x3f803f803f803f80,0x3f723f753f7d3f7e,0x3f463f4d3f5f3f64,0x3f483f553f723f79,0x3e483e8f3f053f17,0x3f073f223f623f70,0xbef1beb43d063e27
.quad 0x3e5e3ec43f4b3f63,0xbf6dbf58beecbe9a,0xbdf53dc93f2f3f53,0xbf75bf7fbf56bf33,0xbee2be483f0e3f40,0xbf0ebf40bf7fbf72,0xbf37bef13ed33f2b,0x3dc9be53bf67bf7d
.quad 0xbf68bf353e853f13,0x3f353ed8bf13bf52,0xbf7fbf623dc93ef1,0x3f7f3f62bdc9bef1,0xbf79bf7bbd863eba,0x3f553f7d3ecebcb3,0xbf56bf7fbe693e7e,0x3e953f333f4d3edd
.quad 0xbf1cbf6dbec43e06,0xbec43e063f7e3f4b,0xbe9fbf46bf073c33,0xbf62befb3f6e3f7c,0x3cb3bf0ebf29bddf,0xbf7bbf6a3f203f76,0x3eb4be95bf46be69,0xbf22bf793e273f3b
.quad 0x8000800080008000,0x8000800080008000,0xbeaabe95be27bdf5,0xbf22bf1abefbbee7,0xbf20bf0ebea5be73,0xbf7bbf76bf5bbf4e,0xbf59bf46bef1beb4,0xbf62bf70bf80bf7d
.quad 0xbf7abf6dbf1cbeec,0xbec4bf0abf63bf74,0xbf7ebf7fbf3bbf11,0x3e953d9cbf0cbf37,0xbf66bf7bbf55bf29,0x3f553f29bd86bea5,0xbf33bf62bf69bf3f,0x3f7f3f7b3edd3e11
.quad 0xbed8bf35bf77bf52,0x3f353f683f523f13,0xbdc9bef1bf7fbf62,0x3dc93ef13f7f3f62,0x3e73be48bf7fbf6f,0xbf0ebe1c3f6a3f80,0x3f0c3dc9bf79bf78,0xbf75bf373f1a3f67
.quad 0x3f4b3ec4bf6dbf7e,0xbf6dbf7e3e063f1c,0x3f733f22bf59bf80,0xbef1bf5fbebf3e3d,0x3f803f55bf40bf7e,0x3e48becebf48be8f,0x3f703f75bf22bf79,0x3f463e69bf7dbf2f
.quad 0x3f803f803f803f80,0x3f803f803f803f80,0x3f1c3f253f3d3f44,0x3e9a3eaf3eec3f00,0xbe85be323db23e32,0xbf52bf44bf13bf00,0xbf6dbf5ebf1cbf00,0xbf4bbf5ebf7ebf80
.quad 0xbf5ebf71bf7cbf71,0x3eaf3e32beafbf00,0xbe06beafbf58bf71,0x3f803f7c3f2d3f00,0x3f353f00be85bf00,0x3e853f003f773f80,0x3f7e3f7c3eec3e32,0xbf58bf253e5e3f00
.quad 0x3f003f443f713f44,0xbf44bf71bf44bf00,0xbec4248d3f6d3f80,0x3ec4a554bf6dbf80,0xbf77bf443ed83f44,0x3f7f3f71bdb2bf00,0xbf4bbf7cbe9a3e32,0x3e5e3f253f583f00
.quad 0xa554bf00bf5ebf00,0xbf5ebf003f5e3f80,0x3f4b3eafbf7abf71,0xbf3dbf7cbd333f00,0x3f773f71bf13bf71,0x3ed8be32bf68bf00,0x3ec43f5e3e06bf00,0x3f7e3f5ebf4bbf80
.quad 0x8000800080008000,0x8000800080008000,0xbf4bbf44bf2dbf25,0xbf74bf71bf63bf5e,0xbf77bf7cbf7fbf7c,0xbf13bf25bf52bf5e,0xbec4bf00bf4bbf5e,0x3f1c3f003e06a50d
.quad 0x3f003eafbe32beaf,0x3f713f7c3f713f5e,0x3f7e3f713f0a3eaf,0xbd333e323f3d3f5e,0x3f353f5e3f773f5e,0xbf77bf5ebe858000,0xbe063e323f633f7c,0xbf0abf44bf7abf5e
.quad 0xbf5ebf253eaf3f25,0x3f253eafbf25bf5e,0xbf6dbf80bec48000,0x3f6d3f803ec4a50d,0xbe85bf25bf68bf25,0xbdb23eaf3f7f3f5e,0x3f1c3e32bf74bf7c,0xbf7abf443f0a3f5e
.quad 0x3f803f5ebf00bf5e,0xbf00bf5ebf008000,0x3f1c3f713e5ebeaf,0x3f2d3e32bf80bf5e,0xbe853eaf3f523eaf,0x3f683f7cbed8bf5e,0xbf6dbf003f7e3f5e,0xbe063f003f1ca50d
.quad 0x3f803f803f803f80,0x3f803f803f803f80,0x3f0a3f133f2d3f35,0x3e5e3e853ec43ed8,0xbed8beafbdb2248d,0xbf68bf5ebf35bf25,0xbf7ebf77bf4bbf35,0xbf1cbf35bf6dbf77
.quad 0xbf25bf44bf7cbf80,0x3f253f00a554be32,0x3e9a3db2bf0abf35,0x3f633f773f6d3f52,0x3f773f5e3e85a554,0xbe85248d3f353f5e,0x3f3d3f683f633f35,0xbf80bf77bec4bdb2
.quad 0xbe323e323f713f80,0xbe32bf00bf80bf71,0xbf6dbf353ec43f35,0x3f6d3f35bec4bf35,0xbf52bf7cbed8248d,0x3f133f5e3f353eaf,0x3d33bed8bf74bf35,0xbf2dbe853f6d3f7f
.quad 0x3f5e3f00bf5ebf80,0xbf5ebf80248d3f00,0x3f633f7fbe5ebf35,0x3e9abe85bf6dbf13,0x3db23f253f13a554,0x3f7f3f5ebf35bf7c,0xbf4bbe853f7e3f35,0x3e063f353ec4be85
.quad 0x8000800080008000,0x8000800080008000,0xbf58bf52bf3dbf35,0xbf7abf77bf6dbf68,0xbf68bf71bf7fbf80,0xbed8bf00bf35bf44,0xbe06be85bf1cbf35,0x3f4b3f353ec43e85
.quad 0x3f443f253e32a50d,0x3f443f5e3f803f7c,0x3f743f7f3f583f35,0xbeecbe853ec43f13,0x3e853f003f773f80,0xbf77bf80bf35bf00,0xbf2dbed83eec3f35,0x3d33be85bf6dbf7f
.quad 0xbf7cbf7cbeaf8000,0x3f7c3f5ea50dbeaf,0xbec4bf35bf6dbf35,0x3ec43f353f6d3f35,0x3f133e32bf68bf80,0xbf52bf003f353f71,0x3f803f68be9abf35,0xbf3dbf77bec43db2
.quad 0x3f003f5e3f00a50d,0x3f00a50dbf80bf5e,0xbeec3db23f7a3f35,0x3f743f77bec4bf52,0xbf7fbf443f523f80,0xbdb23f003f353e32,0xbf1cbf773e063f35,0xbf7ebf353f6d3f77
.quad 0x3f803f803f803f80,0x3f803f803f803f80,0x3f1a3f223f3b3f42,0x3e953eaa3ee73efb,0xbe8fbe483d863e1c,0xbf55bf48bf17bf05,0xbf70bf62bf22bf07,0xbf46bf59bf7dbf80
.quad 0xbf58bf6dbf7ebf74,0x3ec43e5ebe9abeec,0xbd9cbe95bf50bf6b,0x3f7f3f7e3f373f0c,0x3f403f0ebe48bee2,0x3e483ee23f723f7f,0x3f7b3f7f3f073e7e,0xbf62bf333e113edd
.quad 0x3ed83f353f773f52,0xbf35bf68bf52bf13,0xbef1bdc93f623f7f,0x3ef13dc9bf62bf7f,0xbf7dbf553ea53f31,0x3f7b3f793cb3bece,0xbf37bf75bed33d5f,0x3dc93f0c3f673f1a
.quad 0x3e06bec4bf6dbf1c,0xbf6dbf1c3f4b3f7e,0x3f5f3ef1bf70bf7b,0xbf22bf73be3d3ebf,0x3f6a3f7bbee2bf60,0x3f0ebcb3bf76bf20,0x3e693f463e95beb4,0x3f753f70bf2fbf7d
.quad 0x8000800080008000,0x8000800080008000,0xbf4dbf46bf2fbf27,0xbf75bf72bf64bf5f,0xbf76bf7bbf7fbf7d,0xbf0ebf20bf4ebf5b,0xbeb4bef1bf46bf59,0x3f223f073e273d06
.quad 0x3f0a3ec4be06be9a,0x3f6d3f7a3f743f63,0x3f7f3f753f153ec9,0xbdc93df53f333f56,0x3f293f553f7b3f66,0xbf7bbf66bea5bd86,0xbe533dc93f593f78,0xbef1bf37bf7dbf67
.quad 0xbf68bf353e853f13,0x3f353ed8bf13bf52,0xbf62bf7fbef1bdc9,0x3f623f7f3ef13dc9,0xbe1cbf0ebf72bf39,0xbe483e733f803f6a,0x3f333e95bf69bf80,0xbf7fbf563edd3f4d
.quad 0x3f7e3f6dbec4bf4b,0xbec4bf4bbf1cbe06,0x3efb3f623eb4be53,0x3f463e9fbf7cbf6e,0xbece3e483f663ef6,0x3f553f80be8fbf48,0xbf79bf223f753f70,0xbe953eb43f3b3e27
.quad 0x3f803f803f803f80,0x3f803f803f803f80,0x3f073f113f2b3f33,0x3e533e7e3ebf3ed3,0xbee2bebabddfbcb3,0xbf6abf60bf39bf29,0xbf7fbf79bf50bf3b,0xbf15bf2fbf69bf75
.quad 0xbf1cbf3dbf7abf80,0x3f2d3f0a3d33be06,0x3eb43e11befbbf2b,0x3f5c3f733f723f59,0x3f7b3f663ea53d86,0xbea5bd863f293f55,0x3f2f3f5f3f6b3f42,0xbf7ebf7cbee7be27
.quad 0xbe853db23f683f7f,0xbdb2bed8bf7fbf77,0xbf75bf463e953f22,0x3f753f46be95bf22,0xbf40bf76bf05bddf,0x3ef63f4e3f483ee2,0x3e27be9fbf7cbf49,0xbf42bebf3f5f3f80
.quad 0x3f6d3f1cbf4bbf7e,0xbf4bbf7ebe063ec4,0x3f503f80bd9cbf1a,0x3eddbdf5bf78bf2f,0xbd863f053f313e1c,0x3f793f6fbf17bf72,0xbf62bed33f803f50,0xbd063f153f07bdc9
.quad 0x8000800080008000,0x8000800080008000,0xbf59bf53bf3fbf37,0xbf7bbf78bf6ebf69,0xbf66bf6fbf7ebf80,0xbecebef6bf31bf40,0xbdc9be69bf15bf2f,0x3f503f3b3ed33e95
.quad 0x3f4b3f2d3e5e3d33,0x3f3d3f583f803f7e,0x3f703f7d3f5f3f3f,0xbf02be9f3eaa3f07,0x3e483ee23f723f7f,0xbf72bf7fbf40bf0e,0xbf3bbefb3ec93f27,0x3df5be3dbf64bf7d
.quad 0xbf77bf7fbed8bdb2,0x3f7f3f683db2be85,0xbe95bf22bf75bf46,0x3e953f223f753f46,0x3f293e8fbf5bbf7e,0xbf60bf173f203f66,0x3f7d3f73be3dbf1e,0xbf27bf6ebefbbd06
.quad 0x3ec43f4b3f1c3e06,0x3f1c3e06bf7ebf6d,0xbf15bd5f3f7f3f4d,0x3f673f7ebe7ebf3b,0xbf7fbf5b3f393f7d,0xbe733eba3f4e3ea5,0xbef1bf69bd063f15,0xbf80bf503f593f7f
.quad 0x3f803f803f803f80,0x3f803f803f803f80,0x3f173f203f393f40,0x3e8f3ea53ee23ef6,0xbe9abe5e3d333e06,0xbf58bf4bbf1cbf0a,0xbf72bf66bf29bf0e,0xbf40bf55bf7bbf7f
.quad 0xbf52bf68bf7fbf77,0x3ed83e85be85bed8,0xbcb3be73bf48bf66,0x3f7d3f7f3f403f17,0x3f4b3f1cbe06bec4,0x3e063ec43f6d3f7e,0x3f763f803f173ea5,0xbf6abf403d863eba
.quad 0x3eaf3f253f7c3f5e,0xbf25bf5ebf5ebf25,0xbf0ebe483f553f7b,0x3f0e3e48bf55bf7b,0xbf80bf633e5e3f1c,0x3f743f7e3e06be9a,0xbf20bf6abf05bd86,0xbcb33ee23f723f31
.quad 0x3e85be85bf77bf35,0xbf77bf353f353f77,0x3f6f3f17bf60bf7f,0xbf05bf66bea53e73,0x3f583f80be9abf4b,0x3f2d3e06bf7ebf3d,0x3d863f293ee2be48,0x3f663f7bbf0ebf72
.quad 0x8000800080008000,0x8000800080008000,0xbf4ebf48bf31bf29,0xbf76bf72bf66bf60,0xbf74bf7abf80bf7e,0xbf0abf1cbf4bbf58,0xbea5bee2bf40bf55,0x3f293f0e3e483d86
.quad 0x3f133ed8bdb2be85,0x3f683f773f773f68,0x3f803f793f203ee2,0xbe1c3d863f293f4e,0x3f1c3f4b3f7e3f6d,0xbf7ebf6dbec4be06,0xbe8f3cb33f4e3f72,0xbecebf29bf7fbf6f
.quad 0xbf71bf443e323f00,0x3f443f00bf00bf44,0xbf55bf7bbf0ebe48,0x3f553f7b3f0e3e48,0xbd33beecbf7abf4b,0xbe9a3e063f7e3f74,0x3f483ecebf5bbf7f,0xbf80bf663ea53f39
.quad 0x3f773f77be85bf35,0xbe85bf35bf35be85,0x3eba3f4e3ef6bd86,0x3f5b3ee2bf72bf79,0xbf0a3d333f743f1c,0x3f3d3f7ebe06bf2d,0xbf7fbf403f663f7b,0xbee23e483f553ea5
.quad 0x3f803f803f803f80,0x3f803f803f803f80,0x3f053f0e3f293f31,0x3e483e733eba3ece,0xbeecbec4be06bd33,0xbf6dbf63bf3dbf2d,0xbf7fbf7bbf55bf40,0xbf0ebf29bf66bf72
.quad 0xbf13bf35bf77bf7f,0x3f353f133db2bdb2,0x3ece3e48bee2bf20,0x3f553f6f3f763f60,0x3f7e3f6d3ec43e06,0xbec4be063f1c3f4b,0x3f203f553f723f4e,0xbf7bbf7ebf05be73
.quad 0xbeaf248d3f5e3f7c,0xa554beafbf7cbf7c,0xbf7bbf553e483f0e,0x3f7b3f55be48bf0e,0xbf2dbf6dbf1cbe5e,0x3ec43f3d3f583f0a,0x3e8fbe48bf7fbf5b,0xbf55bef63f4e3f7d
.quad 0x3f773f35bf35bf77,0xbf35bf77be853e85,0x3f393f7b3d86bef6,0x3f0e3cb3bf7ebf48,0xbe5e3ec43f4b3e9a,0x3f6d3f7abeecbf63,0xbf72bf0e3f7b3f66,0xbe483ee23f293d86
.quad 0x8000800080008000,0x8000800080008000,0xbf5bbf55bf40bf39,0xbf7bbf79bf6fbf6a,0xbf63bf6dbf7ebf80,0xbec4beecbf2dbf3d,0xbd86be48bf0ebf29,0x3f553f403ee23ea5
.quad 0x3f523f353e853db2,0x3f353f523f7f3f7f,0x3f6a3f7b3f663f48,0xbf0ebeba3e8f3ef6,0x3e063ec43f6d3f7e,0xbf6dbf7ebf4bbf1c,0xbf48bf0e3ea53f17,0x3e48bddfbf5bbf79
.quad 0xbf71bf80bf00be32,0x3f803f713e32be32,0xbe48bf0ebf7bbf55,0x3e483f0e3f7b3f55,0x3f3d3ec4bf4bbf7a,0xbf6dbf2d3f0a3f58,0x3f763f7bbd86bf05,0xbf0ebf60bf17be1c
.quad 0x3e853f353f353e85,0x3f353e85bf77bf77,0xbf31be483f7f3f60,0x3f553f80bddfbf20,0xbf7abf6d3f1c3f74,0xbec43e5e3f633eec,0xbea5bf55be483ee2,0xbf7bbf663f403f7f
.quad 0x3f803f803f803f80,0x3f803f803f803f80,0x3f153f1e3f373f3f,0x3e8a3e9f3edd3ef1,0xbea5be733cb33ddf,0xbf5bbf4ebf20bf0e,0xbf75bf69bf2fbf15,0xbf3bbf50bf79bf7f
.quad 0xbf4bbf63bf80bf7a,0x3eec3e9abe5ebec4,0x3d06be3dbf3fbf5f,0x3f7b3f803f493f22,0x3f553f29bd86bea5,0x3d863ea53f663f7b,0x3f703f803f273ec9,0xbf72bf4dbc333e95
.quad 0x3e853f133f7f3f68,0xbf13bf52bf68bf35,0xbf22be953f463f75,0x3f223e95bf46bf75,0xbf7fbf6f3ddf3f05,0x3f6a3f803e73be48,0xbf07bf5cbf1ebe3d,0xbe113eaa3f7b3f46
.quad 0x3ec4be06bf7ebf4b,0xbf7ebf4b3f1c3f6d,0x3f793f33bf4dbf7f,0xbec9bf53bee73dc9,0x3f403f7ebe1cbf31,0x3f483e8fbf80bf55,0xbdc93f073f15bd06,0x3f503f80bed3bf62
.quad 0x8000800080008000,0x8000800080008000,0xbf50bf49bf33bf2b,0xbf77bf73bf67bf62,0xbf72bf79bf80bf7e,0xbf05bf17bf48bf55,0xbe95bed3bf3bbf50,0x3f2f3f153e693dc9
.quad 0x3f1c3eecbd33be5e,0x3f633f743f7a3f6d,0x3f803f7c3f2b3efb,0xbe533c333f1e3f46,0x3f0e3f403f7f3f72,0xbf7fbf72bee2be48,0xbeb4bd5f3f423f6b,0xbeaabf1abf80bf75
.quad 0xbf77bf523db23ed8,0x3f523f13bed8bf35,0xbf46bf75bf22be95,0x3f463f753f223e95,0x3d86bebabf7ebf5b,0xbece3cb33f793f7b,0x3f593f02bf49bf7c,0xbf7dbf723e533f22
.quad 0x3f6d3f7ebe06bf1c,0xbe06bf1cbf4bbec4,0x3e693f373f1a3d9c,0x3f6b3f11bf64bf7f,0xbf29bddf3f7d3f39,0x3f203f763cb3bf0e,0xbf7fbf593f503f80,0xbf153d063f693ef1
.quad 0x3f803f803f803f80,0x3f803f803f803f80,0x3f023f0c3f273f2f,0x3e3d3e693eb43ec9,0xbef6becebe1cbd86,0xbf6fbf66bf40bf31,0xbf80bf7dbf59bf46,0xbf07bf22bf62bf70
.quad 0xbf0abf2dbf74bf7e,0x3f3d3f1c3e06bd33,0x3ee73e7ebec9bf15,0x3f4d3f693f793f67,0x3f7f3f723ee23e48,0xbee2be483f0e3f40,0x3f113f493f783f59,0xbf77bf80bf15be9f
.quad 0xbed8bdb23f523f77,0x3db2be85bf77bf7f,0xbf7fbf623dc93ef1,0x3f7f3f62bdc9bef1,0xbf17bf60bf31bea5,0x3e8f3f293f663f20,0x3ec9bd9cbf80bf69,0xbf64bf153f3b3f77
.quad 0x3f7e3f4bbf1cbf6d,0xbf1cbf6dbec43e06,0x3f1e3f723e53beb4,0x3f2b3e27bf80bf5c,0xbeba3e733f603ee2,0x3f5b3f7fbea5bf4e,0xbf7dbf2f3f703f75,0xbeb43e953f463e69
.quad 0x8000800080008000,0x8000800080008000,0xbf5cbf56bf42bf3b,0xbf7cbf79bf70bf6b,0xbf60bf6abf7dbf7f,0xbebabee2bf29bf39,0xbd06be27bf07bf22,0x3f593f463ef13eb4
.quad 0x3f583f3d3e9a3e06,0x3f2d3f4b3f7e3f80,0x3f643f783f6b3f50,0xbf1abed33e693edd,0x3d863ea53f663f7b,0xbf66bf7bbf55bf29,0xbf53bf1e3e7e3f07,0x3e8abd06bf50bf73
.quad 0xbf68bf7fbf13be85,0x3f7f3f773e85bdb2,0xbdc9bef1bf7fbf62,0x3dc93ef13f7f3f62,0x3f4e3ef6bf39bf72,0xbf76bf403ee23f48,0x3f6b3f7f3d5fbed3,0xbee7bf50bf2fbe8a
.quad 0x3e063f1c3f4b3ec4,0x3f4b3ec4bf6dbf7e,0xbf49beaa3f7b3f70,0x3f3f3f7d3d06bf02,0xbf6fbf793ef63f66,0xbf053d863f723f17,0xbe27bf3bbeb43e95,0xbf70bf753f223f79
.quad 0x3f803f803f803f80,0x3f803f803f803f80,0xbd33248d3e063e32,0xbec4beafbe5ebe32,0xbf7fbf80bf77bf71,0xbf35bf44bf68bf71,0x3e06a554bec4bf00,0x3f6d3f5e3f1c3f00
.quad 0x3f7c3f803f5e3f44,0x248d3e323f253f44,0xbe5e248d3f1c3f44,0xbf6dbf7cbf63bf44,0xbf77bf80bf35bf00,0x3f353f00be85bf00,0x3e9aa554bf4bbf71,0x3ec43f253f803f71
.quad 0x3f713f803f003e32,0xbf80bf71be323e32,0xbec4248d3f6d3f80,0x3ec4a554bf6dbf80,0xbf68bf80be853e32,0x3f353f713f133e32,0x3eeca554bf7ebf71,0xbf6dbf253f2d3f71
.quad 0x3f5e3f80a554bf00,0xa554bf00bf5ebf00,0xbf0a248d3f7e3f44,0x3f6d3f7cbe9abf44,0xbf52bf803e853f44,0xbf35be323f7f3f44,0x3f1ca554bf6dbf00,0xbec4bf5ebe063f00
.quad 0x8000800080008000,0x8000800080008000,0xbf80bf80bf7ebf7c,0xbf6dbf71bf7abf7c,0x3db2a50dbe85beaf,0x3f353f253ed83eaf,0x3f7e3f803f6d3f5e,0x3ec43f003f4b3f5e
.quad 0xbe3280003f003f25,0xbf80bf7cbf44bf25,0xbf7abf80bf4bbf25,0x3ec43e32beecbf25,0x3e85a50dbf35bf5e,0x3f353f5e3f773f5e,0x3f743f803f1c3eaf,0xbf6dbf443d333eaf
.quad 0xbeaf80003f5e3f7c,0xa50dbeafbf7cbf7c,0xbf6dbf80bec48000,0x3f6d3f803ec4a50d,0x3ed8a50dbf77bf7c,0xbf35beaf3f523f7c,0x3f633f803e06beaf,0xbec4bf44bf3dbeaf
.quad 0xbf0080003f803f5e,0x3f803f5ebf00bf5e,0xbf58bf803e063f25,0xbec43e323f743f25,0x3f13a50dbf77bf25,0xbf35bf7c3db23f25,0x3f4b3f80bec4bf5e,0x3f6d3f00bf7ebf5e
.quad 0x3f803f803f803f80,0x3f803f803f803f80,0xbe06bdb23d333db2,0xbeecbed8be9abe85,0xbf77bf7cbf7fbf7c,0xbf13bf25bf52bf5e,0x3ec43e85be06be85,0x3f7e3f773f4b3f35
.quad 0x3f5e3f713f7c3f71,0xbeafbe323eaf3f00,0xbf1cbed83e5e3ed8,0xbf2dbf52bf80bf77,0xbf35bf5ebf77bf5e,0x3f773f5e3e85a554,0x3f4b3f13be9abf13,0xbe5e3db23f583f77
.quad 0x3f003f443f713f44,0xbf44bf71bf44bf00,0xbf6dbf353ec43f35,0x3f6d3f35bec4bf35,0xbe85bf25bf68bf25,0xbdb23eaf3f7f3f5e,0x3f7e3f52beecbf52,0xbf58bf7fbe5e3e85
.quad 0x248d3f003f5e3f00,0x3f5e3f00bf5ebf80,0xbf7ebf683f0a3f68,0x3d333f133f3d3e85,0x3e85beafbf52beaf,0xbf68bf7c3ed83f5e,0x3f6d3f77bf1cbf77,0x3f4b3e85bf7ebf35
.quad 0x8000800080008000,0x8000800080008000,0xbf7ebf7fbf80bf7f,0xbf63bf68bf74bf77,0x3e853e32bdb2be32,0x3f523f443f133f00,0x3f6d3f773f7e3f77,0x3e063e853f1c3f35
.quad 0xbf00beaf3e323eaf,0xbf71bf7cbf71bf5e,0xbf4bbf68bf7abf68,0x3f3d3f13bd33be85,0x3f353f00be85bf00,0x3e853f003f773f80,0x3f1c3f523f743f52,0xbf7abf7fbf0abe85
.quad 0xbf5ebf253eaf3f25,0x3f253eafbf25bf5e,0xbec4bf35bf6dbf35,0x3ec43f353f6d3f35,0x3f773f44bed8bf44,0xbf7fbf713db23f00,0x3e063f133f633f13,0x3f0a3db2bf7abf77
.quad 0xbf80bf5e3f003f5e,0x3f003f5e3f00a50d,0x3e06bed8bf58bed8,0xbf80bf523f2d3f77,0x3f773f71bf13bf71,0x3ed8be32bf68bf00,0xbec43e853f4b3e85,0x3f1c3f77be06bf35
.quad 0x3f803f803f803f80,0x3f803f803f803f80,0xbd5fbc333df53e27,0xbec9beb4be69be3d,0xbf7ebf80bf79bf72,0xbf31bf40bf66bf6f,0x3e273d06beb4bef1,0x3f703f623f223f07
.quad 0x3f7a3f803f633f4b,0xbd333e063f1c3f3d,0xbe8abd5f3f113f3b,0xbf67bf79bf69bf4d,0xbf72bf7fbf40bf0e,0x3f403f0ebe48bee2,0x3ebf3d9cbf3fbf69,0x3e9f3f153f803f77
.quad 0x3f683f7f3f133e85,0xbf7fbf77be853db2,0xbef1bdc93f623f7f,0x3ef13dc9bf62bf7f,0xbf5bbf7ebeba3d86,0x3f203f663f293e8f,0x3f113df5bf78bf79,0xbf77bf3b3f153f64
.quad 0x3f4b3f7e3e06bec4,0x3e06bec4bf6dbf1c,0xbf27be113f803f59,0x3f5c3f80be27bf2b,0xbf39bf7d3ddf3f29,0xbf4ebea53f7f3f5b,0x3f3b3e27bf79bf22,0xbe69bf46be953eb4
.quad 0x8000800080008000,0x8000800080008000,0xbf80bf80bf7ebf7d,0xbf6bbf70bf79bf7c,0x3ddf3cb3be73bea5,0x3f393f293ee23eba,0x3f7d3f803f703f62,0x3eb43ef13f463f59
.quad 0xbe5ebd333eec3f1c,0xbf80bf7ebf4bbf2d,0xbf77bf80bf53bf2f,0x3edd3e69bed3bf1a,0x3ea53d86bf29bf55,0x3f293f553f7b3f66,0x3f6e3f7f3f2b3ed3,0xbf73bf50bd063e8a
.quad 0xbed8bdb23f523f77,0x3db2be85bf77bf7f,0xbf62bf7fbef1bdc9,0x3f623f7f3ef13dc9,0x3f053ddfbf6fbf7f,0xbf48bee23f403f76,0x3f533f7e3e7ebe69,0xbe8abf2fbf50bee7
.quad 0xbf1cbe063f7e3f6d,0x3f7e3f6dbec4bf4b,0xbf42bf7dbc333f07,0xbf023d063f7d3f3f,0x3f313e1cbf7ebf40,0xbf17bf72bd863f05,0x3f2f3f7dbe69bf46,0x3f793f22bf75bf70
.quad 0x3f803f803f803f80,0x3f803f803f803f80,0xbe11bdc93d063d9c,0xbef1beddbe9fbe8a,0xbf76bf7bbf7fbf7d,0xbf0ebf20bf4ebf5b,0x3ed33e95bdc9be69,0x3f7f3f793f503f3b
.quad 0x3f583f6d3f7e3f74,0xbec4be5e3e9a3eec,0xbf27bef13e273ebf,0xbf22bf49bf80bf7b,0xbf29bf55bf7bbf66,0x3f7b3f663ea53d86,0x3f563f22be69bf02,0xbe953c333f4d3f72
.quad 0x3ed83f353f773f52,0xbf35bf68bf52bf13,0xbf75bf463e953f22,0x3f753f46be95bf22,0xbe1cbf0ebf72bf39,0xbe483e733f803f6a,0x3f803f62beb4bf3f,0xbf46bf7bbeaa3e11
.quad 0xbe063ec43f6d3f1c,0x3f6d3f1cbf4bbf7e,0xbf77bf753ed33f56,0xbdc93ee73f533ec9,0x3ecebe48bf66bef6,0xbf55bf803e8f3f48,0x3f593f7fbef1bf69,0x3f623ed3bf80bf50
.quad 0x8000800080008000,0x8000800080008000,0xbf7dbf7fbf80bf7f,0xbf62bf67bf73bf77,0x3e8f3e48bd86be1c,0x3f553f483f173f05,0x3f693f753f7f3f79,0x3dc93e693f153f2f
.quad 0xbf0abec43e063e9a,0xbf6dbf7abf74bf63,0xbf42bf62bf7dbf6e,0x3f463f1e3c33be53,0x3f403f0ebe48bee2,0x3e483ee23f723f7f,0x3f0c3f463f793f5c,0xbf75bf80bf1abeaa
.quad 0xbf68bf353e853f13,0x3f353ed8bf13bf52,0xbe95bf22bf75bf46,0x3e953f223f753f46,0x3f7d3f55bea5bf31,0xbf7bbf79bcb33ece,0x3c333ef13f703f2b,0x3f223e53bf72bf7d
.quad 0xbf7ebf6d3ec43f4b,0x3ec43f4b3f1c3e06,0x3e8abe95bf69bf0c,0xbf7fbf643f113f6b,0x3f6a3f7bbee2bf60,0x3f0ebcb3bf76bf20,0xbf073dc93f623ed3,0x3ef13f693d06bf15
.quad 0x3f803f803f803f80,0x3f803f803f803f80,0xbd86bcb33ddf3e1c,0xbecebebabe73be48,0xbf7ebf80bf7abf74,0xbf2dbf3dbf63bf6d,0x3e483d86bea5bee2,0x3f723f663f293f0e
.quad 0x3f773f7f3f683f52,0xbdb23db23f133f35,0xbea5bddf3f053f31,0xbf60bf76bf6fbf55,0xbf6dbf7ebf4bbf1c,0x3f4b3f1cbe06bec4,0x3ee23e1cbf31bf60,0x3e733f053f7e3f7b
.quad 0x3f5e3f7c3f253eaf,0xbf7cbf7cbeaf248d,0xbf0ebe483f553f7b,0x3f0e3e48bf55bf7b,0xbf4bbf7abeecbd33,0x3f0a3f583f3d3ec4,0x3f293e73bf6fbf7e,0xbf7dbf4e3ef63f55
.quad 0x3f353f773e85be85,0x3e85be85bf77bf35,0xbf40be8f3f7d3f6a,0x3f483f7ebcb3bf0e,0xbf1cbf74bd333f0a,0xbf63beec3f7a3f6d,0x3f553ea5bf7fbf40,0xbd86bf29bee23e48
.quad 0x8000800080008000,0x8000800080008000,0xbf7fbf80bf7ebf7d,0xbf6abf6fbf79bf7b,0x3e063d33be5ebe9a,0x3f3d3f2d3eec3ec4,0x3f7b3f7f3f723f66,0x3ea53ee23f403f55
.quad 0xbe85bdb23ed83f13,0xbf7fbf7fbf52bf35,0xbf72bf7ebf5bbf39,0x3ef63e8fbebabf0e,0x3ec43e06bf1cbf4b,0x3f1c3f4b3f7e3f6d,0x3f663f7d3f393ef6,0xbf79bf5bbddf3e48
.quad 0xbf00be323f443f71,0x3e32be32bf71bf80,0xbf55bf7bbf0ebe48,0x3f553f7b3f0e3e48,0x3f1c3e5ebf63bf80,0xbf58bf0a3f2d3f6d,0x3f403f793ebabddf,0xbe1cbf17bf60bf0e
.quad 0xbf35be853f773f77,0x3f773f77be85bf35,0xbf29bf76be1c3ece,0xbf20bddf3f803f55,0x3f4b3e9abf80bf58,0xbeecbf63be5e3ec4,0x3f0e3f72bd86bf29,0x3f7f3f40bf66bf7b
.quad 0x3f803f803f803f80,0x3f803f803f803f80,0xbe1cbddf3cb33d86,0xbef6bee2bea5be8f,0xbf74bf7abf80bf7e,0xbf0abf1cbf4bbf58,0x3ee23ea5bd86be48,0x3f7f3f7b3f553f40
.quad 0x3f523f683f7f3f77,0xbed8be853e853ed8,0xbf31bf053ddf3ea5,0xbf17bf40bf7fbf7d,0xbf1cbf4bbf7ebf6d,0x3f7e3f6d3ec43e06,0x3f603f31be1cbee2,0xbebabd863f403f6a
.quad 0x3eaf3f253f7c3f5e,0xbf25bf5ebf5ebf25,0xbf7bbf553e483f0e,0x3f7b3f55be48bf0e,0xbd33beecbf7abf4b,0xbe9a3e063f7e3f74,0x3f7e3f6fbe73bf29,0xbf31bf72bee23cb3
.quad 0xbe853e853f773f35,0x3f773f35bf35bf77,0xbf6abf7d3e8f3f40,0xbe733ea53f663f05,0x3f0abd33bf74bf1c,0xbf3dbf7e3e063f2d,0x3f403f7fbea5bf55,0x3f723f0ebf7bbf66
.quad 0x8000800080008000,0x8000800080008000,0xbf7dbf7ebf80bf7f,0xbf60bf66bf72bf76,0x3e9a3e5ebd33be06,0x3f583f4b3f1c3f0a,0x3f663f723f7f3f7b,0x3d863e483f0e3f29
.quad 0xbf13bed83db23e85,0xbf68bf77bf77bf68,0xbf39bf5bbf7ebf72,0x3f4e3f293d86be1c,0x3f4b3f1cbe06bec4,0x3e063ec43f6d3f7e,0x3ef63f393f7d3f66,0xbf6fbf7fbf29bece
.quad 0xbf71bf443e323f00,0x3f443f00bf00bf44,0xbe48bf0ebf7bbf55,0x3e483f0e3f7b3f55,0x3f803f63be5ebf1c,0xbf74bf7ebe063e9a,0xbddf3eba3f793f40,0x3f393ea5bf66bf80
.quad 0xbf77bf773e853f35,0x3e853f353f353e85,0x3ecebe1cbf76bf29,0xbf79bf723ee23f5b,0x3f583f80be9abf4b,0x3f2d3e06bf7ebf3d,0xbf29bd863f723f0e,0x3ea53f553e48bee2
.quad 0x3f803f803f803f80,0x3f803f803f803f80,0xbd9cbd063dc93e11,0xbed3bebfbe7ebe53,0xbf7dbf7fbf7bbf76,0xbf29bf39bf60bf6a,0x3e693dc9be95bed3,0x3f753f693f2f3f15
.quad 0x3f743f7e3f6d3f58,0xbe063d333f0a3f2d,0xbebfbe273ef13f27,0xbf59bf72bf73bf5c,0xbf66bf7bbf55bf29,0x3f553f29bd86bea5,0x3f023e69bf22bf56,0x3e273ee73f7c3f7e
.quad 0x3f523f773f353ed8,0xbf77bf7fbed8bdb2,0xbf22be953f463f75,0x3f223e95bf46bf75,0xbf39bf72bf0ebe1c,0x3ee23f483f4e3ef6,0x3f3f3eb4bf62bf80,0xbf80bf5f3ebf3f42
.quad 0x3f1c3f6d3ec4be06,0x3ec4be06bf7ebf4b,0xbf56bed33f753f77,0x3f2f3f783df5bedd,0xbef6bf66be483ece,0xbf72bf173f6f3f79,0x3f693ef1bf7fbf59,0x3dc9bf07bf153d06
.quad 0x8000800080008000,0x8000800080008000,0xbf7fbf80bf7fbf7d,0xbf69bf6ebf78bf7b,0x3e1c3d86be48be8f,0x3f403f313ef63ece,0x3f793f7f3f753f69,0x3e953ed33f3b3f50
.quad 0xbe9abe063ec43f0a,0xbf7ebf80bf58bf3d,0xbf6ebf7dbf62bf42,0x3f073eaabe9fbf02,0x3ee23e48bf0ebf40,0x3f0e3f403f7f3f72,0x3f5c3f793f463f0c,0xbf7dbf64be3d3df5
.quad 0xbf13be853f353f68,0x3e85bdb2bf68bf7f,0xbf46bf75bf22be95,0x3f463f753f223e95,0x3f313ea5bf55bf7d,0xbf66bf203f173f60,0x3f2b3f703ef13c33,0xbd06befbbf6ebf27
.quad 0xbf4bbec43f6d3f7e,0x3f6d3f7ebe06bf1c,0xbf0cbf69be953e8a,0xbf3bbe7e3f7e3f67,0x3f603ee2bf7bbf6a,0xbea5bf4ebeba3e73,0x3ed33f623dc9bf07,0x3f7f3f59bf50bf80
.quad 0x3f803f803f803f80,0x3f803f803f803f80,0xbe27bdf53c333d5f,0xbefbbee7beaabe95,0xbf72bf79bf80bf7e,0xbf05bf17bf48bf55,0x3ef13eb4bd06be27,0x3f803f7d3f593f46
.quad 0x3f4b3f633f803f7a,0xbeecbe9a3e5e3ec4,0xbf3bbf113d5f3e8a,0xbf0cbf37bf7ebf7f,0xbf0ebf40bf7fbf72,0x3f7f3f723ee23e48,0x3f693f3fbd9cbebf,0xbeddbe113f333f62
.quad 0x3e853f133f7f3f68,0xbf13bf52bf68bf35,0xbf7fbf623dc93ef1,0x3f7f3f62bdc9bef1,0x3d86bebabf7ebf5b,0xbece3cb33f793f7b,0x3f793f78bdf5bf11,0xbf1abf67bf0cbdc9
.quad 0xbec43e063f7e3f4b,0x3f7e3f4bbf1cbf6d,0xbf59bf803e113f27,0xbebf3e3d3f733f22,0x3f293ddfbf7dbf39,0xbf20bf76bcb33f0e,0x3f223f79be27bf3b,0x3f7d3f2fbf70bf75
.quad 0x8000800080008000,0x8000800080008000,0xbf7dbf7ebf80bf80,0xbf5fbf64bf72bf75,0x3ea53e73bcb3bddf,0x3f5b3f4e3f203f0e,0x3f623f703f803f7d,0x3d063e273f073f22
.quad 0xbf1cbeec3d333e5e,0xbf63bf74bf7abf6d,0xbf2fbf53bf80bf77,0x3f563f333df5bdc9,0x3f553f29bd86bea5,0x3d863ea53f663f7b,0x3ed33f2b3f7f3f6e,0xbf67bf7dbf37bef1
.quad 0xbf77bf523db23ed8,0x3f523f13bed8bf35,0xbdc9bef1bf7fbf62,0x3dc93ef13f7f3f62,0x3f7f3f6fbddfbf05,0xbf6abf80be733e48,0xbe693e7e3f7e3f53,0x3f4d3eddbf56bf7f
.quad 0xbf6dbf7e3e063f1c,0x3e063f1c3f4b3ec4,0x3f07bc33bf7dbf42,0xbf6ebf7c3e9f3f46,0x3f403f7ebe1cbf31,0x3f483e8fbf80bf55,0xbf46be693f7d3f2f,0x3e273f3b3eb4be95
.quad 0x3f803f803f803f80,0x3f803f803f803f80,0xbf2dbf25bf0abf00,0xbf63bf5ebf4bbf44,0xbdb2be32bed8bf00,0x3f133f003e853e32,0x3f4b3f5e3f7e3f80,0xbe06248d3ec43f00
.quad 0xbf7cbf71bf25bf00,0xbeafbf00bf5ebf71,0x3f0a3eafbe9abf00,0x3f3d3f5e3f7e3f71,0x3e853f003f773f80,0xbf77bf80bf35bf00,0xbf63bf7cbf3dbf00,0x3f7a3f5e3e06be32
.quad 0x3f713f44be32bf00,0xbf44bf003f003f44,0xbec4248d3f6d3f80,0x3ec4a554bf6dbf80,0xbed8bf44bf52bf00,0x3db23f003f773f44,0x3f743f7cbd33bf00,0xbf0abf5ebf1cbe32
.quad 0xbf5ebf003f5e3f80,0x3f5e3f80a554bf00,0x3e5ebeafbf63bf00,0xbf80bf5e3f1c3f71,0x3f133f713db2bf00,0x3f683f00bf77bf71,0xbf7ebf5e3f4b3f80,0xbf1c248d3f6d3f00
.quad 0x8000800080008000,0x8000800080008000,0xbf3dbf44bf58bf5e,0xbeecbf00bf1cbf25,0x3f7f3f7c3f683f5e,0x3f523f5e3f773f7c,0xbf1cbf00be068000,0xbf7ebf80bf6dbf5e
.quad 0xbe32beafbf44bf5e,0x3f713f5e3f003eaf,0x3f583f713f743f5e,0xbf2dbf003e063eaf,0xbf77bf5ebe858000,0x3e85a50dbf35bf5e,0x3eec3e32bf2dbf5e,0x3e5e3f003f7e3f7c
.quad 0x3eaf3f253f7c3f5e,0xbf25bf5ebf5ebf25,0xbf6dbf80bec48000,0x3f6d3f803ec4a50d,0x3f683f25bf13bf5e,0xbf7fbf5e3e853f25,0xbe9a3e323f803f5e,0x3f583f00bf4bbf7c
.quad 0xbf00bf5ebf008000,0xbf0080003f803f5e,0x3f7a3f71beecbf5e,0x3d33bf00bf4bbeaf,0xbf52beaf3f7f3f5e,0x3ed83f5e3e85beaf,0x3e06bf00bf1c8000,0xbf4bbf803ec43f5e
.quad 0x3f803f803f803f80,0x3f803f803f803f80,0xbf3dbf35bf1cbf13,0xbf6dbf68bf58bf52,0x3db2a554be85beaf,0x3f353f253ed83eaf,0x3f1c3f353f6d3f77,0xbec4be853e063e85
.quad 0xbf7cbf80bf5ebf44,0xa554be32bf25bf44,0x3f583f353e06bdb2,0x3ec43f133f743f7f,0xbe85248d3f353f5e,0xbf35bf5ebf77bf5e,0xbeecbf35bf7ebf68,0x3f6d3f7f3f2d3ed8
.quad 0x3f713f803f003e32,0xbf80bf71be323e32,0xbf6dbf353ec43f35,0x3f6d3f35bec4bf35,0x3ed8a554bf77bf7c,0xbf35beaf3f523f7c,0x3e9a3f353f4b3ed8,0x3ec4bdb2bf80bf68
.quad 0xbf5ebf80248d3f00,0x248d3f003f5e3f00,0x3f7a3f35bf4bbf7f,0xbec4bf52beec3db2,0xbf13248d3f773f25,0x3f353f7cbdb2bf25,0xbe06bf35bec43e85,0xbf6dbf773f1c3f77
.quad 0x8000800080008000,0x8000800080008000,0xbf2dbf35bf4bbf52,0xbec4bed8bf0abf13,0x3f7f3f803f773f71,0x3f353f443f683f71,0xbf4bbf35bec4be85,0xbf6dbf77bf7ebf77
.quad 0x3e32a50dbf00bf25,0x3f803f7c3f443f25,0x3f0a3f353f7e3f7f,0xbf6dbf52be9abdb2,0xbf77bf80bf35bf00,0x3f353f00be85bf00,0x3f633f35be06bed8,0xbec4bdb23f3d3f68
.quad 0xbeaf80003f5e3f7c,0xa50dbeafbf7cbf7c,0xbec4bf35bf6dbf35,0x3ec43f353f6d3f35,0x3f683f803e85be32,0xbf35bf71bf13be32,0xbf74bf353f1c3f68,0x3f6d3f7f3d33bed8
.quad 0x3f00a50dbf80bf5e,0xbf80bf5e3f003f5e,0x3e5e3f353f1c3db2,0x3f6d3f13bf63bf7f,0xbf52bf803e853f44,0xbf35be323f7f3f44,0x3f7e3f35bf6dbf77,0x3ec4be85bf4bbe85
.quad 0x3f803f803f803f80,0x3f803f803f803f80,0xbf2fbf27bf0cbf02,0xbf64bf5fbf4dbf46,0xbd86be1cbecebef6,0x3f173f053e8f3e48,0x3f463f593f7d3f80,0xbe27bd063eb43ef1
.quad 0xbf7ebf74bf2dbf0a,0xbe9abeecbf58bf6d,0x3f153ec9be7ebee7,0x3f333f563f7f3f75,0x3e483ee23f723f7f,0xbf72bf7fbf40bf0e,0xbf59bf78bf49bf11,0x3f7d3f673e53bdc9
.quad 0x3f773f52bdb2bed8,0xbf52bf133ed83f35,0xbef1bdc93f623f7f,0x3ef13dc9bf62bf7f,0xbea5bf31bf60bf17,0xbcb33ece3f7d3f55,0x3f693f803d9cbec9,0xbeddbf4dbf33be95
.quad 0xbf6dbf1c3f4b3f7e,0x3f4b3f7e3e06bec4,0x3eb4be53bf72bf1e,0xbf7cbf6e3efb3f62,0x3ee23f603e73beba,0x3f763f20bf6abf7b,0xbf75bf703f2f3f7d,0xbf3bbe273f793f22
.quad 0x8000800080008000,0x8000800080008000,0xbf3bbf42bf56bf5c,0xbee7befbbf1abf22,0x3f7f3f7d3f6a3f60,0x3f4e3f5b3f763f7b,0xbf22bf07be27bd06,0xbf7dbf80bf70bf62
.quad 0xbe06be9abf3dbf58,0x3f743f633f0a3ec4,0x3f503f6b3f783f64,0xbf37bf0c3d9c3e95,0xbf7bbf66bea5bd86,0x3ea53d86bf29bf55,0x3f073e7ebf1ebf53,0x3e113edd3f7b3f7f
.quad 0x3e853f133f7f3f68,0xbf13bf52bf68bf35,0xbf62bf7fbef1bdc9,0x3f623f7f3ef13dc9,0x3f723f39bef6bf4e,0xbf80bf6a3e1c3f0e,0xbed33d5f3f7f3f6b,0x3f673f1abf37bf75
.quad 0xbec4bf4bbf1cbe06,0xbf1cbe063f7e3f6d,0x3f703f7bbeaabf49,0x3e3dbebfbf5fbef1,0xbf66bef63f793f6f,0x3e8f3f483ecebe48,0x3e95beb4bf3bbe27,0xbf2fbf7d3e693f46
.quad 0x3f803f803f803f80,0x3f803f803f803f80,0xbf3fbf37bf1ebf15,0xbf6ebf69bf59bf53,0x3ddf3cb3be73bea5,0x3f393f293ee23eba,0x3f153f2f3f693f75,0xbed3be953dc93e69
.quad 0xbf7abf80bf63bf4b,0x3d33be06bf1cbf3d,0x3f5f3f3f3e3dbd06,0x3eaa3f073f703f7d,0xbea5bd863f293f55,0xbf29bf55bf7bbf66,0xbec9bf27bf80bf70,0x3f643f7d3f3b3efb
.quad 0x3f683f7f3f133e85,0xbf7fbf77be853db2,0xbf75bf463e953f22,0x3f753f46be95bf22,0x3f053ddfbf6fbf7f,0xbf48bee23f403f76,0x3e3d3f1e3f5c3f07,0x3efb3d06bf7dbf73
.quad 0xbf4bbf7ebe063ec4,0xbe063ec43f6d3f1c,0x3f7f3f4dbf33bf79,0xbe7ebf3bbf15bd5f,0xbf31be1c3f7e3f40,0x3f173f723d86bf05,0x3d06bf15bf073dc9,0xbf59bf7f3ef13f69
.quad 0x8000800080008000,0x8000800080008000,0xbf2bbf33bf49bf50,0xbebfbed3bf07bf11,0x3f7e3f803f793f72,0x3f313f403f663f6f,0xbf50bf3bbed3be95,0xbf69bf75bf7fbf79
.quad 0x3e5e3d33beecbf1c,0x3f803f7e3f4b3f2d,0x3efb3f2b3f7c3f80,0xbf72bf59beb4be11,0xbf72bf7fbf40bf0e,0x3f403f0ebe48bee2,0x3f6b3f42bd5fbeb4,0xbee7be273f2f3f5f
.quad 0xbed8bdb23f523f77,0x3db2be85bf77bf7f,0xbe95bf22bf75bf46,0x3e953f223f753f46,0x3f5b3f7e3ebabd86,0xbf20bf66bf29be8f,0xbf7cbf493f023f59,0x3f5f3f803e27be9f
.quad 0x3f1c3e06bf7ebf6d,0xbf7ebf6d3ec43f4b,0x3d9c3f1a3f373e69,0x3f783f2fbf50bf80,0xbf39bf7d3ddf3f29,0xbf4ebea53f7f3f5b,0x3f803f50bf59bf7f,0x3f07bdc9bf62bed3
.quad 0x3f803f803f803f80,0x3f803f803f803f80,0xbf31bf29bf0ebf05,0xbf66bf60bf4ebf48,0xbd33be06bec4beec,0x3f1c3f0a3e9a3e5e,0x3f403f553f7b3f7f,0xbe48bd863ea53ee2
.quad 0xbf7fbf77bf35bf13,0xbe85bed8bf52bf68,0x3f203ee2be48bece,0x3f293f4e3f803f79,0x3e063ec43f6d3f7e,0xbf6dbf7ebf4bbf1c,0xbf4ebf72bf55bf20,0x3f7f3f6f3e8fbcb3
.quad 0x3f7c3f5ea554beaf,0xbf5ebf253eaf3f25,0xbf0ebe483f553f7b,0x3f0e3e48bf55bf7b,0xbe5ebf1cbf6dbf2d,0xbe063e9a3f803f63,0x3f5b3f7f3e48be8f,0xbea5bf39bf48bece
.quad 0xbf77bf353f353f77,0x3f353f773e85be85,0x3ef6bd86bf7bbf39,0xbf72bf793eba3f4e,0x3e9a3f4b3ec4be5e,0x3f7e3f3dbf58bf80,0xbf66bf7b3f0e3f72,0xbf55bea53f7f3f40
.quad 0x8000800080008000,0x8000800080008000,0xbf39bf40bf55bf5b,0xbee2bef6bf17bf20,0x3f803f7e3f6d3f63,0x3f4b3f583f743f7a,0xbf29bf0ebe48bd86,0xbf7bbf7fbf72bf66
.quad 0xbdb2be85bf35bf52,0x3f773f683f133ed8,0x3f483f663f7b3f6a,0xbf40bf173cb33e73,0xbf7ebf6dbec4be06,0x3ec43e06bf1cbf4b,0x3f173ea5bf0ebf48,0x3d863eba3f763f80
.quad 0x3e323f003f803f71,0xbf00bf44bf71bf44,0xbf55bf7bbf0ebe48,0x3f553f7b3f0e3e48,0x3f7a3f4bbec4bf3d,0xbf7ebf743d333eec,0xbf05bd863f7b3f76,0x3f723f31bf20bf6a
.quad 0xbe85bf35bf35be85,0xbf35be853f773f77,0x3f603f7fbe48bf31,0x3ea5be73bf6fbf17,0xbf74bf1c3f6d3f7a,0x3e063f2d3f0abd33,0x3ee2be48bf55bea5,0xbf0ebf723d863f29
.quad 0x3f803f803f803f80,0x3f803f803f803f80,0xbf40bf39bf20bf17,0xbf6fbf6abf5bbf55,0x3e063d33be5ebe9a,0x3f3d3f2d3eec3ec4,0x3f0e3f293f663f72,0xbee2bea53d863e48
.quad 0xbf77bf7fbf68bf52,0x3db2bdb2bf13bf35,0x3f663f483e733cb3,0x3e8f3ef63f6a3f7b,0xbec4be063f1c3f4b,0xbf1cbf4bbf7ebf6d,0xbea5bf17bf80bf76,0x3f5b3f793f483f0e
.quad 0x3f5e3f7c3f253eaf,0xbf7cbf7cbeaf248d,0xbf7bbf553e483f0e,0x3f7b3f55be48bf0e,0x3f1c3e5ebf63bf80,0xbf58bf0a3f2d3f6d,0x3d863f053f6a3f20,0x3f173e1cbf76bf7b
.quad 0xbf35bf77be853e85,0xbe853e853f773f35,0x3f7f3f60bf17bf6f,0xbddfbf20bf31be48,0xbf4bbe9a3f803f58,0x3eec3f633e5ebec4,0x3e48bee2bf29bd86,0xbf40bf7f3ea53f55
.quad 0x8000800080008000,0x8000800080008000,0xbf29bf31bf48bf4e,0xbebabecebf05bf0e,0x3f7e3f803f7a3f74,0x3f2d3f3d3f633f6d,0xbf55bf40bee2bea5,0xbf66bf72bf7fbf7b
.quad 0x3e853db2bed8bf13,0x3f7f3f7f3f523f35,0x3ee23f203f793f80,0xbf76bf60becebe48,0xbf6dbf7ebf4bbf1c,0x3f4b3f1cbe06bec4,0x3f723f4e3cb3be8f,0xbf05be733f203f55
.quad 0xbf00be323f443f71,0x3e32be32bf71bf80,0xbe48bf0ebf7bbf55,0x3e483f0e3f7b3f55,0x3f4b3f7a3eec3d33,0xbf0abf58bf3dbec4,0xbf7fbf5b3ece3f48,0x3f4e3f7d3e8fbe48
.quad 0x3f353e85bf77bf77,0xbf77bf773e853f35,0xbd863ef63f4e3eba,0x3f7e3f48bf39bf7b,0xbf1cbf74bd333f0a,0xbf63beec3f7a3f6d,0x3f7b3f66bf40bf7f,0x3f293d86bf72bf0e
.quad 0x3f803f803f803f80,0x3f803f803f803f80,0xbf33bf2bbf11bf07,0xbf67bf62bf50bf49,0xbcb3bddfbebabee2,0x3f203f0e3ea53e73,0x3f3b3f503f793f7f,0xbe69bdc93e953ed3
.quad 0xbf80bf7abf3dbf1c,0xbe5ebec4bf4bbf63,0x3f2b3efbbe11beb4,0x3f1e3f463f803f7c,0x3d863ea53f663f7b,0xbf66bf7bbf55bf29,0xbf42bf6bbf5fbf2f,0x3f803f753eb43d5f
.quad 0x3f7f3f683db2be85,0xbf68bf353e853f13,0xbf22be953f463f75,0x3f223e95bf46bf75,0xbddfbf05bf76bf40,0xbe733e483f7f3f6f,0x3f493f7c3e9fbe27,0xbe53bf22bf59bf02
.quad 0xbf7ebf4b3f1c3f6d,0x3f1c3f6d3ec4be06,0x3f1a3d9cbf80bf50,0xbf64bf7f3e693f37,0x3e1c3f313f05bd86,0x3f803f55bf40bf7e,0xbf50bf803ed33f62,0xbf69bef13f7f3f59
.quad 0x8000800080008000,0x8000800080008000,0xbf37bf3fbf53bf59,0xbeddbef1bf15bf1e,0x3f803f7e3f6f3f66,0x3f483f553f723f79,0xbf2fbf15be69bdc9,0xbf79bf7fbf75bf69
.quad 0xbd33be5ebf2dbf4b,0x3f7a3f6d3f1c3eec,0x3f3f3f5f3f7d3f70,0xbf49bf22bd063e3d,0xbf7fbf72bee2be48,0x3ee23e48bf0ebf40,0x3f273ec9befbbf3b,0xbc333e953f703f80
.quad 0x3db23ed83f7f3f77,0xbed8bf35bf77bf52,0xbf46bf75bf22be95,0x3f463f753f223e95,0x3f7e3f5bbe8fbf29,0xbf79bf7bbd863eba,0xbf1ebe3d3f733f7d,0x3f7b3f46bf07bf5c
.quad 0xbe06bf1cbf4bbec4,0xbf4bbec43f6d3f7e,0x3f4d3f7fbd5fbf15,0x3ee7bdc9bf79bf33,0xbf7dbf393f5b3f7f,0xbcb33f0e3f293ddf,0x3f15bd06bf69bef1,0xbed3bf62bdc93f07
.quad 0x3f803f803f803f80,0x3f803f803f803f80,0xbf42bf3bbf22bf1a,0xbf70bf6bbf5cbf56,0x3e1c3d86be48be8f,0x3f403f313ef63ece,0x3f073f223f623f70,0xbef1beb43d063e27
.quad 0xbf74bf7ebf6dbf58,0x3e06bd33bf0abf2d,0x3f6b3f503e953d9c,0x3e693edd3f643f78,0xbee2be483f0e3f40,0xbf0ebf40bf7fbf72,0xbe7ebf07bf7fbf7b,0x3f503f733f533f1e
.quad 0x3f523f773f353ed8,0xbf77bf7fbed8bdb2,0xbf7fbf623dc93ef1,0x3f7f3f62bdc9bef1,0x3f313ea5bf55bf7d,0xbf66bf203f173f60,0xbd5f3ed33f753f37,0x3f2f3e8abf6bbf7f
.quad 0xbf1cbf6dbec43e06,0xbec43e063f7e3f4b,0x3f7b3f70bef1bf5f,0x3d06bf02bf49beaa,0xbf60bee23f7b3f6a,0x3ea53f4e3ebabe73,0x3eb4be95bf46be69,0xbf22bf793e273f3b
.quad 0x8000800080008000,0x8000800080008000,0xbf27bf2fbf46bf4d,0xbeb4bec9bf02bf0c,0x3f7d3f7f3f7b3f76,0x3f293f393f603f6a,0xbf59bf46bef1beb4,0xbf62bf70bf80bf7d
.quad 0x3e9a3e06bec4bf0a,0x3f7e3f803f583f3d,0x3ec93f153f753f7f,0xbf79bf67bee7be7e,0xbf66bf7bbf55bf29,0x3f553f29bd86bea5,0x3f783f593dc9be53,0xbf15be9f3f113f49
.quad 0xbf13be853f353f68,0x3e85bdb2bf68bf7f,0xbdc9bef1bf7fbf62,0x3dc93ef13f7f3f62,0x3f393f723f0e3e1c,0xbee2bf48bf4ebef6,0xbf80bf693e953f33,0x3f3b3f773ec9bd9c
.quad 0x3f4b3ec4bf6dbf7e,0xbf6dbf7e3e063f1c,0xbe533eb43f623efb,0x3f803f5cbf1ebf72,0xbef6bf66be483ece,0xbf72bf173f6f3f79,0x3f703f75bf22bf79,0x3f463e69bf7dbf2f
.quad 0x3f803f803f803f80,0x3f803f803f803f80,0xbf7ebf7cbf74bf71,0xbf7abf7cbf80bf80,0x3f773f713f523f44,0x3f683f713f7f3f80,0xbf6dbf5ebf1cbf00,0xbf4bbf5ebf7ebf80
.quad 0x3f5e3f443eaf3e32,0x3f253f443f7c3f80,0xbf4bbf25bd333e32,0xbeecbf25bf7abf80,0x3f353f00be85bf00,0x3e853f003f773f80,0xbf1cbeaf3f0a3f44,0xbd33beafbf74bf80
.quad 0x3f003e32bf44bf71,0xbe323e323f713f80,0xbec4248d3f6d3f80,0x3ec4a554bf6dbf80,0x3e85be32bf7fbf71,0xbf13be323f683f80,0xbe063eaf3f7a3f44,0x3f3d3eafbf63bf80
.quad 0xa554bf00bf5ebf00,0xbf5ebf003f5e3f80,0x3e063f253f2d3e32,0x3f743f25bf58bf80,0xbe85bf44bed83e32,0xbf7fbf443f523f80,0x3ec43f5e3e06bf00,0x3f7e3f5ebf4bbf80
.quad 0x8000800080008000,0x8000800080008000,0xbe06be32be9abeaf,0x3e5e3e323d33a50d,0x3e853eaf3f133f25,0xbed8beafbdb28000,0xbec4bf00bf4bbf5e,0x3f1c3f003e06a50d
.quad 0x3f003f253f713f7c,0xbf44bf25be328000,0xbf1cbf44bf80bf7c,0x3f633f443e5ea50d,0x3f353f5e3f773f5e,0xbf77bf5ebe858000,0xbf4bbf71bf58bf25,0x3f803f713e9aa50d
.quad 0x3f5e3f7c3f253eaf,0xbf7cbf7cbeaf8000,0xbf6dbf80bec48000,0x3f6d3f803ec4a50d,0x3f773f7c3db2beaf,0xbf52bf7cbed88000,0xbf7ebf713e5e3f25,0x3f2d3f713eeca50d
.quad 0x3f803f5ebf00bf5e,0xbf00bf5ebf008000,0xbf7ebf443f3d3f7c,0x3e9a3f443f0aa50d,0x3f773f25bf68bf7c,0xbdb2bf25bf138000,0xbf6dbf003f7e3f5e,0xbe063f003f1ca50d
.quad 0x3f803f803f803f80,0x3f803f803f803f80,0xbf80bf7fbf7abf77,0xbf74bf77bf7ebf7f,0x3f7f3f7c3f683f5e,0x3f523f5e3f773f7c,0xbf7ebf77bf4bbf35,0xbf1cbf35bf6dbf77
.quad 0x3f7c3f713f253f00,0x3eaf3f003f5e3f71,0xbf7abf68beecbe85,0xbd33be85bf4bbf68,0x3f773f5e3e85a554,0xbe85248d3f353f5e,0xbf74bf52bd333e85,0x3f0a3e85bf1cbf52
.quad 0x3f713f44be32bf00,0xbf44bf003f003f44,0xbf6dbf353ec43f35,0x3f6d3f35bec4bf35,0x3f683f25bf13bf5e,0xbf7fbf5e3e853f25,0xbf63bf133f3d3f77,0x3f7a3f77be06bf13
.quad 0x3f5e3f00bf5ebf80,0xbf5ebf80248d3f00,0xbf58bed83f743f77,0x3f2d3f773e06bed8,0x3f523eafbf7fbf5e,0xbed8bf5ebe853eaf,0xbf4bbe853f7e3f35,0x3e063f353ec4be85
.quad 0x8000800080008000,0x8000800080008000,0xbd33bdb2be5ebe85,0x3e9a3e853e063db2,0x3db23e323ed83f00,0xbf13bf00be85be32,0xbe06be85bf1cbf35,0x3f4b3f353ec43e85
.quad 0x3e323eaf3f443f5e,0xbf71bf5ebf00beaf,0xbe5ebed8bf63bf77,0x3f803f773f1c3ed8,0x3e853f003f773f80,0xbf77bf80bf35bf00,0xbe9abf13bf80bf77,0x3f583f773f4b3f13
.quad 0x3eaf3f253f7c3f5e,0xbf25bf5ebf5ebf25,0xbec4bf35bf6dbf35,0x3ec43f353f6d3f35,0x3ed83f443f523f00,0xbdb2bf00bf77bf44,0xbeecbf52bf2dbe85,0xbe5e3e853f7e3f52
.quad 0x3f003f5e3f00a50d,0x3f00a50dbf80bf5e,0xbf0abf68be9a3e85,0xbf3dbe853f7e3f68,0x3f133f713db2bf00,0x3f683f00bf77bf71,0xbf1cbf773e063f35,0xbf7ebf353f6d3f77
.quad 0x3f803f803f803f80,0x3f803f803f803f80,0xbf7ebf7dbf75bf72,0xbf79bf7cbf80bf80,0x3f793f723f553f48,0x3f663f6f3f7e3f80,0xbf70bf62bf22bf07,0xbf46bf59bf7dbf80
.quad 0x3f633f4b3ec43e5e,0x3f1c3f3d3f7a3f80,0xbf53bf2fbdc93df5,0xbed3bf1abf77bf80,0x3f403f0ebe48bee2,0x3e483ee23f723f7f,0xbf2bbed33ef13f37,0x3d06be8abf6ebf7f
.quad 0x3f133e85bf35bf68,0xbe853db23f683f7f,0xbef1bdc93f623f7f,0x3ef13dc9bf62bf7f,0x3ebabd86bf7bbf79,0xbf29be8f3f5b3f7e,0xbe7e3e693f7f3f56,0x3f503ee7bf53bf7e
.quad 0x3e06bec4bf6dbf1c,0xbf6dbf1c3f4b3f7e,0xbc333f073f463e9f,0x3f7d3f3fbf42bf7d,0xbddfbf29bf0e3cb3,0xbf7fbf5b3f393f7d,0x3e693f463e95beb4,0x3f753f70bf2fbf7d
.quad 0x8000800080008000,0x8000800080008000,0xbdf5be27be95beaa,0x3e693e3d3d5f3c33,0x3e733ea53f0e3f20,0xbee2bebabddfbcb3,0xbeb4bef1bf46bf59,0x3f223f073e273d06
.quad 0x3eec3f1c3f6d3f7a,0xbf4bbf2dbe5ebd33,0xbf11bf3bbf7fbf7e,0x3f693f4d3e8a3d5f,0x3f293f553f7b3f66,0xbf7bbf66bea5bd86,0xbf3fbf69bf62bf33,0x3f803f773ebf3d9c
.quad 0x3f523f773f353ed8,0xbf77bf7fbed8bdb2,0xbf62bf7fbef1bdc9,0x3f623f7f3ef13dc9,0x3f6f3f7f3e48be73,0xbf40bf76bf05bddf,0xbf78bf793dc93f0c,0x3f153f643f113df5
.quad 0x3f7e3f6dbec4bf4b,0xbec4bf4bbf1cbe06,0xbf80bf593f223f73,0x3e273f2b3f273e11,0x3f7e3f40bf55bf80,0x3d86bf05bf31be1c,0xbf79bf223f753f70,0xbe953eb43f3b3e27
.quad 0x3f803f803f803f80,0x3f803f803f803f80,0xbf80bf7fbf7bbf78,0xbf73bf77bf7dbf7f,0x3f7f3f7d3f6a3f60,0x3f4e3f5b3f763f7b,0xbf7fbf79bf50bf3b,0xbf15bf2fbf69bf75
.quad 0x3f7e3f743f2d3f0a,0x3e9a3eec3f583f6d,0xbf7dbf6ebf02be9f,0x3c33be53bf42bf62,0x3f7b3f663ea53d86,0xbea5bd863f293f55,0xbf79bf5cbdf53e3d,0x3f1a3eaabf0cbf46
.quad 0x3f773f52bdb2bed8,0xbf52bf133ed83f35,0xbf75bf463e953f22,0x3f753f46be95bf22,0x3f723f39bef6bf4e,0xbf80bf6a3e1c3f0e,0xbf70bf2b3f273f6e,0x3f723f7dbc33bef1
.quad 0x3f6d3f1cbf4bbf7e,0xbf4bbf7ebe063ec4,0xbf69bf0c3f673f7e,0x3f113f6b3e8abe95,0x3f663ef6bf79bf6f,0xbe8fbf48bece3e48,0xbf62bed33f803f50,0xbd063f153f07bdc9
.quad 0x8000800080008000,0x8000800080008000,0xbd06bd9cbe53be7e,0x3e9f3e8a3e113dc9,0x3d863e1c3ece3ef6,0xbf17bf05be8fbe48,0xbdc9be69bf15bf2f,0x3f503f3b3ed33e95
.quad 0x3e063e9a3f3d3f58,0xbf74bf63bf0abec4,0xbe27bebfbf5cbf73,0x3f803f7b3f273ef1,0x3e483ee23f723f7f,0xbf72bf7fbf40bf0e,0xbe69bf02bf7ebf7c,0x3f4d3f723f563f22
.quad 0x3e853f133f7f3f68,0xbf13bf52bf68bf35,0xbe95bf22bf75bf46,0x3e953f223f753f46,0x3ea53f313f603f17,0x3cb3becebf7dbf55,0xbeb4bf3fbf42bebf,0xbeaa3e113f803f62
.quad 0x3ec43f4b3f1c3e06,0x3f1c3e06bf7ebf6d,0xbed3bf56bedd3df5,0xbf53bec93f773f75,0x3ee23f603e73beba,0x3f763f20bf6abf7b,0xbef1bf69bd063f15,0xbf80bf503f593f7f
.quad 0x3f803f803f803f80,0x3f803f803f803f80,0xbf7ebf7dbf76bf72,0xbf79bf7bbf7fbf80,0x3f7a3f743f583f4b,0x3f633f6d3f7e3f80,0xbf72bf66bf29bf0e,0xbf40bf55bf7bbf7f
.quad 0x3f683f523ed83e85,0x3f133f353f773f7f,0xbf5bbf39be1c3d86,0xbebabf0ebf72bf7e,0x3f4b3f1cbe06bec4,0x3e063ec43f6d3f7e,0xbf39bef63ece3f29,0x3ddfbe48bf66bf7d
.quad 0x3f253eafbf25bf5e,0xbeaf248d3f5e3f7c,0xbf0ebe483f553f7b,0x3f0e3e48bf55bf7b,0x3eec3d33bf74bf7e,0xbf3dbec43f4b3f7a,0xbeba3ddf3f803f66,0x3f603f0ebf40bf79
.quad 0x3e85be85bf77bf35,0xbf77bf353f353f77,0xbe1c3ece3f5b3ee2,0x3f803f55bf29bf76,0x3d33bf0abf2dbe06,0xbf7abf6d3f1c3f74,0x3d863f293ee2be48,0x3f663f7bbf0ebf72
.quad 0x8000800080008000,0x8000800080008000,0xbddfbe1cbe8fbea5,0x3e733e483d863cb3,0x3e5e3e9a3f0a3f1c,0xbeecbec4be06bd33,0xbea5bee2bf40bf55,0x3f293f0e3e483d86
.quad 0x3ed83f133f683f77,0xbf52bf35be85bdb2,0xbf05bf31bf7dbf7f,0x3f6f3f553ea53ddf,0x3f1c3f4b3f7e3f6d,0xbf7ebf6dbec4be06,0xbf31bf60bf6abf40,0x3f7e3f7b3ee23e1c
.quad 0x3f443f713f443f00,0xbf71bf80bf00be32,0xbf55bf7bbf0ebe48,0x3f553f7b3f0e3e48,0x3f633f803e9abe06,0xbf2dbf6dbf1cbe5e,0xbf6fbf7ebcb33ee2,0x3ef63f553f293e73
.quad 0x3f773f77be85bf35,0xbe85bf35bf35be85,0xbf7dbf6a3f053f66,0x3cb33f0e3f403e8f,0x3f803f58bf3dbf7e,0x3e5ebec4bf4bbe9a,0xbf7fbf403f663f7b,0xbee23e483f553ea5
.quad 0x3f803f803f803f80,0x3f803f803f803f80,0xbf80bf7fbf7bbf79,0xbf72bf76bf7dbf7e,0x3f803f7e3f6d3f63,0x3f4b3f583f743f7a,0xbf7fbf7bbf55bf40,0xbf0ebf29bf66bf72
.quad 0x3f7f3f773f353f13,0x3e853ed83f523f68,0xbf7ebf72bf0ebeba,0x3d86be1cbf39bf5b,0x3f7e3f6d3ec43e06,0xbec4be063f1c3f4b,0xbf7dbf66be483ddf,0x3f293ecebef6bf39
.quad 0x3f7c3f5ea554beaf,0xbf5ebf253eaf3f25,0xbf7bbf553e483f0e,0x3f7b3f55be48bf0e,0x3f7a3f4bbec4bf3d,0xbf7ebf743d333eec,0xbf79bf403f0e3f60,0x3f663f803ddfbeba
.quad 0x3f773f35bf35bf77,0xbf35bf77be853e85,0xbf76bf293f553f80,0x3ee23f5b3ecebe1c,0x3f743f1cbf6dbf7a,0xbe06bf2dbf0a3d33,0xbf72bf0e3f7b3f66,0xbe483ee23f293d86
.quad 0x8000800080008000,0x8000800080008000,0xbcb3bd86be48be73,0x3ea53e8f3e1c3ddf,0x3d333e063ec43eec,0xbf1cbf0abe9abe5e,0xbd86be48bf0ebf29,0x3f553f403ee23ea5
.quad 0x3db23e853f353f52,0xbf77bf68bf13bed8,0xbddfbea5bf55bf6f,0x3f7f3f7d3f313f05,0x3e063ec43f6d3f7e,0xbf6dbf7ebf4bbf1c,0xbe1cbee2bf7bbf7e,0x3f403f6a3f603f31
.quad 0x3e323f003f803f71,0xbf00bf44bf71bf44,0xbe48bf0ebf7bbf55,0x3e483f0e3f7b3f55,0x3e5e3f1c3f6d3f2d,0x3e06be9abf80bf63,0xbe73bf29bf55bef6,0xbee23cb33f7e3f6f
.quad 0x3e853f353f353e85,0x3f353e85bf77bf77,0xbe8fbf40bf0ebcb3,0xbf66bf053f6a3f7d,0x3e9a3f4b3ec4be5e,0x3f7e3f3dbf58bf80,0xbea5bf55be483ee2,0xbf7bbf663f403f7f
.quad 0x3f803f803f803f80,0x3f803f803f803f80,0xbf7fbf7dbf77bf73,0xbf78bf7bbf7fbf80,0x3f7b3f763f5b3f4e,0x3f603f6a3f7d3f7f,0xbf75bf69bf2fbf15,0xbf3bbf50bf79bf7f
.quad 0x3f6d3f583eec3e9a,0x3f0a3f2d3f743f7e,0xbf62bf42be533c33,0xbe9fbf02bf6ebf7d,0x3f553f29bd86bea5,0x3d863ea53f663f7b,0xbf46bf0c3eaa3f1a,0x3e3dbdf5bf5cbf79
.quad 0x3f353ed8bf13bf52,0xbed8bdb23f523f77,0xbf22be953f463f75,0x3f223e95bf46bf75,0x3f0e3e1cbf6abf80,0xbf4ebef63f393f72,0xbef1bc333f7d3f72,0x3f6e3f27bf2bbf70
.quad 0x3ec4be06bf7ebf4b,0xbf7ebf4b3f1c3f6d,0xbe953e8a3f6b3f11,0x3f7e3f67bf0cbf69,0x3e48becebf48be8f,0xbf6fbf793ef63f66,0xbdc93f073f15bd06,0x3f503f80bed3bf62
.quad 0x8000800080008000,0x8000800080008000,0xbdc9be11be8abe9f,0x3e7e3e533d9c3d06,0x3e483e8f3f053f17,0xbef6becebe1cbd86,0xbe95bed3bf3bbf50,0x3f2f3f153e693dc9
.quad 0x3ec43f0a3f633f74,0xbf58bf3dbe9abe06,0xbef1bf27bf7bbf80,0x3f733f5c3ebf3e27,0x3f0e3f403f7f3f72,0xbf7fbf72bee2be48,0xbf22bf56bf72bf4d,0x3f7c3f7e3f023e69
.quad 0x3f353f683f523f13,0xbf68bf7fbf13be85,0xbf46bf75bf22be95,0x3f463f753f223e95,0x3f553f7d3ecebcb3,0xbf17bf60bf31bea5,0xbf62bf80be113eaa,0x3ebf3f423f3f3eb4
.quad 0x3f6d3f7ebe06bf1c,0xbe06bf1cbf4bbec4,0xbf75bf773ec93f53,0xbdf53edd3f563ed3,0x3f7b3f6abf20bf76,0x3ebabe73bf60bee2,0xbf7fbf593f503f80,0xbf153d063f693ef1
.quad 0x3f803f803f803f80,0x3f803f803f803f80,0xbf80bf80bf7cbf79,0xbf72bf75bf7dbf7e,0x3f803f7e3f6f3f66,0x3f483f553f723f79,0xbf80bf7dbf59bf46,0xbf07bf22bf62bf70
.quad 0x3f803f7a3f3d3f1c,0x3e5e3ec43f4b3f63,0xbf80bf77bf1abed3,0x3df5bdc9bf2fbf53,0x3f7f3f723ee23e48,0xbee2be483f0e3f40,0xbf7fbf6ebe8a3d06,0x3f373ef1bed3bf2b
.quad 0x3f7f3f683db2be85,0xbf68bf353e853f13,0xbf7fbf623dc93ef1,0x3f7f3f62bdc9bef1,0x3f7e3f5bbe8fbf29,0xbf79bf7bbd863eba,0xbf7ebf533ee73f50,0x3f563f7f3e69be7e
.quad 0x3f7e3f4bbf1cbf6d,0xbf1cbf6dbec43e06,0xbf7dbf423f3f3f7d,0x3e9f3f463f07bc33,0x3f7d3f39bf5bbf7f,0x3cb3bf0ebf29bddf,0xbf7dbf2f3f703f75,0xbeb43e953f463e69
.quad 0x8000800080008000,0x8000800080008000,0xbc33bd5fbe3dbe69,0x3eaa3e953e273df5,0x3cb33ddf3eba3ee2,0xbf20bf0ebea5be73,0xbd06be27bf07bf22,0x3f593f463ef13eb4
.quad 0x3d333e5e3f2d3f4b,0xbf7abf6dbf1cbeec,0xbd5fbe8abf4dbf69,0x3f7e3f7f3f3b3f11,0x3d863ea53f663f7b,0xbf66bf7bbf55bf29,0xbd9cbebfbf77bf80,0x3f333f623f693f3f
.quad 0x3db23ed83f7f3f77,0xbed8bf35bf77bf52,0xbdc9bef1bf7fbf62,0x3dc93ef13f7f3f62,0x3ddf3f053f763f40,0x3e73be48bf7fbf6f,0xbdf5bf11bf64bf15,0xbf0cbdc93f793f78
.quad 0x3e063f1c3f4b3ec4,0x3f4b3ec4bf6dbf7e,0xbe11bf27bf2bbe27,0xbf73bf223f593f80,0x3e1c3f313f05bd86,0x3f803f55bf40bf7e,0xbe27bf3bbeb43e95,0xbf70bf753f223f79
.quad 0x3f803f803f803f80,0x3f803f803f803f80,0xbf58bf5ebf6dbf71,0xbf1cbf25bf3dbf44,0x3ed83f003f353f44,0xbe85be323db23e32,0x3e06a554bec4bf00,0x3f6d3f5e3f1c3f00
.quad 0xbf25bf00248d3e32,0xbf5ebf71bf7cbf71,0x3f743f5e3ec43e32,0x3e063eaf3f583f71,0xbf77bf80bf35bf00,0x3f353f00be85bf00,0x3f2d3f5e3f6d3f44,0xbf7ebf7cbeecbe32
.quad 0xbe32bf00bf80bf71,0x3f003f443f713f44,0xbec4248d3f6d3f80,0x3ec4a554bf6dbf80,0x3f523f00bf35bf71,0xbf77bf443ed83f44,0xbf80bf5e3ec43f44,0x3f4b3f7c3e9abe32
.quad 0x3f5e3f80a554bf00,0xa554bf00bf5ebf00,0xbeecbf5ebec43e32,0xbf4bbeaf3f7a3f71,0xbdb23f003f353e32,0x3f773f71bf13bf71,0x3f1ca554bf6dbf00,0xbec4bf5ebe063f00
.quad 0x8000800080008000,0x8000800080008000,0x3f0a3f003ec43eaf,0x3f4b3f443f2d3f25,0xbf68bf5ebf35bf25,0xbf77bf7cbf7fbf7c,0x3f7e3f803f6d3f5e,0x3ec43f003f4b3f5e
.quad 0xbf44bf5ebf80bf7c,0x3f003eafbe32beaf,0x3e9a3f003f6d3f7c,0xbf7ebf71bf0abeaf,0x3e85a50dbf35bf5e,0x3f353f5e3f773f5e,0xbf3dbf003ec43f25,0x3e06be32bf63bf7c
.quad 0x3f7c3f5ea50dbeaf,0xbf5ebf253eaf3f25,0xbf6dbf80bec48000,0x3f6d3f803ec4a50d,0x3f133f5e3f353eaf,0xbe85bf25bf68bf25,0xbd33bf00bf6dbf25,0xbf1cbe323f743f7c
.quad 0xbf0080003f803f5e,0x3f803f5ebf00bf5e,0x3f633f00bf6dbf7c,0xbf1cbf71be5e3eaf,0xbf7fbf5e3f353f7c,0xbe853eaf3f523eaf,0x3f4b3f80bec4bf5e,0x3f6d3f00bf7ebf5e
.quad 0x3f803f803f803f80,0x3f803f803f803f80,0xbf4bbf52bf63bf68,0xbf0abf13bf2dbf35,0x3e853eaf3f133f25,0xbed8beafbdb2248d,0x3ec43e85be06be85,0x3f7e3f773f4b3f35
.quad 0xbf5ebf44beafbe32,0xbf25bf44bf7cbf80,0x3f7e3f7f3f3d3f13,0xbe9abdb23f0a3f35,0xbf35bf5ebf77bf5e,0x3f773f5e3e85a554,0x3e063ed83f7a3f7f,0xbf3dbf68bf63bf35
.quad 0x3f003e32bf44bf71,0xbe323e323f713f80,0xbf6dbf353ec43f35,0x3f6d3f35bec4bf35,0x3f773f7c3db2beaf,0xbf52bf7cbed8248d,0xbf1cbf68bf0abdb2,0xbd333ed83f743f35
.quad 0x248d3f003f5e3f00,0x3f5e3f00bf5ebf80,0x3f1c3db2bf80bf52,0xbf63bf7f3e5e3f35,0xbf77bf253f683f7c,0x3db23f253f13a554,0x3f6d3f77bf1cbf77,0x3f4b3e85bf7ebf35
.quad 0x8000800080008000,0x8000800080008000,0x3f1c3f133eec3ed8,0x3f583f523f3d3f35,0xbf77bf71bf52bf44,0xbf68bf71bf7fbf80,0x3f6d3f773f7e3f77,0x3e063e853f1c3f35
.quad 0xbf00bf25bf71bf7c,0x3f443f253e32a50d,0xbe063db23f2d3f52,0xbf74bf7fbf58bf35,0x3f353f00be85bf00,0x3e853f003f773f80,0xbf7ebf68be5e3db2,0x3f2d3ed8beecbf35
.quad 0x3f5e3f7c3f253eaf,0xbf7cbf7cbeaf8000,0xbec4bf35bf6dbf35,0x3ec43f353f6d3f35,0xbe853e323f7f3f71,0x3f133e32bf68bf80,0x3f4b3ed8bf58bf7f,0xbf80bf683e9a3f35
.quad 0xbf80bf5e3f003f5e,0x3f003f5e3f00a50d,0x3f4b3f7fbd33bf13,0x3eecbdb2bf7abf35,0xbe85bf44bed83e32,0xbf7fbf443f523f80,0xbec43e853f4b3e85,0x3f1c3f77be06bf35
.quad 0x3f803f803f803f80,0x3f803f803f803f80,0xbf56bf5cbf6bbf70,0xbf1abf22bf3bbf42,0x3ece3ef63f313f40,0xbe8fbe483d863e1c,0x3e273d06beb4bef1,0x3f703f623f223f07
.quad 0xbf2dbf0abd333e06,0xbf58bf6dbf7ebf74,0x3f783f643edd3e69,0x3d9c3e953f503f6b,0xbf72bf7fbf40bf0e,0x3f403f0ebe48bee2,0x3f1e3f533f733f50,0xbf7bbf7fbf07be7e
.quad 0xbdb2bed8bf7fbf77,0x3ed83f353f773f52,0xbef1bdc93f623f7f,0x3ef13dc9bf62bf7f,0x3f603f17bf20bf66,0xbf7dbf553ea53f31,0xbf7fbf6b3e8a3f2f,0x3f373f753ed3bd5f
.quad 0x3f4b3f7e3e06bec4,0x3e06bec4bf6dbf1c,0xbeaabf49bf023d06,0xbf5fbef13f703f7b,0xbe733eba3f4e3ea5,0x3f6a3f7bbee2bf60,0x3f3b3e27bf79bf22,0xbe69bf46be953eb4
.quad 0x8000800080008000,0x8000800080008000,0x3f0c3f023ec93eb4,0x3f4d3f463f2f3f27,0xbf6abf60bf39bf29,0xbf76bf7bbf7fbf7d,0x3f7d3f803f703f62,0x3eb43ef13f463f59
.quad 0xbf3dbf58bf80bf7e,0x3f0a3ec4be06be9a,0x3e7e3ee73f673f79,0xbf7fbf75bf15bec9,0x3ea53d86bf29bf55,0x3f293f553f7b3f66,0xbf49bf113e9f3f15,0x3e53bdc9bf59bf78
.quad 0x3f7f3f683db2be85,0xbf68bf353e853f13,0xbf62bf7fbef1bdc9,0x3f623f7f3ef13dc9,0x3ef63f4e3f483ee2,0xbe1cbf0ebf72bf39,0x3d9cbec9bf77bf3b,0xbf33be953f693f80
.quad 0xbf1cbe063f7e3f6d,0x3f7e3f6dbec4bf4b,0x3f723f1ebf5cbf80,0xbefbbf62beb43e53,0xbf79bf6f3f173f72,0xbece3e483f663ef6,0x3f2f3f7dbe69bf46,0x3f793f22bf75bf70
.quad 0x3f803f803f803f80,0x3f803f803f803f80,0xbf49bf50bf62bf67,0xbf07bf11bf2bbf33,0x3e733ea53f0e3f20,0xbee2bebabddfbcb3,0x3ed33e95bdc9be69,0x3f7f3f793f503f3b
.quad 0xbf63bf4bbec4be5e,0xbf1cbf3dbf7abf80,0x3f7c3f803f463f1e,0xbeb4be113efb3f2b,0xbf29bf55bf7bbf66,0x3f7b3f663ea53d86,0x3d5f3eb43f753f80,0xbf2fbf5fbf6bbf42
.quad 0x3f133e85bf35bf68,0xbe853db23f683f7f,0xbf75bf463e953f22,0x3f753f46be95bf22,0x3f6f3f7f3e48be73,0xbf40bf76bf05bddf,0xbf02bf59bf22be53,0xbe273e9f3f7c3f49
.quad 0xbe063ec43f6d3f1c,0x3f6d3f1cbf4bbf7e,0x3f373e69bf7fbf64,0xbf50bf803d9c3f1a,0xbf7ebf403f553f80,0xbd863f053f313e1c,0x3f593f7fbef1bf69,0x3f623ed3bf80bf50
.quad 0x8000800080008000,0x8000800080008000,0x3f1e3f153ef13edd,0x3f593f533f3f3f37,0xbf79bf72bf55bf48,0xbf66bf6fbf7ebf80,0x3f693f753f7f3f79,0x3dc93e693f153f2f
.quad 0xbeecbf1cbf6dbf7a,0x3f4b3f2d3e5e3d33,0xbe3d3d063f223f49,0xbf70bf7dbf5fbf3f,0x3f403f0ebe48bee2,0x3e483ee23f723f7f,0xbf80bf70be953c33,0x3f3b3efbbec9bf27
.quad 0x3f523f773f353ed8,0xbf77bf7fbed8bdb2,0xbe95bf22bf75bf46,0x3e953f223f753f46,0xbeba3d863f7b3f79,0x3f293e8fbf5bbf7e,0x3f5c3f07bf46bf7b,0xbf7dbf733e3d3f1e
.quad 0xbf7ebf6d3ec43f4b,0x3ec43f4b3f1c3e06,0x3f333f793dc9bee7,0x3f153d5fbf7fbf4d,0xbddfbf29bf0e3cb3,0xbf7fbf5b3f393f7d,0xbf073dc93f623ed3,0x3ef13f693d06bf15
.quad 0x3f803f803f803f80,0x3f803f803f803f80,0xbf55bf5bbf6abf6f,0xbf17bf20bf39bf40,0x3ec43eec3f2d3f3d,0xbe9abe5e3d333e06,0x3e483d86bea5bee2,0x3f723f663f293f0e
.quad 0xbf35bf13bdb23db2,0xbf52bf68bf7fbf77,0x3f7b3f6a3ef63e8f,0x3cb33e733f483f66,0xbf6dbf7ebf4bbf1c,0x3f4b3f1cbe06bec4,0x3f0e3f483f793f5b,0xbf76bf80bf17bea5
.quad 0xa554beafbf7cbf7c,0x3eaf3f253f7c3f5e,0xbf0ebe483f553f7b,0x3f0e3e48bf55bf7b,0x3f6d3f2dbf0abf58,0xbf80bf633e5e3f1c,0xbf7bbf763e1c3f17,0x3f203f6a3f053d86
.quad 0x3f353f773e85be85,0x3e85be85bf77bf35,0xbe48bf31bf20bddf,0xbf6fbf173f603f7f,0xbec43e5e3f633eec,0x3f583f80be9abf4b,0x3f553ea5bf7fbf40,0xbd86bf29bee23e48
.quad 0x8000800080008000,0x8000800080008000,0x3f0e3f053ece3eba,0x3f4e3f483f313f29,0xbf6dbf63bf3dbf2d,0xbf74bf7abf80bf7e,0x3f7b3f7f3f723f66,0x3ea53ee23f403f55
.quad 0xbf35bf52bf7fbf7f,0x3f133ed8bdb2be85,0x3e483ece3f603f76,0xbf80bf79bf20bee2,0x3ec43e06bf1cbf4b,0x3f1c3f4b3f7e3f6d,0xbf55bf203e733f05,0x3e8fbcb3bf4ebf72
.quad 0x3f803f713e32be32,0xbf71bf443e323f00,0xbf55bf7bbf0ebe48,0x3f553f7b3f0e3e48,0x3ec43f3d3f583f0a,0xbd33beecbf7abf4b,0x3e48be8fbf7dbf4e,0xbf48bece3f5b3f7f
.quad 0xbf35be853f773f77,0x3f773f77be85bf35,0x3f7b3f39bf48bf7e,0xbebabf4ebef63d86,0xbf6dbf7a3eec3f63,0xbf0a3d333f743f1c,0x3f0e3f72bd86bf29,0x3f7f3f40bf66bf7b
.quad 0x3f803f803f803f80,0x3f803f803f803f80,0xbf48bf4ebf60bf66,0xbf05bf0ebf29bf31,0x3e5e3e9a3f0a3f1c,0xbeecbec4be06bd33,0x3ee23ea5bd86be48,0x3f7f3f7b3f553f40
.quad 0xbf68bf52bed8be85,0xbf13bf35bf77bf7f,0x3f793f803f4e3f29,0xbecebe483ee23f20,0xbf1cbf4bbf7ebf6d,0x3f7e3f6d3ec43e06,0xbcb33e8f3f6f3f7f,0xbf20bf55bf72bf4e
.quad 0x3f253eafbf25bf5e,0xbeaf248d3f5e3f7c,0xbf7bbf553e483f0e,0x3f7b3f55be48bf0e,0x3f633f803e9abe06,0xbf2dbf6dbf1cbe5e,0xbecebf48bf39bea5,0xbe8f3e483f7f3f5b
.quad 0xbe853e853f773f35,0x3f773f35bf35bf77,0x3f4e3ebabf79bf72,0xbf39bf7bbd863ef6,0xbf80bf583f3d3f7e,0xbe5e3ec43f4b3e9a,0x3f403f7fbea5bf55,0x3f723f0ebf7bbf66
.quad 0x8000800080008000,0x8000800080008000,0x3f203f173ef63ee2,0x3f5b3f553f403f39,0xbf7abf74bf58bf4b,0xbf63bf6dbf7ebf80,0x3f663f723f7f3f7b,0x3d863e483f0e3f29
.quad 0xbed8bf13bf68bf77,0x3f523f353e853db2,0xbe73bcb33f173f40,0xbf6abf7bbf66bf48,0x3f4b3f1cbe06bec4,0x3e063ec43f6d3f7e,0xbf80bf76bebabd86,0x3f483f0ebea5bf17
.quad 0x3f443f713f443f00,0xbf71bf80bf00be32,0xbe48bf0ebf7bbf55,0x3e483f0e3f7b3f55,0xbeecbd333f743f7e,0x3f3d3ec4bf4bbf7a,0x3f6a3f20bf31bf72,0xbf76bf7b3d863f05
.quad 0xbf77bf773e853f35,0x3e853f353f353e85,0x3f173f6f3e73bea5,0x3f313e48bf7fbf60,0x3d33bf0abf2dbe06,0xbf7abf6d3f1c3f74,0xbf29bd863f723f0e,0x3ea53f553e48bee2
.quad 0x3f803f803f803f80,0x3f803f803f803f80,0xbf53bf59bf69bf6e,0xbf15bf1ebf37bf3f,0x3eba3ee23f293f39,0xbea5be733cb33ddf,0x3e693dc9be95bed3,0x3f753f693f2f3f15
.quad 0xbf3dbf1cbe063d33,0xbf4bbf63bf80bf7a,0x3f7d3f703f073eaa,0xbd063e3d3f3f3f5f,0xbf66bf7bbf55bf29,0x3f553f29bd86bea5,0x3efb3f3b3f7d3f64,0xbf70bf80bf27bec9
.quad 0x3db2be85bf77bf7f,0x3e853f133f7f3f68,0xbf22be953f463f75,0x3f223e95bf46bf75,0x3f763f40bee2bf48,0xbf7fbf6f3ddf3f05,0xbf73bf7d3d063efb,0x3f073f5c3f1e3e3d
.quad 0x3f1c3f6d3ec4be06,0x3ec4be06bf7ebf4b,0xbd5fbf15bf3bbe7e,0xbf79bf333f4d3f7f,0xbf053d863f723f17,0x3f403f7ebe1cbf31,0x3f693ef1bf7fbf59,0x3dc9bf07bf153d06
.quad 0x8000800080008000,0x8000800080008000,0x3f113f073ed33ebf,0x3f503f493f333f2b,0xbf6fbf66bf40bf31,0xbf72bf79bf80bf7e,0x3f793f7f3f753f69,0x3e953ed33f3b3f50
.quad 0xbf2dbf4bbf7ebf80,0x3f1c3eecbd33be5e,0x3e113eb43f593f72,0xbf80bf7cbf2bbefb,0x3ee23e48bf0ebf40,0x3f0e3f403f7f3f72,0xbf5fbf2f3e273ee7,0x3eb43d5fbf42bf6b
.quad 0x3f7f3f773e85bdb2,0xbf77bf523db23ed8,0xbf46bf75bf22be95,0x3f463f753f223e95,0x3e8f3f293f663f20,0x3d86bebabf7ebf5b,0x3e9fbe27bf80bf5f,0xbf59bf023f493f7c
.quad 0xbf4bbec43f6d3f7e,0x3f6d3f7ebe06bf1c,0x3f803f50bf2fbf78,0xbe69bf37bf1abd9c,0xbf5bbf7f3ea53f4e,0xbf29bddf3f7d3f39,0x3ed33f623dc9bf07,0x3f7f3f59bf50bf80
.quad 0x3f803f803f803f80,0x3f803f803f803f80,0xbf46bf4dbf5fbf64,0xbf02bf0cbf27bf2f,0x3e483e8f3f053f17,0xbef6becebe1cbd86,0x3ef13eb4bd06be27,0x3f803f7d3f593f46
.quad 0xbf6dbf58beecbe9a,0xbf0abf2dbf74bf7e,0x3f753f7f3f563f33,0xbee7be7e3ec93f15,0xbf0ebf40bf7fbf72,0x3f7f3f723ee23e48,0xbdc93e533f673f7d,0xbf11bf49bf78bf59
.quad 0x3f353ed8bf13bf52,0xbed8bdb23f523f77,0xbf7fbf623dc93ef1,0x3f7f3f62bdc9bef1,0x3f553f7d3ecebcb3,0xbf17bf60bf31bea5,0xbe95bf33bf4dbedd,0xbec93d9c3f803f69
.quad 0xbec43e063f7e3f4b,0x3f7e3f4bbf1cbf6d,0x3f623efbbf6ebf7c,0xbf1ebf72be533eb4,0xbf7bbf6a3f203f76,0xbeba3e733f603ee2,0x3f223f79be27bf3b,0x3f7d3f2fbf70bf75
.quad 0x8000800080008000,0x8000800080008000,0x3f223f1a3efb3ee7,0x3f5c3f563f423f3b,0xbf7bbf76bf5bbf4e,0xbf60bf6abf7dbf7f,0x3f623f703f803f7d,0x3d063e273f073f22
.quad 0xbec4bf0abf63bf74,0x3f583f3d3e9a3e06,0xbe95bd9c3f0c3f37,0xbf64bf78bf6bbf50,0x3f553f29bd86bea5,0x3d863ea53f663f7b,0xbf7fbf7bbeddbe11,0x3f533f1ebe7ebf07
.quad 0x3f353f683f523f13,0xbf68bf7fbf13be85,0xbdc9bef1bf7fbf62,0x3dc93ef13f7f3f62,0xbf0ebe1c3f6a3f80,0x3f4e3ef6bf39bf72,0x3f753f37bf1abf67,0xbf6bbf7fbd5f3ed3
.quad 0xbf6dbf7e3e063f1c,0x3e063f1c3f4b3ec4,0x3ef13f5f3ebfbe3d,0x3f493eaabf7bbf70,0x3e48becebf48be8f,0xbf6fbf793ef63f66,0xbf46be693f7d3f2f,0x3e273f3b3eb4be95
.quad 0x3f803f803f803f80,0x3f803f803f803f80,0xbe9abeafbeecbf00,0x3d33a554be06be32,0xbf52bf44bf13bf00,0xbf7fbf80bf77bf71,0x3f4b3f5e3f7e3f80,0xbe06248d3ec43f00
.quad 0x3eaf3e32beafbf00,0x3f7c3f803f5e3f44,0xbf80bf7cbf2dbf00,0x3e5ea554bf1cbf44,0x3e853f003f773f80,0xbf77bf80bf35bf00,0x3f583f25be5ebf00,0xbe9a248d3f4b3f71
.quad 0xbf44bf71bf44bf00,0x3f713f803f003e32,0xbec4248d3f6d3f80,0x3ec4a554bf6dbf80,0x3f7f3f71bdb2bf00,0xbf68bf80be853e32,0xbe5ebf25bf58bf00,0xbeec248d3f7e3f71
.quad 0xbf5ebf003f5e3f80,0x3f5e3f80a554bf00,0x3f3d3f7c3d33bf00,0x3f0aa554bf7ebf44,0x3ed8be32bf68bf00,0xbf52bf803e853f44,0xbf7ebf5e3f4b3f80,0xbf1c248d3f6d3f00
.quad 0x8000800080008000,0x8000800080008000,0x3f743f713f633f5e,0x3f803f803f7e3f7c,0xbf13bf25bf52bf5e,0x3db2a50dbe85beaf,0xbf1cbf00be068000,0xbf7ebf80bf6dbf5e
.quad 0x3f713f7c3f713f5e,0xbe3280003f003f25,0x3d33be32bf3dbf5e,0x3f7a3f803f4b3f25,0xbf77bf5ebe858000,0x3e85a50dbf35bf5e,0x3f0a3f443f7a3f5e,0xbf74bf80bf1cbeaf
.quad 0x3f253eafbf25bf5e,0xbeaf80003f5e3f7c,0xbf6dbf80bec48000,0x3f6d3f803ec4a50d,0xbdb23eaf3f7f3f5e,0x3ed8a50dbf77bf7c,0x3f7a3f44bf0abf5e,0xbf63bf80be063eaf
.quad 0xbf00bf5ebf008000,0xbf0080003f803f5e,0xbf2dbe323f803f5e,0x3f583f80be06bf25,0x3f683f7cbed8bf5e,0x3f13a50dbf77bf25,0x3e06bf00bf1c8000,0xbf4bbf803ec43f5e
.quad 0x3f803f803f803f80,0x3f803f803f803f80,0xbe5ebe85bec4bed8,0x3e063db2bd33bdb2,0xbf68bf5ebf35bf25,0xbf77bf7cbf7fbf7c,0x3f1c3f353f6d3f77,0xbec4be853e063e85
.quad 0x3f253f00a554be32,0x3f5e3f713f7c3f71,0xbf63bf77bf6dbf52,0x3f1c3ed8be5ebed8,0xbe85248d3f353f5e,0xbf35bf5ebf77bf5e,0x3f803f773ec43db2,0xbf4bbf133e9a3f13
.quad 0xbe32bf00bf80bf71,0x3f003f443f713f44,0xbf6dbf353ec43f35,0x3f6d3f35bec4bf35,0x3f133f5e3f353eaf,0xbe85bf25bf68bf25,0x3f2d3e85bf6dbf7f,0xbf7ebf523eec3f52
.quad 0xbf5ebf80248d3f00,0x248d3f003f5e3f00,0xbe9a3e853f6d3f13,0x3f7e3f68bf0abf68,0x3f7f3f5ebf35bf7c,0x3e85beafbf52beaf,0xbe06bf35bec43e85,0xbf6dbf773f1c3f77
.quad 0x8000800080008000,0x8000800080008000,0x3f7a3f773f6d3f68,0x3f7e3f7f3f803f7f,0xbed8bf00bf35bf44,0x3e853e32bdb2be32,0xbf4bbf35bec4be85,0xbf6dbf77bf7ebf77
.quad 0x3f443f5e3f803f7c,0xbf00beaf3e323eaf,0x3eec3e85bec4bf13,0x3f4b3f683f7a3f68,0xbf77bf80bf35bf00,0x3f353f00be85bf00,0xbd333e853f6d3f7f,0xbf1cbf52bf74bf52
.quad 0x3f7c3f5ea50dbeaf,0xbf5ebf253eaf3f25,0xbec4bf35bf6dbf35,0x3ec43f353f6d3f35,0xbf52bf003f353f71,0x3f773f44bed8bf44,0x3f3d3f773ec4bdb2,0xbe06bf13bf63bf13
.quad 0x3f00a50dbf80bf5e,0xbf80bf5e3f003f5e,0xbf74bf773ec43f52,0xbe063ed83f583ed8,0xbdb23f003f353e32,0x3f773f71bf13bf71,0x3f7e3f35bf6dbf77,0x3ec4be85bf4bbe85
.quad 0x3f803f803f803f80,0x3f803f803f803f80,0xbe95beaabee7befb,0x3d5f3c33bdf5be27,0xbf55bf48bf17bf05,0xbf7ebf80bf79bf72,0x3f463f593f7d3f80,0xbe27bd063eb43ef1
.quad 0x3ec43e5ebe9abeec,0x3f7a3f803f633f4b,0xbf7fbf7ebf37bf0c,0x3e8a3d5fbf11bf3b,0x3e483ee23f723f7f,0xbf72bf7fbf40bf0e,0x3f623f33be11bedd,0xbebfbd9c3f3f3f69
.quad 0xbf35bf68bf52bf13,0x3f683f7f3f133e85,0xbef1bdc93f623f7f,0x3ef13dc9bf62bf7f,0x3f7b3f793cb3bece,0xbf5bbf7ebeba3d86,0xbdc9bf0cbf67bf1a,0xbf11bdf53f783f79
.quad 0xbf6dbf1c3f4b3f7e,0x3f4b3f7e3e06bec4,0x3f223f733e3dbebf,0x3f273e11bf80bf59,0x3f0ebcb3bf76bf20,0xbf39bf7d3ddf3f29,0xbf75bf703f2f3f7d,0xbf3bbe273f793f22
.quad 0x8000800080008000,0x8000800080008000,0x3f753f723f643f5f,0x3f803f803f7e3f7d,0xbf0ebf20bf4ebf5b,0x3ddf3cb3be73bea5,0xbf22bf07be27bd06,0xbf7dbf80bf70bf62
.quad 0x3f6d3f7a3f743f63,0xbe5ebd333eec3f1c,0x3dc9bdf5bf33bf56,0x3f773f803f533f2f,0xbf7bbf66bea5bd86,0x3ea53d86bf29bf55,0x3ef13f373f7d3f67,0xbf6ebf7fbf2bbed3
.quad 0x3f353ed8bf13bf52,0xbed8bdb23f523f77,0xbf62bf7fbef1bdc9,0x3f623f7f3ef13dc9,0xbe483e733f803f6a,0x3f053ddfbf6fbf7f,0x3f7f3f56beddbf4d,0xbf53bf7ebe7e3e69
.quad 0xbec4bf4bbf1cbe06,0xbf1cbe063f7e3f6d,0xbf46be9f3f7c3f6e,0x3f423f7d3c33bf07,0x3f553f80be8fbf48,0x3f313e1cbf7ebf40,0x3e95beb4bf3bbe27,0xbf2fbf7d3e693f46
.quad 0x3f803f803f803f80,0x3f803f803f803f80,0xbe53be7ebebfbed3,0x3e113dc9bd06bd9c,0xbf6abf60bf39bf29,0xbf76bf7bbf7fbf7d,0x3f153f2f3f693f75,0xbed3be953dc93e69
.quad 0x3f2d3f0a3d33be06,0x3f583f6d3f7e3f74,0xbf5cbf73bf72bf59,0x3f273ef1be27bebf,0xbea5bd863f293f55,0xbf29bf55bf7bbf66,0x3f7e3f7c3ee73e27,0xbf56bf223e693f02
.quad 0xbdb2bed8bf7fbf77,0x3ed83f353f773f52,0xbf75bf463e953f22,0x3f753f46be95bf22,0x3ef63f4e3f483ee2,0xbe1cbf0ebf72bf39,0x3f423ebfbf5fbf80,0xbf80bf623eb43f3f
.quad 0xbf4bbf7ebe063ec4,0xbe063ec43f6d3f1c,0xbedd3df53f783f2f,0x3f773f75bed3bf56,0x3f793f6fbf17bf72,0x3ecebe48bf66bef6,0x3d06bf15bf073dc9,0xbf59bf7f3ef13f69
.quad 0x8000800080008000,0x8000800080008000,0x3f7b3f783f6e3f69,0x3f7d3f7f3f803f7f,0xbecebef6bf31bf40,0x3e8f3e48bd86be1c,0xbf50bf3bbed3be95,0xbf69bf75bf7fbf79
.quad 0x3f3d3f583f803f7e,0xbf0abec43e063e9a,0x3f023e9fbeaabf07,0x3f423f623f7d3f6e,0xbf72bf7fbf40bf0e,0x3f403f0ebe48bee2,0xbdf53e3d3f643f7d,0xbf0cbf46bf79bf5c
.quad 0x3f7f3f683db2be85,0xbf68bf353e853f13,0xbe95bf22bf75bf46,0x3e953f223f753f46,0xbf60bf173f203f66,0x3f7d3f55bea5bf31,0x3f273f6e3efb3d06,0xbc33bef1bf70bf2b
.quad 0x3f1c3e06bf7ebf6d,0xbf7ebf6d3ec43f4b,0xbf67bf7e3e7e3f3b,0xbe8a3e953f693f0c,0xbe733eba3f4e3ea5,0x3f6a3f7bbee2bf60,0x3f803f50bf59bf7f,0x3f07bdc9bf62bed3
.quad 0x3f803f803f803f80,0x3f803f803f803f80,0xbe8fbea5bee2bef6,0x3d863cb3bddfbe1c,0xbf58bf4bbf1cbf0a,0xbf7ebf80bf7abf74,0x3f403f553f7b3f7f,0xbe48bd863ea53ee2
.quad 0x3ed83e85be85bed8,0x3f773f7f3f683f52,0xbf7dbf7fbf40bf17,0x3ea53ddfbf05bf31,0x3e063ec43f6d3f7e,0xbf6dbf7ebf4bbf1c,0x3f6a3f40bd86beba,0xbee2be1c3f313f60
.quad 0xbf25bf5ebf5ebf25,0x3f5e3f7c3f253eaf,0xbf0ebe483f553f7b,0x3f0e3e48bf55bf7b,0x3f743f7e3e06be9a,0xbf4bbf7abeecbd33,0x3cb3bee2bf72bf31,0xbf29be733f6f3f7e
.quad 0xbf77bf353f353f77,0x3f353f773e85be85,0x3f053f663ea5be73,0x3f403e8fbf7dbf6a,0x3f2d3e06bf7ebf3d,0xbf1cbf74bd333f0a,0xbf66bf7b3f0e3f72,0xbf55bea53f7f3f40
.quad 0x8000800080008000,0x8000800080008000,0x3f763f723f663f60,0x3f7f3f803f7e3f7d,0xbf0abf1cbf4bbf58,0x3e063d33be5ebe9a,0xbf29bf0ebe48bd86,0xbf7bbf7fbf72bf66
.quad 0x3f683f773f773f68,0xbe85bdb23ed83f13,0x3e1cbd86bf29bf4e,0x3f723f7e3f5b3f39,0xbf7ebf6dbec4be06,0x3ec43e06bf1cbf4b,0x3ece3f293f7f3f6f,0xbf66bf7dbf39bef6
.quad 0x3f443f00bf00bf44,0xbf00be323f443f71,0xbf55bf7bbf0ebe48,0x3f553f7b3f0e3e48,0xbe9a3e063f7e3f74,0x3f1c3e5ebf63bf80,0x3f803f66bea5bf39,0xbf40bf79beba3ddf
.quad 0xbe85bf35bf35be85,0xbf35be853f773f77,0xbf5bbee23f723f79,0x3f293f763e1cbece,0x3f3d3f7ebe06bf2d,0x3f4b3e9abf80bf58,0x3ee2be48bf55bea5,0xbf0ebf723d863f29
.quad 0x3f803f803f803f80,0x3f803f803f803f80,0xbe48be73bebabece,0x3e1c3ddfbcb3bd86,0xbf6dbf63bf3dbf2d,0xbf74bf7abf80bf7e,0x3f0e3f293f663f72,0xbee2bea53d863e48
.quad 0x3f353f133db2bdb2,0x3f523f683f7f3f77,0xbf55bf6fbf76bf60,0x3f313f05bddfbea5,0xbec4be063f1c3f4b,0xbf1cbf4bbf7ebf6d,0x3f7b3f7e3f053e73,0xbf60bf313e1c3ee2
.quad 0xa554beafbf7cbf7c,0x3eaf3f253f7c3f5e,0xbf7bbf553e483f0e,0x3f7b3f55be48bf0e,0x3ec43f3d3f583f0a,0xbd33beecbf7abf4b,0x3f553ef6bf4ebf7d,0xbf7ebf6f3e733f29
.quad 0xbf35bf77be853e85,0xbe853e853f773f35,0xbf0ebcb33f7e3f48,0x3f6a3f7dbe8fbf40,0x3f6d3f7abeecbf63,0x3f0abd33bf74bf1c,0x3e48bee2bf29bd86,0xbf40bf7f3ea53f55
.quad 0x8000800080008000,0x8000800080008000,0x3f7b3f793f6f3f6a,0x3f7d3f7e3f803f7f,0xbec4beecbf2dbf3d,0x3e9a3e5ebd33be06,0xbf55bf40bee2bea5,0xbf66bf72bf7fbf7b
.quad 0x3f353f523f7f3f7f,0xbf13bed83db23e85,0x3f0e3ebabe8fbef6,0x3f393f5b3f7e3f72,0xbf6dbf7ebf4bbf1c,0x3f4b3f1cbe06bec4,0xbe483ddf3f5b3f79,0xbef6bf39bf7dbf66
.quad 0x3f803f713e32be32,0xbf71bf443e323f00,0xbe48bf0ebf7bbf55,0x3e483f0e3f7b3f55,0xbf6dbf2d3f0a3f58,0x3f803f63be5ebf1c,0x3f0e3f603f173e1c,0x3ddfbebabf79bf40
.quad 0x3f353e85bf77bf77,0xbf77bf773e853f35,0xbf55bf803ddf3f20,0xbece3e1c3f763f29,0xbec43e5e3f633eec,0x3f583f80be9abf4b,0x3f7b3f66bf40bf7f,0x3f293d86bf72bf0e
.quad 0x3f803f803f803f80,0x3f803f803f803f80,0xbe8abe9fbeddbef1,0x3d9c3d06bdc9be11,0xbf5bbf4ebf20bf0e,0xbf7dbf7fbf7bbf76,0x3f3b3f503f793f7f,0xbe69bdc93e953ed3
.quad 0x3eec3e9abe5ebec4,0x3f743f7e3f6d3f58,0xbf7bbf80bf49bf22,0x3ebf3e27bef1bf27,0x3d863ea53f663f7b,0xbf66bf7bbf55bf29,0x3f723f4d3c33be95,0xbf02be693f223f56
.quad 0xbf13bf52bf68bf35,0x3f523f773f353ed8,0xbf22be953f463f75,0x3f223e95bf46bf75,0x3f6a3f803e73be48,0xbf39bf72bf0ebe1c,0x3e11beaabf7bbf46,0xbf3fbeb43f623f80
.quad 0xbf7ebf4b3f1c3f6d,0x3f1c3f6d3ec4be06,0x3ec93f533ee7bdc9,0x3f563ed3bf75bf77,0x3f483e8fbf80bf55,0xbef6bf66be483ece,0xbf50bf803ed33f62,0xbf69bef13f7f3f59
.quad 0x8000800080008000,0x8000800080008000,0x3f773f733f673f62,0x3f7f3f803f7f3f7d,0xbf05bf17bf48bf55,0x3e1c3d86be48be8f,0xbf2fbf15be69bdc9,0xbf79bf7fbf75bf69
.quad 0x3f633f743f7a3f6d,0xbe9abe063ec43f0a,0x3e53bc33bf1ebf46,0x3f6e3f7d3f623f42,0xbf7fbf72bee2be48,0x3ee23e48bf0ebf40,0x3eaa3f1a3f803f75,0xbf5cbf79bf46bf0c
.quad 0x3f523f13bed8bf35,0xbf13be853f353f68,0xbf46bf75bf22be95,0x3f463f753f223e95,0xbece3cb33f793f7b,0x3f313ea5bf55bf7d,0x3f7d3f72be53bf22,0xbf2bbf70bef1bc33
.quad 0xbe06bf1cbf4bbec4,0xbf4bbec43f6d3f7e,0xbf6bbf113f643f7f,0x3f0c3f693e95be8a,0x3f203f763cb3bf0e,0x3f603ee2bf7bbf6a,0x3f15bd06bf69bef1,0xbed3bf62bdc93f07
.quad 0x3f803f803f803f80,0x3f803f803f803f80,0xbe3dbe69beb4bec9,0x3e273df5bc33bd5f,0xbf6fbf66bf40bf31,0xbf72bf79bf80bf7e,0x3f073f223f623f70,0xbef1beb43d063e27
.quad 0x3f3d3f1c3e06bd33,0x3f4b3f633f803f7a,0xbf4dbf69bf79bf67,0x3f3b3f11bd5fbe8a,0xbee2be483f0e3f40,0xbf0ebf40bf7fbf72,0x3f773f803f153e9f,0xbf69bf3f3d9c3ebf
.quad 0x3db2be85bf77bf7f,0x3e853f133f7f3f68,0xbf7fbf623dc93ef1,0x3f7f3f62bdc9bef1,0x3e8f3f293f663f20,0x3d86bebabf7ebf5b,0x3f643f15bf3bbf77,0xbf79bf783df53f11
.quad 0xbf1cbf6dbec43e06,0xbec43e063f7e3f4b,0xbf2bbe273f803f5c,0x3f593f80be11bf27,0x3f5b3f7fbea5bf4e,0x3f293ddfbf7dbf39,0x3eb4be95bf46be69,0xbf22bf793e273f3b
.quad 0x8000800080008000,0x8000800080008000,0x3f7c3f793f703f6b,0x3f7d3f7e3f803f80,0xbebabee2bf29bf39,0x3ea53e73bcb3bddf,0xbf59bf46bef1beb4,0xbf62bf70bf80bf7d
.quad 0x3f2d3f4b3f7e3f80,0xbf1cbeec3d333e5e,0x3f1a3ed3be69bedd,0x3f2f3f533f803f77,0xbf66bf7bbf55bf29,0x3f553f29bd86bea5,0xbe8a3d063f503f73,0xbed3bf2bbf7fbf6e
.quad 0x3f7f3f773e85bdb2,0xbf77bf523db23ed8,0xbdc9bef1bf7fbf62,0x3dc93ef13f7f3f62,0xbf76bf403ee23f48,0x3f7f3f6fbddfbf05,0x3ee73f503f2f3e8a,0x3e69be7ebf7ebf53
.quad 0x3f4b3ec4bf6dbf7e,0xbf6dbf7e3e063f1c,0xbf3fbf7dbd063f02,0xbf073c333f7d3f42,0xbf053d863f723f17,0x3f403f7ebe1cbf31,0x3f703f75bf22bf79,0x3f463e69bf7dbf2f
.quad 0x3f803f803f803f80,0x3f803f803f803f80,0x3ec43eaf3e5e3e32,0x3f2d3f253f0a3f00,0xbf35bf44bf68bf71,0xbdb2be32bed8bf00,0xbf6dbf5ebf1cbf00,0xbf4bbf5ebf7ebf80
.quad 0x248d3e323f253f44,0xbf7cbf71bf25bf00,0x3f6d3f7c3f633f44,0xbf0abeaf3e9a3f00,0x3f353f00be85bf00,0x3e853f003f773f80,0xbec4bf25bf80bf71,0x3f633f7c3f3d3f00
.quad 0xbf80bf71be323e32,0x3f713f44be32bf00,0xbec4248d3f6d3f80,0x3ec4a554bf6dbf80,0x3f353f713f133e32,0xbed8bf44bf52bf00,0x3f6d3f25bf2dbf71,0xbf74bf7c3d333f00
.quad 0xa554bf00bf5ebf00,0xbf5ebf003f5e3f80,0xbf6dbf7c3e9a3f44,0xbe5e3eaf3f633f00,0xbf35be323f7f3f44,0x3f133f713db2bf00,0x3ec43f5e3e06bf00,0x3f7e3f5ebf4bbf80
.quad 0x8000800080008000,0x8000800080008000,0x3f6d3f713f7a3f7c,0x3f3d3f443f583f5e,0x3f353f253ed83eaf,0x3f7f3f7c3f683f5e,0xbec4bf00bf4bbf5e,0x3f1c3f003e06a50d
.quad 0xbf80bf7cbf44bf25,0xbe32beafbf44bf5e,0xbec4be323eec3f25,0xbf58bf71bf74bf5e,0x3f353f5e3f773f5e,0xbf77bf5ebe858000,0x3f6d3f44bd33beaf,0xbeecbe323f2d3f5e
.quad 0xa50dbeafbf7cbf7c,0x3eaf3f253f7c3f5e,0xbf6dbf80bec48000,0x3f6d3f803ec4a50d,0xbf35beaf3f523f7c,0x3f683f25bf13bf5e,0x3ec43f443f3d3eaf,0x3e9abe32bf80bf5e
.quad 0x3f803f5ebf00bf5e,0xbf00bf5ebf008000,0x3ec4be32bf74bf25,0xbf7abf713eec3f5e,0xbf35bf7c3db23f25,0xbf52beaf3f7f3f5e,0xbf6dbf003f7e3f5e,0xbe063f003f1ca50d
.quad 0x3f803f803f803f80,0x3f803f803f803f80,0x3eec3ed83e9a3e85,0x3f3d3f353f1c3f13,0xbf13bf25bf52bf5e,0x3db2a554be85beaf,0xbf7ebf77bf4bbf35,0xbf1cbf35bf6dbf77
.quad 0xbeafbe323eaf3f00,0xbf7cbf80bf5ebf44,0x3f2d3f523f803f77,0xbf58bf35be063db2,0x3f773f5e3e85a554,0xbe85248d3f353f5e,0x3e5ebdb2bf58bf77,0x3eec3f353f7e3f68
.quad 0xbf44bf71bf44bf00,0x3f713f803f003e32,0xbf6dbf353ec43f35,0x3f6d3f35bec4bf35,0xbdb23eaf3f7f3f5e,0x3ed8a554bf77bf7c,0x3f583f7f3e5ebe85,0xbe9abf35bf4bbed8
.quad 0x3f5e3f00bf5ebf80,0xbf5ebf80248d3f00,0xbd33bf13bf3dbe85,0xbf7abf353f4b3f7f,0xbf68bf7c3ed83f5e,0xbf13248d3f773f25,0xbf4bbe853f7e3f35,0x3e063f353ec4be85
.quad 0x8000800080008000,0x8000800080008000,0x3f633f683f743f77,0x3f2d3f353f4b3f52,0x3f523f443f133f00,0x3f7f3f803f773f71,0xbe06be85bf1cbf35,0x3f4b3f353ec43e85
.quad 0xbf71bf7cbf71bf5e,0x3e32a50dbf00bf25,0xbf3dbf133d333e85,0xbf0abf35bf7ebf7f,0x3e853f003f773f80,0xbf77bf80bf35bf00,0x3f7a3f7f3f0a3e85,0xbf63bf353e063ed8
.quad 0x3f253eafbf25bf5e,0xbeaf80003f5e3f7c,0xbec4bf35bf6dbf35,0x3ec43f353f6d3f35,0xbf7fbf713db23f00,0x3f683f803e85be32,0xbf0abdb23f7a3f77,0x3f743f35bf1cbf68
.quad 0x3f003f5e3f00a50d,0x3f00a50dbf80bf5e,0x3f803f52bf2dbf77,0xbe5ebf35bf1cbdb2,0x3ed8be32bf68bf00,0xbf52bf803e853f44,0xbf1cbf773e063f35,0xbf7ebf353f6d3f77
.quad 0x3f803f803f803f80,0x3f803f803f803f80,0x3ec93eb43e693e3d,0x3f2f3f273f0c3f02,0xbf31bf40bf66bf6f,0xbd86be1cbecebef6,0xbf70bf62bf22bf07,0xbf46bf59bf7dbf80
.quad 0xbd333e063f1c3f3d,0xbf7ebf74bf2dbf0a,0x3f673f793f693f4d,0xbf15bec93e7e3ee7,0x3f403f0ebe48bee2,0x3e483ee23f723f7f,0xbe9fbf15bf80bf77,0x3f593f783f493f11
.quad 0xbf7fbf77be853db2,0x3f773f52bdb2bed8,0xbef1bdc93f623f7f,0x3ef13dc9bf62bf7f,0x3f203f663f293e8f,0xbea5bf31bf60bf17,0x3f773f3bbf15bf64,0xbf69bf80bd9c3ec9
.quad 0x3e06bec4bf6dbf1c,0xbf6dbf1c3f4b3f7e,0xbf5cbf803e273f2b,0xbeb43e533f723f1e,0xbf4ebea53f7f3f5b,0x3ee23f603e73beba,0x3e693f463e95beb4,0x3f753f70bf2fbf7d
.quad 0x8000800080008000,0x8000800080008000,0x3f6b3f703f793f7c,0x3f3b3f423f563f5c,0x3f393f293ee23eba,0x3f7f3f7d3f6a3f60,0xbeb4bef1bf46bf59,0x3f223f073e273d06
.quad 0xbf80bf7ebf4bbf2d,0xbe06be9abf3dbf58,0xbeddbe693ed33f1a,0xbf50bf6bbf78bf64,0x3f293f553f7b3f66,0xbf7bbf66bea5bd86,0x3f733f503d06be8a,0xbf07be7e3f1e3f53
.quad 0x3db2be85bf77bf7f,0x3e853f133f7f3f68,0xbf62bf7fbef1bdc9,0x3f623f7f3ef13dc9,0xbf48bee23f403f76,0x3f723f39bef6bf4e,0x3e8a3f2f3f503ee7,0x3ed3bd5fbf7fbf6b
.quad 0x3f7e3f6dbec4bf4b,0xbec4bf4bbf1cbe06,0x3f02bd06bf7dbf3f,0xbf70bf7b3eaa3f49,0xbf17bf72bd863f05,0xbf66bef63f793f6f,0xbf79bf223f753f70,0xbe953eb43f3b3e27
.quad 0x3f803f803f803f80,0x3f803f803f803f80,0x3ef13edd3e9f3e8a,0x3f3f3f373f1e3f15,0xbf0ebf20bf4ebf5b,0x3ddf3cb3be73bea5,0xbf7fbf79bf50bf3b,0xbf15bf2fbf69bf75
.quad 0xbec4be5e3e9a3eec,0xbf7abf80bf63bf4b,0x3f223f493f803f7b,0xbf5fbf3fbe3d3d06,0x3f7b3f663ea53d86,0xbea5bd863f293f55,0x3e95bc33bf4dbf72,0x3ec93f273f803f70
.quad 0xbf35bf68bf52bf13,0x3f683f7f3f133e85,0xbf75bf463e953f22,0x3f753f46be95bf22,0xbe483e733f803f6a,0x3f053ddfbf6fbf7f,0x3f463f7b3eaabe11,0xbe3dbf1ebf5cbf07
.quad 0x3f6d3f1cbf4bbf7e,0xbf4bbf7ebe063ec4,0x3dc9bee7bf53bec9,0xbf7fbf4d3f333f79,0xbf55bf803e8f3f48,0xbf31be1c3f7e3f40,0xbf62bed33f803f50,0xbd063f153f07bdc9
.quad 0x8000800080008000,0x8000800080008000,0x3f623f673f733f77,0x3f2b3f333f493f50,0x3f553f483f173f05,0x3f7e3f803f793f72,0xbdc9be69bf15bf2f,0x3f503f3b3ed33e95
.quad 0xbf6dbf7abf74bf63,0x3e5e3d33beecbf1c,0xbf46bf1ebc333e53,0xbefbbf2bbf7cbf80,0x3e483ee23f723f7f,0xbf72bf7fbf40bf0e,0x3f753f803f1a3eaa,0xbf6bbf423d5f3eb4
.quad 0x3f353ed8bf13bf52,0xbed8bdb23f523f77,0xbe95bf22bf75bf46,0x3e953f223f753f46,0xbf7bbf79bcb33ece,0x3f5b3f7e3ebabd86,0xbf22be533f723f7d,0x3f7c3f49bf02bf59
.quad 0x3ec43f4b3f1c3e06,0x3f1c3e06bf7ebf6d,0x3f7f3f64bf11bf6b,0xbd9cbf1abf37be69,0x3f0ebcb3bf76bf20,0xbf39bf7d3ddf3f29,0xbef1bf69bd063f15,0xbf80bf503f593f7f
.quad 0x3f803f803f803f80,0x3f803f803f803f80,0x3ece3eba3e733e48,0x3f313f293f0e3f05,0xbf2dbf3dbf63bf6d,0xbd33be06bec4beec,0xbf72bf66bf29bf0e,0xbf40bf55bf7bbf7f
.quad 0xbdb23db23f133f35,0xbf7fbf77bf35bf13,0x3f603f763f6f3f55,0xbf20bee23e483ece,0x3f4b3f1cbe06bec4,0x3e063ec43f6d3f7e,0xbe73bf05bf7ebf7b,0x3f4e3f723f553f20
.quad 0xbf7cbf7cbeaf248d,0x3f7c3f5ea554beaf,0xbf0ebe483f553f7b,0x3f0e3e48bf55bf7b,0x3f0a3f583f3d3ec4,0xbe5ebf1cbf6dbf2d,0x3f7d3f4ebef6bf55,0xbf5bbf7fbe483e8f
.quad 0x3e85be85bf77bf35,0xbf77bf353f353f77,0xbf48bf7e3cb33f0e,0xbef63d863f7b3f39,0xbf63beec3f7a3f6d,0x3e9a3f4b3ec4be5e,0x3d863f293ee2be48,0x3f663f7bbf0ebf72
.quad 0x8000800080008000,0x8000800080008000,0x3f6a3f6f3f793f7b,0x3f393f403f553f5b,0x3f3d3f2d3eec3ec4,0x3f803f7e3f6d3f63,0xbea5bee2bf40bf55,0x3f293f0e3e483d86
.quad 0xbf7fbf7fbf52bf35,0xbdb2be85bf35bf52,0xbef6be8f3eba3f0e,0xbf48bf66bf7bbf6a,0x3f1c3f4b3f7e3f6d,0xbf7ebf6dbec4be06,0x3f793f5b3ddfbe48,0xbf17bea53f0e3f48
.quad 0x3e32be32bf71bf80,0x3e323f003f803f71,0xbf55bf7bbf0ebe48,0x3f553f7b3f0e3e48,0xbf58bf0a3f2d3f6d,0x3f7a3f4bbec4bf3d,0x3e1c3f173f603f0e,0x3f053d86bf7bbf76
.quad 0x3f773f77be85bf35,0xbe85bf35bf35be85,0x3f203ddfbf80bf55,0xbf60bf7f3e483f31,0xbeecbf63be5e3ec4,0xbf74bf1c3f6d3f7a,0xbf7fbf403f663f7b,0xbee23e483f553ea5
.quad 0x3f803f803f803f80,0x3f803f803f803f80,0x3ef63ee23ea53e8f,0x3f403f393f203f17,0xbf0abf1cbf4bbf58,0x3e063d33be5ebe9a,0xbf7fbf7bbf55bf40,0xbf0ebf29bf66bf72
.quad 0xbed8be853e853ed8,0xbf77bf7fbf68bf52,0x3f173f403f7f3f7d,0xbf66bf48be73bcb3,0x3f7e3f6d3ec43e06,0xbec4be063f1c3f4b,0x3eba3d86bf40bf6a,0x3ea53f173f803f76
.quad 0xbf25bf5ebf5ebf25,0x3f5e3f7c3f253eaf,0xbf7bbf553e483f0e,0x3f7b3f55be48bf0e,0xbe9a3e063f7e3f74,0x3f1c3e5ebf63bf80,0x3f313f723ee2bcb3,0xbd86bf05bf6abf20
.quad 0x3f773f35bf35bf77,0xbf35bf77be853e85,0x3e73bea5bf66bf05,0xbf7fbf603f173f6f,0xbf3dbf7e3e063f2d,0xbf4bbe9a3f803f58,0xbf72bf0e3f7b3f66,0xbe483ee23f293d86
.quad 0x8000800080008000,0x8000800080008000,0x3f603f663f723f76,0x3f293f313f483f4e,0x3f583f4b3f1c3f0a,0x3f7e3f803f7a3f74,0xbd86be48bf0ebf29,0x3f553f403ee23ea5
.quad 0xbf68bf77bf77bf68,0x3e853db2bed8bf13,0xbf4ebf29bd863e1c,0xbee2bf20bf79bf80,0x3e063ec43f6d3f7e,0xbf6dbf7ebf4bbf1c,0x3f6f3f7f3f293ece,0xbf72bf4ebcb33e8f
.quad 0x3f443f00bf00bf44,0xbf00be323f443f71,0xbe48bf0ebf7bbf55,0x3e483f0e3f7b3f55,0xbf74bf7ebe063e9a,0x3f4b3f7a3eec3d33,0xbf39bea53f663f80,0x3f7f3f5bbecebf48
.quad 0x3e853f353f353e85,0x3f353e85bf77bf77,0x3f793f72bee2bf5b,0x3d86bef6bf4ebeba,0x3f2d3e06bf7ebf3d,0xbf1cbf74bd333f0a,0xbea5bf55be483ee2,0xbf7bbf663f403f7f
.quad 0x3f803f803f803f80,0x3f803f803f803f80,0x3ed33ebf3e7e3e53,0x3f333f2b3f113f07,0xbf29bf39bf60bf6a,0xbcb3bddfbebabee2,0xbf75bf69bf2fbf15,0xbf3bbf50bf79bf7f
.quad 0xbe063d333f0a3f2d,0xbf80bf7abf3dbf1c,0x3f593f723f733f5c,0xbf2bbefb3e113eb4,0x3f553f29bd86bea5,0x3d863ea53f663f7b,0xbe27bee7bf7cbf7e,0x3f423f6b3f5f3f2f
.quad 0xbf77bf7fbed8bdb2,0x3f7f3f683db2be85,0xbf22be953f463f75,0x3f223e95bf46bf75,0x3ee23f483f4e3ef6,0xbddfbf05bf76bf40,0x3f803f5fbebfbf42,0xbf49bf7cbe9f3e27
.quad 0x3ec4be06bf7ebf4b,0xbf7ebf4b3f1c3f6d,0xbf2fbf78bdf53edd,0xbf1abd9c3f803f50,0xbf72bf173f6f3f79,0x3e1c3f313f05bd86,0xbdc93f073f15bd06,0x3f503f80bed3bf62
.quad 0x8000800080008000,0x8000800080008000,0x3f693f6e3f783f7b,0x3f373f3f3f533f59,0x3f403f313ef63ece,0x3f803f7e3f6f3f66,0xbe95bed3bf3bbf50,0x3f2f3f153e693dc9
.quad 0xbf7ebf80bf58bf3d,0xbd33be5ebf2dbf4b,0xbf07beaa3e9f3f02,0xbf3fbf5fbf7dbf70,0x3f0e3f403f7f3f72,0xbf7fbf72bee2be48,0x3f7d3f643e3dbdf5,0xbf27bec93efb3f3b
.quad 0x3e85bdb2bf68bf7f,0x3db23ed83f7f3f77,0xbf46bf75bf22be95,0x3f463f753f223e95,0xbf66bf203f173f60,0x3f7e3f5bbe8fbf29,0x3d063efb3f6e3f27,0x3f1e3e3dbf73bf7d
.quad 0x3f6d3f7ebe06bf1c,0xbe06bf1cbf4bbec4,0x3f3b3e7ebf7ebf67,0xbf4dbf7f3d5f3f15,0xbea5bf4ebeba3e73,0xbf7dbf393f5b3f7f,0xbf7fbf593f503f80,0xbf153d063f693ef1
.quad 0x3f803f803f803f80,0x3f803f803f803f80,0x3efb3ee73eaa3e95,0x3f423f3b3f223f1a,0xbf05bf17bf48bf55,0x3e1c3d86be48be8f,0xbf80bf7dbf59bf46,0xbf07bf22bf62bf70
.quad 0xbeecbe9a3e5e3ec4,0xbf74bf7ebf6dbf58,0x3f0c3f373f7e3f7f,0xbf6bbf50be95bd9c,0x3f7f3f723ee23e48,0xbee2be483f0e3f40,0x3edd3e11bf33bf62,0x3e7e3f073f7f3f7b
.quad 0xbf13bf52bf68bf35,0x3f523f773f353ed8,0xbf7fbf623dc93ef1,0x3f7f3f62bdc9bef1,0xbece3cb33f793f7b,0x3f313ea5bf55bf7d,0x3f1a3f673f0c3dc9,0x3d5fbed3bf75bf37
.quad 0x3f7e3f4bbf1cbf6d,0xbf1cbf6dbec43e06,0x3ebfbe3dbf73bf22,0xbf7bbf703ef13f5f,0xbf20bf76bcb33f0e,0xbf60bee23f7b3f6a,0xbf7dbf2f3f703f75,0xbeb43e953f463e69
.quad 0x8000800080008000,0x8000800080008000,0x3f5f3f643f723f75,0x3f273f2f3f463f4d,0x3f5b3f4e3f203f0e,0x3f7d3f7f3f7b3f76,0xbd06be27bf07bf22,0x3f593f463ef13eb4
.quad 0xbf63bf74bf7abf6d,0x3e9a3e06bec4bf0a,0xbf56bf33bdf53dc9,0xbec9bf15bf75bf7f,0x3d863ea53f663f7b,0xbf66bf7bbf55bf29,0x3f673f7d3f373ef1,0xbf78bf59bdc93e53
.quad 0x3f523f13bed8bf35,0xbf13be853f353f68,0xbdc9bef1bf7fbf62,0x3dc93ef13f7f3f62,0xbf6abf80be733e48,0x3f393f723f0e3e1c,0xbf4dbedd3f563f7f,0x3f803f69be95bf33
.quad 0x3e063f1c3f4b3ec4,0x3f4b3ec4bf6dbf7e,0x3f6e3f7cbe9fbf46,0x3e53beb4bf62befb,0x3f483e8fbf80bf55,0xbef6bf66be483ece,0xbe27bf3bbeb43e95,0xbf70bf753f223f79
.quad 0x3f803f803f803f80,0x3f803f803f803f80,0x3f633f5e3f4b3f44,0x3f7e3f7c3f743f71,0x3f133f003e853e32,0x3f773f713f523f44,0x3e06a554bec4bf00,0x3f6d3f5e3f1c3f00
.quad 0xbeafbf00bf5ebf71,0x3f5e3f443eaf3e32,0xbf3dbf5ebf7ebf71,0x3f4b3f253d33be32,0xbf77bf80bf35bf00,0x3f353f00be85bf00,0xbf7abf5ebe063e32,0x3f1c3eafbf0abf44
.quad 0xbf44bf003f003f44,0x3f003e32bf44bf71,0xbec4248d3f6d3f80,0x3ec4a554bf6dbf80,0x3db23f003f773f44,0x3e85be32bf7fbf71,0x3f0a3f5e3f1c3e32,0x3e06beafbf7abf44
.quad 0x3f5e3f80a554bf00,0xa554bf00bf5ebf00,0x3f803f5ebf1cbf71,0xbe06bf25bf2dbe32,0x3f683f00bf77bf71,0xbe85bf44bed83e32,0x3f1ca554bf6dbf00,0xbec4bf5ebe063f00
.quad 0x8000800080008000,0x8000800080008000,0x3eec3f003f1c3f25,0x3e063e323e9a3eaf,0x3f523f5e3f773f7c,0x3e853eaf3f133f25,0x3f7e3f803f6d3f5e,0x3ec43f003f4b3f5e
.quad 0x3f713f5e3f003eaf,0x3f003f253f713f7c,0x3f2d3f00be06beaf,0x3f1c3f443f803f7c,0x3e85a50dbf35bf5e,0x3f353f5e3f773f5e,0xbe5ebf00bf7ebf7c,0x3f4b3f713f583f25
.quad 0xbf25bf5ebf5ebf25,0x3f5e3f7c3f253eaf,0xbf6dbf80bec48000,0x3f6d3f803ec4a50d,0xbf7fbf5e3e853f25,0x3f773f7c3db2beaf,0xbf58bf003f4b3f7c,0x3f7e3f71be5ebf25
.quad 0xbf0080003f803f5e,0x3f803f5ebf00bf5e,0xbd333f003f4b3eaf,0x3f7e3f44bf3dbf7c,0x3ed83f5e3e85beaf,0x3f773f25bf68bf7c,0x3f4b3f80bec4bf5e,0x3f6d3f00bf7ebf5e
.quad 0x3f803f803f803f80,0x3f803f803f803f80,0x3f6d3f683f583f52,0x3f803f7f3f7a3f77,0x3f353f253ed83eaf,0x3f7f3f7c3f683f5e,0x3ec43e85be06be85,0x3f7e3f773f4b3f35
.quad 0xa554be32bf25bf44,0x3f7c3f713f253f00,0xbec4bf13bf74bf7f,0x3f7a3f683eec3e85,0xbf35bf5ebf77bf5e,0x3f773f5e3e85a554,0xbf6dbf7fbf2dbed8,0x3f743f523d33be85
.quad 0xbf80bf71be323e32,0x3f713f44be32bf00,0xbf6dbf353ec43f35,0x3f6d3f35bec4bf35,0xbf35beaf3f523f7c,0x3f683f25bf13bf5e,0xbec43db23f803f68,0x3f633f13bf3dbf77
.quad 0x248d3f003f5e3f00,0x3f5e3f00bf5ebf80,0x3ec43f523eecbdb2,0x3f583ed8bf74bf77,0x3f353f7cbdb2bf25,0x3f523eafbf7fbf5e,0x3f6d3f77bf1cbf77,0x3f4b3e85bf7ebf35
.quad 0x8000800080008000,0x8000800080008000,0x3ec43ed83f0a3f13,0x3d333db23e5e3e85,0x3f353f443f683f71,0x3db23e323ed83f00,0x3f6d3f773f7e3f77,0x3e063e853f1c3f35
.quad 0x3f803f7c3f443f25,0x3e323eaf3f443f5e,0x3f6d3f523e9a3db2,0x3e5e3ed83f633f77,0x3f353f00be85bf00,0x3e853f003f773f80,0x3ec43db2bf3dbf68,0x3e9a3f133f803f77
.quad 0xa50dbeafbf7cbf7c,0x3eaf3f253f7c3f5e,0xbec4bf35bf6dbf35,0x3ec43f353f6d3f35,0xbf35bf71bf13be32,0x3ed83f443f523f00,0xbf6dbf7fbd333ed8,0x3eec3f523f2d3e85
.quad 0xbf80bf5e3f003f5e,0x3f003f5e3f00a50d,0xbf6dbf133f633f7f,0x3f0a3f683e9abe85,0xbf35be323f7f3f44,0x3f133f713db2bf00,0xbec43e853f4b3e85,0x3f1c3f77be06bf35
.quad 0x3f803f803f803f80,0x3f803f803f803f80,0x3f643f5f3f4d3f46,0x3f7e3f7d3f753f72,0x3f173f053e8f3e48,0x3f793f723f553f48,0x3e273d06beb4bef1,0x3f703f623f223f07
.quad 0xbe9abeecbf58bf6d,0x3f633f4b3ec43e5e,0xbf33bf56bf7fbf75,0x3f533f2f3dc9bdf5,0xbf72bf7fbf40bf0e,0x3f403f0ebe48bee2,0xbf7dbf67be533dc9,0x3f2b3ed3bef1bf37
.quad 0xbf52bf133ed83f35,0x3f133e85bf35bf68,0xbef1bdc93f623f7f,0x3ef13dc9bf62bf7f,0xbcb33ece3f7d3f55,0x3ebabd86bf7bbf79,0x3edd3f4d3f333e95,0x3e7ebe69bf7fbf56
.quad 0x3f4b3f7e3e06bec4,0x3e06bec4bf6dbf1c,0x3f7c3f6ebefbbf62,0x3c33bf07bf46be9f,0x3f763f20bf6abf7b,0xbddfbf29bf0e3cb3,0x3f3b3e27bf79bf22,0xbe69bf46be953eb4
.quad 0x8000800080008000,0x8000800080008000,0x3ee73efb3f1a3f22,0x3df53e273e953eaa,0x3f4e3f5b3f763f7b,0x3e733ea53f0e3f20,0x3f7d3f803f703f62,0x3eb43ef13f463f59
.quad 0x3f743f633f0a3ec4,0x3eec3f1c3f6d3f7a,0x3f373f0cbd9cbe95,0x3f113f3b3f7f3f7e,0x3ea53d86bf29bf55,0x3f293f553f7b3f66,0xbe11beddbf7bbf7f,0x3f3f3f693f623f33
.quad 0xbf13bf52bf68bf35,0x3f523f773f353ed8,0xbf62bf7fbef1bdc9,0x3f623f7f3ef13dc9,0xbf80bf6a3e1c3f0e,0x3f6f3f7f3e48be73,0xbf67bf1a3f373f75,0x3f783f79bdc9bf0c
.quad 0xbf1cbe063f7e3f6d,0x3f7e3f6dbec4bf4b,0xbe3d3ebf3f5f3ef1,0x3f803f59bf22bf73,0x3e8f3f483ecebe48,0x3f7e3f40bf55bf80,0x3f2f3f7dbe69bf46,0x3f793f22bf75bf70
.quad 0x3f803f803f803f80,0x3f803f803f803f80,0x3f6e3f693f593f53,0x3f803f7f3f7b3f78,0x3f393f293ee23eba,0x3f7f3f7d3f6a3f60,0x3ed33e95bdc9be69,0x3f7f3f793f503f3b
.quad 0x3d33be06bf1cbf3d,0x3f7e3f743f2d3f0a,0xbeaabf07bf70bf7d,0x3f7d3f6e3f023e9f,0xbf29bf55bf7bbf66,0x3f7b3f663ea53d86,0xbf64bf7dbf3bbefb,0x3f793f5c3df5be3d
.quad 0xbf7fbf77be853db2,0x3f773f52bdb2bed8,0xbf75bf463e953f22,0x3f753f46be95bf22,0xbf48bee23f403f76,0x3f723f39bef6bf4e,0xbefbbd063f7d3f73,0x3f703f2bbf27bf6e
.quad 0xbe063ec43f6d3f1c,0x3f6d3f1cbf4bbf7e,0x3e7e3f3b3f153d5f,0x3f693f0cbf67bf7e,0x3f173f723d86bf05,0x3f663ef6bf79bf6f,0x3f593f7fbef1bf69,0x3f623ed3bf80bf50
.quad 0x8000800080008000,0x8000800080008000,0x3ebf3ed33f073f11,0x3d063d9c3e533e7e,0x3f313f403f663f6f,0x3d863e1c3ece3ef6,0x3f693f753f7f3f79,0x3dc93e693f153f2f
.quad 0x3f803f7e3f4b3f2d,0x3e063e9a3f3d3f58,0x3f723f593eb43e11,0x3e273ebf3f5c3f73,0x3f403f0ebe48bee2,0x3e483ee23f723f7f,0x3ee73e27bf2fbf5f,0x3e693f023f7e3f7c
.quad 0x3db2be85bf77bf7f,0x3e853f133f7f3f68,0xbe95bf22bf75bf46,0x3e953f223f753f46,0xbf20bf66bf29be8f,0x3ea53f313f603f17,0xbf5fbf80be273e9f,0x3eb43f3f3f423ebf
.quad 0xbf7ebf6d3ec43f4b,0x3ec43f4b3f1c3e06,0xbf78bf2f3f503f80,0x3ed33f563eddbdf5,0xbf4ebea53f7f3f5b,0x3ee23f603e73beba,0xbf073dc93f623ed3,0x3ef13f693d06bf15
.quad 0x3f803f803f803f80,0x3f803f803f803f80,0x3f663f603f4e3f48,0x3f7e3f7d3f763f72,0x3f1c3f0a3e9a3e5e,0x3f7a3f743f583f4b,0x3e483d86bea5bee2,0x3f723f663f293f0e
.quad 0xbe85bed8bf52bf68,0x3f683f523ed83e85,0xbf29bf4ebf80bf79,0x3f5b3f393e1cbd86,0xbf6dbf7ebf4bbf1c,0x3f4b3f1cbe06bec4,0xbf7fbf6fbe8f3cb3,0x3f393ef6becebf29
.quad 0xbf5ebf253eaf3f25,0x3f253eafbf25bf5e,0xbf0ebe483f553f7b,0x3f0e3e48bf55bf7b,0xbe063e9a3f803f63,0x3eec3d33bf74bf7e,0x3ea53f393f483ece,0x3ebabddfbf80bf66
.quad 0x3f353f773e85be85,0x3e85be85bf77bf35,0x3f723f79bebabf4e,0x3e1cbecebf5bbee2,0x3f7e3f3dbf58bf80,0x3d33bf0abf2dbe06,0x3f553ea5bf7fbf40,0xbd86bf29bee23e48
.quad 0x8000800080008000,0x8000800080008000,0x3ee23ef63f173f20,0x3ddf3e1c3e8f3ea5,0x3f4b3f583f743f7a,0x3e5e3e9a3f0a3f1c,0x3f7b3f7f3f723f66,0x3ea53ee23f403f55
.quad 0x3f773f683f133ed8,0x3ed83f133f683f77,0x3f403f17bcb3be73,0x3f053f313f7d3f7f,0x3ec43e06bf1cbf4b,0x3f1c3f4b3f7e3f6d,0xbd86bebabf76bf80,0x3f313f603f6a3f40
.quad 0xbf00bf44bf71bf44,0x3f443f713f443f00,0xbf55bf7bbf0ebe48,0x3f553f7b3f0e3e48,0xbf7ebf743d333eec,0x3f633f803e9abe06,0xbf72bf313f203f6a,0x3f6f3f7e3cb3bee2
.quad 0xbf35be853f773f77,0x3f773f77be85bf35,0xbea53e733f6f3f17,0x3f7d3f6abf05bf66,0x3e063f2d3f0abd33,0x3f803f58bf3dbf7e,0x3f0e3f72bd86bf29,0x3f7f3f40bf66bf7b
.quad 0x3f803f803f803f80,0x3f803f803f803f80,0x3f6f3f6a3f5b3f55,0x3f803f7f3f7b3f79,0x3f3d3f2d3eec3ec4,0x3f803f7e3f6d3f63,0x3ee23ea5bd86be48,0x3f7f3f7b3f553f40
.quad 0x3db2bdb2bf13bf35,0x3f7f3f773f353f13,0xbe8fbef6bf6abf7b,0x3f7e3f723f0e3eba,0xbf1cbf4bbf7ebf6d,0x3f7e3f6d3ec43e06,0xbf5bbf79bf48bf0e,0x3f7d3f663e48bddf
.quad 0xbf7cbf7cbeaf248d,0x3f7c3f5ea554beaf,0xbf7bbf553e483f0e,0x3f7b3f55be48bf0e,0xbf58bf0a3f2d3f6d,0x3f7a3f4bbec4bf3d,0xbf17be1c3f763f7b,0x3f793f40bf0ebf60
.quad 0xbe853e853f773f35,0x3f773f35bf35bf77,0x3ddf3f203f313e48,0x3f763f29bf55bf80,0x3eec3f633e5ebec4,0x3f743f1cbf6dbf7a,0x3f403f7fbea5bf55,0x3f723f0ebf7bbf66
.quad 0x8000800080008000,0x8000800080008000,0x3eba3ece3f053f0e,0x3cb33d863e483e73,0x3f2d3f3d3f633f6d,0x3d333e063ec43eec,0x3f663f723f7f3f7b,0x3d863e483f0e3f29
.quad 0x3f7f3f7f3f523f35,0x3db23e853f353f52,0x3f763f603ece3e48,0x3ddf3ea53f553f6f,0x3f4b3f1cbe06bec4,0x3e063ec43f6d3f7e,0x3f053e73bf20bf55,0x3e1c3ee23f7b3f7e
.quad 0x3e32be32bf71bf80,0x3e323f003f803f71,0xbe48bf0ebf7bbf55,0x3e483f0e3f7b3f55,0xbf0abf58bf3dbec4,0x3e5e3f1c3f6d3f2d,0xbf4ebf7dbe8f3e48,0x3e733f293f553ef6
.quad 0xbf77bf773e853f35,0x3e853f353f353e85,0xbf7ebf483f393f7b,0x3e8f3f403f0e3cb3,0xbf63beec3f7a3f6d,0x3e9a3f4b3ec4be5e,0xbf29bd863f723f0e,0x3ea53f553e48bee2
.quad 0x3f803f803f803f80,0x3f803f803f803f80,0x3f673f623f503f49,0x3f7f3f7d3f773f73,0x3f203f0e3ea53e73,0x3f7b3f763f5b3f4e,0x3e693dc9be95bed3,0x3f753f693f2f3f15
.quad 0xbe5ebec4bf4bbf63,0x3f6d3f583eec3e9a,0xbf1ebf46bf80bf7c,0x3f623f423e53bc33,0xbf66bf7bbf55bf29,0x3f553f29bd86bea5,0xbf80bf75beb4bd5f,0x3f463f0cbeaabf1a
.quad 0xbf68bf353e853f13,0x3f353ed8bf13bf52,0xbf22be953f463f75,0x3f223e95bf46bf75,0xbe733e483f7f3f6f,0x3f0e3e1cbf6abf80,0x3e533f223f593f02,0x3ef13c33bf7dbf72
.quad 0x3f1c3f6d3ec4be06,0x3ec4be06bf7ebf4b,0x3f643f7fbe69bf37,0x3e95be8abf6bbf11,0x3f803f55bf40bf7e,0x3e48becebf48be8f,0x3f693ef1bf7fbf59,0x3dc9bf07bf153d06
.quad 0x8000800080008000,0x8000800080008000,0x3edd3ef13f153f1e,0x3dc93e113e8a3e9f,0x3f483f553f723f79,0x3e483e8f3f053f17,0x3f793f7f3f753f69,0x3e953ed33f3b3f50
.quad 0x3f7a3f6d3f1c3eec,0x3ec43f0a3f633f74,0x3f493f223d06be3d,0x3ef13f273f7b3f80,0x3ee23e48bf0ebf40,0x3f0e3f403f7f3f72,0x3c33be95bf70bf80,0x3f223f563f723f4d
.quad 0xbed8bf35bf77bf52,0x3f353f683f523f13,0xbf46bf75bf22be95,0x3f463f753f223e95,0xbf79bf7bbd863eba,0x3f553f7d3ecebcb3,0xbf7bbf463f073f5c,0x3f623f803e11beaa
.quad 0xbf4bbec43f6d3f7e,0x3f6d3f7ebe06bf1c,0xbee73dc93f793f33,0x3f753f77bec9bf53,0xbcb33f0e3f293ddf,0x3f7b3f6abf20bf76,0x3ed33f623dc9bf07,0x3f7f3f59bf50bf80
.quad 0x3f803f803f803f80,0x3f803f803f803f80,0x3f703f6b3f5c3f56,0x3f803f803f7c3f79,0x3f403f313ef63ece,0x3f803f7e3f6f3f66,0x3ef13eb4bd06be27,0x3f803f7d3f593f46
.quad 0x3e06bd33bf0abf2d,0x3f803f7a3f3d3f1c,0xbe69beddbf64bf78,0x3f803f773f1a3ed3,0xbf0ebf40bf7fbf72,0x3f7f3f723ee23e48,0xbf50bf73bf53bf1e,0x3f7f3f6e3e8abd06
.quad 0xbf77bf7fbed8bdb2,0x3f7f3f683db2be85,0xbf7fbf623dc93ef1,0x3f7f3f62bdc9bef1,0xbf66bf203f173f60,0x3f7e3f5bbe8fbf29,0xbf2fbe8a3f6b3f7f,0x3f7e3f53bee7bf50
.quad 0xbec43e063f7e3f4b,0x3f7e3f4bbf1cbf6d,0xbd063f023f493eaa,0x3f7d3f42bf3fbf7d,0x3ea53f4e3ebabe73,0x3f7d3f39bf5bbf7f,0x3f223f79be27bf3b,0x3f7d3f2fbf70bf75
.quad 0x8000800080008000,0x8000800080008000,0x3eb43ec93f023f0c,0x3c333d5f3e3d3e69,0x3f293f393f603f6a,0x3cb33ddf3eba3ee2,0x3f623f703f803f7d,0x3d063e273f073f22
.quad 0x3f7e3f803f583f3d,0x3d333e5e3f2d3f4b,0x3f793f673ee73e7e,0x3d5f3e8a3f4d3f69,0x3f553f29bd86bea5,0x3d863ea53f663f7b,0x3f153e9fbf11bf49,0x3d9c3ebf3f773f80
.quad 0x3e85bdb2bf68bf7f,0x3db23ed83f7f3f77,0xbdc9bef1bf7fbf62,0x3dc93ef13f7f3f62,0xbee2bf48bf4ebef6,0x3ddf3f053f763f40,0xbf3bbf77bec93d9c,0x3df53f113f643f15
.quad 0xbf6dbf7e3e063f1c,0x3e063f1c3f4b3ec4,0xbf80bf5c3f1e3f72,0x3e113f273f2b3e27,0xbf72bf173f6f3f79,0x3e1c3f313f05bd86,0xbf46be693f7d3f2f,0x3e273f3b3eb4be95
.quad 0xbf71bf713f443f80,0xbf71bf003f803f44,0xbf58bf7c3f3d3f80,0xbf7abf5e3f6d3f71,0xbf35bf803f353f80,0xbf35bf803f353f80,0xbf0abf7c3f2d3f80,0xbe5ebf5e3ec43f71
.quad 0xbeafbf713f253f80,0x3eafbf00248d3f44,0xbe06bf5e3f1c3f80,0x3f4ba554bec43f00,0x3db2bf443f133f80,0x3f7f3f00bf353e32,0x3e9abf253f0a3f80,0x3f633f5ebf6dbe32
.quad 0x3f00bf003f003f80,0x3f003f80bf80bf00,0x3f2dbeaf3eec3f80,0xbd333f5ebf6dbf44,0x3f52be323ed83f80,0xbf133f00bf35bf71,0x3f6da5543ec43f80,0xbf6d248dbec4bf80
.quad 0x3f7c3e323eaf3f80,0xbf7cbf00a554bf71,0x3f803eaf3e9a3f80,0xbf3dbf5e3ec4bf44,0x3f773f003e853f80,0xbe85bf803f35bf00,0x3f633f253e5e3f80,0x3e9abf5e3f6dbe32
.quad 0x3eafbeafbf258000,0xbeafbf5e80003f25,0x3f0abe32bf2d8000,0x3e5ebf00bec43eaf,0x3f35a50dbf358000,0x3f35a50dbf358000,0x3f583e32bf3d8000,0x3f7a3f00bf6dbeaf
.quad 0x3f713eafbf448000,0x3f713f5ebf80bf25,0x3f7e3f00bf4b8000,0x3f1c3f80bf6dbf5e,0x3f7f3f25bf528000,0x3db23f5ebf35bf7c,0x3f743f44bf588000,0xbeec3f00bec4bf7c
.quad 0x3f5e3f5ebf5e8000,0xbf5e8000a50dbf5e,0x3f3d3f71bf638000,0xbf80bf003ec4bf25,0x3f133f7cbf688000,0xbf52bf5e3f35beaf,0x3ec43f80bf6d8000,0xbec4bf803f6da50d
.quad 0x3e323f7cbf718000,0x3e32bf5e3f803eaf,0xbd333f71bf748000,0x3f2dbf003f6d3f25,0xbe853f5ebf778000,0x3f77a50d3f353f5e,0xbeec3f44bf7a8000,0x3f743f003ec43f7c
.quad 0x3e32bf00bf003e32,0xbf00bf713e323f44,0x3eecbe85bf1c3db2,0x3e06bf13be9a3ed8,0x3f35a554bf35248d,0x3f35a554bf35248d,0x3f633e85bf4bbdb2,0x3f7e3f13bf74bed8
.quad 0x3f7c3f00bf5ebe32,0x3f5e3f71bf7cbf44,0x3f7e3f35bf6dbe85,0x3ec43f77bf4bbf77,0x3f683f5ebf77beaf,0xbe853f25bed8bf7c,0x3f3d3f77bf7ebed8,0xbf4b3db23d33bf52
.quad 0x3f003f80bf80bf00,0xbf80bf003f00bf00,0x3e5e3f77bf7ebf13,0xbf4bbf683f58bdb2,0xbdb23f5ebf77bf25,0xbe85bf7c3f7f3eaf,0xbec43f35bf6dbf35,0x3ec4bf353f6d3f35
.quad 0xbf253f00bf5ebf44,0x3f5ebe323f253f71,0xbf583e85bf4bbf52,0x3f7e3ed83e5e3f7f,0xbf77248dbf35bf5e,0x3f353f5ebe853f5e,0xbf80be85bf1cbf68,0x3e063f7fbf2d3f13
.quad 0x3f7c3f5ebf5ebf7c,0x3f5e3eafbf7cbf25,0x3f633f77bf4bbf7f,0x3f7e3f52bf74bf68,0x3f353f80bf35bf80,0x3f353f80bf35bf80,0x3eec3f77bf1cbf7f,0x3e063f52be9abf68
.quad 0x3e323f5ebf00bf7c,0xbf003eaf3e32bf25,0xbe063f35bec4bf77,0xbf6dbe853f1cbe85,0xbed83f00be85bf71,0xbf77bf443f683e32,0xbf2d3e85be06bf68,0xbf1cbf7f3f803f13
.quad 0xbf5e8000a50dbf5e,0xa50dbf5e3f5e3f5e,0xbf7abe853e06bf52,0x3f1cbed83f0a3f7f,0xbf7fbf003e85bf44,0x3f773e323db23f71,0xbf6dbf353ec4bf35,0x3f6d3f35bec43f35
.quad 0xbf44bf5e3f00bf25,0x3f003f7cbf443eaf,0xbf0abf773f1cbf13,0xbe063f68bf7abdb2,0xbe85bf803f35bf00,0xbf353f00bf77bf00,0x3d33bf773f4bbed8,0xbf7ebdb2bf3dbf52
.quad 0xbf5ebf7c3f253f7c,0xbf7cbf253f7c3f5e,0xbf3bbf803f1a3f7c,0xbf6bbf723f563f7d,0xbf0ebf7b3f0e3f7b,0xbf0ebf7b3f0e3f7b,0xbeb4bf6e3f023f7b,0xbc33bf3f3e3d3f59
.quad 0xbe06bf583eec3f7a,0x3f0abe9abe5e3f1c,0x3dc9bf3b3ed33f79,0x3f693e69bf153e95,0x3ea5bf173eba3f79,0x3f7d3f31bf5bbd86,0x3f07bedd3e9f3f78,0x3f3f3f77bf7dbed3
.quad 0x3f35be853e853f77,0x3e853f77bf77bf35,0x3f59bd9c3e533f77,0xbe9f3f33bf49bf69,0x3f723ddf3e1c3f76,0xbf483e73bef6bf7f,0x3f7f3e953dc93f75,0xbf7fbe95bdc9bf75
.quad 0x3f7e3eec3d333f74,0xbf63bf3d3e9abf4b,0x3f703f1ebc333f73,0xbefbbf7b3f27bf07,0x3f553f40bd863f72,0x3d86bf723f66be48,0x3f2f3f5cbdf53f72,0x3f1abf273f803e27
.quad 0x3f00be32bf44be32,0xbe32bf44be323f00,0x3f2f3c33bf4dbe3d,0x3ec9beaabf0c3e27,0x3f553e48bf55be48,0x3f553e48bf55be48,0x3f703ebfbf5cbe53,0x3f803f2bbf7cbf07
.quad 0x3f7e3f0abf63be5e,0x3f583f74bf7abf4b,0x3f7f3f2fbf69be69,0x3ed33f79bf50bf75,0x3f723f4ebf6fbe73,0xbe1c3f39bf05bf7f,0x3f593f67bf73be7e,0xbf2b3e8abe11bf69
.quad 0x3f353f77bf77be85,0xbf77be853e85bf35,0x3f073f7fbf7bbe8a,0xbf73bf373f1ebed3,0x3ea53f7ebf7dbe8f,0xbf20bf793f60bd86,0x3dc93f75bf7fbe95,0xbdc9bf753f7f3e95
.quad 0xbe063f63bf80be9a,0x3eecbf2d3f743f1c,0xbeb43f49bf80be9f,0x3f5fbe533f423f59,0xbf0e3f29bf7fbea5,0x3f7f3ea53ee23f7b,0xbf3b3f02bf7ebeaa,0x3f4d3f423d5f3f7d
.quad 0x3eafbeafbf25248d,0xbeafbf5e248d3f25,0x3f1ebd9cbf3fbdc9,0x3e9fbed3bef13e7e,0x3f553e48bf55be48,0x3f553e48bf55be48,0x3f773ee7bf67be95,0x3f7f3f3bbf7fbf1a
.quad 0x3f803f2dbf74bec4,0x3f3d3f7ebf6dbf63,0x3f703f59bf7dbef1,0x3e273f62bf22bf80,0x3f483f76bf80bf0e,0xbef63ee2be48bf6a,0x3f0c3f80bf7ebf22,0xbf6bbe273e95bf27
.quad 0x3e853f77bf77bf35,0xbf77bf353f35be85,0xbd5f3f5cbf6bbf46,0xbf1abf7d3f753e3d,0xbeba3f31bf5bbf55,0x3cb3bf663f7b3f17,0xbf223ef1bf46bf62,0x3f22bef13f463f62
.quad 0xbf583e5ebf2dbf6d,0x3f7a3e063ec43f80,0xbf78bd5fbf11bf75,0x3f673f2fbdc93f6b,0xbf7fbea5bee2bf7b,0x3ee23f7bbf0e3f29,0xbf6ebf11be9fbf7f,0xbe533f69bf623e8a
.quad 0x3f713f71bf44bf80,0x3f713f00bf80bf44,0x3f493f7fbf2bbf7f,0x3f733f69bf62bf78,0x3f0e3f7bbf0ebf7b,0x3f0e3f7bbf0ebf7b,0x3e8a3f64beddbf75,0xbd9c3f2fbdc9bf4d
.quad 0xbd333f3dbe9abf6d,0xbf2d3e063ec4beec,0xbeb43f07be27bf62,0xbf7dbef13f46bd06,0xbf203e8fbcb3bf55,0xbf60bf663f7b3ece,0xbf563c333df5bf46,0xbec9bf7d3f753f42
.quad 0xbf77be853e85bf35,0x3e85bf353f353f77,0xbf80bf023ec9bf22,0x3f4dbe273e953f7c,0xbf6fbf393f05bf0e,0x3f803ee2be483f4e,0xbf46bf623f22bef1,0x3f463f62bf223ef1
.quad 0xbf0abf7a3f3dbec4,0x3e5e3f7ebf6d3d33,0xbe7ebf803f53be95,0xbedd3f3bbf7fbec9,0x3d86bf723f66be48,0xbf663e48bf55bf40,0x3ebfbf533f73bdc9,0xbf7bbed3bef1bf77
.quad 0xbf44bf803f003f71,0xbf80bf443f713f71,0xbf17bf7b3ee23f6f,0xbf55bf7d3f393f80,0xbec4bf6d3ec43f6d,0xbec4bf6d3ec43f6d,0xbe1cbf553ea53f6a,0x3e48bf17bcb33f39
.quad 0x3db2bf353e853f68,0x3f35bdb2bed83ed8,0x3ea5bf0e3e483f66,0x3f7b3ee2bf403d86,0x3f0abec43e063f63,0x3f6d3f58bf74be9a,0x3f39be483d863f60,0x3f0e3f80bf7ebf20
.quad 0x3f5ea554248d3f5e,0x248d3f5ebf5ebf5e,0x3f763e48bd863f5b,0xbf0e3ef6bf17bf7d,0x3f803ec4be063f58,0xbf6dbd33be5ebf7a,0x3f7b3f0ebe483f55,0xbf7bbf0e3e48bf55
.quad 0x3f683f35be853f52,0xbf35bf683f13bf13,0x3f483f55bea53f4e,0xbe48bf7e3f5bbe73,0x3f1c3f6dbec43f4b,0x3ec4bf4b3f7e3e06,0x3ece3f7bbee23f48,0x3f55beba3f763ef6
.quad 0x3f25a50dbf5ebeaf,0xa50dbf25beaf3eaf,0x3f4e3e48bf66beba,0x3f0ebe1cbf31bcb3,0x3f6d3ec4bf6dbec4,0x3f6d3ec4bf6dbec4,0x3f7d3f0ebf72bece,0x3f7b3f4ebf80bf31
.quad 0x3f7f3f35bf77bed8,0x3f353f7fbf68bf68,0x3f723f55bf7bbee2,0x3e483f66bf29bf7f,0x3f583f6dbf7ebeec,0xbec43f0abe9abf74,0x3f313f7bbf7fbef6,0xbf553cb33ddfbf48
.quad 0x3f003f80bf80bf00,0xbf80bf003f00bf00,0x3e8f3f7bbf7fbf05,0xbf55bf603f4ebe1c,0x3d333f6dbf7ebf0a,0xbec4bf803f7a3e5e,0xbe483f55bf7bbf0e,0x3e48bf553f7b3f0e
.quad 0xbed83f35bf77bf13,0x3f35bed83f523f52,0xbf203f0ebf72bf17,0x3f7b3ddf3f053f79,0xbf4b3ec4bf6dbf1c,0x3f6d3f1c3e063f7e,0xbf6a3e48bf66bf20,0x3f0e3f6fbe8f3f60
.quad 0x3f00be32bf44be32,0xbe32bf44be323f00,0x3f403ddfbf5bbe8f,0x3ef6be73bf203d86,0x3f6d3ec4bf6dbec4,0x3f6d3ec4bf6dbec4,0x3f7f3f20bf79bef6,0x3f763f5bbf7ebf40
.quad 0x3f773f52bf7fbf13,0x3f133f7fbf52bf77,0x3f553f72bf7fbf29,0xbd863f40bee2bf7b,0x3f1c3f80bf7abf3d,0xbf2d3e5e3d33bf4b,0x3ea53f79bf6fbf4e,0xbf7dbece3f05bee2
.quad 0x248d3f5ebf5ebf5e,0xbf5ebf5e3f5ea554,0xbea53f31bf48bf6a,0xbebabf7e3f803ee2,0xbf1c3eecbf2dbf74,0x3e9abf3d3f633f4b,0xbf553e48bf0ebf7b,0x3f55be483f0e3f7b
.quad 0xbf77bdb2bed8bf7f,0x3f7f3ed83db23f77,0xbf7fbebabe8fbf80,0x3f393f60bece3f40,0xbf6dbf1cbe06bf7e,0x3e063f7ebf4b3ec4,0xbf40bf4e3cb3bf79,0xbf053f39bf7dbd86
.quad 0x3f5e3f7cbf25bf7c,0x3f7c3f25bf7cbf5e,0x3f293f7ebf05bf76,0x3f603f79bf48bf7f,0x3ec43f6dbec4bf6d,0x3ec43f6dbec4bf6d,0x3d863f48be73bf60,0xbe8f3f053ddfbf29
.quad 0xbe853f13bdb2bf52,0xbf52bdb23f13be85,0xbf0e3ea53d86bf40,0xbf7fbf293f663e48,0xbf4b3d333e5ebf2d,0xbf3dbf7a3f803f1c,0xbf72be733ebabf17,0xbe1cbf6a3f5b3f66
.quad 0xbf80bf003f00bf00,0x3f00bf003f003f80,0xbf72bf393f20bece,0x3f6f3ddf3cb33f66,0xbf4bbf633f3dbe9a,0x3f743f2dbeec3f1c,0xbf0ebf7b3f55be48,0x3f0e3f7bbf553e48
.quad 0xbe85bf7f3f68bdb2,0xbdb23f68bf7fbe85,0x3d86bf6f3f763cb3,0xbf313ef6bf6abf29,0x3ec4bf4b3f7e3e06,0xbf7ebe06bf1cbf6d,0x3f29bf173f803e73,0xbf5bbf31be1cbf7f
.quad 0xbf25bf7c3eaf3f5e,0xbf7cbf5e3f5e3f7c,0xbeddbf6e3e8a3f59,0xbf37bf803f153f7b,0xbe48bf553e483f55,0xbe48bf553e483f55,0x3d5fbf333df53f50,0x3ec9bed3be693f11
.quad 0x3e9abf0a3d333f4b,0x3f583e06bf1c3e5e,0x3f07beb4bd063f46,0x3f803f22bf62be27,0x3f39be1cbddf3f40,0x3f4e3f72bf7fbf05,0x3f5f3d5fbe3d3f3b,0x3eaa3f79bf70bf4d
.quad 0x3f773e85be853f35,0xbe853f35bf35bf77,0x3f803ee7beaa3f2f,0xbf423e69beb4bf7e,0x3f793f20bece3f29,0xbf7ebea53d86bf60,0x3f623f46bef13f22,0xbf62bf463ef1bf22
.quad 0x3f3d3f63bf0a3f1c,0xbeecbf7e3f4bbe9a,0x3f0c3f77bf1a3f15,0x3df5bf693f793d9c,0x3ea53f7fbf293f0e,0x3f29bf0e3f7b3ee2,0x3d9c3f7dbf373f07,0x3f78bd063f503f3f
.quad 0x3f443e32bf71bf00,0x3e32bf00bf003e32,0x3f673ebfbf77bf07,0x3f333d06bf50be53,0x3f7b3f0ebf7bbf0e,0x3f7b3f0ebf7bbf0e,0x3f803f37bf7ebf15,0x3f6b3f69bf79bf53
.quad 0x3f743f58bf80bf1c,0x3f0a3f7ebf4bbf7a,0x3f593f70bf80bf22,0xbd063f46bef1bf7d,0x3f313f7dbf7ebf29,0xbf173ea5bd86bf5b,0x3efb3f80bf7cbf2f,0xbf72be693eb4bf1a
.quad 0x3e853f77bf77bf35,0xbf77bf353f35be85,0x3c333f64bf72bf3b,0xbf27bf793f703df5,0xbe733f48bf6abf40,0xbddfbf723f7f3ef6,0xbef13f22bf62bf46,0x3ef1bf223f623f46
.quad 0xbf2d3eecbf58bf4b,0x3f63be063f1c3f74,0xbf563e8abf4dbf50,0x3f7e3ed33e693f7f,0xbf723d86bf40bf55,0x3f403f55be483f66,0xbf7fbe11bf33bf59,0x3e7e3f80bf153f2b
.quad 0x3f25a554bf5ebeaf,0xa554bf25beaf3eaf,0x3f5c3e95bf70bee7,0x3f22bd5fbf42bdf5,0x3f7b3f0ebf7bbf0e,0x3f7b3f0ebf7bbf0e,0x3f7d3f46bf80bf27,0x3f623f72bf73bf5f
.quad 0x3f633f6dbf7ebf3d,0x3ec43f74bf2dbf80,0x3f2f3f7fbf75bf50,0xbe953f15be69bf69,0x3ece3f7bbf66bf60,0xbf55bcb33e8fbf20,0x3d9c3f62bf50bf6e,0xbf7fbf1e3f37be53
.quad 0xbe853f35bf35bf77,0xbf35bf773f773e85,0xbf113ef1bf15bf7d,0xbdc9bf6e3f783f2b,0xbf4e3e48bee2bf80,0x3f0ebf053f393f6f,0xbf75bdc9be95bf7f,0x3f753dc93e953f7f
.quad 0xbf80bec4be06bf7a,0x3f6d3f2dbe5e3f58,0xbf6ebf223d06bf72,0x3ef13f7cbf2b3f02,0xbf40bf553e48bf66,0xbe483f66bf723d86,0xbefbbf753eb4bf56,0xbf463ee7bf7cbec9
.quad 0x3f443f80bf00bf71,0x3f803f44bf71bf71,0x3f023f75beb4bf64,0x3f463f80bf27bf7e,0x3e483f55be48bf55,0x3e483f55be48bf55,0xbe113f22bd06bf42,0xbef13eaa3e9fbefb
.quad 0xbeec3ec43e06bf2d,0xbf6dbe9a3f3dbd33,0xbf3b3dc93e95bf15,0xbf75bf503f793ed3,0xbf6abe483ee2bef6,0xbf0ebf803f763f48,0xbf7fbef13f15bebf,0x3dc9bf493f333f7b
.quad 0xbf77bf353f35be85,0x3f35be853e853f77,0xbf53bf623f50be11,0x3f7f3ebfbe7e3f3f,0xbf17bf7b3f66bcb3,0x3f553f5bbf313eba,0xbe95bf7f3f753dc9,0x3e953f7fbf75bdc9
.quad 0x3d33bf6d3f7e3e5e,0xbec43f3dbf7abf0a,0x3ebfbf463f803eaa,0xbf623e3dbf3fbf5c,0x3f29bf0e3f7b3ee2,0xbf7bbee2bea5bf7f,0x3f5fbe953f703f0c,0xbf22bf643e3dbf6b
.quad 0xbf003e323f443e32,0x3e323f443e32bf00,0xbf7ebf253f803f44,0xbf63beaf3f743f00,0xbf35bf803f353f80,0xbf35bf803f353f80,0x3e06bf253d333f44,0x3eecbeafbe9a3f00
.quad 0x3f5e3e32bf253e32,0x3f7c3f44bf7cbf00,0x3f6d3f5ebf7ebf00,0x3e063f5ebf1cbf80,0x3e853f71bf52bf71,0xbf68be323ed8bf00,0xbf1c3eafbe5ebf71,0xbf2dbf7c3f803f00
.quad 0xbf80bf003f00bf00,0x3f00bf003f003f80,0xbf1cbf7c3f743e32,0x3f7a3f25bf0a3f00,0x3e85bf443f683f44,0x3db23f71bf7fbf00,0x3f6da5543ec43f80,0xbf6d248dbec4bf80
.quad 0x3f5e3f44beaf3f44,0xbf25bf713f25bf00,0x3e063f7cbf633e32,0x3f0abf253f7a3f00,0xbf353f00bf77bf00,0x3f773f003e853f80,0xbf7ebeafbf0abf71,0x3d333f7cbf3d3f00
.quad 0xbf5ebf7c3f253f7c,0xbf7cbf253f7c3f5e,0xbe06bf44bd333f25,0xbeecbf713e9a3f5e,0x3f35a50dbf358000,0x3f35a50dbf358000,0x3f7e3f44bf80bf25,0x3f633f71bf74bf5e
.quad 0x3f003f7cbf44bf7c,0xbe323f25be32bf5e,0xbec43f00be06bf5e,0xbf7ebf003f4ba50d,0xbf77beaf3f13beaf,0xbed8bf7c3f683f5e,0xbf4bbf713f7a3eaf,0x3f3dbe323d333f5e
.quad 0xa50dbf5e3f5e3f5e,0x3f5e3f5ebf5e8000,0x3f4bbe323e9a3f7c,0xbe5e3f44bf58bf5e,0x3f773f25bed83f25,0xbf7fbeaf3db2bf5e,0x3ec43f80bf6d8000,0xbec4bf803f6da50d
.quad 0xbf003f25bf71bf25,0x3f44beaf3f443f5e,0xbf7ebe32beecbf7c,0x3f583f44be5e3f5e,0xbf35bf5e3e85bf5e,0xbe853f5ebf778000,0x3e06bf713f58beaf,0xbf80be32bf2dbf5e
.quad 0xbf71bf713f443f80,0xbf71bf003f803f44,0xbe5ebf523d333f35,0xbf0abf773ec43f68,0x3f35a554bf35248d,0x3f35a554bf35248d,0x3f7a3f52bf80bf35,0x3f583f77bf6dbf68
.quad 0x3eaf3f71bf25bf80,0xbeaf3f00a554bf44,0xbf1c3e853e06bf35,0xbf7ebf353f6d3e85,0xbf7fbf253f52a554,0xbdb2bf5e3f353f7c,0xbeecbf7f3f7a3f35,0x3f743e85bec43f13
.quad 0x3f00bf003f003f80,0x3f003f80bf80bf00,0x3f803ed8be9a3f35,0xbf3d3e85bec4bf7f,0x3f133f7cbf68248d,0xbf52bf5e3f35beaf,0xbec43f35bf6dbf35,0x3ec4bf353f6d3f35
.quad 0xbf7cbe32beafbf80,0x3f7c3f00248d3f71,0xbf2dbf683eecbf35,0x3d333f77bf6d3db2,0x3e85bf5e3f77a554,0xbf77248dbf35bf5e,0x3f74bdb23f583f35,0xbeecbf773ec4bf52
.quad 0x3eafbeafbf258000,0xbeafbf5e80003f25,0x3f7a3f13bf80bf35,0x3f583e85bf6dbed8,0x3f353f80bf35bf80,0x3f353f80bf35bf80,0xbe5e3f133d33bf35,0xbf0a3e853ec4bed8
.quad 0xbf71beaf3f44a50d,0xbf71bf5e3f803f25,0xbf4bbf773f7e3f35,0x3e06bf353ec43f77,0x3db2bf443f133f80,0x3f7f3f00bf353e32,0x3f633db2be5e3f35,0x3e9a3f77bf6dbf52
.quad 0x3f5e3f5ebf5e8000,0xbf5e8000a50dbf5e,0x3d333f68bf74bf35,0xbf2dbf773f6d3db2,0xbf523e32bed8bf80,0x3f13bf003f353f71,0xbf6dbf353ec4bf35,0x3f6d3f35bec43f35
.quad 0xbe32bf7c3f71a50d,0xbe323f5ebf80beaf,0x3f3dbed83f633f35,0xbf80be85bec4bf7f,0x3f773f003e853f80,0xbe85bf803f35bf00,0x3e9a3f7fbf0a3f35,0x3f63be853f6d3f13
.quad 0xbf25248d3f5e3eaf,0x248d3f253eafbeaf,0xbf80bf463f793f5f,0xbf75bf023f7e3f27,0xbf0ebf7b3f0e3f7b,0xbf0ebf7b3f0e3f7b,0x3eaabef1be273f1e,0x3f22be11befb3e9f
.quad 0x3f743ec4bf4bbd33,0x3f6d3f63bf80bf2d,0x3f503f75bf7fbf2f,0xbdc93f3bbed3bf79,0x3cb33f55bf29bf7e,0xbf7bbece3f20be8f,0xbf493dc93d06bf53,0xbef1bf7f3f7b3f33
.quad 0xbf77bf353f35be85,0x3f35be853e853f77,0xbebfbf7f3f803edd,0x3f623f53bf3f3e7e,0x3f05bf0e3f403f6a,0xbe483f4ebf6fbf39,0x3f7f3e953dc93f75,0xbf7fbe95bdc9bf75
.quad 0x3f2d3f6dbf1c3f0a,0xbec4bf803f58be5e,0xbe3d3f62bf7dbe11,0x3f46bebf3f5c3f3f,0xbf663e48bf55bf40,0x3f553f40bd863f72,0xbf64bf22be69bf80,0xbe953f5fbf6b3e3d
.quad 0xbf44bf803f003f71,0xbf80bf443f713f71,0x3d5fbf22be693efb,0xbe95bf5c3df53f42,0x3f553e48bf55be48,0x3f553e48bf55be48,0x3f723f62bf7dbf49,0x3f463f7dbf5fbf73
.quad 0x3e9a3f6dbf1cbf80,0xbec43eec3d33bf3d,0xbf153e953dc9bf3b,0xbf7fbf2f3f693e69,0xbf80bf0e3f40bddf,0xbe48bf6a3f483f76,0xbf1ebf7f3f803f11,0x3f623d9cbe533f37
.quad 0x3e85bf353f353f77,0x3f353f77bf77be85,0x3f6e3dc93d063f67,0xbef13f11bf2bbf78,0x3f5b3f55bf293ece,0xbf7bbf173ebabf31,0x3dc93f75bf7fbe95,0xbdc9bf753f7f3e95
.quad 0xbf3d3ec4bf4bbf58,0x3f6dbd333f0a3f7a,0xbf7cbef1be27bf7d,0x3f223f6ebf023f2b,0xbee2bf7b3f0ebf29,0xbf0e3f29bf7fbea5,0x3ee7bf463f79bc33,0xbf75befbbec9bf7c
.quad 0xbf5ebf7c3f253f7c,0xbf7cbf253f7c3f5e,0xbd06bf33be113f11,0xbebfbf673e533f50,0x3f553e48bf55be48,0x3f553e48bf55be48,0x3f693f6bbf78bf56,0x3f373f80bf53bf79
.quad 0x3e063f58beecbf7a,0xbf0a3e9a3e5ebf1c,0xbf463d063eb4bf07,0xbf70bf593f7d3ef1,0xbf72bf4e3f6f3e73,0x3e1cbf393f053f7f,0xbe69bf723f643f5c,0x3f803efbbf1a3eb4
.quad 0x3f35be853e853f77,0x3e853f77bf77bf35,0x3f793f27bf0c3efb,0xbf64bc33bdf5bf70,0x3ea53f7ebf7dbe8f,0xbf20bf793f60bd86,0xbf223ef1bf46bf62,0x3f22bef13f463f62
.quad 0xbf7ebeecbd33bf74,0x3f633f3dbe9a3f4b,0xbed3bf7e3f37bee7,0xbe8a3f56bf7fbe69,0x3f0ebf293f7f3ea5,0xbf7fbea5bee2bf7b,0x3f803e7e3f1e3f67,0xbe11bf7f3f2bbf15
.quad 0x3f00be32bf44be32,0xbe32bf44be323f00,0x3f803f37bf7dbf53,0x3f6e3eddbf7bbf15,0x3f0e3f7bbf0ebf7b,0x3f0e3f7bbf0ebf7b,0xbed33ec93e7ebf0c,0xbf333d5f3f11be69
.quad 0xbf7ebf0a3f633e5e,0xbf58bf743f7a3f4b,0xbf22bf803f703f59,0x3eb4bf073e273f62,0x3ea5bf173eba3f79,0x3f7d3f31bf5bbd86,0x3f793eaabee73f02,0x3d5f3f5fbf4dbf70
.quad 0x3f353f77bf77be85,0xbf77be853e85bf35,0xbe693f42bf56bf5f,0xbee7bf803f7e3eb4,0xbf72bddfbe1cbf76,0x3f48be733ef63f7f,0xbf46bf623f22bef1,0x3f463f62bf223ef1
.quad 0x3e06bf633f803e9a,0xbeec3f2dbf74bf1c,0x3f69bdf53f333f64,0xbf77bf0cbd9cbf79,0x3f553f40bd863f72,0x3d86bf723f66be48,0xbd063f78bf493edd,0x3f7d3d9c3f3f3f50
.quad 0xbf44be323f713f00,0xbe323f003f00be32,0xbf79bf603f6a3f72,0xbf7ebf293f7f3f48,0xbec4bf6d3ec43f6d,0xbec4bf6d3ec43f6d,0x3f05be8fbeba3ee2,0x3f483d86bf293ddf
.quad 0x3f7f3f13bf68be85,0x3f523f77bf77bf52,0x3f293f7fbf72bf55,0xbea53f0ebe48bf66,0xbe5e3f2dbeecbf7e,0xbf80bf1c3f4bbd33,0xbf6abe1c3e8fbf29,0xbe73bf723f663f5b
.quad 0xbf5ebf5e3f5ea554,0x3f5ea554248d3f5e,0xbddfbf6f3f793f29,0x3f393f72bf66bcb3,0x3f3dbe9a3f0a3f7e,0xbeec3f1cbf4bbf63,0x3f7b3f0ebe483f55,0xbf7bbf0e3e48bf55
.quad 0x3ed83f7fbf523e85,0xbdb2bf773f773db2,0xbef63f31bf7dbee2,0x3f6fbd863f293f6a,0xbf7ebe06bf1cbf6d,0x3f1c3f6dbec43f4b,0xbf31bf5b3ddfbf72,0xbf173f29bf7fbe1c
.quad 0xbf25bf7c3eaf3f5e,0xbf7cbf5e3f5e3f7c,0x3e73bef6bece3ea5,0xbddfbf40bd863f20,0x3f6d3ec4bf6dbec4,0x3f6d3ec4bf6dbec4,0x3f5b3f76bf6fbf66,0x3f203f7fbf40bf7e
.quad 0x3db23f52bed8bf77,0xbf133e853e85bf13,0xbf403d863ea5bf0e,0xbf72bf553f7b3ee2,0xbf7abf3d3f633e06,0x3d33bf4b3f1c3f80,0xbecebf7d3f763f40,0x3f793ea5bee23f05
.quad 0x3f00bf003f003f80,0x3f003f80bf80bf00,0x3f7e3ebabe733f40,0xbf313ea5bee2bf80,0x3f2d3f74bf583e06,0xbf63bf4b3f1cbeec,0xbe483f55bf7bbf0e,0x3e48bf553f7b3f0e
.quad 0xbf683db2bf13bf77,0x3f7f3e853e853f7f,0xbf60bf393e1cbf66,0x3eba3f7fbf403ece,0xbe06bf7e3f4bbec4,0xbf4b3ec4bf6dbf1c,0x3f39bf053f7e3ea5,0xbf4ebf40bd86bf7d
.quad 0xbf44bf803f003f71,0xbf80bf443f713f71,0x3e1cbf0ebea53ece,0xbe48bf4e3cb33f31,0x3f6d3ec4bf6dbec4,0x3f6d3ec4bf6dbec4,0x3f4e3f7bbf66bf6f,0x3f0e3f7dbf31bf80
.quad 0xbdb23f35be85bf68,0xbf353db23ed8bed8,0xbf66be483f0ebea5,0xbf55bf723f7f3f29,0xbf58bf6d3f7e3eec,0x3ec4bf0a3e9a3f74,0x3cb3bf553f403f76,0x3f7b3f31bf483ddf
.quad 0x3f5ea554248d3f5e,0x248d3f5ebf5ebf5e,0x3f603f55bf403e73,0xbf7bbe8f3e1cbf4e,0x3d333f6dbf7ebf0a,0xbec4bf803f7a3e5e,0xbf553e48bf0ebf7b,0x3f55be483f0e3f7b
.quad 0xbf68bf353e85bf52,0x3f353f68bf133f13,0xbddfbf7b3f66be1c,0xbf0e3f20bf79bf05,0x3f4bbec43f6d3f1c,0xbf6dbf1cbe06bf7e,0x3f6f3f0e3ea53f7e,0x3e48bf6a3f60be8f
.quad 0x3f25a50dbf5ebeaf,0xa50dbf25beaf3eaf,0x3f7d3f55bf72bf6a,0x3f7b3f17bf80bf39,0x3ec43f6dbec4bf6d,0x3ec43f6dbec4bf6d,0xbf173e483ee2beba,0xbf55be1c3f39bcb3
.quad 0xbf7fbf353f773ed8,0xbf35bf7f3f683f68,0xbee2bf7b3f553f72,0x3f0ebea5bd863f40,0x3f0abec43e063f63,0x3f6d3f58bf74be9a,0x3f803f0ebf293e8f,0xbe483f39bf20bf7e
.quad 0x3f003f80bf80bf00,0xbf80bf003f00bf00,0xbef63f0ebf29bf79,0xbe48bf763f7d3f17,0xbf80bec43e06bf58,0x3f6d3d333e5e3f7a,0xbf0ebf7b3f55be48,0x3f0e3f7bbf553e48
.quad 0x3ed8bf353f773f13,0xbf353ed8bf52bf52,0x3f7e3e483ee23f7d,0xbf55bf483e73bf5b,0x3f1c3f6dbec43f4b,0x3ec4bf4b3f7e3e06,0xbeba3f55bf723ddf,0x3f7b3ece3ef63f76
.quad 0xbf5ebeaf3f7c3f25,0xbeaf3eaf3f25a554,0xbf69bf733f533f7d,0xbf7fbf493f783f62,0xbe48bf553e483f55,0xbe48bf553e483f55,0x3f2fbd9cbf0c3e7e,0x3f643e8abf4dbdc9
.quad 0x3f7e3f3dbf7abeec,0x3f2d3f80bf63bf6d,0x3ef13f7dbf59bf70,0xbf073eb43d06bf46,0xbee23ef6be73bf6f,0xbf76bf483f6a3e48,0xbf7dbec93f02bee7,0x3c33bf563f423f75
.quad 0xbf35bf773f773e85,0x3f773e85be853f35,0x3e27bf4d3f5f3f56,0x3f023f80bf7cbe95,0x3f66bcb33e8f3f7d,0xbf313ebabf17bf7b,0x3f623f46bef13f22,0xbf62bf463ef1bf22
.quad 0x3e063f7abf74bd33,0x3e5ebf583f803ec4,0xbf3b3eddbf64bf33,0x3f803e7e3ec93f7f,0xbf7bbee2bea5bf7f,0x3ea53f7fbf293f0e,0xbed3bf7b3eddbf49,0xbf533ebfbf77bef1
.quad 0xbf00bf713e323f44,0xbf71bf713f443f80,0x3ed3be9fbf113e11,0x3d9cbf1ebe7e3ef1,0x3f7b3f0ebf7bbf0e,0x3f7b3f0ebf7bbf0e,0x3f3b3f7fbf56bf78,0x3ee73f77bf1abf7f
.quad 0xbe063f2dbe5ebf63,0xbf3d3d333eecbec4,0xbf62be273f07beb4,0xbf59bf703f803f22,0xbf66bf603f793eba,0x3e8fbf203ece3f7b,0xbe27bf6b3f5c3f64,0x3f803f0cbf273e95
.quad 0x3f35be853e853f77,0x3e853f77bf77bf35,0x3f7d3f1abefb3f0c,0xbf5c3d5fbe3dbf75,0x3ee23f80bf76be1c,0xbf39bf6f3f4ebe48,0xbef13f22bf62bf46,0x3ef1bf223f623f46
.quad 0xbf7ebe5ebe9abf80,0x3f7a3f0abd333f6d,0xbf2fbf673ee7bf37,0x3d5f3f78bf6b3dc9,0x3e48bf663f72bd86,0xbf723d86bf40bf55,0x3f69be533f673f1e,0xbf11bf6e3e8abf62
.quad 0xbf25bf7c3eaf3f5e,0xbf7cbf5e3f5e3f7c,0x3eaabec9befb3e69,0xbc33bf2fbe273f0c,0x3f7b3f0ebf7bbf0e,0x3f7b3f0ebf7bbf0e,0x3f2b3f80bf49bf7d,0x3ebf3f70bf07bf7c
.quad 0xbe9a3f0abd33bf4b,0xbf58be063f1cbe5e,0xbf79bed33f3bbdc9,0xbf2fbf7f3f753f50,0xbf31bf7d3f7e3f29,0x3f17bea53d863f5b,0x3e8abf2b3f113f80,0x3f673f59bf69be11
.quad 0x3f773e85be853f35,0xbe853f35bf35bf77,0x3f373f73bf67bd06,0xbf7fbf073ed3bf1e,0xbe733f48bf6abf40,0xbddfbf723f7f3ef6,0xbf75bdc9be95bf7f,0x3f753dc93e953f7f
.quad 0xbf3dbf633f0abf1c,0x3eec3f7ebf4b3e9a,0x3e53bf5f3f7d3e27,0xbf493eb4bf59bf42,0x3f72bd863f403f55,0xbf40bf553e48bf66,0x3f423f4dbc333f79,0x3f02bf3b3f7d3d5f
.quad 0x3f443e32bf71bf00,0x3e32bf00bf003e32,0x3f723f6bbf5fbf79,0x3f803f3bbf7dbf56,0x3e483f55be48bf55,0x3e483f55be48bf55,0xbf3fbc333f1ebe27,0xbf6ebeb43f593e3d
.quad 0xbf74bf583f803f1c,0xbf0abf7e3f4b3f7a,0xbe69bf693f2f3f7f,0x3f3bbdc9be953f15,0x3f39be1cbddf3f40,0x3f4e3f72bf7fbf05,0x3f773f3fbf533d06,0xbedd3f07bed3bf7d
.quad 0x3e853f77bf77bf35,0xbf77bf353f35be85,0xbf333e9fbeddbf80,0x3d9cbf593f693f49,0xbf79bf203ecebf29,0x3f7e3ea5bd863f60,0xbe95bf7f3f753dc9,0x3e953f7fbf75bdc9
.quad 0x3f2dbeec3f583f4b,0xbf633e06bf1cbf74,0x3f7b3efb3e113f7d,0xbf1ebf703f07bf27,0x3ea53f7fbf293f0e,0x3f29bf0e3f7b3ee2,0xbf273f1abf80be69,0x3f5c3f2f3e273f80
.quad 0x3f443f80bf00bf71,0x3f803f44bf71bf71,0xbf2d248d3f4b3e32,0xbec43eaf3f0abe32,0xbf35bf803f353f80,0xbf35bf803f353f80,0x3f3da554bf1c3e32,0x3f6d3eafbf58be32
.quad 0x3f253f80bf5ebf71,0x248d3f44beafbf71,0xbf4b248d3ec4bf00,0xbf6dbf5e3f7e3f00,0xbf13bf803f773f44,0x3f35be32bdb23f44,0x3f58a554be063f44,0x3ec43f7cbf74bf44
.quad 0x3f003f80bf80bf00,0xbf80bf003f00bf00,0xbf63248dbe06bf71,0x3ec4bf253f3d3f71,0xbed8bf803f773e32,0x3f353f71bf523e32,0x3f6da5543ec43f80,0xbf6d248dbec4bf80
.quad 0x3eaf3f80bf5e3e32,0xa554bf713f7c3e32,0xbf74248dbf1cbf71,0x3f6d3f25bd333f71,0xbe85bf803f35bf00,0xbf353f00bf77bf00,0x3f7aa5543f4b3f44,0xbec4bf7c3eecbf44
.quad 0xbf2580003f5e3eaf,0x80003f253eafbeaf,0xbf3dbf803f1c3f7c,0xbf6dbf713f583f7c,0x3f35a50dbf358000,0x3f35a50dbf358000,0x3f2d3f80bf4bbf7c,0x3ec43f71bf0abf7c
.quad 0xbf4480003f00beaf,0xbf80bf253f713eaf,0xbf1cbf803f6d3f5e,0x3ec4bf003e063f5e,0x3f52a50dbe853f25,0x3f353f7cbf7fbf25,0x3f0a3f80bf7ebf25,0xbf6dbe323e9abf25
.quad 0xbf5e8000a50dbf5e,0xa50dbf5e3f5e3f5e,0xbeecbf803f7e3eaf,0x3f6d3f44bf2d3eaf,0x3f68a50d3e853f7c,0xbf353eafbf13bf7c,0x3ec43f80bf6d8000,0xbec4bf803f6da50d
.quad 0xbf718000bf00bf7c,0x3f803eaf3e323f7c,0xbe9abf803f4bbeaf,0xbec43f44bf80beaf,0x3f77a50d3f353f5e,0xbf35bf5e3e85bf5e,0x3e5e3f80bf1c3f25,0x3f6dbe323f633f25
.quad 0xbf003e323f443e32,0x3e323f443e32bf00,0xbf4bbf7f3f2d3f7f,0xbf74bf683f633f77,0x3f35a554bf35248d,0x3f35a554bf35248d,0x3f1c3f7fbf3dbf7f,0x3e9a3f68beecbf77
.quad 0xbf5ebe323f25be32,0xbf7cbf443f7c3f00,0xbec4bf773f4b3f77,0x3f1cbe85be063f35,0x3f773eafbf133eaf,0x3ed83f7cbf68bf5e,0x3e063f68bf58bf68,0xbf80bf133f2dbe85
.quad 0xbf80bf003f00bf00,0x3f00bf003f003f80,0x3e06bf523f633f52,0x3f0a3f7fbf7abe85,0x3f773f25bed83f25,0xbf7fbeaf3db2bf5e,0xbec43f35bf6dbf35,0x3ec4bf353f6d3f35
.quad 0xbf5ebf443eafbf44,0x3f253f71bf253f00,0x3f1cbf133f743f13,0xbf7abdb2bf0abf77,0x3f353f5ebe853f5e,0x3e85bf5e3f77a554,0xbf4b3ed8bf7abed8,0x3f3d3f52bd333f77
.quad 0xbf5ebf7c3f253f7c,0xbf7cbf253f7c3f5e,0x3f1cbdb2bf3dbdb2,0x3e9abed8beec3e85,0x3f353f80bf35bf80,0x3f353f80bf35bf80,0xbf4bbdb23f2dbdb2,0xbf74bed83f633e85
.quad 0xbf00bf7c3f443f7c,0x3e32bf253e323f5e,0x3f6d3e85bf1c3e85,0x3f4b3f77bf7ebf35,0x3e853f71bf52bf71,0xbf68be323ed8bf00,0xbf7ebed83f0abed8,0x3d33bf523f3d3f77
.quad 0xa50dbf5e3f5e3f5e,0x3f5e3f5ebf5e8000,0x3f7e3f13beec3f13,0xbf583db2be5ebf77,0xbe853f44bf68bf44,0xbdb2bf713f7f3f00,0xbf6dbf353ec4bf35,0x3f6d3f35bec43f35
.quad 0x3f00bf253f713f25,0xbf443eafbf44bf5e,0x3f4b3f52be9a3f52,0xbe5ebf7f3f58be85,0xbf353f00bf77bf00,0x3f773f003e853f80,0xbf1cbf683e5ebf68,0xbf2d3f13bf80be85
.quad 0x3f253f7cbeafbf5e,0x3f7c3f5ebf5ebf7c,0xbf4dbe3d3f643eb4,0xbf0c3e273f2f3c33,0xbf0ebf7b3f0e3f7b,0xbf0ebf7b3f0e3f7b,0x3f5c3e53bf42bd06,0x3f7c3f07bf70bebf
.quad 0x3eec3f7abf3dbf7e,0xbe5e3f1cbe06bf58,0xbf69be693f15be95,0xbf50bf753f7f3f2f,0xbebabf793f603f66,0x3f5b3d86bea53f17,0x3f733e7ebebf3f15,0x3e113f69bf59bf67
.quad 0x3e853f77bf77bf35,0xbf77bf353f35be85,0xbf7bbe8a3e11bf50,0x3f1ebed33f073f7f,0xbe1cbf763f803ee2,0x3ef63f7fbf72bddf,0x3f7f3e953dc93f75,0xbf7fbe95bdc9bf75
.quad 0x3d333f74bf7abe06,0x3e9abf4b3f7e3eec,0xbf80be9fbeaabf80,0x3f423f59beb43f49,0x3d86bf723f66be48,0xbf663e48bf55bf40,0x3f7e3eaa3f0c3f70,0xbd5fbf7d3f3bbf02
.quad 0xbf44be323f713f00,0xbe323f003f00be32,0xbf1abf7c3ee73f70,0xbf56bf7d3f3b3f80,0x3f553e48bf55be48,0x3f553e48bf55be48,0x3f023f7bbf27bf80,0x3e3d3f59beb4bf6e
.quad 0xbf63be5e3f2dbe06,0xbf7abf4b3f7e3f0a,0xbed3bf793f503f75,0x3f15be95bdc93f3b,0x3f6f3e73bef63ee2,0x3f053f7fbf72bf4e,0x3e9f3f78bf6ebf50,0xbf7dbed33f07bedd
.quad 0xbf77be853e85bf35,0x3e85bf353f353f77,0xbe53bf773f7d3f15,0x3f493f69bf593d9c,0x3f7d3e8fbcb33f66,0xbf603d86bea5bf7e,0x3dc93f75bf7fbe95,0xbdc9bf753f7f3e95
.quad 0xbf80be9abe5ebf7e,0x3f743f1cbe063f63,0x3c33bf733f72bd06,0xbf273f07bf70bf1e,0x3f7f3ea53ee23f7b,0xbee2bf7b3f0ebf29,0xbdf53f72bf563eb4,0x3f803e273f2f3f5c
.quad 0xbf25248d3f5e3eaf,0x248d3f253eafbeaf,0xbf2bbf7f3f073f77,0xbf62bf783f493f7f,0x3f553e48bf55be48,0x3f553e48bf55be48,0x3edd3f75bf15bf7e,0x3dc93f4dbe8abf64
.quad 0xbf74bec43f4b3d33,0xbf6dbf633f803f2d,0xbe27bf623f223f80,0x3f46bd06beb43f07,0x3f803f0ebf403ddf,0x3e483f6abf48bf76,0xbdf53f46bf2fbf7c,0xbf75bf423f56bc33
.quad 0xbf77bf353f35be85,0x3f35be853e853f77,0x3ec9bf223f3b3f72,0x3e953f7cbf80bf02,0x3f5b3f55bf293ece,0xbf7bbf173ebabf31,0xbf223ef1bf46bf62,0x3f22bef13f463f62
.quad 0xbf2dbf6d3f1cbf0a,0x3ec43f80bf583e5e,0x3f53be953f503f4d,0xbf7fbec9be7ebf80,0x3ee23f7bbf0e3f29,0x3f0ebf293f7f3ea5,0xbf733dc9bf59bf33,0x3ef13f77bebf3f53
.quad 0xbf44bf803f003f71,0xbf80bf443f713f71,0x3f3f3dc9bf59be8a,0x3ef1be7ebf1e3d9c,0x3f0e3f7bbf0ebf7b,0x3f0e3f7bbf0ebf7b,0xbf67be953f503df5,0xbf7fbf1a3f773ee7
.quad 0xbe9abf6d3f1c3f80,0x3ec4beecbd333f3d,0x3f7d3ef1bf463d06,0x3f223f80bf70bf59,0x3cb33f55bf29bf7e,0xbf7bbece3f20be8f,0xbf7ebf223f3bbe3d,0x3e95bf273f0c3f80
.quad 0x3e85bf353f353f77,0x3f353f77bf77be85,0x3f6b3f46bf2f3eaa,0xbf75be3d3d5fbf5c,0xbf053f0ebf40bf6a,0x3e48bf4e3f6f3f39,0xbf46bf623f22bef1,0x3f463f62bf223ef1
.quad 0x3f3dbec43f4b3f58,0xbf6d3d33bf0abf7a,0x3f113f75bf153f1a,0x3dc9bf6b3f783d5f,0xbf663e48bf55bf40,0x3f553f40bd863f72,0xbe9fbf7f3f07bf37,0xbf623e8abf6ebf11
.quad 0x3f003f71be32bf44,0x3f713f71bf44bf80,0xbf66beba3f763f05,0xbf31bcb33f4e3e48,0xbec4bf6d3ec43f6d,0xbec4bf6d3ec43f6d,0x3f723ecebf60be73,0x3f803f31bf7dbf0e
.quad 0x3e853f68bf13bf7f,0xbed83ed83db2bf35,0xbf7bbee23f40bd86,0xbf29bf7f3f723f55,0xbe06bf633f3d3f7a,0x3f743e9abf0a3ec4,0x3f7f3ef6bf173eba,0xbddf3f48bf31bf7b
.quad 0x248d3f5ebf5ebf5e,0xbf5ebf5e3f5ea554,0xbf7fbf053ecebf20,0x3f4ebe1c3e8f3f7b,0x3e06bf583f743f2d,0x3e5e3f7abf80bec4,0x3f7b3f0ebe483f55,0xbf7bbf0e3e48bf55
.quad 0xbe853f52bf7fbed8,0x3f13bf133f683f35,0xbf72bf17bcb3bf76,0x3f053f79bf203f0e,0x3ec4bf4b3f7e3e06,0xbf7ebe06bf1cbf6d,0x3f663f203e733f80,0x3e8fbf603f6abe48
.quad 0xbf5ebeaf3f7c3f25,0xbeaf3eaf3f25a50d,0xbee2bf6f3e8f3f5b,0xbf39bf803f173f7b,0x3f6d3ec4bf6dbec4,0x3f6d3ec4bf6dbec4,0x3ea53f6abef6bf79,0xbcb33f39be1cbf55
.quad 0xbf77bed83f523db2,0xbf68bf683f7f3f35,0xbe48bf663f293f7f,0x3f40bd86bea53f0e,0x3f7e3eecbf2d3e5e,0x3e9a3f74bf58bf6d,0x3d863f60bf4ebf6f,0xbf7ebf203f39be48
.quad 0xbf80bf003f00bf00,0x3f00bf003f003f80,0x3d86bf5b3f6a3f48,0x3f173f7dbf76be48,0x3f7e3f0abe9a3f3d,0xbf7abe5ebd33bf6d,0xbe483f55bf7bbf0e,0x3e48bf553f7b3f0e
.quad 0xbf77bf133db2bf68,0x3f523f52bed83f35,0x3ea5bf4e3f803e8f,0xbf5b3e73bf48bf55,0x3f6d3f1c3e063f7e,0xbe06bf7e3f4bbec4,0xbee23f48bf793cb3,0x3f763ef63ece3f7b
.quad 0xbf44be323f713f00,0xbe323f003f00be32,0xbf05bf763eba3f66,0xbf48bf7f3f293f7e,0x3f6d3ec4bf6dbec4,0x3f6d3ec4bf6dbec4,0x3e733f60becebf72,0xbddf3f29bd86bf48
.quad 0xbf7fbf133f683e85,0xbf52bf773f773f52,0x3d86bf403ee23f7b,0x3f663e48bf0e3ea5,0x3f7a3f3dbf63be06,0xbd333f4bbf1cbf80,0xbeba3f17bef6bf7f,0xbf5bbf663f723e73
.quad 0xbf5ebf5e3f5ea554,0x3f5ea554248d3f5e,0x3f20bece3f053f7f,0x3cb33f66bf72bf39,0x3f2d3f74bf583e06,0xbf63bf4b3f1cbeec,0xbf553e48bf0ebf7b,0x3f55be483f0e3f7b
.quad 0xbed8bf7f3f52be85,0x3db23f77bf77bdb2,0x3f763cb33f173f72,0xbf6abf293d86bf6f,0x3e063f7ebf4b3ec4,0x3f4bbec43f6d3f1c,0xbf80be73bf20bf66,0x3e1c3f7fbf293f17
.quad 0xbf25bf7c3eaf3f5e,0xbf7cbf5e3f5e3f7c,0x3f5b3e8fbf6fbee2,0x3f20bd86bf40bddf,0x3ec43f6dbec4bf6d,0x3ec43f6dbec4bf6d,0xbf79bef63f6a3ea5,0xbf7ebf403f7f3f20
.quad 0xbdb2bf523ed83f77,0x3f13be85be853f13,0x3f7f3f29bf66be48,0x3ee23f7bbf55bf72,0xbe5e3f2dbeecbf7e,0xbf80bf1c3f4bbd33,0xbf6fbf4e3f603d86,0x3f05bee23ea53f79
.quad 0x3f00bf003f003f80,0x3f003f80bf80bf00,0x3f483f6abf5b3d86,0xbf80bee23ea5bf31,0xbf3d3e9abf0abf7e,0x3eecbf1c3f4b3f63,0xbf0ebf7b3f55be48,0x3f0e3f7bbf553e48
.quad 0x3f68bdb23f133f77,0xbf7fbe85be85bf7f,0x3e8f3f80bf4e3ea5,0x3ecebf403f7f3eba,0xbf7ebe06bf1cbf6d,0x3f1c3f6dbec43f4b,0x3cb3bf793f48bee2,0xbf7dbd86bf40bf4e
.quad 0x3eaf3f5ea554bf25,0x3f5e3f7cbf25bf7c,0xbf77bf073f7f3f2b,0xbf50be533f673ebf,0xbe48bf553e483f55,0xbe48bf553e483f55,0x3f7e3f15bf75bedd,0x3f793f53bf80bf37
.quad 0x3d333f4bbec4bf74,0xbf1c3e5e3e9abf0a,0xbf80bf223f623e27,0xbef1bf7d3f593f70,0x3ddfbf403f0e3f80,0x3f7f3f05bf393e1c,0x3f7c3f2fbf463df5,0xbeb43f1abefbbf80
.quad 0xbe853f35bf35bf77,0xbf35bf773f773e85,0xbf72bf3b3f22bec9,0x3f703df53c333f64,0x3ecebf293f553f5b,0xbd863f60bf79bf20,0x3f623f46bef13f22,0xbf62bf463ef1bf22
.quad 0xbf0a3f1cbf6dbf2d,0x3f4bbe9a3f3d3f63,0xbf4dbf503e95bf53,0x3e693f7fbf563e8a,0x3f29bf0e3f7b3ee2,0xbf7bbee2bea5bf7f,0x3f333f59bdc93f73,0x3f15bf2b3f7f3e11
.quad 0xbf71bf003f803f44,0xbf003e323f443e32,0xbe8abf593dc93f3f,0xbf15bf7b3edd3f6e,0x3f7b3f0ebf7bbf0e,0x3f7b3f0ebf7bbf0e,0x3df53f50be95bf67,0xbe693f113d5fbf33
.quad 0xbf80bf1c3f6d3e9a,0xbf4bbf7a3f743f58,0x3d06bf463ef13f7d,0x3f623e27bf073eb4,0x3f7e3f29bf55bcb3,0x3d863f5bbf31bf7d,0xbe3d3f3bbf22bf7e,0xbf70bf4d3f5f3d5f
.quad 0xbf77bf353f35be85,0x3f35be853e853f77,0x3eaabf2f3f463f6b,0x3eb43f7ebf80bee7,0x3f6a3f40bf0e3f05,0xbf7fbef63e73bf48,0xbef13f22bf62bf46,0x3ef1bf223f623f46
.quad 0xbf58bf4b3ec4bf3d,0x3f1c3f74bf2d3eec,0x3f1abf153f753f11,0xbf79bd9cbf0cbf77,0x3f403f55be483f66,0x3e48bf663f72bd86,0xbf373f07bf7fbe9f,0x3f503f3f3d9c3f7d
.quad 0xbf5ebeaf3f7c3f25,0xbeaf3eaf3f25a554,0xbeb4bf643e3d3f4d,0xbf27bf7e3f023f75,0x3f7b3f0ebf7bbf0e,0x3f7b3f0ebf7bbf0e,0x3d063f42be53bf5c,0xbe9f3efb3e11bf22
.quad 0xbf7ebf3d3f7a3eec,0xbf2dbf803f633f6d,0x3e95bf153e693f69,0x3f793ed3bf3b3dc9,0x3f663f60bf79beba,0xbe8f3f20becebf7b,0xbf153ebfbe7ebf73,0xbf33bf7b3f7f3ef1
.quad 0xbf35bf773f773e85,0x3f773e85be853f35,0x3f50be113e8a3f7b,0xbe7e3f3fbf53bf62,0x3ee23f80bf76be1c,0xbf39bf6f3f4ebe48,0xbf75bdc9be95bf7f,0x3f753dc93e953f7f
.quad 0xbe06bf7a3f743d33,0xbe5e3f58bf80bec4,0x3f803eaa3e9f3f80,0xbf3fbf5c3ebfbf46,0xbe483f66bf723d86,0x3f72bd863f403f55,0xbf70bf0cbeaabf7e,0xbe3d3f6bbf5f3e95
.quad 0xbf00bf713e323f44,0xbf71bf713f443f80,0x3f703ee7bf7cbf1a,0x3f423df5bf5cbe95,0x3e483f55be48bf55,0x3e483f55be48bf55,0xbf80bf273f7b3f02,0xbf73bf5f3f7d3f46
.quad 0x3e06bf2d3e5e3f63,0x3f3dbd33beec3ec4,0x3f753f50bf79bed3,0x3e693f69bf2fbf7f,0xbee23ef6be73bf6f,0xbf76bf483f6a3e48,0xbf50bf6e3f783e9f,0x3f37be533d9c3f62
.quad 0x3f35be853e853f77,0x3e853f77bf77bf35,0x3f153f7dbf77be53,0xbf78bf2b3f11bef1,0xbf663cb3be8fbf7d,0x3f31beba3f173f7b,0xbe95bf7f3f753dc9,0x3e953f7fbf75bdc9
.quad 0x3f7e3e5e3e9a3f80,0xbf7abf0a3d33bf6d,0xbd063f72bf733c33,0x3f2bbf023f6e3f22,0xbf7bbee2bea5bf7f,0x3ea53f7fbf293f0e,0x3eb4bf563f72bdf5,0xbf7cbec9befbbf75
.quad 0x3f443e32bf71bf00,0x3e32bf00bf003e32,0xbd333f253e5ebf00,0x3e9a3f5ebe06bf44,0xbf35bf803f353f80,0xbf35bf803f353f80,0x3f803f25bf7abf00,0x3f743f5ebf7ebf44
.quad 0xbf253e323eafbf00,0xbf7cbf003f5e3e32,0xbe06bf5e3f1c3f80,0x3f4ba554bec43f00,0x3f523f71bf7fbf00,0xbed83f00be85bf71,0xbf7abeaf3eecbf00,0xbd33bf5e3f4b3f71
.quad 0x3f00bf003f003f80,0x3f003f80bf80bf00,0x3e9a3f7cbf80bf00,0xbf58bf5e3f4bbe32,0xbf68bf443f13bf00,0x3f7f3f00be853f44,0x3f6da5543ec43f80,0xbf6d248dbec4bf80
.quad 0xbeaf3f44bf7cbf00,0x3f25bf003f5e3f44,0xbeecbf7c3f2dbf00,0xbe5e3f5ebf7ebe32,0x3f773f003e853f80,0xbe85bf803f35bf00,0xbf583eafbf74bf00,0x3f2d3f5ebe063f71
.quad 0x3f253f7cbeafbf5e,0x3f7c3f5ebf5ebf7c,0xbf80bf443f7a3f5e,0xbf74bf003f7e3f25,0x3f35a50dbf358000,0x3f35a50dbf358000,0x3d333f44be5ebf5e,0xbe9a3f003e06bf25
.quad 0xbf44bf7c3f713f5e,0xbe32bf5e3f003f7c,0x3f7e3f00bf4b8000,0x3f1c3f80bf6dbf5e,0xbf133eafbdb2bf5e,0xbf68bf5e3f773eaf,0xbe5ebf713f633f5e,0x3f803f00bf1c3eaf
.quad 0x3f5e3f5ebf5e8000,0xbf5e8000a50dbf5e,0xbf74be323d33bf5e,0x3f0abf003f1c3f7c,0x3ed8bf253f523f5e,0xbdb23f5ebf77bf25,0x3ec43f80bf6d8000,0xbec4bf803f6da50d
.quad 0xbf71bf253e32bf5e,0x3f443f5ebf003f25,0x3f63be323f3d3f5e,0xbf7abf00be06bf7c,0xbe853f5ebf778000,0x3f77a50d3f353f5e,0xbf0abf713e9abf5e,0xbf3d3f00bf7ebeaf
.quad 0x3f443f80bf00bf71,0x3f803f44bf71bf71,0xbf80bf353f7e3f52,0xbf6dbed83f7a3f13,0x3f35a554bf35248d,0x3f35a554bf35248d,0xbd333f35be06bf52,0xbec43ed83e5ebf13
.quad 0xbf25bf803f5e3f71,0xa554bf443eaf3f71,0x3f7e3f35bf6dbe85,0x3ec43f77bf4bbf77,0xbf52248d3e85bf25,0xbf35bf7c3f7f3f25,0x3e5ebf353f1c3f7f,0x3f6d3f52bf63bdb2
.quad 0x3f003f80bf80bf00,0xbf80bf003f00bf00,0xbf74bf353f1cbed8,0x3f6d3db23d333f68,0x3f68a5543e853f7c,0xbf353eafbf13bf7c,0xbec43f35bf6dbf35,0x3ec4bf353f6d3f35
.quad 0xbeafbf803f5ebe32,0x248d3f71bf7cbe32,0x3f633f35be063f68,0xbec4bf7f3f3dbed8,0xbf77248dbf35bf5e,0x3f353f5ebe853f5e,0x3f0abf353f7e3db2,0xbf6dbf13be9abf7f
.quad 0xbf2580003f5e3eaf,0x80003f253eafbeaf,0xbd33bf35be063f13,0xbec4bf683e5e3f52,0x3f353f80bf35bf80,0x3f353f80bf35bf80,0xbf80bf353f7e3f13,0xbf6dbf683f7a3f52
.quad 0x3f44a50dbf003eaf,0x3f803f25bf71beaf,0xbe063f35bec4bf77,0xbf6dbe853f1cbe85,0xbf13bf803f773f44,0x3f35be32bdb23f44,0x3f7a3f35bf4b3db2,0xbec43f13beecbf7f
.quad 0xbf5e8000a50dbf5e,0xa50dbf5e3f5e3f5e,0x3e9abf353f4b3f68,0x3ec43f7fbf80bed8,0x3ed83f80bf77be32,0xbf35bf713f52be32,0xbf6dbf353ec4bf35,0x3f6d3f35bec43f35
.quad 0x3f71a50d3f003f7c,0xbf80beafbe32bf7c,0xbeec3f35bf7ebed8,0x3f6dbdb23f2d3f68,0xbe85bf803f35bf00,0xbf353f00bf77bf00,0x3f583f353e063f7f,0x3ec4bf523f74bdb2
.quad 0x3f5e3eafbf7cbf25,0x3eafbeafbf25248d,0xbe693efb3ec9beaa,0x3df53f423d5fbf22,0xbf0ebf7b3f0e3f7b,0xbf0ebf7b3f0e3f7b,0x3f7d3f49bf80bf2b,0x3f5f3f73bf72bf62
.quad 0xbf4bbd333f0abe9a,0xbf80bf2d3f743ec4,0x3dc9bf3b3ed33f79,0x3f693e69bf153e95,0x3f293f7ebf7dbf31,0xbf203e8fbcb3bf55,0xbf80bf113f2bbe8a,0x3e53bf373f1e3f7f
.quad 0x3f35be853e853f77,0x3e853f77bf77bf35,0x3d063f67bf73bf37,0xbf2bbf783f6e3dc9,0xbf40bf6a3f48be73,0x3f6f3f39bf053f0e,0x3f7f3e953dc93f75,0xbf7fbe95bdc9bf75
.quad 0xbf1c3f0abf63bf3d,0x3f58be5e3f2d3f6d,0xbe27bf7d3f5fbe53,0xbf023f2bbf7cbef1,0x3f553f40bd863f72,0x3d86bf723f66be48,0xbf793c33bf4dbf42,0x3ec93f7cbee73f46
.quad 0x3f003f71be32bf44,0x3f713f71bf44bf80,0xbf79bf5f3f6b3f72,0xbf7ebf273f803f46,0x3f553e48bf55be48,0x3f553e48bf55be48,0xbe273f1ebc33bf3f,0xbefb3e9f3eaabef1
.quad 0xbf1cbf803f583f74,0x3d33bf3d3e9a3f6d,0x3f7f3f2fbf69be69,0x3ed33f79bf50bf75,0xbf403ddf3e1cbf39,0xbf48bf763f803f0e,0x3d06bf533f3f3f77,0x3f7b3f33bf493dc9
.quad 0x3f353f77bf77be85,0xbf77be853e85bf35,0xbf80bedd3e9fbf33,0x3f3fbe7e3ebf3f7f,0x3f29bece3f203f79,0xbeba3f31bf5bbf55,0x3dc93f75bf7fbe95,0xbdc9bf753f7f3e95
.quad 0xbf4bbf583eecbf2d,0x3f0a3f7abf3d3ec4,0x3f7d3e113efb3f7b,0xbf5cbf3f3e3dbf62,0xbf0e3f29bf7fbea5,0x3f7f3ea53ee23f7b,0xbe69bf803f1abf27,0xbf6b3e3dbf64bf22
.quad 0x3f253f7cbeafbf5e,0x3f7c3f5ebf5ebf7c,0xbf7dbf533f733f69,0xbf7bbf153f803f37,0x3f553e48bf55be48,0x3f553e48bf55be48,0xbe7e3f0c3d9cbf2f,0xbf113e693ed3bec9
.quad 0xbeecbf7a3f3d3f7e,0x3e5ebf1c3e063f58,0x3f703f59bf7dbef1,0x3e273f62bf22bf80,0xbf6fbe733ef6bee2,0xbf05bf7f3f723f4e,0x3ee7bf023ec93f7d,0x3f4d3f70bf79beaa
.quad 0x3e853f77bf77bf35,0xbf77bf353f35be85,0xbf56bf5f3f4dbe27,0x3f7e3eb4be693f42,0x3f7d3e8fbcb33f66,0xbf603d86bea5bf7e,0xbf223ef1bf46bf62,0x3f22bef13f463f62
.quad 0xbd33bf743f7a3e06,0xbe9a3f4bbf7ebeec,0x3f333f64bedd3f3b,0xbd9cbf793f69bdf5,0xbf7fbea5bee2bf7b,0x3ee23f7bbf0e3f29,0x3f49bedd3f7b3ed3,0xbf3fbf503d06bf78
.quad 0xbf44be323f713f00,0xbe323f003f00be32,0x3e11bf11be9f3ed3,0xbe53bf503d063f33,0x3f0e3f7bbf0ebf7b,0x3f0e3f7bbf0ebf7b,0xbf78bf563f7f3f3b,0xbf53bf793f693f6b
.quad 0x3f633e5ebf2d3e06,0x3f7a3f4bbf7ebf0a,0xbeb43f07be27bf62,0xbf7dbef13f46bd06,0xbebabf793f603f66,0x3f5b3d86bea53f17,0x3f643f5cbf6bbe27,0xbf1a3eb4be69bf72
.quad 0xbf77be853e85bf35,0x3e85bf353f353f77,0x3f0cbefb3f1a3f7d,0x3df53f70bf79bf27,0x3e1c3f76bf80bee2,0xbef6bf7f3f723ddf,0xbf46bf623f22bef1,0x3f463f62bf223ef1
.quad 0x3f803e9a3e5e3f7e,0xbf74bf1c3e06bf63,0xbf373ee7bf67bf2f,0x3f7f3e693ed33f7e,0x3d86bf723f66be48,0xbf663e48bf55bf40,0x3f1e3f67be533f69,0x3f2bbf153f803e7e
.quad 0x3f713f00bf80bf44,0x3f00be32bf44be32,0xbece3ea53f0ebe1c,0xbd863f203e73bef6,0xbec4bf6d3ec43f6d,0xbec4bf6d3ec43f6d,0x3f6f3f66bf7bbf4e,0x3f403f7ebf5bbf76
.quad 0xbf68be853f35bdb2,0xbf77bf523f7f3f13,0x3ea5bf0e3e483f66,0x3f7b3ee2bf403d86,0x3eec3f7ebf6dbf58,0xbf4b3d333e5ebf2d,0xbf76bf403f55bcb3,0x3ee2bf053ece3f7d
.quad 0x3f5ea554248d3f5e,0x248d3f5ebf5ebf5e,0xbe733f40bf55bf60,0xbee2bf803f7e3eba,0xbf0abf7e3f6d3d33,0x3f4b3f63bf3d3e9a,0x3f7b3f0ebe483f55,0xbf7bbf0e3e48bf55
.quad 0xbf523e85bf35bf68,0x3f773db23ed83f7f,0x3e1cbf663f7b3ddf,0xbf403ecebf60bf39,0x3f1c3f6dbec43f4b,0x3ec4bf4b3f7e3e06,0xbf7ebea5bf0ebf6f,0x3d863f7dbf393f05
.quad 0x3eaf3f5ea50dbf25,0x3f5e3f7cbf25bf7c,0xbf6abf723f553f7d,0xbf7fbf483f793f60,0x3f6d3ec4bf6dbec4,0x3f6d3ec4bf6dbec4,0xbeba3ee23e48bf17,0xbf293ddf3f05be8f
.quad 0xbed8bf773f353f7f,0x3e85bf133db23f52,0x3f723f55bf7bbee2,0x3e483f66bf29bf7f,0xbf63be063ec4bf0a,0xbf1cbf803f7a3f3d,0x3e8fbf293f0e3f80,0x3f663f5bbf6abe1c
.quad 0x3f003f80bf80bf00,0xbf80bf003f00bf00,0xbf79bf293f0ebef6,0x3f663cb33ddf3f6f,0x3f58be063ec43f80,0xbf1c3eecbf2dbf74,0xbe483f55bf7bbf0e,0x3e48bf553f7b3f0e
.quad 0xbf13bf773f35bed8,0x3e853f7fbf683db2,0x3f7d3ee23e483f7e,0xbf29bf6a3ef6bf31,0xbf4b3ec4bf6dbf1c,0x3f6d3f1c3e063f7e,0x3ddfbf723f55beba,0xbf7fbe1cbf31bf5b
.quad 0x3f003f71be32bf44,0x3f713f71bf44bf80,0xbf72bf6a3f603f79,0xbf80bf393f7d3f55,0x3f6d3ec4bf6dbec4,0x3f6d3ec4bf6dbec4,0xbee23eba3e8fbf05,0xbf393cb33f17be48
.quad 0xbe85bf683f133f7f,0x3ed8bed8bdb23f35,0x3f553f72bf7fbf29,0xbd863f40bee2bf7b,0xbf7ebeec3f2dbe5e,0xbe9abf743f583f6d,0x3f29be8f3e1c3f6a,0x3f203f7ebf80bf0e
.quad 0x248d3f5ebf5ebf5e,0xbf5ebf5e3f5ea554,0xbf29bf793f6f3ddf,0x3f7d3f17bef63f0e,0x3f7e3f0abe9a3f3d,0xbf7abe5ebd33bf6d,0xbf553e48bf0ebf7b,0x3f55be483f0e3f7b
.quad 0x3e85bf523f7f3ed8,0xbf133f13bf68bf35,0x3ee23f7dbf313ef6,0x3e73bf5b3f7e3e48,0xbf6dbf1cbe06bf7e,0x3e063f7ebf4b3ec4,0x3f72bddf3f5b3f31,0xbef6bf763ebabf55
.quad 0xbf5ebeaf3f7c3f25,0xbeaf3eaf3f25a50d,0x3ea5becebef63e73,0xbcb3bf31be1c3f0e,0x3ec43f6dbec4bf6d,0x3ec43f6dbec4bf6d,0xbf66bf6f3f763f5b,0xbf31bf803f4e3f7b
.quad 0x3f773ed8bf52bdb2,0x3f683f68bf7fbf35,0xbf0e3ea53d86bf40,0xbf7fbf293f663e48,0xbe06bf633f3d3f7a,0x3f743e9abf0a3ec4,0x3f403f76bf7dbece,0xbf483ddf3cb3bf55
.quad 0xbf80bf003f00bf00,0x3f00bf003f003f80,0x3f40be733eba3f7e,0xbe1c3f4ebf60bf55,0xbe063f58bf74bf2d,0xbe5ebf7a3f803ec4,0xbf0ebf7b3f55be48,0x3f0e3f7bbf553e48
.quad 0x3f773f13bdb23f68,0xbf52bf523ed8bf35,0xbf663e1cbf39bf60,0x3f793f053ddf3f7b,0x3ec4bf4b3f7e3e06,0xbf7ebe06bf1cbf6d,0x3ea53f7ebf053f39,0x3f60be8f3f6f3f0e
.quad 0x3f7c3f25bf7cbf5e,0x3f25a554bf5ebeaf,0xbf113e113f333d06,0xbe7e3ef13ed3be9f,0xbe48bf553e483f55,0xbe48bf553e483f55,0x3f563f78bf6bbf69,0x3f1a3f7fbf3bbf7f
.quad 0xbf7abeec3f583e06,0xbf63bf6d3f7e3f3d,0x3f07beb4bd063f46,0x3f803f22bf62be27,0x3e733f6fbf4ebf72,0xbf6abe483ee2bef6,0xbf5cbf643f723e69,0x3f27be953e273f6b
.quad 0x3f773e85be853f35,0xbe853f35bf35bf77,0xbefb3f0cbf27bf79,0xbe3dbf753f7d3f1a,0xbe8fbf7d3f7e3ea5,0x3f173f7bbf663cb3,0x3f623f46bef13f22,0xbf62bf463ef1bf22
.quad 0xbf74bd33beecbf7e,0x3f803ec43e063f7a,0x3ee7bf373f7e3ed3,0xbf6b3dc9bf2fbf67,0x3ea53f7fbf293f0e,0x3f29bf0e3f7b3ee2,0xbf67bf1ebe7ebf80,0xbe8a3f62bf693e53
.quad 0x3e323f443e32bf00,0x3f443f80bf00bf71,0xbf53bf7d3f373f80,0xbf78bf623f693f73,0x3f7b3f0ebf7bbf0e,0x3f7b3f0ebf7bbf0e,0xbf0c3e7e3ec9bed3,0xbf4dbdc93f2fbd9c
.quad 0xbe5ebf633f0a3f7e,0x3eecbec4be063f2d,0x3f593f70bf80bf22,0xbd063f46bef1bf7d,0xbf79beba3f17bea5,0xbecebf7b3f663f60,0x3f02bee73eaa3f79,0x3f423f75bf7dbec9
.quad 0x3e853f77bf77bf35,0xbf77bf353f35be85,0xbf5fbf563f42be69,0x3f7c3e95be273f4d,0x3f763e1c3ddf3f72,0xbf4e3e48bee2bf80,0xbef13f22bf62bf46,0x3ef1bf223f623f46
.quad 0xbe9abf803f63be06,0xbd333f6dbf7ebe5e,0x3f643f33bdf53f69,0xbec9bf7f3f3bbedd,0xbf723d86bf40bf55,0x3f403f55be483f66,0x3eddbf493f78bd06,0xbf77bef1bed3bf7b
.quad 0x3eaf3f5ea554bf25,0x3f5e3f7cbf25bf7c,0xbf5fbf793f463f80,0xbf7dbf563f723f6b,0x3f7b3f0ebf7bbf0e,0x3f7b3f0ebf7bbf0e,0xbf1e3e273ef1beaa,0xbf59be3d3f3f3c33
.quad 0xbd33bf4b3ec43f74,0x3f1cbe5ebe9a3f0a,0x3f2f3f7fbf75bf50,0xbe953f15be69bf69,0xbf7ebf293f553cb3,0xbd86bf5b3f313f7d,0x3f53bd06bdc93f49,0x3ed33f7dbf77bf3f
.quad 0xbe853f35bf35bf77,0xbf35bf773f773e85,0xbeddbf803f7f3ebf,0x3f693f49bf333e9f,0x3f6a3f40bf0e3f05,0xbf7fbef63e73bf48,0xbf75bdc9be95bf7f,0x3f753dc93e953f7f
.quad 0x3f0abf1c3f6d3f2d,0xbf4b3e9abf3dbf63,0x3e113f7dbf623e3d,0x3f07bf273f7b3efb,0xbf40bf553e48bf66,0xbe483f66bf723d86,0x3f803e693f223f64,0xbe27bf803f27bf1a
.quad 0xbf71bf003f803f44,0xbf003e323f443e32,0x3efbbe69bf223d5f,0x3e27bf0cbeaa3ec9,0x3e483f55be48bf55,0x3e483f55be48bf55,0xbf49bf7d3f623f72,0xbf07bf7c3f2b3f80
.quad 0x3f803f1cbf6dbe9a,0x3f4b3f7abf74bf58,0xbf3b3dc93e95bf15,0xbf75bf503f793ed3,0x3ddfbf403f0e3f80,0x3f7f3f05bf393e1c,0x3f113f80bf7fbf1e,0xbf69be113e8abf2b
.quad 0xbf77bf353f35be85,0x3f35be853e853f77,0x3f673d063dc93f6e,0xbed33f1ebf37bf73,0xbece3f29bf55bf5b,0x3d86bf603f793f20,0xbe95bf7f3f753dc9,0x3e953f7fbf75bdc9
.quad 0x3f583f4bbec43f3d,0xbf1cbf743f2dbeec,0xbf7dbe27bef1bf7c,0x3f593f42be533f5f,0x3f29bf0e3f7b3ee2,0xbf7bbee2bea5bf7f,0xbc333f79bf463ee7,0x3f7d3d5f3f423f4d
.quad 0xbf00bf713e323f44,0xbf71bf713f443f80,0x3f1c3f7cbeecbf71,0x3f583f7cbf3dbf80,0xbf35bf803f353f80,0xbf35bf803f353f80,0x3f4b3f7cbf63bf71,0x3f0a3f7cbf2dbf80
.quad 0xbf5ebf713f7c3f44,0xbeafbf713f253f80,0x3f6d3f5ebf7ebf00,0x3e063f5ebf1cbf80,0xbf77bf443f683e32,0x3db2bf443f133f80,0x3f7e3f25bf3d3e32,0xbe9a3f25bf0abf80
.quad 0xbf80bf003f00bf00,0x3f00bf003f003f80,0x3f7e3eafbe5e3f44,0xbf2d3eafbeecbf80,0xbf77be32bdb2bf71,0x3f52be323ed83f80,0x3f6da5543ec43f80,0xbf6d248dbec4bf80
.quad 0xbf5e3e32bf25bf71,0x3f7c3e323eaf3f80,0x3f4bbeaf3f583f44,0xbf80beafbe9abf80,0xbf353f00bf77bf00,0x3f773f003e853f80,0x3f1cbf253f803e32,0xbf63bf25be5ebf80
.quad 0x3f5e3eafbf7cbf25,0x3eafbeafbf258000,0xbf4bbe323f633eaf,0xbf0a3e323f2da50d,0x3f35a50dbf358000,0x3f35a50dbf358000,0xbf1c3e323eecbeaf,0xbf58be323f3da50d
.quad 0x3f00beafbe323f25,0x3f713eafbf448000,0xbec43f00be06bf5e,0xbf7ebf003f4ba50d,0x3e85bf253ed83f7c,0x3f7f3f25bf528000,0xbe063f44bf2dbf7c,0xbf74bf443f58a50d
.quad 0xa50dbf5e3f5e3f5e,0x3f5e3f5ebf5e8000,0x3e063f71bf7abf25,0xbf3dbf713f63a50d,0xbe85bf7c3f7f3eaf,0x3f133f7cbf688000,0x3ec43f80bf6d8000,0xbec4bf803f6da50d
.quad 0xbf00bf7c3f44beaf,0x3e323f7cbf718000,0x3f1c3f71bf0a3f25,0x3d33bf713f74a50d,0xbf35bf5e3e85bf5e,0xbe853f5ebf778000,0x3f4b3f443d333f7c,0x3eecbf443f7aa50d
.quad 0x3f443e32bf71bf00,0x3e32bf00bf003e32,0xbf3dbdb23f583e85,0xbeec3e853f1cbdb2,0x3f35a554bf35248d,0x3f35a554bf35248d,0xbf2d3db23f0abe85,0xbf63be853f4b3db2
.quad 0x3f25be32beaf3f00,0x3f7c3f00bf5ebe32,0xbf1c3e853e06bf35,0xbf7ebf353f6d3e85,0x3f13beaf3db23f5e,0x3f683f5ebf77beaf,0xbf0a3ed8be9abf77,0xbf3dbf773f7e3ed8
.quad 0x3f00bf003f003f80,0x3f003f80bf80bf00,0xbeec3f13bf2dbf77,0xbe5ebf773f7e3f13,0x3ed8bf253f523f5e,0xbdb23f5ebf77bf25,0xbec43f35bf6dbf35,0x3ec4bf353f6d3f35
.quad 0x3eafbf443f7c3f00,0xbf253f00bf5ebf44,0xbe9a3f52bf80be85,0x3f58be853f4b3f52,0x3e85bf5e3f77a554,0xbf77248dbf35bf5e,0xbe5e3f68bf633e85,0x3f803e853f1c3f68
.quad 0x3f253f7cbeafbf5e,0x3f7c3f5ebf5ebf7c,0xbf2dbf7f3f0a3f77,0xbf63bf773f4b3f7f,0x3f353f80bf35bf80,0x3f353f80bf35bf80,0xbf3dbf7f3f583f77,0xbeecbf773f1c3f7f
.quad 0x3f443f7cbf71bf5e,0x3e323f5ebf00bf7c,0xbf4bbf773f7e3f35,0x3e06bf353ec43f77,0x3f523f71bf7fbf00,0xbed83f00be85bf71,0xbf58bf683f743e85,0x3f2dbe853e063f68
.quad 0x3f5e3f5ebf5e8000,0xbf5e8000a50dbf5e,0xbf63bf523f3dbe85,0x3f7a3e85be063f52,0x3f683f44bf133f00,0xbf7fbf003e85bf44,0xbf6dbf353ec4bf35,0x3f6d3f35bec43f35
.quad 0x3f713f25be323f5e,0xbf44bf5e3f00bf25,0xbf74bf13bd33bf77,0x3f0a3f77bf1c3f13,0x3f773f003e853f80,0xbe85bf803f35bf00,0xbf7abed8beecbf77,0xbd333f77bf4b3ed8
.quad 0xbeafbf5e248d3f25,0xbf5ebf7c3f253f7c,0x3ee73f70be95bf5c,0x3f3b3f80bf1abf7c,0xbf0ebf7b3f0e3f7b,0xbf0ebf7b3f0e3f7b,0x3f273f80bf46bf7d,0x3eb43f6ebf02bf7b
.quad 0xbf3dbf7e3f6d3f63,0xbe06bf583eec3f7a,0x3f503f75bf7fbf2f,0xbdc93f3bbed3bf79,0xbf60bf663f7b3ece,0x3ea5bf173eba3f79,0x3f6e3f50bf62bd9c,0xbf073eddbe9fbf78
.quad 0xbf77bf353f35be85,0x3f35be853e853f77,0x3f7d3f15bef13f11,0xbf593d9cbe53bf77,0xbf80bee23e48bf4e,0x3f723ddf3e1c3f76,0x3f7f3e953dc93f75,0xbf7fbe95bdc9bf75
.quad 0xbf7abe06bec4bf80,0x3f7e3eec3d333f74,0x3f72bd063f223f6e,0xbf70bf1e3c33bf73,0xbf663e48bf55bf40,0x3f553f40bd863f72,0x3f56beb43f753efb,0xbf2fbf5c3df5bf72
.quad 0x3f713f00bf80bf44,0x3f00be32bf44be32,0xbf64beb43f753f02,0xbf2fbc333f4d3e3d,0x3f553e48bf55be48,0x3f553e48bf55be48,0xbf42bd063f22be11,0xbf70bebf3f5c3e53
.quad 0x3f2dbe06bec43eec,0x3f7e3f0abf63be5e,0xbf153e953dc9bf3b,0xbf7fbf2f3f693e69,0x3ef6bee23e483f6a,0x3f723f4ebf6fbe73,0xbebf3f15bef1bf7f,0xbf59bf673f733e7e
.quad 0x3e85bf353f353f77,0x3f353f77bf77be85,0xbe113f50bf62bf53,0xbf07bf7f3f7b3e8a,0x3cb3bf663f7b3f17,0x3ea53f7ebf7dbe8f,0x3dc93f75bf7fbe95,0xbdc9bf753f7f3e95
.quad 0xbe5ebf7e3f6dbd33,0xbe063f63bf80be9a,0x3eaa3f80bf463ebf,0x3eb4bf493f803e9f,0xbee2bf7b3f0ebf29,0xbf0e3f29bf7fbea5,0x3f0c3f70be953f5f,0x3f3bbf023f7e3eaa
.quad 0x3f5e3eafbf7cbf25,0x3eafbeafbf25248d,0xbf59be8a3f6e3edd,0xbf1e3d9c3f3f3dc9,0x3f553e48bf55be48,0x3f553e48bf55be48,0xbf50bdf53f33bd5f,0xbf77bee73f673e95
.quad 0x3f4b3d33bf0a3e9a,0x3f803f2dbf74bec4,0xbf463d063eb4bf07,0xbf70bf593f7d3ef1,0x3f40bddfbe1c3f39,0x3f483f76bf80bf0e,0xbf3b3e3dbd5fbf5f,0xbf0cbf803f7e3f22
.quad 0x3f35be853e853f77,0x3e853f77bf77bf35,0xbf2f3eaabee7bf80,0x3d5fbf5c3f6b3f46,0x3f29bece3f203f79,0xbeba3f31bf5bbf55,0xbf223ef1bf46bf62,0x3f22bef13f463f62
.quad 0x3f1cbf0a3f633f3d,0xbf583e5ebf2dbf6d,0xbf153f1abf77bf0c,0x3f783d5f3f113f75,0x3f0ebf293f7f3ea5,0xbf7fbea5bee2bf7b,0xbf073f37bf7dbd9c,0x3f6e3f113e9f3f7f
.quad 0x3f003f71be32bf44,0x3f713f71bf44bf80,0xbf07bf773ebf3f67,0xbf49bf7f3f2b3f7f,0x3f0e3f7bbf0ebf7b,0x3f0e3f7bbf0ebf7b,0xbf15bf7e3f373f80,0xbe8abf643edd3f75
.quad 0x3f1c3f80bf58bf74,0xbd333f3dbe9abf6d,0xbf22bf803f703f59,0x3eb4bf073e273f62,0x3f293f7ebf7dbf31,0xbf203e8fbcb3bf55,0xbf2fbf7c3f803efb,0x3f56bc33bdf53f46
.quad 0x3f353f77bf77be85,0xbf77be853e85bf35,0xbf3bbf723f643c33,0x3f803f02bec93f22,0x3f403f6abf483e73,0xbf6fbf393f05bf0e,0xbf46bf623f22bef1,0x3f463f62bf223ef1
.quad 0x3f4b3f58beec3f2d,0xbf0abf7a3f3dbec4,0xbf50bf4d3e8abf56,0x3e7e3f80bf533e95,0x3f553f40bd863f72,0x3d86bf723f66be48,0xbf59bf33be11bf7f,0xbebf3f53bf733dc9
.quad 0xbe32bf44be323f00,0xbf44bf803f003f71,0x3e8f3f5bbddfbf40,0x3f173f7bbee2bf6f,0xbec4bf6d3ec43f6d,0xbec4bf6d3ec43f6d,0x3ef63f79bf20bf7f,0x3e1c3f55bea5bf6a
.quad 0xbf13bf7f3f523f77,0x3db2bf353e853f68,0x3f293f7fbf72bf55,0xbea53f0ebe48bf66,0xbf3dbf7a3f803f1c,0x3f0abec43e063f63,0x3f4e3f6fbf79bea5,0xbf393e48bd86bf60
.quad 0xbf5ebf5e3f5ea554,0x3f5ea554248d3f5e,0x3f6a3f48bf313ea5,0xbf76be483d86bf5b,0xbf74bf2d3eecbf1c,0x3f803ec4be063f58,0x3f7b3f0ebe483f55,0xbf7bbf0e3e48bf55
.quad 0xbf7fbed8bdb2bf77,0x3f683f35be853f52,0x3f803e8f3eba3f7f,0xbf48bf553ea5bf4e,0xbf7ebe06bf1cbf6d,0x3f1c3f6dbec43f4b,0x3f79bcb33f4e3f40,0xbecebf7b3ee2bf48
.quad 0x3f7c3f25bf7cbf5e,0x3f25a50dbf5ebeaf,0xbf76bf053f7e3f29,0xbf4ebe483f663eba,0x3f6d3ec4bf6dbec4,0x3f6d3ec4bf6dbec4,0xbf60be733f483d86,0xbf7dbf0e3f723ece
.quad 0x3f523db2bf133e85,0x3f7f3f35bf77bed8,0xbf403d863ea5bf0e,0xbf72bf553f7b3ee2,0x3f2dbe5ebd333f4b,0x3f583f6dbf7ebeec,0xbf173ebabe73bf72,0xbf31bf7b3f7f3ef6
.quad 0x3f00bf003f003f80,0x3f003f80bf80bf00,0xbece3f20bf39bf72,0xbe8fbf7b3f7f3f05,0x3e9abf3d3f633f4b,0x3d333f6dbf7ebf0a,0xbe483f55bf7bbf0e,0x3e48bf553f7b3f0e
.quad 0x3db2bf683f7f3e85,0xbed83f35bf77bf13,0x3cb33f76bf6f3d86,0x3f20bf0e3f723f17,0xbe06bf7e3f4bbec4,0xbf4b3ec4bf6dbf1c,0x3e733f80bf173f29,0x3f6abe483f663f20
.quad 0x3f713f00bf80bf44,0x3f00be32bf44be32,0xbf6fbee23f7b3f17,0xbf40bddf3f5b3e8f,0x3f6d3ec4bf6dbec4,0x3f6d3ec4bf6dbec4,0xbf6abea53f553e1c,0xbf7fbf203f793ef6
.quad 0x3f683e85bf353db2,0x3f773f52bf7fbf13,0xbf66be483f0ebea5,0xbf55bf723f7f3f29,0x3f633e06bec43f0a,0x3f1c3f80bf7abf3d,0xbf60bd863e48bf39,0xbea5bf793f6f3f4e
.quad 0x3f5ea554248d3f5e,0x248d3f5ebf5ebf5e,0xbf5b3d86be48bf76,0x3ea5bf313f483f6a,0x3f58be063ec43f80,0xbf1c3eecbf2dbf74,0xbf553e48bf0ebf7b,0x3f55be483f0e3f7b
.quad 0x3f52be853f353f68,0xbf77bdb2bed8bf7f,0xbf4e3ea5bf55bf48,0x3f7f3eba3e8f3f80,0x3f4bbec43f6d3f1c,0xbf6dbf1cbe06bf7e,0xbf483ee2bf7bbece,0x3f403f4ebcb33f79
.quad 0x3eaf3f5ea50dbf25,0x3f5e3f7cbf25bf7c,0xbebabf663e483f4e,0xbf29bf7e3f053f76,0x3ec43f6dbec4bf6d,0x3ec43f6dbec4bf6d,0xbecebf723f0e3f7d,0xbd86bf483e733f60
.quad 0x3ed83f77bf35bf7f,0xbe853f13bdb2bf52,0xbee2bf7b3f553f72,0x3f0ebea5bd863f40,0x3eec3f7ebf6dbf58,0xbf4b3d333e5ebf2d,0xbef6bf7f3f7b3f31,0x3f723e73beba3f17
.quad 0x3f003f80bf80bf00,0xbf80bf003f00bf00,0xbf05bf7f3f7b3e8f,0x3f723f39bf203ece,0x3f0a3f7ebf6dbd33,0xbf4bbf633f3dbe9a,0xbf0ebf7b3f55be48,0x3f0e3f7bbf553e48
.quad 0x3f133f77bf353ed8,0xbe85bf7f3f68bdb2,0xbf17bf723f0ebf20,0xbd863f6fbf76bcb3,0x3f1c3f6dbec43f4b,0x3ec4bf4b3f7e3e06,0xbf20bf663e48bf6a,0xbf293f17bf80be73
.quad 0xa554bf25beaf3eaf,0xbf25bf7c3eaf3f5e,0x3dc93f3f3d9cbf1e,0x3edd3f6ebe8abf59,0xbe48bf553e483f55,0xbe48bf553e483f55,0x3e953f67bee7bf77,0xbd5f3f33bdf5bf50
.quad 0xbec4bf743f2d3f80,0x3e9abf0a3d333f4b,0x3ef13f7dbf59bf70,0xbf073eb43d06bf46,0xbf0ebf803f763f48,0x3f39be1cbddf3f40,0x3f223f7ebf80bf0c,0xbf5fbd5f3e3dbf3b
.quad 0xbf35bf773f773e85,0x3f773e85be853f35,0x3f463f6bbf5c3d5f,0xbf80bee73eaabf2f,0xbf55bf5b3f31beba,0x3f793f20bece3f29,0x3f623f46bef13f22,0xbf62bf463ef1bf22
.quad 0xbf6dbf2d3e5ebf58,0x3f3d3f63bf0a3f1c,0x3f753f113d5f3f78,0xbf0cbf773f1abf15,0xbf7bbee2bea5bf7f,0x3ea53f7fbf293f0e,0x3f7f3e9f3f113f6e,0xbd9cbf7d3f37bf07
.quad 0x3f803f44bf71bf71,0x3f443e32bf71bf00,0xbf7fbf2b3f7f3f49,0xbf67bebf3f773f07,0x3f7b3f0ebf7bbf0e,0x3f7b3f0ebf7bbf0e,0xbf75bedd3f643e8a,0xbf80bf373f7e3f15
.quad 0x3f6d3e9abf3d3d33,0x3f743f58bf80bf1c,0xbf62be273f07beb4,0xbf59bf703f803f22,0x3f553cb3be8f3f20,0x3f313f7dbf7ebf29,0xbf463df53c33bf56,0xbefbbf803f7c3f2f
.quad 0x3f35be853e853f77,0x3e853f77bf77bf35,0xbf223ec9bf02bf80,0xbc33bf643f723f3b,0x3f0ebf053f393f6f,0xbe733f48bf6abf40,0xbef13f22bf62bf46,0x3ef1bf223f623f46
.quad 0x3ec4bf3d3f7a3f0a,0xbf2d3eecbf58bf4b,0xbe953f53bf80be7e,0x3f56be8a3f4d3f50,0x3e48bf663f72bd86,0xbf723d86bf40bf55,0xbdc93f73bf533ebf,0x3f7f3e113f333f59
.quad 0x3f7c3f25bf7cbf5e,0x3f25a554bf5ebeaf,0xbf7cbf1a3f803f3b,0xbf5cbe953f703ee7,0x3f7b3f0ebf7bbf0e,0x3f7b3f0ebf7bbf0e,0xbf7bbf023f6e3eb4,0xbf7dbf463f803f27
.quad 0x3f7a3eecbf58be06,0x3f633f6dbf7ebf3d,0xbf79bed33f3bbdc9,0xbf2fbf7f3f753f50,0x3f793ebabf173ea5,0x3ece3f7bbf66bf60,0xbf78be9f3eddbf07,0xbd9cbf623f503f6e
.quad 0x3f773e85be853f35,0xbe853f35bf35bf77,0xbf77be533d9cbf59,0x3f11bef13f153f7d,0x3f763e1c3ddf3f72,0xbf4e3e48bee2bf80,0xbf75bdc9be95bf7f,0x3f753dc93e953f7f
.quad 0x3f743d333eec3f7e,0xbf80bec4be06bf7a,0xbf733c33bf1ebf70,0x3f6e3f22bd063f72,0x3f72bd863f403f55,0xbf40bf553e48bf66,0xbf723df5bf5cbf2f,0x3efb3f75beb43f56
.quad 0x3e323f443e32bf00,0x3f443f80bf00bf71,0xbe3dbf4d3c333f2f,0xbf02bf753eb43f64,0x3e483f55be48bf55,0x3e483f55be48bf55,0xbe53bf5c3ebf3f70,0x3e11bf223d063f42
.quad 0x3e5e3f63bf0abf7e,0xbeec3ec43e06bf2d,0xbe69bf693f2f3f7f,0x3f3bbdc9be953f15,0x3e733f6fbf4ebf72,0xbf6abe483ee2bef6,0xbe7ebf733f673f59,0x3f7f3ef1bf153ebf
.quad 0x3e853f77bf77bf35,0xbf77bf353f35be85,0xbe8abf7b3f7f3f07,0x3f533f62bf503e11,0x3e8f3f7dbf7ebea5,0xbf17bf7b3f66bcb3,0xbe95bf7f3f753dc9,0x3e953f7fbf75bdc9
.quad 0x3e9a3f80bf633e06,0x3d33bf6d3f7e3e5e,0xbe9fbf803f49beb4,0xbebf3f46bf80beaa,0x3ea53f7fbf293f0e,0x3f29bf0e3f7b3ee2,0xbeaabf7e3f02bf3b,0xbf5f3e95bf70bf0c
.quad 0xbf71bf003f803f44,0xbf003e323f443e32,0x3f7a3f5ebf6dbf71,0x3f7e3f25bf80bf44,0xbf35bf803f353f80,0xbf35bf803f353f80,0x3e5e3f5ebec4bf71,0xbe063f25bd33bf44
.quad 0x3eafbf00248d3f44,0x3f5e3e32bf253e32,0xbf4b248d3ec4bf00,0xbf6dbf5e3f7e3f00,0x3f7f3f00bf353e32,0x3e853f71bf52bf71,0xbf63bf5e3f6d3e32,0x3f1cbeaf3e5e3f71
.quad 0x3f003f80bf80bf00,0xbf80bf003f00bf00,0x3d33bf5e3f6d3f44,0x3f1c3f7cbf74be32,0xbf133f00bf35bf71,0x3e85bf443f683f44,0x3f6da5543ec43f80,0xbf6d248dbec4bf80
.quad 0xbf7cbf00a554bf71,0x3f5e3f44beaf3f44,0x3f3d3f5ebec43f44,0xbe06bf7c3f63be32,0xbe85bf803f35bf00,0xbf353f00bf77bf00,0xbe9a3f5ebf6d3e32,0x3f7e3eaf3f0a3f71
.quad 0xbeafbf5e80003f25,0xbf5ebf7c3f253f7c,0xbe5e3f003ec4beaf,0x3e063f443d33bf25,0x3f35a50dbf358000,0x3f35a50dbf358000,0xbf7abf003f6d3eaf,0xbf7ebf443f803f25
.quad 0x3f713f5ebf80bf25,0x3f003f7cbf44bf7c,0xbf1cbf803f6d3f5e,0x3ec4bf003e063f5e,0x3db23f5ebf35bf7c,0xbf77beaf3f13beaf,0x3eecbf003ec43f7c,0x3f4b3f71bf7abeaf
.quad 0xbf5e8000a50dbf5e,0xa50dbf5e3f5e3f5e,0x3f803f00bec43f25,0xbf4b3e32be9abf7c,0xbf52bf5e3f35beaf,0x3f773f25bed83f25,0x3ec43f80bf6d8000,0xbec4bf803f6da50d
.quad 0x3e32bf5e3f803eaf,0xbf003f25bf71bf25,0xbf2d3f00bf6dbf25,0x3f7e3e323eec3f7c,0x3f77a50d3f353f5e,0xbf35bf5e3e85bf5e,0xbf74bf00bec4bf7c,0xbe063f71bf583eaf
.quad 0xbf00bf713e323f44,0xbf71bf713f443f80,0xbe063f133e9abed8,0x3e5e3f52bd33bf35,0x3f35a554bf35248d,0x3f35a554bf35248d,0xbf7ebf133f743ed8,0xbf7abf523f803f35
.quad 0x3f5e3f71bf7cbf44,0x3eaf3f71bf25bf80,0xbec4bf773f4b3f77,0x3f1cbe85be063f35,0xbe853f25bed8bf7c,0xbf7fbf253f52a554,0x3f4bbdb2bd333f52,0x3eec3f7fbf7abf35
.quad 0xbf80bf003f00bf00,0x3f00bf003f003f80,0x3f4b3f68bf583db2,0xbf80bed83e9abf35,0xbe85bf7c3f7f3eaf,0x3f133f7cbf68248d,0xbec43f35bf6dbf35,0x3ec4bf353f6d3f35
.quad 0x3f5ebe323f253f71,0xbf7cbe32beafbf80,0xbf7ebed8be5ebf7f,0x3f2d3f68beec3f35,0x3f353f5ebe853f5e,0x3e85bf5e3f77a554,0xbe06bf7f3f2dbf13,0xbf743db2bf58bf35
.quad 0x3f5e3eafbf7cbf25,0x3eafbeafbf258000,0xbf7ebf523f743f68,0xbf7abf133f803f35,0x3f353f80bf35bf80,0x3f353f80bf35bf80,0xbe06bf523e9a3f68,0x3e5ebf13bd333f35
.quad 0xbf003eaf3e32bf25,0xbf71beaf3f44a50d,0x3f6d3e85bf1c3e85,0x3f4b3f77bf7ebf35,0xbf77bf443f683e32,0x3db2bf443f133f80,0x3f1c3f7fbf80bf13,0xbf63bdb23e5ebf35
.quad 0xa50dbf5e3f5e3f5e,0x3f5e3f5ebf5e8000,0xbf1c3ed8bf0abf7f,0xbd33bf683f743f35,0x3f773e323db23f71,0xbf523e32bed8bf80,0xbf6dbf353ec4bf35,0x3f6d3f35bec43f35
.quad 0x3f003f7cbf443eaf,0xbe32bf7c3f71a50d,0x3e06bf683f7a3db2,0xbf3d3ed8bf63bf35,0xbf353f00bf77bf00,0x3f773f003e853f80,0x3f7e3db23f3d3f52,0xbe9abf7f3f0abf35
.quad 0xbf7cbf253f7c3f5e,0xbf25248d3f5e3eaf,0x3f6b3f72bf56bf7d,0x3f803f46bf79bf5f,0xbf0ebf7b3f0e3f7b,0xbf0ebf7b3f0e3f7b,0x3c333f3fbe3dbf59,0xbeaa3ef13e27bf1e
.quad 0x3f0abe9abe5e3f1c,0x3f743ec4bf4bbd33,0xbf69be693f15be95,0xbf50bf753f7f3f2f,0x3f7d3f31bf5bbd86,0x3cb33f55bf29bf7e,0xbf3fbf773f7d3ed3,0x3f49bdc9bd063f53
.quad 0x3e853f77bf77bf35,0xbf77bf353f35be85,0x3e9fbf333f493f69,0x3ebf3f7fbf80bedd,0xbf483e73bef6bf7f,0x3f05bf0e3f403f6a,0x3f7f3e953dc93f75,0xbf7fbe95bdc9bf75
.quad 0xbf63bf3d3e9abf4b,0x3f2d3f6dbf1c3f0a,0x3efb3f7bbf273f07,0x3e3dbf623f7d3e11,0x3d86bf723f66be48,0xbf663e48bf55bf40,0xbf1a3f27bf80be27,0x3f643f223e693f80
.quad 0xbe32bf44be323f00,0xbf44bf803f003f71,0xbec93eaa3f0cbe27,0xbd5f3f223e69befb,0x3f553e48bf55be48,0x3f553e48bf55be48,0xbf80bf2b3f7c3f07,0xbf72bf623f7d3f49
.quad 0x3f583f74bf7abf4b,0x3e9a3f6dbf1cbf80,0xbed3bf793f503f75,0x3f15be95bdc93f3b,0xbe1c3f39bf05bf7f,0xbf80bf0e3f40bddf,0x3f2bbe8a3e113f69,0x3f1e3f7fbf80bf11
.quad 0xbf77be853e85bf35,0x3e85bf353f353f77,0x3f733f37bf1e3ed3,0xbf6ebdc9bd06bf67,0xbf20bf793f60bd86,0x3f5b3f55bf293ece,0x3dc93f75bf7fbe95,0xbdc9bf753f7f3e95
.quad 0x3eecbf2d3f743f1c,0xbf3d3ec4bf4bbf58,0xbf5f3e53bf42bf59,0x3f7c3ef13e273f7d,0x3f7f3ea53ee23f7b,0xbee2bf7b3f0ebf29,0xbf4dbf42bd5fbf7d,0xbee73f46bf793c33
.quad 0xbeafbf5e248d3f25,0xbf5ebf7c3f253f7c,0xbe9f3ed33ef1be7e,0x3d063f333e11bf11,0x3f553e48bf55be48,0x3f553e48bf55be48,0xbf7fbf3b3f7f3f1a,0xbf69bf6b3f783f56
.quad 0x3f3d3f7ebf6dbf63,0x3e063f58beecbf7a,0xbe27bf623f223f80,0x3f46bd06beb43f07,0xbef63ee2be48bf6a,0xbf72bf4e3f6f3e73,0x3f6b3e27be953f27,0x3e693f72bf64bf5c
.quad 0xbf77bf353f35be85,0x3f35be853e853f77,0x3f1a3f7dbf75be3d,0xbf79bf273f0cbefb,0x3cb3bf663f7b3f17,0x3ea53f7ebf7dbe8f,0xbf223ef1bf46bf62,0x3f22bef13f463f62
.quad 0x3f7a3e063ec43f80,0xbf7ebeecbd33bf74,0xbf67bf2f3dc9bf6b,0x3ed33f7ebf373ee7,0x3ee23f7bbf0e3f29,0x3f0ebf293f7f3ea5,0x3e53bf693f62be8a,0xbf80be7ebf1ebf67
.quad 0x3f713f00bf80bf44,0x3f00be32bf44be32,0xbf73bf693f623f78,0xbf80bf373f7d3f53,0x3f0e3f7bbf0ebf7b,0x3f0e3f7bbf0ebf7b,0x3d9cbf2f3dc93f4d,0x3ed3bec9be7e3f0c
.quad 0xbf2d3e063ec4beec,0xbf7ebf0a3f633e5e,0x3f7d3ef1bf463d06,0x3f223f80bf70bf59,0xbf60bf663f7b3ece,0x3ea5bf173eba3f79,0x3ec93f7dbf75bf42,0xbf79beaa3ee7bf02
.quad 0x3e85bf353f353f77,0x3f353f77bf77be85,0xbf4d3e27be95bf7c,0x3e69bf423f563f5f,0x3f803ee2be483f4e,0xbf72bddfbe1cbf76,0xbf46bf623f22bef1,0x3f463f62bf223ef1
.quad 0x3e5e3f7ebf6d3d33,0x3e06bf633f803e9a,0x3eddbf3b3f7f3ec9,0xbf693df5bf33bf64,0xbf663e48bf55bf40,0x3f553f40bd863f72,0x3f7b3ed33ef13f77,0x3d06bf783f49bedd
.quad 0xbf80bf443f713f71,0xbf44be323f713f00,0x3f553f7dbf39bf80,0x3f793f60bf6abf72,0xbec4bf6d3ec43f6d,0xbec4bf6d3ec43f6d,0xbe483f173cb3bf39,0xbf053e8f3ebabee2
.quad 0x3f35bdb2bed83ed8,0x3f7f3f13bf68be85,0xbf7bbee23f40bd86,0xbf29bf7f3f723f55,0x3f6d3f58bf74be9a,0xbe5e3f2dbeecbf7e,0xbf0ebf803f7e3f20,0x3f6a3e1cbe8f3f29
.quad 0x248d3f5ebf5ebf5e,0xbf5ebf5e3f5ea554,0x3f0ebef63f173f7d,0x3ddf3f6fbf79bf29,0xbf6dbd33be5ebf7a,0x3f3dbe9a3f0a3f7e,0x3f7b3f0ebe483f55,0xbf7bbf0e3e48bf55
.quad 0xbf35bf683f13bf13,0x3ed83f7fbf523e85,0x3e483f7ebf5b3e73,0x3ef6bf313f7d3ee2,0x3ec4bf4b3f7e3e06,0xbf7ebe06bf1cbf6d,0xbf553ebabf76bef6,0x3f313f5bbddf3f72
.quad 0xa50dbf25beaf3eaf,0xbf25bf7c3eaf3f5e,0xbf0e3e1c3f313cb3,0xbe733ef63ecebea5,0x3f6d3ec4bf6dbec4,0x3f6d3ec4bf6dbec4,0xbf7bbf4e3f803f31,0xbf5bbf763f6f3f66
.quad 0x3f353f7fbf68bf68,0x3db23f52bed8bf77,0xbe48bf663f293f7f,0x3f40bd86bea53f0e,0xbec43f0abe9abf74,0xbf7abf3d3f633e06,0x3f55bcb3bddf3f48,0x3ece3f7dbf76bf40
.quad 0xbf80bf003f00bf00,0x3f00bf003f003f80,0x3f553f60bf4e3e1c,0xbf7ebeba3e73bf40,0xbec4bf803f7a3e5e,0x3f2d3f74bf583e06,0xbe483f55bf7bbf0e,0x3e48bf553f7b3f0e
.quad 0x3f35bed83f523f52,0xbf683db2bf13bf77,0xbf7bbddfbf05bf79,0x3f603f39be1c3f66,0x3f6d3f1c3e063f7e,0xbe06bf7e3f4bbec4,0xbf0ebf6f3e8fbf60,0xbf393f05bf7ebea5
.quad 0xbe32bf44be323f00,0xbf44bf803f003f71,0xbef63e733f20bd86,0xbe1c3f0e3ea5bece,0x3f6d3ec4bf6dbec4,0x3f6d3ec4bf6dbec4,0xbf76bf5b3f7e3f40,0xbf4ebf7b3f663f6f
.quad 0x3f133f7fbf52bf77,0xbdb23f35be85bf68,0x3d86bf403ee23f7b,0x3f663e48bf0e3ea5,0xbf2d3e5e3d33bf4b,0xbf58bf6d3f7e3eec,0x3f7d3ecebf053ee2,0xbcb33f55bf40bf76
.quad 0xbf5ebf5e3f5ea554,0x3f5ea554248d3f5e,0x3eba3f7ebf80bee2,0xbf60bf553f40be73,0x3e9abf3d3f633f4b,0x3d333f6dbf7ebf0a,0xbf553e48bf0ebf7b,0x3f55be483f0e3f7b
.quad 0x3f7f3ed83db23f77,0xbf68bf353e85bf52,0xbf39bf603ecebf40,0x3ddf3f7bbf663e1c,0x3e063f7ebf4b3ec4,0x3f4bbec43f6d3f1c,0x3f05bf393f7d3d86,0xbf6fbf0ebea5bf7e
.quad 0x3f7c3f25bf7cbf5e,0x3f25a50dbf5ebeaf,0xbf60bf793f483f7f,0xbf7dbf553f723f6a,0x3ec43f6dbec4bf6d,0x3ec43f6dbec4bf6d,0x3e8fbf05bddf3f29,0x3f17be48bee23eba
.quad 0xbf52bdb23f13be85,0xbf7fbf353f773ed8,0x3f7f3f29bf66be48,0x3ee23f7bbf55bf72,0xbf3dbf7a3f803f1c,0x3f0abec43e063f63,0x3e1c3f6abf5bbf66,0xbf80bf0e3f29be8f
.quad 0x3f00bf003f003f80,0x3f003f80bf80bf00,0xbf6fbddfbcb3bf66,0x3ef6bf0e3f293f79,0x3f743f2dbeec3f1c,0xbf80bec43e06bf58,0xbf0ebf7b3f55be48,0x3f0e3f7bbf553e48
.quad 0xbdb23f68bf7fbe85,0x3ed8bf353f773f13,0x3f31bef63f6a3f29,0xbf7ebe48bee2bf7d,0xbf7ebe06bf1cbf6d,0x3f1c3f6dbec43f4b,0x3f5b3f313e1c3f7f,0x3ebabf553f72bddf
.quad 0xbf7cbf5e3f5e3f7c,0xbf5ebeaf3f7c3f25,0x3f373f80bf15bf7b,0x3f693f73bf53bf7d,0xbe48bf553e483f55,0xbe48bf553e483f55,0xbec93ed33e69bf11,0xbf2f3d9c3f0cbe7e
.quad 0x3f583e06bf1c3e5e,0x3f7e3f3dbf7abeec,0xbf80bf223f623e27,0xbef1bf7d3f593f70,0x3f4e3f72bf7fbf05,0xbee23ef6be73bf6f,0xbeaabf793f703f4d,0x3f7d3ec9bf023ee7
.quad 0xbe853f35bf35bf77,0xbf35bf773f773e85,0x3f42be693eb43f7e,0xbe273f4dbf5fbf56,0xbf7ebea53d86bf60,0x3f66bcb33e8f3f7d,0x3f623f46bef13f22,0xbf62bf463ef1bf22
.quad 0xbeecbf7e3f4bbe9a,0x3e063f7abf74bd33,0xbdf53f69bf79bd9c,0x3f3bbedd3f643f33,0x3f29bf0e3f7b3ee2,0xbf7bbee2bea5bf7f,0xbf783d06bf50bf3f,0x3ed33f7bbedd3f49
.quad 0x3e32bf00bf003e32,0xbf00bf713e323f44,0xbf33bd063f503e53,0xbed33e9f3f11be11,0x3f7b3f0ebf7bbf0e,0x3f7b3f0ebf7bbf0e,0xbf6bbf693f793f53,0xbf3bbf7f3f563f78
.quad 0x3f0a3f7ebf4bbf7a,0xbe063f2dbe5ebf63,0x3d06bf463ef13f7d,0x3f623e27bf073eb4,0xbf173ea5bd86bf5b,0xbf66bf603f793eba,0x3f723e69beb43f1a,0x3e273f6bbf5cbf64
.quad 0xbf77bf353f35be85,0x3f35be853e853f77,0x3f273f79bf70bdf5,0xbf7dbf1a3efbbf0c,0xbddfbf723f7f3ef6,0x3ee23f80bf76be1c,0xbef13f22bf62bf46,0x3ef1bf223f623f46
.quad 0x3f63be063f1c3f74,0xbf7ebe5ebe9abf80,0xbf7ebed3be69bf7f,0x3f2f3f67bee73f37,0x3f403f55be483f66,0x3e48bf663f72bd86,0xbe7ebf803f15bf2b,0xbf693e53bf67bf1e
.quad 0xa554bf25beaf3eaf,0xbf25bf7c3eaf3f5e,0xbf223d5f3f423df5,0xbeaa3ec93efbbe69,0x3f7b3f0ebf7bbf0e,0x3f7b3f0ebf7bbf0e,0xbf62bf723f733f5f,0xbf2bbf803f493f7d
.quad 0x3ec43f74bf2dbf80,0xbe9a3f0abd33bf4b,0x3e95bf153e693f69,0x3f793ed3bf3b3dc9,0xbf55bcb33e8fbf20,0xbf31bf7d3f7e3f29,0x3f7f3f1ebf373e53,0xbe8a3f2bbf11bf80
.quad 0xbf35bf773f773e85,0x3f773e85be853f35,0x3dc93f6ebf78bf2b,0xbf37bf733f673d06,0x3f0ebf053f393f6f,0xbe733f48bf6abf40,0xbf75bdc9be95bf7f,0x3f753dc93e953f7f
.quad 0x3f6d3f2dbe5e3f58,0xbf3dbf633f0abf1c,0xbef1bf7c3f2bbf02,0xbe533f5fbf7dbe27,0xbe483f66bf723d86,0x3f72bd863f403f55,0x3f46bee73f7c3ec9,0xbf42bf4d3c33bf79
.quad 0x3f803f44bf71bf71,0x3f443e32bf71bf00,0xbf46bf803f273f7e,0xbf72bf6b3f5f3f79,0x3e483f55be48bf55,0x3e483f55be48bf55,0x3ef1beaabe9f3efb,0x3f3f3c33bf1e3e27
.quad 0xbf6dbe9a3f3dbd33,0xbf74bf583f803f1c,0x3f753f50bf79bed3,0x3e693f69bf2fbf7f,0xbf0ebf803f763f48,0x3f39be1cbddf3f40,0xbdc93f49bf33bf7b,0xbf77bf3f3f53bd06
.quad 0x3f35be853e853f77,0x3e853f77bf77bf35,0xbf7fbebf3e7ebf3f,0x3f33be9f3edd3f80,0x3f553f5bbf313eba,0xbf79bf203ecebf29,0xbe95bf7f3f753dc9,0x3e953f7fbf75bdc9
.quad 0xbec43f3dbf7abf0a,0x3f2dbeec3f583f4b,0x3f62be3d3f3f3f5c,0xbf7bbefbbe11bf7d,0xbf7bbee2bea5bf7f,0x3ea53f7fbf293f0e,0x3f223f64be3d3f6b,0x3f27bf1a3f803e69
.quad 0x3e323f443e32bf00,0x3f443f80bf00bf71,0x3f633eafbf74bf00,0x3f2da554bf4bbe32,0xbf35bf803f353f80,0xbf35bf803f353f80,0xbeec3eaf3e9abf00,0xbf3d248d3f1cbe32
.quad 0x3f7c3f44bf7cbf00,0x3f253f80bf5ebf71,0xbe06bf5e3f1c3f80,0x3f4ba554bec43f00,0xbf68be323ed8bf00,0xbf13bf803f773f44,0x3f2d3f7cbf80bf00,0xbf58248d3e06bf44
.quad 0x3f00bf003f003f80,0x3f003f80bf80bf00,0xbf7abf253f0abf00,0x3f63a5543e063f71,0x3db23f71bf7fbf00,0xbed8bf803f773e32,0x3f6da5543ec43f80,0xbf6d248dbec4bf80
.quad 0xbf25bf713f25bf00,0x3eaf3f80bf5e3e32,0xbf0a3f25bf7abf00,0x3f74a5543f1c3f71,0x3f773f003e853f80,0xbe85bf803f35bf00,0xbd33bf7c3f3dbf00,0xbf7a248dbf4bbf44
.quad 0xbf7cbf253f7c3f5e,0xbf2580003f5e3eaf,0x3eec3f71be9abf5e,0x3f3d3f80bf1cbf7c,0x3f35a50dbf358000,0x3f35a50dbf358000,0xbf63bf713f743f5e,0xbf2dbf803f4b3f7c
.quad 0xbe323f25be32bf5e,0xbf4480003f00beaf,0x3f7e3f00bf4b8000,0x3f1c3f80bf6dbf5e,0xbed8bf7c3f683f5e,0x3f52a50dbe853f25,0xbf3d3e32bd33bf5e,0xbf0abf803f7e3f25
.quad 0x3f5e3f5ebf5e8000,0xbf5e8000a50dbf5e,0x3e5ebf443f583f5e,0x3eec3f80bf7ebeaf,0xbf7fbeaf3db2bf5e,0x3f68a50d3e853f7c,0x3ec43f80bf6d8000,0xbec4bf803f6da50d
.quad 0x3f44beaf3f443f5e,0xbf718000bf00bf7c,0xbf58bf443e5ebf5e,0x3e9a3f80bf4b3eaf,0xbe853f5ebf778000,0x3f77a50d3f353f5e,0x3f803e323f2d3f5e,0xbe5ebf803f1cbf25
.quad 0xbf71bf003f803f44,0xbf003e323f443e32,0x3f0a3f77bec4bf68,0x3f4b3f7fbf2dbf7f,0x3f35a554bf35248d,0x3f35a554bf35248d,0xbf58bf773f6d3f68,0xbf1cbf7f3f3d3f7f
.quad 0xbeaf3f00a554bf44,0xbf5ebe323f25be32,0x3f7e3f35bf6dbe85,0x3ec43f77bf4bbf77,0xbdb2bf5e3f353f7c,0x3f773eafbf133eaf,0xbf74be853ec4bf13,0xbe06bf683f583f68
.quad 0x3f003f80bf80bf00,0xbf80bf003f00bf00,0x3f3dbe853ec43f7f,0xbe063f52bf63bf52,0xbf52bf5e3f35beaf,0x3f773f25bed83f25,0xbec43f35bf6dbf35,0x3ec4bf353f6d3f35
.quad 0x3f7c3f00248d3f71,0xbf5ebf443eafbf44,0xbd33bf773f6dbdb2,0xbf1c3f13bf74bf13,0xbf77248dbf35bf5e,0x3f353f5ebe853f5e,0x3eec3f77bec43f52,0x3f4bbed83f7a3ed8
.quad 0xbeafbf5e80003f25,0xbf5ebf7c3f253f7c,0xbf58be853f6d3ed8,0xbf1c3db23f3d3db2,0x3f353f80bf35bf80,0x3f353f80bf35bf80,0x3f0abe85bec43ed8,0x3f4b3db2bf2d3db2
.quad 0xbf71bf5e3f803f25,0xbf00bf7c3f443f7c,0xbe063f35bec4bf77,0xbf6dbe853f1cbe85,0x3f7f3f00bf353e32,0x3e853f71bf52bf71,0xbe9abf773f6d3f52,0x3f7e3ed8bf0a3ed8
.quad 0xbf5e8000a50dbf5e,0xa50dbf5e3f5e3f5e,0x3f2d3f77bf6dbdb2,0xbf7ebf133eecbf13,0x3f13bf003f353f71,0xbe853f44bf68bf44,0xbf6dbf353ec4bf35,0x3f6d3f35bec43f35
.quad 0xbe323f5ebf80beaf,0x3f00bf253f713f25,0x3f803e853ec43f7f,0xbf4bbf523e9abf52,0xbe85bf803f35bf00,0xbf353f00bf77bf00,0xbf633e85bf6dbf13,0x3f1c3f68be5e3f68
.quad 0x248d3f253eafbeaf,0x3f253f7cbeafbf5e,0x3f753f02bf7ebf27,0x3f4d3e3dbf64beb4,0xbf0ebf7b3f0e3f7b,0xbf0ebf7b3f0e3f7b,0xbf223e113efbbe9f,0xbf5cbe533f423d06
.quad 0x3f6d3f63bf80bf2d,0x3eec3f7abf3dbf7e,0x3dc9bf3b3ed33f79,0x3f693e69bf153e95,0xbf7bbece3f20be8f,0xbebabf793f603f66,0x3ef13f7fbf7bbf33,0xbf73be7e3ebfbf15
.quad 0x3f35be853e853f77,0x3e853f77bf77bf35,0xbf62bf533f3fbe7e,0x3f7b3e8abe113f50,0xbe483f4ebf6fbf39,0xbe1cbf763f803ee2,0x3f7f3e953dc93f75,0xbf7fbe95bdc9bf75
.quad 0xbec4bf803f58be5e,0x3d333f74bf7abe06,0xbf463ebfbf5cbf3f,0x3f803e9f3eaa3f80,0x3f553f40bd863f72,0x3d86bf723f66be48,0x3e95bf5f3f6bbe3d,0xbf7ebeaabf0cbf70
.quad 0xbf80bf443f713f71,0xbf44be323f713f00,0x3e953f5cbdf5bf42,0x3f1a3f7cbee7bf70,0x3f553e48bf55be48,0x3f553e48bf55be48,0xbf46bf7d3f5f3f73,0xbf02bf7b3f273f80
.quad 0xbec43eec3d33bf3d,0xbf63be5e3f2dbe06,0x3f7f3f2fbf69be69,0x3ed33f79bf50bf75,0xbe48bf6a3f483f76,0x3f6f3e73bef63ee2,0xbf62bd9c3e53bf37,0xbe9fbf783f6e3f50
.quad 0x3f353f77bf77be85,0xbf77be853e85bf35,0x3ef1bf113f2b3f78,0x3e533f77bf7dbf15,0xbf7bbf173ebabf31,0x3f7d3e8fbcb33f66,0x3dc93f75bf7fbe95,0xbdc9bf753f7f3e95
.quad 0x3f6dbd333f0a3f7a,0xbf80be9abe5ebf7e,0xbf22bf6e3f02bf2b,0xbc333f73bf723d06,0xbf0e3f29bf7fbea5,0x3f7f3ea53ee23f7b,0x3f753efb3ec93f7c,0x3df5bf723f56beb4
.quad 0xbf7cbf253f7c3f5e,0xbf25248d3f5e3eaf,0x3ebf3f67be53bf50,0x3f2b3f7fbf07bf77,0x3f553e48bf55be48,0x3f553e48bf55be48,0xbf37bf803f533f79,0xbeddbf753f153f7e
.quad 0xbf0a3e9a3e5ebf1c,0xbf74bec43f4b3d33,0x3f703f59bf7dbef1,0x3e273f62bf22bf80,0x3e1cbf393f053f7f,0x3f803f0ebf403ddf,0xbf80befb3f1abeb4,0x3df5bf463f2f3f7c
.quad 0x3e853f77bf77bf35,0xbf77bf353f35be85,0x3f643c333df53f70,0xbec93f22bf3bbf72,0xbf20bf793f60bd86,0x3f5b3f55bf293ece,0xbf223ef1bf46bf62,0x3f22bef13f463f62
.quad 0x3f633f3dbe9a3f4b,0xbf2dbf6d3f1cbf0a,0x3e8abf563f7f3e69,0xbf533e95bf50bf4d,0xbf7fbea5bee2bf7b,0x3ee23f7bbf0e3f29,0x3e113f7fbf2b3f15,0x3f73bdc93f593f33
.quad 0xbe32bf44be323f00,0xbf44bf803f003f71,0xbf6ebedd3f7b3f15,0xbf3fbdc93f593e8a,0x3f0e3f7bbf0ebf7b,0x3f0e3f7bbf0ebf7b,0x3f33bd5fbf113e69,0x3f673e95bf50bdf5
.quad 0xbf58bf743f7a3f4b,0xbe9abf6d3f1c3f80,0xbeb43f07be27bf62,0xbf7dbef13f46bd06,0x3f7d3f31bf5bbd86,0x3cb33f55bf29bf7e,0xbd5fbf5f3f4d3f70,0x3f7e3f22bf3b3e3d
.quad 0xbf77be853e85bf35,0x3e85bf353f353f77,0x3ee73f80bf7ebeb4,0xbf6bbf463f2fbeaa,0x3f48be733ef63f7f,0xbf053f0ebf40bf6a,0xbf46bf623f22bef1,0x3f463f62bf223ef1
.quad 0xbeec3f2dbf74bf1c,0x3f3dbec43f4b3f58,0x3f773f0c3d9c3f79,0xbf11bf753f15bf1a,0x3d86bf723f66be48,0xbf663e48bf55bf40,0xbf7dbd9cbf3fbf50,0x3e9f3f7fbf073f37
.quad 0xbe323f003f00be32,0x3f003f71be32bf44,0x3f7e3f29bf7fbf48,0x3f663ebabf76bf05,0xbec4bf6d3ec43f6d,0xbec4bf6d3ec43f6d,0xbf48bd863f29bddf,0xbf72bece3f603e73
.quad 0x3f523f77bf77bf52,0x3e853f68bf13bf7f,0x3ea5bf0e3e483f66,0x3f7b3ee2bf403d86,0xbf80bf1c3f4bbd33,0xbe06bf633f3d3f7a,0x3e733f72bf66bf5b,0xbf7fbef63f17beba
.quad 0x3f5ea554248d3f5e,0x248d3f5ebf5ebf5e,0xbf39bf723f663cb3,0x3f7f3f05bece3f20,0xbeec3f1cbf4bbf63,0x3e06bf583f743f2d,0x3f7b3f0ebe483f55,0xbf7bbf0e3e48bf55
.quad 0xbdb2bf773f773db2,0xbe853f52bf7fbed8,0xbf6f3d86bf29bf6a,0x3f723f173cb33f76,0x3f1c3f6dbec43f4b,0x3ec4bf4b3f7e3e06,0x3f17bf293f7f3e1c,0xbf66bf20be73bf80
.quad 0xbf7cbf5e3f5e3f7c,0xbf5ebeaf3f7c3f25,0x3ddf3f403d86bf20,0x3ee23f6fbe8fbf5b,0x3f6d3ec4bf6dbec4,0x3f6d3ec4bf6dbec4,0xbf20bf7f3f403f7e,0xbea5bf6a3ef63f79
.quad 0xbf133e853e85bf13,0xbf77bed83f523db2,0x3f723f55bf7bbee2,0x3e483f66bf29bf7f,0x3d33bf4b3f1c3f80,0x3f7e3eecbf2d3e5e,0xbf79bea53ee2bf05,0xbd86bf603f4e3f6f
.quad 0x3f003f80bf80bf00,0xbf80bf003f00bf00,0x3f31bea53ee23f80,0xbd863f5bbf6abf48,0xbf63bf4b3f1cbeec,0x3f7e3f0abe9a3f3d,0xbe483f55bf7bbf0e,0x3e48bf553f7b3f0e
.quad 0x3f7f3e853e853f7f,0xbf77bf133db2bf68,0xbebabf7f3f40bece,0xbea53f4ebf80be8f,0xbf4b3ec4bf6dbf1c,0x3f6d3f1c3e063f7e,0x3f4e3f403d863f7d,0x3ee2bf483f79bcb3
.quad 0xbf80bf443f713f71,0xbf44be323f713f00,0x3e483f4ebcb3bf31,0x3f053f76bebabf66,0x3f6d3ec4bf6dbec4,0x3f6d3ec4bf6dbec4,0xbf0ebf7d3f313f80,0xbe73bf603ece3f72
.quad 0xbf353db23ed8bed8,0xbf7fbf133f683e85,0x3f553f72bf7fbf29,0xbd863f40bee2bf7b,0x3ec4bf0a3e9a3f74,0x3f7a3f3dbf63be06,0xbf7bbf313f48bddf,0x3ebabf173ef63f7f
.quad 0x248d3f5ebf5ebf5e,0xbf5ebf5e3f5ea554,0x3f7b3e8fbe1c3f4e,0xbf203ecebf05bf7f,0xbec4bf803f7a3e5e,0x3f2d3f74bf583e06,0xbf553e48bf0ebf7b,0x3f55be483f0e3f7b
.quad 0x3f353f68bf133f13,0xbed8bf7f3f52be85,0x3f0ebf203f793f05,0xbf76bcb3bf17bf72,0xbf6dbf1cbe06bf7e,0x3e063f7ebf4b3ec4,0xbe483f6abf603e8f,0x3f803e733f203f66
.quad 0xa50dbf25beaf3eaf,0xbf25bf7c3eaf3f5e,0xbf7bbf173f803f39,0xbf5bbe8f3f6f3ee2,0x3ec43f6dbec4bf6d,0x3ec43f6dbec4bf6d,0x3f553e1cbf393cb3,0x3f793ef6bf6abea5
.quad 0xbf35bf7f3f683f68,0xbdb2bf523ed83f77,0xbf0e3ea53d86bf40,0xbf7fbf293f663e48,0x3f6d3f58bf74be9a,0xbe5e3f2dbeecbf7e,0x3e48bf393f203f7e,0x3f6f3f4ebf60bd86
.quad 0xbf80bf003f00bf00,0x3f00bf003f003f80,0x3e483f76bf7dbf17,0xbf48bf6a3f5bbd86,0x3f6d3d333e5e3f7a,0xbf3d3e9abf0abf7e,0xbf0ebf7b3f55be48,0x3f0e3f7bbf553e48
.quad 0xbf353ed8bf52bf52,0x3f68bdb23f133f77,0x3f553f48be733f5b,0xbe8fbf803f4ebea5,0x3ec4bf4b3f7e3e06,0xbf7ebe06bf1cbf6d,0xbf7bbecebef6bf76,0xbcb33f79bf483ee2
.quad 0xbeaf3eaf3f25a554,0x3eaf3f5ea554bf25,0x3f7f3f49bf78bf62,0x3f773f07bf7fbf2b,0xbe48bf553e483f55,0xbe48bf553e483f55,0xbf64be8a3f4d3dc9,0xbf7ebf153f753edd
.quad 0x3f2d3f80bf63bf6d,0x3d333f4bbec4bf74,0x3f07beb4bd063f46,0x3f803f22bf62be27,0xbf76bf483f6a3e48,0x3ddfbf403f0e3f80,0xbc333f56bf42bf75,0xbf7cbf2f3f46bdf5
.quad 0x3f773e85be853f35,0xbe853f35bf35bf77,0xbf02bf803f7c3e95,0x3f723f3bbf223ec9,0xbf313ebabf17bf7b,0x3ecebf293f553f5b,0x3f623f46bef13f22,0xbf62bf463ef1bf22
.quad 0x3e5ebf583f803ec4,0xbf0a3f1cbf6dbf2d,0xbf80be7ebec9bf7f,0x3f4d3f50be953f53,0x3ea53f7fbf293f0e,0x3f29bf0e3f7b3ee2,0x3f53bebf3f773ef1,0xbf33bf593dc9bf73
.quad 0xbf71bf713f443f80,0xbf71bf003f803f44,0xbd9c3f1e3e7ebef1,0x3e8a3f59bdc9bf3f,0x3f7b3f0ebf7bbf0e,0x3f7b3f0ebf7bbf0e,0xbee7bf773f1a3f7f,0xbdf5bf503e953f67
.quad 0xbf3d3d333eecbec4,0xbf80bf1c3f6d3e9a,0x3f593f70bf80bf22,0xbd063f46bef1bf7d,0x3e8fbf203ece3f7b,0x3f7e3f29bf55bcb3,0xbf80bf0c3f27be95,0x3e3dbf3b3f223f7e
.quad 0x3e853f77bf77bf35,0xbf77bf353f35be85,0x3f5cbd5f3e3d3f75,0xbeaa3f2fbf46bf6b,0xbf39bf6f3f4ebe48,0x3f6a3f40bf0e3f05,0xbef13f22bf62bf46,0x3ef1bf223f623f46
.quad 0x3f7a3f0abd333f6d,0xbf58bf4b3ec4bf3d,0xbd5fbf783f6bbdc9,0xbf1a3f15bf75bf11,0xbf723d86bf40bf55,0x3f403f55be483f66,0x3f113f6ebe8a3f62,0x3f37bf073f7f3e9f
.quad 0xbf7cbf5e3f5e3f7c,0xbf5ebeaf3f7c3f25,0x3c333f2f3e27bf0c,0x3eb43f64be3dbf4d,0x3f7b3f0ebf7bbf0e,0x3f7b3f0ebf7bbf0e,0xbebfbf703f073f7c,0xbd06bf423e533f5c
.quad 0xbf58be063f1cbe5e,0xbf7ebf3d3f7a3eec,0x3f2f3f7fbf75bf50,0xbe953f15be69bf69,0x3f17bea53d863f5b,0x3f663f60bf79beba,0xbf67bf593f693e11,0x3f15bebf3e7e3f73
.quad 0xbe853f35bf35bf77,0xbf35bf773f773e85,0x3f7f3f07bed33f1e,0xbf503e11be8abf7b,0xbddfbf723f7f3ef6,0x3ee23f80bf76be1c,0xbf75bdc9be95bf7f,0x3f753dc93e953f7f
.quad 0x3eec3f7ebf4b3e9a,0xbe06bf7a3f743d33,0x3f49beb43f593f42,0xbf80beaabe9fbf80,0xbf40bf553e48bf66,0xbe483f66bf723d86,0xbf023f3bbf7dbd5f,0x3f703f0c3eaa3f7e
.quad 0x3e32bf00bf003e32,0xbf00bf713e323f44,0xbf80bf3b3f7d3f56,0xbf70bee73f7c3f1a,0x3e483f55be48bf55,0x3e483f55be48bf55,0x3f6e3eb4bf59be3d,0x3f803f27bf7bbf02
.quad 0xbf0abf7e3f4b3f7a,0x3e06bf2d3e5e3f63,0xbf3b3dc93e95bf15,0xbf75bf503f793ed3,0x3f4e3f72bf7fbf05,0xbee23ef6be73bf6f,0x3eddbf073ed33f7d,0x3f503f6ebf78be9f
.quad 0xbf77bf353f35be85,0x3f35be853e853f77,0xbd9c3f59bf69bf49,0xbf15bf7d3f773e53,0x3f7e3ea5bd863f60,0xbf663cb3be8fbf7d,0xbe95bf7f3f753dc9,0x3e953f7fbf75bdc9
.quad 0xbf633e06bf1cbf74,0x3f7e3e5e3e9a3f80,0x3f1e3f70bf073f27,0x3d06bf723f73bc33,0x3f29bf0e3f7b3ee2,0xbf7bbee2bea5bf7f,0xbf5cbf2fbe27bf80,0xbeb43f56bf723df5
.quad 0x3f803f44bf71bf71,0x3f443e32bf71bf00,0x3ec4beafbf0a3e32,0x3d33bf25be5e3f00,0xbf35bf803f353f80,0xbf35bf803f353f80,0xbf6dbeaf3f583e32,0xbf80bf253f7a3f00
.quad 0x248d3f44beafbf71,0xbf253e323eafbf00,0x3f6d3f5ebf7ebf00,0x3e063f5ebf1cbf80,0x3f35be32bdb23f44,0x3f523f71bf7fbf00,0xbec4bf7c3f743f44,0x3f7a3eafbeec3f00
.quad 0xbf80bf003f00bf00,0x3f00bf003f003f80,0xbec43f25bf3dbf71,0xbe9abf7c3f803f00,0x3f353f71bf523e32,0xbf68bf443f13bf00,0x3f6da5543ec43f80,0xbf6d248dbec4bf80
.quad 0xa554bf713f7c3e32,0xbeaf3f44bf7cbf00,0xbf6dbf253d33bf71,0x3eec3f7cbf2d3f00,0xbf353f00bf77bf00,0x3f773f003e853f80,0x3ec43f7cbeec3f44,0x3f58beaf3f743f00
.quad 0x80003f253eafbeaf,0x3f253f7cbeafbf5e,0x3f6d3f71bf58bf7c,0x3f803f44bf7abf5e,0x3f35a50dbf358000,0x3f35a50dbf358000,0xbec4bf713f0a3f7c,0xbd33bf443e5e3f5e
.quad 0xbf80bf253f713eaf,0xbf44bf7c3f713f5e,0xbec43f00be06bf5e,0xbf7ebf003f4ba50d,0x3f353f7cbf7fbf25,0xbf133eafbdb2bf5e,0x3f6d3e32be9a3f25,0x3e5e3f71bf63bf5e
.quad 0xa50dbf5e3f5e3f5e,0x3f5e3f5ebf5e8000,0xbf6dbf443f2dbeaf,0x3f743e32bd333f5e,0xbf353eafbf13bf7c,0x3ed8bf253f523f5e,0x3ec43f80bf6d8000,0xbec4bf803f6da50d
.quad 0x3f803eaf3e323f7c,0xbf71bf253e32bf5e,0x3ec4bf443f803eaf,0xbf633e32bf3dbf5e,0xbf35bf5e3e85bf5e,0xbe853f5ebf778000,0xbf6d3e32bf63bf25,0x3f0a3f71be9a3f5e
.quad 0x3e323f443e32bf00,0x3f443f80bf00bf71,0x3f743f68bf63bf77,0x3f803f35bf7ebf52,0x3f35a554bf35248d,0x3f35a554bf35248d,0xbe9abf683eec3f77,0x3d33bf353e063f52
.quad 0xbf7cbf443f7c3f00,0xbf25bf803f5e3f71,0xbf1c3e853e06bf35,0xbf7ebf353f6d3e85,0x3ed83f7cbf68bf5e,0xbf52248d3e85bf25,0x3f803f13bf2d3e85,0xbe5e3f35bf1cbf7f
.quad 0x3f00bf003f003f80,0x3f003f80bf80bf00,0xbf0abf7f3f7a3e85,0x3f743f35bf1c3ed8,0xbf7fbeaf3db2bf5e,0x3f68a5543e853f7c,0xbec43f35bf6dbf35,0x3ec4bf353f6d3f35
.quad 0x3f253f71bf253f00,0xbeafbf803f5ebe32,0x3f7a3db23f0a3f77,0xbf63bf353e06bf68,0x3e85bf5e3f77a554,0xbf77248dbf35bf5e,0xbf3dbf523d33bf77,0xbf0a3f35bf7ebdb2
.quad 0xbf7cbf253f7c3f5e,0xbf2580003f5e3eaf,0xbe9a3ed83eecbe85,0x3d333f353e06bf13,0x3f353f80bf35bf80,0x3f353f80bf35bf80,0x3f743ed8bf63be85,0x3f803f35bf7ebf13
.quad 0x3e32bf253e323f5e,0x3f44a50dbf003eaf,0xbf4bbf773f7e3f35,0x3e06bf353ec43f77,0xbf68be323ed8bf00,0xbf13bf803f773f44,0xbd333f52bf3dbf77,0xbf7abf353f4bbdb2
.quad 0x3f5e3f5ebf5e8000,0xbf5e8000a50dbf5e,0x3f58bdb23e5e3f77,0xbe9a3f35bf4bbf68,0xbdb2bf713f7f3f00,0x3ed83f80bf77be32,0xbf6dbf353ec4bf35,0x3f6d3f35bec43f35
.quad 0xbf443eafbf44bf5e,0x3f71a50d3f003f7c,0x3e5e3f7fbf583e85,0x3eecbf353f7e3ed8,0x3f773f003e853f80,0xbe85bf803f35bf00,0x3f2dbf133f803e85,0xbf58bf35be06bf7f
.quad 0x3f7c3f5ebf5ebf7c,0x3f5e3eafbf7cbf25,0x3f0cbe27bf2fbc33,0x3e69befbbec93eaa,0xbf0ebf7b3f0e3f7b,0xbf0ebf7b3f0e3f7b,0xbf7cbf073f703ebf,0xbf7dbf493f803f2b
.quad 0xbe5e3f1cbe06bf58,0xbf4bbd333f0abe9a,0x3f503f75bf7fbf2f,0xbdc93f3bbed3bf79,0x3f5b3d86bea53f17,0x3f293f7ebf7dbf31,0xbe11bf693f593f67,0x3f803f11bf2b3e8a
.quad 0xbf77bf353f35be85,0x3f35be853e853f77,0xbf1e3ed3bf07bf7f,0xbd06bf673f733f37,0x3ef63f7fbf72bddf,0xbf40bf6a3f48be73,0x3f7f3e953dc93f75,0xbf7fbe95bdc9bf75
.quad 0x3e9abf4b3f7e3eec,0xbf1c3f0abf63bf3d,0xbf42bf593eb4bf49,0x3e273f7dbf5f3e53,0xbf663e48bf55bf40,0x3f553f40bd863f72,0x3d5f3f7dbf3b3f02,0x3f79bc333f4d3f42
.quad 0xbe323f003f00be32,0x3f003f71be32bf44,0x3f563f7dbf3bbf80,0x3f793f5fbf6bbf72,0x3f553e48bf55be48,0x3f553e48bf55be48,0xbe3dbf593eb43f6e,0x3e27bf1e3c333f3f
.quad 0xbf7abf4b3f7e3f0a,0xbf1cbf803f583f74,0xbf153e953dc9bf3b,0xbf7fbf2f3f693e69,0x3f053f7fbf72bf4e,0xbf403ddf3e1cbf39,0x3f7d3ed3bf073edd,0xbd063f53bf3fbf77
.quad 0x3e85bf353f353f77,0x3f353f77bf77be85,0xbf49bf693f59bd9c,0x3f803eddbe9f3f33,0xbf603d86bea5bf7e,0x3f29bece3f203f79,0x3dc93f75bf7fbe95,0xbdc9bf753f7f3e95
.quad 0x3f743f1cbe063f63,0xbf4bbf583eecbf2d,0x3f27bf073f703f1e,0xbf7dbe11befbbf7b,0xbee2bf7b3f0ebf29,0xbf0e3f29bf7fbea5,0xbf80be27bf2fbf5c,0x3e693f80bf1a3f27
.quad 0x248d3f253eafbeaf,0x3f253f7cbeafbf5e,0x3f623f78bf49bf7f,0x3f7d3f53bf73bf69,0x3f553e48bf55be48,0x3f553e48bf55be48,0xbdc9bf4d3e8a3f64,0x3e7ebf0cbd9c3f2f
.quad 0xbf6dbf633f803f2d,0xbeecbf7a3f3d3f7e,0xbf463d063eb4bf07,0xbf70bf593f7d3ef1,0x3e483f6abf48bf76,0xbf6fbe733ef6bee2,0x3f753f42bf563c33,0xbee73f02bec9bf7d
.quad 0x3f35be853e853f77,0x3e853f77bf77bf35,0xbe95bf7c3f803f02,0x3f563f5fbf4d3e27,0xbf7bbf173ebabf31,0x3f7d3e8fbcb33f66,0xbf223ef1bf46bf62,0x3f22bef13f463f62
.quad 0x3ec43f80bf583e5e,0xbd33bf743f7a3e06,0x3f7f3ec93e7e3f80,0xbf33bf643eddbf3b,0x3f0ebf293f7f3ea5,0xbf7fbea5bee2bf7b,0xbef1bf773ebfbf53,0xbf493eddbf7bbed3
.quad 0xbf80bf443f713f71,0xbf44be323f713f00,0xbef13e7e3f1ebd9c,0xbe113f113e9fbed3,0x3f0e3f7bbf0ebf7b,0x3f0e3f7bbf0ebf7b,0x3f7f3f1abf77bee7,0x3f783f56bf7fbf3b
.quad 0x3ec4beecbd333f3d,0x3f633e5ebf2d3e06,0xbf22bf803f703f59,0x3eb4bf073e273f62,0xbf7bbece3f20be8f,0xbebabf793f603f66,0xbe953f27bf0cbf80,0xbf64bf5c3f6b3e27
.quad 0x3f353f77bf77be85,0xbf77be853e85bf35,0x3f753e3dbd5f3f5c,0xbf0c3efbbf1abf7d,0x3e48bf4e3f6f3f39,0x3e1c3f76bf80bee2,0xbf46bf623f22bef1,0x3f463f62bf223ef1
.quad 0xbf6d3d33bf0abf7a,0x3f803e9a3e5e3f7e,0xbdc93f6bbf78bd5f,0x3f37bee73f673f2f,0x3f553f40bd863f72,0x3d86bf723f66be48,0x3f62be8a3f6e3f11,0xbf1ebf673e53bf69
.quad 0x3f713f71bf44bf80,0x3f713f00bf80bf44,0x3f313cb3bf4ebe48,0x3ecebea5bf0e3e1c,0xbec4bf6d3ec43f6d,0xbec4bf6d3ec43f6d,0xbf80bf313f7d3f0e,0xbf6fbf663f7b3f4e
.quad 0xbed83ed83db2bf35,0xbf68be853f35bdb2,0x3f293f7fbf72bf55,0xbea53f0ebe48bf66,0x3f743e9abf0a3ec4,0x3eec3f7ebf6dbf58,0x3ddfbf483f313f7b,0x3f763f40bf553cb3
.quad 0xbf5ebf5e3f5ea554,0x3f5ea554248d3f5e,0xbf4e3e1cbe8fbf7b,0x3e73bf403f553f60,0x3e5e3f7abf80bec4,0xbf0abf7e3f6d3d33,0x3f7b3f0ebe483f55,0xbf7bbf0e3e48bf55
.quad 0x3f13bf133f683f35,0xbf523e85bf35bf68,0xbf05bf793f20bf0e,0xbe1c3f66bf7bbddf,0xbf7ebe06bf1cbf6d,0x3f1c3f6dbec43f4b,0xbe8f3f60bf6a3e48,0x3f7e3ea53f0e3f6f
.quad 0xbeaf3eaf3f25a50d,0x3eaf3f5ea50dbf25,0x3f393f80bf17bf7b,0x3f6a3f72bf55bf7d,0x3f6d3ec4bf6dbec4,0x3f6d3ec4bf6dbec4,0x3cb3bf393e1c3f55,0x3ebabee2be483f17
.quad 0xbf68bf683f7f3f35,0xbed8bf773f353f7f,0xbf403d863ea5bf0e,0xbf72bf553f7b3ee2,0x3e9a3f74bf58bf6d,0xbf63be063ec4bf0a,0x3f7e3f20bf393e48,0xbe8f3f29bf0ebf80
.quad 0x3f00bf003f003f80,0x3f003f80bf80bf00,0xbf17bf7d3f763e48,0x3f793f29bf0e3ef6,0xbf7abe5ebd33bf6d,0x3f58be063ec43f80,0xbe483f55bf7bbf0e,0x3e48bf553f7b3f0e
.quad 0x3f523f52bed83f35,0xbf13bf773f35bed8,0x3f5bbe733f483f55,0xbf7dbee2be48bf7e,0xbe06bf7e3f4bbec4,0xbf4b3ec4bf6dbf1c,0xbf76bef6becebf7b,0xbddf3f72bf553eba
.quad 0xbe323f003f00be32,0x3f003f71be32bf44,0x3f483f7fbf29bf7e,0x3f723f6abf60bf79,0x3f6d3ec4bf6dbec4,0x3f6d3ec4bf6dbec4,0x3ddfbf293d863f48,0x3ee2bebabe8f3f05
.quad 0xbf52bf773f773f52,0xbe85bf683f133f7f,0xbf66be483f0ebea5,0xbf55bf723f7f3f29,0xbd333f4bbf1cbf80,0xbf7ebeec3f2dbe5e,0x3f5b3f66bf72be73,0xbf293e8fbe1cbf6a
.quad 0x3f5ea554248d3f5e,0x248d3f5ebf5ebf5e,0xbcb3bf663f723f39,0x3f293f79bf6fbddf,0xbf63bf4b3f1cbeec,0x3f7e3f0abe9a3f3d,0xbf553e48bf0ebf7b,0x3f55be483f0e3f7b
.quad 0x3db23f77bf77bdb2,0x3e85bf523f7f3ed8,0x3f6a3f29bd863f6f,0xbee2bf7d3f31bef6,0x3f4bbec43f6d3f1c,0xbf6dbf1cbe06bf7e,0xbe1cbf7f3f29bf17,0xbf723ddfbf5bbf31
.quad 0xbf7cbf5e3f5e3f7c,0xbf5ebeaf3f7c3f25,0xbf203d863f403ddf,0xbea53ece3ef6be73,0x3ec43f6dbec4bf6d,0x3ec43f6dbec4bf6d,0x3f7e3f40bf7fbf20,0x3f663f6fbf76bf5b
.quad 0x3f13be85be853f13,0x3f773ed8bf52bdb2,0xbee2bf7b3f553f72,0x3f0ebea5bd863f40,0xbf80bf1c3f4bbd33,0xbe06bf633f3d3f7a,0xbf053ee2bea5bf79,0xbf40bf763f7d3ece
.quad 0x3f003f80bf80bf00,0xbf80bf003f00bf00,0x3f803ee2bea53f31,0xbf403e73bebabf7e,0x3eecbf1c3f4b3f63,0xbe063f58bf74bf2d,0xbf0ebf7b3f55be48,0x3f0e3f7bbf553e48
.quad 0xbf7fbe85be85bf7f,0x3f773f13bdb23f68,0xbece3f40bf7fbeba,0x3f66be1c3f393f60,0x3f1c3f6dbec43f4b,0x3ec4bf4b3f7e3e06,0x3f7d3d863f403f4e,0xbea5bf7e3f05bf39
.quad 0x3f5e3f7cbf25bf7c,0x3f7c3f25bf7cbf5e,0x3f503e53bf67bebf,0x3f11be11bf33bd06,0xbe48bf553e483f55,0xbe48bf553e483f55,0xbf79bf533f803f37,0xbf56bf783f6b3f69
.quad 0xbf1c3e5e3e9abf0a,0xbf7abeec3f583e06,0x3ef13f7dbf59bf70,0xbf073eb43d06bf46,0x3f7f3f05bf393e1c,0x3e733f6fbf4ebf72,0x3eb4bf1a3efb3f80,0x3f5c3f64bf72be69
.quad 0xbf35bf773f773e85,0x3f773e85be853f35,0xbf70bdf5bc33bf64,0x3efbbf0c3f273f79,0xbd863f60bf79bf20,0xbe8fbf7d3f7e3ea5,0x3f623f46bef13f22,0xbf62bf463ef1bf22
.quad 0x3f4bbe9a3f3d3f63,0xbf74bd33beecbf7e,0xbe69bf7f3f56be8a,0xbee73f37bf7ebed3,0xbf7bbee2bea5bf7f,0x3ea53f7fbf293f0e,0xbf153f2bbf7fbe11,0x3f673f1e3e7e3f80
.quad 0xbf003e323f443e32,0x3e323f443e32bf00,0x3f153f7bbeddbf6e,0x3f533f7dbf37bf80,0x3f7b3f0ebf7bbf0e,0x3f7b3f0ebf7bbf0e,0x3e69bf11bd5f3f33,0x3f0cbe7ebec93ed3
.quad 0xbf4bbf7a3f743f58,0xbe5ebf633f0a3f7e,0xbf62be273f07beb4,0xbf59bf703f803f22,0x3d863f5bbf31bf7d,0xbf79beba3f17bea5,0x3f703f4dbf5fbd5f,0xbf023ee7beaabf79
.quad 0x3f35be853e853f77,0x3e853f77bf77bf35,0xbeb4bf7e3f803ee7,0x3f5f3f56bf423e69,0xbf7fbef63e73bf48,0x3f763e1c3ddf3f72,0xbef13f22bf62bf46,0x3ef1bf223f623f46
.quad 0x3f1c3f74bf2d3eec,0xbe9abf803f63be06,0x3f793d9c3f0c3f77,0xbf64bf333df5bf69,0x3e48bf663f72bd86,0xbf723d86bf40bf55,0xbf50bf3fbd9cbf7d,0xbedd3f49bf783d06
.quad 0xbeaf3eaf3f25a554,0x3eaf3f5ea554bf25,0x3f273f7ebf02bf75,0x3f5f3f79bf46bf80,0x3f7b3f0ebf7bbf0e,0x3f7b3f0ebf7bbf0e,0x3e9fbefbbe113f22,0x3f1ebe27bef13eaa
.quad 0xbf2dbf803f633f6d,0xbd33bf4b3ec43f74,0xbf79bed33f3bbdc9,0xbf2fbf7f3f753f50,0xbe8f3f20becebf7b,0xbf7ebf293f553cb3,0x3f333f7bbf7fbef1,0xbf533d063dc9bf49
.quad 0x3f773e85be853f35,0xbe853f35bf35bf77,0x3e7ebf3f3f533f62,0x3edd3f80bf7fbebf,0xbf39bf6f3f4ebe48,0x3f6a3f40bf0e3f05,0xbf75bdc9be95bf7f,0x3f753dc93e953f7f
.quad 0xbe5e3f58bf80bec4,0x3f0abf1c3f6d3f2d,0x3f3f3f5cbebf3f46,0xbe11bf7d3f62be3d,0x3f72bd863f403f55,0xbf40bf553e48bf66,0x3e3dbf6b3f5fbe95,0xbf80be69bf22bf64
.quad 0xbf71bf713f443f80,0xbf71bf003f803f44,0xbf42bdf53f5c3e95,0xbefb3e693f22bd5f,0x3e483f55be48bf55,0x3e483f55be48bf55,0x3f733f5fbf7dbf46,0x3f493f7dbf62bf72
.quad 0x3f3dbd33beec3ec4,0x3f803f1cbf6dbe9a,0xbe69bf693f2f3f7f,0x3f3bbdc9be953f15,0xbf76bf483f6a3e48,0x3ddfbf403f0e3f80,0xbf373e53bd9cbf62,0xbf11bf803f7f3f1e
.quad 0x3e853f77bf77bf35,0xbf77bf353f35be85,0x3f783f2bbf113ef1,0xbf67bd06bdc9bf6e,0x3f31beba3f173f7b,0xbece3f29bf55bf5b,0xbe95bf7f3f753dc9,0x3e953f7fbf75bdc9
.quad 0xbf7abf0a3d33bf6d,0x3f583f4bbec43f3d,0xbf2b3f02bf6ebf22,0x3f7d3e273ef13f7c,0x3ea53f7fbf293f0e,0x3f29bf0e3f7b3ee2,0x3f7c3ec93efb3f75,0x3c33bf793f46bee7
.quad 0x3e32bf00bf003e32,0xbf00bf713e323f44,0xbe9abf5e3e063f44,0xbf1cbf7c3eec3f71,0xbf35bf803f353f80,0xbf35bf803f353f80,0xbf74bf5e3f7e3f44,0xbf4bbf7c3f633f71
.quad 0xbf7cbf003f5e3e32,0xbf5ebf713f7c3f44,0xbf4b248d3ec4bf00,0xbf6dbf5e3f7e3f00,0xbed83f00be85bf71,0xbf77bf443f683e32,0x3d333f5ebf4bbf71,0xbf7ebf253f3dbe32
.quad 0x3f003f80bf80bf00,0xbf80bf003f00bf00,0x3f583f5ebf4b3e32,0xbf7ebeaf3e5ebf44,0x3f7f3f00be853f44,0xbf77be32bdb2bf71,0x3f6da5543ec43f80,0xbf6d248dbec4bf80
.quad 0x3f25bf003f5e3f44,0xbf5e3e32bf25bf71,0x3e5ebf5e3f7e3e32,0xbf4b3eafbf58bf44,0xbe85bf803f35bf00,0xbf353f00bf77bf00,0xbf2dbf5e3e06bf71,0xbf1c3f25bf80be32
.quad 0x3f7c3f5ebf5ebf7c,0x3f5e3eafbf7cbf25,0x3f743f00bf7ebf25,0x3f4b3e32bf63beaf,0x3f35a50dbf358000,0x3f35a50dbf358000,0x3e9abf00be063f25,0x3f1cbe32beec3eaf
.quad 0xbe32bf5e3f003f7c,0x3f00beafbe323f25,0xbf1cbf803f6d3f5e,0x3ec4bf003e063f5e,0xbf68bf5e3f773eaf,0x3e85bf253ed83f7c,0xbf80bf003f1cbeaf,0x3e06bf443f2d3f7c
.quad 0xbf5e8000a50dbf5e,0xa50dbf5e3f5e3f5e,0xbf0a3f00bf1cbf7c,0xbe06bf713f7a3f25,0xbdb23f5ebf77bf25,0xbe85bf7c3f7f3eaf,0x3ec43f80bf6d8000,0xbec4bf803f6da50d
.quad 0x3f443f5ebf003f25,0xbf00bf7c3f44beaf,0x3f7a3f003e063f7c,0xbf1cbf713f0abf25,0x3f77a50d3f353f5e,0xbf35bf5e3e85bf5e,0x3f3dbf003f7e3eaf,0xbf4bbf44bd33bf7c
.quad 0x3f803f44bf71bf71,0x3f443e32bf71bf00,0x3f6d3ed8bf7abf13,0x3f3d3db2bf58be85,0x3f35a554bf35248d,0x3f35a554bf35248d,0x3ec4bed8be5e3f13,0x3f2dbdb2bf0a3e85
.quad 0xa554bf443eaf3f71,0x3f25be32beaf3f00,0xbec4bf773f4b3f77,0x3f1cbe85be063f35,0xbf35bf7c3f7f3f25,0x3f13beaf3db23f5e,0xbf6dbf523f633db2,0x3f0abed83e9a3f77
.quad 0xbf80bf003f00bf00,0x3f00bf003f003f80,0xbf6dbdb2bd33bf68,0x3eecbf133f2d3f77,0xbf353eafbf13bf7c,0x3ed8bf253f523f5e,0xbec43f35bf6dbf35,0x3ec4bf353f6d3f35
.quad 0x248d3f71bf7cbe32,0x3eafbf443f7c3f00,0x3ec43f7fbf3d3ed8,0x3e9abf523f803e85,0x3f353f5ebe853f5e,0x3e85bf5e3f77a554,0x3f6d3f133e9a3f7f,0x3e5ebf683f63be85
.quad 0x80003f253eafbeaf,0x3f253f7cbeafbf5e,0x3ec43f68be5ebf52,0x3f2d3f7fbf0abf77,0x3f353f80bf35bf80,0x3f353f80bf35bf80,0x3f6d3f68bf7abf52,0x3f3d3f7fbf58bf77
.quad 0x3f803f25bf71beaf,0x3f443f7cbf71bf5e,0x3f6d3e85bf1c3e85,0x3f4b3f77bf7ebf35,0x3f35be32bdb23f44,0x3f523f71bf7fbf00,0x3ec4bf133eec3f7f,0x3f583f68bf74be85
.quad 0xa50dbf5e3f5e3f5e,0x3f5e3f5ebf5e8000,0xbec4bf7f3f803ed8,0x3f633f52bf3d3e85,0xbf35bf713f52be32,0x3f683f44bf133f00,0xbf6dbf353ec4bf35,0x3f6d3f35bec43f35
.quad 0xbf80beafbe32bf7c,0x3f713f25be323f5e,0xbf6d3db2bf2dbf68,0x3f743f133d333f77,0xbf353f00bf77bf00,0x3f773f003e853f80,0xbec43f52bf743db2,0x3f7a3ed83eec3f77
.quad 0x3eafbeafbf25248d,0xbeafbf5e248d3f25,0xbdf5bf42bd5f3f22,0xbee7bf703e953f5c,0xbf0ebf7b3f0e3f7b,0xbf0ebf7b3f0e3f7b,0xbf5fbf733f723f62,0xbf27bf803f463f7d
.quad 0xbf80bf2d3f743ec4,0xbf3dbf7e3f6d3f63,0xbf69be693f15be95,0xbf50bf753f7f3f2f,0xbf203e8fbcb3bf55,0xbf60bf663f7b3ece,0xbe533f37bf1ebf7f,0xbf6ebf503f623d9c
.quad 0x3e853f77bf77bf35,0xbf77bf353f35be85,0x3f2b3f78bf6ebdc9,0xbf7dbf153ef1bf11,0x3f6f3f39bf053f0e,0xbf80bee23e48bf4e,0x3f7f3e953dc93f75,0xbf7fbe95bdc9bf75
.quad 0x3f58be5e3f2d3f6d,0xbf7abe06bec4bf80,0x3f02bf2b3f7c3ef1,0xbf723d06bf22bf6e,0x3d86bf723f66be48,0xbf663e48bf55bf40,0xbec9bf7c3ee7bf46,0xbf563eb4bf75befb
.quad 0x3f713f71bf44bf80,0x3f713f00bf80bf44,0x3f7e3f27bf80bf46,0x3f643eb4bf75bf02,0x3f553e48bf55be48,0x3f553e48bf55be48,0x3efbbe9fbeaa3ef1,0x3f423d06bf223e11
.quad 0x3d33bf3d3e9a3f6d,0x3f2dbe06bec43eec,0xbed3bf793f503f75,0x3f15be95bdc93f3b,0xbf48bf763f803f0e,0x3ef6bee23e483f6a,0xbf7bbf333f49bdc9,0x3ebfbf153ef13f7f
.quad 0xbf77be853e85bf35,0x3e85bf353f353f77,0xbf3f3e7ebebfbf7f,0x3e11bf503f623f53,0xbeba3f31bf5bbf55,0x3cb3bf663f7b3f17,0x3dc93f75bf7fbe95,0xbdc9bf753f7f3e95
.quad 0x3f0a3f7abf3d3ec4,0xbe5ebf7e3f6dbd33,0x3f5c3f3fbe3d3f62,0xbeaabf803f46bebf,0x3f7f3ea53ee23f7b,0xbee2bf7b3f0ebf29,0x3f6bbe3d3f643f22,0xbf0cbf703e95bf5f
.quad 0x3f7c3f5ebf5ebf7c,0x3f5e3eafbf7cbf25,0x3f7b3f15bf80bf37,0x3f593e8abf6ebedd,0x3f553e48bf55be48,0x3f553e48bf55be48,0x3f11be69bed33ec9,0x3f503df5bf333d5f
.quad 0x3e5ebf1c3e063f58,0x3f4b3d33bf0a3e9a,0xbe27bf623f223f80,0x3f46bd06beb43f07,0xbf05bf7f3f723f4e,0x3f40bddfbe1c3f39,0xbf4dbf703f793eaa,0x3f3bbe3d3d5f3f5f
.quad 0xbf77bf353f35be85,0x3f35be853e853f77,0xbf7ebeb43e69bf42,0x3f2fbeaa3ee73f80,0xbf603d86bea5bf7e,0x3f29bece3f203f79,0xbf223ef1bf46bf62,0x3f22bef13f463f62
.quad 0xbe9a3f4bbf7ebeec,0x3f1cbf0a3f633f3d,0x3d9c3f79bf693df5,0x3f15bf1a3f773f0c,0x3ee23f7bbf0e3f29,0x3f0ebf293f7f3ea5,0x3f3f3f50bd063f78,0x3f07bf373f7d3d9c
.quad 0xbe323f003f00be32,0x3f003f71be32bf44,0x3e533f50bd06bf33,0x3f073f77bebfbf67,0x3f0e3f7bbf0ebf7b,0x3f0e3f7bbf0ebf7b,0x3f533f79bf69bf6b,0x3f153f7ebf37bf80
.quad 0x3f7a3f4bbf7ebf0a,0x3f1c3f80bf58bf74,0x3f7d3ef1bf463d06,0x3f223f80bf70bf59,0x3f5b3d86bea53f17,0x3f293f7ebf7dbf31,0x3f1abeb43e693f72,0x3f2f3f7cbf80befb
.quad 0x3e85bf353f353f77,0x3f353f77bf77be85,0xbdf5bf703f793f27,0x3f3b3f72bf64bc33,0xbef6bf7f3f723ddf,0x3f403f6abf483e73,0xbf46bf623f22bef1,0x3f463f62bf223ef1
.quad 0xbf74bf1c3e06bf63,0x3f4b3f58beec3f2d,0xbf7fbe69bed3bf7e,0x3f503f4dbe8a3f56,0xbf663e48bf55bf40,0x3f553f40bd863f72,0xbf2b3f15bf80be7e,0x3f593f333e113f7f
.quad 0x3f00be32bf44be32,0xbe32bf44be323f00,0x3d86bf20be733ef6,0xbe8fbf5b3ddf3f40,0xbec4bf6d3ec43f6d,0xbec4bf6d3ec43f6d,0xbf40bf7e3f5b3f76,0xbef6bf793f203f7f
.quad 0xbf77bf523f7f3f13,0xbf13bf7f3f523f77,0xbf7bbee23f40bd86,0xbf29bf7f3f723f55,0xbf4b3d333e5ebf2d,0xbf3dbf7a3f803f1c,0xbee23f05becebf7d,0xbf4ebf6f3f793ea5
.quad 0x248d3f5ebf5ebf5e,0xbf5ebf5e3f5ea554,0x3ee23f80bf7ebeba,0xbf6abf483f31bea5,0x3f4b3f63bf3d3e9a,0xbf74bf2d3eecbf1c,0x3f7b3f0ebe483f55,0xbf7bbf0e3e48bf55
.quad 0x3f773db23ed83f7f,0xbf7fbed8bdb2bf77,0x3f40bece3f603f39,0xbf80be8fbebabf7f,0x3ec4bf4b3f7e3e06,0xbf7ebe06bf1cbf6d,0xbd86bf7d3f39bf05,0xbf793cb3bf4ebf40
.quad 0x3f5e3f7cbf25bf7c,0x3f7c3f25bf7cbf5e,0x3f7f3f48bf79bf60,0x3f763f05bf7ebf29,0x3f6d3ec4bf6dbec4,0x3f6d3ec4bf6dbec4,0x3f29bddfbf053e8f,0x3f603e73bf48bd86
.quad 0x3e85bf133db23f52,0x3f523db2bf133e85,0xbe48bf663f293f7f,0x3f40bd86bea53f0e,0xbf1cbf803f7a3f3d,0x3f2dbe5ebd333f4b,0xbf66bf5b3f6a3e1c,0x3f17beba3e733f72
.quad 0xbf80bf003f00bf00,0x3f00bf003f003f80,0xbf66bcb3bddfbf6f,0x3ecebf203f393f72,0xbf1c3eecbf2dbf74,0x3e9abf3d3f633f4b,0xbe483f55bf7bbf0e,0x3e48bf553f7b3f0e
.quad 0x3e853f7fbf683db2,0x3db2bf683f7f3e85,0x3f293f6abef63f31,0xbcb3bf763f6fbd86,0x3f6d3f1c3e063f7e,0xbe06bf7e3f4bbec4,0x3f7f3e1c3f313f5b,0xbe73bf803f17bf29
.quad 0x3f713f71bf44bf80,0x3f713f00bf80bf44,0x3f803f39bf7dbf55,0x3f6f3ee2bf7bbf17,0x3f6d3ec4bf6dbec4,0x3f6d3ec4bf6dbec4,0x3f39bcb3bf173e48,0x3f6a3ea5bf55be1c
.quad 0x3ed8bed8bdb23f35,0x3f683e85bf353db2,0x3d86bf403ee23f7b,0x3f663e48bf0e3ea5,0xbe9abf743f583f6d,0x3f633e06bec43f0a,0xbf20bf7e3f803f0e,0x3f603d86be483f39
.quad 0xbf5ebf5e3f5ea554,0x3f5ea554248d3f5e,0xbf7dbf173ef6bf0e,0x3f5bbd863e483f76,0xbf7abe5ebd33bf6d,0x3f58be063ec43f80,0xbf553e48bf0ebf7b,0x3f55be483f0e3f7b
.quad 0xbf133f13bf68bf35,0x3f52be853f353f68,0xbe733f5bbf7ebe48,0x3f4ebea53f553f48,0x3e063f7ebf4b3ec4,0x3f4bbec43f6d3f1c,0x3ef63f76beba3f55,0x3f48bee23f7b3ece
.quad 0xbeaf3eaf3f25a50d,0x3eaf3f5ea50dbf25,0x3cb33f313e1cbf0e,0x3eba3f66be48bf4e,0x3ec43f6dbec4bf6d,0x3ec43f6dbec4bf6d,0x3f313f80bf4ebf7b,0x3ece3f72bf0ebf7d
.quad 0x3f683f68bf7fbf35,0x3ed83f77bf35bf7f,0x3f7f3f29bf66be48,0x3ee23f7bbf55bf72,0x3f743e9abf0a3ec4,0x3eec3f7ebf6dbf58,0x3f48bddfbcb33f55,0x3ef63f7fbf7bbf31
.quad 0x3f00bf003f003f80,0x3f003f80bf80bf00,0x3e1cbf4e3f603f55,0x3f053f7fbf7bbe8f,0xbe5ebf7a3f803ec4,0x3f0a3f7ebf6dbd33,0xbf0ebf7b3f55be48,0x3f0e3f7bbf553e48
.quad 0xbf52bf523ed8bf35,0x3f133f77bf353ed8,0xbf79bf05bddfbf7b,0x3f173f72bf0e3f20,0xbf7ebe06bf1cbf6d,0x3f1c3f6dbec43f4b,0xbf603e8fbf6fbf0e,0x3f203f66be483f6a
.quad 0x3f25a554bf5ebeaf,0xa554bf25beaf3eaf,0x3e7ebef1bed33e9f,0xbdc9bf3fbd9c3f1e,0xbe48bf553e483f55,0xbe48bf553e483f55,0xbf1abf7f3f3b3f7f,0xbe95bf673ee73f77
.quad 0xbf63bf6d3f7e3f3d,0xbec4bf743f2d3f80,0xbf80bf223f623e27,0xbef1bf7d3f593f70,0xbf6abe483ee2bef6,0xbf0ebf803f763f48,0xbf273e95be27bf6b,0xbf22bf7e3f803f0c
.quad 0xbe853f35bf35bf77,0xbf35bf773f773e85,0x3e3d3f75bf7dbf1a,0xbf46bf6b3f5cbd5f,0x3f173f7bbf663cb3,0xbf55bf5b3f31beba,0x3f623f46bef13f22,0xbf62bf463ef1bf22
.quad 0x3f803ec43e063f7a,0xbf6dbf2d3e5ebf58,0x3f6bbdc93f2f3f67,0xbf75bf11bd5fbf78,0x3f29bf0e3f7b3ee2,0xbf7bbee2bea5bf7f,0x3e8abf623f69be53,0xbf7fbe9fbf11bf6e
.quad 0x3f443f80bf00bf71,0x3f803f44bf71bf71,0x3f783f62bf69bf73,0x3f7f3f2bbf7fbf49,0x3f7b3f0ebf7bbf0e,0x3f7b3f0ebf7bbf0e,0x3f4d3dc9bf2f3d9c,0x3f753eddbf64be8a
.quad 0x3eecbec4be063f2d,0x3f6d3e9abf3d3d33,0x3d06bf463ef13f7d,0x3f623e27bf073eb4,0xbecebf7b3f663f60,0x3f553cb3be8f3f20,0xbf42bf753f7d3ec9,0x3f46bdf5bc333f56
.quad 0xbf77bf353f35be85,0x3f35be853e853f77,0xbf7cbe953e27bf4d,0x3f22bec93f023f80,0xbf4e3e48bee2bf80,0x3f0ebf053f393f6f,0xbef13f22bf62bf46,0x3ef1bf223f623f46
.quad 0xbd333f6dbf7ebe5e,0x3ec4bf3d3f7a3f0a,0x3ec93f7fbf3b3edd,0x3e95bf533f803e7e,0x3f403f55be483f66,0x3e48bf663f72bd86,0x3f773ef13ed33f7b,0x3dc9bf733f53bebf
.quad 0x3f5e3f7cbf25bf7c,0x3f7c3f25bf7cbf5e,0x3f7d3f56bf72bf6b,0x3f7c3f1abf80bf3b,0x3f7b3f0ebf7bbf0e,0x3f7b3f0ebf7bbf0e,0x3f593e3dbf3fbc33,0x3f7b3f02bf6ebeb4
.quad 0x3f1cbe5ebe9a3f0a,0x3f7a3eecbf58be06,0x3e95bf153e693f69,0x3f793ed3bf3b3dc9,0xbd86bf5b3f313f7d,0x3f793ebabf173ea5,0xbed3bf7d3f773f3f,0x3f783e9fbedd3f07
.quad 0xbf35bf773f773e85,0x3f773e85be853f35,0xbf69bf493f33be9f,0x3f773e53bd9c3f59,0xbf7fbef63e73bf48,0x3f763e1c3ddf3f72,0xbf75bdc9be95bf7f,0x3f753dc93e953f7f
.quad 0xbf4b3e9abf3dbf63,0x3f743d333eec3f7e,0xbf073f27bf7bbefb,0x3f73bc333f1e3f70,0xbe483f66bf723d86,0x3f72bd863f403f55,0x3e273f80bf273f1a,0x3f72bdf53f5c3f2f
.quad 0xbf003e323f443e32,0x3e323f443e32bf00,0xbe273f0c3eaabec9,0x3e3d3f4dbc33bf2f,0x3e483f55be48bf55,0x3e483f55be48bf55,0x3f073f7cbf2bbf80,0x3e533f5cbebfbf70
.quad 0x3f4b3f7abf74bf58,0x3e5e3f63bf0abf7e,0x3f753f50bf79bed3,0x3e693f69bf2fbf7f,0x3f7f3f05bf393e1c,0x3e733f6fbf4ebf72,0x3f693e11be8a3f2b,0x3e7e3f73bf67bf59
.quad 0x3f35be853e853f77,0x3e853f77bf77bf35,0x3ed3bf1e3f373f73,0x3e8a3f7bbf7fbf07,0x3d86bf603f793f20,0x3e8f3f7dbf7ebea5,0xbe95bf7f3f753dc9,0x3e953f7fbf75bdc9
.quad 0xbf1cbf743f2dbeec,0x3e9a3f80bf633e06,0xbf59bf423e53bf5f,0x3e9f3f80bf493eb4,0xbf7bbee2bea5bf7f,0x3ea53f7fbf293f0e,0xbf7dbd5fbf42bf4d,0x3eaa3f7ebf023f3b
.quad 0x3f443f443e323f80,0x3f44bf003f803e32,0x3f1c3f5e3e063f80,0x3f7ea5543f6d3f00,0x3ed83f713db23f80,0x3f683f003f353f44,0x3e5e3f7c3d333f80,0x3f0a3f5e3ec43f71
.quad 0x248d3f80248d3f80,0x248d3f80248d3f80,0xbe5e3f7cbd333f80,0xbf0a3f5ebec43f71,0xbed83f71bdb23f80,0xbf683f00bf353f44,0xbf1c3f5ebe063f80,0xbf7e248dbf6d3f00
.quad 0xbf443f44be323f80,0xbf44bf00bf803e32,0xbf633f25be5e3f80,0xbe9abf5ebf6dbe32,0xbf773f00be853f80,0x3e85bf80bf35bf00,0xbf803eafbe9a3f80,0x3f3dbf5ebec4bf44
.quad 0xbf7c3e32beaf3f80,0x3f7cbf00a554bf71,0xbf6d248dbec43f80,0x3f6da5543ec4bf80,0xbf52be32bed83f80,0x3f133f003f35bf71,0xbf2dbeafbeec3f80,0x3d333f5e3f6dbf44
.quad 0xbf253f25bf7c8000,0x3f253f5e80003f7c,0xbf4b3f00bf7e8000,0x3e063f80bec43f5e,0xbf683eafbf7f8000,0xbed83f5ebf353f25,0xbf7a3e32bf808000,0xbf583f00bf6d3eaf
.quad 0xbf808000bf808000,0xbf808000bf808000,0xbf7abe32bf808000,0xbf58bf00bf6dbeaf,0xbf68beafbf7f8000,0xbed8bf5ebf35bf25,0xbf4bbf00bf7e8000,0x3e06bf80bec4bf5e
.quad 0xbf25bf25bf7c8000,0x3f25bf5ea50dbf7c,0xbeecbf44bf7a8000,0x3f74bf003ec4bf7c,0xbe85bf5ebf778000,0x3f77a50d3f35bf5e,0xbd33bf71bf748000,0x3f2d3f003f6dbf25
.quad 0x3e32bf7cbf718000,0x3e323f5e3f80beaf,0x3ec4bf80bf6d8000,0xbec43f803f6da50d,0x3f13bf7cbf688000,0xbf523f5e3f353eaf,0x3f3dbf71bf638000,0xbf803f003ec43f25
.quad 0xbf71bf00bf00bf71,0xbf003f44bf713e32,0xbf4bbf35bec4bf77,0xbf6d3e85bf7ebe85,0xbf13bf5ebe85bf7c,0xbf77beafbf52bf25,0xbe9abf77be06bf7f,0xbf1cbf52beecbf68
.quad 0xa554bf80a554bf80,0xa554bf80a554bf80,0x3e9abf773e06bf7f,0x3f1cbf523eecbf68,0x3f13bf5e3e85bf7c,0x3f77beaf3f52bf25,0x3f4bbf353ec4bf77,0x3f6d3e853f7ebe85
.quad 0x3f71bf003f00bf71,0x3f003f443f713e32,0x3f80be853f1cbf68,0xbe063f7f3f2d3f13,0x3f77a5543f35bf5e,0xbf353f5e3e853f5e,0x3f583e853f4bbf52,0xbf7e3ed8be5e3f7f
.quad 0x3f253f003f5ebf44,0xbf5ebe32bf253f71,0x3ec43f353f6dbf35,0xbec4bf35bf6d3f35,0x3db23f5e3f77bf25,0x3e85bf7cbf7f3eaf,0xbe5e3f773f7ebf13,0x3f4bbf68bf58bdb2
.quad 0x3eafbf5e3f5ebeaf,0xbf5ebf25beafbf7c,0x3f1cbf353f6dbe85,0xbec4bf773e06bf77,0x3f52bf003f77be32,0x3e85bf713f13bf44,0x3f74be853f7ebdb2,0x3f4bbf133f63bed8
.quad 0x3f80a50d3f80a50d,0x3f80a50d3f80a50d,0x3f743e853f7e3db2,0x3f4b3f133f633ed8,0x3f523f003f773e32,0x3e853f713f133f44,0x3f1c3f353f6d3e85,0xbec43f773e063f77
.quad 0x3eaf3f5e3f5e3eaf,0xbf5e3f25beaf3f7c,0x3d333f773f4b3ed8,0xbf7e3db2bf3d3f52,0xbe853f803f353f00,0xbf35bf00bf773f00,0xbf0a3f773f1c3f13,0xbe06bf68bf7a3db2
.quad 0xbf443f5e3f003f25,0x3f00bf7cbf44beaf,0xbf6d3f353ec43f35,0x3f6dbf35bec4bf35,0xbf7f3f003e853f44,0x3f77be323db2bf71,0xbf7a3e853e063f52,0x3f1c3ed83f0abf7f
.quad 0x3f003f71be323f71,0x3f71be323f713f00,0x3e953f7dbe693f70,0x3f793eb43f3b3f46,0x3d863f80be8f3f6f,0x3f313f483ece3f72,0xbe273f7bbeaa3f6e,0x3e3d3f7d3c333f80
.quad 0xbec43f6dbec43f6d,0xbec43f6dbec43f6d,0xbf153f56bedd3f6b,0xbf533f1abf373f3b,0xbf403f39bef63f6a,0xbf803ddfbf6f3ee2,0xbf623f15bf073f69,0xbf59bed3bf803dc9
.quad 0xbf773ed8bf133f68,0xbed8bf52bf68be85,0xbf803e7ebf1e3f67,0x3e11bf7fbf2bbf15,0xbf7b3d86bf293f66,0x3f29bf66bea5bf55,0xbf69bdf5bf333f64,0x3f77bf0c3d9cbf79
.quad 0xbf4bbe9abf3d3f63,0x3f74bd333eecbf7e,0xbf22bef1bf463f62,0x3f223ef13f46bf62,0xbee2bf20bf4e3f60,0x3ddf3f5b3f76bf29,0xbe69bf42bf563f5f,0xbee73f803f7ebeb4
.quad 0xbf5e3eafbf7cbeaf,0x3eaf3f7cbeaf3f5e,0xbf753e27bf79beb4,0xbe693f70bf2f3f22,0xbf7fbcb3bf76beba,0xbf393f20bf6a3ea5,0xbf7dbe53bf72bebf,0xbf7c3e11bf80bd06
.quad 0xbf6dbec4bf6dbec4,0xbf6dbec4bf6dbec4,0xbf50bf0cbf67bec9,0xbf11bf4dbf33bf2f,0xbf29bf31bf60bece,0xbcb3bf7ebebabf66,0xbef1bf50bf59bed3,0x3f07bf693d06bf7f
.quad 0xbe85bf68bf52bed8,0x3f68bf133ed8bf77,0xbd06bf78bf49bedd,0x3f7dbd9c3f3fbf50,0x3e48bf7fbf40bee2,0x3f403ee23f72bf0e,0x3ed3bf7ebf37bee7,0x3e8a3f563f7fbe69
.quad 0x3f1cbf74bf2dbeec,0xbe9a3f803f633e06,0x3f46bf62bf22bef1,0xbf463f623f223ef1,0x3f66bf48bf17bef6,0xbf7e3f053e8f3f40,0x3f79bf27bf0cbefb,0xbf643c33bdf53f70
.quad 0xbf44bf44be32bf80,0xbf443f00bf80be32,0xbf07bf69bd06bf7f,0xbf80bdc9bf62bf15,0xbe73bf7d3ddfbf7b,0xbf4ebf29bf0ebf60,0x3d9cbf7e3e7ebf75,0xbe8abf79bdc9bf80
.quad 0x3ec4bf6d3ec4bf6d,0x3ec4bf6d3ec4bf6d,0x3f27bf493f02bf62,0x3f5fbf073f46bf2b,0x3f5bbf173f20bf55,0x3f7d3d863f7bbe8f,0x3f79beb43f3bbf46,0x3f2f3f223f753e27
.quad 0x3f7fbdb23f52bf35,0x3db23f773f353f13,0x3f6b3e3d3f64bf22,0xbf0c3f703e953f5f,0x3f403ee23f72bf0e,0xbf723f0ebe483f7f,0x3f023f2b3f7cbef1,0xbf72bd06bf223f6e
.quad 0x3e5e3f583f80bec4,0xbf0abf1cbf6d3f2d,0xbdc93f753f7fbe95,0x3dc9bf75bf7f3e95,0xbece3f803f79be48,0x3f31bf72bf55be1c,0xbf2b3f783f6ebdc9,0x3f7dbf15bef1bf11
.quad 0x3f25bf253f7ca50d,0xbf25bf5ea50dbf7c,0x3f59bed33f803dc9,0xbd06bf7f3ef1bf50,0x3f79be1c3f7e3e48,0x3f17bf403f55bef6,0x3f7f3df53f783e95,0x3f77be693f7fbd5f
.quad 0x3f6d3ec43f6d3ec4,0x3f6d3ec43f6d3ec4,0x3f423f1e3f5c3ef1,0x3efb3f593f223f3f,0x3f053f4e3f483f0e,0xbe1c3f7f3e483f76,0x3e693f703f2f3f22,0xbf3b3f46be953f7d
.quad 0xbdb23f7f3f133f35,0xbf7f3e85bf353f52,0xbec93f7c3ee73f46,0xbf56beb4bf753efb,0xbf293f663ea53f55,0xbea5bf55bf7b3d86,0xbf5c3f3f3e3d3f62,0x3eaabf80bf46bebf
.quad 0xbf7a3f0a3d333f6d,0x3f58bf4bbec4bf3d,0xbf7f3e95bdc93f75,0x3f7fbe953dc9bf75,0xbf6a3cb3be733f7b,0x3f393ea53f0ebf7d,0xbf3fbe7ebebf3f7f,0x3e113f503f62bf53
.quad 0x3e323f80bf003f44,0x3f803e323f443f44,0xbd863f7bbf0e3f40,0x3f553f293ee23f72,0xbe9a3f6dbf1c3f3d,0x3ec43f743d333f80,0xbf053f55bf293f39,0xbe483f79beba3f6a
.quad 0xbf353f35bf353f35,0xbf353f35bf353f35,0xbf5b3f0ebf403f31,0xbf7b3e73bf6f3ece,0xbf743ec4bf4b3f2d,0xbf6dbe9abf803d33,0xbf7f3e48bf553f29,0xbf0ebf40bf66bea5
.quad 0xbf7c248dbf5e3f25,0xa554bf7cbf25bf25,0xbf6abe48bf663f20,0x3f0ebf6fbe8fbf60,0xbf4bbec4bf6d3f1c,0x3f6dbf1c3e06bf7e,0xbf20bf0ebf723f17,0x3f7bbddf3f05bf79
.quad 0xbed8bf35bf773f13,0x3f353ed83f52bf52,0xbe48bf55bf7b3f0e,0x3e483f553f7bbf0e,0x3d33bf6dbf7e3f0a,0xbec43f803f7abe5e,0x3e8fbf7bbf7f3f05,0xbf553f603f4e3e1c
.quad 0xbf7c8000bf5ebf25,0x80003f7cbf253f25,0xbf7fbe48bf55bf29,0xbf0e3f40bf663ea5,0xbf74bec4bf4bbf2d,0xbf6d3e9abf80bd33,0xbf5bbf0ebf40bf31,0xbf7bbe73bf6fbece
.quad 0xbf35bf35bf35bf35,0xbf35bf35bf35bf35,0xbf05bf55bf29bf39,0xbe48bf79bebabf6a,0xbe9abf6dbf1cbf3d,0x3ec4bf743d33bf80,0xbd86bf7bbf0ebf40,0x3f55bf293ee2bf72
.quad 0x3e32bf80bf00bf44,0x3f80be323f44bf44,0x3ecebf7bbee2bf48,0x3f553eba3f76bef6,0x3f1cbf6dbec4bf4b,0x3ec43f4b3f7ebe06,0x3f48bf55bea5bf4e,0xbe483f7e3f5b3e73
.quad 0x3f68bf35be85bf52,0xbf353f683f133f13,0x3f7bbf0ebe48bf55,0xbf7b3f0e3e483f55,0x3f80bec4be06bf58,0xbf6d3d33be5e3f7a,0x3f76be48bd86bf5b,0xbf0ebef6bf173f7d
.quad 0xbf00bf713e32bf71,0xbf713e32bf71bf00,0xbe48bf7f3ea5bf66,0xbf72bee2bf29bf55,0x3e06bf7a3eecbf58,0xbf0abf63be5ebf7e,0x3ee2bf603f17bf48,0x3ddfbf7d3e8fbf72
.quad 0x3f35bf353f35bf35,0x3f35bf353f35bf35,0x3f66bef63f4ebf20,0x3f7ebe1c3f76bea5,0x3f7ebe5e3f63bf0a,0x3f583eec3f7a3e06,0x3f7b3d863f72bee2,0x3ea53f663f403f0e
.quad 0x3f5e3eaf3f7cbeaf,0xbeaf3f7c3eaf3f5e,0x3f293f173f80be73,0xbf5b3f31be1c3f7f,0x3ec43f4b3f7ebe06,0xbf7e3e06bf1c3f6d,0x3d863f6f3f76bcb3,0xbf31bef6bf6a3f29
.quad 0xbe853f7f3f683db2,0xbdb2bf68bf7f3e85,0xbf0e3f7b3f553e48,0x3f0ebf7bbf55be48,0xbf4b3f633f3d3e9a,0x3f74bf2dbeecbf1c,0xbf723f393f203ece,0x3f6fbddf3cb3bf66
.quad 0x3f5ebeaf3f7c3eaf,0xbeafbf7c3eafbf5e,0x3f7bbd863f723ee2,0x3ea5bf663f40bf0e,0x3f7e3e5e3f633f0a,0x3f58beec3f7abe06,0x3f663ef63f4e3f20,0x3f7e3e1c3f763ea5
.quad 0x3f353f353f353f35,0x3f353f353f353f35,0x3ee23f603f173f48,0x3ddf3f7d3e8f3f72,0x3e063f7a3eec3f58,0xbf0a3f63be5e3f7e,0xbe483f7f3ea53f66,0xbf723ee2bf293f55
.quad 0xbf003f713e323f71,0xbf71be32bf713f00,0xbf403f4e3cb33f79,0xbf05bf39bf7d3d86,0xbf6d3f1cbe063f7e,0x3e06bf7ebf4bbec4,0xbf7f3ebabe8f3f80,0x3f39bf60becebf40
.quad 0xbf773db2bed83f7f,0x3f7fbed83db2bf77,0xbf55be48bf0e3f7b,0x3f553e483f0ebf7b,0xbf1cbeecbf2d3f74,0x3e9a3f3d3f63bf4b,0xbea5bf31bf483f6a,0xbeba3f7e3f80bee2
.quad 0xbe323f71bf443f00,0x3f713f003f003f71,0xbed33f59bf503ef1,0x3f153f623dc93f80,0xbf203f39bf5b3ee2,0x3cb33f7fbea53f6a,0xbf4d3f11bf643ed3,0xbf0c3f50bf2f3f33
.quad 0xbf6d3ec4bf6d3ec4,0xbf6d3ec4bf6d3ec4,0xbf7d3e3dbf733eb4,0xbf7bbe27bf803c33,0xbf7ebcb3bf793ea5,0xbf31bf29bf66beba,0xbf70be69bf7d3e95,0xbe27bf75bf22bf2f
.quad 0xbf52bed8bf7f3e85,0x3ed8bf77be85bf68,0xbf27bf1abf803e69,0x3f5cbf2f3e27bf80,0xbee2bf40bf7f3e48,0x3f7fbe483f0ebf72,0xbe53bf5fbf7d3e27,0x3f493eb43f59bf42
.quad 0x3d33bf74bf7a3e06,0x3e9a3f4b3f7ebeec,0x3e95bf7fbf753dc9,0xbe953f7f3f75bdc9,0x3f05bf7ebf6f3d86,0xbf483f663f403e8f,0x3f37bf73bf673d06,0xbf7f3f073ed33f1e
.quad 0xbf7cbeafbf25bf5e,0xbeaf3f5ebf5e3eaf,0xbf69bf07bf15bf62,0xbf503ef1bf7fbd06,0xbf48bf31bf05bf66,0xbf80bd86bf72bece,0xbf1abf53bee7bf69,0xbf56bf15bf3bbf37
.quad 0xbec4bf6dbec4bf6d,0xbec4bf6dbec4bf6d,0xbe11bf7cbe9fbf70,0x3e53bf7d3d06bf80,0x3ddfbf80be73bf72,0x3f39bf403ee2bf6f,0x3eb4bf79be27bf75,0x3f7dbe953f46bf3b
.quad 0x3f13bf68bdb2bf77,0x3f683e853f77bed8,0x3f42bf4dbc33bf79,0x3f023f3b3f7dbd5f,0x3f66bf293d86bf7b,0xbd863f7b3f553ea5,0x3f7bbefb3e11bf7d,0xbf1e3f703f073f27
.quad 0x3f80be9a3e5ebf7e,0xbf743f1c3e063f63,0x3f75bdc93e95bf7f,0xbf753dc9be953f7f,0x3f5b3ddf3ebabf7f,0xbf20bee2bf293f76,0x3f333e9f3eddbf80,0xbd9cbf59bf693f49
.quad 0xbe32bf803f00bf44,0xbf80be32bf44bf44,0x3e27bf753f22bf2f,0xbf46bf3bbeb4bf79,0x3ef6bf553f40bf17,0xbe48bf7e3e1cbf79,0x3f3fbf223f59befb,0x3ef1bf5c3f1ebf42
.quad 0x3f6dbec43f6dbec4,0x3f6dbec43f6dbec4,0x3f80bdc93f79be8a,0x3f753e7e3f7e3d9c,0x3f763e483f7fbe1c,0x3f0e3f483f4e3f05,0x3f503ef13f7fbd06,0xbdc93f803ed33f59
.quad 0x3f133f353f773db2,0xbf353f52bdb23f7f,0x3e8a3f623f693e53,0xbf7f3e9fbf113f6e,0xbd863f7b3f553ea5,0xbf55bea5bf663f29,0xbec93f7f3f3b3edd,0xbe95bf53bf803e7e
.quad 0xbf2d3f6d3f1c3f0a,0x3ec4bf80bf58be5e,0xbf623f463ef13f22,0x3f62bf46bef1bf22,0xbf7d3f0e3ea53f39,0x3f7bbe733cb3bf6a,0xbf7c3e953e273f4d,0x3f223ec93f02bf80
.quad 0x3f7ca50d3f5e3f25,0xa50dbf7c3f25bf25,0x3f7d3e953f463f3b,0x3f22bf2f3f70be69,0x3f603f0e3f293f4e,0x3f7bbddf3f7d3e73,0x3f2b3f463f073f5f,0x3f623f023f493f27
.quad 0x3ec43f6d3ec43f6d,0x3ec43f6d3ec43f6d,0x3d5f3f7f3e693f77,0xbe953f78bdf53f7f,0xbe8f3f7b3d863f7d,0xbf553f20bf173f5b,0xbf153f62bdc93f80,0xbf7f3d06bf693f07
.quad 0xbf523f35be853f7f,0xbf35bf13bf7f3db2,0xbf773ef1bed33f7b,0xbdc9bf73bf53bebf,0xbf7f3e48bf0e3f72,0x3f0ebf72bee2bf40,0xbf6bbdc9bf2f3f67,0x3f75bf113d5fbf78
.quad 0xbf3dbec4bf4b3f58,0x3f6d3d333f0abf7a,0xbef1bf22bf623f46,0x3ef13f223f62bf46,0xbe1cbf55bf723f31,0xbe483f793f80bece,0x3e3dbf75bf7d3f1a,0xbf463f6b3f5c3d5f
.quad 0xbf00bf713e32bf71,0xbf713e32bf71bf00,0x3ec4bf5e3f4bbf00,0xbf1cbf5ebe06bf80,0x3f77be323f7f3e32,0x3f13bf443f52bf00,0x3f4b3f253f2d3f44,0x3f743eaf3f633f00
.quad 0x248d3f80248d3f80,0x248d3f80248d3f80,0xbf4b3f25bf2d3f44,0xbf743eafbf633f00,0xbf77be32bf7f3e32,0xbf13bf44bf52bf00,0xbec4bf5ebf4bbf00,0x3f1cbf5e3e06bf80
.quad 0x3f00bf71be32bf71,0x3f713e323f71bf00,0x3f7ebeaf3f0abf71,0xbd333f7c3f3d3f00,0x3f353f003f77bf00,0xbf773f00be853f80,0xbe063f7c3f633e32,0xbf0abf25bf7a3f00
.quad 0xbf5e3f443eaf3f44,0x3f25bf71bf25bf00,0xbf6d248dbec43f80,0x3f6da5543ec4bf80,0xbe85bf44bf683f44,0xbdb23f713f7fbf00,0x3f1cbf7cbf743e32,0xbf7a3f253f0a3f00
.quad 0x3f5ebeaf3f7c3eaf,0xbeafbf7c3eafbf5e,0x3f6d3f003f1c3f5e,0x3f4bbf003f7ea50d,0x3e853f7cbdb23f7c,0x3f523f253f133f5e,0xbf1c3f44bf3d3f25,0xbe9a3f71beec3f5e
.quad 0xbf808000bf808000,0xbf808000bf808000,0xbf1cbf44bf3dbf25,0xbe9abf71beecbf5e,0x3e85bf7cbdb2bf7c,0x3f52bf253f13bf5e,0x3f6dbf003f1cbf5e,0x3f4b3f003f7ea50d
.quad 0x3f5e3eaf3f7cbeaf,0xbeaf3f7c3eaf3f5e,0x3e063f713f583eaf,0xbf803e32bf2d3f5e,0xbf353f5e3e853f5e,0xbe85bf5ebf778000,0xbf7e3e32beec3f7c,0x3f58bf44be5ebf5e
.quad 0xbf00bf25bf713f25,0x3f443eaf3f44bf5e,0x3ec4bf80bf6d8000,0xbec43f803f6da50d,0x3f77bf25bed8bf25,0xbf7f3eaf3db23f5e,0x3f4b3e323e9abf7c,0xbe5ebf44bf583f5e
.quad 0x3f443f443e323f80,0x3f44bf003f803e32,0xbe063f77bf1c3f35,0x3f4b3f353ec43f77,0xbf683eafbf7f248d,0xbed83f5ebf353f25,0xbf58bf13bf3dbf35,0xbf7abe85bf6dbed8
.quad 0xa554bf80a554bf80,0xa554bf80a554bf80,0x3f58bf133f3dbf35,0x3f7abe853f6dbed8,0x3f683eaf3f7fa554,0x3ed83f5e3f353f25,0x3e063f773f1c3f35,0xbf4b3f35bec43f77
.quad 0xbf443f44be323f80,0xbf44bf00bf803e32,0xbf74bdb2bf583f35,0x3eecbf77bec4bf52,0xbe85bf5ebf77248d,0x3f77a5543f35bf5e,0x3f2dbf68beecbf35,0xbd333f773f6d3db2
.quad 0x3f7cbe323eafbf80,0xbf7c3f00248d3f71,0x3ec43f353f6dbf35,0xbec4bf35bf6d3f35,0xbf133f7c3f68a554,0x3f52bf5ebf35beaf,0xbf803ed83e9a3f35,0x3f3d3e853ec4bf7f
.quad 0xbf253f25bf7c8000,0x3f253f5e80003f7c,0xbf7ebe85bf4bbf35,0xbf1c3f35bf6d3e85,0xbed8bf71bdb2bf80,0xbf68bf00bf35bf44,0x3f0abf523f2dbf35,0x3e5ebf773ec4bf68
.quad 0x3f80a50d3f80a50d,0x3f80a50d3f80a50d,0x3f0a3f523f2d3f35,0x3e5e3f773ec43f68,0xbed83f71bdb23f80,0xbf683f00bf353f44,0xbf7e3e85bf4b3f35,0xbf1cbf35bf6dbe85
.quad 0xbf25bf25bf7c8000,0x3f25bf5ea50dbf7c,0x3e9abf7fbf0abf35,0x3f633e853f6dbf13,0x3f77bf003e85bf80,0xbe853f803f353f00,0x3f3d3ed83f63bf35,0xbf803e85bec43f7f
.quad 0xbe323f7c3f71a50d,0xbe32bf5ebf803eaf,0xbf6d3f353ec43f35,0x3f6dbf35bec4bf35,0xbf52be32bed83f80,0x3f133f003f35bf71,0x3d33bf68bf743f35,0xbf2d3f773f6dbdb2
.quad 0xbe32bf803f00bf44,0xbf80be32bf44bf44,0x3f2fbf223f75be27,0xbe95bf7d3e69bf70,0x3f7e3e483f663f05,0x3f55bef63f79be1c,0x3f023f623eb43f73,0x3f463f2b3f273f49
.quad 0xbec43f6dbec43f6d,0xbec43f6dbec43f6d,0xbf783e95bf693ee7,0xbf7fbd5fbf7f3df5,0xbf48bf0ebf72be73,0xbe48bf76bf05bf4e,0x3d06bf7fbef1bf50,0x3f62bf153f07bf69
.quad 0x3f52bf353e85bf7f,0x3f353f133f7fbdb2,0x3f733dc93f59bf33,0xbef13f773ebf3f53,0x3ea53f553f7bbd86,0xbf7b3d86bf293f66,0xbf113f753f153f1a,0xbdc9bf6bbf783d5f
.quad 0xbf803ec4be063f7a,0x3f6dbf2dbe5ebf58,0xbf22bef1bf463f62,0x3f223ef13f46bf62,0x3e73bf7bbf7f3eba,0xbf0e3f7d3f6abcb3,0x3f6bbf46bf2fbeaa,0xbf753e3d3d5f3f5c
.quad 0x3f7ca50d3f5e3f25,0xa50dbf7c3f25bf25,0x3f3b3f463e953f7d,0x3f75be273f793eb4,0xbddf3f7bbee23f5b,0x3f0e3f603e733f7d,0xbf5c3ef1bf703e9f,0xbf223f3fbf423f1e
.quad 0xbf6dbec4bf6dbec4,0xbf6dbec4bf6dbec4,0xbe7ebf75bed3bf64,0x3dc9bf80bd9cbf7e,0x3f20bf553ea5bf79,0x3f7bbe8f3f5bbf17,0x3f80bdc93f62bf15,0x3ef13f503f593ed3
.quad 0x3f133f353f773db2,0xbf353f52bdb23f7f,0xbe9f3f7f3f073f37,0xbf62be8abf6e3f11,0xbf723f0ebe483f7f,0x3e48bf7fbf40bee2,0xbf53be95bf503f4d,0x3f7fbec93e7ebf80
.quad 0xbd33bf6dbf7e3e5e,0x3ec43f3d3f7abf0a,0x3f46bf62bf22bef1,0xbf463f623f223ef1,0x3f79be483d86bf6f,0xbf55be1cbece3f80,0x3ec93f223f3bbf72,0x3e95bf7cbf803f02
.quad 0x3f003f71be323f71,0x3f71be323f713f00,0xbef13f50bf593ed3,0x3f073f693d063f7f,0xbf7fbcb3bf76beba,0xbf393f20bf6a3ea5,0xbf15bf56beddbf6b,0xbf53bf1abf37bf3b
.quad 0x3ec4bf6d3ec4bf6d,0x3ec4bf6d3ec4bf6d,0x3f7dbe533f72bebf,0x3f7c3e113f80bd06,0x3f293f313f603ece,0x3cb33f7e3eba3f66,0xbe953f7d3e693f70,0xbf793eb4bf3b3f46
.quad 0xbf773ed8bf133f68,0xbed8bf52bf68be85,0xbf3bbf02bf7e3eaa,0x3f4dbf423d5fbf7d,0x3e48bf7fbf40bee2,0x3f403ee23f72bf0e,0x3f70bf1ebc33bf73,0xbefb3f7b3f273f07
.quad 0x3f4b3e9a3f3dbf63,0xbf743d33beec3f7e,0xbdc93f753f7fbe95,0x3dc9bf75bf7f3e95,0xbf663f483f173ef6,0x3f7ebf05be8fbf40,0xbf59bd9cbe533f77,0x3e9f3f333f49bf69
.quad 0xbf5e3eafbf7cbeaf,0x3eaf3f7cbeaf3f5e,0xbf62bf15bf07bf69,0xbf593ed3bf80bdc9,0xbd86bf803e8fbf6f,0xbf31bf48becebf72,0x3f50bf0c3f67bec9,0x3f11bf4d3f33bf2f
.quad 0x3f6d3ec43f6d3ec4,0x3f6d3ec43f6d3ec4,0x3e273f7b3eaa3f6e,0xbe3d3f7dbc333f80,0xbf403f39bef63f6a,0xbf803ddfbf6f3ee2,0xbf75be27bf793eb4,0xbe69bf70bf2fbf22
.quad 0xbe85bf68bf52bed8,0x3f68bf133ed8bf77,0x3f2fbf5cbdf5bf72,0x3f1a3f273f80be27,0x3f7bbd863f29bf66,0xbf293f663ea53f55,0x3eb43f493f80be9f,0xbf5fbe53bf423f59
.quad 0xbf1c3f743f2d3eec,0x3e9abf80bf63be06,0xbf7f3e95bdc93f75,0x3f7fbe953dc9bf75,0xbee2bf20bf4e3f60,0x3ddf3f5b3f76bf29,0x3f07bf7fbf7b3e8a,0xbf733f373f1e3ed3
.quad 0x3e32bf713f44bf00,0xbf71bf00bf00bf71,0x3f66bea53f7f3e48,0x3d86bf7b3f0ebf40,0x3f633f0a3f2d3f4b,0x3f7abe063f7e3e5e,0x3e1c3f7ebcb33f7f,0x3ef63f663ea53f76
.quad 0xbf353f35bf353f35,0xbf353f35bf353f35,0xbf7dbddfbf803d86,0xbf60bee2bf72be8f,0xbeecbf58bf3dbf1c,0x3e5ebf7ebe06bf7a,0x3ee2bf72bd86bf7b,0x3f7fbe483f55bf29
.quad 0x3f7cbeaf3f25bf5e,0x3eaf3f5e3f5e3eaf,0x3f393f053f7ebea5,0xbf4e3f40bd863f7d,0xbe063f7e3f4b3ec4,0xbf4bbec4bf6d3f1c,0xbf603f393e1c3f66,0x3ebabf7fbf40bece
.quad 0xbf68bdb2bf133f77,0x3f7fbe853e85bf7f,0xbe48bf55bf7b3f0e,0x3e483f553f7bbf0e,0x3f2dbf74bf58be06,0xbf633f4b3f1c3eec,0x3f7ebebabe73bf40,0xbf31bea5bee23f80
.quad 0x3f7c3eaf3f253f5e,0x3eafbf5e3f5ebeaf,0x3ee23f72bd863f7b,0x3f7f3e483f553f29,0xbeec3f58bf3d3f1c,0x3e5e3f7ebe063f7a,0xbf7d3ddfbf80bd86,0xbf603ee2bf723e8f
.quad 0xbf35bf35bf35bf35,0xbf35bf35bf35bf35,0x3e1cbf7ebcb3bf7f,0x3ef6bf663ea5bf76,0x3f63bf0a3f2dbf4b,0x3f7a3e063f7ebe5e,0x3f663ea53f7fbe48,0x3d863f7b3f0e3f40
.quad 0x3e323f713f443f00,0xbf713f00bf003f71,0xbf313f5b3ddf3f72,0xbf17bf29bf7f3e1c,0xbf7e3e06bf1c3f6d,0x3f1cbf6dbec4bf4b,0xbef6bf31bf7d3ee2,0x3f6f3d863f29bf6a
.quad 0x3ed8bf7fbf52be85,0xbdb23f773f77bdb2,0x3f7bbf0ebe48bf55,0xbf7b3f0e3e483f55,0x3f3d3e9a3f0abf7e,0xbeecbf1cbf4b3f63,0xbddf3f6f3f79bf29,0x3f39bf72bf663cb3
.quad 0x3e323f80bf003f44,0x3f803e323f443f44,0xbf403f0ebf7b3d86,0x3e483f7fbea53f66,0xbf74bec4bf4bbf2d,0xbf6d3e9abf80bd33,0xbe73bf7bbd86bf80,0xbf0ebf5bbecebf6f
.quad 0x3f35bf353f35bf35,0x3f35bf353f35bf35,0x3f793e483f7f3cb3,0x3f553f053f6a3eba,0x3e9a3f6d3f1c3f3d,0xbec43f74bd333f80,0xbf293f55be483f7f,0xbf7bbd86bf723ee2
.quad 0xbf7c248dbf5e3f25,0xa554bf7cbf25bf25,0xbebabf55bf72bddf,0x3f7bbece3ef6bf76,0x3f1cbf6dbec4bf4b,0x3ec43f4b3f7ebe06,0x3f7ebe483ee2bf7d,0xbf553f483e733f5b
.quad 0x3ed83f353f77bf13,0xbf35bed8bf523f52,0xbf0e3f7b3f553e48,0x3f0ebf7bbf55be48,0xbf803ec43e063f58,0x3f6dbd333e5ebf7a,0xbef6bf0ebf293f79,0xbe483f763f7dbf17
.quad 0xbf7c8000bf5ebf25,0x80003f7cbf253f25,0xbf29bf55be48bf7f,0xbf7b3d86bf72bee2,0x3e9abf6d3f1cbf3d,0xbec4bf74bd33bf80,0x3f79be483f7fbcb3,0x3f55bf053f6abeba
.quad 0x3f353f353f353f35,0x3f353f353f353f35,0xbe733f7bbd863f80,0xbf0e3f5bbece3f6f,0xbf743ec4bf4b3f2d,0xbf6dbe9abf803d33,0xbf40bf0ebf7bbd86,0x3e48bf7fbea5bf66
.quad 0x3e32bf80bf00bf44,0x3f80be323f44bf44,0x3f6fbf0e3ea5bf7e,0x3e483f6a3f603e8f,0x3f4b3ec43f6dbf1c,0xbf6d3f1cbe063f7e,0xbddf3f7b3f663e1c,0xbf0ebf20bf793f05
.quad 0xbf683f353e853f52,0x3f35bf68bf13bf13,0xbf55be48bf0e3f7b,0x3f553e483f0ebf7b,0x3d33bf6dbf7e3f0a,0xbec43f803f7abe5e,0x3f60bf55bf40be73,0xbf7b3e8f3e1c3f4e
.quad 0x3f00bf443f71be32,0xbf44bf44be32bf80,0x3f7f3d063f693f07,0x3ed3bf593f50bef1,0x3f293f4e3eba3f76,0x3f7d3e733f603f0e,0xbe693f77bec93f67,0x3df53f7fbd5f3f7f
.quad 0xbf6d3ec4bf6d3ec4,0xbf6d3ec4bf6d3ec4,0xbf59befbbf6ebeaa,0xbf1ebf42bf3fbf22,0xbd86bf7dbecebf60,0x3f17bf5b3e8fbf7b,0x3f46bf3b3eb4bf79,0x3f703e693f7dbe95
.quad 0x3f773db23f68bf13,0xbdb23f7f3f133f35,0x3eb43f563f723df5,0xbf7c3ec9befb3f75,0xbf0e3f723ee23f40,0xbee2bf40bf7f3e48,0xbf803eaabe9f3f80,0x3f3fbf5cbebfbf46
.quad 0xbf1cbf0abf633f3d,0x3f583e5e3f2dbf6d,0x3e95bf7fbf753dc9,0xbe953f7f3f75bdc9,0x3f72bf31bef6bf17,0xbf803ece3e1c3f55,0x3f503e113e8abf7b,0xbe7ebf3fbf533f62
.quad 0x3f5e3f253eaf3f7c,0x3f25bf253f7ca50d,0x3dc93f80bed33f59,0x3f693f073f153f62,0xbf403f17bf6f3e8f,0xbe1c3f79bef63f55,0xbf79be8abf6bbedd,0xbf7e3d9cbf80bdc9
.quad 0xbec4bf6dbec4bf6d,0xbec4bf6dbec4bf6d,0x3f07bf5f3ebfbf72,0x3f49bf273f2bbf46,0x3f7fbe1c3f6abef6,0x3f4e3f053f763e48,0x3f223f2f3f703e69,0xbeb43f793e273f75
.quad 0xbe853f7f3ed83f52,0xbf7f3db2bf523f35,0xbf703f0cbeaa3f7e,0xbe3dbf6bbf5fbe95,0xbf55bea5bf663f29,0x3f66bf293d86bf7b,0xbd06bf72bf73bc33,0x3f2b3f023f6ebf22
.quad 0x3f4bbf58beecbf2d,0xbf0a3f7a3f3d3ec4,0x3f75bdc93e95bf7f,0xbf753dc9be953f7f,0x3ea53f393f60bf4e,0x3cb3bf6abf7d3f0e,0xbf153f7d3f77be53,0x3f78bf2bbf11bef1
.quad 0xbe323f71bf443f00,0x3f713f003f003f71,0xbf703e69bf7dbe95,0xbe273f75bf223f2f,0xbf48bf31bf05bf66,0xbf80bd86bf72bece,0x3e11bf7c3e9fbf70,0xbe53bf7dbd06bf80
.quad 0x3f6dbec43f6dbec4,0x3f6dbec43f6dbec4,0x3f4d3f113f643ed3,0x3f0c3f503f2f3f33,0xbddf3f803e733f72,0xbf393f40bee23f6f,0xbf693f07bf153f62,0xbf50bef1bf7f3d06
.quad 0xbf52bed8bf7f3e85,0x3ed8bf77be85bf68,0x3d9cbf7dbf37bf07,0x3f783d063f50bf3f,0x3f66bf293d86bf7b,0xbd863f7b3f553ea5,0x3f563e8a3f4dbf50,0xbf7e3ed3be693f7f
.quad 0xbd333f743f7abe06,0xbe9abf4bbf7e3eec,0xbf623f463ef13f22,0x3f62bf46bef1bf22,0xbf5bbddfbeba3f7f,0x3f203ee23f29bf76,0x3c33bf64bf723f3b,0xbf273f793f70bdf5
.quad 0xbf7cbeafbf25bf5e,0xbeaf3f5ebf5e3eaf,0xbeb4bf793e27bf75,0xbf7dbe95bf46bf3b,0x3f20bf393f5bbee2,0xbcb3bf7f3ea5bf6a,0x3f7d3e3d3f733eb4,0x3f7bbe273f803c33
.quad 0x3ec43f6d3ec43f6d,0x3ec43f6d3ec43f6d,0xbf1a3f53bee73f69,0xbf563f15bf3b3f37,0xbf7ebcb3bf793ea5,0xbf31bf29bf66beba,0xbed3bf59bf50bef1,0x3f15bf623dc9bf80
.quad 0x3f13bf68bdb2bf77,0x3f683e853f77bed8,0x3f7fbe113f33bf59,0xbe7e3f803f153f2b,0x3ee23f403f7fbe48,0xbf7f3e48bf0e3f72,0xbf0c3f773f1a3f15,0xbdf5bf69bf793d9c
.quad 0xbf803e9abe5e3f7e,0x3f74bf1cbe06bf63,0xbef1bf22bf623f46,0x3ef13f223f62bf46,0x3f05bf7ebf6f3d86,0xbf483f663f403e8f,0x3f80bee7beaabf2f,0xbf42be69beb43f7e
.quad 0x3e323f80bf003f44,0x3f803e323f443f44,0xbf7e248dbf6dbf00,0xbec43f5ebf4b3f00,0xbdb2bf803e85bf71,0xbf35bf44bed8bf71,0x3f80a5543f7e3e32,0x3f6dbeaf3f7abe32
.quad 0x248d3f80248d3f80,0x248d3f80248d3f80,0xbf80248dbf7e3e32,0xbf6dbeafbf7abe32,0x3db2bf80be85bf71,0x3f35bf443ed8bf71,0x3f7ea5543f6dbf00,0x3ec43f5e3f4b3f00
.quad 0xbe323f803f003f44,0xbf803e32bf443f44,0xbf7a248dbf4b3f44,0x3ec4bf7cbeecbf44,0x3e85bf80bf35bf00,0x3f353f003f77bf00,0x3f74a5543f1cbf71,0xbf6d3f253d333f71
.quad 0xbeaf3f803f5e3e32,0xa554bf71bf7c3e32,0xbf6d248dbec43f80,0x3f6da5543ec4bf80,0x3ed8bf80bf773e32,0xbf353f713f523e32,0x3f63a5543e06bf71,0xbec4bf25bf3d3f71
.quad 0xbf7c8000bf5ebf25,0x80003f7cbf253f25,0xbe06bf803ec4bf5e,0xbf6dbf00bf1cbf5e,0x3f7fa50d3f773eaf,0x3f35bf253f68beaf,0x3d333f80be063f7c,0x3ec43f713e5e3f7c
.quad 0xbf808000bf808000,0xbf808000bf808000,0x3d33bf80be06bf7c,0x3ec4bf713e5ebf7c,0x3f7fa50d3f77beaf,0x3f353f253f683eaf,0xbe063f803ec43f5e,0xbf6d3f00bf1c3f5e
.quad 0xbf7c8000bf5e3f25,0xa50dbf7cbf25bf25,0x3e5ebf80bf1cbf25,0x3f6d3e323f63bf25,0x3f77a50d3f35bf5e,0xbf353f5e3e853f5e,0xbe9a3f803f4b3eaf,0xbec4bf44bf803eaf
.quad 0xbf718000bf003f7c,0x3f80beaf3e32bf7c,0x3ec4bf80bf6d8000,0xbec43f803f6da50d,0x3f68a50d3e85bf7c,0xbf35beafbf133f7c,0xbeec3f803f7ebeaf,0x3f6dbf44bf2dbeaf
.quad 0xbf00bf713e32bf71,0xbf713e32bf71bf00,0x3f6dbe853f7e3e85,0x3e06bf773f1cbf35,0x3e853f7cbdb23f7c,0x3f523f253f133f5e,0xbf7e3db2bf80bdb2,0xbf633ed8bf743e85
.quad 0xa554bf80a554bf80,0xa554bf80a554bf80,0x3f7e3db23f80bdb2,0x3f633ed83f743e85,0xbe853f7c3db23f7c,0xbf523f25bf133f5e,0xbf6dbe85bf7e3e85,0xbe06bf77bf1cbf35
.quad 0x3f00bf71be32bf71,0x3f713e323f71bf00,0x3f4b3ed83f7abed8,0xbf3d3f523d333f77,0xbf353f5e3e853f5e,0xbe85bf5ebf77248d,0xbf1cbf13bf743f13,0x3f7abdb23f0abf77
.quad 0x3f5ebf44beafbf44,0xbf253f713f253f00,0x3ec43f353f6dbf35,0xbec4bf35bf6d3f35,0xbf773f253ed83f25,0x3f7fbeafbdb2bf5e,0xbe06bf52bf633f52,0xbf0a3f7f3f7abe85
.quad 0x3f5ebeaf3f7c3eaf,0xbeafbf7c3eafbf5e,0x3ec43f77be063f77,0x3f7e3e853f4b3f35,0xbf773e32bf7fbe32,0xbf133f44bf523f00,0xbe06bf7f3d33bf7f,0xbeecbf68be9abf77
.quad 0x3f80a50d3f80a50d,0x3f80a50d3f80a50d,0xbe063f7f3d333f7f,0xbeec3f68be9a3f77,0xbf77be32bf7f3e32,0xbf13bf44bf52bf00,0x3ec4bf77be06bf77,0x3f7ebe853f4bbf35
.quad 0x3f5e3eaf3f7cbeaf,0xbeaf3f7c3eaf3f5e,0xbf1c3f683e5e3f68,0xbf2dbf13bf803e85,0xbf35bf00bf773f00,0x3f77bf003e85bf80,0x3f4bbf52be9abf52,0xbe5e3f7f3f583e85
.quad 0x3f003f253f71bf25,0xbf44beafbf443f5e,0xbf6d3f353ec43f35,0x3f6dbf35bec4bf35,0xbe85bf44bf683f44,0xbdb23f713f7fbf00,0x3f7ebf13beecbf13,0xbf58bdb2be5e3f77
.quad 0xbe323f71bf443f00,0x3f713f003f003f71,0xbf79beb4bf3bbf46,0xbf2f3f22bf753e27,0x3e8fbf6f3f17bf40,0xbecebf72bd86bf80,0x3f723ebf3f5f3f07,0x3f803d063f7d3e53
.quad 0xbec43f6dbec43f6d,0xbec43f6dbec43f6d,0xbf67bec9bf77be69,0xbf33bf2fbf50bf0c,0x3ef6bf6a3e1cbf7f,0x3f6fbee23f40bf39,0x3f593ed33f80bdc9,0xbd063f7f3ef13f50
.quad 0xbf133f683db23f77,0xbf68be85bf773ed8,0xbf49beddbf7b3ed3,0x3f3fbf50bd06bf78,0x3f29bf66bea5bf55,0x3ea53f553f7bbd86,0x3f373ee73f67bf2f,0xbf7f3e69bed33f7e
.quad 0xbf3d3f633f0a3f1c,0x3eecbf7ebf4bbe9a,0xbf22bef1bf463f62,0x3f223ef13f46bf62,0x3f4ebf60bf39bea5,0xbf763f293ee23f20,0x3f0c3efb3f1abf7d,0x3df5bf70bf793f27
.quad 0xbf7cbeafbf25bf5e,0xbeaf3f5ebf5e3eaf,0x3e69bf703f2fbf22,0xbf3bbf46be95bf7d,0x3f763eba3f4e3f29,0x3f6abea53f7f3cb3,0xbeaa3f6ebefb3f59,0x3c333f80be273f7b
.quad 0xbf6dbec4bf6dbec4,0xbf6dbec4bf6dbec4,0x3eddbf6b3e8abf79,0x3f37bf3b3f15bf56,0x3f603ece3f7d3d86,0x3eba3f663f293f31,0xbf073f69bd063f7f,0xbf803dc9bf623f15
.quad 0xbf52bed8bf7f3e85,0x3ed8bf77be85bf68,0x3f1ebf67be53bf69,0x3f2b3f153f80be7e,0x3f403ee23f72bf0e,0xbf723f0ebe483f7f,0xbf333f643edd3f3b,0x3d9cbf79bf69bdf5
.quad 0xbf2dbeecbf583f4b,0x3f633e063f1cbf74,0x3f46bf62bf22bef1,0xbf463f623f223ef1,0x3f173ef63f31bf72,0xbe8fbf40bf663f48,0xbf563f5f3f4d3e27,0x3f7ebeb4be69bf42
.quad 0xbe32bf803f00bf44,0xbf80be32bf44bf44,0x3f803dc93f623f15,0x3ef1bf503f59bed3,0xbddf3f7bbee23f5b,0x3f0e3f603e733f7d,0xbf78be95bf69bee7,0xbf7f3d5fbf7fbdf5
.quad 0x3ec4bf6d3ec4bf6d,0x3ec4bf6d3ec4bf6d,0x3f5c3ef13f703e9f,0x3f223f3f3f423f1e,0xbf203f55bea53f79,0xbf7b3e8fbf5b3f17,0xbf2fbf22bf75be27,0x3e95bf7dbe69bf70
.quad 0x3f52bf353e85bf7f,0x3f353f133f7fbdb2,0x3ee73f463f793c33,0xbf753efbbec93f7c,0xbf723f0ebe483f7f,0x3e48bf7fbf40bee2,0xbe3dbf62bf7d3e11,0x3f463ebf3f5cbf3f
.quad 0x3f80bec43e06bf7a,0xbf6d3f2d3e5e3f58,0xbdc93f753f7fbe95,0x3dc9bf75bf7f3e95,0xbf793e48bd863f6f,0x3f553e1c3ecebf80,0x3ebfbf7fbf803edd,0xbf623f533f3f3e7e
.quad 0x3f7ca50d3f5e3f25,0xa50dbf7c3f25bf25,0x3d063f7fbef13f50,0x3f623f153f073f69,0xbf7ebe48bf66bf05,0xbf553ef6bf793e1c,0x3e7ebf753ed3bf64,0xbdc9bf803d9cbf7e
.quad 0x3f6d3ec43f6d3ec4,0x3f6d3ec43f6d3ec4,0xbf023f62beb43f73,0xbf463f2bbf273f49,0xbf48bf0ebf72be73,0xbe48bf76bf05bf4e,0x3f3bbf463e95bf7d,0x3f753e273f79beb4
.quad 0x3f133f353f773db2,0xbf353f52bdb23f7f,0xbf643f22be693f80,0xbe95bf5fbf6bbe3d,0xbea5bf55bf7b3d86,0x3f7bbd863f29bf66,0x3f7cbef13e27bf7d,0xbf223f6e3f023f2b
.quad 0x3d333f6d3f7ebe5e,0xbec4bf3dbf7a3f0a,0xbf7f3e95bdc93f75,0x3f7fbe953dc9bf75,0x3e73bf7bbf7f3eba,0xbf0e3f7d3f6abcb3,0x3f6ebdc93d06bf67,0xbef1bf11bf2b3f78
.quad 0xbf003f44bf713e32,0x3f443f443e323f80,0xbf55bf29bee2bf72,0xbf663ea5bf7fbe48,0x3f1cbf3d3f58beec,0xbd33bf803e9abf6d,0x3f403f313f203f4e,0x3f6f3ece3f5b3f0e
.quad 0xbf353f35bf353f35,0xbf353f35bf353f35,0xbf29bf39bf48bf17,0xbebabf6abf05bf55,0x3f4bbf2d3f0abf63,0x3f80bd333f74bec4,0x3f0e3f403f663ea5,0xbee23f723d863f7b
.quad 0xbf5e3f25beaf3f7c,0xbf25bf25bf7c248d,0xbee2bf48bf79bcb3,0x3f76bef63ecebf7b,0x3f6dbf1c3e06bf7e,0xbe063f7e3f4b3ec4,0x3ea53f4e3f80be8f,0xbf5bbe73bf483f55
.quad 0xbf773f133db23f68,0x3f52bf52bed8bf35,0xbe48bf55bf7b3f0e,0x3e483f553f7bbf0e,0x3f7ebf0abe9abf3d,0xbf7a3e5ebd333f6d,0x3d863f5b3f6abf48,0x3f17bf7dbf763e48
.quad 0xbf5ebf25beafbf7c,0xbf253f25bf7c8000,0x3f0ebf403f66bea5,0xbee2bf723d86bf7b,0x3f4b3f2d3f0a3f63,0x3f803d333f743ec4,0xbf293f39bf483f17,0xbeba3f6abf053f55
.quad 0xbf35bf35bf35bf35,0xbf35bf35bf35bf35,0x3f40bf313f20bf4e,0x3f6fbece3f5bbf0e,0x3f1c3f3d3f583eec,0xbd333f803e9a3f6d,0xbf553f29bee23f72,0xbf66bea5bf7f3e48
.quad 0xbf00bf44bf71be32,0x3f44bf443e32bf80,0x3f66bf203e73bf80,0x3e8f3f603f6a3e48,0x3ec43f4b3f7ebe06,0xbf7e3e06bf1c3f6d,0xbf723f17bcb33f76,0x3f05bf79bf20bf0e
.quad 0xbe85bf52bf7f3ed8,0x3f133f133f68bf35,0x3f7bbf0ebe48bf55,0xbf7b3f0e3e483f55,0x3e063f583f74bf2d,0x3e5ebf7abf803ec4,0xbf7f3f053ece3f20,0x3f4e3e1c3e8fbf7b
.quad 0x3e32bf713f44bf00,0xbf71bf00bf00bf71,0x3f723ee23f293f55,0x3f40bf0e3f7bbd86,0xbeec3f58bf3d3f1c,0x3e5e3f7ebe063f7a,0xbf4ebf20bf31bf40,0xbf76bea5bf66bef6
.quad 0x3f35bf353f35bf35,0x3f35bf353f35bf35,0x3f173f483f393f29,0x3e8f3f723ee23f60,0xbf633f0abf2d3f4b,0xbf7abe06bf7e3e5e,0xbea5bf66bf40bf0e,0x3f29bf553e48bf7f
.quad 0x3f7cbeaf3f25bf5e,0x3eaf3f5e3f5e3eaf,0x3cb33f793f483ee2,0xbf7d3d86bf403f4e,0xbf7e3e06bf1c3f6d,0x3f1cbf6dbec4bf4b,0x3e8fbf80bf4ebea5,0x3ece3f403f7fbeba
.quad 0x3f683db23f13bf77,0xbf7f3e85be853f7f,0xbf0e3f7b3f553e48,0x3f0ebf7bbf55be48,0xbf3dbe9abf0a3f7e,0x3eec3f1c3f4bbf63,0x3f48bf6abf5bbd86,0xbf803ee23ea53f31
.quad 0x3f7c3eaf3f253f5e,0x3eafbf5e3f5ebeaf,0xbea53f66bf403f0e,0x3f293f553e483f7f,0xbf63bf0abf2dbf4b,0xbf7a3e06bf7ebe5e,0x3f17bf483f39bf29,0x3e8fbf723ee2bf60
.quad 0x3f353f353f353f35,0x3f353f353f353f35,0xbf4e3f20bf313f40,0xbf763ea5bf663ef6,0xbeecbf58bf3dbf1c,0x3e5ebf7ebe06bf7a,0x3f72bee23f29bf55,0x3f403f0e3f7b3d86
.quad 0x3e323f713f443f00,0xbf713f00bf003f71,0xbf803e73bf203f66,0x3e1cbf7fbf29bf17,0x3e06bf7ebf4bbec4,0x3f4b3ec43f6dbf1c,0x3f76bcb33f17bf72,0xbf6a3f293d863f6f
.quad 0xbed83f7f3f523e85,0x3db2bf77bf773db2,0xbf55be48bf0e3f7b,0x3f553e483f0ebf7b,0x3f2dbf74bf58be06,0xbf633f4b3f1c3eec,0x3f203ece3f05bf7f,0x3cb3bf66bf723f39
.quad 0xbf443f00bf80be32,0x3f003f71be323f71,0xbf15bf62bdc9bf80,0xbf7fbd06bf69bf07,0x3f5bbee23f7bbddf,0x3ea5bf6a3f20bf39,0x3ee73f693e953f78,0x3f3b3f373f1a3f53
.quad 0xbf6d3ec4bf6d3ec4,0xbf6d3ec4bf6d3ec4,0xbe9fbf70bef1bf5c,0x3d06bf80be11bf7c,0x3f79bea53f55bf20,0x3f663eba3f7e3cb3,0x3e273f753f223f2f,0xbf463f3bbeb43f79
.quad 0xbf7f3e85bf353f52,0xbe85bf68bf52bed8,0xbc33bf79bf46bee7,0x3f7dbd5f3f42bf4d,0x3f7fbe483f0ebf72,0xbf0e3f723ee23f40,0xbe113f7d3f623e3d,0xbf07bf27bf7b3efb
.quad 0xbf7a3e06bec43f80,0x3f7ebeec3d33bf74,0x3e95bf7fbf753dc9,0xbe953f7f3f75bdc9,0x3f6fbd863e48bf79,0xbf40be8fbf053f7e,0xbedd3f803f7fbebf,0x3f69bf49bf33be9f
.quad 0xbf25bf5ea50dbf7c,0xbf5e3eafbf7cbeaf,0x3f50bef13f7f3d06,0xbdc9bf803ed3bf59,0x3f053f663e483f7e,0x3f723ece3f483f31,0xbf643ed3bf753e7e,0xbf2f3f33bf4d3f11
.quad 0xbec4bf6dbec4bf6d,0xbec4bf6dbec4bf6d,0x3f73beb43f62bf02,0x3f80bc333f7dbe3d,0x3e733f723f0e3f48,0xbee23f6fbddf3f80,0xbf7d3e95bf463f3b,0xbf22bf2fbf70be69
.quad 0xbdb2bf77bf35bf13,0x3f77bed83f13bf68,0x3f80be693f22bf64,0xbe273f803f273f1a,0xbd863f7b3f553ea5,0xbf55bea5bf663f29,0xbf7d3e27bef13f7c,0x3f59bf42be53bf5f
.quad 0x3e5ebf7ebf6dbd33,0x3e063f633f80be9a,0x3f75bdc93e95bf7f,0xbf753dc9be953f7f,0xbeba3f7f3f7bbe73,0x3f29bf76bf5bbddf,0xbf673d06bdc93f6e,0x3ed33f1e3f37bf73
.quad 0x3f00bf443f71be32,0xbf44bf44be32bf80,0x3f463f3b3eb43f79,0x3f70be693f7d3e95,0xbf403f17bf6f3e8f,0xbe1c3f79bef63f55,0xbf07bf5fbebfbf72,0xbf49bf27bf2bbf46
.quad 0x3f6dbec43f6dbec4,0x3f6dbec43f6dbec4,0x3e693f773ec93f67,0xbdf53f7f3d5f3f7f,0xbf7f3e1cbf6a3ef6,0xbf4ebf05bf76be48,0x3dc9bf80bed3bf59,0x3f69bf073f15bf62
.quad 0x3f773db23f68bf13,0xbdb23f7f3f133f35,0xbed33f7b3edd3f49,0xbf53bebfbf773ef1,0xbf55bea5bf663f29,0x3f66bf293d86bf7b,0x3f2fbf67bee7bf37,0xbd5f3f783f6b3dc9
.quad 0x3f1c3f0a3f63bf3d,0xbf58be5ebf2d3f6d,0xbf623f463ef13f22,0x3f62bf46bef1bf22,0xbea5bf39bf603f4e,0xbcb33f6a3f7dbf0e,0x3f7dbf1abefbbf0c,0xbf5cbd5fbe3d3f75
.quad 0x3f5e3f253eaf3f7c,0x3f25bf253f7ca50d,0xbf223f2fbf703e69,0x3eb43f79be273f75,0xbf29bf4ebebabf76,0xbf7dbe73bf60bf0e,0x3f59befb3f6ebeaa,0x3f1ebf423f3fbf22
.quad 0x3ec43f6d3ec43f6d,0x3ec43f6d3ec43f6d,0xbf793e8abf6b3edd,0xbf7ebd9cbf803dc9,0xbd86bf7dbecebf60,0x3f17bf5b3e8fbf7b,0x3f7fbd063f69bf07,0x3ed33f593f503ef1
.quad 0xbe853f7f3ed83f52,0xbf7f3db2bf523f35,0xbf69be53bf673f1e,0x3f11bf6ebe8abf62,0x3f0ebf72bee2bf40,0x3ee23f403f7fbe48,0x3f3b3edd3f64bf33,0xbf803e7ebec93f7f
.quad 0xbf4b3f583eec3f2d,0x3f0abf7abf3dbec4,0xbef1bf22bf623f46,0x3ef13f223f62bf46,0x3f72bf31bef6bf17,0xbf803ece3e1c3f55,0x3e273f4d3f5fbf56,0x3f02bf80bf7c3e95
.quad 0x3e32bf713f44bf00,0xbf71bf00bf00bf71,0x3f1c3f5e3e063f80,0x3f7ea5543f6d3f00,0xbf7fbe32bf68bf00,0xbf523f00bf773e32,0x3f3dbf253f58bf00,0x3eecbf5e3f1cbf44
.quad 0x248d3f80248d3f80,0x248d3f80248d3f80,0xbf3dbf25bf58bf00,0xbeecbf5ebf1cbf44,0x3f7fbe323f68bf00,0x3f523f003f773e32,0xbf1c3f5ebe063f80,0xbf7e248dbf6d3f00
.quad 0xbe32bf71bf44bf00,0x3f71bf003f00bf71,0x3f583eaf3f74bf00,0xbf2d3f5e3e063f71,0xbf773f00be853f80,0x3e85bf80bf35bf00,0x3eecbf7cbf2dbf00,0x3e5e3f5e3f7ebe32
.quad 0x3eaf3f443f7cbf00,0xbf25bf00bf5e3f44,0xbf6d248dbec43f80,0x3f6da5543ec4bf80,0x3f68bf44bf13bf00,0xbf7f3f003e853f44,0xbe9a3f7c3f80bf00,0x3f58bf5ebf4bbe32
.quad 0x3f7c3eaf3f253f5e,0x3eafbf5e3f5ebeaf,0xbf4b3f00bf7e8000,0x3e063f80bec43f5e,0x3db2bf7c3ed8bf5e,0xbf13bf5ebe85bf7c,0x3f2d3f443f0a3f5e,0x3f633f003f4b3f25
.quad 0xbf808000bf808000,0xbf808000bf808000,0x3f2dbf443f0abf5e,0x3f63bf003f4bbf25,0x3db23f7c3ed83f5e,0xbf133f5ebe853f7c,0xbf4bbf00bf7e8000,0x3e06bf80bec4bf5e
.quad 0x3f7cbeaf3f25bf5e,0x3eaf3f5e3f5e3eaf,0xbf0a3f713e9a3f5e,0xbf3dbf00bf7e3eaf,0xbe85bf5ebf778000,0x3f77a50d3f35bf5e,0x3f633e323f3dbf5e,0xbf7a3f00be063f7c
.quad 0xbf713f253e323f5e,0x3f44bf5ebf00bf25,0x3ec4bf80bf6d8000,0xbec43f803f6da50d,0x3ed83f253f52bf5e,0xbdb2bf5ebf773f25,0xbf743e323d333f5e,0x3f0a3f003f1cbf7c
.quad 0x3e323f80bf003f44,0x3f803e323f443f44,0xbf4bbf35bec4bf77,0xbf6d3e85bf7ebe85,0x3f7fa5543f773eaf,0x3f35bf253f68beaf,0xbf2d3f35bf4b3f13,0xbec43f68bf0a3f52
.quad 0xa554bf80a554bf80,0xa554bf80a554bf80,0x3f2d3f353f4b3f13,0x3ec43f683f0a3f52,0xbf7f248dbf773eaf,0xbf35bf25bf68beaf,0x3f4bbf353ec4bf77,0x3f6d3e853f7ebe85
.quad 0xbe323f803f003f44,0xbf803e32bf443f44,0xbf0abf35bf7e3db2,0x3f6dbf133e9abf7f,0x3f77a5543f35bf5e,0xbf353f5e3e853f5e,0xbf633f353e063f68,0x3ec4bf7fbf3dbed8
.quad 0x3eafbf80bf5ebe32,0x248d3f713f7cbe32,0x3ec43f353f6dbf35,0xbec4bf35bf6d3f35,0xbf68248dbe853f7c,0x3f353eaf3f13bf7c,0x3f74bf35bf1cbed8,0xbf6d3db2bd333f68
.quad 0xbf7c8000bf5ebf25,0x80003f7cbf253f25,0x3f1cbf353f6dbe85,0xbec4bf773e06bf77,0x3db23f80be853f71,0x3f353f443ed83f71,0xbf3dbf35bf1cbf52,0xbf6dbed8bf58bf13
.quad 0x3f80a50d3f80a50d,0x3f80a50d3f80a50d,0xbf3d3f35bf1c3f52,0xbf6d3ed8bf583f13,0x3db2bf80be85bf71,0x3f35bf443ed8bf71,0x3f1c3f353f6d3e85,0xbec43f773e063f77
.quad 0xbf7c8000bf5e3f25,0xa50dbf7cbf25bf25,0x3f58bf353e06bf7f,0x3ec43f523f743db2,0xbe853f803f353f00,0xbf35bf00bf773f00,0xbeecbf35bf7e3ed8,0x3f6d3db23f2dbf68
.quad 0x3f71a50d3f00bf7c,0xbf803eafbe323f7c,0xbf6d3f353ec43f35,0x3f6dbf35bec4bf35,0x3ed8bf80bf773e32,0xbf353f713f523e32,0x3e9a3f353f4bbf68,0x3ec4bf7fbf803ed8
.quad 0x3f00bf443f71be32,0xbf44bf44be32bf80,0x3e953f7dbe693f70,0x3f793eb43f3b3f46,0xbf66bf05bf31bf48,0xbf793e1cbf7ebe48,0x3f70be9f3f7cbe11,0x3f42bf1e3f5cbef1
.quad 0xbec43f6dbec43f6d,0xbec43f6dbec43f6d,0xbed3bf64bf11bf4d,0xbd9cbf7ebe7ebf75,0x3f723e733f80bddf,0x3f053f4e3f483f0e,0xbf623f15bf073f69,0xbf59bed3bf803dc9
.quad 0x3e85bf7fbed8bf52,0x3f7fbdb23f52bf35,0x3f073f373f7dbd9c,0xbf6e3f11be9f3f7f,0xbf7b3d86bf293f66,0x3f29bf66bea5bf55,0x3f50bf4dbe8abf56,0xbe7e3f803f533e95
.quad 0xbe063f7a3f74bd33,0xbe5ebf58bf803ec4,0xbf22bef1bf463f62,0x3f223ef13f46bf62,0x3f7fbebabddfbf5b,0xbf6a3cb3be733f7b,0xbf3b3f723f64bc33,0x3f80bf02bec9bf22
.quad 0x3f5e3f253eaf3f7c,0x3f25bf253f7ca50d,0xbf753e27bf79beb4,0xbe693f70bf2f3f22,0x3ee2bf5b3f39bf20,0xbe73bf7d3ddfbf7b,0x3eb43f733e3d3f7d,0x3f273f493f023f62
.quad 0xbf6dbec4bf6dbec4,0xbf6dbec4bf6dbec4,0x3f69bee73f53bf1a,0x3f7fbdf53f78be95,0xbea53f793cb33f7e,0xbf5b3f17bf203f55,0xbef1bf50bf59bed3,0x3f07bf693d06bf7f
.quad 0x3f773db23f68bf13,0xbdb23f7f3f133f35,0xbf593f33be113f7f,0xbebfbf53bf73bdc9,0x3e48bf7fbf40bee2,0x3f403ee23f72bf0e,0x3f153f1a3f77bf0c,0xbf783d5fbf113f75
.quad 0xbf7e3e5ebe9a3f80,0x3f7abf0abd33bf6d,0x3f46bf62bf22bef1,0xbf463f623f223ef1,0xbd863f6f3f7ebf05,0x3ecebf80bf793e48,0xbf2fbeaabee73f80,0x3d5f3f5c3f6bbf46
.quad 0xbe323f71bf443f00,0x3f713f003f003f71,0xbf07bf69bd06bf7f,0xbf80bdc9bf62bf15,0x3f763eba3f4e3f29,0x3f6abea53f7f3cb3,0xbf673ec9bf773e69,0xbf333f2fbf503f0c
.quad 0x3ec4bf6d3ec4bf6d,0x3ec4bf6d3ec4bf6d,0x3eaa3f6e3efb3f59,0xbc333f803e273f7b,0xbf60becebf7dbd86,0xbebabf66bf29bf31,0x3f79beb43f3bbf46,0x3f2f3f223f753e27
.quad 0xbf133f683db23f77,0xbf68be85bf773ed8,0xbdf5bf72bf56beb4,0x3f80be273f2fbf5c,0x3f403ee23f72bf0e,0xbf723f0ebe483f7f,0xbf803e9fbeaa3f80,0x3f42bf59beb4bf49
.quad 0x3f3dbf63bf0abf1c,0xbeec3f7e3f4b3e9a,0xbdc93f753f7fbe95,0x3dc9bf75bf7f3e95,0xbf17bef6bf313f72,0x3e8f3f403f66bf48,0x3f7bbe8abe11bf50,0xbf1ebed3bf073f7f
.quad 0xbf7cbeafbf25bf5e,0xbeaf3f5ebf5e3eaf,0x3f59bed33f803dc9,0xbd06bf7f3ef1bf50,0xbe8f3f6fbf173f40,0x3ece3f723d863f80,0xbeddbf6bbe8abf79,0xbf37bf3bbf15bf56
.quad 0x3f6d3ec43f6d3ec4,0x3f6d3ec43f6d3ec4,0xbf723ebfbf5f3f07,0xbf803d06bf7d3e53,0x3ef6bf6a3e1cbf7f,0x3f6fbee23f40bf39,0x3e693f703f2f3f22,0xbf3b3f46be953f7d
.quad 0xbf52bed8bf7f3e85,0x3ed8bf77be85bf68,0x3f7ebeaa3f0cbf70,0xbd5f3f7d3f3b3f02,0xbf293f663ea53f55,0xbea5bf55bf7b3d86,0xbc33bf73bf72bd06,0x3f273f073f70bf1e
.quad 0x3f2d3eec3f58bf4b,0xbf63be06bf1c3f74,0xbf7f3e95bdc93f75,0x3f7fbe953dc9bf75,0x3f4ebf60bf39bea5,0xbf763f293ee23f20,0xbe533f773f7dbf15,0x3f49bf69bf59bd9c
.quad 0x3f44bf003f803e32,0xbf00bf713e32bf71,0xbd863f7bbf0e3f40,0x3f553f293ee23f72,0xbf2dbf4bbec4bf74,0xbf7ebe5ebf63bf0a,0x3f803d863f7b3e73,0x3f72be8f3f7dbddf
.quad 0xbf353f35bf353f35,0xbf353f35bf353f35,0xbcb3bf7fbe48bf79,0x3ea5bf763e1cbf7e,0x3f3d3f1c3f6d3e9a,0x3e063f7a3eec3f58,0xbf7f3e48bf553f29,0xbf0ebf40bf66bea5
.quad 0x3f25bf5ea554bf7c,0x3f5e3eaf3f7cbeaf,0x3ddf3f723f553eba,0xbf7f3e1cbf313f5b,0xbf4bbec4bf6d3f1c,0x3f6dbf1c3e06bf7e,0x3f7dbee23e48bf7e,0xbf293f6a3ef63f31
.quad 0xbf133f773f353ed8,0x3e85bf7fbf68bdb2,0xbe48bf55bf7b3f0e,0x3e483f553f7bbf0e,0x3f583e063ec4bf80,0xbf1cbeecbf2d3f74,0xbf793f293f0e3ef6,0x3f66bcb33ddfbf6f
.quad 0x3f253f5e80003f7c,0x3f5ebeaf3f7c3eaf,0xbf7fbe48bf55bf29,0xbf0e3f40bf663ea5,0x3f3dbf1c3f6dbe9a,0x3e06bf7a3eecbf58,0xbcb33f7fbe483f79,0x3ea53f763e1c3f7e
.quad 0xbf35bf35bf35bf35,0xbf35bf35bf35bf35,0x3f80bd863f7bbe73,0x3f723e8f3f7d3ddf,0xbf2d3f4bbec43f74,0xbf7e3e5ebf633f0a,0xbd86bf7bbf0ebf40,0x3f55bf293ee2bf72
.quad 0x3f443f003f80be32,0xbf003f713e323f71,0xbf7e3ea5bf0e3f6f,0x3d86bf7dbf39bf05,0x3f1cbf6dbec4bf4b,0x3ec43f4b3f7ebe06,0x3e1c3f663f7bbddf,0xbf40becebf603f39
.quad 0xbf52be85bf353f68,0x3f77bdb23ed8bf7f,0x3f7bbf0ebe48bf55,0xbf7b3f0e3e483f55,0xbf0a3f7e3f6dbd33,0x3f4bbf63bf3dbe9a,0xbe73bf40bf553f60,0xbee23f803f7ebeba
.quad 0xbf003f44bf713e32,0x3f443f443e323f80,0xbe48bf7f3ea5bf66,0xbf72bee2bf29bf55,0x3f4b3f2d3f0a3f63,0x3f803d333f743ec4,0xbf7f3cb3bf7ebe1c,0xbf6a3ebabf793e48
.quad 0x3f35bf353f35bf35,0x3f35bf353f35bf35,0xbd863f803ddf3f7d,0xbece3f6fbe733f7b,0xbf1cbf3dbf58beec,0x3d33bf80be9abf6d,0x3f7b3d863f72bee2,0x3ea53f663f403f0e
.quad 0xbf5e3f25beaf3f7c,0xbf25bf25bf7c248d,0x3ea5bf7ebf05bf39,0x3f603e8f3f6fbf0e,0x3ec43f4b3f7ebe06,0xbf7e3e06bf1c3f6d,0xbf66be1cbf393f60,0x3f79bf053ddfbf7b
.quad 0x3f77bf13bdb2bf68,0xbf523f523ed83f35,0xbf0e3f7b3f553e48,0x3f0ebf7bbf55be48,0xbe06bf58bf743f2d,0xbe5e3f7a3f80bec4,0x3f403e733ebabf7e,0xbe1cbf4ebf603f55
.quad 0xbf5ebf25beafbf7c,0xbf253f25bf7c8000,0x3f7bbd863f723ee2,0x3ea5bf663f40bf0e,0xbf1c3f3dbf583eec,0x3d333f80be9a3f6d,0xbd86bf803ddfbf7d,0xbecebf6fbe73bf7b
.quad 0x3f353f353f353f35,0x3f353f353f353f35,0xbf7fbcb3bf7e3e1c,0xbf6abebabf79be48,0x3f4bbf2d3f0abf63,0x3f80bd333f74bec4,0xbe483f7f3ea53f66,0xbf723ee2bf293f55
.quad 0xbf00bf44bf71be32,0x3f44bf443e32bf80,0x3f723ddf3f5bbf31,0xbef63f763eba3f55,0xbf6d3f1cbe063f7e,0x3e06bf7ebf4bbec4,0x3ee2bf7dbf31bef6,0x3e733f5b3f7ebe48
.quad 0x3e853f523f7fbed8,0xbf13bf13bf683f35,0xbf55be48bf0e3f7b,0x3f553e483f0ebf7b,0x3f7ebf0abe9abf3d,0xbf7a3e5ebd333f6d,0xbf293f793f6fbddf,0x3f7dbf17bef6bf0e
.quad 0x3f71be323f713f00,0xbe32bf803f00bf44,0xbed33f59bf503ef1,0x3f153f623dc93f80,0xbebabf76bcb3bf7f,0xbf60bf0ebf29bf4e,0x3f6b3edd3f563f15,0x3f803dc93f793e8a
.quad 0xbf6d3ec4bf6d3ec4,0xbf6d3ec4bf6d3ec4,0x3ebfbf723e53bf7d,0x3f2bbf463f07bf5f,0x3ece3f603f313f29,0xbe8f3f7b3d863f7d,0xbf70be69bf7d3e95,0xbe27bf75bf22bf2f
.quad 0x3f68bf133ed8bf77,0x3f133f353f773db2,0xbeaa3f7e3f023f3b,0xbf5fbe95bf703f0c,0xbee2bf40bf7f3e48,0x3f7fbe483f0ebf72,0x3f733c333f1ebf70,0xbf6e3f223d063f72
.quad 0xbf633f3d3e9a3f4b,0x3f2dbf6dbf1cbf0a,0x3e95bf7fbf753dc9,0xbe953f7f3f75bdc9,0x3ef63f173f48bf66,0xbe1cbf55bf723f31,0xbf773e533d9c3f59,0x3f113ef13f15bf7d
.quad 0x3eaf3f7cbeaf3f5e,0x3f7ca50d3f5e3f25,0xbf69bf07bf15bf62,0xbf503ef1bf7fbd06,0x3f6fbe8f3f803d86,0x3ef6bf553f40bf17,0xbec93f67bf0c3f50,0xbd5f3f7fbe693f77
.quad 0xbec4bf6dbec4bf6d,0xbec4bf6dbec4bf6d,0x3f6e3eaa3f7b3e27,0x3f3f3f223f593efb,0xbf6a3ef6bf393f40,0xbf76be48bf7f3e1c,0x3eb4bf79be27bf75,0x3f7dbe953f46bf3b
.quad 0x3ed83f523f683e85,0xbf523f35be853f7f,0xbf72bdf5bf5c3f2f,0x3efbbf75beb4bf56,0x3f66bf293d86bf7b,0xbd863f7b3f553ea5,0xbe9f3f803f493eb4,0xbebfbf46bf803eaa
.quad 0xbeecbf2dbf743f1c,0x3f3d3ec43f4bbf58,0x3f75bdc93e95bf7f,0xbf753dc9be953f7f,0xbf603f4e3f203ee2,0x3f7dbf0ebea5bf39,0x3e8abf7bbf7f3f07,0xbf533f623f503e11
.quad 0xbf443f00bf80be32,0x3f003f71be323f71,0x3e27bf753f22bf2f,0xbf46bf3bbeb4bf79,0x3f053f663e483f7e,0x3f723ece3f483f31,0xbf73beb4bf62bf02,0xbf80bc33bf7dbe3d
.quad 0x3f6dbec43f6dbec4,0x3f6dbec43f6dbec4,0xbee73f69be953f78,0xbf3b3f37bf1a3f53,0xbe73bf72bf0ebf48,0x3ee2bf6f3ddfbf80,0x3f503ef13f7fbd06,0xbdc93f803ed33f59
.quad 0xbf7f3e85bf353f52,0xbe85bf68bf52bed8,0x3f33bf59bdc9bf73,0x3f153f2b3f7fbe11,0xbd863f7b3f553ea5,0xbf55bea5bf663f29,0xbf1abf15bf753f11,0x3f79bd9c3f0cbf77
.quad 0x3f7abe063ec4bf80,0xbf7e3eecbd333f74,0xbf623f463ef13f22,0x3f62bf46bef1bf22,0x3ebabf7fbf7b3e73,0xbf293f763f5b3ddf,0x3eaa3f2f3f46bf6b,0x3eb4bf7ebf803ee7
.quad 0xbf25bf5ea50dbf7c,0xbf5e3eafbf7cbeaf,0x3f7d3e953f463f3b,0x3f22bf2f3f70be69,0xbf5b3ee2bf7b3ddf,0xbea53f6abf203f39,0x3e9fbf703ef1bf5c,0xbd06bf803e11bf7c
.quad 0x3ec43f6d3ec43f6d,0x3ec43f6d3ec43f6d,0xbf64bed3bf75be7e,0xbf2fbf33bf4dbf11,0x3f79bea53f55bf20,0x3f663eba3f7e3cb3,0xbf153f62bdc93f80,0xbf7f3d06bf693f07
.quad 0xbdb2bf77bf35bf13,0x3f77bed83f13bf68,0x3f373f073f7fbe9f,0xbf503f3fbd9c3f7d,0xbf7f3e48bf0e3f72,0x3f0ebf72bee2bf40,0x3f4dbf50be95bf53,0xbe693f7f3f563e8a
.quad 0xbe5e3f7e3f6d3d33,0xbe06bf63bf803e9a,0xbef1bf22bf623f46,0x3ef13f223f62bf46,0x3f6fbd863e48bf79,0xbf40be8fbf053f7e,0xbf723f3b3f223ec9,0x3f70bdf53c33bf64
.quad 0xbf003f44bf713e32,0x3f443f443e323f80,0x3ec4bf5e3f4bbf00,0xbf1cbf5ebe06bf80,0xbe853f71bf133f44,0x3ed83f713db23f80,0x3e06bf7c3e9abf71,0xbe5ebf7cbd33bf80
.quad 0x248d3f80248d3f80,0x248d3f80248d3f80,0xbe06bf7cbe9abf71,0x3e5ebf7c3d33bf80,0x3e853f713f133f44,0xbed83f71bdb23f80,0xbec4bf5ebf4bbf00,0x3f1cbf5e3e06bf80
.quad 0x3f003f443f713e32,0xbf443f44be323f80,0xbf1cbf25bf803e32,0x3f63bf253e5ebf80,0x3f353f003f77bf00,0xbf773f00be853f80,0xbf4bbeafbf583f44,0x3f80beaf3e9abf80
.quad 0x3f5e3e323f25bf71,0xbf7c3e32beaf3f80,0xbf6d248dbec43f80,0x3f6da5543ec4bf80,0x3f77be323db2bf71,0xbf52be32bed83f80,0xbf7e3eaf3e5e3f44,0x3f2d3eaf3eecbf80
.quad 0xbf5ebf25beafbf7c,0xbf253f25bf7c8000,0x3f6d3f003f1c3f5e,0x3f4bbf003f7ea50d,0xbf77beafbf52bf25,0xbf683eafbf7f8000,0x3f7e3e323f743eaf,0x3f7abe323f80a50d
.quad 0xbf808000bf808000,0xbf808000bf808000,0x3f7ebe323f74beaf,0x3f7a3e323f80a50d,0xbf773eafbf523f25,0xbf68beafbf7f8000,0x3f6dbf003f1cbf5e,0x3f4b3f003f7ea50d
.quad 0xbf5e3f25beaf3f7c,0xbf25bf25bf7c8000,0x3f4bbf443d33bf7c,0x3eec3f443f7aa50d,0xbf353f5e3e853f5e,0xbe85bf5ebf778000,0x3f1cbf71bf0abf25,0x3d333f713f74a50d
.quad 0xbf003f7c3f443eaf,0x3e32bf7cbf718000,0x3ec4bf80bf6d8000,0xbec43f803f6da50d,0xbe853f7c3f7fbeaf,0x3f13bf7cbf688000,0x3e06bf71bf7a3f25,0xbf3d3f713f63a50d
.quad 0x3e32bf713f44bf00,0xbf71bf00bf00bf71,0xbe063f77bf1c3f35,0x3f4b3f353ec43f77,0x3db2bf7c3ed8bf5e,0xbf13bf5ebe85bf7c,0xbd333f7fbe5e3f77,0x3e9a3f773e063f7f
.quad 0xa554bf80a554bf80,0xa554bf80a554bf80,0x3d333f7f3e5e3f77,0xbe9a3f77be063f7f,0xbdb2bf7cbed8bf5e,0x3f13bf5e3e85bf7c,0x3e063f773f1c3f35,0xbf4b3f35bec43f77
.quad 0xbe32bf71bf44bf00,0x3f71bf003f00bf71,0x3e5e3f683f633e85,0xbf803e85bf1c3f68,0xbe85bf5ebf77248d,0x3f77a5543f35bf5e,0x3e9a3f523f80be85,0xbf58be85bf4b3f52
.quad 0xbeafbf44bf7c3f00,0x3f253f003f5ebf44,0x3ec43f353f6dbf35,0xbec4bf35bf6d3f35,0xbed8bf25bf523f5e,0x3db23f5e3f77bf25,0x3eec3f133f2dbf77,0x3e5ebf77bf7e3f13
.quad 0x3f7c3eaf3f253f5e,0x3eafbf5e3f5ebeaf,0xbf7ebe85bf4bbf35,0xbf1c3f35bf6d3e85,0x3f7f3e323f683f00,0x3f52bf003f77be32,0xbf80bdb2bf7abe85,0xbf743e85bf7e3db2
.quad 0x3f80a50d3f80a50d,0x3f80a50d3f80a50d,0xbf803db2bf7a3e85,0xbf74be85bf7ebdb2,0x3f7fbe323f68bf00,0x3f523f003f773e32,0xbf7e3e85bf4b3f35,0xbf1cbf35bf6dbe85
.quad 0x3f7cbeaf3f25bf5e,0x3eaf3f5e3f5e3eaf,0xbf7a3ed8beec3f77,0xbd33bf77bf4bbed8,0x3f77bf003e85bf80,0xbe853f803f353f00,0xbf743f13bd333f77,0x3f0abf77bf1cbf13
.quad 0x3f71bf25be32bf5e,0xbf443f5e3f003f25,0xbf6d3f353ec43f35,0x3f6dbf35bec4bf35,0x3f68bf44bf13bf00,0xbf7f3f003e853f44,0xbf633f523f3d3e85,0x3f7abe85be06bf52
.quad 0xbf443f00bf80be32,0x3f003f71be323f71,0x3f2fbf223f75be27,0xbe95bf7d3e69bf70,0xbf173f40bf553ef6,0x3d863f80be8f3f6f,0x3efbbf593f22bf3f,0x3e27bf7b3eaabf6e
.quad 0xbec43f6dbec43f6d,0xbec43f6dbec43f6d,0x3e8abf793dc9bf80,0x3f15bf563eddbf6b,0xbe1c3f7f3e483f76,0xbf403f39bef63f6a,0x3d06bf7fbef1bf50,0x3f62bf153f07bf69
.quad 0x3db23f773f353f13,0xbf773ed8bf133f68,0xbe53bf69bf62be8a,0x3f80be7e3f1ebf67,0x3ea53f553f7bbd86,0xbf7b3d86bf293f66,0xbeddbf3bbf7f3ec9,0x3f693df53f33bf64
.quad 0x3f0a3f1c3f6dbf2d,0xbf4bbe9abf3d3f63,0xbf22bef1bf463f62,0x3f223ef13f46bf62,0x3f393ea53f0ebf7d,0xbee2bf20bf4e3f60,0xbf4dbe27be953f7c,0x3e693f423f56bf5f
.quad 0xbf25bf5ea50dbf7c,0xbf5e3eafbf7cbeaf,0x3f3b3f463e953f7d,0x3f75be273f793eb4,0xbf4ebf29bf0ebf60,0xbf7fbcb3bf76beba,0x3f5f3f073f463f2b,0x3f7d3e533f723ebf
.quad 0xbf6dbec4bf6dbec4,0xbf6dbec4bf6dbec4,0x3f773e693f7f3d5f,0x3f503f0c3f673ec9,0xbf7dbd86bf7b3e8f,0xbf29bf31bf60bece,0x3f80bdc93f62bf15,0x3ef13f503f593ed3
.quad 0xbf7f3e85bf353f52,0xbe85bf68bf52bed8,0x3f7bbed33ef1bf77,0x3d063f783f493edd,0xbf723f0ebe483f7f,0x3e48bf7fbf40bee2,0x3f67bf2fbdc9bf6b,0xbed33f7e3f373ee7
.quad 0xbf583f4b3ec43f3d,0x3f1cbf74bf2dbeec,0x3f46bf62bf22bef1,0xbf463f623f223ef1,0xbf313f723f553e1c,0x3f66bf48bf17bef6,0x3f1abf7dbf753e3d,0xbf793f273f0c3efb
.quad 0x3f00bf443f71be32,0xbf44bf44be32bf80,0xbef13f50bf593ed3,0x3f073f693d063f7f,0x3ee2bf5b3f39bf20,0xbe73bf7d3ddfbf7b,0xbed33f64bf113f4d,0xbd9c3f7ebe7e3f75
.quad 0x3ec4bf6d3ec4bf6d,0x3ec4bf6d3ec4bf6d,0xbeb43f73be3d3f7d,0xbf273f49bf023f62,0x3ea5bf79bcb3bf7e,0x3f5bbf173f20bf55,0xbe953f7d3e693f70,0xbf793eb4bf3b3f46
.quad 0x3e85bf7fbed8bf52,0x3f7fbdb23f52bf35,0xbe693f803f1a3f27,0xbf6bbe3dbf643f22,0x3e48bf7fbf40bee2,0x3f403ee23f72bf0e,0xbe273f7d3f5f3e53,0xbf02bf2bbf7c3ef1
.quad 0x3e06bf7abf743d33,0x3e5e3f583f80bec4,0xbdc93f753f7fbe95,0x3dc9bf75bf7f3e95,0x3d86bf6fbf7e3f05,0xbece3f803f79be48,0xbd063f673f73bf37,0x3f2bbf78bf6e3dc9
.quad 0x3f5e3f253eaf3f7c,0x3f25bf253f7ca50d,0xbf62bf15bf07bf69,0xbf593ed3bf80bdc9,0x3f663f053f313f48,0x3f79be1c3f7e3e48,0xbf69bee7bf53bf1a,0xbf7fbdf5bf78be95
.quad 0x3f6d3ec43f6d3ec4,0x3f6d3ec43f6d3ec4,0xbf70be9fbf7cbe11,0xbf42bf1ebf5cbef1,0x3f723e733f80bddf,0x3f053f4e3f483f0e,0xbf75be27bf793eb4,0xbe69bf70bf2fbf22
.quad 0x3f773db23f68bf13,0xbdb23f7f3f133f35,0xbf79bc33bf4d3f42,0x3ec9bf7cbee7bf46,0x3f7bbd863f29bf66,0xbf293f663ea53f55,0xbf7d3e11befb3f7b,0x3f5cbf3fbe3dbf62
.quad 0x3f7ebe5e3e9abf80,0xbf7a3f0a3d333f6d,0xbf7f3e95bdc93f75,0x3f7fbe953dc9bf75,0x3f7fbebabddfbf5b,0xbf6a3cb3be733f7b,0xbf803edd3e9f3f33,0x3f3f3e7e3ebfbf7f
.quad 0xbf713e32bf71bf00,0x3e323f80bf003f44,0x3f66bea53f7f3e48,0x3d86bf7b3f0ebf40,0xbf583eecbf7a3e06,0xbe9a3f6dbf1c3f3d,0x3f48bf173f60bee2,0x3f05bf553f29bf39
.quad 0xbf353f35bf353f35,0xbf353f35bf353f35,0x3f20bf4e3ef6bf66,0x3f5bbf0e3f40bf31,0xbf0a3f63be5e3f7e,0xbf743ec4bf4b3f2d,0x3ee2bf72bd86bf7b,0x3f7fbe483f55bf29
.quad 0xbeaf3f7c3eaf3f5e,0xbf7c248dbf5e3f25,0x3e73bf80bf17bf29,0x3f6a3e483f66bf20,0xbe063f7e3f4b3ec4,0xbf4bbec4bf6d3f1c,0x3cb3bf76bf6fbd86,0x3f203f0e3f72bf17
.quad 0x3db23f683f7fbe85,0xbed8bf35bf773f13,0xbe48bf55bf7b3f0e,0x3e483f553f7bbf0e,0x3e9a3f3d3f63bf4b,0x3d33bf6dbf7e3f0a,0xbecebf20bf393f72,0xbe8f3f7b3f7fbf05
.quad 0xbeafbf7c3eafbf5e,0xbf7c8000bf5ebf25,0x3ee23f72bd863f7b,0x3f7f3e483f553f29,0xbf0abf63be5ebf7e,0xbf74bec4bf4bbf2d,0x3f203f4e3ef63f66,0x3f5b3f0e3f403f31
.quad 0xbf35bf35bf35bf35,0xbf35bf35bf35bf35,0x3f483f173f603ee2,0x3f053f553f293f39,0xbf58beecbf7abe06,0xbe9abf6dbf1cbf3d,0x3f663ea53f7fbe48,0x3d863f7b3f0e3f40
.quad 0xbf71be32bf713f00,0x3e32bf80bf00bf44,0x3f793cb33f4ebf40,0xbece3f7b3ee23f48,0xbf7e3e06bf1c3f6d,0x3f1cbf6dbec4bf4b,0x3f80be8f3ebabf7f,0xbf483f553ea53f4e
.quad 0xbf7f3ed8bdb23f77,0x3f68bf35be85bf52,0x3f7bbf0ebe48bf55,0xbf7b3f0e3e483f55,0xbf743f2d3eec3f1c,0x3f80bec4be06bf58,0x3f6abf48bf31bea5,0xbf763e483d863f5b
.quad 0x3f44bf003f803e32,0xbf00bf713e32bf71,0xbf403f0ebf7b3d86,0x3e483f7fbea53f66,0x3f3dbf1c3f6dbe9a,0x3e06bf7a3eecbf58,0xbf393f29bf553f05,0xbee23f60bf173f48
.quad 0x3f35bf353f35bf35,0x3f35bf353f35bf35,0xbf313f40bf0e3f5b,0xbf663ef6bf4e3f20,0x3f2dbf4b3ec4bf74,0x3f7ebe5e3f63bf0a,0xbf293f55be483f7f,0xbf7bbd86bf723ee2
.quad 0x3f25bf5ea554bf7c,0x3f5e3eaf3f7cbeaf,0xbf203f663e483f6a,0xbf29bf17bf803e73,0x3f1cbf6dbec4bf4b,0x3ec43f4b3f7ebe06,0xbf173f723f0e3f20,0xbd86bf6fbf763cb3
.quad 0x3f13bf77bf35bed8,0xbe853f7f3f683db2,0xbf0e3f7b3f553e48,0x3f0ebf7bbf55be48,0x3f0abf7ebf6d3d33,0xbf4b3f633f3d3e9a,0xbf053f7f3f7bbe8f,0x3f72bf39bf20bece
.quad 0x3f253f5e80003f7c,0x3f5ebeaf3f7c3eaf,0xbf29bf55be48bf7f,0xbf7b3d86bf72bee2,0x3f2d3f4b3ec43f74,0x3f7e3e5e3f633f0a,0xbf31bf40bf0ebf5b,0xbf66bef6bf4ebf20
.quad 0x3f353f353f353f35,0x3f353f353f353f35,0xbf39bf29bf55bf05,0xbee2bf60bf17bf48,0x3f3d3f1c3f6d3e9a,0x3e063f7a3eec3f58,0xbf40bf0ebf7bbd86,0x3e48bf7fbea5bf66
.quad 0x3f443f003f80be32,0xbf003f713e323f71,0xbf48bee2bf7b3ece,0x3f40bf4ebcb3bf79,0x3f4b3ec43f6dbf1c,0xbf6d3f1cbe063f7e,0xbf4ebea5bf553f48,0x3f7fbeba3e8fbf80
.quad 0x3f523e853f35bf68,0xbf773db2bed83f7f,0xbf55be48bf0e3f7b,0x3f553e483f0ebf7b,0x3f583e063ec4bf80,0xbf1cbeecbf2d3f74,0xbf5bbd86be483f76,0x3ea53f313f48bf6a
.quad 0xbf80be32bf44bf44,0xbe323f71bf443f00,0x3f7f3d063f693f07,0x3ed3bf593f50bef1,0xbf7b3ddfbf7dbe73,0xbf203f39bf5b3ee2,0x3f75be7e3f7ebd9c,0x3f4dbf113f64bed3
.quad 0xbf6d3ec4bf6d3ec4,0xbf6d3ec4bf6d3ec4,0x3f62bf023f49bf27,0x3f7dbe3d3f73beb4,0xbf553f20bf173f5b,0xbf7ebcb3bf793ea5,0x3f46bf3b3eb4bf79,0x3f703e693f7dbe95
.quad 0xbf353f52bdb23f7f,0xbf52bed8bf7f3e85,0x3f22bf64be3dbf6b,0x3f273f1a3f80be69,0xbf0e3f723ee23f40,0xbee2bf40bf7f3e48,0x3ef1bf7cbf2bbf02,0x3e533f5f3f7dbe27
.quad 0xbec43f803f583e5e,0x3d33bf74bf7a3e06,0x3e95bf7fbf753dc9,0xbe953f7f3f75bdc9,0xbe483f793f80bece,0x3f05bf7ebf6f3d86,0x3dc9bf6ebf783f2b,0xbf373f733f67bd06
.quad 0xa50dbf7c3f25bf25,0xbf7cbeafbf25bf5e,0x3dc93f80bed33f59,0x3f693f073f153f62,0xbe48bf7e3e1cbf79,0xbf48bf31bf05bf66,0x3e953f783df53f7f,0x3f1a3f533ee73f69
.quad 0xbec4bf6dbec4bf6d,0xbec4bf6dbec4bf6d,0x3ef13f5c3f1e3f42,0x3e113f7c3e9f3f70,0xbf0ebf48bf4ebf05,0x3ddfbf80be73bf72,0x3f223f2f3f703e69,0xbeb43f793e273f75
.quad 0xbf35bf13bf7f3db2,0x3f13bf68bdb2bf77,0x3f463ee73f7cbec9,0xbf423f4d3c333f79,0xbf55bea5bf663f29,0x3f66bf293d86bf7b,0x3f623e3d3f3fbf5c,0xbf7b3efbbe113f7d
.quad 0xbf6dbd33bf0a3f7a,0x3f80be9a3e5ebf7e,0x3f75bdc93e95bf7f,0xbf753dc9be953f7f,0xbf7b3e73bcb33f6a,0x3f5b3ddf3ebabf7f,0x3f7fbebfbe7ebf3f,0xbf33be9fbedd3f80
.quad 0x3f71be323f713f00,0xbe32bf803f00bf44,0xbf703e69bf7dbe95,0xbe273f75bf223f2f,0x3f6fbe8f3f803d86,0x3ef6bf553f40bf17,0xbf6e3eaabf7b3e27,0xbf3f3f22bf593efb
.quad 0x3f6dbec43f6dbec4,0x3f6dbec43f6dbec4,0xbf6b3eddbf563f15,0xbf803dc9bf793e8a,0x3f6abef63f39bf40,0x3f763e483f7fbe1c,0xbf693f07bf153f62,0xbf50bef1bf7f3d06
.quad 0x3f68bf133ed8bf77,0x3f133f353f773db2,0xbf673f1ebe7e3f80,0xbe8abf62bf69be53,0x3f66bf293d86bf7b,0xbd863f7b3f553ea5,0xbf643f333df53f69,0x3ec9bf7fbf3bbedd
.quad 0x3f63bf3dbe9abf4b,0xbf2d3f6d3f1c3f0a,0xbf623f463ef13f22,0x3f62bf46bef1bf22,0x3f60bf4ebf20bee2,0xbf7d3f0e3ea53f39,0xbf5f3f563f423e69,0x3f7cbe95be27bf4d
.quad 0x3eaf3f7cbeaf3f5e,0x3f7ca50d3f5e3f25,0xbeb4bf793e27bf75,0xbf7dbe95bf46bf3b,0x3eba3f763cb33f7f,0x3f603f0e3f293f4e,0xbebfbf72be53bf7d,0xbf2bbf46bf07bf5f
.quad 0x3ec43f6d3ec43f6d,0x3ec43f6d3ec43f6d,0xbec9bf67bf0cbf50,0xbd5fbf7fbe69bf77,0x3ece3f603f313f29,0xbe8f3f7b3d863f7d,0xbed3bf59bf50bef1,0x3f15bf623dc9bf80
.quad 0x3ed83f523f683e85,0xbf523f35be853f7f,0xbeddbf49bf78bd06,0x3f77bef13ed3bf7b,0x3ee23f403f7fbe48,0xbf7f3e48bf0e3f72,0xbee7bf37bf7e3ed3,0x3f6b3dc93f2fbf67
.quad 0x3eec3f2d3f74bf1c,0xbf3dbec4bf4b3f58,0xbef1bf22bf623f46,0x3ef13f223f62bf46,0x3ef63f173f48bf66,0xbe1cbf55bf723f31,0xbefbbf0cbf273f79,0xbe3d3f753f7dbf1a
.quad 0x3f44bf003f803e32,0xbf00bf713e32bf71,0xbf7e248dbf6dbf00,0xbec43f5ebf4b3f00,0x3f683f003f353f44,0x3f77be323f7f3e32,0xbf0abf5ebec4bf71,0xbf4bbf25bf2dbf44
.quad 0x248d3f80248d3f80,0x248d3f80248d3f80,0x3f0abf5e3ec4bf71,0x3f4bbf253f2dbf44,0xbf683f00bf353f44,0xbf77be32bf7f3e32,0x3f7ea5543f6dbf00,0x3ec43f5e3f4b3f00
.quad 0xbf44bf00bf803e32,0x3f00bf71be32bf71,0x3e9a3f5e3f6d3e32,0xbf7e3eafbf0a3f71,0x3e85bf80bf35bf00,0x3f353f003f77bf00,0xbf3d3f5e3ec43f44,0x3e06bf7cbf63be32
.quad 0x3f7cbf00a554bf71,0xbf5e3f443eaf3f44,0xbf6d248dbec43f80,0x3f6da5543ec4bf80,0x3f133f003f35bf71,0xbe85bf44bf683f44,0xbd33bf5ebf6d3f44,0xbf1c3f7c3f74be32
.quad 0x3f253f5e80003f7c,0x3f5ebeaf3f7c3eaf,0xbe06bf803ec4bf5e,0xbf6dbf00bf1cbf5e,0xbed83f5ebf353f25,0x3e853f7cbdb23f7c,0x3f58bf003f6dbeaf,0x3f1cbf443f3dbf25
.quad 0xbf808000bf808000,0xbf808000bf808000,0x3f583f003f6d3eaf,0x3f1c3f443f3d3f25,0xbed8bf5ebf35bf25,0x3e85bf7cbdb2bf7c,0xbe063f803ec43f5e,0xbf6d3f00bf1c3f5e
.quad 0x3f25bf5ea50dbf7c,0x3f5e3eaf3f7cbeaf,0xbf743f00bec43f7c,0xbe06bf71bf58beaf,0x3f77a50d3f35bf5e,0xbf353f5e3e853f5e,0xbf2dbf00bf6d3f25,0x3f7ebe323eecbf7c
.quad 0x3e323f5e3f80beaf,0xbf00bf25bf713f25,0x3ec4bf80bf6d8000,0xbec43f803f6da50d,0xbf523f5e3f353eaf,0x3f77bf25bed8bf25,0x3f80bf00bec4bf25,0xbf4bbe32be9a3f7c
.quad 0xbf003f44bf713e32,0x3f443f443e323f80,0x3f6dbe853f7e3e85,0x3e06bf773f1cbf35,0xbf77beafbf52bf25,0xbf683eafbf7f248d,0x3f1c3f523eec3f68,0x3f583f133f3d3f35
.quad 0xa554bf80a554bf80,0xa554bf80a554bf80,0xbf1c3f52beec3f68,0xbf583f13bf3d3f35,0x3f77beaf3f52bf25,0x3f683eaf3f7fa554,0xbf6dbe85bf7e3e85,0xbe06bf77bf1cbf35
.quad 0x3f003f443f713e32,0xbf443f44be323f80,0x3e06bf7fbf2dbf13,0x3f743db23f58bf35,0xbf353f5e3e853f5e,0xbe85bf5ebf77248d,0x3f7ebed83e5ebf7f,0xbf2d3f683eec3f35
.quad 0xbf5ebe32bf253f71,0x3f7cbe323eafbf80,0x3ec43f353f6dbf35,0xbec4bf35bf6d3f35,0x3e85bf7cbf7f3eaf,0xbf133f7c3f68a554,0xbf4b3f683f583db2,0x3f80bed8be9abf35
.quad 0xbf5ebf25beafbf7c,0xbf253f25bf7c8000,0x3ec43f77be063f77,0x3f7e3e853f4b3f35,0x3e85bf713f13bf44,0xbed8bf71bdb2bf80,0xbf4b3f13bf633ed8,0xbf0a3f52bf2d3f35
.quad 0x3f80a50d3f80a50d,0x3f80a50d3f80a50d,0xbf4bbf13bf63bed8,0xbf0abf52bf2dbf35,0x3e853f713f133f44,0xbed83f71bdb23f80,0x3ec4bf77be06bf77,0x3f7ebe853f4bbf35
.quad 0xbf5e3f25beaf3f7c,0xbf25bf25bf7c8000,0x3f7ebdb23f3dbf52,0xbe9a3f7f3f0a3f35,0xbf35bf00bf773f00,0x3f77bf003e85bf80,0x3e063f683f7abdb2,0xbf3dbed8bf633f35
.quad 0x3f00bf7cbf44beaf,0xbe323f7c3f71a50d,0xbf6d3f353ec43f35,0x3f6dbf35bec4bf35,0x3f77be323db2bf71,0xbf52be32bed83f80,0xbf1cbed8bf0a3f7f,0xbd333f683f74bf35
.quad 0x3f71be323f713f00,0xbe32bf803f00bf44,0xbf79beb4bf3bbf46,0xbf2f3f22bf753e27,0x3f313f483ece3f72,0x3f7e3e483f663f05,0xbe3dbf7dbc33bf80,0xbf02bf62beb4bf73
.quad 0xbec43f6dbec43f6d,0xbec43f6dbec43f6d,0x3f53bf1a3f37bf3b,0x3f78be953f69bee7,0xbf803ddfbf6f3ee2,0xbf48bf0ebf72be73,0x3f593ed33f80bdc9,0xbd063f7f3ef13f50
.quad 0xbed8bf52bf68be85,0x3f52bf353e85bf7f,0xbe113f7f3f2b3f15,0xbf73bdc9bf593f33,0x3f29bf66bea5bf55,0x3ea53f553f7bbd86,0xbf773f0cbd9c3f79,0x3f11bf75bf15bf1a
.quad 0x3f74bd333eecbf7e,0xbf803ec4be063f7a,0xbf22bef1bf463f62,0x3f223ef13f46bf62,0x3ddf3f5b3f76bf29,0x3e73bf7bbf7f3eba,0x3ee7bf80bf7e3eb4,0xbf6b3f463f2f3eaa
.quad 0x3eaf3f7cbeaf3f5e,0x3f7ca50d3f5e3f25,0x3e69bf703f2fbf22,0xbf3bbf46be95bf7d,0xbf393f20bf6a3ea5,0xbddf3f7bbee23f5b,0x3f7cbe113f803d06,0x3f5cbef13f70be9f
.quad 0xbf6dbec4bf6dbec4,0xbf6dbec4bf6dbec4,0x3f113f4d3f333f2f,0x3e7e3f753ed33f64,0xbcb3bf7ebebabf66,0x3f20bf553ea5bf79,0xbf073f69bd063f7f,0xbf803dc9bf623f15
.quad 0x3f68bf133ed8bf77,0x3f133f353f773db2,0xbf7d3d9cbf3f3f50,0x3e9fbf7fbf07bf37,0x3f403ee23f72bf0e,0xbf723f0ebe483f7f,0xbe8abf56bf7f3e69,0x3f533e953f50bf4d
.quad 0xbe9a3f803f633e06,0xbd33bf6dbf7e3e5e,0x3f46bf62bf22bef1,0xbf463f623f223ef1,0xbf7e3f053e8f3f40,0x3f79be483d86bf6f,0x3f64bc333df5bf70,0xbec9bf22bf3b3f72
.quad 0xbf443f00bf80be32,0x3f003f71be323f71,0x3f803dc93f623f15,0x3ef1bf503f59bed3,0xbf4ebf29bf0ebf60,0xbf7fbcb3bf76beba,0x3e8a3f793dc93f80,0x3f153f563edd3f6b
.quad 0x3ec4bf6d3ec4bf6d,0x3ec4bf6d3ec4bf6d,0xbf5f3f07bf463f2b,0xbf7d3e53bf723ebf,0x3f7d3d863f7bbe8f,0x3f293f313f603ece,0xbf2fbf22bf75be27,0x3e95bf7dbe69bf70
.quad 0x3db23f773f353f13,0xbf773ed8bf133f68,0x3f0cbf70be95bf5f,0x3f3b3f023f7ebeaa,0xbf723f0ebe483f7f,0x3e48bf7fbf40bee2,0x3f723d063f22bf6e,0xbf703f1e3c333f73
.quad 0xbf0abf1cbf6d3f2d,0x3f4b3e9a3f3dbf63,0xbdc93f753f7fbe95,0x3dc9bf75bf7f3e95,0x3f31bf72bf55be1c,0xbf663f483f173ef6,0xbf7d3f153ef13f11,0x3f593d9c3e53bf77
.quad 0xbf25bf5ea50dbf7c,0xbf5e3eafbf7cbeaf,0x3d063f7fbef13f50,0x3f623f153f073f69,0x3f17bf403f55bef6,0xbd86bf803e8fbf6f,0xbf773e69bf7f3d5f,0xbf503f0cbf673ec9
.quad 0x3f6d3ec43f6d3ec4,0x3f6d3ec43f6d3ec4,0xbefbbf59bf22bf3f,0xbe27bf7bbeaabf6e,0xbe1c3f7f3e483f76,0xbf403f39bef63f6a,0x3f3bbf463e95bf7d,0x3f753e273f79beb4
.quad 0xbf7f3e85bf353f52,0xbe85bf68bf52bed8,0x3f563eb43f75befb,0xbf2f3f5c3df53f72,0xbea5bf55bf7b3d86,0x3f7bbd863f29bf66,0xbeaa3f803f463ebf,0xbeb4bf49bf803e9f
.quad 0x3f58bf4bbec4bf3d,0xbf1c3f743f2d3eec,0xbf7f3e95bdc93f75,0x3f7fbe953dc9bf75,0x3f393ea53f0ebf7d,0xbee2bf20bf4e3f60,0xbe11bf50bf623f53,0xbf073f7f3f7bbe8a
.quad 0x3f803e323f443f44,0x3e32bf713f44bf00,0xbf55bf29bee2bf72,0xbf663ea5bf7fbe48,0x3ec43f743d333f80,0x3f633f0a3f2d3f4b,0x3e48bf793ebabf6a,0xbe1cbf7e3cb3bf7f
.quad 0xbf353f35bf353f35,0xbf353f35bf353f35,0x3f7bbe733f6fbece,0x3f7d3ddf3f80bd86,0xbf6dbe9abf803d33,0xbeecbf58bf3dbf1c,0x3f0e3f403f663ea5,0xbee23f723d863f7b
.quad 0xa554bf7cbf25bf25,0x3f7cbeaf3f25bf5e,0xbf0e3f6f3e8f3f60,0xbf39bf05bf7e3ea5,0x3f6dbf1c3e06bf7e,0xbe063f7e3f4b3ec4,0xbf7b3ddfbf053f79,0x3f60bf39be1cbf66
.quad 0x3f353ed83f52bf52,0xbf68bdb2bf133f77,0xbe48bf55bf7b3f0e,0x3e483f553f7bbf0e,0xbec43f803f7abe5e,0x3f2dbf74bf58be06,0x3f55bf60bf4ebe1c,0xbf7e3eba3e733f40
.quad 0x80003f7cbf253f25,0x3f7c3eaf3f253f5e,0x3f0ebf403f66bea5,0xbee2bf723d86bf7b,0xbf6d3e9abf80bd33,0xbeec3f58bf3d3f1c,0x3f7b3e733f6f3ece,0x3f7dbddf3f803d86
.quad 0xbf35bf35bf35bf35,0xbf35bf35bf35bf35,0x3e483f793eba3f6a,0xbe1c3f7e3cb33f7f,0x3ec4bf743d33bf80,0x3f63bf0a3f2dbf4b,0xbf553f29bee23f72,0xbf66bea5bf7f3e48
.quad 0x3f80be323f44bf44,0x3e323f713f443f00,0xbf55bebabf763ef6,0x3f31bf5bbddfbf72,0x3ec43f4b3f7ebe06,0xbf7e3e06bf1c3f6d,0x3e48bf7ebf5bbe73,0x3ef63f313f7dbee2
.quad 0xbf353f683f133f13,0x3ed8bf7fbf52be85,0x3f7bbf0ebe48bf55,0xbf7b3f0e3e483f55,0xbf6d3d33be5e3f7a,0x3f3d3e9a3f0abf7e,0x3f0e3ef63f17bf7d,0x3ddfbf6fbf793f29
.quad 0xbf713e32bf71bf00,0x3e323f80bf003f44,0x3f723ee23f293f55,0x3f40bf0e3f7bbd86,0xbf0abf63be5ebf7e,0xbf74bec4bf4bbf2d,0xbddf3f7dbe8f3f72,0x3e733f7b3d863f80
.quad 0x3f35bf353f35bf35,0x3f35bf353f35bf35,0xbf7e3e1cbf763ea5,0xbf79be48bf7fbcb3,0x3f583eec3f7a3e06,0x3e9a3f6d3f1c3f3d,0xbea5bf66bf40bf0e,0x3f29bf553e48bf7f
.quad 0xbeaf3f7c3eaf3f5e,0xbf7c248dbf5e3f25,0x3f5bbf313e1cbf7f,0x3eba3f553f723ddf,0xbf7e3e06bf1c3f6d,0x3f1cbf6dbec4bf4b,0x3f313ef63f6abf29,0xbf7e3e48bee23f7d
.quad 0xbdb2bf68bf7f3e85,0x3ed83f353f77bf13,0xbf0e3f7b3f553e48,0x3f0ebf7bbf55be48,0x3f74bf2dbeecbf1c,0xbf803ec43e063f58,0xbf6f3ddfbcb33f66,0x3ef63f0e3f29bf79
.quad 0xbeafbf7c3eafbf5e,0xbf7c8000bf5ebf25,0xbea53f66bf403f0e,0x3f293f553e483f7f,0x3f58beec3f7abe06,0x3e9abf6d3f1cbf3d,0xbf7ebe1cbf76bea5,0xbf793e48bf7f3cb3
.quad 0x3f353f353f353f35,0x3f353f353f353f35,0xbddfbf7dbe8fbf72,0x3e73bf7b3d86bf80,0xbf0a3f63be5e3f7e,0xbf743ec4bf4b3f2d,0x3f72bee23f29bf55,0x3f403f0e3f7b3d86
.quad 0xbf71be32bf713f00,0x3e32bf80bf00bf44,0x3f053f393f7dbd86,0xbf6f3f0ebea53f7e,0x3e06bf7ebf4bbec4,0x3f4b3ec43f6dbf1c,0xbf393f603ece3f40,0x3ddfbf7bbf66be1c
.quad 0x3f7fbed83db2bf77,0xbf683f353e853f52,0xbf55be48bf0e3f7b,0x3f553e483f0ebf7b,0x3e9a3f3d3f63bf4b,0x3d33bf6dbf7e3f0a,0x3ebabf7ebf803ee2,0xbf603f553f403e73
.quad 0x3f713f003f003f71,0x3f00bf443f71be32,0xbf15bf62bdc9bf80,0xbf7fbd06bf69bf07,0x3cb33f7fbea53f6a,0x3f293f4e3eba3f76,0x3f0cbf503f2fbf33,0x3e69bf773ec9bf67
.quad 0xbf6d3ec4bf6d3ec4,0xbf6d3ec4bf6d3ec4,0x3f7b3e273f80bc33,0x3f593efb3f6e3eaa,0xbf31bf29bf66beba,0xbd86bf7dbecebf60,0x3e273f753f223f2f,0xbf463f3bbeb43f79
.quad 0x3ed8bf77be85bf68,0x3f773db23f68bf13,0xbf5c3f2fbe273f80,0xbeb4bf56bf72bdf5,0x3f7fbe483f0ebf72,0xbf0e3f723ee23f40,0xbf49beb4bf593f42,0x3f80beaa3e9fbf80
.quad 0x3e9a3f4b3f7ebeec,0xbf1cbf0abf633f3d,0x3e95bf7fbf753dc9,0xbe953f7f3f75bdc9,0xbf483f663f403e8f,0x3f72bf31bef6bf17,0x3f7fbf07bed3bf1e,0xbf50be11be8a3f7b
.quad 0xbeaf3f5ebf5e3eaf,0x3f5e3f253eaf3f7c,0x3f50bef13f7f3d06,0xbdc9bf803ed3bf59,0xbf80bd86bf72bece,0xbf403f17bf6f3e8f,0x3f563f153f3b3f37,0x3f793e8a3f6b3edd
.quad 0xbec4bf6dbec4bf6d,0xbec4bf6dbec4bf6d,0xbe533f7dbd063f80,0xbf073f5fbebf3f72,0x3f39bf403ee2bf6f,0x3f7fbe1c3f6abef6,0xbf7d3e95bf463f3b,0xbf22bf2fbf70be69
.quad 0x3f683e853f77bed8,0xbe853f7f3ed83f52,0xbf02bf3bbf7d3d5f,0x3f70bf0c3eaabf7e,0xbd863f7b3f553ea5,0xbf55bea5bf663f29,0x3f1ebf70bf07bf27,0x3d063f723f733c33
.quad 0xbf743f1c3e063f63,0x3f4bbf58beecbf2d,0x3f75bdc93e95bf7f,0xbf753dc9be953f7f,0xbf20bee2bf293f76,0x3ea53f393f60bf4e,0x3d9c3f593f69bf49,0x3f15bf7dbf773e53
.quad 0xbf80be32bf44bf44,0xbe323f71bf443f00,0x3f463f3b3eb43f79,0x3f70be693f7d3e95,0xbe48bf7e3e1cbf79,0xbf48bf31bf05bf66,0xbef13f5cbf1e3f42,0xbe113f7cbe9f3f70
.quad 0x3f6dbec43f6dbec4,0x3f6dbec43f6dbec4,0xbf75be7ebf7ebd9c,0xbf4dbf11bf64bed3,0x3f0e3f483f4e3f05,0xbddf3f803e733f72,0x3dc9bf80bed3bf59,0x3f69bf073f15bf62
.quad 0xbf353f52bdb23f7f,0xbf52bed8bf7f3e85,0x3f7fbe9f3f11bf6e,0xbd9c3f7d3f373f07,0xbf55bea5bf663f29,0x3f66bf293d86bf7b,0x3e953f533f80be7e,0xbf56be8abf4d3f50
.quad 0x3ec4bf80bf58be5e,0xbd333f743f7abe06,0xbf623f463ef13f22,0x3f62bf46bef1bf22,0x3f7bbe733cb3bf6a,0xbf5bbddfbeba3f7f,0xbf22bec9bf023f80,0xbc333f643f72bf3b
.quad 0xa50dbf7c3f25bf25,0xbf7cbeafbf25bf5e,0xbf223f2fbf703e69,0x3eb43f79be273f75,0x3f7bbddf3f7d3e73,0x3f20bf393f5bbee2,0xbf62bf02bf49bf27,0xbf7dbe3dbf73beb4
.quad 0x3ec43f6d3ec43f6d,0x3ec43f6d3ec43f6d,0x3e95bf783df5bf7f,0x3f1abf533ee7bf69,0xbf553f20bf173f5b,0xbf7ebcb3bf793ea5,0x3f7fbd063f69bf07,0x3ed33f593f503ef1
.quad 0xbf35bf13bf7f3db2,0x3f13bf68bdb2bf77,0x3dc93f733f533ebf,0xbf7f3e11bf333f59,0x3f0ebf72bee2bf40,0x3ee23f403f7fbe48,0xbf753f11bd5f3f78,0x3f0cbf77bf1abf15
.quad 0x3f6d3d333f0abf7a,0xbf803e9abe5e3f7e,0xbef1bf22bf623f46,0x3ef13f223f62bf46,0xbe483f793f80bece,0x3f05bf7ebf6f3d86,0x3f46bf6bbf5cbd5f,0xbf803ee73eaa3f2f
.quad 0xbf713e32bf71bf00,0x3e323f80bf003f44,0x3f1c3f5e3e063f80,0x3f7ea5543f6d3f00,0x3f13bf443f52bf00,0xbdb2bf803e85bf71,0xbf74beafbf63bf00,0xbf80248dbf7ebe32
.quad 0x248d3f80248d3f80,0x248d3f80248d3f80,0x3f74beaf3f63bf00,0x3f80a5543f7ebe32,0xbf13bf44bf52bf00,0x3db2bf80be85bf71,0xbf1c3f5ebe063f80,0xbf7e248dbf6d3f00
.quad 0x3f713e323f71bf00,0xbe323f803f003f44,0x3d33bf7cbf3dbf00,0x3f7aa5543f4bbf44,0xbf773f00be853f80,0x3e85bf80bf35bf00,0x3f0a3f253f7abf00,0xbf74248dbf1c3f71
.quad 0x3f25bf71bf25bf00,0xbeaf3f803f5e3e32,0xbf6d248dbec43f80,0x3f6da5543ec4bf80,0xbdb23f713f7fbf00,0x3ed8bf80bf773e32,0x3f7abf25bf0abf00,0xbf63248dbe063f71
.quad 0xbeafbf7c3eafbf5e,0xbf7c8000bf5ebf25,0xbf4b3f00bf7e8000,0x3e063f80bec43f5e,0x3f523f253f133f5e,0x3f7fa50d3f773eaf,0x3e9abf713eecbf5e,0xbd33bf803e06bf7c
.quad 0xbf808000bf808000,0xbf808000bf808000,0x3e9a3f713eec3f5e,0xbd333f803e063f7c,0x3f52bf253f13bf5e,0x3f7fa50d3f77beaf,0xbf4bbf00bf7e8000,0x3e06bf80bec4bf5e
.quad 0xbeaf3f7c3eaf3f5e,0xbf7c8000bf5e3f25,0x3f80be323f2dbf5e,0xbe5e3f803f1c3f25,0xbe85bf5ebf778000,0x3f77a50d3f35bf5e,0xbf583f443e5e3f5e,0x3e9abf80bf4bbeaf
.quad 0x3f443eaf3f44bf5e,0xbf718000bf003f7c,0x3ec4bf80bf6d8000,0xbec43f803f6da50d,0xbf7f3eaf3db23f5e,0x3f68a50d3e85bf7c,0x3e5e3f443f58bf5e,0x3eecbf80bf7e3eaf
.quad 0x3f44bf003f803e32,0xbf00bf713e32bf71,0xbf4bbf35bec4bf77,0xbf6d3e85bf7ebe85,0xbed83f5ebf353f25,0x3e853f7cbdb23f7c,0x3f7a3e853f6d3ed8,0x3f7ebdb23f803db2
.quad 0xa554bf80a554bf80,0xa554bf80a554bf80,0xbf7a3e85bf6d3ed8,0xbf7ebdb2bf803db2,0x3ed83f5e3f353f25,0xbe853f7c3db23f7c,0x3f4bbf353ec4bf77,0x3f6d3e853f7ebe85
.quad 0xbf44bf00bf803e32,0x3f00bf71be32bf71,0xbeec3f773ec43f52,0xbf4bbed8bf7a3ed8,0x3f77a5543f35bf5e,0xbf353f5e3e853f5e,0x3d33bf77bf6dbdb2,0x3f1c3f133f74bf13
.quad 0xbf7c3f00248d3f71,0x3f5ebf44beafbf44,0x3ec43f353f6dbf35,0xbec4bf35bf6d3f35,0x3f52bf5ebf35beaf,0xbf773f253ed83f25,0xbf3dbe85bec43f7f,0x3e063f523f63bf52
.quad 0x3f253f5e80003f7c,0x3f5ebeaf3f7c3eaf,0x3f1cbf353f6dbe85,0xbec4bf773e06bf77,0xbf68bf00bf35bf44,0xbf773e32bf7fbe32,0xbe5e3f77bec43f68,0x3e063f7fbd333f7f
.quad 0x3f80a50d3f80a50d,0x3f80a50d3f80a50d,0xbe5ebf77bec4bf68,0x3e06bf7fbd33bf7f,0xbf683f00bf353f44,0xbf77be32bf7f3e32,0x3f1c3f353f6d3e85,0xbec43f773e063f77
.quad 0x3f25bf5ea50dbf7c,0x3f5e3eaf3f7cbeaf,0xbf63be85bf6d3f13,0x3f1cbf68be5ebf68,0xbe853f803f353f00,0xbf35bf00bf773f00,0x3f80be853ec4bf7f,0xbf4b3f523e9a3f52
.quad 0xbe32bf5ebf803eaf,0x3f003f253f71bf25,0xbf6d3f353ec43f35,0x3f6dbf35bec4bf35,0x3f133f003f35bf71,0xbe85bf44bf683f44,0x3f2dbf77bf6d3db2,0xbf7e3f133eec3f13
.quad 0xbf80be32bf44bf44,0xbe323f71bf443f00,0x3e953f7dbe693f70,0x3f793eb43f3b3f46,0x3f55bef63f79be1c,0x3e8fbf6f3f17bf40,0xbf46bf2bbf27bf49,0xbf72bebfbf5fbf07
.quad 0xbec43f6dbec43f6d,0xbec43f6dbec43f6d,0x3f7f3d5f3f7fbdf5,0x3f673ec93f773e69,0xbe48bf76bf05bf4e,0x3ef6bf6a3e1cbf7f,0xbf623f15bf073f69,0xbf59bed3bf803dc9
.quad 0x3f353f133f7fbdb2,0xbf133f683db23f77,0x3ef1bf77bebfbf53,0x3f493edd3f7bbed3,0xbf7b3d86bf293f66,0x3f29bf66bea5bf55,0x3dc93f6b3f78bd5f,0xbf37bee7bf673f2f
.quad 0x3f6dbf2dbe5ebf58,0xbf3d3f633f0a3f1c,0xbf22bef1bf463f62,0x3f223ef13f46bf62,0xbf0e3f7d3f6abcb3,0x3f4ebf60bf39bea5,0x3f75be3dbd5fbf5c,0xbf0cbefbbf1a3f7d
.quad 0xa50dbf7c3f25bf25,0xbf7cbeafbf25bf5e,0xbf753e27bf79beb4,0xbe693f70bf2f3f22,0x3f0e3f603e733f7d,0x3f763eba3f4e3f29,0x3f22bf3f3f42bf1e,0x3eaabf6e3efbbf59
.quad 0xbf6dbec4bf6dbec4,0xbf6dbec4bf6dbec4,0xbdc93f803d9c3f7e,0xbedd3f6bbe8a3f79,0x3f7bbe8f3f5bbf17,0x3f603ece3f7d3d86,0xbef1bf50bf59bed3,0x3f07bf693d06bf7f
.quad 0xbf353f52bdb23f7f,0xbf52bed8bf7f3e85,0x3f623e8a3f6ebf11,0xbf1e3f673e533f69,0x3e48bf7fbf40bee2,0x3f403ee23f72bf0e,0xbf7f3ec9be7e3f80,0x3f33bf64beddbf3b
.quad 0x3ec43f3d3f7abf0a,0xbf2dbeecbf583f4b,0x3f46bf62bf22bef1,0xbf463f623f223ef1,0xbf55be1cbece3f80,0x3f173ef63f31bf72,0xbe953f7c3f80bf02,0x3f56bf5fbf4dbe27
.quad 0x3f71be323f713f00,0xbe32bf803f00bf44,0xbf07bf69bd06bf7f,0xbf80bdc9bf62bf15,0xbf393f20bf6a3ea5,0xbddf3f7bbee23f5b,0x3f533f1a3f373f3b,0x3f783e953f693ee7
.quad 0x3ec4bf6d3ec4bf6d,0x3ec4bf6d3ec4bf6d,0xbf7cbe11bf803d06,0xbf5cbef1bf70be9f,0x3cb33f7e3eba3f66,0xbf203f55bea53f79,0x3f79beb43f3bbf46,0x3f2f3f223f753e27
.quad 0xbed8bf52bf68be85,0x3f52bf353e85bf7f,0xbf4d3f42bd5f3f7d,0xbee7bf46bf79bc33,0x3f403ee23f72bf0e,0xbf723f0ebe483f7f,0x3efbbf7bbf27bf07,0x3e3d3f623f7dbe11
.quad 0xbf743d33beec3f7e,0x3f80bec43e06bf7a,0xbdc93f753f7fbe95,0x3dc9bf75bf7f3e95,0x3f7ebf05be8fbf40,0xbf793e48bd863f6f,0xbe9fbf33bf493f69,0xbebf3f7f3f80bedd
.quad 0x3eaf3f7cbeaf3f5e,0x3f7ca50d3f5e3f25,0x3f59bed33f803dc9,0xbd06bf7f3ef1bf50,0xbf31bf48becebf72,0xbf7ebe48bf66bf05,0xbf113f4dbf333f2f,0xbe7e3f75bed33f64
.quad 0x3f6d3ec43f6d3ec4,0x3f6d3ec43f6d3ec4,0x3e3dbf7d3c33bf80,0x3f02bf623eb4bf73,0xbf803ddfbf6f3ee2,0xbf48bf0ebf72be73,0x3e693f703f2f3f22,0xbf3b3f46be953f7d
.quad 0x3f68bf133ed8bf77,0x3f133f353f773db2,0xbf1abf27bf803e27,0x3f64bf223e69bf80,0xbf293f663ea53f55,0xbea5bf55bf7b3d86,0x3f5f3e533f42bf59,0xbf7c3ef1be273f7d
.quad 0x3e9abf80bf63be06,0x3d333f6d3f7ebe5e,0xbf7f3e95bdc93f75,0x3f7fbe953dc9bf75,0x3ddf3f5b3f76bf29,0x3e73bf7bbf7f3eba,0x3f73bf37bf1ebed3,0xbf6e3dc9bd063f67
.quad 0xbf71bf00bf00bf71,0xbf003f44bf713e32,0xbd863f7bbf0e3f40,0x3f553f293ee23f72,0x3f7abe063f7e3e5e,0x3f1cbf3d3f58beec,0xbef6bf66bea5bf76,0xbf40bf31bf20bf4e
.quad 0xbf353f35bf353f35,0xbf353f35bf353f35,0x3f603ee23f723e8f,0x3f293f393f483f17,0x3e5ebf7ebe06bf7a,0x3f4bbf2d3f0abf63,0xbf7f3e48bf553f29,0xbf0ebf40bf66bea5
.quad 0x3eaf3f5e3f5e3eaf,0xbf5e3f25beaf3f7c,0x3f4ebf403d86bf7d,0x3ee23f483f793cb3,0xbf4bbec4bf6d3f1c,0x3f6dbf1c3e06bf7e,0xbeba3f7f3f403ece,0xbea5bf4ebf803e8f
.quad 0x3f7fbe853e85bf7f,0xbf773f133db23f68,0xbe48bf55bf7b3f0e,0x3e483f553f7bbf0e,0xbf633f4b3f1c3eec,0x3f7ebf0abe9abf3d,0x3f313ea53ee2bf80,0xbd86bf5bbf6a3f48
.quad 0x3eafbf5e3f5ebeaf,0xbf5ebf25beafbf7c,0xbf7fbe48bf55bf29,0xbf0e3f40bf663ea5,0x3e5e3f7ebe063f7a,0x3f4b3f2d3f0a3f63,0x3f60bee23f72be8f,0x3f29bf393f48bf17
.quad 0xbf35bf35bf35bf35,0xbf35bf35bf35bf35,0xbef63f66bea53f76,0xbf403f31bf203f4e,0x3f7a3e063f7ebe5e,0x3f1c3f3d3f583eec,0xbd86bf7bbf0ebf40,0x3f55bf293ee2bf72
.quad 0xbf713f00bf003f71,0xbf00bf44bf71be32,0x3f173f293f7fbe1c,0xbf663f20be733f80,0x3f1cbf6dbec4bf4b,0x3ec43f4b3f7ebe06,0xbf6fbd86bf293f6a,0x3f72bf173cb3bf76
.quad 0xbdb23f773f77bdb2,0xbe85bf52bf7f3ed8,0x3f7bbf0ebe48bf55,0xbf7b3f0e3e483f55,0xbeecbf1cbf4b3f63,0x3e063f583f74bf2d,0xbf393f723f66bcb3,0x3f7fbf05becebf20
.quad 0x3f803e323f443f44,0x3e32bf713f44bf00,0xbe48bf7f3ea5bf66,0xbf72bee2bf29bf55,0xbf6d3e9abf80bd33,0xbeec3f58bf3d3f1c,0x3f0e3f5b3ece3f6f,0x3f4e3f203f313f40
.quad 0x3f35bf353f35bf35,0x3f35bf353f35bf35,0xbf55bf05bf6abeba,0xbf17bf48bf39bf29,0xbec43f74bd333f80,0xbf633f0abf2d3f4b,0x3f7b3d863f72bee2,0x3ea53f663f403f0e
.quad 0xa554bf7cbf25bf25,0x3f7cbeaf3f25bf5e,0xbf7b3ecebef63f76,0xbcb3bf79bf48bee2,0x3ec43f4b3f7ebe06,0xbf7e3e06bf1c3f6d,0x3f55bf48be73bf5b,0xbe8f3f803f4e3ea5
.quad 0xbf35bed8bf523f52,0x3f683db23f13bf77,0xbf0e3f7b3f553e48,0x3f0ebf7bbf55be48,0x3f6dbd333e5ebf7a,0xbf3dbe9abf0a3f7e,0x3e48bf76bf7d3f17,0xbf483f6a3f5b3d86
.quad 0x80003f7cbf253f25,0x3f7c3eaf3f253f5e,0x3f7bbd863f723ee2,0x3ea5bf663f40bf0e,0xbec4bf74bd33bf80,0xbf63bf0abf2dbf4b,0xbf553f05bf6a3eba,0xbf173f48bf393f29
.quad 0x3f353f353f353f35,0x3f353f353f353f35,0x3f0ebf5b3ecebf6f,0x3f4ebf203f31bf40,0xbf6dbe9abf803d33,0xbeecbf58bf3dbf1c,0xbe483f7f3ea53f66,0xbf723ee2bf293f55
.quad 0x3f80be323f44bf44,0x3e323f713f443f00,0xbe48bf6abf60be8f,0x3f80be733f20bf66,0xbf6d3f1cbe063f7e,0x3e06bf7ebf4bbec4,0x3f0e3f203f79bf05,0xbf763cb3bf173f72
.quad 0x3f35bf68bf13bf13,0xbed83f7f3f523e85,0xbf55be48bf0e3f7b,0x3f553e483f0ebf7b,0xbec43f803f7abe5e,0x3f2dbf74bf58be06,0x3f7bbe8fbe1cbf4e,0xbf20becebf053f7f
.quad 0xbf44bf44be32bf80,0xbf443f00bf80be32,0xbed33f59bf503ef1,0x3f153f623dc93f80,0x3f7d3e733f603f0e,0x3f5bbee23f7bbddf,0xbdf5bf7f3d5fbf7f,0xbee7bf69be95bf78
.quad 0xbf6d3ec4bf6d3ec4,0xbf6d3ec4bf6d3ec4,0x3f1e3f423f3f3f22,0x3e9f3f703ef13f5c,0x3f17bf5b3e8fbf7b,0x3f79bea53f55bf20,0xbf70be69bf7d3e95,0xbe27bf75bf22bf2f
.quad 0xbdb23f7f3f133f35,0xbf7f3e85bf353f52,0x3f7cbec93efbbf75,0x3c333f793f463ee7,0xbee2bf40bf7f3e48,0x3f7fbe483f0ebf72,0xbf3f3f5c3ebf3f46,0x3e11bf7dbf62be3d
.quad 0x3f583e5e3f2dbf6d,0xbf7a3e06bec43f80,0x3e95bf7fbf753dc9,0xbe953f7f3f75bdc9,0xbf803ece3e1c3f55,0x3f6fbd863e48bf79,0x3e7e3f3f3f53bf62,0x3eddbf80bf7f3ebf
.quad 0x3f25bf253f7ca50d,0xbf25bf5ea50dbf7c,0xbf69bf07bf15bf62,0xbf503ef1bf7fbd06,0xbe1c3f79bef63f55,0x3f053f663e483f7e,0x3f7ebd9c3f803dc9,0x3f64bed33f75be7e
.quad 0xbec4bf6dbec4bf6d,0xbec4bf6dbec4bf6d,0xbf493f27bf2b3f46,0xbf733eb4bf623f02,0x3f4e3f053f763e48,0x3e733f723f0e3f48,0x3eb4bf79be27bf75,0x3f7dbe953f46bf3b
.quad 0xbf7f3db2bf523f35,0xbdb2bf77bf35bf13,0x3e3d3f6b3f5f3e95,0xbf803e69bf223f64,0x3f66bf293d86bf7b,0xbd863f7b3f553ea5,0xbf2bbf02bf6e3f22,0x3f7dbe273ef1bf7c
.quad 0xbf0a3f7a3f3d3ec4,0x3e5ebf7ebf6dbd33,0x3f75bdc93e95bf7f,0xbf753dc9be953f7f,0x3cb3bf6abf7d3f0e,0xbeba3f7f3f7bbe73,0xbf783f2b3f113ef1,0x3f67bd063dc9bf6e
.quad 0x3f713f003f003f71,0x3f00bf443f71be32,0x3e27bf753f22bf2f,0xbf46bf3bbeb4bf79,0xbf80bd86bf72bece,0xbf403f17bf6f3e8f,0x3e533f7d3d063f80,0x3f073f5f3ebf3f72
.quad 0x3f6dbec43f6dbec4,0x3f6dbec43f6dbec4,0xbf0cbf50bf2fbf33,0xbe69bf77bec9bf67,0xbf393f40bee23f6f,0xbf7f3e1cbf6a3ef6,0x3f503ef13f7fbd06,0xbdc93f803ed33f59
.quad 0x3ed8bf77be85bf68,0x3f773db23f68bf13,0xbf78bd06bf503f3f,0x3ed3bf7bbeddbf49,0xbd863f7b3f553ea5,0xbf55bea5bf663f29,0x3f7ebed33e69bf7f,0xbf2f3f673ee73f37
.quad 0xbe9abf4bbf7e3eec,0x3f1c3f0a3f63bf3d,0xbf623f463ef13f22,0x3f62bf46bef1bf22,0x3f203ee23f29bf76,0xbea5bf39bf603f4e,0x3f27bf79bf703df5,0xbf7d3f1a3efb3f0c
.quad 0xbeaf3f5ebf5e3eaf,0x3f5e3f253eaf3f7c,0x3f7d3e953f463f3b,0x3f22bf2f3f70be69,0xbcb3bf7f3ea5bf6a,0xbf29bf4ebebabf76,0xbf7b3e27bf80bc33,0xbf593efbbf6e3eaa
.quad 0x3ec43f6d3ec43f6d,0x3ec43f6d3ec43f6d,0x3f56bf153f3bbf37,0x3f79be8a3f6bbedd,0xbf31bf29bf66beba,0xbd86bf7dbecebf60,0xbf153f62bdc93f80,0xbf7f3d06bf693f07
.quad 0x3f683e853f77bed8,0xbe853f7f3ed83f52,0x3e7ebf80bf15bf2b,0x3f693e533f67bf1e,0xbf7f3e48bf0e3f72,0x3f0ebf72bee2bf40,0x3df53f693f79bd9c,0xbf3bbeddbf643f33
.quad 0x3f74bf1cbe06bf63,0xbf4b3f583eec3f2d,0xbef1bf22bf623f46,0x3ef13f223f62bf46,0xbf483f663f403e8f,0x3f72bf31bef6bf17,0x3f423e693eb4bf7e,0xbe27bf4dbf5f3f56
.quad 0x3f803e323f443f44,0x3e32bf713f44bf00,0x3ec4bf5e3f4bbf00,0xbf1cbf5ebe06bf80,0xbf35bf44bed8bf71,0xbf7fbe32bf68bf00,0xbf6d3eafbf7a3e32,0xbf3d3f25bf583f00
.quad 0x248d3f80248d3f80,0x248d3f80248d3f80,0x3f6d3eaf3f7a3e32,0x3f3d3f253f583f00,0x3f35bf443ed8bf71,0x3f7fbe323f68bf00,0xbec4bf5ebf4bbf00,0x3f1cbf5e3e06bf80
.quad 0xbf803e32bf443f44,0xbe32bf71bf44bf00,0xbec43f7c3eec3f44,0xbf58beafbf743f00,0x3f353f003f77bf00,0xbf773f00be853f80,0x3f6dbf25bd33bf71,0xbeec3f7c3f2d3f00
.quad 0xa554bf71bf7c3e32,0x3eaf3f443f7cbf00,0xbf6d248dbec43f80,0x3f6da5543ec4bf80,0xbf353f713f523e32,0x3f68bf44bf13bf00,0x3ec43f253f3dbf71,0x3e9abf7cbf803f00
.quad 0x80003f7cbf253f25,0x3f7c3eaf3f253f5e,0x3f6d3f003f1c3f5e,0x3f4bbf003f7ea50d,0x3f35bf253f68beaf,0x3db2bf7c3ed8bf5e,0xbec4bf71be5ebf7c,0xbf2dbf44bf0abf5e
.quad 0xbf808000bf808000,0xbf808000bf808000,0xbec43f71be5e3f7c,0xbf2d3f44bf0a3f5e,0x3f353f253f683eaf,0x3db23f7c3ed83f5e,0x3f6dbf003f1cbf5e,0x3f4b3f003f7ea50d
.quad 0xa50dbf7cbf25bf25,0x3f7cbeaf3f25bf5e,0xbf6dbe32bf633f25,0x3f0abf71be9abf5e,0xbf353f5e3e853f5e,0xbe85bf5ebf778000,0x3ec43f443f80beaf,0xbf63be32bf3d3f5e
.quad 0x3f80beaf3e32bf7c,0xbf713f253e323f5e,0x3ec4bf80bf6d8000,0xbec43f803f6da50d,0xbf35beafbf133f7c,0x3ed83f253f52bf5e,0xbf6d3f443f2d3eaf,0x3f74be32bd33bf5e
.quad 0xbf713e32bf71bf00,0x3e323f80bf003f44,0xbe063f77bf1c3f35,0x3f4b3f353ec43f77,0x3f523f253f133f5e,0x3f7fa5543f773eaf,0x3f63bed83f74be85,0x3f2dbf353f4bbf13
.quad 0xa554bf80a554bf80,0xa554bf80a554bf80,0xbf63bed8bf74be85,0xbf2dbf35bf4bbf13,0xbf523f25bf133f5e,0xbf7f248dbf773eaf,0x3e063f773f1c3f35,0xbf4b3f35bec43f77
.quad 0x3f713e323f71bf00,0xbe323f803f003f44,0x3f3dbf52bd33bf77,0x3f0a3f353f7ebdb2,0xbe85bf5ebf77248d,0x3f77a5543f35bf5e,0xbf7a3db2bf0a3f77,0x3f63bf35be06bf68
.quad 0xbf253f713f253f00,0x3eafbf80bf5ebe32,0x3ec43f353f6dbf35,0xbec4bf35bf6d3f35,0x3f7fbeafbdb2bf5e,0xbf68248dbe853f7c,0x3f0abf7fbf7a3e85,0xbf743f353f1c3ed8
.quad 0xbeafbf7c3eafbf5e,0xbf7c8000bf5ebf25,0xbf7ebe85bf4bbf35,0xbf1c3f35bf6d3e85,0xbf133f44bf523f00,0x3db23f80be853f71,0x3eec3f683e9a3f77,0x3f3d3f353f1c3f52
.quad 0x3f80a50d3f80a50d,0x3f80a50d3f80a50d,0x3eecbf683e9abf77,0x3f3dbf353f1cbf52,0xbf13bf44bf52bf00,0x3db2bf80be85bf71,0xbf7e3e85bf4b3f35,0xbf1cbf35bf6dbe85
.quad 0xbeaf3f7c3eaf3f5e,0xbf7c8000bf5e3f25,0x3f2d3f133f80be85,0xbf583f35be063f7f,0x3f77bf003e85bf80,0xbe853f803f353f00,0x3e5ebf7fbf58be85,0x3eec3f353f7ebed8
.quad 0xbf44beafbf443f5e,0x3f71a50d3f00bf7c,0xbf6d3f353ec43f35,0x3f6dbf35bec4bf35,0xbdb23f713f7fbf00,0x3ed8bf80bf773e32,0x3f583db23e5ebf77,0xbe9abf35bf4b3f68
.quad 0x3f713f003f003f71,0x3f00bf443f71be32,0x3f2fbf223f75be27,0xbe95bf7d3e69bf70,0xbecebf72bd86bf80,0xbf66bf05bf31bf48,0xbf80bd06bf7dbe53,0xbf703e9fbf7c3e11
.quad 0xbec43f6dbec43f6d,0xbec43f6dbec43f6d,0x3f333f2f3f503f0c,0x3ed33f643f113f4d,0x3f6fbee23f40bf39,0x3f723e733f80bddf,0x3d06bf7fbef1bf50,0x3f62bf153f07bf69
.quad 0xbf68be85bf773ed8,0x3e85bf7fbed8bf52,0xbf3f3f503d063f78,0xbf07bf37bf7d3d9c,0x3ea53f553f7bbd86,0xbf7b3d86bf293f66,0x3f7fbe693ed3bf7e,0xbf503f4d3e8a3f56
.quad 0x3eecbf7ebf4bbe9a,0xbe063f7a3f74bd33,0xbf22bef1bf463f62,0x3f223ef13f46bf62,0xbf763f293ee23f20,0x3f7fbebabddfbf5b,0xbdf53f703f79bf27,0x3f3bbf72bf643c33
.quad 0xbeaf3f5ebf5e3eaf,0x3f5e3f253eaf3f7c,0x3f3b3f463e953f7d,0x3f75be273f793eb4,0x3f6abea53f7f3cb3,0x3ee2bf5b3f39bf20,0xbc33bf803e27bf7b,0xbeb4bf73be3dbf7d
.quad 0xbf6dbec4bf6dbec4,0xbf6dbec4bf6dbec4,0xbf373f3bbf153f56,0xbf693ee7bf533f1a,0x3eba3f663f293f31,0xbea53f793cb33f7e,0x3f80bdc93f62bf15,0x3ef13f503f593ed3
.quad 0x3ed8bf77be85bf68,0x3f773db23f68bf13,0xbf2bbf15bf803e7e,0x3f59bf333e11bf7f,0xbf723f0ebe483f7f,0x3e48bf7fbf40bee2,0xbd9c3f793f693df5,0xbf15bf1abf773f0c
.quad 0x3f633e063f1cbf74,0xbf7e3e5ebe9a3f80,0x3f46bf62bf22bef1,0xbf463f623f223ef1,0xbe8fbf40bf663f48,0xbd863f6f3f7ebf05,0xbf7e3eb43e693f42,0x3f2f3eaa3ee7bf80
.quad 0xbf80be32bf44bf44,0xbe323f71bf443f00,0xbef13f50bf593ed3,0x3f073f693d063f7f,0x3f0e3f603e733f7d,0x3f763eba3f4e3f29,0x3f7fbd5f3f7f3df5,0x3f67bec93f77be69
.quad 0x3ec4bf6d3ec4bf6d,0x3ec4bf6d3ec4bf6d,0xbf22bf3fbf42bf1e,0xbeaabf6ebefbbf59,0xbf7b3e8fbf5b3f17,0xbf60becebf7dbd86,0xbe953f7d3e693f70,0xbf793eb4bf3b3f46
.quad 0x3f353f133f7fbdb2,0xbf133f683db23f77,0x3f75befb3ec9bf7c,0x3df53f723f563eb4,0x3e48bf7fbf40bee2,0x3f403ee23f72bf0e,0xbf46bebfbf5c3f3f,0x3f80be9f3eaabf80
.quad 0xbf6d3f2d3e5e3f58,0x3f3dbf63bf0abf1c,0xbdc93f753f7fbe95,0x3dc9bf75bf7f3e95,0x3f553e1c3ecebf80,0xbf17bef6bf313f72,0x3f62bf53bf3fbe7e,0xbf7b3e8a3e113f50
.quad 0xa50dbf7c3f25bf25,0xbf7cbeafbf25bf5e,0xbf62bf15bf07bf69,0xbf593ed3bf80bdc9,0xbf553ef6bf793e1c,0xbe8f3f6fbf173f40,0x3dc93f80bd9c3f7e,0x3edd3f6b3e8a3f79
.quad 0x3f6d3ec43f6d3ec4,0x3f6d3ec43f6d3ec4,0x3f46bf2b3f27bf49,0x3f72bebf3f5fbf07,0xbe48bf76bf05bf4e,0x3ef6bf6a3e1cbf7f,0xbf75be27bf793eb4,0xbe69bf70bf2fbf22
.quad 0xbf353f52bdb23f7f,0xbf52bed8bf7f3e85,0x3e953f5f3f6b3e3d,0xbf7e3eaabf0c3f70,0x3f7bbd863f29bf66,0xbf293f663ea53f55,0x3f22bf6ebf02bf2b,0x3c333f733f723d06
.quad 0xbec4bf3dbf7a3f0a,0x3f2d3eec3f58bf4b,0xbf7f3e95bdc93f75,0x3f7fbe953dc9bf75,0xbf0e3f7d3f6abcb3,0x3f4ebf60bf39bea5,0x3ef13f113f2bbf78,0x3e53bf77bf7d3f15
.quad 0x3f443f443e323f80,0x3f44bf003f803e32,0x3f66bea53f7f3e48,0x3d86bf7b3f0ebf40,0xbd33bf803e9abf6d,0xbf2dbf4bbec4bf74,0xbf6fbecebf5bbf0e,0xbf80bd86bf7bbe73
.quad 0xbf353f35bf353f35,0xbf353f35bf353f35,0x3eba3f6a3f053f55,0x3cb33f7f3e483f79,0x3f80bd333f74bec4,0x3f3d3f1c3f6d3e9a,0x3ee2bf72bd86bf7b,0x3f7fbe483f55bf29
.quad 0xbf25bf25bf7c248d,0x3f25bf5ea554bf7c,0xbf763ef6bece3f7b,0xbddfbf72bf55beba,0xbe063f7e3f4b3ec4,0xbf4bbec4bf6d3f1c,0x3f5b3e733f48bf55,0xbf7d3ee2be483f7e
.quad 0x3f52bf52bed8bf35,0xbf133f773f353ed8,0xbe48bf55bf7b3f0e,0x3e483f553f7bbf0e,0xbf7a3e5ebd333f6d,0x3f583e063ec4bf80,0xbf173f7d3f76be48,0x3f79bf29bf0ebef6
.quad 0xbf253f25bf7c8000,0x3f253f5e80003f7c,0x3ee23f72bd863f7b,0x3f7f3e483f553f29,0x3f803d333f743ec4,0x3f3dbf1c3f6dbe9a,0x3ebabf6a3f05bf55,0x3cb3bf7f3e48bf79
.quad 0xbf35bf35bf35bf35,0xbf35bf35bf35bf35,0xbf6f3ecebf5b3f0e,0xbf803d86bf7b3e73,0xbd333f803e9a3f6d,0xbf2d3f4bbec43f74,0x3f663ea53f7fbe48,0x3d863f7b3f0e3f40
.quad 0x3f44bf443e32bf80,0x3f443f003f80be32,0xbe8fbf60bf6abe48,0x3f7ebea53f0ebf6f,0xbf7e3e06bf1c3f6d,0x3f1cbf6dbec4bf4b,0xbf053f793f203f0e,0xbe1cbf66bf7b3ddf
.quad 0x3f133f133f68bf35,0xbf52be85bf353f68,0x3f7bbf0ebe48bf55,0xbf7b3f0e3e483f55,0x3e5ebf7abf803ec4,0xbf0a3f7e3f6dbd33,0xbf4ebe1cbe8f3f7b,0x3e733f403f55bf60
.quad 0xbf71bf00bf00bf71,0xbf003f44bf713e32,0xbf403f0ebf7b3d86,0x3e483f7fbea53f66,0x3e5e3f7ebe063f7a,0x3f4b3f2d3f0a3f63,0x3f763ea53f663ef6,0x3f7fbcb33f7e3e1c
.quad 0x3f35bf353f35bf35,0x3f35bf353f35bf35,0xbe8fbf72bee2bf60,0x3d86bf80bddfbf7d,0xbf7abe06bf7e3e5e,0xbf1cbf3dbf58beec,0xbf293f55be483f7f,0xbf7bbd86bf723ee2
.quad 0x3eaf3f5e3f5e3eaf,0xbf5e3f25beaf3f7c,0x3f7dbd863f40bf4e,0xbea53f7e3f053f39,0x3f1cbf6dbec4bf4b,0x3ec43f4b3f7ebe06,0xbecebf40bf7f3eba,0x3f663e1c3f39bf60
.quad 0xbf7f3e85be853f7f,0x3f77bf13bdb2bf68,0xbf0e3f7b3f553e48,0x3f0ebf7bbf55be48,0x3eec3f1c3f4bbf63,0xbe06bf58bf743f2d,0x3f80bee2bea5bf31,0xbf40be73beba3f7e
.quad 0x3eafbf5e3f5ebeaf,0xbf5ebf25beafbf7c,0xbf29bf55be48bf7f,0xbf7b3d86bf72bee2,0xbf7a3e06bf7ebe5e,0xbf1c3f3dbf583eec,0xbe8f3f72bee23f60,0x3d863f80bddf3f7d
.quad 0x3f353f353f353f35,0x3f353f353f353f35,0x3f76bea53f66bef6,0x3f7f3cb33f7ebe1c,0x3e5ebf7ebe06bf7a,0x3f4bbf2d3f0abf63,0xbf40bf0ebf7bbd86,0x3e48bf7fbea5bf66
.quad 0xbf713f00bf003f71,0xbf00bf44bf71be32,0xbe1c3f7f3f293f17,0xbf72bddfbf5b3f31,0x3f4b3ec43f6dbf1c,0xbf6d3f1cbe063f7e,0x3f6abf29bd86bf6f,0xbee23f7d3f313ef6
.quad 0x3db2bf77bf773db2,0x3e853f523f7fbed8,0xbf55be48bf0e3f7b,0x3f553e483f0ebf7b,0xbf633f4b3f1c3eec,0x3f7ebf0abe9abf3d,0xbcb33f663f72bf39,0x3f29bf79bf6f3ddf
.quad 0x3f003f71be323f71,0x3f71be323f713f00,0x3f7f3d063f693f07,0x3ed3bf593f50bef1,0x3ea5bf6a3f20bf39,0xbebabf76bcb3bf7f,0xbf3bbf37bf1abf53,0xbf6bbeddbf56bf15
.quad 0xbf6d3ec4bf6d3ec4,0xbf6d3ec4bf6d3ec4,0xbd063f803e113f7c,0xbebf3f72be533f7d,0x3f663eba3f7e3cb3,0x3ece3f603f313f29,0x3f46bf3b3eb4bf79,0x3f703e693f7dbe95
.quad 0xbe85bf68bf52bed8,0x3f68bf133ed8bf77,0xbf7d3d5fbf423f4d,0x3eaabf7ebf02bf3b,0xbf0e3f723ee23f40,0xbee2bf40bf7f3e48,0x3f073f273f7bbefb,0xbf73bc33bf1e3f70
.quad 0x3f7ebeec3d33bf74,0xbf633f3d3e9a3f4b,0x3e95bf7fbf753dc9,0xbe953f7f3f75bdc9,0xbf40be8fbf053f7e,0x3ef63f173f48bf66,0xbf693f493f333e9f,0x3f77be53bd9cbf59
.quad 0xbf5e3eafbf7cbeaf,0x3eaf3f7cbeaf3f5e,0x3dc93f80bed33f59,0x3f693f073f153f62,0x3f723ece3f483f31,0x3f6fbe8f3f803d86,0x3f2fbf333f4dbf11,0x3ec9bf673f0cbf50
.quad 0xbec4bf6dbec4bf6d,0xbec4bf6dbec4bf6d,0xbf803c33bf7d3e3d,0xbf6ebeaabf7bbe27,0xbee23f6fbddf3f80,0xbf6a3ef6bf393f40,0x3f223f2f3f703e69,0xbeb43f793e273f75
.quad 0x3f77bed83f13bf68,0x3ed83f523f683e85,0x3e27bf80bf27bf1a,0x3f723df53f5cbf2f,0xbf55bea5bf663f29,0x3f66bf293d86bf7b,0xbf593f423e533f5f,0x3e9fbf80bf49beb4
.quad 0x3e063f633f80be9a,0xbeecbf2dbf743f1c,0x3f75bdc93e95bf7f,0xbf753dc9be953f7f,0x3f29bf76bf5bbddf,0xbf603f4e3f203ee2,0xbed3bf1ebf373f73,0xbe8a3f7b3f7fbf07
.quad 0xbf44bf44be32bf80,0xbf443f00bf80be32,0xbf703e69bf7dbe95,0xbe273f75bf223f2f,0xbe1c3f79bef63f55,0x3f053f663e483f7e,0x3f493f273f2b3f46,0x3f733eb43f623f02
.quad 0x3f6dbec43f6dbec4,0x3f6dbec43f6dbec4,0x3df5bf7fbd5fbf7f,0x3ee7bf693e95bf78,0xbf4ebf05bf76be48,0xbe73bf72bf0ebf48,0xbf693f07bf153f62,0xbf50bef1bf7f3d06
.quad 0xbdb23f7f3f133f35,0xbf7f3e85bf353f52,0x3f533ebf3f77bef1,0xbf333f593dc93f73,0x3f66bf293d86bf7b,0xbd863f7b3f553ea5,0x3d5fbf78bf6bbdc9,0x3f1a3f153f75bf11
.quad 0xbf58be5ebf2d3f6d,0x3f7abe063ec4bf80,0xbf623f463ef13f22,0x3f62bf46bef1bf22,0xbcb33f6a3f7dbf0e,0x3ebabf7fbf7b3e73,0x3f5c3d5f3e3dbf75,0xbeaabf2fbf463f6b
.quad 0x3f25bf253f7ca50d,0xbf25bf5ea50dbf7c,0xbeb4bf793e27bf75,0xbf7dbe95bf46bf3b,0xbf7dbe73bf60bf0e,0xbf5b3ee2bf7b3ddf,0xbf1e3f42bf3f3f22,0xbe9f3f70bef13f5c
.quad 0x3ec43f6d3ec43f6d,0x3ec43f6d3ec43f6d,0x3f7e3d9c3f80bdc9,0x3f643ed33f753e7e,0x3f17bf5b3e8fbf7b,0x3f79bea53f55bf20,0xbed3bf59bf50bef1,0x3f15bf623dc9bf80
.quad 0xbf7f3db2bf523f35,0xbdb2bf77bf35bf13,0xbf113f6e3e8a3f62,0xbf37bf07bf7f3e9f,0x3ee23f403f7fbe48,0xbf7f3e48bf0e3f72,0x3f80be7e3ec9bf7f,0xbf4d3f503e953f53
.quad 0x3f0abf7abf3dbec4,0xbe5e3f7e3f6d3d33,0xbef1bf22bf623f46,0x3ef13f223f62bf46,0xbf803ece3e1c3f55,0x3f6fbd863e48bf79,0xbf023f803f7cbe95,0x3f72bf3bbf22bec9
.quad 0xbf71bf00bf00bf71,0xbf003f44bf713e32,0xbf7e248dbf6dbf00,0xbec43f5ebf4b3f00,0xbf523f00bf773e32,0xbe853f71bf133f44,0xbeec3f5ebf1c3f44,0xbe063f7cbe9a3f71
.quad 0x248d3f80248d3f80,0x248d3f80248d3f80,0x3eec3f5e3f1c3f44,0x3e063f7c3e9a3f71,0x3f523f003f773e32,0x3e853f713f133f44,0x3f7ea5543f6dbf00,0x3ec43f5e3f4b3f00
.quad 0x3f71bf003f00bf71,0x3f003f443f713e32,0x3f2dbf5ebe06bf71,0x3f1c3f253f80be32,0x3e85bf80bf35bf00,0x3f353f003f77bf00,0xbe5ebf5ebf7e3e32,0x3f4b3eaf3f58bf44
.quad 0xbf25bf00bf5e3f44,0x3f5e3e323f25bf71,0xbf6d248dbec43f80,0x3f6da5543ec4bf80,0xbf7f3f003e853f44,0x3f77be323db2bf71,0xbf583f5e3f4b3e32,0x3f7ebeafbe5ebf44
.quad 0x3eafbf5e3f5ebeaf,0xbf5ebf25beafbf7c,0xbe06bf803ec4bf5e,0xbf6dbf00bf1cbf5e,0xbf13bf5ebe85bf7c,0xbf77beafbf52bf25,0xbf63bf00bf4bbf25,0xbf7ebe32bf74beaf
.quad 0xbf808000bf808000,0xbf808000bf808000,0xbf633f00bf4b3f25,0xbf7e3e32bf743eaf,0xbf133f5ebe853f7c,0xbf773eafbf523f25,0xbe063f803ec43f5e,0xbf6d3f00bf1c3f5e
.quad 0x3eaf3f5e3f5e3eaf,0xbf5e3f25beaf3f7c,0x3f3d3f003f7ebeaf,0xbf4b3f44bd333f7c,0x3f77a50d3f35bf5e,0xbf353f5e3e853f5e,0x3f7abf003e06bf7c,0xbf1c3f713f0a3f25
.quad 0x3f44bf5ebf00bf25,0xbf003f7c3f443eaf,0x3ec4bf80bf6d8000,0xbec43f803f6da50d,0xbdb2bf5ebf773f25,0xbe853f7c3f7fbeaf,0xbf0abf00bf1c3f7c,0xbe063f713f7abf25
.quad 0x3f803e323f443f44,0x3e32bf713f44bf00,0x3f6dbe853f7e3e85,0x3e06bf773f1cbf35,0x3f35bf253f68beaf,0x3db2bf7c3ed8bf5e,0x3ec4bf683f0abf52,0x3d33bf7f3e5ebf77
.quad 0xa554bf80a554bf80,0xa554bf80a554bf80,0xbec4bf68bf0abf52,0xbd33bf7fbe5ebf77,0xbf35bf25bf68beaf,0xbdb2bf7cbed8bf5e,0xbf6dbe85bf7e3e85,0xbe06bf77bf1cbf35
.quad 0xbf803e32bf443f44,0xbe32bf71bf44bf00,0xbf6d3f13be9a3f7f,0xbe5ebf68bf63be85,0xbf353f5e3e853f5e,0xbe85bf5ebf77248d,0xbec43f7f3f3d3ed8,0xbe9abf52bf803e85
.quad 0x248d3f713f7cbe32,0xbeafbf44bf7c3f00,0x3ec43f353f6dbf35,0xbec4bf35bf6d3f35,0x3f353eaf3f13bf7c,0xbed8bf25bf523f5e,0x3f6dbdb23d33bf68,0xbeecbf13bf2d3f77
.quad 0x80003f7cbf253f25,0x3f7c3eaf3f253f5e,0x3ec43f77be063f77,0x3f7e3e853f4b3f35,0x3f353f443ed83f71,0x3f7f3e323f683f00,0x3f6d3ed83f583f13,0x3f803db23f7a3e85
.quad 0x3f80a50d3f80a50d,0x3f80a50d3f80a50d,0x3f6dbed83f58bf13,0x3f80bdb23f7abe85,0x3f35bf443ed8bf71,0x3f7fbe323f68bf00,0x3ec4bf77be06bf77,0x3f7ebe853f4bbf35
.quad 0xa50dbf7cbf25bf25,0x3f7cbeaf3f25bf5e,0xbec4bf52bf74bdb2,0x3f7abed83eecbf77,0xbf35bf00bf773f00,0x3f77bf003e85bf80,0xbf6dbdb2bf2d3f68,0x3f74bf133d33bf77
.quad 0xbf803eafbe323f7c,0x3f71bf25be32bf5e,0xbf6d3f353ec43f35,0x3f6dbf35bec4bf35,0xbf353f713f523e32,0x3f68bf44bf13bf00,0xbec43f7f3f80bed8,0x3f63bf52bf3dbe85
.quad 0xbf44bf44be32bf80,0xbf443f00bf80be32,0xbf79beb4bf3bbf46,0xbf2f3f22bf753e27,0xbf793e1cbf7ebe48,0xbf173f40bf553ef6,0xbf423f1ebf5c3ef1,0xbefb3f59bf223f3f
.quad 0xbec43f6dbec43f6d,0xbec43f6dbec43f6d,0x3d9c3f7e3e7e3f75,0xbe8a3f79bdc93f80,0x3f053f4e3f483f0e,0xbe1c3f7f3e483f76,0x3f593ed33f80bdc9,0xbd063f7f3ef13f50
.quad 0x3f7fbdb23f52bf35,0x3db23f773f353f13,0x3f6ebf113e9fbf7f,0x3e533f693f623e8a,0x3f29bf66bea5bf55,0x3ea53f553f7bbd86,0x3e7ebf80bf53be95,0x3edd3f3b3f7fbec9
.quad 0xbe5ebf58bf803ec4,0x3f0a3f1c3f6dbf2d,0xbf22bef1bf463f62,0x3f223ef13f46bf62,0xbf6a3cb3be733f7b,0x3f393ea53f0ebf7d,0xbf803f023ec93f22,0x3f4d3e273e95bf7c
.quad 0x3f25bf253f7ca50d,0xbf25bf5ea50dbf7c,0x3e69bf703f2fbf22,0xbf3bbf46be95bf7d,0xbe73bf7d3ddfbf7b,0xbf4ebf29bf0ebf60,0xbf27bf49bf02bf62,0xbf5fbf07bf46bf2b
.quad 0xbf6dbec4bf6dbec4,0xbf6dbec4bf6dbec4,0xbf7f3df5bf783e95,0xbf77be69bf7fbd5f,0xbf5b3f17bf203f55,0xbf7dbd86bf7b3e8f,0xbf073f69bd063f7f,0xbf803dc9bf623f15
.quad 0xbdb23f7f3f133f35,0xbf7f3e85bf353f52,0x3ebf3f533f733dc9,0xbf7b3ed3bef13f77,0x3f403ee23f72bf0e,0xbf723f0ebe483f7f,0x3f78bd5f3f11bf75,0xbf673f2f3dc93f6b
.quad 0x3f7abf0abd33bf6d,0xbf583f4b3ec43f3d,0x3f46bf62bf22bef1,0xbf463f623f223ef1,0x3ecebf80bf793e48,0xbf313f723f553e1c,0xbd5fbf5cbf6b3f46,0xbf1a3f7d3f75be3d
.quad 0x3f713f003f003f71,0x3f00bf443f71be32,0x3f803dc93f623f15,0x3ef1bf503f59bed3,0x3f6abea53f7f3cb3,0x3ee2bf5b3f39bf20,0x3f33bf2f3f50bf0c,0x3ed3bf643f11bf4d
.quad 0x3ec4bf6d3ec4bf6d,0x3ec4bf6d3ec4bf6d,0x3c33bf80be27bf7b,0x3eb4bf733e3dbf7d,0xbebabf66bf29bf31,0x3ea5bf79bcb3bf7e,0xbf2fbf22bf75be27,0x3e95bf7dbe69bf70
.quad 0xbf68be85bf773ed8,0x3e85bf7fbed8bf52,0xbf803e27bf2f3f5c,0x3e69bf80bf1abf27,0xbf723f0ebe483f7f,0x3e48bf7fbf40bee2,0xbf423f593eb43f49,0x3e27bf7dbf5fbe53
.quad 0xbeec3f7e3f4b3e9a,0x3e06bf7abf743d33,0xbdc93f753f7fbe95,0x3dc9bf75bf7f3e95,0x3e8f3f403f66bf48,0x3d86bf6fbf7e3f05,0x3f1e3ed33f07bf7f,0x3d06bf67bf733f37
.quad 0xbeaf3f5ebf5e3eaf,0x3f5e3f253eaf3f7c,0x3d063f7fbef13f50,0x3f623f153f073f69,0x3ece3f723d863f80,0x3f663f053f313f48,0x3f373f3b3f153f56,0x3f693ee73f533f1a
.quad 0x3f6d3ec43f6d3ec4,0x3f6d3ec43f6d3ec4,0x3f80bd063f7dbe53,0x3f703e9f3f7c3e11,0x3f6fbee23f40bf39,0x3f723e733f80bddf,0x3f3bbf463e95bf7d,0x3f753e273f79beb4
.quad 0x3ed8bf77be85bf68,0x3f773db23f68bf13,0x3d5fbf7dbf3bbf02,0x3f793c333f4dbf42,0xbea5bf55bf7b3d86,0x3f7bbd863f29bf66,0xbf27bf07bf703f1e,0x3f7dbe113efbbf7b
.quad 0xbf63be06bf1c3f74,0x3f7ebe5e3e9abf80,0xbf7f3e95bdc93f75,0x3f7fbe953dc9bf75,0xbf763f293ee23f20,0x3f7fbebabddfbf5b,0xbf493f693f593d9c,0x3f80beddbe9fbf33
.quad 0xbf00bf713e32bf71,0xbf713e32bf71bf00,0xbf55bf29bee2bf72,0xbf663ea5bf7fbe48,0xbf7ebe5ebf63bf0a,0xbf583eecbf7a3e06,0xbf723e8fbf7d3ddf,0xbf483f17bf603ee2
.quad 0xbf353f35bf353f35,0xbf353f35bf353f35,0xbea53f76be1c3f7e,0xbf203f4ebef63f66,0x3e063f7a3eec3f58,0xbf0a3f63be5e3f7e,0x3f0e3f403f663ea5,0xbee23f723d863f7b
.quad 0x3f5e3eaf3f7cbeaf,0xbeaf3f7c3eaf3f5e,0x3f7fbe1c3f31bf5b,0xbe733f803f173f29,0x3f6dbf1c3e06bf7e,0xbe063f7e3f4b3ec4,0x3f29bf6abef6bf31,0xbcb33f763f6f3d86
.quad 0x3e85bf7fbf68bdb2,0x3db23f683f7fbe85,0xbe48bf55bf7b3f0e,0x3e483f553f7bbf0e,0xbf1cbeecbf2d3f74,0x3e9a3f3d3f63bf4b,0xbf663cb3bddf3f6f,0x3ece3f203f39bf72
.quad 0x3f5ebeaf3f7c3eaf,0xbeafbf7c3eafbf5e,0x3f0ebf403f66bea5,0xbee2bf723d86bf7b,0x3e06bf7a3eecbf58,0xbf0abf63be5ebf7e,0xbea5bf76be1cbf7e,0xbf20bf4ebef6bf66
.quad 0xbf35bf35bf35bf35,0xbf35bf35bf35bf35,0xbf72be8fbf7dbddf,0xbf48bf17bf60bee2,0xbf7e3e5ebf633f0a,0xbf58beecbf7abe06,0xbf553f29bee23f72,0xbf66bea5bf7f3e48
.quad 0xbf003f713e323f71,0xbf71be32bf713f00,0xbd863f7d3f393f05,0xbf79bcb3bf4e3f40,0x3ec43f4b3f7ebe06,0xbf7e3e06bf1c3f6d,0x3f403ece3f60bf39,0xbf803e8fbeba3f7f
.quad 0x3f77bdb23ed8bf7f,0xbf7f3ed8bdb23f77,0x3f7bbf0ebe48bf55,0xbf7b3f0e3e483f55,0x3f4bbf63bf3dbe9a,0xbf743f2d3eec3f1c,0x3ee2bf80bf7e3eba,0xbf6a3f483f313ea5
.quad 0x3f443f443e323f80,0x3f44bf003f803e32,0x3f723ee23f293f55,0x3f40bf0e3f7bbd86,0x3f803d333f743ec4,0x3f3dbf1c3f6dbe9a,0x3f6abeba3f79be48,0x3f39bf293f55bf05
.quad 0x3f35bf353f35bf35,0x3f35bf353f35bf35,0x3ecebf6f3e73bf7b,0x3f31bf403f0ebf5b,0x3d33bf80be9abf6d,0x3f2dbf4b3ec4bf74,0xbea5bf66bf40bf0e,0x3f29bf553e48bf7f
.quad 0xbf25bf25bf7c248d,0x3f25bf5ea554bf7c,0xbf60be8fbf6f3f0e,0x3f20bf66be48bf6a,0xbf7e3e06bf1c3f6d,0x3f1cbf6dbec4bf4b,0xbf793f05bddf3f7b,0x3f17bf72bf0ebf20
.quad 0xbf523f523ed83f35,0x3f13bf77bf35bed8,0xbf0e3f7b3f553e48,0x3f0ebf7bbf55be48,0xbe5e3f7a3f80bec4,0x3f0abf7ebf6d3d33,0x3e1c3f4e3f60bf55,0x3f05bf7fbf7b3e8f
.quad 0xbf253f25bf7c8000,0x3f253f5e80003f7c,0xbea53f66bf403f0e,0x3f293f553e483f7f,0x3d333f80be9a3f6d,0x3f2d3f4b3ec43f74,0x3ece3f6f3e733f7b,0x3f313f403f0e3f5b
.quad 0x3f353f353f353f35,0x3f353f353f353f35,0x3f6a3eba3f793e48,0x3f393f293f553f05,0x3f80bd333f74bec4,0x3f3d3f1c3f6d3e9a,0x3f72bee23f29bf55,0x3f403f0e3f7b3d86
.quad 0x3f44bf443e32bf80,0x3f443f003f80be32,0x3ef6bf76bebabf55,0x3f483ee23f7bbece,0x3e06bf7ebf4bbec4,0x3f4b3ec43f6dbf1c,0xbe73bf5bbf7e3e48,0x3f4e3ea53f55bf48
.quad 0xbf13bf13bf683f35,0x3f523e853f35bf68,0xbf55be48bf0e3f7b,0x3f553e483f0ebf7b,0xbf7a3e5ebd333f6d,0x3f583e063ec4bf80,0xbf7d3f173ef63f0e,0x3f5b3d863e48bf76
.quad 0xbe32bf803f00bf44,0xbf80be32bf44bf44,0xbf15bf62bdc9bf80,0xbf7fbd06bf69bf07,0xbf60bf0ebf29bf4e,0xbf7b3ddfbf7dbe73,0xbf80bdc9bf79be8a,0xbf753e7ebf7e3d9c
.quad 0xbf6d3ec4bf6d3ec4,0xbf6d3ec4bf6d3ec4,0xbf2b3f46bf073f5f,0xbf623f02bf493f27,0xbe8f3f7b3d863f7d,0xbf553f20bf173f5b,0x3e273f753f223f2f,0xbf463f3bbeb43f79
.quad 0x3f133f353f773db2,0xbf353f52bdb23f7f,0x3f5f3e953f70bf0c,0xbf223f643e3d3f6b,0x3f7fbe483f0ebf72,0xbf0e3f723ee23f40,0x3f6ebf22bd06bf72,0xbef13f7c3f2b3f02
.quad 0x3f2dbf6dbf1cbf0a,0xbec43f803f583e5e,0x3e95bf7fbf753dc9,0xbe953f7f3f75bdc9,0xbe1cbf55bf723f31,0xbe483f793f80bece,0xbf11bef1bf153f7d,0xbdc93f6e3f78bf2b
.quad 0x3f7ca50d3f5e3f25,0xa50dbf7c3f25bf25,0x3f50bef13f7f3d06,0xbdc9bf803ed3bf59,0x3ef6bf553f40bf17,0xbe48bf7e3e1cbf79,0x3d5fbf7f3e69bf77,0xbe95bf78bdf5bf7f
.quad 0xbec4bf6dbec4bf6d,0xbec4bf6dbec4bf6d,0xbf3fbf22bf59befb,0xbef1bf5cbf1ebf42,0xbf76be48bf7f3e1c,0xbf0ebf48bf4ebf05,0xbf7d3e95bf463f3b,0xbf22bf2fbf70be69
.quad 0xbf523f35be853f7f,0xbf35bf13bf7f3db2,0xbefb3f753eb43f56,0xbf46bee7bf7c3ec9,0xbd863f7b3f553ea5,0xbf55bea5bf663f29,0x3ebf3f463f80beaa,0xbf62be3dbf3f3f5c
.quad 0x3f3d3ec43f4bbf58,0xbf6dbd33bf0a3f7a,0x3f75bdc93e95bf7f,0xbf753dc9be953f7f,0x3f7dbf0ebea5bf39,0xbf7b3e73bcb33f6a,0x3f53bf62bf50be11,0xbf7f3ebf3e7e3f3f
.quad 0x3f003f71be323f71,0x3f71be323f713f00,0x3f463f3b3eb43f79,0x3f70be693f7d3e95,0x3f723ece3f483f31,0x3f6fbe8f3f803d86,0x3f803c333f7d3e3d,0x3f6ebeaa3f7bbe27
.quad 0x3f6dbec43f6dbec4,0x3f6dbec43f6dbec4,0x3f3bbf373f1abf53,0x3f6bbedd3f56bf15,0x3ee2bf6f3ddfbf80,0x3f6abef63f39bf40,0x3dc9bf80bed3bf59,0x3f69bf073f15bf62
.quad 0xbe85bf68bf52bed8,0x3f68bf133ed8bf77,0xbf15bf2bbf7f3e11,0x3f67bf1e3e7ebf80,0xbf55bea5bf663f29,0x3f66bf293d86bf7b,0xbf793d9cbf0c3f77,0x3f64bf33bdf5bf69
.quad 0xbf7e3eecbd333f74,0x3f63bf3dbe9abf4b,0xbf623f463ef13f22,0x3f62bf46bef1bf22,0xbf293f763f5b3ddf,0x3f60bf4ebf20bee2,0xbeb43f7e3f80bee7,0x3f5fbf56bf42be69
.quad 0xbf5e3eafbf7cbeaf,0x3eaf3f7cbeaf3f5e,0xbf223f2fbf703e69,0x3eb43f79be273f75,0xbea53f6abf203f39,0x3eba3f763cb33f7f,0x3d063f80be113f7c,0x3ebf3f723e533f7d
.quad 0x3ec43f6d3ec43f6d,0x3ec43f6d3ec43f6d,0x3f2f3f333f4d3f11,0x3ec93f673f0c3f50,0x3f663eba3f7e3cb3,0x3ece3f603f313f29,0x3f7fbd063f69bf07,0x3ed33f593f503ef1
.quad 0x3f77bed83f13bf68,0x3ed83f523f683e85,0x3f50bf3f3d9cbf7d,0x3edd3f493f783d06,0x3f0ebf72bee2bf40,0x3ee23f403f7fbe48,0x3e69bf7fbf56be8a,0x3ee73f373f7ebed3
.quad 0xbe06bf63bf803e9a,0x3eec3f2d3f74bf1c,0xbef1bf22bf623f46,0x3ef13f223f62bf46,0xbf40be8fbf053f7e,0x3ef63f173f48bf66,0xbf703df5bc333f64,0x3efb3f0c3f27bf79
.quad 0xbf00bf00bf003f80,0xbf003f803f80bf00,0xbe9abf25bf0a3f80,0xbf633f5e3f6dbe32,0xbdb2bf44bf133f80,0xbf7f3f003f353e32,0x3e06bf5ebf1c3f80,0xbf4b248d3ec43f00
.quad 0x3eafbf71bf253f80,0xbeafbf00248d3f44,0x3f0abf7cbf2d3f80,0x3e5ebf5ebec43f71,0x3f35bf80bf353f80,0x3f35bf80bf353f80,0x3f58bf7cbf3d3f80,0x3f7abf5ebf6d3f71
.quad 0x3f71bf71bf443f80,0x3f71bf00bf803f44,0x3f7ebf5ebf4b3f80,0x3f1ca554bf6d3f00,0x3f7fbf44bf523f80,0x3db23f00bf353e32,0x3f74bf25bf583f80,0xbeec3f5ebec4be32
.quad 0x3f5ebf00bf5e3f80,0xbf5e3f80a554bf00,0x3f3dbeafbf633f80,0xbf803f5e3ec4bf44,0x3f13be32bf683f80,0xbf523f003f35bf71,0x3ec4a554bf6d3f80,0xbec4248d3f6dbf80
.quad 0x3f5ebf5ebf5e8000,0xbf5e800080003f5e,0x3f74bf44bf588000,0xbeecbf00bec43f7c,0x3f7fbf25bf528000,0x3db2bf5ebf353f7c,0x3f7ebf00bf4b8000,0x3f1cbf80bf6d3f5e
.quad 0x3f71beafbf448000,0x3f71bf5ebf803f25,0x3f58be32bf3d8000,0x3f7abf00bf6d3eaf,0x3f35a50dbf358000,0x3f35a50dbf358000,0x3f0a3e32bf2d8000,0x3e5e3f00bec4beaf
.quad 0x3eaf3eafbf258000,0xbeaf3f5ea50dbf25,0x3e063f00bf1c8000,0xbf4b3f803ec4bf5e,0xbdb23f25bf138000,0xbf7f3f5e3f35bf7c,0xbe9a3f44bf0a8000,0xbf633f003f6dbf7c
.quad 0xbf003f5ebf008000,0xbf0080003f80bf5e,0xbf2d3f71beec8000,0x3d33bf003f6dbf25,0xbf523f7cbed88000,0x3f13bf5e3f35beaf,0xbf6d3f80bec48000,0x3f6dbf803ec4a50d
.quad 0xbf003f803f80bf00,0x3f80bf00bf00bf00,0xbf3d3f773f7ebed8,0x3f4b3db2bd33bf52,0xbf683f5e3f77beaf,0x3e853f253ed8bf7c,0xbf7e3f353f6dbe85,0xbec43f773f4bbf77
.quad 0xbf7c3f003f5ebe32,0xbf5e3f713f7cbf44,0xbf633e853f4bbdb2,0xbf7e3f133f74bed8,0xbf35248d3f35a554,0xbf35248d3f35a554,0xbeecbe853f1c3db2,0xbe06bf133e9a3ed8
.quad 0xbe32bf003f003e32,0x3f00bf71be323f44,0x3e06bf353ec43e85,0x3f6dbf77bf1c3f77,0x3ed8bf5e3e853eaf,0x3f77bf25bf683f7c,0x3f2dbf773e063ed8,0x3f1cbdb2bf803f52
.quad 0x3f5ebf80248d3f00,0x248d3f00bf5e3f00,0x3f7abf77be063f13,0xbf1c3f68bf0a3db2,0x3f7fbf5ebe853f25,0xbf773f7cbdb2beaf,0x3f6dbf35bec43f35,0xbf6d3f353ec4bf35
.quad 0xbf5e800080003f5e,0x80003f5e3f5ebf5e,0xbf2dbe85be063f68,0xbf1c3f7f3f80bf13,0xbed8bf00be853f71,0xbf773f443f68be32,0xbe06bf35bec43f77,0xbf6d3e853f1c3e85
.quad 0x3e32bf5ebf003f7c,0xbf00beaf3e323f25,0x3eecbf77bf1c3f7f,0x3e06bf52be9a3f68,0x3f35bf80bf353f80,0x3f35bf80bf353f80,0x3f63bf77bf4b3f7f,0x3f7ebf52bf743f68
.quad 0x3f7cbf5ebf5e3f7c,0x3f5ebeafbf7c3f25,0x3f7ebf35bf6d3f77,0x3ec43e85bf4b3e85,0x3f68bf00bf773f71,0xbe853f44bed8be32,0x3f3dbe85bf7e3f68,0xbf4b3f7f3d33bf13
.quad 0x3f00a50dbf803f5e,0xbf803f5e3f00bf5e,0x3e5e3e85bf7e3f52,0xbf4b3ed83f58bf7f,0xbdb23f00bf773f44,0xbe85be323f7fbf71,0xbec43f35bf6d3f35,0x3ec4bf353f6dbf35
.quad 0xa554bf5ebf5e3f5e,0xbf5e3f5e3f5ea554,0x3e69bf72bf643f5c,0xbf803efb3f1a3eb4,0x3ee2bf7dbf6a3f5b,0xbf4ebcb33e733f29,0x3f22bf80bf703f59,0xbeb4bf07be273f62
.quad 0x3f4bbf7abf743f58,0x3e5ebf63bf0a3f7e,0x3f69bf6bbf783f56,0x3f37bf80bf533f79,0x3f7bbf55bf7b3f55,0x3f7bbf55bf7b3f55,0x3f80bf37bf7d3f53,0x3f6ebeddbf7b3f15
.quad 0x3f77bf13bf7f3f52,0x3f133db2bf523e85,0x3f62bed3bf803f50,0x3d063f15bf07bdc9,0x3f40be73bf803f4e,0xbf053f6abe1cbee2,0x3f15bd5fbf7f3f4d,0xbf673f7e3e7ebf3b
.quad 0x3ec43e06bf7e3f4b,0xbf7e3f4b3f1cbf6d,0x3e273e9fbf7c3f49,0xbf423ebf3f5fbf80,0xbd863ef6bf793f48,0xbe8fbe1c3f7ebf72,0xbe953f22bf753f46,0x3e95bf223f75bf46
.quad 0x3f80bf00bf00bf00,0xbf00bf00bf003f80,0x3f79beaabee7bf02,0x3d5fbf5fbf4d3f70,0x3f66be1cbecebf05,0x3f17bf80bf793f40,0x3f463d06beb4bf07,0x3f70bf59bf7d3ef1
.quad 0x3f1c3e5ebe9abf0a,0x3f7abeecbf583e06,0x3ed33ec9be7ebf0c,0x3f333d5fbf11be69,0x3e483f0ebe48bf0e,0x3e483f0ebe48bf0e,0xbd063f33be11bf11,0xbebf3f673e53bf50
.quad 0xbe853f52bdb2bf13,0xbf523f7f3f13bf77,0xbef13f69bd06bf15,0xbf803f503f59bf7f,0xbf293f793cb3bf17,0xbf5b3ece3f7dbf66,0xbf503f803d9cbf1a,0xbeddbdf53f78bf2f
.quad 0xbf6d3f7e3e06bf1c,0x3e06bf1c3f4bbec4,0xbf7d3f733e3dbf1e,0x3f27bf6e3efbbd06,0xbf7f3f603e73bf20,0x3f76bf7d3ddf3ea5,0xbf753f463e95bf22,0x3f75bf46be953f22
.quad 0xbf5e3f5e3f5ea554,0x3f5ea554a554bf5e,0xbf7b3f333f493dc9,0x3ebf3f153ef1bf7f,0xbf7e3ef63f313e48,0xbe8f3f723f55bf6f,0xbf693e693f153e95,0xbf503f753f7fbf2f
.quad 0xbf3dbd333eec3ec4,0xbf803f1c3f6dbe9a,0xbefbbe9f3eaa3ef1,0xbf423d063f223e11,0xbe48bf0e3e483f0e,0xbe48bf0e3e483f0e,0x3df5bf423d5f3f22,0x3ee7bf70be953f5c
.quad 0x3ed8bf68bdb23f35,0x3f68bf77bf353f7f,0x3f2fbf7dbe693f46,0x3f79bf22bf753f70,0x3f60bf7ebeba3f55,0x3f20bd86bf7b3f31,0x3f7cbf6ebefb3f62,0x3c333f07bf463e9f
.quad 0x3f7ebf4bbf1c3f6d,0xbf1c3f6dbec4be06,0x3f67bf1abf373f75,0xbf783f793dc9bf0c,0x3f39bebabf4e3f7b,0xbf6a3f293f0ebf5b,0x3ef1bdc9bf623f7f,0xbef13dc93f62bf7f
.quad 0xbf00bf00bf003f80,0xbf003f803f80bf00,0xbe53bf37bf1e3f7f,0xbf6e3f503f62bd9c,0x3ddfbf60bf393f7b,0xbf763ea53f0e3eba,0x3ed3bf79bf503f75,0xbf15be953dc93f3b
.quad 0x3f2dbf80bf633f6d,0x3d33bf4bbec43f74,0x3f5fbf73bf723f62,0x3f27bf80bf463f7d,0x3f7bbf55bf7b3f55,0x3f7bbf55bf7b3f55,0x3f7ebf27bf803f46,0x3f64beb4bf753f02
.quad 0x3f68bed8bf7f3f35,0x3ed83e85bf353db2,0x3f3bbe27bf793f22,0xbe693f46be95beb4,0x3ef63ddfbf6f3f0e,0xbf483f7f3e48bf39,0x3e3d3ebfbf5f3ef1,0xbf803f593f22bf73
.quad 0xbe063f1cbf4b3ec4,0xbf4b3ec43f6dbf7e,0xbedd3f4dbf333e95,0xbe7ebe693f7fbf56,0xbf313f6fbf173e48,0x3ecebf403f55bf05,0xbf623f7fbef13dc9,0x3f62bf7f3ef1bdc9
.quad 0x3f00bf80bf803f00,0xbf803f003f003f00,0x3f31bf7bbf7f3ef6,0xbf55bcb33ddf3f48,0x3f58bf6dbf7e3eec,0xbec4bf0abe9a3f74,0x3f72bf55bf7b3ee2,0x3e48bf66bf293f7f
.quad 0x3f7fbf35bf773ed8,0x3f35bf7fbf683f68,0x3f7dbf0ebf723ece,0x3f7bbf4ebf803f31,0x3f6dbec4bf6d3ec4,0x3f6dbec4bf6d3ec4,0x3f4ebe48bf663eba,0x3f0e3e1cbf313cb3
.quad 0x3f25a554bf5e3eaf,0x248d3f25beafbeaf,0x3ee23e48bf553ea5,0xbf0e3f723d86bf29,0x3e5e3ec4bf4b3e9a,0xbf6d3f7a3eecbf63,0xbcb33f0ebf403e8f,0xbf7b3f393f48bf7e
.quad 0xbe853f35bf353e85,0xbf353e853f77bf77,0xbef63f55bf293e73,0xbe48be8f3f7dbf4e,0xbf2d3f6dbf1c3e5e,0x3ec4bf3d3f58bf0a,0xbf553f7bbf0e3e48,0x3f55bf7b3f0ebe48
.quad 0x3f5ea50da50dbf5e,0xa50dbf5ebf5e3f5e,0x3f393e483d86bf60,0x3f0ebf80bf7e3f20,0x3f0a3ec43e06bf63,0x3f6dbf58bf743e9a,0x3ea53f0e3e48bf66,0x3f7bbee2bf40bd86
.quad 0x3db23f353e85bf68,0x3f353db2bed8bed8,0xbe1c3f553ea5bf6a,0x3e483f17bcb3bf39,0xbec43f6d3ec4bf6d,0xbec43f6d3ec4bf6d,0xbf173f7b3ee2bf6f,0xbf553f7d3f39bf80
.quad 0xbf443f803f00bf71,0xbf803f443f71bf71,0xbf663f7b3f0ebf72,0xbf553ea53f7fbf40,0xbf7a3f6d3f1cbf74,0xbec4be5e3f63beec,0xbf803f553f29bf76,0x3e48bf313f20bddf
.quad 0xbf773f353f35bf77,0x3f35bf773e853e85,0xbf603f0e3f40bf79,0x3f7bbf76be1c3f17,0xbf3d3ec43f4bbf7a,0x3f6dbf2dbf0a3f58,0xbf0e3e483f55bf7b,0x3f0ebe48bf553f7b
.quad 0xbf803f003f003f00,0x3f003f003f00bf80,0xbf723e733eba3f17,0xbe1c3f6a3f5bbf66,0xbf4bbd333e5e3f2d,0xbf3d3f7a3f80bf1c,0xbf0ebea53d863f40,0xbf7f3f293f66be48
.quad 0xbe85bf13bdb23f52,0xbf523db23f133e85,0x3d86bf48be733f60,0xbe8fbf053ddf3f29,0x3ec4bf6dbec43f6d,0x3ec4bf6dbec43f6d,0x3f29bf7ebf053f76,0x3f60bf79bf483f7f
.quad 0x3f5ebf7cbf253f7c,0x3f7cbf25bf7c3f5e,0x3f7bbf66bf403f7f,0x3f29bd86bf723f0e,0x3f7ebf3dbf583f80,0x3d333f0abf2d3e06,0x3f66bf05bf6a3f7d,0xbf173f6fbe73bea5
.quad 0x3f35be85bf773f77,0xbf773f773e85bf35,0x3ee23cb3bf7e3f6f,0xbf6a3f203f31bf72,0x3e063e9abf803f63,0xbeec3d333f74bf7e,0xbe483f0ebf7b3f55,0x3e48bf0e3f7bbf55
.quad 0xa50dbf5ebf5e3f5e,0xbf5e3f5e3f5ea50d,0x3ea5bf79bf6f3f4e,0xbf7d3ece3f053ee2,0x3f1cbf80bf7a3f3d,0xbf2dbe5e3d333f4b,0x3f55bf72bf7f3f29,0xbd86bf40bee23f7b
.quad 0x3f77bf52bf7f3f13,0x3f13bf7fbf523f77,0x3f7fbf20bf793ef6,0x3f76bf5bbf7e3f40,0x3f6dbec4bf6d3ec4,0x3f6dbec4bf6d3ec4,0x3f40bddfbf5b3e8f,0x3ef63e73bf20bd86
.quad 0x3f003e32bf443e32,0xbe323f44be32bf00,0x3e483ee2bf293d86,0xbf403f7f3ea5bf55,0xbe063f2dbf0abd33,0xbf803f583f3dbf7e,0xbee23f5bbecebe1c,0xbf4e3eba3f79bf72
.quad 0xbf353f77be85be85,0xbe85be853f77bf35,0xbf663f80bddfbeba,0x3ecebf483f39bea5,0xbf7e3f743d33beec,0x3f63bf803e9a3e06,0xbf7b3f553e48bf0e,0x3f7bbf55be483f0e
.quad 0x3f5ebf5ebf5e248d,0xbf5e248d248d3f5e,0x3f77bf3fbf53bd06,0xbeddbf07bed33f7d,0x3f80bf17bf48bd86,0x3e1cbf66bf403f79,0x3f79bed3bf3bbdc9,0x3f2fbf7fbf753f50
.quad 0x3f63be5ebf2dbe06,0x3f7abf4bbf7e3f0a,0x3f3fbc33bf1ebe27,0x3f6ebeb4bf593e3d,0x3f0e3e48bf0ebe48,0x3f0e3e48bf0ebe48,0x3eaa3ec9befbbe69,0xbc333f2fbe27bf0c
.quad 0x3db23f13bed8be85,0xbf133f773e85bf52,0xbe273f3bbeb4be95,0xbf703f753f22bf79,0xbece3f5bbe8fbea5,0xbf793f293f66bf7d,0xbf1e3f72be53beb4,0xbf2b3e273f80bf5c
.quad 0xbf4b3f7ebe06bec4,0xbe06bec43f6dbf1c,0xbf6b3f7fbd5fbed3,0x3ee7bf503f2fbe8a,0xbf7d3f763cb3bee2,0x3f60bf7f3ea53ddf,0xbf7f3f623dc9bef1,0x3f7fbf62bdc93ef1
.quad 0x3f003f003f00bf80,0x3f00bf80bf803f00,0x3e8a3f2b3f11bf80,0x3f67bf59bf693e11,0x3cb33f4e3f20bf7f,0x3f7dbee2bf29be73,0xbe693f693f2fbf7f,0x3f3b3dc9be95bf15
.quad 0xbeec3f7a3f3dbf7e,0x3e5e3f1c3e06bf58,0xbf2b3f803f49bf7d,0xbebf3f703f07bf7c,0xbf553f7b3f55bf7b,0xbf553f7b3f55bf7b,0xbf723f6b3f5fbf79,0xbf803f3b3f7dbf56
.quad 0xbf7f3f523f68bf77,0xbf523e853f77bf13,0xbf7d3f2f3f70bf75,0xbeb4be953f46be69,0xbf6a3f053f76bf72,0x3e73bf403ee23e1c,0xbf493eaa3f7bbf70,0x3f3fbf7d3d063f02
.quad 0xbf1c3e063f7ebf6d,0x3f7ebf6dbec43f4b,0xbec9bd9c3f80bf69,0x3f64bf15bf3b3f77,0xbe1cbe8f3f80bf66,0x3ef6bd86bf723f7e,0x3dc9bef13f7fbf62,0xbdc93ef1bf7f3f62
.quad 0xbf5e248d248d3f5e,0x248d3f5e3f5ebf5e,0xbf27be95be273f6b,0xbf223f7e3f80bf0c,0xbebabf0ebea53f76,0xbf7b3f393f60bddf,0xbd06bf46bef13f7d,0xbf623e273f073eb4
.quad 0x3e9abf6dbf1c3f80,0xbec4beec3d333f3d,0x3f1abf7fbf3b3f7f,0x3e95bf67bee73f77,0x3f55bf7bbf553f7b,0x3f55bf7bbf553f7b,0x3f78bf62bf693f73,0x3f7fbf2bbf7f3f49
.quad 0x3f7fbf35bf773f68,0x3f35bdb2bf683ed8,0x3f69bef1bf7f3f59,0x3dc93f07bf15bd06,0x3f39be48bf7f3f48,0xbf0e3f6fbddfbef6,0x3ee73dc9bf793f33,0xbf753f773ec9bf53
.quad 0x3e063ec4bf6d3f1c,0xbf6d3f1c3f4bbf7e,0xbe533f22bf593f02,0xbef13c333f7dbf72,0xbf053f55bf403ece,0x3e48bf173f6fbf31,0xbf463f75bf223e95,0x3f46bf753f22be95
.quad 0x3f00bf80bf803f00,0xbf803f003f003f00,0x3f42bf75bf7d3ec9,0xbf46bdf53c333f56,0x3f6fbf55bf723e8f,0xbe48bf31bef63f7e,0x3f80bf22bf623e27,0x3ef1bf7dbf593f70
.quad 0x3f74bec4bf4b3d33,0x3f6dbf63bf803f2d,0x3f4dbdc9bf2fbd9c,0x3f75beddbf643e8a,0x3f0e3e48bf0ebe48,0x3f0e3e48bf0ebe48,0x3e7e3ef1bed3be9f,0xbdc93f3fbd9cbf1e
.quad 0xbdb23f35be85bed8,0xbf353f7f3ed8bf68,0xbed33f62bdc9bf07,0xbf7f3f593f50bf80,0xbf313f7b3d86bf20,0xbf553eba3f7ebf60,0xbf643f7f3e69bf37,0xbe95be8a3f6bbf11
.quad 0xbf7e3f6d3ec4bf4b,0x3ec4bf4b3f1cbe06,0xbf7b3f463f07bf5c,0x3f62bf803e113eaa,0xbf5b3f0e3f29bf6a,0x3f7bbf4ebeba3f39,0xbf223e953f46bf75,0x3f22be95bf463f75
.quad 0x3f80bf00bf00bf00,0xbf00bf00bf003f80,0x3f1c3eaf3e5ebf71,0x3f2dbf7cbf803f00,0xbe853f713f52bf71,0x3f68be32bed8bf00,0xbf6d3f5e3f7ebf00,0xbe063f5e3f1cbf80
.quad 0xbf5e3e323f253e32,0xbf7c3f443f7cbf00,0xbe06bf25bd333f44,0xbeecbeaf3e9a3f00,0x3f35bf80bf353f80,0x3f35bf80bf353f80,0x3f7ebf25bf803f44,0x3f63beafbf743f00
.quad 0x3f003e32bf443e32,0xbe323f44be32bf00,0xbec43f5ebe06bf00,0xbf7e3f5e3f4bbf80,0xbf773f713f13bf71,0xbed8be323f68bf00,0xbf4b3eaf3f7abf71,0x3f3dbf7c3d333f00
.quad 0xa554bf003f5ebf00,0x3f5ebf00bf5e3f80,0x3f4bbf7c3e9a3e32,0xbe5e3f25bf583f00,0x3f77bf44bed83f44,0xbf7f3f713db2bf00,0x3ec4a554bf6d3f80,0xbec4248d3f6dbf80
.quad 0x80003f5e3f5ebf5e,0x3f5ebf5ebf5e8000,0xbf4b3f713f7abeaf,0x3f3d3e323d33bf5e,0xbf773eaf3f133eaf,0xbed83f7c3f68bf5e,0xbec4bf00be063f5e,0xbf7e3f003f4ba50d
.quad 0x3f00bf7cbf443f7c,0xbe32bf25be323f5e,0x3f7ebf44bf803f25,0x3f63bf71bf743f5e,0x3f35a50dbf358000,0x3f35a50dbf358000,0xbe063f44bd33bf25,0xbeec3f713e9abf5e
.quad 0xbf5e3f7c3f25bf7c,0xbf7c3f253f7cbf5e,0xbf6d3f003f7ebf5e,0xbe06bf003f1ca50d,0xbe85beaf3f52beaf,0x3f68bf7cbed83f5e,0x3f1cbf713e5e3eaf,0x3f2dbe32bf803f5e
.quad 0x3f80bf5ebf003f5e,0xbf003f5ebf008000,0x3f1cbe32bf743f7c,0xbf7a3f443f0abf5e,0xbe853f25bf683f25,0xbdb2beaf3f7fbf5e,0xbf6d3f80bec48000,0x3f6dbf803ec4a50d
.quad 0xbf00bf00bf003f80,0xbf003f803f80bf00,0x3eecbf7fbf7a3f35,0xbf743e853ec43f13,0x3f7fbf25bf52248d,0x3db2bf5ebf353f7c,0x3f1c3e85be06bf35,0x3f7ebf35bf6d3e85
.quad 0xbeaf3f713f25bf80,0x3eaf3f00a554bf44,0xbf7a3f523f80bf35,0xbf583f773f6dbf68,0xbf35248d3f35a554,0xbf35248d3f35a554,0x3e5ebf52bd333f35,0x3f0abf77bec43f68
.quad 0x3f71bf71bf443f80,0x3f71bf00bf803f44,0x3f4bbe85bf7e3f35,0xbe063f35bec4be85,0xbdb23f25bf13248d,0xbf7f3f5e3f35bf7c,0xbf633f7f3e5ebf35,0xbe9abe853f6dbf13
.quad 0xbf5e3f003f5ebf80,0x3f5ebf80248d3f00,0xbd33bed83f74bf35,0x3f2dbe85bf6d3f7f,0x3f52bf7c3ed8a554,0xbf133f5ebf353eaf,0x3f6dbf35bec43f35,0xbf6d3f353ec4bf35
.quad 0x3f5ebf5ebf5e8000,0xbf5e800080003f5e,0x3f63bdb2be5ebf35,0x3e9abf77bf6d3f52,0x3db23f443f13bf80,0x3f7fbf00bf35be32,0xbf4b3f773f7ebf35,0x3e063f353ec4bf77
.quad 0xbf713eaf3f44a50d,0xbf713f5e3f80bf25,0xbe5ebf133d333f35,0xbf0abe853ec43ed8,0x3f35bf80bf353f80,0x3f35bf80bf353f80,0x3f7abf13bf803f35,0x3f58be85bf6d3ed8
.quad 0x3eaf3eafbf258000,0xbeaf3f5ea50dbf25,0xbf1c3f773e06bf35,0xbf7e3f353f6dbf77,0xbf7f3f443f52bf80,0xbdb2bf003f35be32,0xbeecbdb23f7abf35,0x3f74bf77bec43f52
.quad 0x3f00bf5e3f00a50d,0x3f00a50dbf803f5e,0x3f80bf68be9a3f35,0xbf3d3f77bec4bdb2,0x3f13be32bf683f80,0xbf523f003f35bf71,0xbec43f35bf6d3f35,0x3ec4bf353f6dbf35
.quad 0x3f5ea554a554bf5e,0xa554bf5ebf5e3f5e,0x3df53f463f2fbf7c,0x3f75bf42bf56bc33,0xbf393f7b3f7fbf20,0x3f0e3eba3ddfbf60,0xbf7d3ef13f463d06,0xbf223f803f70bf59
.quad 0xbeecbec43e063f2d,0xbf6d3e9a3f3d3d33,0x3eddbf75bf153f7e,0x3dc9bf4dbe8a3f64,0x3f7bbf55bf7b3f55,0x3f7bbf55bf7b3f55,0x3f3fbdc9bf593e8a,0x3ef13e7ebf1ebd9c
.quad 0xbdb23f35be85bed8,0xbf353f7f3ed8bf68,0xbf593f7f3ef1bf69,0xbf623ed33f80bf50,0xbf6f3f0e3f72bf76,0x3e48bf393ef63ddf,0xbe8abe953f69bf0c,0x3f7fbf64bf113f6b
.quad 0x3f1cbf6d3ec43e06,0x3ec43e06bf7e3f4b,0x3f80bf62beb43f3f,0xbf463f7bbeaabe11,0x3f17be48bf663f80,0xbf553f053f31bf6f,0xbe953f22bf753f46,0x3e95bf223f75bf46
.quad 0xbf003f803f80bf00,0x3f80bf00bf00bf00,0xbf7e3f223f3b3e3d,0x3e953f273f0cbf80,0xbf31be483d863f48,0xbf553f6f3f7ebef6,0x3e27bf62bf223f80,0xbf46bd063eb43f07
.quad 0x3f63bf6dbf7e3f3d,0x3ec4bf74bf2d3f80,0x3f67be95bf503df5,0x3f7fbf1abf773ee7,0x3e483f0ebe48bf0e,0x3e483f0ebe48bf0e,0xbf2b3f7f3f07bf77,0xbf623f783f49bf7f
.quad 0xbf7f3f353f77bf68,0xbf353db23f68bed8,0xbf07bdc93f62bed3,0x3ef1bf693d063f15,0x3ebabf553ea53e8f,0x3f7bbf31bf603f7e,0x3f77bf75bed33f56,0x3dc93ee7bf533ec9
.quad 0x3f4bbec4bf6d3f7e,0xbf6d3f7e3e06bf1c,0xbc333ef1bf703f2b,0xbf223e533f72bf7d,0xbf4e3f7bbee23cb3,0x3f0ebf5b3f39beba,0xbf753f463e95bf22,0x3f75bf46be953f22
.quad 0xa554bf5ebf5e3f5e,0xbf5e3f5e3f5ea554,0x3f59bf67bf733e7e,0xbf2bbe8abe113f69,0x3f66be1cbecebf05,0x3f17bf80bf793f40,0x3dc93f3b3ed3bf79,0x3f69be69bf15be95
.quad 0xbf4b3f7a3f74bf58,0xbe5e3f633f0abf7e,0xbf703ebf3f5cbe53,0xbf803f2b3f7cbf07,0xbe48bf0e3e483f0e,0xbe48bf0e3e483f0e,0x3f3bbf80bf1a3f7c,0x3f6bbf72bf563f7d
.quad 0x3f77bf13bf7f3f52,0x3f133db2bf523e85,0x3e953eb4bf3b3e27,0xbf2f3f7d3e69bf46,0xbf293f793cb3bf17,0xbf5b3ece3f7dbf66,0xbf7d3f3f3f42bf7d,0x3eaabf493f023d06
.quad 0xbec4be063f7ebf4b,0x3f7ebf4bbf1c3f6d,0x3f15bf643f11bdf5,0x3d9c3ec9bf773f3b,0x3f7fbf60be733f20,0xbf763f7dbddfbea5,0x3ef1bdc9bf623f7f,0xbef13dc93f62bf7f
.quad 0x3f80bf00bf00bf00,0xbf00bf00bf003f80,0x3f073edd3e9fbf78,0x3f3fbf77bf7d3ed3,0xbee23f7d3f6abf5b,0x3f4e3cb3be73bf29,0xbf7f3f2f3f69be69,0xbed33f793f50bf75
.quad 0xbf1cbe5e3e9a3f0a,0xbf7a3eec3f58be06,0x3eb4bf6ebf023f7b,0x3c33bf3fbe3d3f59,0x3f7bbf55bf7b3f55,0x3f7bbf55bf7b3f55,0x3f2fbc33bf4d3e3d,0x3ec93eaabf0cbe27
.quad 0xbe853f52bdb2bf13,0xbf523f7f3f13bf77,0xbf753f703f2fbf7d,0xbf3b3e273f79bf22,0xbf403e733f80bf4e,0x3f05bf6a3e1c3ee2,0x3e27bf2b3f27be11,0x3f72bf1ebf5c3f80
.quad 0x3f6dbf7ebe063f1c,0xbe063f1cbf4b3ec4,0x3f50bee7bf533f7e,0xbf7f3f6b3e8abf2f,0xbd863ef6bf793f48,0xbe8fbe1c3f7ebf72,0xbf623f7fbef13dc9,0x3f62bf7f3ef1bdc9
.quad 0x3f003f003f00bf80,0x3f00bf80bf803f00,0xbece3f7d3f76bf40,0x3f79bea5bee2bf05,0xbf7a3f3d3f63be06,0x3d333f4b3f1cbf80,0xbf40bd863ea53f0e,0xbf723f553f7bbee2
.quad 0x3db2bf52bed83f77,0xbf13be853e853f13,0x3f5bbf76bf6f3f66,0x3f20bf7fbf403f7e,0x3f6dbec4bf6d3ec4,0x3f6dbec4bf6d3ec4,0x3e733ef6becebea5,0xbddf3f40bd86bf20
.quad 0xbf253f7c3eafbf5e,0xbf7c3f5e3f5ebf7c,0xbf7f3f403f66bf7b,0xbee2be483f55bea5,0xbf0abd333f74bf1c,0x3f3dbf7ebe063f2d,0x3ebabf4e3ef63d86,0x3f5bbee2bf723f79
.quad 0x3f77bf77be853f35,0xbe853f35bf353e85,0x3f48becebf5b3f7f,0xbf803f663ea5bf39,0xbd333eecbf7a3f4b,0xbe9abe063f7ebf74,0xbf553f7bbf0e3e48,0x3f55bf7b3f0ebe48
.quad 0xbf5e3f5e3f5ea50d,0x3f5ea50da50dbf5e,0xbf6a3e1c3e8f3f29,0xbe733f723f66bf5b,0xbe5ebf2dbeec3f7e,0xbf803f1c3f4b3d33,0x3f29bf7fbf723f55,0xbea5bf0ebe483f66
.quad 0x3f7fbf13bf683e85,0x3f52bf77bf773f52,0x3f053e8fbebabee2,0x3f48bd86bf29bddf,0xbec43f6d3ec4bf6d,0xbec43f6d3ec4bf6d,0xbf793f603f6abf72,0xbf7e3f293f7fbf48
.quad 0xbf443e323f71bf00,0xbe32bf003f003e32,0x3d86bf293ee23e48,0x3f66bf7bbf0e3f72,0x3f58bf80be9a3f4b,0x3f2dbe06bf7e3f3d,0x3f6fbf17bf603f7f,0xbf053f66bea5be73
.quad 0x3e853e85bf773f35,0xbf773f353f35bf77,0xbf203f6abf053d86,0xbcb3bee23f72bf31,0xbf803f633e5ebf1c,0x3f74bf7e3e063e9a,0xbf0e3e483f55bf7b,0x3f0ebe48bf553f7b
.quad 0x3f00bf80bf803f00,0xbf803f003f003f00,0x3f80bf0ebf29be8f,0xbe48bf39bf203f7e,0x3f0a3ec43e06bf63,0x3f6dbf58bf743e9a,0xbee23f7b3f55bf72,0x3f0e3ea5bd86bf40
.quad 0xbf7f3f353f77bed8,0xbf353f7f3f68bf68,0xbf17be483ee23eba,0xbf553e1c3f393cb3,0x3ec4bf6dbec43f6d,0x3ec4bf6dbec43f6d,0x3f7dbf55bf723f6a,0x3f7bbf17bf803f39
.quad 0x3f25a554bf5e3eaf,0x248d3f25beafbeaf,0xbea53f55be48bee2,0xbf7b3f663f40bf7f,0xbf7a3f6d3f1cbf74,0xbec4be5e3f63beec,0xbf313e483f7fbf60,0x3f55bf80bddf3f20
.quad 0x3e85bf353f35be85,0x3f35be85bf773f77,0x3f76bf7bbd863f05,0xbf0e3f60bf173e1c,0x3f3dbec4bf4b3f7a,0xbf6d3f2d3f0abf58,0xbe483f0ebf7b3f55,0x3e48bf0e3f7bbf55
.quad 0x3f5ea50da50dbf5e,0xa50dbf5ebf5e3f5e,0x3cb33f553f40bf76,0x3f7bbf31bf48bddf,0xbf583f6d3f7ebeec,0x3ec43f0a3e9abf74,0xbf663e483f0e3ea5,0xbf553f723f7fbf29
.quad 0xbdb2bf35be853f68,0xbf35bdb23ed83ed8,0x3f4ebf7bbf663f6f,0x3f0ebf7dbf313f80,0x3f6dbec4bf6d3ec4,0x3f6dbec4bf6d3ec4,0x3e1c3f0ebea5bece,0xbe483f4e3cb3bf31
.quad 0xbf443f803f00bf71,0xbf803f443f71bf71,0xbf723f0e3f7bbf66,0xbe48bee23f29bd86,0xbe5ebec43f4bbe9a,0x3f6dbf7abeec3f63,0x3f39bf7b3d863ef6,0x3f0ebcb3bf7e3f48
.quad 0x3f77bf35bf353f77,0xbf353f77be85be85,0x3e8f3e48bf7f3f5b,0xbf553ef63f4ebf7d,0xbf2d3f6dbf1c3e5e,0x3ec4bf3d3f58bf0a,0xbf7b3f553e48bf0e,0x3f7bbf55be483f0e
.quad 0x248d3f5e3f5ebf5e,0x3f5ebf5ebf5e248d,0xbf503f6e3f78be9f,0x3f373e533d9cbf62,0xbf723e8f3f053ece,0xbef63f7e3f6fbf55,0xbe95bf15be693f69,0xbf793ed33f3b3dc9
.quad 0x3f1cbf80bf583f74,0xbd33bf3dbe9a3f6d,0x3f80bf27bf7b3f02,0x3f73bf5fbf7d3f46,0x3f0e3e48bf0ebe48,0x3f0e3e48bf0ebe48,0xbeb43f643e3dbf4d,0xbf273f7e3f02bf75
.quad 0xbf773f683f52bf7f,0xbf683ed83f7fbf35,0xbf463e693f7dbf2f,0x3e27bf3b3eb43e95,0x3d86bf203f17bcb3,0x3f7ebf60bf313f7b,0x3f59bf80be113f27,0x3ebf3e3dbf733f22
.quad 0x3f6dbf1cbf4b3f7e,0xbf4b3f7ebe06bec4,0x3e693e7ebf7e3f53,0xbf4d3edd3f56bf7f,0xbf293f6abf203e73,0x3ebabf393f5bbf0e,0xbf7f3f623dc9bef1,0x3f7fbf62bdc93ef1
.quad 0xbf803f003f003f00,0x3f003f003f00bf80,0xbf15bebfbe7e3f73,0xbf333f7b3f7fbef1,0x3ea5bf76bf5b3f6a,0xbf603ddf3eba3f0e,0x3f75bf50bf793ed3,0x3e69bf69bf2f3f7f
.quad 0x3f4bbd33bf0abe9a,0x3f80bf2dbf743ec4,0xbd063f423e53bf5c,0x3e9f3efbbe11bf22,0xbf553f7b3f55bf7b,0xbf553f7b3f55bf7b,0xbf703ee73f7cbf1a,0xbf423df53f5cbe95
.quad 0xbe85bed83f133db2,0x3ed8bf68bdb23f35,0x3f22bf79be273f3b,0x3f7dbf2fbf703f75,0x3f7fbf48bf4e3f80,0x3ddf3ef6bf393e48,0x3f073c33bf7d3f42,0xbf6e3f7c3e9fbf46
.quad 0xbec43f4bbf1c3e06,0xbf1c3e063f7ebf6d,0xbf793f783df5bf11,0x3f1abf673f0cbdc9,0xbf403ece3f48bf79,0x3f6fbf31bf053f55,0x3dc9bef13f7fbf62,0xbdc93ef1bf7f3f62
.quad 0x3f5ebf5ebf5e248d,0xbf5e248d248d3f5e,0x3f5fbd5fbe3dbf3b,0x3eaabf79bf703f4d,0x3cb33f4e3f20bf7f,0x3f7dbee2bf29be73,0xbf593f703f80bf22,0x3d063f463ef1bf7d
.quad 0xbf633e5e3f2d3e06,0xbf7a3f4b3f7ebf0a,0xbd5fbf33bdf53f50,0xbec9bed33e693f11,0x3f55bf7bbf553f7b,0x3f55bf7bbf553f7b,0x3f67bebfbf773f07,0x3f33bd06bf503e53
.quad 0x3db23f13bed8be85,0xbf133f773e85bf52,0xbf503f803ed3bf62,0xbf693ef13f7fbf59,0xbf6a3f053f76bf72,0x3e73bf403ee23e1c,0xbdf5bedd3f56bed3,0x3f80bf50bf2f3f78
.quad 0x3f4bbf7e3e063ec4,0x3e063ec4bf6d3f1c,0x3f6ebf27bf2b3f70,0xbf733f7d3d06befb,0x3e1c3e8fbf803f66,0xbef63d863f72bf7e,0xbf463f75bf223e95,0x3f46bf753f22be95
.quad 0x3f003f003f00bf80,0x3f00bf80bf803f00,0xbefb3f803f7cbf2f,0x3f72be69beb4bf1a,0xbf803f173f483d86,0xbe1c3f663f40bf79,0xbf07beb43d063f46,0xbf803f223f62be27
.quad 0x3eecbf7abf3d3f7e,0xbe5ebf1cbe063f58,0x3f80bf37bf7e3f15,0x3f6bbf69bf793f53,0x3f0e3e48bf0ebe48,0x3f0e3e48bf0ebe48,0xbedd3f6e3e8abf59,0xbf373f803f15bf7b
.quad 0xbf7f3f523f68bf77,0xbf523e853f77bf13,0xbf15bd063f69bef1,0x3ed3bf623dc93f07,0x3ecebf5b3e8f3ea5,0x3f79bf29bf663f7d,0x3f7ebf67bf0c3f69,0xbd5f3f15bf3b3e7e
.quad 0x3f1cbe06bf7e3f6d,0xbf7e3f6d3ec4bf4b,0xbebf3f42bf3f3eb4,0xbe9fbe273f80bf5f,0xbf7d3f763cb3bee2,0x3f60bf7f3ea53ddf,0xbf223e953f46bf75,0x3f22be95bf463f75
.quad 0xbf003f803f80bf00,0x3f80bf00bf00bf00,0xbf58248d3e063f44,0xbec43f7c3f74bf44,0x3f13bf80bf773f44,0xbf35be323db23f44,0x3f4ba554bec4bf00,0x3f6dbf5ebf7e3f00
.quad 0xbf253f803f5ebf71,0x248d3f443eafbf71,0xbf3d248d3f1c3e32,0xbf6d3eaf3f58be32,0x3f35bf80bf353f80,0x3f35bf80bf353f80,0x3f2da554bf4b3e32,0x3ec43eafbf0abe32
.quad 0xbf443f803f00bf71,0xbf803f443f71bf71,0xbf1c248d3f6dbf00,0x3ec4bf5e3e063f00,0x3f52bf80be853f44,0x3f35be32bf7f3f44,0x3f0aa554bf7e3f44,0xbf6d3f7c3e9abf44
.quad 0xbf5e3f80a554bf00,0xa554bf003f5ebf00,0xbeec248d3f7ebf71,0x3f6dbf25bf2d3f71,0x3f68bf803e853e32,0xbf353f71bf133e32,0x3ec4a554bf6d3f80,0xbec4248d3f6dbf80
.quad 0xbf5e800080003f5e,0x80003f5e3f5ebf5e,0x3f0abf80bf7e3f25,0xbf6d3e323e9a3f25,0x3f52a50dbe85bf25,0x3f35bf7cbf7f3f25,0xbf1c3f803f6dbf5e,0x3ec43f003e06bf5e
.quad 0xbf4480003f003eaf,0xbf803f253f71beaf,0x3f2dbf80bf4b3f7c,0x3ec4bf71bf0a3f7c,0x3f35a50dbf358000,0x3f35a50dbf358000,0xbf3d3f803f1cbf7c,0xbf6d3f713f58bf7c
.quad 0xbf2580003f5ebeaf,0xa50dbf253eaf3eaf,0x3f4bbf80bec43f5e,0x3f6dbf00bf7e3f5e,0x3f13a50dbf773f25,0xbf353f7c3db2bf25,0xbf583f803e06bf25,0xbec4be323f74bf25
.quad 0xbf0080003f80bf5e,0x3f80bf5ebf003f5e,0x3f63bf803e063eaf,0xbec43f44bf3d3eaf,0x3ed8a50dbf773f7c,0xbf353eaf3f52bf7c,0xbf6d3f80bec48000,0x3f6dbf803ec4a50d
.quad 0x3f80bf00bf00bf00,0xbf00bf00bf003f80,0xbe063f683f58bf68,0x3f80bf13bf2dbe85,0xbf773eaf3f133eaf,0xbed83f7c3f68bf5e,0x3ec4bf77bf4b3f77,0xbf1cbe853e063f35
.quad 0x3f5ebe32bf25be32,0x3f7cbf44bf7c3f00,0xbf1c3f7f3f3dbf7f,0xbe9a3f683eecbf77,0xbf35248d3f35a554,0xbf35248d3f35a554,0x3f4bbf7fbf2d3f7f,0x3f74bf68bf633f77
.quad 0x3f003e32bf443e32,0xbe323f44be32bf00,0xbf6d3f773f1cbf77,0xbf4b3e853f7ebf35,0xbe85beaf3f52beaf,0x3f68bf7cbed83f5e,0x3f7ebf68bf0a3f68,0xbd333f13bf3d3e85
.quad 0x248d3f00bf5e3f00,0xbf5e3f003f5ebf80,0xbf7e3f523eecbf52,0x3f58bf7f3e5e3e85,0x3e85bf253f68bf25,0x3db23eafbf7f3f5e,0x3f6dbf35bec43f35,0xbf6d3f353ec4bf35
.quad 0x80003f5e3f5ebf5e,0x3f5ebf5ebf5e8000,0xbf7e3ed83f0a3ed8,0x3d333f523f3dbf77,0x3e85bf71bf523f71,0xbf683e323ed83f00,0x3f6dbe85bf1cbe85,0x3f4bbf77bf7e3f35
.quad 0xbf003f7c3f44bf7c,0x3e323f253e32bf5e,0xbf4b3db23f2d3db2,0xbf743ed83f63be85,0x3f35bf80bf353f80,0x3f35bf80bf353f80,0x3f1c3db2bf3d3db2,0x3e9a3ed8beecbe85
.quad 0xbf5e3f7c3f25bf7c,0xbf7c3f253f7cbf5e,0xbec4be853f4bbe85,0x3f1cbf77be063f35,0x3f77bf71bf133f71,0x3ed83e32bf683f00,0x3e063ed8bf583ed8,0xbf803f523f2dbf77
.quad 0xbf803f5e3f00bf5e,0x3f00bf5e3f00a50d,0x3e06bf133f63bf13,0x3f0abdb2bf7a3f77,0x3f77bf44bed83f44,0xbf7f3f713db2bf00,0xbec43f35bf6d3f35,0x3ec4bf353f6dbf35
.quad 0xbf5e3f5e3f5ea554,0x3f5ea554a554bf5e,0xbee7bf02bec93f7d,0xbf4d3f703f79beaa,0x3f6abf5bbf763ea5,0xbe73bf29bee23f7d,0x3eb43f073e27bf62,0x3f7dbef1bf46bd06
.quad 0xbf743f583f80bf1c,0xbf0a3f7e3f4bbf7a,0xbe7ebf0c3d9c3f2f,0xbf11be693ed33ec9,0x3f7bbf55bf7b3f55,0x3f7bbf55bf7b3f55,0x3e113f11be9fbed3,0xbe533f503d06bf33
.quad 0xbf7f3f523f68bf77,0xbf523e853f77bf13,0xbd06bf153f073dc9,0x3f59bf7fbef13f69,0x3f80bf4ebf483f7f,0x3e1c3ee2bf403e73,0xbd9c3f1abf373e69,0xbf783f2f3f50bf80
.quad 0xbf7e3f4b3f1cbf6d,0x3f1cbf6d3ec43e06,0x3e3dbf1e3f5cbf07,0x3efbbd06bf7d3f73,0x3f79bf48bece3f40,0xbf7e3f723d86bef6,0xbe953f22bf753f46,0x3e95bf223f75bf46
.quad 0xbf00bf00bf003f80,0xbf003f803f80bf00,0x3f64bf5cbf6b3e27,0xbf1abeb4be693f72,0x3ece3f053e8fbf72,0x3f79bf40bf663e1c,0xbf703f593f7dbef1,0xbe273f623f22bf80
.quad 0xbe9abf0abd333f4b,0xbf583e063f1c3e5e,0x3f78bf56bf7f3f3b,0x3f53bf79bf693f6b,0x3e483f0ebe48bf0e,0x3e483f0ebe48bf0e,0xbf7d3f533f73bf69,0xbf7b3f153f80bf37
.quad 0xbdb2bf133ed83e85,0x3f13bf77be853f52,0x3f80bf50bf593f7f,0x3f073dc9bf623ed3,0xbcb33f17bf203d86,0xbf7d3f663f29bf79,0xbf7f3f4d3f33bf79,0x3e7ebf3b3f15bd5f
.quad 0x3e06bf1c3f4bbec4,0x3f4bbec4bf6d3f7e,0x3f7cbf49bf023f59,0xbf5f3f80be27be9f,0xbe733f20bf6a3f29,0xbddfbea53f7fbf60,0xbf753f463e95bf22,0x3f75bf46be953f22
.quad 0x3f5ea554a554bf5e,0xa554bf5ebf5e3f5e,0xbf1e3f7f3f80bf11,0x3f62bd9cbe53bf37,0xbf31be483d863f48,0xbf553f6f3f7ebef6,0x3f50bf75bf7f3f2f,0xbdc9bf3bbed33f79
.quad 0x3eec3ec4be06bf2d,0x3f6dbe9abf3dbd33,0xbf723f623f7dbf49,0xbf463f7d3f5fbf73,0xbe48bf0e3e483f0e,0xbe48bf0e3e483f0e,0x3f80bf46bf793f5f,0x3f75bf02bf7e3f27
.quad 0xbdb23f35be85bed8,0xbf353f7f3ed8bf68,0xbf793f223f75bf70,0xbe95beb43f3bbe27,0x3ebabf553ea53e8f,0x3f7bbf31bf603f7e,0x3f5fbef1bf703f7b,0xbf223f73be3dbebf
.quad 0xbf1c3f6dbec4be06,0xbec4be063f7ebf4b,0xbf333e953f69bf80,0x3f7fbf56bedd3f4d,0x3f4ebf7b3ee2bcb3,0xbf0e3f5bbf393eba,0x3ef1bdc9bf623f7f,0xbef13dc93f62bf7f
.quad 0xbf003f803f80bf00,0x3f80bf00bf00bf00,0xbf49bdc93d063f53,0xbef13f7f3f7bbf33,0x3f39bf7bbf7f3f20,0xbf0ebebabddf3f60,0x3f153e95bdc9bf3b,0x3f7fbf2fbf693e69
.quad 0xbf633f6d3f7ebf3d,0xbec43f743f2dbf80,0xbeaabef13e273f1e,0xbf22be113efb3e9f,0x3f7bbf55bf7b3f55,0x3f7bbf55bf7b3f55,0x3d5f3f22be69befb,0xbe953f5c3df5bf42
.quad 0xbf7f3f353f77bf68,0xbf353db23f68bed8,0x3e69bf463e953eb4,0x3f75bf70bf2f3f7d,0x3f6fbf0ebf723f76,0xbe483f39bef6bddf,0xbefb3f62beb4be53,0xbf463e9f3f7cbf6e
.quad 0xbf4b3ec43f6dbf7e,0x3f6dbf7ebe063f1c,0x3f37bf753ed33d5f,0xbdc93f0cbf673f1a,0x3f17be48bf663f80,0xbf553f053f31bf6f,0xbf623f7fbef13dc9,0x3f62bf7f3ef1bdc9
.quad 0xbf803f003f003f00,0x3f003f003f00bf80,0x3d86bf60bf4e3f6f,0xbf7e3f203f393e48,0x3f7ebeecbf2dbe5e,0x3e9abf74bf583f6d,0xbe483f663f29bf7f,0x3f403d86bea5bf0e
.quad 0xbf773ed83f52bdb2,0xbf683f683f7fbf35,0x3ea5bf6abef63f79,0xbcb3bf39be1c3f55,0x3f6dbec4bf6d3ec4,0x3f6dbec4bf6d3ec4,0xbee23f6f3e8fbf5b,0xbf393f803f17bf7b
.quad 0xbf5e3eaf3f7cbf25,0xbeafbeaf3f25a554,0x3f0ebf72bd863f29,0x3f7fbf40bf663f7b,0x3f4bbe9abf803f58,0xbeec3f63be5ebec4,0xbf293f76be1cbece,0xbf203ddf3f80bf55
.quad 0xbf353e853f77bf77,0x3f77bf77be853f35,0x3f40bf793eba3ddf,0xbe1c3f17bf603f0e,0x3f1cbe5ebf633f80,0xbf583f0a3f2dbf6d,0xbf553f7bbf0e3e48,0x3f55bf7b3f0ebe48
.quad 0xa50dbf5ebf5e3f5e,0xbf5e3f5e3f5ea50d,0x3f7fbef6bf17beba,0xbddfbf48bf313f7b,0xbe063f633f3dbf7a,0x3f74be9abf0abec4,0xbf7b3ee23f403d86,0xbf293f7f3f72bf55
.quad 0x3e85bf68bf133f7f,0xbed8bed83db23f35,0x3f72becebf603e73,0x3f80bf31bf7d3f0e,0xbec43f6d3ec4bf6d,0xbec43f6d3ec4bf6d,0xbf663eba3f76bf05,0xbf313cb33f4ebe48
.quad 0x3f00bf71be323f44,0x3f71bf71bf443f80,0x3f55bea5bf7f3f40,0xbd863f29bee2be48,0xbf1c3f74bd33bf0a,0xbf633eec3f7abf6d,0xbf403e8f3f7dbf6a,0x3f48bf7ebcb33f0e
.quad 0x3f35bf773e853e85,0x3e853e85bf773f35,0x3f29be73bf6f3f7e,0xbf7d3f4e3ef6bf55,0xbf4b3f7abeec3d33,0x3f0abf583f3dbec4,0xbf0e3e483f55bf7b,0x3f0ebe48bf553f7b
.quad 0x3f003f003f00bf80,0x3f00bf80bf803f00,0xbf6f3f4e3f60bd86,0x3f053ee23ea5bf79,0xbe5ebf2dbeec3f7e,0xbf803f1c3f4b3d33,0x3f7fbf29bf663e48,0x3ee2bf7bbf553f72
.quad 0xbdb23f523ed8bf77,0x3f133e85be85bf13,0xbf793ef63f6abea5,0xbf7e3f403f7fbf20,0x3ec4bf6dbec43f6d,0x3ec4bf6dbec43f6d,0x3f5bbe8fbf6f3ee2,0x3f203d86bf403ddf
.quad 0xbf253f7c3eafbf5e,0xbf7c3f5e3f5ebf7c,0xbf293d863f72bf0e,0x3ea5bf553e483ee2,0x3f58bf80be9a3f4b,0x3f2dbe06bf7e3f3d,0x3ece3e1cbf763f29,0xbf793f723ee2bf5b
.quad 0xbf773f773e85bf35,0x3e85bf353f35be85,0xbddfbeba3f79bf40,0x3f39bea5bf663f80,0x3f80bf63be5e3f1c,0xbf743f7ebe06be9a,0xbe483f0ebf7b3f55,0x3e48bf0e3f7bbf55
.quad 0xbf5e3f5e3f5ea50d,0x3f5ea50da50dbf5e,0xbebabf17bef63f7f,0xbf5b3f663f72be73,0x3f7abf3dbf633e06,0xbd33bf4bbf1c3f80,0x3d863f403ee2bf7b,0x3f66be48bf0ebea5
.quad 0xbf7f3f133f68be85,0xbf523f773f77bf52,0x3e73bf60bece3f72,0xbddfbf29bd863f48,0x3f6dbec4bf6d3ec4,0x3f6dbec4bf6d3ec4,0xbf053f763ebabf66,0xbf483f7f3f29bf7e
.quad 0xbf443e323f71bf00,0xbe32bf003f003e32,0x3f40bf7fbea53f55,0x3f72bf0ebf7b3f66,0x3f0a3d33bf743f1c,0xbf3d3f7e3e06bf2d,0xbf6a3f7d3e8fbf40,0xbe73bea53f66bf05
.quad 0xbe85be853f77bf35,0x3f77bf35bf353f77,0x3f7ebf6fbe733f29,0xbf313f72bee2bcb3,0xbd333eecbf7a3f4b,0xbe9abe063f7ebf74,0xbf7b3f553e48bf0e,0x3f7bbf55be483f0e
.quad 0xbf5e248d248d3f5e,0x248d3f5e3f5ebf5e,0x3f11bf80bf7f3f1e,0xbf693e113e8a3f2b,0x3f483d86be48bf31,0x3f40bf79bf803f17,0xbf2f3f7f3f75bf50,0x3e953f153e69bf69
.quad 0xbf2dbe063ec43eec,0xbf7e3f0a3f63be5e,0x3f49bf7dbf623f72,0x3f07bf7cbf2b3f80,0x3f0e3e48bf0ebe48,0x3f0e3e48bf0ebe48,0xbf5f3f793f46bf80,0xbf7d3f563f72bf6b
.quad 0xbed8be853f35bdb2,0x3e85bf523db23f13,0x3f70bf75bf223f79,0x3f46be69bf7d3f2f,0x3e8f3ea5bf553eba,0xbf663f7d3ecebf5b,0xbf7b3f703ef1bf5f,0xbd06bf023f49beaa
.quad 0xbe06bec43f6dbf1c,0x3f6dbf1cbf4b3f7e,0x3f80bf69be953f33,0xbf3b3f77bec9bd9c,0xbcb33ee2bf7b3f4e,0xbea5bddf3f7dbf76,0xbf7f3f623dc9bef1,0x3f7fbf62bdc93ef1
.quad 0x3f00bf80bf803f00,0xbf803f003f003f00,0x3f533d06bdc9bf49,0x3ed3bf7dbf773f3f,0xbf203f7f3f7bbf39,0x3f293e73bcb3bf4e,0xbf3bbdc93e953f15,0xbf753f503f79bed3
.quad 0x3f3dbf7ebf6d3f63,0x3e06bf58beec3f7a,0x3f1e3e27bef1beaa,0x3f59be3dbf3f3c33,0xbf553f7b3f55bf7b,0xbf553f7b3f55bf7b,0xbefbbe693f223d5f,0xbe27bf0c3eaa3ec9
.quad 0x3f68bf77bf353f7f,0x3f77bf13bf7f3f52,0x3eb43e95bf463e69,0xbf223f793e27bf3b,0xbf763f723f0ebf6f,0xbee2be1c3f6abf05,0xbe53beb43f62befb,0x3f80bf5cbf1e3f72
.quad 0x3f7ebf6dbec43f4b,0xbec43f4bbf1c3e06,0x3d5f3ed3bf753f37,0xbf2f3e8a3f6bbf7f,0xbf803f663e48bf17,0x3f72bf7e3e1c3e8f,0x3dc9bef13f7fbf62,0xbdc93ef1bf7f3f62
.quad 0x248d3f5e3f5ebf5e,0x3f5ebf5ebf5e248d,0xbf7d3ec93f023ee7,0x3c333f563f42bf75,0x3ea5bf76bf5b3f6a,0xbf603ddf3eba3f0e,0x3f62be27bf07beb4,0x3f59bf70bf803f22
.quad 0xbf1c3f803f58bf74,0x3d333f3d3e9abf6d,0xbf2fbd9c3f0c3e7e,0xbf643e8a3f4dbdc9,0x3f55bf7bbf553f7b,0x3f55bf7bbf553f7b,0x3ed33e9fbf11be11,0x3d9c3f1ebe7ebef1
.quad 0xbf773f683f52bf7f,0xbf683ed83f7fbf35,0xbdc9bf073f153d06,0x3f50bf80bed33f62,0x3f7fbf48bf4e3f80,0x3ddf3ef6bf393e48,0xbe693f37bf1a3d9c,0xbf6b3f113f64bf7f
.quad 0xbf6d3f1c3f4bbf7e,0x3f4bbf7e3e063ec4,0x3f07bf5c3f1ebe3d,0x3e113eaabf7b3f46,0x3f40becebf483f79,0xbf6f3f313f05bf55,0xbf463f75bf223e95,0x3f46bf753f22be95
.quad 0xbf803f003f003f00,0x3f003f003f00bf80,0x3e27bf6bbf5c3f64,0xbf803f0c3f273e95,0x3f72be8fbf05bece,0x3ef6bf7ebf6f3f55,0xbef13f7d3f59bf70,0x3f073eb4bd06bf46
.quad 0xbf4b3d333f0a3e9a,0xbf803f2d3f74bec4,0x3f3bbf7fbf563f78,0x3ee7bf77bf1a3f7f,0x3f0e3e48bf0ebe48,0x3f0e3e48bf0ebe48,0xbf693f733f53bf7d,0xbf7f3f493f78bf62
.quad 0xbe85bed83f133db2,0x3ed8bf68bdb23f35,0x3f7fbf59bf503f80,0x3f153d06bf693ef1,0xbd863f20bf173cb3,0xbf7e3f603f31bf7b,0xbf793f333f4dbf7f,0x3ec9bf533ee73dc9
.quad 0x3ec4bf4b3f1cbe06,0x3f1cbe06bf7e3f6d,0x3f59bf02bf493f7c,0xbf7d3f723e53bf22,0xbf293f6abf203e73,0x3ebabf393f5bbf0e,0xbf223e953f46bf75,0x3f22be95bf463f75
.quad 0xbf00bf00bf003f80,0xbf003f803f80bf00,0x3f7abeafbeecbf00,0x3d33bf5ebf4b3f71,0xbf523f713f7fbf00,0x3ed83f003e85bf71,0x3e06bf5ebf1c3f80,0xbf4b248d3ec43f00
.quad 0x3f253e32beafbf00,0x3f7cbf00bf5e3e32,0xbf803f253f7abf00,0xbf743f5e3f7ebf44,0x3f35bf80bf353f80,0x3f35bf80bf353f80,0x3d333f25be5ebf00,0xbe9a3f5e3e06bf44
.quad 0xbf443e323f71bf00,0xbe32bf003f003e32,0x3f7ebf5ebf4b3f80,0x3f1ca554bf6d3f00,0xbf133f71bdb2bf00,0xbf683f003f77bf71,0xbe5ebeaf3f63bf00,0x3f80bf5ebf1c3f71
.quad 0x3f5ebf00bf5e3f80,0xbf5e3f80a554bf00,0xbf743f7c3d33bf00,0x3f0abf5e3f1cbe32,0x3ed8bf443f52bf00,0xbdb23f00bf773f44,0x3ec4a554bf6d3f80,0xbec4248d3f6dbf80
.quad 0x3f5ebf5ebf5e8000,0xbf5e800080003f5e,0xbe5e3f713f63bf5e,0x3f80bf00bf1cbeaf,0xbf13beafbdb23f5e,0xbf683f5e3f77beaf,0x3f7ebf00bf4b8000,0x3f1cbf80bf6d3f5e
.quad 0xbf443f7c3f71bf5e,0xbe323f5e3f00bf7c,0x3d33bf44be5e3f5e,0xbe9abf003e063f25,0x3f35a50dbf358000,0x3f35a50dbf358000,0xbf803f443f7abf5e,0xbf743f003f7ebf25
.quad 0x3f25bf7cbeaf3f5e,0x3f7cbf5ebf5e3f7c,0x3e063f00bf1c8000,0xbf4b3f803ec4bf5e,0xbf523eaf3f7fbf5e,0x3ed8bf5e3e853eaf,0x3f7abf71beec3f5e,0x3d333f00bf4b3eaf
.quad 0xbf003f5ebf008000,0xbf0080003f80bf5e,0xbe9abe323f80bf5e,0x3f58bf00bf4b3f7c,0x3f68bf25bf133f5e,0xbf7f3f5e3e85bf25,0xbf6d3f80bec48000,0x3f6dbf803ec4a50d
.quad 0xbf003f803f80bf00,0x3f80bf00bf00bf00,0xbe5ebf35bf1c3f7f,0xbf6d3f523f63bdb2,0x3f52a554be85bf25,0x3f35bf7cbf7f3f25,0xbf7e3f353f6dbe85,0xbec43f773f4bbf77
.quad 0x3f25bf80bf5e3f71,0xa554bf44beaf3f71,0x3d333f353e06bf52,0x3ec43ed8be5ebf13,0xbf35248d3f35a554,0xbf35248d3f35a554,0x3f80bf35bf7e3f52,0x3f6dbed8bf7a3f13
.quad 0xbf443f803f00bf71,0xbf803f443f71bf71,0x3e06bf353ec43e85,0x3f6dbf77bf1c3f77,0x3f13a554bf773f25,0xbf353f7c3db2bf25,0xbf7a3f353f4bbf7f,0x3ec4bf523eec3db2
.quad 0x3f5ebf80248d3f00,0x248d3f00bf5e3f00,0xbe9a3f35bf4b3ed8,0xbec4bdb23f80bf68,0xbed8248d3f77bf7c,0x3f35beafbf523f7c,0x3f6dbf35bec43f35,0xbf6d3f353ec4bf35
.quad 0xbf5e800080003f5e,0x80003f5e3f5ebf5e,0x3f7abf35bf4bbdb2,0xbec4bf13beec3f7f,0xbf133f803f77bf44,0x3f353e32bdb2bf44,0xbe06bf35bec43f77,0xbf6d3e853f1c3e85
.quad 0x3f44a50dbf00beaf,0x3f80bf25bf713eaf,0xbf803f353f7ebf13,0xbf6d3f683f7abf52,0x3f35bf80bf353f80,0x3f35bf80bf353f80,0xbd333f35be06bf13,0xbec43f683e5ebf52
.quad 0xbf2580003f5ebeaf,0xa50dbf253eaf3eaf,0x3f7ebf35bf6d3f77,0x3ec43e85bf4b3e85,0xbf523f803e85bf44,0xbf353e323f7fbf44,0x3e5ebf353f1cbdb2,0x3f6dbf13bf633f7f
.quad 0x3f00a50dbf803f5e,0xbf803f5e3f00bf5e,0xbf743f353f1cbf68,0x3f6dbf7f3d333ed8,0x3f68bf803e853e32,0xbf353f71bf133e32,0xbec43f35bf6d3f35,0x3ec4bf353f6dbf35
.quad 0xa554bf5ebf5e3f5e,0xbf5e3f5e3f5ea554,0x3f3b3e3d3d5fbf5f,0x3f0cbf80bf7e3f22,0xbf7f3f203f4e3cb3,0xbddf3f603f39bf7b,0x3f22bf80bf703f59,0xbeb4bf07be273f62
.quad 0x3e063f2d3e5ebf63,0x3f3d3d33beecbec4,0xbf503df53f333d5f,0xbf773ee73f67be95,0x3f7bbf55bf7b3f55,0x3f7bbf55bf7b3f55,0xbf073f773ebfbf67,0xbf493f7f3f2bbf7f
.quad 0xbe85bed83f133db2,0x3ed8bf68bdb23f35,0x3f62bed3bf803f50,0x3d063f15bf07bdc9,0xbf723f763f05bf6a,0xbef6bddf3f6fbf0e,0x3ed3bf563edd3df5,0x3f53bec9bf773f75
.quad 0x3ec43e06bf7e3f4b,0xbf7e3f4b3f1cbf6d,0xbf703f2b3f27bf6e,0x3f72bf7dbc333ef1,0x3f66bf803e8f3e1c,0xbf313f6fbf173e48,0xbe953f22bf753f46,0x3e95bf223f75bf46
.quad 0x3f80bf00bf00bf00,0xbf00bf00bf003f80,0xbf2f3f7c3f80befb,0x3f563c33bdf5bf46,0xbd86bf48bf173f80,0xbf7e3ef63f313e48,0x3f463d06beb4bf07,0x3f70bf59bf7d3ef1
.quad 0xbf7e3f3d3f7abeec,0xbf2d3f803f63bf6d,0x3f15bf7ebf373f80,0x3e8abf64bedd3f75,0x3e483f0ebe48bf0e,0x3e483f0ebe48bf0e,0xbf593e8a3f6ebedd,0xbf1ebd9c3f3fbdc9
.quad 0x3f77bf68bf523f7f,0x3f68bed8bf7f3f35,0xbef13f69bd06bf15,0xbf803f503f59bf7f,0xbea5be8f3f5bbece,0x3f60bf7ebeba3f55,0x3f69bf0cbf673f7e,0xbf113f6bbe8abe95
.quad 0xbf6d3f7e3e06bf1c,0x3e06bf1c3f4bbec4,0x3eb4bf3f3f42bebf,0x3eaa3e11bf803f62,0x3ee2bcb3bf763f7d,0xbf393eba3f4ebf7b,0xbf753f463e95bf22,0x3f75bf46be953f22
.quad 0xbf5e3f5e3f5ea554,0x3f5ea554a554bf5e,0x3e9fbf78bf6e3f50,0xbf7d3ed33f073edd,0x3ece3f053e8fbf72,0x3f79bf40bf663e1c,0xbf693e693f153e95,0xbf503f753f7fbf2f
.quad 0x3f74bf58bf803f1c,0x3f0abf7ebf4b3f7a,0xbf023f7b3f27bf80,0xbe3d3f593eb4bf6e,0xbe48bf0e3e483f0e,0xbe48bf0e3e483f0e,0x3f4dbe3dbf643eb4,0x3f0c3e27bf2f3c33
.quad 0xbf7f3f523f68bf77,0xbf523e853f77bf13,0x3f2fbf7dbe693f46,0x3f79bf22bf753f70,0xbcb33f17bf203d86,0xbf7d3f663f29bf79,0xbf273e113f80bf59,0x3f5cbf80be273f2b
.quad 0x3f7ebf4bbf1c3f6d,0xbf1c3f6dbec4be06,0xbf533f7ebe7ebe69,0x3e8abf2f3f50bee7,0x3e73bf203f6abf29,0x3ddf3ea5bf7f3f60,0x3ef1bdc9bf623f7f,0xbef13dc93f62bf7f
.quad 0xbf00bf00bf003f80,0xbf003f803f80bf00,0x3f73be7ebebfbf15,0x3e11bf69bf593f67,0xbf6a3f5b3f76bea5,0x3e733f293ee2bf7d,0x3ed3bf79bf503f75,0xbf15be953dc93f3b
.quad 0x3e9a3f0a3d33bf4b,0x3f58be06bf1cbe5e,0xbf5c3e533f42bd06,0xbf7c3f073f70bebf,0x3f7bbf55bf7b3f55,0x3f7bbf55bf7b3f55,0xbf1a3f7c3ee7bf70,0xbf563f7d3f3bbf80
.quad 0xbdb2bf133ed83e85,0x3f13bf77be853f52,0x3f3bbe27bf793f22,0xbe693f46be95beb4,0xbf803f4e3f48bf7f,0xbe1cbee23f40be73,0x3f42bf7d3c333f07,0x3f023d06bf7d3f3f
.quad 0xbe063f1cbf4b3ec4,0xbf4b3ec43f6dbf7e,0xbf113df53f78bf79,0x3f77bf3bbf153f64,0x3f79bf48bece3f40,0xbf7e3f723d86bef6,0xbf623f7fbef13dc9,0x3f62bf7f3ef1bdc9
.quad 0x3f00bf80bf803f00,0xbf803f003f003f00,0x3e8f3f293f0ebf80,0x3f66bf5bbf6a3e1c,0xbf633e063ec43f0a,0xbf1c3f803f7abf3d,0x3f72bf55bf7b3ee2,0x3e48bf66bf293f7f
.quad 0xbed83f773f35bf7f,0x3e853f133db2bf52,0xbebabee23e483f17,0xbf29bddf3f053e8f,0x3f6dbec4bf6d3ec4,0x3f6dbec4bf6d3ec4,0xbf6a3f723f55bf7d,0xbf7f3f483f79bf60
.quad 0x3eafbf5e248d3f25,0x3f5ebf7cbf253f7c,0x3ee23e48bf553ea5,0xbf0e3f723d86bf29,0xbf743f1c3f6dbf7a,0x3e06bf2d3f0a3d33,0x3f60bf7fbe483f31,0x3ea53e73bf6f3f17
.quad 0xbe853f35bf353e85,0xbf353e853f77bf77,0xbf053d863f7bbf76,0x3f72bf31bf203f6a,0x3f7abf4bbec43f3d,0xbf7e3f743d33beec,0xbf553f7bbf0e3e48,0x3f55bf7b3f0ebe48
.quad 0x3f5ea50da50dbf5e,0xa50dbf5ebf5e3f5e,0xbf763f403f553cb3,0x3ee23f053ecebf7d,0x3eecbf7ebf6d3f58,0xbf4bbd333e5e3f2d,0x3ea53f0e3e48bf66,0x3f7bbee2bf40bd86
.quad 0xbf683e853f353db2,0xbf773f523f7fbf13,0x3f6fbf66bf7b3f4e,0x3f40bf7ebf5b3f76,0xbec43f6d3ec4bf6d,0xbec43f6d3ec4bf6d,0xbecebea53f0e3e1c,0xbd86bf203e733ef6
.quad 0x3f71bf00bf803f44,0x3f003e32bf443e32,0xbf663f7b3f0ebf72,0xbf553ea53f7fbf40,0x3e9abf4b3ec43e5e,0x3f7ebf3dbf583f80,0x3ef63d86bf7b3f39,0xbf723f793ebabf4e
.quad 0xbf773f353f35bf77,0x3f35bf773e853e85,0x3f5bbf7f3e483e8f,0xbea53f39bf483ece,0xbe5e3f1cbf6d3f2d,0xbe06be9a3f80bf63,0xbf0e3e483f55bf7b,0x3f0ebe48bf553f7b
.quad 0xbf803f003f003f00,0x3f003f003f00bf80,0x3f40bf76bf7d3ece,0xbf48bddf3cb33f55,0xbe063f633f3dbf7a,0x3f74be9abf0abec4,0xbf0ebea53d863f40,0xbf7f3f293f66be48
.quad 0x3f77bed8bf523db2,0x3f68bf68bf7f3f35,0xbf663f6f3f76bf5b,0xbf313f803f4ebf7b,0x3ec4bf6dbec43f6d,0x3ec4bf6dbec43f6d,0x3ea53ecebef6be73,0xbcb33f31be1cbf0e
.quad 0xbf5e3eaf3f7cbf25,0xbeafbeaf3f25a554,0x3f7bbf66bf403f7f,0x3f29bd86bf723f0e,0xbf1c3f74bd33bf0a,0xbf633eec3f7abf6d,0xbd86bef63f4ebeba,0x3f7ebf48bf393f7b
.quad 0x3f35be85bf773f77,0xbf773f773e85bf35,0xbf7f3f5b3ecebf48,0x3f4ebf7d3e8f3e48,0x3f4bbf7a3eecbd33,0xbf0a3f58bf3d3ec4,0xbe483f0ebf7b3f55,0x3e48bf0e3f7bbf55
.quad 0xa50dbf5ebf5e3f5e,0xbf5e3f5e3f5ea50d,0x3f293e8f3e1cbf6a,0x3f20bf7ebf803f0e,0xbf7e3eec3f2d3e5e,0xbe9a3f743f58bf6d,0x3f55bf72bf7f3f29,0xbd86bf40bee23f7b
.quad 0xbe853f683f13bf7f,0x3ed83ed8bdb2bf35,0xbee2beba3e8f3f05,0xbf39bcb33f173e48,0x3f6dbec4bf6d3ec4,0x3f6dbec4bf6d3ec4,0xbf723f6a3f60bf79,0xbf803f393f7dbf55
.quad 0x3f00bf71be323f44,0x3f71bf71bf443f80,0x3e483ee2bf293d86,0xbf403f7f3ea5bf55,0xbf4b3e9a3f80bf58,0x3eecbf633e5e3ec4,0x3f7fbf60bf173f6f,0xbddf3f20bf313e48
.quad 0xbf353f77be85be85,0xbe85be853f77bf35,0x3d86bf053f6abf20,0x3f17be1cbf763f7b,0x3f1cbe5ebf633f80,0xbf583f0a3f2dbf6d,0xbf7b3f553e48bf0e,0x3f7bbf55be483f0e
.quad 0x3f5ebf5ebf5e248d,0xbf5e248d248d3f5e,0xbe7e3f733f67bf59,0x3f7fbef1bf15bebf,0xbf05becebe1c3f66,0xbf6f3f553f72be8f,0x3f79bed3bf3bbdc9,0x3f2fbf7fbf753f50
.quad 0xbf583f743f7abf4b,0xbe9a3f6d3f1cbf80,0x3e53bf5cbebf3f70,0xbe11bf22bd063f42,0x3f0e3e48bf0ebe48,0x3f0e3e48bf0ebe48,0xbf7c3f1a3f80bf3b,0xbf5c3e953f70bee7
.quad 0x3f52bf7fbf133f77,0x3f7fbf35bf773f68,0xbe273f3bbeb4be95,0xbf703f753f22bf79,0xbf173cb33f79bf29,0x3f31bf7bbd863f20,0x3f7dbf42bf3f3f7d,0xbe9f3f46bf07bc33
.quad 0xbf4b3f7ebe06bec4,0xbe06bec43f6dbf1c,0x3df5bf113f64bf15,0x3f0cbdc9bf793f78,0x3f20be73bf603f7f,0xbf5b3f0e3f29bf6a,0xbf7f3f623dc9bef1,0x3f7fbf62bdc93ef1
.quad 0x3f003f003f00bf80,0x3f00bf80bf803f00,0xbf783e9f3edd3f07,0xbd9c3f623f50bf6e,0x3f5bbf6abf7d3ee2,0xbebabf0ebea53f76,0xbe693f693f2fbf7f,0x3f3b3dc9be95bf15
.quad 0xbf0abe9a3e5e3f1c,0xbf743ec43f4bbd33,0x3f7bbf02bf6e3eb4,0x3f7dbf46bf803f27,0xbf553f7b3f55bf7b,0xbf553f7b3f55bf7b,0x3e3dbf4dbc333f2f,0x3f02bf75beb43f64
.quad 0x3f133db2bf523e85,0xbdb23f35be85bed8,0xbf7d3f2f3f70bf75,0xbeb4be953f46be69,0x3f4ebf80be733f40,0x3f39be48bf7f3f48,0xbe113f27bf2b3e27,0xbf733f223f59bf80
.quad 0xbf1c3e063f7ebf6d,0x3f7ebf6dbec43f4b,0x3f7ebf53bee73f50,0xbf563f7fbe69be7e,0xbf483f79bef63d86,0x3f05bf553f40bece,0x3dc9bef13f7fbf62,0xbdc93ef1bf7f3f62
.quad 0xbf5e248d248d3f5e,0x248d3f5e3f5ebf5e,0x3f7cbf2fbf46bdf5,0xbeb4bf1abefb3f80,0xbf203f7f3f7bbf39,0x3f293e73bcb3bf4e,0xbd06bf46bef13f7d,0xbf623e273f073eb4
.quad 0x3f2d3e06bec4beec,0x3f7ebf0abf633e5e,0xbf7e3f153f75bedd,0xbf793f533f80bf37,0x3f55bf7bbf553f7b,0x3f55bf7bbf553f7b,0xbe8a3f593dc9bf3f,0xbf153f7b3eddbf6e
.quad 0xbed8be853f35bdb2,0x3e85bf523db23f13,0x3f69bef1bf7f3f59,0x3dc93f07bf15bd06,0xbf763f723f0ebf6f,0xbee2be1c3f6abf05,0x3f0cbf693e953e8a,0x3f3bbe7ebf7e3f67
.quad 0x3e063ec4bf6d3f1c,0xbf6d3f1c3f4bbf7e,0xbf3f3eb43f62bf80,0x3f80bf5fbebf3f42,0x3f80bf66be483f17,0xbf723f7ebe1cbe8f,0xbf463f75bf223e95,0x3f46bf753f22be95
.quad 0x3f00bf80bf803f00,0xbf803f003f003f00,0x3e3d3f3b3f22bf7e,0x3f70bf4dbf5f3d5f,0xbf48bd863e483f31,0xbf403f793f80bf17,0x3f80bf22bf623e27,0x3ef1bf7dbf593f70
.quad 0xbf3d3f7e3f6dbf63,0xbe063f583eecbf7a,0x3df5bf50be953f67,0xbe69bf113d5f3f33,0x3f0e3e48bf0ebe48,0x3f0e3e48bf0ebe48,0xbf773f073f7fbf2b,0xbf503e533f67bebf
.quad 0x3f68bf77bf353f7f,0x3f77bf13bf7f3f52,0xbed33f62bdc9bf07,0xbf7f3f593f50bf80,0xbe8fbea53f55beba,0x3f66bf7dbece3f5b,0x3f56bed3bf753f77,0xbf2f3f78bdf5bedd
.quad 0xbf7e3f6d3ec4bf4b,0x3ec4bf4b3f1cbe06,0x3f2bbf703ef1bc33,0xbd063efbbf6e3f27,0xbcb33ee2bf7b3f4e,0xbea5bddf3f7dbf76,0xbf223e953f46bf75,0x3f22be95bf463f75
.quad 0x3f80bf00bf00bf00,0xbf00bf00bf003f80,0xbf7e3f253f3d3e32,0x3e9a3f253f0abf80,0x3f77bf44bf683e32,0xbdb2bf44bf133f80,0xbf6d3f5e3f7ebf00,0xbe063f5e3f1cbf80
.quad 0x3f5ebf71bf7c3f44,0x3eafbf71bf253f80,0xbf4b3f7c3f63bf71,0xbf0a3f7c3f2dbf80,0x3f35bf80bf353f80,0x3f35bf80bf353f80,0xbf1c3f7c3eecbf71,0xbf583f7c3f3dbf80
.quad 0x3f00bf71be323f44,0x3f71bf71bf443f80,0xbec43f5ebe06bf00,0xbf7e3f5e3f4bbf80,0x3e85bf443ed83e32,0x3f7fbf44bf523f80,0xbe063f25bf2d3e32,0xbf743f253f58bf80
.quad 0xa554bf003f5ebf00,0x3f5ebf00bf5e3f80,0x3e063eafbf7a3f44,0xbf3d3eaf3f63bf80,0xbe85be323f7fbf71,0x3f13be32bf683f80,0x3ec4a554bf6d3f80,0xbec4248d3f6dbf80
.quad 0x80003f5e3f5ebf5e,0x3f5ebf5ebf5e8000,0xbe06bf44bf2d3f7c,0xbf743f443f58a50d,0x3e853f253ed8bf7c,0x3f7fbf25bf528000,0xbec4bf00be063f5e,0xbf7e3f003f4ba50d
.quad 0x3f003eafbe32bf25,0x3f71beafbf448000,0xbf1cbe323eec3eaf,0xbf583e323f3da50d,0x3f35a50dbf358000,0x3f35a50dbf358000,0xbf4b3e323f63beaf,0xbf0abe323f2da50d
.quad 0x3f5ebeafbf7c3f25,0x3eaf3eafbf258000,0xbf6d3f003f7ebf5e,0xbe06bf003f1ca50d,0x3f77bf25bf683f7c,0xbdb23f25bf138000,0xbf7e3f443f3dbf7c,0x3e9abf443f0aa50d
.quad 0x3f80bf5ebf003f5e,0xbf003f5ebf008000,0xbf7e3f713e5ebf25,0x3f2dbf713eeca50d,0x3f77bf7c3db23eaf,0xbf523f7cbed88000,0xbf6d3f80bec48000,0x3f6dbf803ec4a50d
.quad 0xbf00bf00bf003f80,0xbf003f803f80bf00,0x3f0a3ed83e9abf77,0x3f3dbf77bf7e3ed8,0xbf13beafbdb23f5e,0xbf683f5e3f77beaf,0x3f1c3e85be06bf35,0x3f7ebf35bf6d3e85
.quad 0xbf25be323eaf3f00,0xbf7c3f003f5ebe32,0x3f2d3db2bf0abe85,0x3f63be85bf4b3db2,0xbf35248d3f35a554,0xbf35248d3f35a554,0x3f3dbdb2bf583e85,0x3eec3e85bf1cbdb2
.quad 0xbf443e323f71bf00,0xbe32bf003f003e32,0x3f4bbe85bf7e3f35,0xbe063f35bec4be85,0xbf523eaf3f7fbf5e,0x3ed8bf5e3e853eaf,0x3f58bed8bf743f77,0xbf2d3f77be06bed8
.quad 0xbf5e3f003f5ebf80,0x3f5ebf80248d3f00,0x3f63bf13bf3d3f77,0xbf7a3f773e06bf13,0xbf683f253f13bf5e,0x3f7fbf5ebe853f25,0x3f6dbf35bec43f35,0xbf6d3f353ec4bf35
.quad 0x3f5ebf5ebf5e8000,0xbf5e800080003f5e,0xbf583f683f74be85,0x3f2d3e853e06bf68,0x3f52bf71bf7f3f00,0xbed8bf00be853f71,0xbf4b3f773f7ebf35,0x3e063f353ec4bf77
.quad 0x3f44bf7cbf713f5e,0x3e32bf5ebf003f7c,0xbf3d3f7f3f58bf77,0xbeec3f773f1cbf7f,0x3f35bf80bf353f80,0x3f35bf80bf353f80,0xbf2d3f7f3f0abf77,0xbf633f773f4bbf7f
.quad 0x3f25bf7cbeaf3f5e,0x3f7cbf5ebf5e3f7c,0xbf1c3f773e06bf35,0xbf7e3f353f6dbf77,0x3f13bf713db23f00,0x3f68bf00bf773f71,0xbf0a3f68be9abe85,0xbf3d3e853f7ebf68
.quad 0x3f00bf5e3f00a50d,0x3f00a50dbf803f5e,0xbeec3f52bf2d3e85,0xbe5ebe853f7ebf52,0x3ed8bf443f52bf00,0xbdb23f00bf773f44,0xbec43f35bf6d3f35,0x3ec4bf353f6dbf35
.quad 0x3f5ea554a554bf5e,0xa554bf5ebf5e3f5e,0xbf6b3e273e953f27,0xbe693f723f64bf5c,0x3f76bea5bf0ebeba,0x3ee2bf7dbf6a3f5b,0xbf7d3ef13f463d06,0xbf223f803f70bf59
.quad 0x3f80bf1cbf6d3e9a,0x3f4bbf7abf743f58,0xbf7f3f3b3f7fbf1a,0xbf693f6b3f78bf56,0x3f7bbf55bf7b3f55,0x3f7bbf55bf7b3f55,0xbf733f693f62bf78,0xbf803f373f7dbf53
.quad 0x3f68bf77bf353f7f,0x3f77bf13bf7f3f52,0xbf593f7f3ef1bf69,0xbf623ed33f80bf50,0x3f48bf7fbe483f39,0x3f40be73bf803f4e,0xbf333f79bdc9bee7,0xbf153d5f3f7fbf4d
.quad 0x3f1cbf6d3ec43e06,0x3ec43e06bf7e3f4b,0xbf023f59bf223e53,0xbe27be9f3f7cbf49,0x3ecebf403f55bf05,0xbd863ef6bf793f48,0xbe953f22bf753f46,0x3e95bf223f75bf46
.quad 0xbf003f803f80bf00,0x3f80bf00bf00bf00,0x3ec9bf7dbf753f42,0xbf793eaa3ee73f02,0xbe8f3f723f55bf6f,0x3f66be1cbecebf05,0x3e27bf62bf223f80,0xbf46bd063eb43f07
.quad 0xbd333f4b3ec4bf74,0x3f1c3e5ebe9abf0a,0xbd9cbf2fbdc93f4d,0xbed3bec93e7e3f0c,0x3e483f0ebe48bf0e,0x3e483f0ebe48bf0e,0xbe9fbed33ef13e7e,0x3d06bf333e113f11
.quad 0x3ed83e85bf353db2,0xbe853f52bdb2bf13,0xbf07bdc93f62bed3,0x3ef1bf693d063f15,0x3f20bd86bf7b3f31,0xbf293f793cb3bf17,0xbf373e693f7fbf64,0x3f50bf80bd9c3f1a
.quad 0x3f4bbec4bf6d3f7e,0xbf6d3f7e3e06bf1c,0xbf5c3f073f46bf7b,0x3f7dbf73be3d3f1e,0x3f6abf29bf0e3f5b,0xbf7f3f603e73bf20,0xbf753f463e95bf22,0x3f75bf46be953f22
.quad 0xa554bf5ebf5e3f5e,0xbf5e3f5e3f5ea554,0x3d063f533f3fbf77,0x3f7bbf33bf49bdc9,0xbd86bf48bf173f80,0xbf7e3ef63f313e48,0x3dc93f3b3ed3bf79,0x3f69be69bf15be95
.quad 0xbe06bf2dbe5e3f63,0xbf3dbd333eec3ec4,0x3e273f1e3c33bf3f,0x3efb3e9fbeaabef1,0xbe48bf0e3e483f0e,0xbe48bf0e3e483f0e,0x3e693efbbec9beaa,0xbdf53f42bd5fbf22
.quad 0xbe85bed83f133db2,0x3ed8bf68bdb23f35,0x3e953eb4bf3b3e27,0xbf2f3f7d3e69bf46,0xbea5be8f3f5bbece,0x3f60bf7ebeba3f55,0x3eb43e53bf723f1e,0xbf7c3f6e3efbbf62
.quad 0xbec4be063f7ebf4b,0x3f7ebf4bbf1c3f6d,0x3ed33d5fbf7f3f6b,0xbf673f1a3f37bf75,0xbee23cb33f76bf7d,0x3f39bebabf4e3f7b,0x3ef1bdc9bf623f7f,0xbef13dc93f62bf7f
.quad 0x3f80bf00bf00bf00,0xbf00bf00bf003f80,0xbf803f113f2b3e8a,0x3e533f373f1ebf7f,0x3f7fbf20bf4ebcb3,0x3ddfbf60bf393f7b,0xbf7f3f2f3f69be69,0xbed33f793f50bf75
.quad 0x3f7ebf3dbf7a3eec,0x3f2dbf80bf633f6d,0xbf7d3f493f80bf2b,0xbf5f3f733f72bf62,0x3f7bbf55bf7b3f55,0x3f7bbf55bf7b3f55,0xbf793f5f3f6bbf72,0xbf7e3f273f80bf46
.quad 0x3f77bf68bf523f7f,0x3f68bed8bf7f3f35,0xbf753f703f2fbf7d,0xbf3b3e273f79bf22,0x3f72bf76bf053f6a,0x3ef63ddfbf6f3f0e,0xbf703f7b3eaabf49,0xbe3dbebf3f5fbef1
.quad 0x3f6dbf7ebe063f1c,0xbe063f1cbf4b3ec4,0xbf693f80bd9cbec9,0x3eddbf4d3f33be95,0x3f66bf803e8f3e1c,0xbf313f6fbf173e48,0xbf623f7fbef13dc9,0x3f62bf7f3ef1bdc9
.quad 0x3f003f003f00bf80,0x3f00bf80bf803f00,0xbf17bebabe733f72,0xbf313f7b3f7fbef6,0x3f2d3e5ebd33bf4b,0x3f58bf6dbf7e3eec,0xbf40bd863ea53f0e,0xbf723f553f7bbee2
.quad 0x3f52bdb2bf13be85,0x3f7fbf35bf773ed8,0xbf603e733f48bd86,0xbf7d3f0e3f72bece,0x3f6dbec4bf6d3ec4,0x3f6dbec4bf6d3ec4,0xbf763f053f7ebf29,0xbf4e3e483f66beba
.quad 0x3f7cbf25bf7c3f5e,0x3f25a554bf5e3eaf,0xbf7f3f403f66bf7b,0xbee2be483f55bea5,0x3f80bf58bf3d3f7e,0x3e5e3ec4bf4b3e9a,0xbf7d3f6a3f05bf66,0x3cb3bf0e3f40be8f
.quad 0x3f77bf77be853f35,0xbe853f35bf353e85,0xbf6f3f7ebcb3bee2,0x3ef6bf553f29be73,0x3f63bf803e9a3e06,0xbf2d3f6dbf1c3e5e,0xbf553f7bbf0e3e48,0x3f55bf7b3f0ebe48
.quad 0xbf5e3f5e3f5ea50d,0x3f5ea50da50dbf5e,0x3f4ebf6fbf793ea5,0xbf39be48bd863f60,0xbf3d3f7a3f80bf1c,0x3f0a3ec43e06bf63,0x3f29bf7fbf723f55,0xbea5bf0ebe483f66
.quad 0xbf133f7f3f52bf77,0x3db23f353e85bf68,0x3ef6bf79bf203f7f,0x3e1cbf55bea53f6a,0xbec43f6d3ec4bf6d,0xbec43f6d3ec4bf6d,0x3e8fbf5bbddf3f40,0x3f17bf7bbee23f6f
.quad 0xbe323f44be32bf00,0xbf443f803f00bf71,0x3d86bf293ee23e48,0x3f66bf7bbf0e3f72,0x3d333f0abf2d3e06,0xbf7a3f6d3f1cbf74,0xbe1cbece3f5bbee2,0x3f80bf55bf293f76
.quad 0x3e853e85bf773f35,0xbf773f353f35bf77,0xbebabddf3f80bf66,0x3f60bf0ebf403f79,0x3eecbd33bf743f7e,0xbf3d3ec43f4bbf7a,0xbf0e3e483f55bf7b,0x3f0ebe48bf553f7b
.quad 0x3f00bf80bf803f00,0xbf803f003f003f00,0xbef63f7f3f7bbf31,0x3f72be73bebabf17,0x3eecbf7ebf6d3f58,0xbf4bbd333e5e3f2d,0xbee23f7b3f55bf72,0x3f0e3ea5bd86bf40
.quad 0x3ed8bf77bf353f7f,0xbe85bf13bdb23f52,0xbece3f723f0ebf7d,0xbd863f483e73bf60,0x3ec4bf6dbec43f6d,0x3ec4bf6dbec43f6d,0xbeba3f663e48bf4e,0xbf293f7e3f05bf76
.quad 0x3eafbf5e248d3f25,0x3f5ebf7cbf253f7c,0xbea53f55be48bee2,0xbf7b3f663f40bf7f,0x3e9abf4b3ec43e5e,0x3f7ebf3dbf583f80,0xbe8f3f40bf0e3cb3,0xbf663f053f6abf7d
.quad 0x3e85bf353f35be85,0x3f35be85bf773f77,0xbe733f29bf553ef6,0xbee2bcb33f7ebf6f,0x3e5ebf1c3f6dbf2d,0x3e063e9abf803f63,0xbe483f0ebf7b3f55,0x3e48bf0e3f7bbf55
.quad 0x3f5ea50da50dbf5e,0xa50dbf5ebf5e3f5e,0xbf603d863e483f39,0xbea53f793f6fbf4e,0x3f63be06bec4bf0a,0x3f1cbf80bf7a3f3d,0xbf663e483f0e3ea5,0xbf553f723f7fbf29
.quad 0x3f68be85bf35bdb2,0x3f77bf52bf7f3f13,0xbf6a3ea53f55be1c,0xbf7f3f203f79bef6,0x3f6dbec4bf6d3ec4,0x3f6dbec4bf6d3ec4,0xbf6f3ee23f7bbf17,0xbf403ddf3f5bbe8f
.quad 0x3f71bf00bf803f44,0x3f003e32bf443e32,0xbf723f0e3f7bbf66,0xbe48bee23f29bd86,0x3f74bf1cbf6d3f7a,0xbe063f2dbf0abd33,0xbf763f293f55bf80,0x3ee2bf5b3ece3e1c
.quad 0x3f77bf35bf353f77,0xbf353f77be85be85,0xbf793f403f0ebf60,0x3f66bf803ddf3eba,0x3f7abf4bbec43f3d,0xbf7e3f743d33beec,0xbf7b3f553e48bf0e,0x3f7bbf55be483f0e
.quad 0x248d3f5e3f5ebf5e,0x3f5ebf5ebf5e248d,0xbdc9bf49bf333f7b,0xbf773f3f3f533d06,0x3e483f313ef6bf7e,0x3f80bf17bf48bd86,0xbe95bf15be693f69,0xbf793ed33f3b3dc9
.quad 0x3ec43eecbd33bf3d,0x3f63be5ebf2dbe06,0xbef1beaa3e9f3efb,0xbf3f3c333f1e3e27,0x3f0e3e48bf0ebe48,0x3f0e3e48bf0ebe48,0xbf22bd5f3f42bdf5,0xbeaabec93efb3e69
.quad 0x3f35bdb2bf683ed8,0x3db23f13bed8be85,0xbf463e693f7dbf2f,0x3e27bf3b3eb43e95,0x3f55bebabf7e3f60,0xbece3f5bbe8fbea5,0xbf623efb3f6ebf7c,0x3f1ebf723e533eb4
.quad 0x3f6dbf1cbf4b3f7e,0xbf4b3f7ebe06bec4,0xbf753f373f1abf67,0x3f6bbf7f3d5f3ed3,0x3f7bbf4ebeba3f39,0xbf7d3f763cb3bee2,0xbf7f3f623dc9bef1,0x3f7fbf62bdc93ef1
.quad 0xbf803f003f003f00,0x3f003f003f00bf80,0x3f7fbf1ebf37be53,0xbe8abf2bbf113f80,0xbf7b3f393f60bddf,0x3cb33f4e3f20bf7f,0x3f75bf50bf793ed3,0x3e69bf69bf2f3f7f
.quad 0xbf6d3f633f80bf2d,0xbeec3f7a3f3dbf7e,0x3f62bf72bf733f5f,0x3f2bbf80bf493f7d,0xbf553f7b3f55bf7b,0xbf553f7b3f55bf7b,0x3f46bf80bf273f7e,0x3f72bf6bbf5f3f79
.quad 0xbf353f7f3ed8bf68,0xbf7f3f523f68bf77,0x3f22bf79be273f3b,0x3f7dbf2fbf703f75,0xbf0e3f6fbddfbef6,0xbf6a3f053f76bf72,0x3ef1bf5f3ebf3e3d,0x3f49beaabf7b3f70
.quad 0xbec43f4bbf1c3e06,0xbf1c3e063f7ebf6d,0x3e95bf333f4dbedd,0x3ec93d9cbf803f69,0xbe483f17bf6f3f31,0xbe1cbe8f3f80bf66,0x3dc9bef13f7fbf62,0xbdc93ef1bf7f3f62
.quad 0x3f5ebf5ebf5e248d,0xbf5e248d248d3f5e,0xbf5c3f643f72be69,0x3f273e953e27bf6b,0x3f5bbf6abf7d3ee2,0xbebabf0ebea53f76,0xbf593f703f80bf22,0x3d063f463ef1bf7d
.quad 0x3f58bf74bf7a3f4b,0x3e9abf6dbf1c3f80,0xbf563f783f6bbf69,0xbf1a3f7f3f3bbf7f,0x3f55bf7bbf553f7b,0x3f55bf7bbf553f7b,0xbf533f7d3f37bf80,0xbf783f623f69bf73
.quad 0x3f52bf7fbf133f77,0x3f7fbf35bf773f68,0xbf503f803ed3bf62,0xbf693ef13f7fbf59,0x3f4ebf80be733f40,0x3f39be48bf7f3f48,0xbf4d3f7f3d5fbf15,0xbee7bdc93f79bf33
.quad 0x3f4bbf7e3e063ec4,0x3e063ec4bf6d3f1c,0xbf493f7cbe9fbe27,0x3e53bf223f59bf02,0x3f48bf793ef6bd86,0xbf053f55bf403ece,0xbf463f75bf223e95,0x3f46bf753f22be95
.quad 0x3f003f003f00bf80,0x3f00bf80bf803f00,0xbf02bee7beaa3f79,0xbf423f753f7dbec9,0x3f053ece3e1cbf66,0x3f6fbf55bf723e8f,0xbf07beb43d063f46,0xbf803f223f62be27
.quad 0x3f0a3e9abe5ebf1c,0x3f74bec4bf4b3d33,0xbf0cbe7e3ec93ed3,0xbf4d3dc93f2f3d9c,0x3f0e3e48bf0ebe48,0x3f0e3e48bf0ebe48,0xbf11be113f33bd06,0xbe7ebef13ed33e9f
.quad 0x3f133db2bf523e85,0xbdb23f35be85bed8,0xbf15bd063f69bef1,0x3ed3bf623dc93f07,0x3f17bcb3bf793f29,0xbf313f7b3d86bf20,0xbf1a3d9c3f80bf50,0x3f64bf7fbe693f37
.quad 0x3f1cbe06bf7e3f6d,0xbf7e3f6d3ec4bf4b,0xbf1e3e3d3f73bf7d,0x3f7bbf46bf073f5c,0x3f20be73bf603f7f,0xbf5b3f0e3f29bf6a,0xbf223e953f46bf75,0x3f22be95bf463f75
.quad 0xbf003f803f80bf00,0x3f80bf00bf00bf00,0x3f63bf5ebf6d3e32,0xbf1cbeafbe5e3f71,0xbf7f3f003f353e32,0xbe853f713f52bf71,0x3f4ba554bec4bf00,0x3f6dbf5ebf7e3f00
.quad 0xbeafbf00248d3f44,0xbf5e3e323f253e32,0xbe5e3f5e3ec4bf71,0x3e063f253d33bf44,0x3f35bf80bf353f80,0x3f35bf80bf353f80,0xbf7a3f5e3f6dbf71,0xbf7e3f253f80bf44
.quad 0x3f71bf00bf803f44,0x3f003e32bf443e32,0xbf1c248d3f6dbf00,0x3ec4bf5e3e063f00,0x3db23f00bf353e32,0xbf773f713f13bf71,0x3eecbf5e3ec43e32,0x3f4bbeafbf7a3f71
.quad 0xbf5e3f80a554bf00,0xa554bf003f5ebf00,0x3f80bf5ebec43f44,0xbf4b3f7cbe9abe32,0xbf523f003f35bf71,0x3f77bf44bed83f44,0x3ec4a554bf6d3f80,0xbec4248d3f6dbf80
.quad 0xbf5e800080003f5e,0x80003f5e3f5ebf5e,0x3eec3f003ec4bf7c,0x3f4bbf71bf7a3eaf,0x3db2bf5ebf353f7c,0xbf773eaf3f133eaf,0xbf1c3f803f6dbf5e,0x3ec43f003e06bf5e
.quad 0x3f71bf5ebf803f25,0x3f00bf7cbf443f7c,0xbf7a3f003f6dbeaf,0xbf7e3f443f80bf25,0x3f35a50dbf358000,0x3f35a50dbf358000,0xbe5ebf003ec43eaf,0x3e06bf443d333f25
.quad 0xbeaf3f5ea50dbf25,0xbf5e3f7c3f25bf7c,0x3f4bbf80bec43f5e,0x3f6dbf00bf7e3f5e,0xbf7f3f5e3f35bf7c,0xbe85beaf3f52beaf,0x3f63bf00bf6d3f7c,0xbf1c3f71be5ebeaf
.quad 0xbf0080003f80bf5e,0x3f80bf5ebf003f5e,0xbd333f00bf6d3f25,0xbf1c3e323f74bf7c,0x3f13bf5e3f35beaf,0xbe853f25bf683f25,0xbf6d3f80bec48000,0x3f6dbf803ec4a50d
.quad 0x3f80bf00bf00bf00,0xbf00bf00bf003f80,0xbf4bbdb23d333f52,0xbeec3f7f3f7abf35,0x3e853f253ed8bf7c,0x3f7fbf25bf52248d,0x3ec4bf77bf4b3f77,0xbf1cbe853e063f35
.quad 0xbf5e3f713f7cbf44,0xbeaf3f713f25bf80,0x3f7ebf13bf743ed8,0x3f7abf52bf803f35,0xbf35248d3f35a554,0xbf35248d3f35a554,0x3e063f13be9abed8,0xbe5e3f523d33bf35
.quad 0x3f00bf71be323f44,0x3f71bf71bf443f80,0xbf6d3f773f1cbf77,0xbf4b3e853f7ebf35,0x3f77bf25bf683f7c,0xbdb23f25bf13248d,0xbf1c3db23f80bf52,0x3f63bf7fbe5e3f35
.quad 0x248d3f00bf5e3f00,0xbf5e3f003f5ebf80,0x3f1cbf683f0abdb2,0x3d333ed8bf743f35,0xbf773f7cbdb2beaf,0x3f52bf7c3ed8a554,0x3f6dbf35bec43f35,0xbf6d3f353ec4bf35
.quad 0x80003f5e3f5ebf5e,0x3f5ebf5ebf5e8000,0x3f1cbf7fbf803f13,0xbf633db23e5e3f35,0xbf773f443f68be32,0x3db23f443f13bf80,0x3f6dbe85bf1cbe85,0x3f4bbf77bf7e3f35
.quad 0xbf00beaf3e323f25,0xbf713eaf3f44a50d,0xbe063f523e9abf68,0x3e5e3f13bd33bf35,0x3f35bf80bf353f80,0x3f35bf80bf353f80,0xbf7e3f523f74bf68,0xbf7a3f133f80bf35
.quad 0x3f5ebeafbf7c3f25,0x3eaf3eafbf258000,0xbec4be853f4bbe85,0x3f1cbf77be063f35,0xbe853f44bed8be32,0xbf7f3f443f52bf80,0x3f4bbf7fbd333f13,0x3eec3db2bf7a3f35
.quad 0xbf803f5e3f00bf5e,0x3f00bf5e3f00a50d,0x3f4bbed8bf583f7f,0xbf803f683e9abf35,0xbe85be323f7fbf71,0x3f13be32bf683f80,0xbec43f35bf6d3f35,0x3ec4bf353f6dbf35
.quad 0xbf5e3f5e3f5ea554,0x3f5ea554a554bf5e,0x3f80befbbf1abeb4,0xbdf5bf46bf2f3f7c,0xbf4ebcb33e733f29,0xbf393f7b3f7fbf20,0x3eb43f073e27bf62,0x3f7dbef1bf46bd06
.quad 0x3e5ebf63bf0a3f7e,0xbeecbec43e063f2d,0xbf373f803f53bf79,0xbedd3f753f15bf7e,0x3f7bbf55bf7b3f55,0x3f7bbf55bf7b3f55,0xbf6e3edd3f7bbf15,0xbf3f3dc93f59be8a
.quad 0x3f133db2bf523e85,0xbdb23f35be85bed8,0xbd06bf153f073dc9,0x3f59bf7fbef13f69,0xbf053f6abe1cbee2,0xbf6f3f0e3f72bf76,0x3f67bf7ebe7e3f3b,0x3e8a3e95bf693f0c
.quad 0xbf7e3f4b3f1cbf6d,0x3f1cbf6d3ec43e06,0x3f42bebfbf5f3f80,0xbf803f623eb4bf3f,0xbe8fbe1c3f7ebf72,0x3f17be48bf663f80,0xbe953f22bf753f46,0x3e95bf223f75bf46
.quad 0xbf00bf00bf003f80,0xbf003f803f80bf00,0xbd5f3f5f3f4dbf70,0x3f7ebf22bf3bbe3d,0x3f17bf80bf793f40,0xbf31be483d863f48,0xbf703f593f7dbef1,0xbe273f623f22bf80
.quad 0x3f7abeecbf583e06,0x3f63bf6dbf7e3f3d,0xbf33bd5f3f113e69,0xbf673e953f50bdf5,0x3e483f0ebe48bf0e,0x3e483f0ebe48bf0e,0x3ebfbf67be533f50,0x3f2bbf7fbf073f77
.quad 0xbf523f7f3f13bf77,0xbf7f3f353f77bf68,0x3f80bf50bf593f7f,0x3f073dc9bf623ed3,0xbf5b3ece3f7dbf66,0x3ebabf553ea53e8f,0x3edd3df5bf783f2f,0xbf773f753ed3bf56
.quad 0x3e06bf1c3f4bbec4,0x3f4bbec4bf6d3f7e,0xbf273f6ebefb3d06,0x3c33bef13f70bf2b,0x3f76bf7d3ddf3ea5,0xbf4e3f7bbee23cb3,0xbf753f463e95bf22,0x3f75bf46be953f22
.quad 0x3f5ea554a554bf5e,0xa554bf5ebf5e3f5e,0xbebfbf15bef13f7f,0xbf593f673f73be7e,0xbe8f3f723f55bf6f,0x3f66be1cbecebf05,0x3f50bf75bf7f3f2f,0xbdc9bf3bbed33f79
.quad 0xbf803f1c3f6dbe9a,0xbf4b3f7a3f74bf58,0x3f42bd06bf22be11,0x3f70bebfbf5c3e53,0xbe48bf0e3e483f0e,0xbe48bf0e3e483f0e,0xbee73f703e95bf5c,0xbf3b3f803f1abf7c
.quad 0x3f68bf77bf353f7f,0x3f77bf13bf7f3f52,0xbf793f223f75bf70,0xbe95beb43f3bbe27,0x3f20bd86bf7b3f31,0xbf293f793cb3bf17,0xbc33bf073f46be9f,0x3f7dbf3fbf423f7d
.quad 0xbf1c3f6dbec4be06,0xbec4be063f7ebf4b,0x3f78bf79bdc93f0c,0xbf153f64bf113df5,0xbf6a3f293f0ebf5b,0x3f7fbf60be733f20,0x3ef1bdc9bf623f7f,0xbef13dc93f62bf7f
.quad 0xbf003f803f80bf00,0x3f80bf00bf00bf00,0x3f6ebf50bf623d9c,0xbf07beddbe9f3f78,0xbf763ea53f0e3eba,0xbee23f7d3f6abf5b,0x3f153e95bdc9bf3b,0x3f7fbf2fbf693e69
.quad 0x3d33bf4bbec43f74,0xbf1cbe5e3e9a3f0a,0xbf273f803f46bf7d,0xbeb43f6e3f02bf7b,0x3f7bbf55bf7b3f55,0x3f7bbf55bf7b3f55,0xbf643eb43f75bf02,0xbf2f3c333f4dbe3d
.quad 0x3ed83e85bf353db2,0xbe853f52bdb2bf13,0x3e69bf463e953eb4,0x3f75bf70bf2f3f7d,0xbf483f7f3e48bf39,0xbf403e733f80bf4e,0x3f80bf59bf223f73,0xbe273f2bbf273e11
.quad 0xbf4b3ec43f6dbf7e,0x3f6dbf7ebe063f1c,0x3e7e3e69bf7f3f56,0xbf503ee73f53bf7e,0x3ecebf403f55bf05,0xbd863ef6bf793f48,0xbf623f7fbef13dc9,0x3f62bf7f3ef1bdc9
.quad 0xbf803f003f003f00,0x3f003f003f00bf80,0x3f553cb3bddfbf48,0x3ecebf7dbf763f40,0xbec4bf0abe9a3f74,0xbf7a3f3d3f63be06,0xbe483f663f29bf7f,0x3f403d86bea5bf0e
.quad 0x3f35bf7fbf683f68,0x3db2bf52bed83f77,0xbf7b3f4e3f80bf31,0xbf5b3f763f6fbf66,0x3f6dbec4bf6d3ec4,0x3f6dbec4bf6d3ec4,0xbf0ebe1c3f31bcb3,0xbe73bef63ece3ea5
.quad 0x248d3f25beafbeaf,0xbf253f7c3eafbf5e,0x3f0ebf72bd863f29,0x3f7fbf40bf663f7b,0xbf6d3f7a3eecbf63,0xbf0abd333f74bf1c,0x3f7bbf39bf483f7e,0xbeba3f4ebef6bd86
.quad 0xbf353e853f77bf77,0x3f77bf77be853f35,0x3e483e8fbf7d3f4e,0xbf483ece3f5bbf7f,0x3ec4bf3d3f58bf0a,0xbd333eecbf7a3f4b,0xbf553f7bbf0e3e48,0x3f55bf7b3f0ebe48
.quad 0xa50dbf5ebf5e3f5e,0xbf5e3f5e3f5ea50d,0xbf0e3f803f7ebf20,0x3f6abe1cbe8fbf29,0x3f6dbf58bf743e9a,0xbe5ebf2dbeec3f7e,0xbf7b3ee23f403d86,0xbf293f7f3f72bf55
.quad 0x3f353db2bed8bed8,0x3f7fbf13bf683e85,0xbe48bf173cb33f39,0xbf05be8f3eba3ee2,0xbec43f6d3ec4bf6d,0xbec43f6d3ec4bf6d,0x3f55bf7dbf393f80,0x3f79bf60bf6a3f72
.quad 0xbf803f443f71bf71,0xbf443e323f71bf00,0x3f55bea5bf7f3f40,0xbd863f29bee2be48,0xbec4be5e3f63beec,0x3f58bf80be9a3f4b,0xbe483f31bf203ddf,0xbf6f3f173f60bf7f
.quad 0x3f35bf773e853e85,0x3e853e85bf773f35,0xbf7b3f763e1cbf17,0x3f20bf6a3f05bd86,0x3f6dbf2dbf0a3f58,0xbf803f633e5ebf1c,0xbf0e3e483f55bf7b,0x3f0ebe48bf553f7b
.quad 0x3f003f003f00bf80,0x3f00bf80bf803f00,0x3e1cbf6abf5b3f66,0xbf803f0e3f293e8f,0xbf3d3f7a3f80bf1c,0x3f0a3ec43e06bf63,0x3f7fbf29bf663e48,0x3ee2bf7bbf553f72
.quad 0xbf523db23f133e85,0xbf7f3f353f77bed8,0x3e8f3f05bddfbf29,0x3f173e48bee2beba,0x3ec4bf6dbec43f6d,0x3ec4bf6dbec43f6d,0xbf603f793f48bf7f,0xbf7d3f553f72bf6a
.quad 0x3f7cbf25bf7c3f5e,0x3f25a554bf5e3eaf,0xbf293d863f72bf0e,0x3ea5bf553e483ee2,0x3d333f0abf2d3e06,0xbf7a3f6d3f1cbf74,0x3f17bf6f3e733ea5,0x3f31be48bf7f3f60
.quad 0xbf773f773e85bf35,0x3e85bf353f35be85,0x3f6abf20bf313f72,0xbf763f7b3d86bf05,0xbeec3d333f74bf7e,0x3f3dbec4bf4b3f7a,0xbe483f0ebf7b3f55,0x3e48bf0e3f7bbf55
.quad 0xbf5e3f5e3f5ea50d,0x3f5ea50da50dbf5e,0x3f7dbecebf05bee2,0xbcb3bf55bf403f76,0xbf2dbe5e3d333f4b,0xbf583f6d3f7ebeec,0x3d863f403ee2bf7b,0x3f66be48bf0ebea5
.quad 0x3f13bf7fbf523f77,0xbdb2bf35be853f68,0xbf763f5b3f7ebf40,0xbf4e3f7b3f66bf6f,0x3f6dbec4bf6d3ec4,0x3f6dbec4bf6d3ec4,0xbef6be733f203d86,0xbe1cbf0e3ea53ece
.quad 0xbe323f44be32bf00,0xbf443f803f00bf71,0x3f40bf7fbea53f55,0x3f72bf0ebf7b3f66,0xbf803f583f3dbf7e,0xbe5ebec43f4bbe9a,0x3f4ebebabf793f72,0xbf393f7bbd86bef6
.quad 0xbe85be853f77bf35,0x3f77bf35bf353f77,0xbece3f48bf393ea5,0xbe8fbe483f7fbf5b,0x3f63bf803e9a3e06,0xbf2d3f6dbf1c3e5e,0xbf7b3f553e48bf0e,0x3f7bbf55be483f0e
.quad 0xbf5e248d248d3f5e,0x248d3f5e3f5ebf5e,0x3edd3f073ed3bf7d,0x3f50bf6ebf783e9f,0x3e1cbf66bf403f79,0xbf723e8f3f053ece,0xbf2f3f7f3f75bf50,0x3e953f153e69bf69
.quad 0x3f7abf4bbf7e3f0a,0x3f1cbf80bf583f74,0xbf6e3eb43f59be3d,0xbf803f273f7bbf02,0x3f0e3e48bf0ebe48,0x3f0e3e48bf0ebe48,0x3c33bf2f3e273f0c,0x3eb4bf64be3d3f4d
.quad 0xbf133f773e85bf52,0xbf773f683f52bf7f,0x3f70bf75bf223f79,0x3f46be69bf7d3f2f,0xbf793f293f66bf7d,0x3d86bf203f17bcb3,0x3f2bbe27bf803f5c,0xbf593f803e11bf27
.quad 0xbe06bec43f6dbf1c,0x3f6dbf1cbf4b3f7e,0xbee73f50bf2f3e8a,0xbe69be7e3f7ebf53,0x3f60bf7f3ea53ddf,0xbf293f6abf203e73,0xbf7f3f623dc9bef1,0x3f7fbf62bdc93ef1
.quad 0x3f00bf80bf803f00,0xbf803f003f003f00,0xbf673f593f69be11,0x3f153ebf3e7ebf73,0x3f7dbee2bf29be73,0x3ea5bf76bf5b3f6a,0xbf3bbdc93e953f15,0xbf753f503f79bed3
.quad 0x3e5e3f1c3e06bf58,0x3f4bbd33bf0abe9a,0x3ebfbf70bf073f7c,0x3d06bf42be533f5c,0xbf553f7b3f55bf7b,0xbf553f7b3f55bf7b,0x3f80bf3bbf7d3f56,0x3f70bee7bf7c3f1a
.quad 0xbf523e853f77bf13,0xbe85bed83f133db2,0x3eb43e95bf463e69,0xbf223f793e27bf3b,0x3e73bf403ee23e1c,0x3f7fbf48bf4e3f80,0xbf3f3f7dbd06bf02,0xbf07bc333f7dbf42
.quad 0x3f7ebf6dbec43f4b,0xbec43f4bbf1c3e06,0xbf643f153f3bbf77,0x3f79bf78bdf53f11,0x3ef6bd86bf723f7e,0xbf403ece3f48bf79,0x3dc9bef13f7fbf62,0xbdc93ef1bf7f3f62
.quad 0x248d3f5e3f5ebf5e,0x3f5ebf5ebf5e248d,0x3f22bf7ebf803f0c,0xbf5f3d5f3e3d3f3b,0xbf7b3f393f60bddf,0x3cb33f4e3f20bf7f,0x3f62be27bf07beb4,0x3f59bf70bf803f22
.quad 0xbec4beec3d333f3d,0xbf633e5e3f2d3e06,0xbe953f673ee7bf77,0x3d5f3f333df5bf50,0x3f55bf7bbf553f7b,0x3f55bf7bbf553f7b,0xbf7f3f2b3f7fbf49,0xbf673ebf3f77bf07
.quad 0x3f35bdb2bf683ed8,0x3db23f13bed8be85,0xbdc9bf073f153d06,0x3f50bf80bed33f62,0xbf0e3f6fbddfbef6,0xbf6a3f053f76bf72,0x3f75bf77bec93f53,0x3df53eddbf563ed3
.quad 0xbf6d3f1c3f4bbf7e,0x3f4bbf7e3e063ec4,0x3ef1bc33bf7d3f72,0xbf6e3f273f2bbf70,0x3e48bf173f6fbf31,0x3e1c3e8fbf803f66,0xbf463f75bf223e95,0x3f46bf753f22be95
.quad 0xbf803f003f003f00,0x3f003f003f00bf80,0x3f463df5bc33bf56,0x3efbbf80bf7c3f2f,0xbe48bf31bef63f7e,0xbf803f173f483d86,0xbef13f7d3f59bf70,0x3f073eb4bd06bf46
.quad 0x3f6dbf63bf803f2d,0x3eecbf7abf3d3f7e,0xbf753edd3f64be8a,0xbf803f373f7ebf15,0x3f0e3e48bf0ebe48,0x3f0e3e48bf0ebe48,0x3dc9bf3f3d9c3f1e,0x3eddbf6ebe8a3f59
.quad 0xbf353f7f3ed8bf68,0xbf7f3f523f68bf77,0x3f7fbf59bf503f80,0x3f153d06bf693ef1,0xbf553eba3f7ebf60,0x3ecebf5b3e8f3ea5,0x3e953e8abf6b3f11,0xbf7e3f673f0cbf69
.quad 0x3ec4bf4b3f1cbe06,0x3f1cbe06bf7e3f6d,0xbf623f80be11beaa,0x3ebfbf423f3fbeb4,0x3f7bbf4ebeba3f39,0xbf7d3f763cb3bee2,0xbf223e953f46bf75,0x3f22be95bf463f75
.quad 0xbf00bf00bf003f80,0xbf003f803f80bf00,0xbf2d3f7c3f80bf00,0x3f58a554be06bf44,0x3f68be32bed8bf00,0x3f13bf80bf773f44,0x3e06bf5ebf1c3f80,0xbf4b248d3ec43f00
.quad 0xbf7c3f443f7cbf00,0xbf253f803f5ebf71,0x3eec3eafbe9abf00,0x3f3da554bf1cbe32,0x3f35bf80bf353f80,0x3f35bf80bf353f80,0xbf633eaf3f74bf00,0xbf2d248d3f4bbe32
.quad 0xbe323f44be32bf00,0xbf443f803f00bf71,0x3f7ebf5ebf4b3f80,0x3f1ca554bf6d3f00,0xbed8be323f68bf00,0x3f52bf80be853f44,0xbf3d3f7cbd33bf00,0xbf0a248d3f7ebf44
.quad 0x3f5ebf00bf5e3f80,0xbf5e3f80a554bf00,0x3e5ebf253f58bf00,0x3eeca554bf7e3f71,0xbf7f3f713db2bf00,0x3f68bf803e853e32,0x3ec4a554bf6d3f80,0xbec4248d3f6dbf80
.quad 0x3f5ebf5ebf5e8000,0xbf5e800080003f5e,0xbf3dbe32bd333f5e,0xbf0a3f803f7ebf25,0xbed83f7c3f68bf5e,0x3f52a50dbe85bf25,0x3f7ebf00bf4b8000,0x3f1cbf80bf6d3f5e
.quad 0xbe32bf25be323f5e,0xbf4480003f003eaf,0xbf633f713f74bf5e,0xbf2d3f803f4bbf7c,0x3f35a50dbf358000,0x3f35a50dbf358000,0x3eecbf71be9a3f5e,0x3f3dbf80bf1c3f7c
.quad 0xbf7c3f253f7cbf5e,0xbf2580003f5ebeaf,0x3e063f00bf1c8000,0xbf4b3f803ec4bf5e,0x3f68bf7cbed83f5e,0x3f13a50dbf773f25,0xbf2d3e323f80bf5e,0x3f58bf80be063f25
.quad 0xbf003f5ebf008000,0xbf0080003f80bf5e,0x3f7abf44bf0a3f5e,0xbf633f80be06beaf,0xbdb2beaf3f7fbf5e,0x3ed8a50dbf773f7c,0xbf6d3f80bec48000,0x3f6dbf803ec4a50d
.quad 0xbf003f803f80bf00,0x3f80bf00bf00bf00,0x3f74be85bec4bf13,0x3e06bf68bf583f68,0x3db2bf5ebf353f7c,0xbf773eaf3f133eaf,0xbf7e3f353f6dbe85,0xbec43f773f4bbf77
.quad 0x3eaf3f00a554bf44,0x3f5ebe32bf25be32,0x3f58bf77bf6d3f68,0x3f1cbf7fbf3d3f7f,0xbf35248d3f35a554,0xbf35248d3f35a554,0xbf0a3f773ec4bf68,0xbf4b3f7f3f2dbf7f
.quad 0x3f71bf00bf803f44,0x3f003e32bf443e32,0x3e06bf353ec43e85,0x3f6dbf77bf1c3f77,0xbf7f3f5e3f35bf7c,0xbe85beaf3f52beaf,0x3e9a3e85bf6d3f13,0xbf7e3f683f0abf68
.quad 0x3f5ebf80248d3f00,0x248d3f00bf5e3f00,0xbf2d3e853f6dbf7f,0x3f7ebf52beec3f52,0xbf133f5ebf353eaf,0x3e85bf253f68bf25,0x3f6dbf35bec43f35,0xbf6d3f353ec4bf35
.quad 0xbf5e800080003f5e,0x80003f5e3f5ebf5e,0xbe9a3f773f6dbf52,0x3f7ebed8bf0abed8,0x3f7fbf00bf35be32,0x3e85bf71bf523f71,0xbe06bf35bec43f77,0xbf6d3e853f1c3e85
.quad 0xbf713f5e3f80bf25,0xbf003f7c3f44bf7c,0x3f0a3e85bec4bed8,0x3f4bbdb2bf2dbdb2,0x3f35bf80bf353f80,0x3f35bf80bf353f80,0xbf583e853f6dbed8,0xbf1cbdb23f3dbdb2
.quad 0xbeaf3f5ea50dbf25,0xbf5e3f7c3f25bf7c,0x3f7ebf35bf6d3f77,0x3ec43e85bf4b3e85,0xbdb2bf003f35be32,0x3f77bf71bf133f71,0xbf743f773ec4bf52,0xbe06bed83f58bed8
.quad 0x3f00a50dbf803f5e,0xbf803f5e3f00bf5e,0x3f3dbf773ec43db2,0xbe063f13bf633f13,0xbf523f003f35bf71,0x3f77bf44bed83f44,0xbec43f35bf6d3f35,0x3ec4bf353f6dbf35
.quad 0xa554bf5ebf5e3f5e,0xbf5e3f5e3f5ea554,0xbf753f423f563c33,0x3ee73f023ec9bf7d,0x3f0e3eba3ddfbf60,0x3f6abf5bbf763ea5,0x3f22bf80bf703f59,0xbeb4bf07be273f62
.quad 0xbf6d3e9a3f3d3d33,0xbf743f583f80bf1c,0xbdc93f4d3e8abf64,0x3e7e3f0cbd9cbf2f,0x3f7bbf55bf7b3f55,0x3f7bbf55bf7b3f55,0xbef1be7e3f1e3d9c,0xbe11bf113e9f3ed3
.quad 0xbf353f7f3ed8bf68,0xbf7f3f523f68bf77,0x3f62bed3bf803f50,0x3d063f15bf07bdc9,0x3e48bf393ef63ddf,0x3f80bf4ebf483f7f,0xbf7f3f643f11bf6b,0x3d9cbf1a3f37be69
.quad 0x3ec43e06bf7e3f4b,0xbf7e3f4b3f1cbf6d,0x3f46bf7b3eaa3e11,0xbe3d3f1ebf5c3f07,0xbf553f053f31bf6f,0x3f79bf48bece3f40,0xbe953f22bf753f46,0x3e95bf223f75bf46
.quad 0x3f80bf00bf00bf00,0xbf00bf00bf003f80,0xbe95bf27bf0c3f80,0xbf643f5c3f6bbe27,0xbf553f6f3f7ebef6,0x3ece3f053e8fbf72,0x3f463d06beb4bf07,0x3f70bf59bf7d3ef1
.quad 0x3ec4bf74bf2d3f80,0xbe9abf0abd333f4b,0xbf7f3f1a3f77bee7,0xbf783f563f7fbf3b,0x3e483f0ebe48bf0e,0x3e483f0ebe48bf0e,0x3f62bf78bf493f7f,0x3f7dbf53bf733f69
.quad 0xbf353db23f68bed8,0xbdb2bf133ed83e85,0xbef13f69bd06bf15,0xbf803f503f59bf7f,0x3f7bbf31bf603f7e,0xbcb33f17bf203d86,0xbdc9bee73f53bec9,0x3f7fbf4dbf333f79
.quad 0xbf6d3f7e3e06bf1c,0x3e06bf1c3f4bbec4,0x3f22be53bf723f7d,0xbf7c3f493f02bf59,0x3f0ebf5b3f39beba,0xbe733f20bf6a3f29,0xbf753f463e95bf22,0x3f75bf46be953f22
.quad 0xbf5e3f5e3f5ea554,0x3f5ea554a554bf5e,0x3f2b3e8a3e11bf69,0x3f1ebf7fbf803f11,0x3f17bf80bf793f40,0xbf31be483d863f48,0xbf693e693f153e95,0xbf503f753f7fbf2f
.quad 0xbe5e3f633f0abf7e,0x3eec3ec4be06bf2d,0x3f80bf2bbf7c3f07,0x3f72bf62bf7d3f49,0xbe48bf0e3e483f0e,0xbe48bf0e3e483f0e,0xbf6b3f723f56bf7d,0xbf803f463f79bf5f
.quad 0x3f133db2bf523e85,0xbdb23f35be85bed8,0x3f2fbf7dbe693f46,0x3f79bf22bf753f70,0xbf5b3ece3f7dbf66,0x3ebabf553ea53e8f,0xbeaa3f49bf02bd06,0xbf5f3ef13f70bf7b
.quad 0x3f7ebf4bbf1c3f6d,0xbf1c3f6dbec4be06,0xbd9cbec93f77bf3b,0x3f33be95bf693f80,0xbf763f7dbddfbea5,0x3f4ebf7b3ee2bcb3,0x3ef1bdc9bf623f7f,0xbef13dc93f62bf7f
.quad 0xbf00bf00bf003f80,0xbf003f803f80bf00,0xbf3f3f773f7dbed3,0x3f493dc9bd06bf53,0x3f4e3cb3be73bf29,0x3f39bf7bbf7f3f20,0x3ed3bf79bf503f75,0xbf15be953dc93f3b
.quad 0xbf7a3eec3f58be06,0xbf633f6d3f7ebf3d,0xbc333f3f3e3dbf59,0x3eaa3ef1be27bf1e,0x3f7bbf55bf7b3f55,0x3f7bbf55bf7b3f55,0xbec9beaa3f0c3e27,0xbd5fbf223e693efb
.quad 0xbf523f7f3f13bf77,0xbf7f3f353f77bf68,0x3f3bbe27bf793f22,0xbe693f46be95beb4,0x3f05bf6a3e1c3ee2,0x3f6fbf0ebf723f76,0xbf723f1e3f5cbf80,0x3efbbf623eb43e53
.quad 0xbe063f1cbf4b3ec4,0xbf4b3ec43f6dbf7e,0x3f7fbf6bbe8a3f2f,0xbf373f75bed3bd5f,0xbe8fbe1c3f7ebf72,0x3f17be48bf663f80,0xbf623f7fbef13dc9,0x3f62bf7f3ef1bdc9
.quad 0x3f00bf80bf803f00,0xbf803f003f003f00,0xbf793ea53ee23f05,0xbd863f603f4ebf6f,0x3d333f4b3f1cbf80,0x3f7ebeecbf2dbe5e,0x3f72bf55bf7b3ee2,0x3e48bf66bf293f7f
.quad 0xbf13be853e853f13,0xbf773ed83f52bdb2,0xbf203f7f3f40bf7e,0xbea53f6a3ef6bf79,0x3f6dbec4bf6d3ec4,0x3f6dbec4bf6d3ec4,0x3ddfbf403d863f20,0x3ee2bf6fbe8f3f5b
.quad 0xbf7c3f5e3f5ebf7c,0xbf5e3eaf3f7cbf25,0x3ee23e48bf553ea5,0xbf0e3f723d86bf29,0x3f3dbf7ebe063f2d,0x3f4bbe9abf803f58,0xbf5b3ee23f72bf79,0x3f29bf763e1c3ece
.quad 0xbe853f35bf353e85,0xbf353e853f77bf77,0x3f80bf66bea53f39,0xbf403f79bebabddf,0xbe9abe063f7ebf74,0x3f1cbe5ebf633f80,0xbf553f7bbf0e3e48,0x3f55bf7b3f0ebe48
.quad 0x3f5ea50da50dbf5e,0xa50dbf5ebf5e3f5e,0x3e73bf72bf663f5b,0xbf7f3ef63f173eba,0xbf803f1c3f4b3d33,0xbe063f633f3dbf7a,0x3ea53f0e3e48bf66,0x3f7bbee2bf40bd86
.quad 0x3f52bf77bf773f52,0x3e85bf68bf133f7f,0xbf483d863f293ddf,0xbf723ece3f60be73,0xbec43f6d3ec4bf6d,0xbec43f6d3ec4bf6d,0x3f7ebf29bf7f3f48,0x3f66bebabf763f05
.quad 0xbe32bf003f003e32,0x3f00bf71be323f44,0xbf663f7b3f0ebf72,0xbf553ea53f7fbf40,0x3f2dbe06bf7e3f3d,0xbf1c3f74bd33bf0a,0x3f05bf663ea53e73,0x3f40be8fbf7d3f6a
.quad 0xbf773f353f35bf77,0x3f35bf773e853e85,0x3cb33ee2bf723f31,0xbf293e733f6fbf7e,0x3f74bf7e3e063e9a,0xbf4b3f7abeec3d33,0xbf0e3e483f55bf7b,0x3f0ebe48bf553f7b
.quad 0xbf803f003f003f00,0x3f003f003f00bf80,0x3e483f393f20bf7e,0x3f6fbf4ebf603d86,0x3f6dbf58bf743e9a,0xbe5ebf2dbeec3f7e,0xbf0ebea53d863f40,0xbf7f3f293f66be48
.quad 0xbf353f7f3f68bf68,0xbdb23f523ed8bf77,0x3f55be1cbf39bcb3,0x3f79bef6bf6a3ea5,0x3ec4bf6dbec43f6d,0x3ec4bf6dbec43f6d,0xbf7b3f173f80bf39,0xbf5b3e8f3f6fbee2
.quad 0x248d3f25beafbeaf,0xbf253f7c3eafbf5e,0x3f7bbf66bf403f7f,0x3f29bd86bf723f0e,0xbec4be5e3f63beec,0x3f58bf80be9a3f4b,0xbf553f803ddfbf20,0xbecebe1c3f76bf29
.quad 0x3f35be85bf773f77,0xbf773f773e85bf35,0x3f0ebf603f17be1c,0x3ddf3ebabf793f40,0xbf6d3f2d3f0abf58,0x3f80bf63be5e3f1c,0xbe483f0ebf7b3f55,0x3e48bf0e3f7bbf55
.quad 0xa50dbf5ebf5e3f5e,0xbf5e3f5e3f5ea50d,0xbf7b3f313f483ddf,0x3eba3f173ef6bf7f,0x3ec43f0a3e9abf74,0x3f7abf3dbf633e06,0x3f55bf72bf7f3f29,0xbd86bf40bee23f7b
.quad 0xbf35bdb23ed83ed8,0xbf7f3f133f68be85,0xbf0e3f7d3f31bf80,0xbe733f603ecebf72,0x3f6dbec4bf6d3ec4,0x3f6dbec4bf6d3ec4,0x3e48bf4ebcb33f31,0x3f05bf76beba3f66
.quad 0xbf803f443f71bf71,0xbf443e323f71bf00,0x3e483ee2bf293d86,0xbf403f7f3ea5bf55,0x3f6dbf7abeec3f63,0x3f0a3d33bf743f1c,0xbf0e3cb33f7ebf48,0x3f6abf7dbe8f3f40
.quad 0xbf353f77be85be85,0xbe85be853f77bf35,0x3f55bef6bf4e3f7d,0xbf7e3f6f3e73bf29,0x3ec4bf3d3f58bf0a,0xbd333eecbf7a3f4b,0xbf7b3f553e48bf0e,0x3f7bbf55be483f0e
.quad 0x3f5ebf5ebf5e248d,0xbf5e248d248d3f5e,0xbf37be53bd9c3f62,0xbf113f803f7fbf1e,0xbef63f7e3f6fbf55,0x3f483d86be48bf31,0x3f79bed3bf3bbdc9,0x3f2fbf7fbf753f50
.quad 0xbd33bf3dbe9a3f6d,0xbf2dbe063ec43eec,0xbf733f5f3f7dbf46,0xbf493f7d3f62bf72,0x3f0e3e48bf0ebe48,0x3f0e3e48bf0ebe48,0x3f27bf7ebf023f75,0x3f5fbf79bf463f80
.quad 0xbf683ed83f7fbf35,0xbed8be853f35bdb2,0xbe273f3bbeb4be95,0xbf703f753f22bf79,0x3f7ebf60bf313f7b,0x3e8f3ea5bf553eba,0xbebfbe3d3f73bf22,0x3f7bbf70bef13f5f
.quad 0xbf4b3f7ebe06bec4,0xbe06bec43f6dbf1c,0x3f4dbeddbf563f7f,0xbf803f693e95bf33,0x3ebabf393f5bbf0e,0xbcb33ee2bf7b3f4e,0xbf7f3f623dc9bef1,0x3f7fbf62bdc93ef1
.quad 0x3f003f003f00bf80,0x3f00bf80bf803f00,0x3f33bf7bbf7f3ef1,0xbf53bd063dc93f49,0xbf603ddf3eba3f0e,0xbf203f7f3f7bbf39,0xbe693f693f2fbf7f,0x3f3b3dc9be95bf15
.quad 0x3f80bf2dbf743ec4,0x3f3dbf7ebf6d3f63,0xbe9fbefb3e113f22,0xbf1ebe273ef13eaa,0xbf553f7b3f55bf7b,0xbf553f7b3f55bf7b,0x3f42bdf5bf5c3e95,0x3efb3e69bf22bd5f
.quad 0x3ed8bf68bdb23f35,0x3f68bf77bf353f7f,0xbf7d3f2f3f70bf75,0xbeb4be953f46be69,0x3ddf3ef6bf393e48,0xbf763f723f0ebf6f,0x3f6ebf7cbe9f3f46,0x3e533eb4bf623efb
.quad 0xbf1c3e063f7ebf6d,0x3f7ebf6dbec43f4b,0xbf1a3f67bf0c3dc9,0xbd5fbed33f75bf37,0x3f6fbf31bf053f55,0xbf803f663e48bf17,0x3dc9bef13f7fbf62,0xbdc93ef1bf7f3f62
.quad 0xbf5e248d248d3f5e,0x248d3f5e3f5ebf5e,0xbeaa3f793f70bf4d,0x3f7dbec9bf02bee7,0x3f7dbee2bf29be73,0x3ea5bf76bf5b3f6a,0xbd06bf46bef13f7d,0xbf623e273f073eb4
.quad 0xbf7a3f4b3f7ebf0a,0xbf1c3f803f58bf74,0x3ec93ed3be69bf11,0x3f2f3d9cbf0cbe7e,0x3f55bf7bbf553f7b,0x3f55bf7bbf553f7b,0xbf333d063f50be53,0xbed3be9f3f113e11
.quad 0xbf133f773e85bf52,0xbf773f683f52bf7f,0x3f69bef1bf7f3f59,0x3dc93f07bf15bd06,0x3e73bf403ee23e1c,0x3f7fbf48bf4e3f80,0xbf803f503f2fbf78,0x3e69bf373f1abd9c
.quad 0x3e063ec4bf6d3f1c,0xbf6d3f1c3f4bbf7e,0x3f73bf7dbd063efb,0xbf073f5cbf1e3e3d,0xbef63d863f72bf7e,0x3f40becebf483f79,0xbf463f75bf223e95,0x3f46bf753f22be95
.quad 0x3f00bf80bf803f00,0xbf803f003f003f00,0xbf723e693eb43f1a,0xbe273f6b3f5cbf64,0xbe1c3f663f40bf79,0x3f72be8fbf05bece,0x3f80bf22bf623e27,0x3ef1bf7dbf593f70
.quad 0xbe5ebf1cbe063f58,0xbf4b3d333f0a3e9a,0xbf6b3f693f79bf53,0xbf3b3f7f3f56bf78,0x3f0e3e48bf0ebe48,0x3f0e3e48bf0ebe48,0x3f37bf80bf153f7b,0x3f69bf73bf533f7d
.quad 0xbf523e853f77bf13,0xbe85bed83f133db2,0xbed33f62bdc9bf07,0xbf7f3f593f50bf80,0x3f79bf29bf663f7d,0xbd863f20bf173cb3,0x3d5fbf153f3bbe7e,0x3f79bf33bf4d3f7f
.quad 0xbf7e3f6d3ec4bf4b,0x3ec4bf4b3f1cbe06,0x3e9f3e27bf803f5f,0xbf593f023f49bf7c,0x3f60bf7f3ea53ddf,0xbf293f6abf203e73,0xbf223e953f46bf75,0x3f22be95bf463f75
.quad 0x3f80bf00bf00bf00,0xbf00bf00bf003f80,0x3ec4bf7cbf743f44,0xbf7a3eaf3eec3f00,0xbf35be323db23f44,0xbf523f713f7fbf00,0xbf6d3f5e3f7ebf00,0xbe063f5e3f1cbf80
.quad 0x248d3f443eafbf71,0x3f253e32beafbf00,0x3f6dbeafbf583e32,0x3f80bf25bf7a3f00,0x3f35bf80bf353f80,0x3f35bf80bf353f80,0xbec4beaf3f0a3e32,0xbd33bf253e5e3f00
.quad 0xbf803f443f71bf71,0xbf443e323f71bf00,0xbec43f5ebe06bf00,0xbf7e3f5e3f4bbf80,0x3f35be32bf7f3f44,0xbf133f71bdb2bf00,0x3f6dbf7cbe9a3f44,0x3e5e3eafbf633f00
.quad 0xa554bf003f5ebf00,0x3f5ebf00bf5e3f80,0xbf6d3f253f2dbf71,0x3f74bf7cbd333f00,0xbf353f71bf133e32,0x3ed8bf443f52bf00,0x3ec4a554bf6d3f80,0xbec4248d3f6dbf80
.quad 0x80003f5e3f5ebf5e,0x3f5ebf5ebf5e8000,0x3f6dbe32be9abf25,0x3e5ebf71bf633f5e,0x3f35bf7cbf7f3f25,0xbf13beafbdb23f5e,0xbec4bf00be063f5e,0xbf7e3f003f4ba50d
.quad 0xbf803f253f71beaf,0xbf443f7c3f71bf5e,0xbec43f713f0abf7c,0xbd333f443e5ebf5e,0x3f35a50dbf358000,0x3f35a50dbf358000,0x3f6dbf71bf583f7c,0x3f80bf44bf7a3f5e
.quad 0xa50dbf253eaf3eaf,0x3f25bf7cbeaf3f5e,0xbf6d3f003f7ebf5e,0xbe06bf003f1ca50d,0xbf353f7c3db2bf25,0xbf523eaf3f7fbf5e,0x3ec43e32bf743f25,0xbf7a3f713eecbf5e
.quad 0x3f80bf5ebf003f5e,0xbf003f5ebf008000,0x3ec4bf443f3dbeaf,0x3e9a3e32bf803f5e,0xbf353eaf3f52bf7c,0x3f68bf25bf133f5e,0xbf6d3f80bec48000,0x3f6dbf803ec4a50d
.quad 0xbf00bf00bf003f80,0xbf003f803f80bf00,0xbf803f133f2d3e85,0x3e5e3f353f1cbf7f,0xbed83f7c3f68bf5e,0x3f52a554be85bf25,0x3f1c3e85be06bf35,0x3f7ebf35bf6d3e85
.quad 0x3f7cbf44bf7c3f00,0x3f25bf80bf5e3f71,0x3e9abf68beec3f77,0xbd33bf35be063f52,0xbf35248d3f35a554,0xbf35248d3f35a554,0xbf743f683f63bf77,0xbf803f353f7ebf52
.quad 0xbe323f44be32bf00,0xbf443f803f00bf71,0x3f4bbe85bf7e3f35,0xbe063f35bec4be85,0x3f68bf7cbed83f5e,0x3f13a554bf773f25,0x3d33bf133f3dbe85,0x3f7abf35bf4b3f7f
.quad 0xbf5e3f003f5ebf80,0x3f5ebf80248d3f00,0xbf583f7fbe5ebe85,0x3e9abf353f4bbed8,0x3db23eafbf7f3f5e,0xbed8248d3f77bf7c,0x3f6dbf35bec43f35,0xbf6d3f353ec4bf35
.quad 0x3f5ebf5ebf5e8000,0xbf5e800080003f5e,0xbd33bf52bf3d3f77,0xbf7a3f353f4b3db2,0xbf683e323ed83f00,0xbf133f803f77bf44,0xbf4b3f773f7ebf35,0x3e063f353ec4bf77
.quad 0x3e323f253e32bf5e,0x3f44a50dbf00beaf,0x3f74bed8bf633e85,0x3f80bf35bf7e3f13,0x3f35bf80bf353f80,0x3f35bf80bf353f80,0xbe9abed83eec3e85,0x3d33bf353e063f13
.quad 0xbf7c3f253f7cbf5e,0xbf2580003f5ebeaf,0xbf1c3f773e06bf35,0xbf7e3f353f6dbf77,0x3ed83e32bf683f00,0xbf523f803e85bf44,0x3f80bf52bf2d3f77,0xbe5e3f35bf1c3db2
.quad 0x3f00bf5e3f00a50d,0x3f00a50dbf803f5e,0xbf0a3db23f7abf77,0x3f74bf35bf1c3f68,0xbf7f3f713db2bf00,0x3f68bf803e853e32,0xbec43f35bf6d3f35,0x3ec4bf353f6dbf35
.quad 0x3f5ea554a554bf5e,0xa554bf5ebf5e3f5e,0x3f4dbf70bf793eaa,0xbf3bbe3dbd5f3f5f,0xbe73bf29bee23f7d,0xbf7f3f203f4e3cb3,0xbf7d3ef13f463d06,0xbf223f803f70bf59
.quad 0xbf0a3f7e3f4bbf7a,0x3e063f2d3e5ebf63,0x3f113e69bed3bec9,0x3f50bdf5bf33bd5f,0x3f7bbf55bf7b3f55,0x3f7bbf55bf7b3f55,0x3e53bf50bd063f33,0x3f07bf77bebf3f67
.quad 0xbf523e853f77bf13,0xbe85bed83f133db2,0xbf593f7f3ef1bf69,0xbf623ed33f80bf50,0x3e1c3ee2bf403e73,0xbf723f763f05bf6a,0x3f78bf2fbf503f80,0xbed33f56beddbdf5
.quad 0x3f1cbf6d3ec43e06,0x3ec43e06bf7e3f4b,0xbefb3d063f7dbf73,0x3f70bf2bbf273f6e,0xbf7e3f723d86bef6,0x3f66bf803e8f3e1c,0xbe953f22bf753f46,0x3e95bf223f75bf46
.quad 0xbf003f803f80bf00,0x3f80bf00bf00bf00,0x3f1a3eb43e69bf72,0x3f2fbf7cbf803efb,0x3f79bf40bf663e1c,0xbd86bf48bf173f80,0x3e27bf62bf223f80,0xbf46bd063eb43f07
.quad 0xbf583e063f1c3e5e,0xbf7e3f3d3f7abeec,0xbf533f793f69bf6b,0xbf153f7e3f37bf80,0x3e483f0ebe48bf0e,0x3e483f0ebe48bf0e,0x3f7bbf15bf803f37,0x3f59be8abf6e3edd
.quad 0x3f13bf77be853f52,0x3f77bf68bf523f7f,0xbf07bdc93f62bed3,0x3ef1bf693d063f15,0xbf7d3f663f29bf79,0xbea5be8f3f5bbece,0xbe7e3f3bbf153d5f,0xbf693f0c3f67bf7e
.quad 0x3f4bbec4bf6d3f7e,0xbf6d3f7e3e06bf1c,0x3f5fbf803e273e9f,0xbeb43f3fbf423ebf,0xbddfbea53f7fbf60,0x3ee2bcb3bf763f7d,0xbf753f463e95bf22,0x3f75bf46be953f22
.quad 0xa554bf5ebf5e3f5e,0xbf5e3f5e3f5ea554,0xbf623d9c3e533f37,0xbe9f3f783f6ebf50,0xbf553f6f3f7ebef6,0x3ece3f053e8fbf72,0x3dc93f3b3ed3bf79,0x3f69be69bf15be95
.quad 0x3f6dbe9abf3dbd33,0x3f74bf58bf803f1c,0x3f46bf7dbf5f3f73,0x3f02bf7bbf273f80,0xbe48bf0e3e483f0e,0xbe48bf0e3e483f0e,0xbf753f023f7ebf27,0xbf4d3e3d3f64beb4
.quad 0xbf353f7f3ed8bf68,0xbf7f3f523f68bf77,0x3e953eb4bf3b3e27,0xbf2f3f7d3e69bf46,0x3f7bbf31bf603f7e,0xbcb33f17bf203d86,0x3f22bf733e3d3ebf,0x3f27be11bf803f59
.quad 0xbec4be063f7ebf4b,0x3f7ebf4bbf1c3f6d,0xbf7f3f563eddbf4d,0x3f53bf7e3e7e3e69,0xbf0e3f5bbf393eba,0x3e73bf203f6abf29,0x3ef1bdc9bf623f7f,0xbef13dc93f62bf7f
.quad 0x3f80bf00bf00bf00,0xbf00bf00bf003f80,0x3ef1bf7fbf7b3f33,0xbf733e7e3ebf3f15,0xbf0ebebabddf3f60,0xbf6a3f5b3f76bea5,0xbf7f3f2f3f69be69,0xbed33f793f50bf75
.quad 0xbec43f743f2dbf80,0x3e9a3f0a3d33bf4b,0x3f223e11befbbe9f,0x3f5cbe53bf423d06,0x3f7bbf55bf7b3f55,0x3f7bbf55bf7b3f55,0x3e95bf5cbdf53f42,0x3f1abf7cbee73f70
.quad 0xbf353db23f68bed8,0xbdb2bf133ed83e85,0xbf753f703f2fbf7d,0xbf3b3e273f79bf22,0xbe483f39bef6bddf,0xbf803f4e3f48bf7f,0x3f46be9fbf7c3f6e,0xbf423f7dbc33bf07
.quad 0x3f6dbf7ebe063f1c,0xbe063f1cbf4b3ec4,0x3dc9bf0c3f67bf1a,0x3f11bdf5bf783f79,0xbf553f053f31bf6f,0x3f79bf48bece3f40,0xbf623f7fbef13dc9,0x3f62bf7f3ef1bdc9
.quad 0x3f003f003f00bf80,0x3f00bf80bf803f00,0x3f7ebf20bf39be48,0xbe8fbf29bf0e3f80,0x3e9abf74bf583f6d,0xbf633e063ec43f0a,0xbf40bd863ea53f0e,0xbf723f553f7bbee2
.quad 0xbf683f683f7fbf35,0xbed83f773f35bf7f,0x3cb33f393e1cbf55,0x3eba3ee2be48bf17,0x3f6dbec4bf6d3ec4,0x3f6dbec4bf6d3ec4,0x3f39bf80bf173f7b,0x3f6abf72bf553f7d
.quad 0xbeafbeaf3f25a554,0x3eafbf5e248d3f25,0xbf7f3f403f66bf7b,0xbee2be483f55bea5,0xbeec3f63be5ebec4,0xbf743f1c3f6dbf7a,0x3f20bddfbf803f55,0xbf603f7f3e48bf31
.quad 0x3f77bf77be853f35,0xbe853f35bf353e85,0x3e1cbf173f60bf0e,0x3f05bd86bf7b3f76,0xbf583f0a3f2dbf6d,0x3f7abf4bbec43f3d,0xbf553f7bbf0e3e48,0x3f55bf7b3f0ebe48
.quad 0xbf5e3f5e3f5ea50d,0x3f5ea50da50dbf5e,0x3ddf3f483f31bf7b,0x3f76bf40bf55bcb3,0x3f74be9abf0abec4,0x3eecbf7ebf6d3f58,0x3f29bf7fbf723f55,0xbea5bf0ebe483f66
.quad 0xbed8bed83db23f35,0xbf683e853f353db2,0xbf803f313f7dbf0e,0xbf6f3f663f7bbf4e,0xbec43f6d3ec4bf6d,0xbec43f6d3ec4bf6d,0x3f31bcb3bf4e3e48,0x3ece3ea5bf0ebe1c
.quad 0x3f71bf71bf443f80,0x3f71bf00bf803f44,0x3d86bf293ee23e48,0x3f66bf7bbf0e3f72,0xbf633eec3f7abf6d,0x3e9abf4b3ec43e5e,0xbf483f7e3cb3bf0e,0xbef6bd863f7bbf39
.quad 0x3e853e85bf773f35,0xbf773f353f35bf77,0x3f7dbf4ebef63f55,0xbf5b3f7fbe48be8f,0x3f0abf583f3dbec4,0xbe5e3f1cbf6d3f2d,0xbf0e3e483f55bf7b,0x3f0ebe48bf553f7b
.quad 0x3f00bf80bf803f00,0xbf803f003f003f00,0xbf05bee2bea53f79,0xbf403f763f7dbece,0xbf803f1c3f4b3d33,0xbe063f633f3dbf7a,0xbee23f7b3f55bf72,0x3f0e3ea5bd86bf40
.quad 0x3f133e85be85bf13,0x3f77bed8bf523db2,0x3f7ebf40bf7f3f20,0x3f66bf6fbf763f5b,0x3ec4bf6dbec43f6d,0x3ec4bf6dbec43f6d,0xbf20bd863f40bddf,0xbea5bece3ef63e73
.quad 0xbf7c3f5e3f5ebf7c,0xbf5e3eaf3f7cbf25,0xbea53f55be48bee2,0xbf7b3f663f40bf7f,0x3f2dbe06bf7e3f3d,0xbf1c3f74bd33bf0a,0x3f79bf72bee23f5b,0x3d863ef6bf4e3eba
.quad 0x3e85bf353f35be85,0x3f35be85bf773f77,0xbf393ea53f66bf80,0x3f7fbf5bbece3f48,0xbf743f7ebe06be9a,0x3f4bbf7a3eecbd33,0xbe483f0ebf7b3f55,0x3e48bf0e3f7bbf55
.quad 0x3f5ea50da50dbf5e,0xa50dbf5ebf5e3f5e,0x3f5bbf66bf723e73,0xbf29be8fbe1c3f6a,0xbd33bf4bbf1c3f80,0xbf7e3eec3f2d3e5e,0xbf663e483f0e3ea5,0xbf553f723f7fbf29
.quad 0xbf523f773f77bf52,0xbe853f683f13bf7f,0x3ddf3f293d86bf48,0x3ee23ebabe8fbf05,0x3f6dbec4bf6d3ec4,0x3f6dbec4bf6d3ec4,0x3f48bf7fbf293f7e,0x3f72bf6abf603f79
.quad 0xbe32bf003f003e32,0x3f00bf71be323f44,0xbf723f0e3f7bbf66,0xbe48bee23f29bd86,0xbf3d3f7e3e06bf2d,0xbf4b3e9a3f80bf58,0x3e733ea5bf663f05,0xbf7f3f603f17bf6f
.quad 0x3f77bf35bf353f77,0xbf353f77be85be85,0x3f31bf723ee23cb3,0xbd863f05bf6a3f20,0xbe9abe063f7ebf74,0x3f1cbe5ebf633f80,0xbf7b3f553e48bf0e,0x3f7bbf55be483f0e
.quad 0x248d3f5e3f5ebf5e,0x3f5ebf5ebf5e248d,0x3f69be11be8abf2b,0x3e7ebf73bf673f59,0x3f40bf79bf803f17,0xbf05becebe1c3f66,0xbe95bf15be693f69,0xbf793ed33f3b3dc9
.quad 0xbf7e3f0a3f63be5e,0xbf583f743f7abf4b,0xbf073f7c3f2bbf80,0xbe533f5c3ebfbf70,0x3f0e3e48bf0ebe48,0x3f0e3e48bf0ebe48,0x3f7dbf56bf723f6b,0x3f7cbf1abf803f3b
.quad 0x3e85bf523db23f13,0x3f52bf7fbf133f77,0xbf463e693f7dbf2f,0x3e27bf3b3eb43e95,0xbf663f7d3ecebf5b,0xbf173cb33f79bf29,0x3d063f02bf493eaa,0xbf7d3f423f3fbf7d
.quad 0x3f6dbf1cbf4b3f7e,0xbf4b3f7ebe06bec4,0x3f3bbf773ec93d9c,0xbdf53f11bf643f15,0xbea5bddf3f7dbf76,0x3f20be73bf603f7f,0xbf7f3f623dc9bef1,0x3f7fbf62bdc93ef1
.quad 0xbf803f003f003f00,0x3f003f003f00bf80,0xbed33f7d3f77bf3f,0x3f78be9fbeddbf07,0x3f293e73bcb3bf4e,0x3f5bbf6abf7d3ee2,0x3f75bf50bf793ed3,0x3e69bf69bf2f3f7f
.quad 0x3e06bf58beec3f7a,0xbf0abe9a3e5e3f1c,0xbf593e3d3f3fbc33,0xbf7b3f023f6ebeb4,0xbf553f7b3f55bf7b,0xbf553f7b3f55bf7b,0x3e273f0cbeaabec9,0xbe3d3f4d3c33bf2f
.quad 0x3f77bf13bf7f3f52,0x3f133db2bf523e85,0x3f22bf79be273f3b,0x3f7dbf2fbf703f75,0xbee2be1c3f6abf05,0x3f4ebf80be733f40,0xbf803f5c3f1ebf72,0x3e11bf273f2bbe27
.quad 0xbec43f4bbf1c3e06,0xbf1c3e063f7ebf6d,0x3f2fbe8abf6b3f7f,0xbf7e3f533ee7bf50,0x3f72bf7e3e1c3e8f,0xbf483f79bef63d86,0x3dc9bef13f7fbf62,0xbdc93ef1bf7f3f62
.quad 0x3f5ebf5ebf5e248d,0xbf5e248d248d3f5e,0xbc33bf56bf423f75,0xbf7c3f2f3f463df5,0xbf603ddf3eba3f0e,0xbf203f7f3f7bbf39,0xbf593f703f80bf22,0x3d063f463ef1bf7d
.quad 0x3d333f3d3e9abf6d,0x3f2d3e06bec4beec,0x3f64be8abf4d3dc9,0x3f7ebf15bf753edd,0x3f55bf7bbf553f7b,0x3f55bf7bbf553f7b,0xbd9cbf1e3e7e3ef1,0x3e8abf59bdc93f3f
.quad 0xbf683ed83f7fbf35,0xbed8be853f35bdb2,0xbf503f803ed3bf62,0xbf693ef13f7fbf59,0x3ddf3ef6bf393e48,0xbf763f723f0ebf6f,0x3f6bbf11bf643f7f,0xbf0c3f69be95be8a
.quad 0x3f4bbf7e3e063ec4,0x3e063ec4bf6d3f1c,0xbe11beaa3f7bbf46,0x3f3fbeb4bf623f80,0xbf6f3f313f05bf55,0x3f80bf66be483f17,0xbf463f75bf223e95,0x3f46bf753f22be95
.quad 0x3f003f003f00bf80,0x3f00bf80bf803f00,0x3f80bf0cbf27be95,0xbe3dbf3bbf223f7e,0x3ef6bf7ebf6f3f55,0xbf48bd863e483f31,0xbf07beb43d063f46,0xbf803f223f62be27
.quad 0xbf803f2d3f74bec4,0xbf3d3f7e3f6dbf63,0xbee73f773f1abf7f,0xbdf53f503e95bf67,0x3f0e3e48bf0ebe48,0x3f0e3e48bf0ebe48,0x3f7fbf49bf783f62,0x3f77bf07bf7f3f2b
.quad 0x3ed8bf68bdb23f35,0x3f68bf77bf353f7f,0xbf15bd063f69bef1,0x3ed3bf623dc93f07,0xbf7e3f603f31bf7b,0xbe8fbea53f55beba,0xbec93f53bee7bdc9,0xbf563ed33f75bf77
.quad 0x3f1cbe06bf7e3f6d,0xbf7e3f6d3ec4bf4b,0x3f7dbf72be533f22,0xbf2b3f70bef13c33,0x3ebabf393f5bbf0e,0xbcb33ee2bf7b3f4e,0xbf223e953f46bf75,0x3f22be95bf463f75
.quad 0xbf003f803f80bf00,0x3f80bf00bf00bf00,0xbd333f5e3f4bbf71,0x3f7ebf25bf3dbe32,0x3ed83f003e85bf71,0x3f77bf44bf683e32,0x3f4ba554bec4bf00,0x3f6dbf5ebf7e3f00
.quad 0x3f7cbf00bf5e3e32,0x3f5ebf71bf7c3f44,0x3f74bf5ebf7e3f44,0x3f4bbf7cbf633f71,0x3f35bf80bf353f80,0x3f35bf80bf353f80,0x3e9abf5ebe063f44,0x3f1cbf7cbeec3f71
.quad 0xbe32bf003f003e32,0x3f00bf71be323f44,0xbf1c248d3f6dbf00,0x3ec4bf5e3e063f00,0xbf683f003f77bf71,0x3e85bf443ed83e32,0xbf803f5e3f1cbf71,0x3e06bf253f2dbe32
.quad 0xbf5e3f80a554bf00,0xa554bf003f5ebf00,0xbf0a3f5ebf1c3e32,0xbe06beaf3f7abf44,0xbdb23f00bf773f44,0xbe85be323f7fbf71,0x3ec4a554bf6d3f80,0xbec4248d3f6dbf80
.quad 0xbf5e800080003f5e,0x80003f5e3f5ebf5e,0xbf803f003f1c3eaf,0x3e063f443f2dbf7c,0xbf683f5e3f77beaf,0x3e853f253ed8bf7c,0xbf1c3f803f6dbf5e,0x3ec43f003e06bf5e
.quad 0xbe323f5e3f00bf7c,0x3f003eafbe32bf25,0x3e9a3f00be06bf25,0x3f1c3e32beecbeaf,0x3f35a50dbf358000,0x3f35a50dbf358000,0x3f74bf00bf7e3f25,0x3f4bbe32bf633eaf
.quad 0x3f7cbf5ebf5e3f7c,0x3f5ebeafbf7c3f25,0x3f4bbf80bec43f5e,0x3f6dbf00bf7e3f5e,0x3ed8bf5e3e853eaf,0x3f77bf25bf683f7c,0xbd33bf003f4bbeaf,0x3f7ebf44bf3d3f7c
.quad 0xbf0080003f80bf5e,0x3f80bf5ebf003f5e,0xbf583f003f4bbf7c,0x3f7ebf71be5e3f25,0xbf7f3f5e3e85bf25,0x3f77bf7c3db23eaf,0xbf6d3f80bec48000,0x3f6dbf803ec4a50d
.quad 0x3f80bf00bf00bf00,0xbf00bf00bf003f80,0x3f6dbf52bf633db2,0xbf0abed8be9a3f77,0x3f35bf7cbf7f3f25,0xbf13beafbdb23f5e,0x3ec4bf77bf4b3f77,0xbf1cbe853e063f35
.quad 0xa554bf44beaf3f71,0xbf25be323eaf3f00,0xbec4bed83e5e3f13,0xbf2dbdb23f0a3e85,0xbf35248d3f35a554,0xbf35248d3f35a554,0xbf6d3ed83f7abf13,0xbf3d3db23f58be85
.quad 0xbf803f443f71bf71,0xbf443e323f71bf00,0xbf6d3f773f1cbf77,0xbf4b3e853f7ebf35,0xbf353f7c3db2bf25,0xbf523eaf3f7fbf5e,0xbec43f52beecbdb2,0xbf583ed83f74bf77
.quad 0x248d3f00bf5e3f00,0xbf5e3f003f5ebf80,0x3ec43db2bf803f68,0xbf633f133f3dbf77,0x3f35beafbf523f7c,0xbf683f253f13bf5e,0x3f6dbf35bec43f35,0xbf6d3f353ec4bf35
.quad 0x80003f5e3f5ebf5e,0x3f5ebf5ebf5e8000,0x3ec43f133eecbf7f,0x3f58bf68bf743e85,0x3f353e32bdb2bf44,0x3f52bf71bf7f3f00,0x3f6dbe85bf1cbe85,0x3f4bbf77bf7e3f35
.quad 0x3f80bf25bf713eaf,0x3f44bf7cbf713f5e,0x3f6dbf68bf7a3f52,0x3f3dbf7fbf583f77,0x3f35bf80bf353f80,0x3f35bf80bf353f80,0x3ec4bf68be5e3f52,0x3f2dbf7fbf0a3f77
.quad 0xa50dbf253eaf3eaf,0x3f25bf7cbeaf3f5e,0xbec4be853f4bbe85,0x3f1cbf77be063f35,0xbf353e323f7fbf44,0x3f13bf713db23f00,0xbf6d3f133f63bf7f,0x3f0abf683e9a3e85
.quad 0xbf803f5e3f00bf5e,0x3f00bf5e3f00a50d,0xbf6d3f7fbd33bed8,0x3eecbf523f2dbe85,0xbf353f71bf133e32,0x3ed8bf443f52bf00,0xbec43f35bf6d3f35,0x3ec4bf353f6dbf35
.quad 0xbf5e3f5e3f5ea554,0x3f5ea554a554bf5e,0xbf0c3f803f7ebf22,0x3f6bbe27be95bf27,0xbddf3f603f39bf7b,0x3f76bea5bf0ebeba,0x3eb43f073e27bf62,0x3f7dbef1bf46bd06
.quad 0x3f3d3d33beecbec4,0x3f80bf1cbf6d3e9a,0x3f77bee7bf673e95,0x3f7fbf3bbf7f3f1a,0x3f7bbf55bf7b3f55,0x3f7bbf55bf7b3f55,0x3f49bf7fbf2b3f7f,0x3f73bf69bf623f78
.quad 0x3ed8bf68bdb23f35,0x3f68bf77bf353f7f,0xbd06bf153f073dc9,0x3f59bf7fbef13f69,0xbef6bddf3f6fbf0e,0x3f48bf7fbe483f39,0xbf533ec93f77bf75,0x3f33bf793dc93ee7
.quad 0xbf7e3f4b3f1cbf6d,0x3f1cbf6d3ec43e06,0xbf723f7d3c33bef1,0x3f02bf593f22be53,0xbf313f6fbf173e48,0x3ecebf403f55bf05,0xbe953f22bf753f46,0x3e95bf223f75bf46
.quad 0xbf00bf00bf003f80,0xbf003f803f80bf00,0xbf56bc333df53f46,0xbec93f7d3f75bf42,0xbf7e3ef63f313e48,0xbe8f3f723f55bf6f,0xbf703f593f7dbef1,0xbe273f623f22bf80
.quad 0xbf2d3f803f63bf6d,0xbd333f4b3ec4bf74,0xbe8a3f643eddbf75,0x3d9c3f2f3dc9bf4d,0x3e483f0ebe48bf0e,0x3e483f0ebe48bf0e,0x3f1e3d9cbf3f3dc9,0x3e9f3ed3bef1be7e
.quad 0x3f68bed8bf7f3f35,0x3ed83e85bf353db2,0x3f80bf50bf593f7f,0x3f073dc9bf623ed3,0x3f60bf7ebeba3f55,0x3f20bd86bf7b3f31,0x3f11bf6b3e8a3e95,0x3f37be69bf7f3f64
.quad 0x3e06bf1c3f4bbec4,0x3f4bbec4bf6d3f7e,0xbeaabe113f80bf62,0x3f5cbf07bf463f7b,0xbf393eba3f4ebf7b,0x3f6abf29bf0e3f5b,0xbf753f463e95bf22,0x3f75bf46be953f22
.quad 0x3f5ea554a554bf5e,0xa554bf5ebf5e3f5e,0x3f7dbed3bf07bedd,0xbd06bf53bf3f3f77,0x3f79bf40bf663e1c,0xbd86bf48bf173f80,0x3f50bf75bf7f3f2f,0xbdc9bf3bbed33f79
.quad 0x3f0abf7ebf4b3f7a,0xbe06bf2dbe5e3f63,0x3e3dbf59beb43f6e,0xbe27bf1ebc333f3f,0xbe48bf0e3e483f0e,0xbe48bf0e3e483f0e,0xbf0cbe273f2fbc33,0xbe69befb3ec93eaa
.quad 0xbf523e853f77bf13,0xbe85bed83f133db2,0xbf793f223f75bf70,0xbe95beb43f3bbe27,0xbf7d3f663f29bf79,0xbea5be8f3f5bbece,0xbf5c3f803e27bf2b,0xbeb4be533f72bf1e
.quad 0xbf1c3f6dbec4be06,0xbec4be063f7ebf4b,0xbe8a3f2fbf503ee7,0xbed3bd5f3f7fbf6b,0x3ddf3ea5bf7f3f60,0xbee23cb33f76bf7d,0x3ef1bdc9bf623f7f,0xbef13dc93f62bf7f
.quad 0xbf003f803f80bf00,0x3f80bf00bf00bf00,0xbe113f693f59bf67,0x3f80bf11bf2bbe8a,0x3e733f293ee2bf7d,0x3f7fbf20bf4ebcb3,0x3f153e95bdc9bf3b,0x3f7fbf2fbf693e69
.quad 0x3f58be06bf1cbe5e,0x3f7ebf3dbf7a3eec,0x3f7cbf07bf703ebf,0x3f7dbf49bf803f2b,0x3f7bbf55bf7b3f55,0x3f7bbf55bf7b3f55,0x3f56bf7dbf3b3f80,0x3f79bf5fbf6b3f72
.quad 0x3f13bf77be853f52,0x3f77bf68bf523f7f,0x3e69bf463e953eb4,0x3f75bf70bf2f3f7d,0xbe1cbee23f40be73,0x3f72bf76bf053f6a,0xbf02bd063f7dbf3f,0x3f70bf7bbeaa3f49
.quad 0xbf4b3ec43f6dbf7e,0x3f6dbf7ebe063f1c,0xbf773f3b3f15bf64,0x3f69bf803d9c3ec9,0xbf7e3f723d86bef6,0x3f66bf803e8f3e1c,0xbf623f7fbef13dc9,0x3f62bf7f3ef1bdc9
.quad 0xbf803f003f003f00,0x3f003f003f00bf80,0xbf663f5b3f6abe1c,0x3f173eba3e73bf72,0xbf1c3f803f7abf3d,0x3f2d3e5ebd33bf4b,0xbe483f663f29bf7f,0x3f403d86bea5bf0e
.quad 0x3e853f133db2bf52,0x3f52bdb2bf13be85,0x3f293ddfbf05be8f,0x3f60be73bf483d86,0x3f6dbec4bf6d3ec4,0x3f6dbec4bf6d3ec4,0x3f7fbf48bf793f60,0x3f76bf05bf7e3f29
.quad 0x3f5ebf7cbf253f7c,0x3f7cbf25bf7c3f5e,0x3f0ebf72bd863f29,0x3f7fbf40bf663f7b,0x3e06bf2d3f0a3d33,0x3f80bf58bf3d3f7e,0xbea5be733f6fbf17,0x3f7dbf6abf053f66
.quad 0xbf353e853f77bf77,0x3f77bf77be853f35,0xbf723f313f20bf6a,0x3f6fbf7e3cb33ee2,0xbf7e3f743d33beec,0x3f63bf803e9a3e06,0xbf553f7bbf0e3e48,0x3f55bf7b3f0ebe48
.quad 0xa50dbf5ebf5e3f5e,0xbf5e3f5e3f5ea50d,0xbee2bf05bece3f7d,0xbf4e3f6f3f79bea5,0xbf4bbd333e5e3f2d,0xbf3d3f7a3f80bf1c,0xbf7b3ee23f403d86,0xbf293f7f3f72bf55
.quad 0xbf773f523f7fbf13,0xbf133f7f3f52bf77,0xbf403f7e3f5bbf76,0xbef63f793f20bf7f,0xbec43f6d3ec4bf6d,0xbec43f6d3ec4bf6d,0x3d863f20be73bef6,0xbe8f3f5b3ddfbf40
.quad 0x3f003e32bf443e32,0xbe323f44be32bf00,0x3f55bea5bf7f3f40,0xbd863f29bee2be48,0x3f7ebf3dbf583f80,0x3d333f0abf2d3e06,0x3f72bf79beba3f4e,0x3e1c3ecebf5b3ee2
.quad 0x3f35bf773e853e85,0x3e853e85bf773f35,0x3ea5bf393f48bece,0x3eba3ddfbf803f66,0xbe06be9a3f80bf63,0x3eecbd33bf743f7e,0xbf0e3e483f55bf7b,0x3f0ebe48bf553f7b
.quad 0x3f003f003f00bf80,0x3f00bf80bf803f00,0x3f483ddfbcb3bf55,0x3ef6bf7fbf7b3f31,0x3f74be9abf0abec4,0x3eecbf7ebf6d3f58,0x3f7fbf29bf663e48,0x3ee2bf7bbf553f72
.quad 0x3f68bf68bf7f3f35,0x3ed8bf77bf353f7f,0x3f31bf80bf4e3f7b,0x3ecebf72bf0e3f7d,0x3ec4bf6dbec43f6d,0x3ec4bf6dbec43f6d,0x3cb3bf313e1c3f0e,0x3ebabf66be483f4e
.quad 0xbeafbeaf3f25a554,0x3eafbf5e248d3f25,0xbf293d863f72bf0e,0x3ea5bf553e483ee2,0xbf633eec3f7abf6d,0x3e9abf4b3ec43e5e,0xbf7e3f483f39bf7b,0x3e8fbf403f0ebcb3
.quad 0xbf773f773e85bf35,0x3e85bf353f35be85,0xbf4e3f7dbe8fbe48,0x3e73bf293f55bef6,0xbf0a3f58bf3d3ec4,0x3e5ebf1c3f6dbf2d,0xbe483f0ebf7b3f55,0x3e48bf0e3f7bbf55
.quad 0xbf5e3f5e3f5ea50d,0x3f5ea50da50dbf5e,0xbf203f7e3f80bf0e,0x3f60bd86be48bf39,0xbe9a3f743f58bf6d,0x3f63be06bec4bf0a,0x3d863f403ee2bf7b,0x3f66be48bf0ebea5
.quad 0x3ed83ed8bdb2bf35,0x3f68be85bf35bdb2,0x3f393cb3bf17be48,0x3f6abea5bf553e1c,0x3f6dbec4bf6d3ec4,0x3f6dbec4bf6d3ec4,0x3f80bf39bf7d3f55,0x3f6fbee2bf7b3f17
.quad 0x3f71bf71bf443f80,0x3f71bf00bf803f44,0x3f40bf7fbea53f55,0x3f72bf0ebf7b3f66,0x3eecbf633e5e3ec4,0x3f74bf1cbf6d3f7a,0x3ddfbf203f31be48,0x3f76bf29bf553f80
.quad 0xbe85be853f77bf35,0x3f77bf35bf353f77,0xbf173e1c3f76bf7b,0x3f79bf40bf0e3f60,0xbf583f0a3f2dbf6d,0x3f7abf4bbec43f3d,0xbf7b3f553e48bf0e,0x3f7bbf55be483f0e
.quad 0xbf5e248d248d3f5e,0x248d3f5e3f5ebf5e,0xbf7f3ef13f153ebf,0x3dc93f493f33bf7b,0xbf6f3f553f72be8f,0x3e483f313ef6bf7e,0xbf2f3f7f3f75bf50,0x3e953f153e69bf69
.quad 0xbe9a3f6d3f1cbf80,0x3ec43eecbd33bf3d,0x3e113f223d06bf42,0x3ef13eaabe9fbefb,0x3f0e3e48bf0ebe48,0x3f0e3e48bf0ebe48,0x3f5cbe95bf703ee7,0x3f223d5fbf423df5
.quad 0x3f7fbf35bf773f68,0x3f35bdb2bf683ed8,0x3f70bf75bf223f79,0x3f46be69bf7d3f2f,0x3f31bf7bbd863f20,0x3f55bebabf7e3f60,0x3e9fbf463f073c33,0x3f62befbbf6e3f7c
.quad 0xbe06bec43f6dbf1c,0x3f6dbf1cbf4b3f7e,0xbf0c3dc93f79bf78,0x3f75bf37bf1a3f67,0xbf5b3f0e3f29bf6a,0x3f7bbf4ebeba3f39,0xbf7f3f623dc9bef1,0x3f7fbf62bdc93ef1
.quad 0x3f00bf80bf803f00,0xbf803f003f003f00,0x3d9cbf62bf503f6e,0xbf7f3f1e3f373e53,0xbebabf0ebea53f76,0xbf7b3f393f60bddf,0xbf3bbdc93e953f15,0xbf753f503f79bed3
.quad 0xbf743ec43f4bbd33,0xbf6d3f633f80bf2d,0xbf7d3f463f80bf27,0xbf623f723f73bf5f,0xbf553f7b3f55bf7b,0xbf553f7b3f55bf7b,0xbf023f753eb4bf64,0xbf463f803f27bf7e
.quad 0xbdb23f35be85bed8,0xbf353f7f3ed8bf68,0x3eb43e95bf463e69,0xbf223f793e27bf3b,0x3f39be48bf7f3f48,0xbf0e3f6fbddfbef6,0x3f73bf22bf593f80,0xbef13f5fbebfbe3d
.quad 0x3f7ebf6dbec43f4b,0xbec43f4bbf1c3e06,0x3f56bf7f3e693e7e,0xbe953f33bf4d3edd,0x3f05bf553f40bece,0xbe483f17bf6f3f31,0x3dc9bef13f7fbf62,0xbdc93ef1bf7f3f62
.quad 0x248d3f5e3f5ebf5e,0x3f5ebf5ebf5e248d,0x3eb43f1a3efbbf80,0x3f5cbf64bf723e69,0x3f293e73bcb3bf4e,0x3f5bbf6abf7d3ee2,0x3f62be27bf07beb4,0x3f59bf70bf803f22
.quad 0x3f7ebf0abf633e5e,0x3f58bf74bf7a3f4b,0x3f79bf53bf803f37,0x3f56bf78bf6b3f69,0x3f55bf7bbf553f7b,0x3f55bf7bbf553f7b,0x3f15bf7bbedd3f6e,0x3f53bf7dbf373f80
.quad 0x3e85bf523db23f13,0x3f52bf7fbf133f77,0xbdc9bf073f153d06,0x3f50bf80bed33f62,0xbee2be1c3f6abf05,0x3f4ebf80be733f40,0xbf3b3e7e3f7ebf67,0x3f4dbf7fbd5f3f15
.quad 0xbf6d3f1c3f4bbf7e,0x3f4bbf7e3e063ec4,0xbf803f5f3ebfbf42,0x3f49bf7c3e9f3e27,0xbf723f7ebe1cbe8f,0x3f48bf793ef6bd86,0xbf463f75bf223e95,0x3f46bf753f22be95
.quad 0xbf803f003f003f00,0x3f003f003f00bf80,0xbf703f4d3f5fbd5f,0x3f023ee73eaabf79,0xbf403f793f80bf17,0x3f053ece3e1cbf66,0xbef13f7d3f59bf70,0x3f073eb4bd06bf46
.quad 0xbe063f583eecbf7a,0x3f0a3e9abe5ebf1c,0x3e693f11bd5fbf33,0x3f0c3e7ebec9bed3,0x3f0e3e48bf0ebe48,0x3f0e3e48bf0ebe48,0x3f50be53bf673ebf,0x3f113e11bf333d06
.quad 0x3f77bf13bf7f3f52,0x3f133db2bf523e85,0x3f7fbf59bf503f80,0x3f153d06bf693ef1,0x3f66bf7dbece3f5b,0x3f17bcb3bf793f29,0x3f2fbf783df53edd,0x3f1abd9cbf803f50
.quad 0x3ec4bf4b3f1cbe06,0x3f1cbe06bf7e3f6d,0x3d06befb3f6ebf27,0x3f1ebe3dbf733f7d,0xbea5bddf3f7dbf76,0x3f20be73bf603f7f,0xbf223e953f46bf75,0x3f22be95bf463f75
.quad 0x3e323e32bf713f80,0x3e32bf003f80bf71,0xbd333eafbf743f80,0x3f2dbf5e3f6dbf44,0xbe853f00bf773f80,0x3f77bf803f35bf00,0xbeec3f25bf7a3f80,0x3f74bf5e3ec4be32
.quad 0xbf253f44bf7c3f80,0x3f25bf00248d3e32,0xbf4b3f5ebf7e3f80,0x3e06a554bec43f00,0xbf683f71bf7f3f80,0xbed83f00bf353f44,0xbf7a3f7cbf803f80,0xbf583f5ebf6d3f71
.quad 0xbf803f80bf803f80,0xbf803f80bf803f80,0xbf7a3f7cbf803f80,0xbf583f5ebf6d3f71,0xbf683f71bf7f3f80,0xbed83f00bf353f44,0xbf4b3f5ebf7e3f80,0x3e06248dbec43f00
.quad 0xbf253f44bf7c3f80,0x3f25bf00a5543e32,0xbeec3f25bf7a3f80,0x3f74bf5e3ec4be32,0xbe853f00bf773f80,0x3f77bf803f35bf00,0xbd333eafbf743f80,0x3f2dbf5e3f6dbf44
.quad 0xbf7c3f7cbeaf8000,0x3f7cbf5e80003eaf,0xbf803f71be9a8000,0x3f3dbf00bec43f25,0xbf773f5ebe858000,0x3e85a50dbf353f5e,0xbf633f44be5e8000,0xbe9a3f00bf6d3f7c
.quad 0xbf443f25be328000,0xbf443f5ebf803f7c,0xbf1c3f00be068000,0xbf7e3f80bf6d3f5e,0xbed83eafbdb28000,0xbf683f5ebf353f25,0xbe5e3e32bd338000,0xbf0a3f00bec43eaf
.quad 0xa50d8000a50d8000,0xa50d8000a50d8000,0x3e5ebe323d338000,0x3f0abf003ec4beaf,0x3ed8beaf3db28000,0x3f68bf5e3f35bf25,0x3f1cbf003e068000,0x3f7ebf803f6dbf5e
.quad 0x3f44bf253e328000,0x3f44bf5e3f80bf7c,0x3f63bf443e5e8000,0x3e9abf003f6dbf7c,0x3f77bf5e3e858000,0xbe85a50d3f35bf5e,0x3f80bf713e9a8000,0xbf3d3f003ec4bf25
.quad 0x3f44bf00bf003f44,0xbf003e323f44bf71,0x3f0abe85bf1c3f52,0x3e06bed83f7abf7f,0x3e85a554bf353f5e,0x3f35bf5e3f77bf5e,0xbd333e85bf4b3f68,0x3f7ebf7f3f3dbf13
.quad 0xbeaf3f00bf5e3f71,0x3f5ebf443eafbe32,0xbf1c3f35bf6d3f77,0x3ec4be85be063e85,0xbf523f5ebf773f7c,0xbe853eafbf133f25,0xbf743f77bf7e3f7f,0xbf4b3f52bf633f68
.quad 0xbf803f80bf803f80,0xbf803f80bf803f80,0xbf743f77bf7e3f7f,0xbf4b3f52bf633f68,0xbf523f5ebf773f7c,0xbe853eafbf133f25,0xbf1c3f35bf6d3f77,0x3ec4be85be063e85
.quad 0xbeaf3f00bf5e3f71,0x3f5ebf443eafbe32,0xbd333e85bf4b3f68,0x3f7ebf7f3f3dbf13,0x3e85248dbf353f5e,0x3f35bf5e3f77bf5e,0x3f0abe85bf1c3f52,0x3e06bed83f7abf7f
.quad 0xbf253f5ebf5e3f25,0x3f5ebf7c3f25beaf,0xbf583f77bf4b3f13,0x3f7ebf683e5e3db2,0xbf773f80bf353f00,0x3f35bf00be853f00,0xbf803f77bf1c3ed8,0x3e063db2bf2d3f52
.quad 0xbf713f5ebf003eaf,0xbf003f25bf713f7c,0xbf4b3f35bec43e85,0xbf6d3f77bf7e3f77,0xbf133f00be853e32,0xbf773f71bf523f44,0xbe9a3e85be063db2,0xbf1c3f13beec3ed8
.quad 0xa50d8000a50d8000,0xa50d8000a50d8000,0x3e9abe853e06bdb2,0x3f1cbf133eecbed8,0x3f13bf003e85be32,0x3f77bf713f52bf44,0x3f4bbf353ec4be85,0x3f6dbf773f7ebf77
.quad 0x3f71bf5e3f00beaf,0x3f00bf253f71bf7c,0x3f80bf773f1cbed8,0xbe06bdb23f2dbf52,0x3f77bf803f35bf00,0xbf353f003e85bf00,0x3f58bf773f4bbf13,0xbf7e3f68be5ebdb2
.quad 0xbf003f44bf713f44,0x3f44bf713f44bf00,0xbf2f3f5fbf6b3f42,0x3f7ebf7c3ee7be27,0xbf553f72bf663f40,0x3f66bf403d863e48,0xbf703f7dbf5f3f3f,0x3f02be9fbeaa3f07
.quad 0xbf7e3f80bf583f3d,0xbd333e5ebf2d3f4b,0xbf7f3f79bf503f3b,0xbf153f2fbf693f75,0xbf723f6abf483f39,0xbf6f3f76bf803f7f,0xbf593f53bf3f3f37,0xbf7b3f78bf6e3f69
.quad 0xbf353f35bf353f35,0xbf353f35bf353f35,0xbf073f11bf2b3f33,0xbe533e7ebebf3ed3,0xbea53ecebf203f31,0x3ebabe8f3cb33d86,0xbdc93e69bf153f2f,0x3f50bf3b3ed3be95
.quad 0x3e063d33bf0a3f2d,0x3f80bf7a3f3dbf1c,0x3eb4be11befb3f2b,0x3f5cbf733f72bf59,0x3f0ebea5bee23f29,0x3ee2bf293f7fbf7b,0x3f3bbefbbec93f27,0xbdf5be3d3f64bf7d
.quad 0xbf5e3f253eafbf25,0x3f25beafbf253f5e,0xbf3b3efb3ec9bf27,0x3df53e3dbf643f7d,0xbf0e3ea53ee2bf29,0xbee23f29bf7f3f7b,0xbeb43e113efbbf2b,0xbf5c3f73bf723f59
.quad 0xbe06bd333f0abf2d,0xbf803f7abf3d3f1c,0x3dc9be693f15bf2f,0xbf503f3bbed33e95,0x3ea5bece3f20bf31,0xbeba3e8fbcb3bd86,0x3f07bf113f2bbf33,0x3e53be7e3ebfbed3
.quad 0x3f35bf353f35bf35,0x3f35bf353f35bf35,0x3f59bf533f3fbf37,0x3f7bbf783f6ebf69,0x3f72bf6a3f48bf39,0x3f6fbf763f80bf7f,0x3f7fbf793f50bf3b,0x3f15bf2f3f69bf75
.quad 0x3f7ebf803f58bf3d,0x3d33be5e3f2dbf4b,0x3f70bf7d3f5fbf3f,0xbf023e9f3eaabf07,0x3f55bf723f66bf40,0xbf663f40bd86be48,0x3f2fbf5f3f6bbf42,0xbf7e3f7cbee73e27
.quad 0x3e323e32bf713f80,0x3e32bf003f80bf71,0xbe113eddbf7b3f7f,0x3f3fbf693f62bf33,0xbee23f29bf7f3f7b,0x3f7fbf7b3f0ebea5,0xbf333f56bf7f3f75,0x3f53bf2f3dc93df5
.quad 0xbf633f74bf7a3f6d,0x3e9abe06bec43f0a,0xbf7d3f80bf703f62,0xbeb43ef1bf463f59,0xbf7d3f79bf603f55,0xbf5b3f66bf7b3f7e,0xbf643f5fbf4d3f46,0xbf7e3f7dbf753f72
.quad 0xbf353f35bf353f35,0xbf353f35bf353f35,0xbee73efbbf1a3f22,0xbdf53e27be953eaa,0xbe1c3e73bef63f0e,0x3f05bee23e48bddf,0x3e27bd06beb43ef1,0x3f70bf623f22bf07
.quad 0x3eecbe9abe5e3ec4,0x3f74bf7e3f6dbf58,0x3f37bf0cbd9c3e95,0x3f11bf3b3f7fbf7e,0x3f66bf403d863e48,0xbd86be483f55bf72,0x3f7dbf673e533dc9,0xbf2b3ed33ef1bf37
.quad 0xbf7c3f7cbeaf8000,0x3f7cbf5e80003eaf,0xbf7d3f67be53bdc9,0x3f2bbed3bef13f37,0xbf663f40bd86be48,0x3d863e48bf553f72,0xbf373f0c3d9cbe95,0xbf113f3bbf7f3f7e
.quad 0xbeec3e9a3e5ebec4,0xbf743f7ebf6d3f58,0xbe273d063eb4bef1,0xbf703f62bf223f07,0x3e1cbe733ef6bf0e,0xbf053ee2be483ddf,0x3ee7befb3f1abf22,0x3df5be273e95beaa
.quad 0x3f35bf353f35bf35,0x3f35bf353f35bf35,0x3f64bf5f3f4dbf46,0x3f7ebf7d3f75bf72,0x3f7dbf793f60bf55,0x3f5bbf663f7bbf7e,0x3f7dbf803f70bf62,0x3eb4bef13f46bf59
.quad 0x3f63bf743f7abf6d,0xbe9a3e063ec4bf0a,0x3f33bf563f7fbf75,0xbf533f2fbdc9bdf5,0x3ee2bf293f7fbf7b,0xbf7f3f7bbf0e3ea5,0x3e11bedd3f7bbf7f,0xbf3f3f69bf623f33
.quad 0xbf713f80bf003e32,0x3f80bf713e323e32,0xbf7e3f7bbee23e1c,0x3f55bf20be733f05,0xbf7e3f6dbec43e06,0x3ec4be06bf1c3f4b,0xbf6f3f55bea53ddf,0xbe483ecebf603f76
.quad 0xbf523f35be853db2,0xbf353f52bf7f3f7f,0xbf293f0ebe483d86,0xbf7b3f7fbf723f66,0xbeec3ec4be063d33,0xbf6d3f63bf3d3f2d,0xbe733e48bd863cb3,0xbf0e3f05bece3eba
.quad 0xa554248da554248d,0xa554248da554248d,0x3e73be483d86bcb3,0x3f0ebf053ecebeba,0x3eecbec43e06bd33,0x3f6dbf633f3dbf2d,0x3f29bf0e3e48bd86,0x3f7bbf7f3f72bf66
.quad 0x3f52bf353e85bdb2,0x3f35bf523f7fbf7f,0x3f6fbf553ea5bddf,0x3e48bece3f60bf76,0x3f7ebf6d3ec4be06,0xbec43e063f1cbf4b,0x3f7ebf7b3ee2be1c,0xbf553f203e73bf05
.quad 0xbeaf80003f5ebf7c,0x80003eafbf7c3f7c,0xbddfbe483f66bf7d,0xbf0e3f48bf793f5b,0x3e06bec43f6dbf7e,0xbf6d3f7ebf4b3f1c,0x3ebabf0e3f72bf7e,0xbf7b3f6abef63e8f
.quad 0x3f13bf353f77bf7f,0xbf353f13bdb2bdb2,0x3f40bf553f7bbf7f,0xbe483d863ea5bee2,0x3f63bf6d3f7ebf80,0x3ec4beec3f2dbf3d,0x3f79bf7b3f7fbf80,0x3f55bf5b3f6abf6f
.quad 0x3f80bf803f80bf80,0x3f80bf803f80bf80,0x3f79bf7b3f7fbf80,0x3f55bf5b3f6abf6f,0x3f63bf6d3f7ebf80,0x3ec4beec3f2dbf3d,0x3f40bf553f7bbf7f,0xbe483d863ea5bee2
.quad 0x3f13bf353f77bf7f,0xbf353f13bdb2bdb2,0x3ebabf0e3f72bf7e,0xbf7b3f6abef63e8f,0x3e06bec43f6dbf7e,0xbf6d3f7ebf4b3f1c,0xbddfbe483f66bf7d,0xbf0e3f48bf793f5b
.quad 0xbf003f44bf713f44,0x3f44bf713f44bf00,0xbf403f6abf603f31,0x3f80bf763ebabd86,0xbf6d3f7ebf4b3f1c,0x3f4bbf1cbe063ec4,0xbf7f3f7dbf313f05,0x3e73bcb3bf173f40
.quad 0xbf773f68bf133ed8,0xbed83f13bf683f77,0xbf553f40bee23ea5,0xbf663f72bf7f3f7b,0xbf1c3f0abe9a3e5e,0xbf7a3f74bf583f4b,0xbea53e8fbe1c3ddf,0xbf203f17bef63ee2
.quad 0xa554248da554248d,0xa554248da554248d,0x3ea5be8f3e1cbddf,0x3f20bf173ef6bee2,0x3f1cbf0a3e9abe5e,0x3f7abf743f58bf4b,0x3f55bf403ee2bea5,0x3f66bf723f7fbf7b
.quad 0x3f77bf683f13bed8,0x3ed8bf133f68bf77,0x3f7fbf7d3f31bf05,0xbe733cb33f17bf40,0x3f6dbf7e3f4bbf1c,0xbf4b3f1c3e06bec4,0x3f40bf6a3f60bf31,0xbf803f76beba3d86
.quad 0xbf5e3f253eafbf25,0x3f25beafbf253f5e,0xbf293ece3ef6bf39,0x3cb33e8fbf6f3f7f,0xbec43e063f1cbf4b,0xbf1c3f4bbf7e3f6d,0xbd86be1c3f39bf5b,0xbf793f80bf4e3f29
.quad 0x3e85bed83f52bf68,0xbf683f52bed83e85,0x3f0ebf293f66bf72,0xbee23ea53d86be48,0x3f4bbf583f74bf7a,0x3e5ebe9a3f0abf1c,0x3f72bf763f7dbf7e,0x3f48bf4e3f60bf66
.quad 0x3f80bf803f80bf80,0x3f80bf803f80bf80,0x3f72bf763f7dbf7e,0x3f48bf4e3f60bf66,0x3f4bbf583f74bf7a,0x3e5ebe9a3f0abf1c,0x3f0ebf293f66bf72,0xbee23ea53d86be48
.quad 0x3e85bed83f52bf68,0xbf683f52bed83e85,0xbd86be1c3f39bf5b,0xbf793f80bf4e3f29,0xbec43e063f1cbf4b,0xbf1c3f4bbf7e3f6d,0xbf293ece3ef6bf39,0x3cb33e8fbf6f3f7f
.quad 0xbf713f443e32bf00,0x3f44bf00bf003f44,0xbf533f1e3e7ebf07,0x3e8a3d06bf503f73,0xbf293ee23ea5bf0e,0xbea53f0ebf7b3f7f,0xbee73e7e3ec9bf15,0xbf4d3f69bf793f67
.quad 0xbe5e3d333eecbf1c,0xbf803f7ebf4b3f2d,0x3d06be273f07bf22,0xbf593f46bef13eb4,0x3e8fbeba3f17bf29,0xbece3ea5bd86bcb3,0x3f02bf0c3f27bf2f,0x3e3dbe693eb4bec9
.quad 0x3f35bf353f35bf35,0x3f35bf353f35bf35,0x3f5cbf563f42bf3b,0x3f7cbf793f70bf6b,0x3f76bf6f3f4ebf40,0x3f6abf723f7fbf80,0x3f80bf7d3f59bf46,0x3f07bf223f62bf70
.quad 0x3f7abf803f63bf4b,0xbd33be063f1cbf3d,0x3f64bf783f6bbf50,0xbf1a3ed33e69bedd,0x3f40bf663f72bf55,0xbf723f55be48bd86,0x3f11bf493f78bf59,0xbf773f80bf153e9f
.quad 0x3eafbf253f7cbf5e,0xbf253f5ebf5e3f25,0x3f11bf493f78bf59,0xbf773f80bf153e9f,0x3f40bf663f72bf55,0xbf723f55be48bd86,0x3f64bf783f6bbf50,0xbf1a3ed33e69bedd
.quad 0x3f7abf803f63bf4b,0xbd33be063f1cbf3d,0x3f80bf7d3f59bf46,0x3f07bf223f62bf70,0x3f76bf6f3f4ebf40,0x3f6abf723f7fbf80,0x3f5cbf563f42bf3b,0x3f7cbf793f70bf6b
.quad 0x3f35bf353f35bf35,0x3f35bf353f35bf35,0x3f02bf0c3f27bf2f,0x3e3dbe693eb4bec9,0x3e8fbeba3f17bf29,0xbece3ea5bd86bcb3,0x3d06be273f07bf22,0xbf593f46bef13eb4
.quad 0xbe5e3d333eecbf1c,0xbf803f7ebf4b3f2d,0xbee73e7e3ec9bf15,0xbf4d3f69bf793f67,0xbf293ee23ea5bf0e,0xbea53f0ebf7b3f7f,0xbf533f1e3e7ebf07,0x3e8a3d06bf503f73
.quad 0xbf713f80bf003e32,0x3f80bf713e323e32,0xbf803f75beb43d5f,0x3f46bf0cbeaa3f1a,0xbf723f55be48bd86,0x3e483d86bf403f66,0xbf493f22bd06be3d,0xbef13f27bf7b3f80
.quad 0xbf0a3ec43e06be9a,0xbf6d3f7abf743f63,0xbe693dc93e95bed3,0xbf753f69bf2f3f15,0x3ddfbe483ee2bf05,0xbf0e3ef6be733e1c,0x3eddbef13f15bf1e,0x3dc9be113e8abe9f
.quad 0x3f35bf353f35bf35,0x3f35bf353f35bf35,0x3f67bf623f50bf49,0x3f7fbf7d3f77bf73,0x3f7ebf7b3f66bf5b,0x3f55bf603f79bf7d,0x3f79bf7f3f75bf69,0x3e95bed33f3bbf50
.quad 0x3f58bf6d3f7ebf74,0xbec43e5e3e9abeec,0x3f1ebf463f80bf7c,0xbf623f42be53bc33,0x3ea5bf0e3f7bbf7f,0xbf7b3f7fbf293ee2,0xbc33be953f70bf80,0xbf223f56bf723f4d
.quad 0xbeaf80003f5ebf7c,0x80003eafbf7c3f7c,0xbc33be953f70bf80,0xbf223f56bf723f4d,0x3ea5bf0e3f7bbf7f,0xbf7b3f7fbf293ee2,0x3f1ebf463f80bf7c,0xbf623f42be53bc33
.quad 0x3f58bf6d3f7ebf74,0xbec43e5e3e9abeec,0x3f79bf7f3f75bf69,0x3e95bed33f3bbf50,0x3f7ebf7b3f66bf5b,0x3f55bf603f79bf7d,0x3f67bf623f50bf49,0x3f7fbf7d3f77bf73
.quad 0x3f35bf353f35bf35,0x3f35bf353f35bf35,0x3eddbef13f15bf1e,0x3dc9be113e8abe9f,0x3ddfbe483ee2bf05,0xbf0e3ef6be733e1c,0xbe693dc93e95bed3,0xbf753f69bf2f3f15
.quad 0xbf0a3ec43e06be9a,0xbf6d3f7abf743f63,0xbf493f22bd06be3d,0xbef13f27bf7b3f80,0xbf723f55be48bd86,0x3e483d86bf403f66,0xbf803f75beb43d5f,0x3f46bf0cbeaa3f1a
.quad 0xbf003f44bf713f44,0x3f44bf713f44bf00,0xbf7e3f7cbeec3e32,0x3f58bf25be5e3f00,0xbf353f003e85bf00,0xbe853f00bf773f80,0x3e06beaf3f58bf71,0xbf803f7cbf2d3f00
.quad 0x3f5ebf713f7cbf71,0xbeaf3e323eafbf00,0x3f6dbf5e3f1cbf00,0x3f4bbf5e3f7ebf80,0x3e85be32bdb23e32,0x3f52bf443f13bf00,0xbf1c3f25bf3d3f44,0xbe9a3eafbeec3f00
.quad 0xbf803f80bf803f80,0xbf803f80bf803f80,0xbf1c3f25bf3d3f44,0xbe9a3eafbeec3f00,0x3e85be32bdb23e32,0x3f52bf443f13bf00,0x3f6dbf5e3f1cbf00,0x3f4bbf5e3f7ebf80
.quad 0x3f5ebf713f7cbf71,0xbeaf3e323eafbf00,0x3e06beaf3f58bf71,0xbf803f7cbf2d3f00,0xbf353f003e85bf00,0xbe853f00bf773f80,0xbf7e3f7cbeec3e32,0x3f58bf25be5e3f00
.quad 0xbf5e3f253eafbf25,0x3f25beafbf253f5e,0xbe06be323f63bf7c,0xbf0a3f44bf7a3f5e,0x3f35bf5e3f77bf5e,0xbf773f5ebe858000,0x3f7ebf713f0abeaf,0xbd33be323f3dbf5e
.quad 0x3f00beafbe323eaf,0x3f71bf7c3f71bf5e,0xbec43f00bf4b3f5e,0x3f1cbf003e06a50d,0xbf773f7cbf7f3f7c,0xbf133f25bf523f5e,0xbf4b3f44bf2d3f25,0xbf743f71bf633f5e
.quad 0xa50d8000a50d8000,0xa50d8000a50d8000,0x3f4bbf443f2dbf25,0x3f74bf713f63bf5e,0x3f77bf7c3f7fbf7c,0x3f13bf253f52bf5e,0x3ec4bf003f4bbf5e,0xbf1c3f00be06a50d
.quad 0xbf003eaf3e32beaf,0xbf713f7cbf713f5e,0xbf7e3f71bf0a3eaf,0x3d333e32bf3d3f5e,0xbf353f5ebf773f5e,0x3f77bf5e3e858000,0x3e063e32bf633f7c,0x3f0abf443f7abf5e
.quad 0x3e323e32bf713f80,0x3e32bf003f80bf71,0xbf3d3f68bf633f35,0x3f80bf773ec4bdb2,0xbf773f5ebe85248d,0x3e85a554bf353f5e,0xbe9a3db23f0abf35,0xbf633f77bf6d3f52
.quad 0x3f25bf443f7cbf80,0xbf253f00a554be32,0x3f7ebf773f4bbf35,0x3f1cbf353f6dbf77,0x3ed8beaf3db2a554,0x3f68bf5e3f35bf25,0xbf0a3f13bf2d3f35,0xbe5e3e85bec43ed8
.quad 0xbf803f80bf803f80,0xbf803f80bf803f80,0xbf0a3f13bf2d3f35,0xbe5e3e85bec43ed8,0x3ed8beaf3db2248d,0x3f68bf5e3f35bf25,0x3f7ebf773f4bbf35,0x3f1cbf353f6dbf77
.quad 0x3f25bf443f7cbf80,0xbf253f00248dbe32,0xbe9a3db23f0abf35,0xbf633f77bf6d3f52,0xbf773f5ebe85a554,0x3e85248dbf353f5e,0xbf3d3f68bf633f35,0x3f80bf773ec4bdb2
.quad 0xbf7c3f7cbeaf8000,0x3f7cbf5e80003eaf,0xbf2d3ed83eecbf35,0x3d333e85bf6d3f7f,0x3e85bf003f77bf80,0xbf773f80bf353f00,0x3f74bf7f3f58bf35,0xbeec3e853ec4bf13
.quad 0x3f44bf253e32a50d,0x3f44bf5e3f80bf7c,0xbe063e85bf1c3f35,0x3f4bbf353ec4be85,0xbf683f71bf7f3f80,0xbed83f00bf353f44,0xbf583f52bf3d3f35,0xbf7a3f77bf6d3f68
.quad 0xa50d8000a50d8000,0xa50d8000a50d8000,0x3f58bf523f3dbf35,0x3f7abf773f6dbf68,0x3f68bf713f7fbf80,0x3ed8bf003f35bf44,0x3e06be853f1cbf35,0xbf4b3f35bec43e85
.quad 0xbf443f25be32a50d,0xbf443f5ebf803f7c,0xbf743f7fbf583f35,0x3eecbe85bec43f13,0xbe853f00bf773f80,0x3f77bf803f35bf00,0x3f2dbed8beec3f35,0xbd33be853f6dbf7f
.quad 0xbf713f80bf003e32,0x3f80bf713e323e32,0xbf563f223e69bf02,0x3e953c33bf4d3f72,0xbd86be483f55bf72,0xbf553f72bf663f40,0x3f42bf623f7dbf6e,0xbf463f1ebc33be53
.quad 0x3f7abf6d3f1cbeec,0x3ec4bf0a3f63bf74,0x3ed3be95bdc93e69,0x3f7fbf793f50bf3b,0xbef63f0ebf403f4e,0x3e48bddfbe1c3e73,0xbf7d3f7fbf803f7f,0xbf623f67bf733f77
.quad 0xbf353f35bf353f35,0xbf353f35bf353f35,0x3e11bdc9bd063d9c,0x3ef1bedd3e9fbe8a,0x3f60bf553f29bf17,0x3f7bbf7e3f7dbf79,0x3f69bf753f7fbf79,0x3dc9be693f15bf2f
.quad 0x3e5ebec43f4bbf63,0xbf6d3f58beec3e9a,0xbf273ef13e27bebf,0xbf223f49bf803f7b,0xbf7f3f7bbf0e3ea5,0x3f0ebea5bee23f29,0xbf0c3f46bf793f5c,0x3f75bf803f1abeaa
.quad 0xbeaf80003f5ebf7c,0x80003eafbf7c3f7c,0x3f0cbf463f79bf5c,0xbf753f80bf1a3eaa,0x3f7fbf7b3f0ebea5,0xbf0e3ea53ee2bf29,0x3f27bef1be273ebf,0x3f22bf493f80bf7b
.quad 0xbe5e3ec4bf4b3f63,0x3f6dbf583eecbe9a,0xbf693f75bf7f3f79,0xbdc93e69bf153f2f,0xbf603f55bf293f17,0xbf7b3f7ebf7d3f79,0xbe113dc93d06bd9c,0xbef13eddbe9f3e8a
.quad 0x3f35bf353f35bf35,0x3f35bf353f35bf35,0x3f7dbf7f3f80bf7f,0x3f62bf673f73bf77,0x3ef6bf0e3f40bf4e,0xbe483ddf3e1cbe73,0xbed33e953dc9be69,0xbf7f3f79bf503f3b
.quad 0xbf7a3f6dbf1c3eec,0xbec43f0abf633f74,0xbf423f62bf7d3f6e,0x3f46bf1e3c333e53,0x3d863e48bf553f72,0x3f55bf723f66bf40,0x3f56bf22be693f02,0xbe95bc333f4dbf72
.quad 0xbf003f44bf713f44,0x3f44bf713f44bf00,0xbf803f77bebf3d9c,0x3f49bf11be9f3f15,0xbf0e3ea53ee2bf29,0xbee23f29bf7f3f7b,0x3ed3bf1a3f77bf80,0xbf783f64bedd3e69
.quad 0x3f7ebf803f58bf3d,0x3d33be5e3f2dbf4b,0x3f22bf073e27bd06,0x3f7dbf803f70bf62,0xbea53ecebf203f31,0x3ebabe8f3cb33d86,0xbf793f7cbf803f80,0xbf563f5cbf6b3f70
.quad 0xbf353f35bf353f35,0xbf353f35bf353f35,0x3e69be3d3d5fbc33,0x3f0cbf023ec9beb4,0x3f72bf6a3f48bf39,0x3f6fbf763f80bf7f,0x3f46bf593f7dbf80,0xbe273d063eb4bef1
.quad 0xbe06bd333f0abf2d,0xbf803f7abf3d3f1c,0xbf693f4dbe8a3d5f,0xbe7e3ee7bf673f79,0xbf553f72bf663f40,0x3f66bf403d863e48,0x3d063e8abf6e3f7f,0x3f1ebf533f73bf50
.quad 0xbf5e3f253eafbf25,0x3f25beafbf253f5e,0xbd06be8a3f6ebf7f,0xbf1e3f53bf733f50,0x3f55bf723f66bf40,0xbf663f40bd86be48,0x3f69bf4d3e8abd5f,0x3e7ebee73f67bf79
.quad 0x3e063d33bf0a3f2d,0x3f80bf7a3f3dbf1c,0xbf463f59bf7d3f80,0x3e27bd06beb43ef1,0xbf723f6abf483f39,0xbf6f3f76bf803f7f,0xbe693e3dbd5f3c33,0xbf0c3f02bec93eb4
.quad 0x3f35bf353f35bf35,0x3f35bf353f35bf35,0x3f79bf7c3f80bf80,0x3f56bf5c3f6bbf70,0x3ea5bece3f20bf31,0xbeba3e8fbcb3bd86,0xbf223f07be273d06,0xbf7d3f80bf703f62
.quad 0xbf7e3f80bf583f3d,0xbd333e5ebf2d3f4b,0xbed33f1abf773f80,0x3f78bf643eddbe69,0x3f0ebea5bee23f29,0x3ee2bf293f7fbf7b,0x3f80bf773ebfbd9c,0xbf493f113e9fbf15
.quad 0xbf713f443e32bf00,0x3f44bf00bf003f44,0xbe8fbcb33f4ebf72,0xbece3f29bf7f3f6f,0x3f1cbf4b3f7ebf6d,0xbf7e3f6dbec43e06,0x3f80bf793f20bee2,0xbe1cbd863f29bf4e
.quad 0x3f13bed8bdb23e85,0x3f68bf773f77bf68,0xbea53ee2bf403f55,0x3f29bf0e3e48bd86,0xbf743f7abf803f7e,0xbf0a3f1cbf4b3f58,0xbf4e3f48bf313f29,0xbf763f72bf663f60
.quad 0xa554248da554248d,0xa554248da554248d,0x3f4ebf483f31bf29,0x3f76bf723f66bf60,0x3f74bf7a3f80bf7e,0x3f0abf1c3f4bbf58,0x3ea5bee23f40bf55,0xbf293f0ebe483d86
.quad 0xbf133ed83db2be85,0xbf683f77bf773f68,0xbf803f79bf203ee2,0x3e1c3d86bf293f4e,0xbf1c3f4bbf7e3f6d,0x3f7ebf6d3ec4be06,0x3e8f3cb3bf4e3f72,0x3ecebf293f7fbf6f
.quad 0x3eafbf253f7cbf5e,0xbf253f5ebf5e3f25,0x3f76bf803f17bea5,0xbf6a3f403d86beba,0x3f4bbf1cbe063ec4,0x3e06bec43f6dbf7e,0xbcb33e73bf483f66,0x3f7dbf7f3f40bf17
.quad 0xbf523f68bf7f3f77,0x3ed8be85be853ed8,0xbf723f66bf293f0e,0xbf403f55bf7b3f7f,0xbe9a3e5e3d33be06,0xbf583f4bbf1c3f0a,0x3f17bf203f39bf40,0x3e8fbea53ee2bef6
.quad 0x3f80bf803f80bf80,0x3f80bf803f80bf80,0x3f17bf203f39bf40,0x3e8fbea53ee2bef6,0xbe9a3e5e3d33be06,0xbf583f4bbf1c3f0a,0xbf723f66bf293f0e,0xbf403f55bf7b3f7f
.quad 0xbf523f68bf7f3f77,0x3ed8be85be853ed8,0xbcb33e73bf483f66,0x3f7dbf7f3f40bf17,0x3f4bbf1cbe063ec4,0x3e06bec43f6dbf7e,0x3f76bf803f17bea5,0xbf6a3f403d86beba
.quad 0xbf713f80bf003e32,0x3f80bf713e323e32,0xbf483f0e3ea5bf17,0x3e483ddfbf5b3f79,0x3e06bec43f6dbf7e,0xbf6d3f7ebf4b3f1c,0x3f6abf7b3f66bf48,0xbf0e3eba3e8fbef6
.quad 0x3f52bf353e85bdb2,0x3f35bf523f7fbf7f,0xbd863e48bf0e3f29,0x3f55bf403ee2bea5,0xbf633f6dbf7e3f80,0xbec43eecbf2d3f3d,0xbf5b3f55bf403f39,0xbf7b3f79bf6f3f6a
.quad 0xa554248da554248d,0xa554248da554248d,0x3f5bbf553f40bf39,0x3f7bbf793f6fbf6a,0x3f63bf6d3f7ebf80,0x3ec4beec3f2dbf3d,0x3d86be483f0ebf29,0xbf553f40bee23ea5
.quad 0xbf523f35be853db2,0xbf353f52bf7f3f7f,0xbf6a3f7bbf663f48,0x3f0ebebabe8f3ef6,0xbe063ec4bf6d3f7e,0x3f6dbf7e3f4bbf1c,0x3f48bf0ebea53f17,0xbe48bddf3f5bbf79
.quad 0xbeaf80003f5ebf7c,0x80003eafbf7c3f7c,0x3f20bf553f72bf4e,0xbf7b3f7ebf053e73,0x3f7ebf6d3ec4be06,0xbec43e063f1cbf4b,0x3ecebe48bee23f20,0x3f55bf6f3f76bf60
.quad 0xbf133f35bf773f7f,0x3f35bf133db23db2,0xbf7f3f7bbf553f40,0xbf0e3f29bf663f72,0xbeec3ec4be063d33,0xbf6d3f63bf3d3f2d,0x3f05bf0e3f29bf31,0x3e48be733ebabece
.quad 0x3f80bf803f80bf80,0x3f80bf803f80bf80,0x3f05bf0e3f29bf31,0x3e48be733ebabece,0xbeec3ec4be063d33,0xbf6d3f63bf3d3f2d,0xbf7f3f7bbf553f40,0xbf0e3f29bf663f72
.quad 0xbf133f35bf773f7f,0x3f35bf133db23db2,0x3ecebe48bee23f20,0x3f55bf6f3f76bf60,0x3f7ebf6d3ec4be06,0xbec43e063f1cbf4b,0x3f20bf553f72bf4e,0xbf7b3f7ebf053e73
.quad 0xbf003e323f44bf71,0x3e323e32bf713f80,0x3ed3bf2b3f7fbf6e,0xbf673f7dbf373ef1,0x3f7bbf7f3f29bee2,0xbf293ee23ea5bf0e,0x3f3bbf11bd5f3e8a,0x3f0cbf373f7ebf7f
.quad 0xbe063e9abf3d3f58,0x3f74bf633f0abec4,0xbf623f70bf803f7d,0xbd063e27bf073f22,0xbf663f5bbf313f20,0xbf793f7dbf7e3f7b,0xbe273df53c33bd5f,0xbefb3ee7beaa3e95
.quad 0x3f35bf353f35bf35,0x3f35bf353f35bf35,0x3f7dbf7e3f80bf80,0x3f5fbf643f72bf75,0x3ee2bf053f39bf48,0xbe733e1c3ddfbe48,0xbef13eb43d06be27,0xbf803f7dbf593f46
.quad 0xbf7e3f74bf2d3f0a,0xbe9a3eecbf583f6d,0xbf2f3f53bf803f77,0x3f56bf333df53dc9,0x3e483d86bf403f66,0x3f40bf663f72bf55,0x3f69bf3fbd9c3ebf,0xbedd3e113f33bf62
.quad 0x3f5ebf7c3f25beaf,0xbf7c3f7cbeaf8000,0x3f69bf3fbd9c3ebf,0xbedd3e113f33bf62,0x3e483d86bf403f66,0x3f40bf663f72bf55,0xbf2f3f53bf803f77,0x3f56bf333df53dc9
.quad 0xbf7e3f74bf2d3f0a,0xbe9a3eecbf583f6d,0xbef13eb43d06be27,0xbf803f7dbf593f46,0x3ee2bf053f39bf48,0xbe733e1c3ddfbe48,0x3f7dbf7e3f80bf80,0x3f5fbf643f72bf75
.quad 0x3f35bf353f35bf35,0x3f35bf353f35bf35,0xbe273df53c33bd5f,0xbefb3ee7beaa3e95,0xbf663f5bbf313f20,0xbf793f7dbf7e3f7b,0xbf623f70bf803f7d,0xbd063e27bf073f22
.quad 0xbe063e9abf3d3f58,0x3f74bf633f0abec4,0x3f3bbf11bd5f3e8a,0x3f0cbf373f7ebf7f,0x3f7bbf7f3f29bee2,0xbf293ee23ea5bf0e,0x3ed3bf2b3f7fbf6e,0xbf673f7dbf373ef1
.quad 0xbf713f443e32bf00,0x3f44bf00bf003f44,0xbe3dbdf53f5cbf79,0xbefb3f3bbf7d3f64,0x3f40bf663f72bf55,0xbf723f55be48bd86,0x3f73bf5c3ebfbe27,0x3e11beb43f59bf72
.quad 0x3e5ebd33beec3f1c,0x3f80bf7e3f4bbf2d,0xbf3b3f50bf793f7f,0x3e69bdc9be953ed3,0xbf763f6fbf4e3f40,0xbf6a3f72bf7f3f80,0xbe7e3e53bd9c3d06,0xbf113f07bed33ebf
.quad 0x3f35bf353f35bf35,0x3f35bf353f35bf35,0x3f78bf7b3f7fbf80,0x3f53bf593f69bf6e,0x3e8fbeba3f17bf29,0xbece3ea5bd86bcb3,0xbf2f3f15be693dc9,0xbf793f7fbf753f69
.quad 0xbf7a3f80bf633f4b,0x3d333e06bf1c3f3d,0xbe9f3f02bf6e3f7d,0x3f7dbf703f07beaa,0x3f29bee2bea53f0e,0x3ea5bf0e3f7bbf7f,0x3f7cbf7e3f02be69,0xbf5f3f2f3e27bee7
.quad 0x3eafbf253f7cbf5e,0xbf253f5ebf5e3f25,0x3f7cbf7e3f02be69,0xbf5f3f2f3e27bee7,0x3f29bee2bea53f0e,0x3ea5bf0e3f7bbf7f,0xbe9f3f02bf6e3f7d,0x3f7dbf703f07beaa
.quad 0xbf7a3f80bf633f4b,0x3d333e06bf1c3f3d,0xbf2f3f15be693dc9,0xbf793f7fbf753f69,0x3e8fbeba3f17bf29,0xbece3ea5bd86bcb3,0x3f78bf7b3f7fbf80,0x3f53bf593f69bf6e
.quad 0x3f35bf353f35bf35,0x3f35bf353f35bf35,0xbe7e3e53bd9c3d06,0xbf113f07bed33ebf,0xbf763f6fbf4e3f40,0xbf6a3f72bf7f3f80,0xbf3b3f50bf793f7f,0x3e69bdc9be953ed3
.quad 0x3e5ebd33beec3f1c,0x3f80bf7e3f4bbf2d,0x3f73bf5c3ebfbe27,0x3e11beb43f59bf72,0x3f40bf663f72bf55,0xbf723f55be48bd86,0xbe3dbdf53f5cbf79,0xbefb3f3bbf7d3f64
.quad 0xbf713f80bf003e32,0x3f80bf713e323e32,0xbe9a248d3f4bbf71,0xbec43f25bf803f71,0x3f77bf803f35bf00,0xbf353f003e85bf00,0x3e5ea554bf1c3f44,0x3f6dbf7c3f63bf44
.quad 0xbf7c3f80bf5e3f44,0x248d3e32bf253f44,0xbe06248d3ec4bf00,0xbf6d3f5ebf1c3f00,0x3f7fbf803f77bf71,0x3f35bf443f68bf71,0x3d33a554be063e32,0x3ec4beaf3e5ebe32
.quad 0xbf803f80bf803f80,0xbf803f80bf803f80,0x3d33248dbe063e32,0x3ec4beaf3e5ebe32,0x3f7fbf803f77bf71,0x3f35bf443f68bf71,0xbe06a5543ec4bf00,0xbf6d3f5ebf1c3f00
.quad 0xbf7c3f80bf5e3f44,0xa5543e32bf253f44,0x3e5e248dbf1c3f44,0x3f6dbf7c3f63bf44,0x3f77bf803f35bf00,0xbf353f003e85bf00,0xbe9aa5543f4bbf71,0xbec43f25bf803f71
.quad 0xbeaf80003f5ebf7c,0x80003eafbf7c3f7c,0x3f74bf803f1cbeaf,0xbf6d3f443d33beaf,0x3e85a50dbf353f5e,0x3f35bf5e3f77bf5e,0xbf7a3f80bf4b3f25,0x3ec4be32beec3f25
.quad 0xbe3280003f00bf25,0xbf803f7cbf443f25,0x3f7ebf803f6dbf5e,0x3ec4bf003f4bbf5e,0x3db2a50dbe853eaf,0x3f35bf253ed8beaf,0xbf803f80bf7e3f7c,0xbf6d3f71bf7a3f7c
.quad 0xa50d8000a50d8000,0xa50d8000a50d8000,0x3f80bf803f7ebf7c,0x3f6dbf713f7abf7c,0xbdb2a50d3e85beaf,0xbf353f25bed83eaf,0xbf7e3f80bf6d3f5e,0xbec43f00bf4b3f5e
.quad 0x3e328000bf003f25,0x3f80bf7c3f44bf25,0x3f7abf803f4bbf25,0xbec43e323eecbf25,0xbe85a50d3f35bf5e,0xbf353f5ebf773f5e,0xbf743f80bf1c3eaf,0x3f6dbf44bd333eaf
.quad 0xbf003f44bf713f44,0x3f44bf713f44bf00,0xbf4b3f133e9abf13,0x3e5e3db2bf583f77,0x3f35bf5e3f77bf5e,0xbf773f5ebe85248d,0x3f1cbed8be5e3ed8,0x3f2dbf523f80bf77
.quad 0xbf5e3f71bf7c3f71,0x3eafbe32beaf3f00,0xbec43e853e06be85,0xbf7e3f77bf4b3f35,0x3f77bf7c3f7fbf7c,0x3f13bf253f52bf5e,0x3e06bdb2bd333db2,0x3eecbed83e9abe85
.quad 0xbf803f80bf803f80,0xbf803f80bf803f80,0x3e06bdb2bd333db2,0x3eecbed83e9abe85,0x3f77bf7c3f7fbf7c,0x3f13bf253f52bf5e,0xbec43e853e06be85,0xbf7e3f77bf4b3f35
.quad 0xbf5e3f71bf7c3f71,0x3eafbe32beaf3f00,0x3f1cbed8be5e3ed8,0x3f2dbf523f80bf77,0x3f35bf5e3f77bf5e,0xbf773f5ebe85a554,0xbf4b3f133e9abf13,0x3e5e3db2bf583f77
.quad 0xbf5e3f253eafbf25,0x3f25beafbf253f5e,0x3f1cbf523f74bf52,0xbf7a3f7fbf0a3e85,0x3f35bf00be853f00,0x3e85bf003f77bf80,0xbf4b3f68bf7a3f68,0x3f3dbf13bd333e85
.quad 0xbf003eaf3e32beaf,0xbf713f7cbf713f5e,0x3f6dbf773f7ebf77,0x3e06be853f1cbf35,0x3e85be32bdb23e32,0x3f52bf443f13bf00,0xbf7e3f7fbf803f7f,0xbf633f68bf743f77
.quad 0xa50d8000a50d8000,0xa50d8000a50d8000,0x3f7ebf7f3f80bf7f,0x3f63bf683f74bf77,0xbe853e323db2be32,0xbf523f44bf133f00,0xbf6d3f77bf7e3f77,0xbe063e85bf1c3f35
.quad 0x3f00beafbe323eaf,0x3f71bf7c3f71bf5e,0x3f4bbf683f7abf68,0xbf3d3f133d33be85,0xbf353f003e85bf00,0xbe853f00bf773f80,0xbf1c3f52bf743f52,0x3f7abf7f3f0abe85
.quad 0xbf713f443e32bf00,0x3f44bf00bf003f44,0x3ec9bf273f80bf70,0xbf643f7dbf3b3efb,0x3f66bf403d863e48,0xbd86be483f55bf72,0xbefb3f2bbf7c3f80,0x3f72bf593eb4be11
.quad 0xbf583f3dbe9a3e06,0xbf2d3f4bbf7e3f80,0x3f15bf2f3f69bf75,0xbed33e953dc9be69,0x3f48bf393f05bee2,0x3f80bf7f3f72bf6a,0xbf2b3f33bf493f50,0xbebf3ed3bf073f11
.quad 0xbf353f35bf353f35,0xbf353f35bf353f35,0x3f3fbf373f1ebf15,0x3f6ebf693f59bf53,0x3f20bf313f5bbf66,0xbcb3bd863ea5bece,0xbf503f3bbed33e95,0xbf693f75bf7f3f79
.quad 0xbf0a3f2dbf743f7e,0x3f3dbf1c3e063d33,0x3f5fbf3f3e3d3d06,0x3eaabf073f70bf7d,0x3ee2bf293f7fbf7b,0xbf7f3f7bbf0e3ea5,0xbf6b3f423d5fbeb4,0x3ee7be27bf2f3f5f
.quad 0x3eafbf253f7cbf5e,0xbf253f5ebf5e3f25,0x3f6bbf42bd5f3eb4,0xbee73e273f2fbf5f,0xbee23f29bf7f3f7b,0x3f7fbf7b3f0ebea5,0xbf5f3f3fbe3dbd06,0xbeaa3f07bf703f7d
.quad 0x3f0abf2d3f74bf7e,0xbf3d3f1cbe06bd33,0x3f50bf3b3ed3be95,0x3f69bf753f7fbf79,0xbf203f31bf5b3f66,0x3cb33d86bea53ece,0xbf3f3f37bf1e3f15,0xbf6e3f69bf593f53
.quad 0x3f35bf353f35bf35,0x3f35bf353f35bf35,0x3f2bbf333f49bf50,0x3ebfbed33f07bf11,0xbf483f39bf053ee2,0xbf803f7fbf723f6a,0xbf153f2fbf693f75,0x3ed3be95bdc93e69
.quad 0x3f58bf3d3e9abe06,0x3f2dbf4b3f7ebf80,0x3efbbf2b3f7cbf80,0xbf723f59beb43e11,0xbf663f40bd86be48,0x3d863e48bf553f72,0xbec93f27bf803f70,0x3f64bf7d3f3bbefb
.quad 0xbf713f80bf003e32,0x3f80bf713e323e32,0xbe53bdc93f59bf78,0xbef13f37bf7d3f67,0x3f7fbf7b3f0ebea5,0xbf0e3ea53ee2bf29,0xbd9c3e95bf503f6b,0x3f7fbf7e3f37bf0c
.quad 0xbf7a3f6dbf1c3eec,0xbec43f0abf633f74,0x3eb4bef13f46bf59,0xbf223f07be273d06,0x3f60bf553f29bf17,0x3f7bbf7e3f7dbf79,0xbf1a3f22bf3b3f42,0xbe953eaabee73efb
.quad 0xbf353f35bf353f35,0xbf353f35bf353f35,0x3f4dbf463f2fbf27,0x3f75bf723f64bf5f,0x3ef6bf0e3f40bf4e,0xbe483ddf3e1cbe73,0xbf703f62bf223f07,0xbf463f59bf7d3f80
.quad 0xbe5e3ec4bf4b3f63,0x3f6dbf583eecbe9a,0x3f7fbf753f15bec9,0xbdc9bdf53f33bf56,0xbd86be483f55bf72,0xbf553f72bf663f40,0xbf7b3f7fbf073e7e,0x3f62bf33be113edd
.quad 0xbeaf80003f5ebf7c,0x80003eafbf7c3f7c,0x3f7bbf7f3f07be7e,0xbf623f333e11bedd,0x3d863e48bf553f72,0x3f55bf723f66bf40,0xbf7f3f75bf153ec9,0x3dc93df5bf333f56
.quad 0x3e5ebec43f4bbf63,0xbf6d3f58beec3e9a,0x3f70bf623f22bf07,0x3f46bf593f7dbf80,0xbef63f0ebf403f4e,0x3e48bddfbe1c3e73,0xbf4d3f46bf2f3f27,0xbf753f72bf643f5f
.quad 0x3f35bf353f35bf35,0x3f35bf353f35bf35,0x3f1abf223f3bbf42,0x3e95beaa3ee7befb,0xbf603f55bf293f17,0xbf7b3f7ebf7d3f79,0xbeb43ef1bf463f59,0x3f22bf073e27bd06
.quad 0x3f7abf6d3f1cbeec,0x3ec4bf0a3f63bf74,0x3d9cbe953f50bf6b,0xbf7f3f7ebf373f0c,0xbf7f3f7bbf0e3ea5,0x3f0ebea5bee23f29,0x3e533dc9bf593f78,0x3ef1bf373f7dbf67
.quad 0xbf003e323f44bf71,0x3e323e32bf713f80,0x3f66bf7d3f39bef6,0xbf793f5bbddfbe48,0x3ec4be06bf1c3f4b,0x3f1cbf4b3f7ebf6d,0xbf723f7ebf5b3f39,0x3ef6be8fbeba3f0e
.quad 0xbe853db23ed8bf13,0xbf7f3f7fbf523f35,0x3f7bbf7f3f72bf66,0x3ea5bee23f40bf55,0x3e06bd33be5e3e9a,0x3f3dbf2d3eecbec4,0xbf7f3f80bf7e3f7d,0xbf6a3f6fbf793f7b
.quad 0xa554248da554248d,0xa554248da554248d,0x3f7fbf803f7ebf7d,0x3f6abf6f3f79bf7b,0xbe063d333e5ebe9a,0xbf3d3f2dbeec3ec4,0xbf7b3f7fbf723f66,0xbea53ee2bf403f55
.quad 0x3e85bdb2bed83f13,0x3f7fbf7f3f52bf35,0x3f72bf7e3f5bbf39,0xbef63e8f3ebabf0e,0xbec43e063f1cbf4b,0xbf1c3f4bbf7e3f6d,0xbf663f7dbf393ef6,0x3f79bf5b3ddf3e48
.quad 0x3f5ebf7c3f25beaf,0xbf7c3f7cbeaf8000,0x3ee2be1cbf313f60,0x3e73bf053f7ebf7b,0xbf6d3f7ebf4b3f1c,0x3f4bbf1cbe063ec4,0xbea53ddf3f05bf31,0xbf603f76bf6f3f55
.quad 0x3f77bf7f3f68bf52,0xbdb2bdb23f13bf35,0x3e48bd86bea53ee2,0x3f72bf663f29bf0e,0xbf7e3f80bf7a3f74,0xbf2d3f3dbf633f6d,0xbd863cb33ddfbe1c,0xbece3ebabe733e48
.quad 0x3f80bf803f80bf80,0x3f80bf803f80bf80,0xbd863cb33ddfbe1c,0xbece3ebabe733e48,0xbf7e3f80bf7a3f74,0xbf2d3f3dbf633f6d,0x3e48bd86bea53ee2,0x3f72bf663f29bf0e
.quad 0x3f77bf7f3f68bf52,0xbdb2bdb23f13bf35,0xbea53ddf3f05bf31,0xbf603f76bf6f3f55,0xbf6d3f7ebf4b3f1c,0x3f4bbf1cbe063ec4,0x3ee2be1cbf313f60,0x3e73bf053f7ebf7b
.quad 0xbf713f443e32bf00,0x3f44bf00bf003f44,0x3ef6bf393f7dbf66,0xbf6f3f7fbf293ece,0x3f4bbf1cbe063ec4,0x3e06bec43f6dbf7e,0xbf393f5bbf7e3f72,0x3f4ebf293d863e1c
.quad 0xbf133ed83db2be85,0xbf683f77bf773f68,0x3f66bf723f7fbf7b,0x3d86be483f0ebf29,0x3e9abe5ebd333e06,0x3f58bf4b3f1cbf0a,0xbf7d3f7ebf803f7f,0xbf603f66bf723f76
.quad 0xa554248da554248d,0xa554248da554248d,0x3f7dbf7e3f80bf7f,0x3f60bf663f72bf76,0xbe9a3e5e3d33be06,0xbf583f4bbf1c3f0a,0xbf663f72bf7f3f7b,0xbd863e48bf0e3f29
.quad 0x3f13bed8bdb23e85,0x3f68bf773f77bf68,0x3f39bf5b3f7ebf72,0xbf4e3f29bd86be1c,0xbf4b3f1c3e06bec4,0xbe063ec4bf6d3f7e,0xbef63f39bf7d3f66,0x3f6fbf7f3f29bece
.quad 0x3eafbf253f7cbf5e,0xbf253f5ebf5e3f25,0x3f60bf31be1c3ee2,0xbeba3d863f40bf6a,0xbf1c3f4bbf7e3f6d,0x3f7ebf6d3ec4be06,0xbf313f053ddfbea5,0xbf173f40bf7f3f7d
.quad 0x3f52bf683f7fbf77,0xbed83e853e85bed8,0x3ee2bea5bd863e48,0x3f7fbf7b3f55bf40,0xbf743f7abf803f7e,0xbf0a3f1cbf4b3f58,0xbe1c3ddf3cb3bd86,0xbef63ee2bea53e8f
.quad 0x3f80bf803f80bf80,0x3f80bf803f80bf80,0xbe1c3ddf3cb3bd86,0xbef63ee2bea53e8f,0xbf743f7abf803f7e,0xbf0a3f1cbf4b3f58,0x3ee2bea5bd863e48,0x3f7fbf7b3f55bf40
.quad 0x3f52bf683f7fbf77,0xbed83e853e85bed8,0xbf313f053ddfbea5,0xbf173f40bf7f3f7d,0xbf1c3f4bbf7e3f6d,0x3f7ebf6d3ec4be06,0x3f60bf31be1c3ee2,0xbeba3d863f40bf6a
.quad 0x3e32bf003f80bf71,0xbf003f44bf713f44,0x3f78bf593dc93e53,0xbf153e9f3f11bf49,0xbea53f0ebf7b3f7f,0x3f7bbf7f3f29bee2,0xbf6b3f50be953d9c,0xbe693eddbf643f78
.quad 0x3eecbf1c3f6dbf7a,0xbf4b3f2dbe5e3d33,0x3f59bf463ef1beb4,0x3f62bf703f80bf7d,0xbf173f29bf553f60,0x3d863cb3be8f3eba,0xbf423f3bbf223f1a,0xbf703f6bbf5c3f56
.quad 0x3f35bf353f35bf35,0x3f35bf353f35bf35,0x3f27bf2f3f46bf4d,0x3eb4bec93f02bf0c,0xbf4e3f40bf0e3ef6,0xbf7f3f80bf763f6f,0xbf073f22bf623f70,0x3ef1beb4bd063e27
.quad 0x3f63bf4b3ec4be5e,0x3f1cbf3d3f7abf80,0x3ec9bf153f75bf7f,0xbf793f67bee73e7e,0xbf723f55be48bd86,0x3e483d86bf403f66,0xbe7e3f07bf7f3f7b,0x3f50bf733f53bf1e
.quad 0x3f7cbf5e80003eaf,0xbf5e3f253eafbf25,0xbe7e3f07bf7f3f7b,0x3f50bf733f53bf1e,0xbf723f55be48bd86,0x3e483d86bf403f66,0x3ec9bf153f75bf7f,0xbf793f67bee73e7e
.quad 0x3f63bf4b3ec4be5e,0x3f1cbf3d3f7abf80,0xbf073f22bf623f70,0x3ef1beb4bd063e27,0xbf4e3f40bf0e3ef6,0xbf7f3f80bf763f6f,0x3f27bf2f3f46bf4d,0x3eb4bec93f02bf0c
.quad 0x3f35bf353f35bf35,0x3f35bf353f35bf35,0xbf423f3bbf223f1a,0xbf703f6bbf5c3f56,0xbf173f29bf553f60,0x3d863cb3be8f3eba,0x3f59bf463ef1beb4,0x3f62bf703f80bf7d
.quad 0x3eecbf1c3f6dbf7a,0xbf4b3f2dbe5e3d33,0xbf6b3f50be953d9c,0xbe693eddbf643f78,0xbea53f0ebf7b3f7f,0x3f7bbf7f3f29bee2,0x3f78bf593dc93e53,0xbf153e9f3f11bf49
.quad 0xbf003e323f44bf71,0x3e323e32bf713f80,0x3f70bf803f27bec9,0xbf723f4dbc33be95,0x3e483d86bf403f66,0x3f40bf663f72bf55,0xbf803f7cbf2b3efb,0x3e533c33bf1e3f46
.quad 0x3e06be9a3f3dbf58,0xbf743f63bf0a3ec4,0x3f75bf693f2fbf15,0x3f3bbf503f79bf7f,0xbee23f05bf393f48,0x3e73be1cbddf3e48,0xbf503f49bf333f2b,0xbf773f73bf673f62
.quad 0x3f35bf353f35bf35,0x3f35bf353f35bf35,0x3f15bf1e3f37bf3f,0x3e8abe9f3eddbef1,0xbf663f5bbf313f20,0xbf793f7dbf7e3f7b,0xbe953ed3bf3b3f50,0x3f2fbf153e69bdc9
.quad 0x3f7ebf743f2dbf0a,0x3e9abeec3f58bf6d,0xbd06be3d3f3fbf5f,0xbf7b3f80bf493f22,0xbf7b3f7fbf293ee2,0x3f29bee2bea53f0e,0x3eb4bd5fbf423f6b,0x3eaabf1a3f80bf75
.quad 0x3f5ebf7c3f25beaf,0xbf7c3f7cbeaf8000,0x3eb4bd5fbf423f6b,0x3eaabf1a3f80bf75,0xbf7b3f7fbf293ee2,0x3f29bee2bea53f0e,0xbd06be3d3f3fbf5f,0xbf7b3f80bf493f22
.quad 0x3f7ebf743f2dbf0a,0x3e9abeec3f58bf6d,0xbe953ed3bf3b3f50,0x3f2fbf153e69bdc9,0xbf663f5bbf313f20,0xbf793f7dbf7e3f7b,0x3f15bf1e3f37bf3f,0x3e8abe9f3eddbef1
.quad 0x3f35bf353f35bf35,0x3f35bf353f35bf35,0xbf503f49bf333f2b,0xbf773f73bf673f62,0xbee23f05bf393f48,0x3e73be1cbddf3e48,0x3f75bf693f2fbf15,0x3f3bbf503f79bf7f
.quad 0x3e06be9a3f3dbf58,0xbf743f63bf0a3ec4,0xbf803f7cbf2b3efb,0x3e533c33bf1e3f46,0x3e483d86bf403f66,0x3f40bf663f72bf55,0x3f70bf803f27bec9,0xbf723f4dbc33be95
.quad 0xbf713f443e32bf00,0x3f44bf00bf003f44,0x3f63bf7c3f3dbf00,0xbf7a3f5ebe06be32,0xbe853f00bf773f80,0x3f77bf803f35bf00,0xbf0a3eaf3e9abf00,0xbf3d3f5ebf7e3f71
.quad 0x3f7cbf713f25bf00,0x3eafbf003f5ebf71,0xbf4b3f5ebf7e3f80,0x3e06a554bec43f00,0x3db2be323ed8bf00,0xbf133f00be853e32,0x3f2dbf253f0abf00,0x3f63bf5e3f4bbf44
.quad 0xbf803f80bf803f80,0xbf803f80bf803f80,0x3f2dbf253f0abf00,0x3f63bf5e3f4bbf44,0x3db2be323ed8bf00,0xbf133f00be853e32,0xbf4b3f5ebf7e3f80,0x3e06248dbec43f00
.quad 0x3f7cbf713f25bf00,0x3eafbf003f5ebf71,0xbf0a3eaf3e9abf00,0xbf3d3f5ebf7e3f71,0xbe853f00bf773f80,0x3f77bf803f35bf00,0x3f63bf7c3f3dbf00,0xbf7a3f5ebe06be32
.quad 0x3eafbf253f7cbf5e,0xbf253f5ebf5e3f25,0x3eecbe32bf2d3f5e,0x3e5ebf003f7ebf7c,0xbf773f5ebe858000,0x3e85a50dbf353f5e,0x3f58bf713f74bf5e,0xbf2d3f003e06beaf
.quad 0xbe323eafbf443f5e,0x3f71bf5e3f00beaf,0xbf1c3f00be068000,0xbf7e3f80bf6d3f5e,0x3f7fbf7c3f68bf5e,0x3f52bf5e3f77bf7c,0xbf3d3f44bf583f5e,0xbeec3f00bf1c3f25
.quad 0xa50d8000a50d8000,0xa50d8000a50d8000,0x3f3dbf443f58bf5e,0x3eecbf003f1cbf25,0xbf7f3f7cbf683f5e,0xbf523f5ebf773f7c,0x3f1cbf003e068000,0x3f7ebf803f6dbf5e
.quad 0x3e32beaf3f44bf5e,0xbf713f5ebf003eaf,0xbf583f71bf743f5e,0x3f2dbf00be063eaf,0x3f77bf5e3e858000,0xbe85a50d3f35bf5e,0xbeec3e323f2dbf5e,0xbe5e3f00bf7e3f7c
.quad 0xbf713f80bf003e32,0x3f80bf713e323e32,0x3eecbf353f7ebf68,0xbf6d3f7fbf2d3ed8,0x3e85a554bf353f5e,0x3f35bf5e3f77bf5e,0xbf583f35be06bdb2,0xbec43f13bf743f7f
.quad 0x3f7cbf803f5ebf44,0xa554be323f25bf44,0xbf1c3f35bf6d3f77,0x3ec4be85be063e85,0xbdb2248d3e85beaf,0xbf353f25bed83eaf,0x3f3dbf353f1cbf13,0x3f6dbf683f58bf52
.quad 0xbf803f80bf803f80,0xbf803f80bf803f80,0x3f3dbf353f1cbf13,0x3f6dbf683f58bf52,0xbdb2a5543e85beaf,0xbf353f25bed83eaf,0xbf1c3f35bf6d3f77,0x3ec4be85be063e85
.quad 0x3f7cbf803f5ebf44,0x248dbe323f25bf44,0xbf583f35be06bdb2,0xbec43f13bf743f7f,0x3e85248dbf353f5e,0x3f35bf5e3f77bf5e,0x3eecbf353f7ebf68,0xbf6d3f7fbf2d3ed8
.quad 0xbeaf80003f5ebf7c,0x80003eafbf7c3f7c,0x3f63bf35be063ed8,0xbec43db23f3dbf68,0xbf773f80bf353f00,0x3f35bf00be853f00,0x3f0abf353f7ebf7f,0xbf6d3f52be9a3db2
.quad 0x3e32a50dbf003f25,0x3f80bf7c3f44bf25,0xbf4b3f35bec43e85,0xbf6d3f77bf7e3f77,0x3f7fbf803f77bf71,0x3f35bf443f68bf71,0xbf2d3f35bf4b3f52,0xbec43ed8bf0a3f13
.quad 0xa50d8000a50d8000,0xa50d8000a50d8000,0x3f2dbf353f4bbf52,0x3ec4bed83f0abf13,0xbf7f3f80bf773f71,0xbf353f44bf683f71,0x3f4bbf353ec4be85,0x3f6dbf773f7ebf77
.quad 0xbe32a50d3f00bf25,0xbf803f7cbf443f25,0xbf0a3f35bf7e3f7f,0x3f6dbf523e9abdb2,0x3f77bf803f35bf00,0xbf353f003e85bf00,0xbf633f353e06bed8,0x3ec4bdb2bf3d3f68
.quad 0xbf003e323f44bf71,0x3e323e32bf713f80,0x3f79bf5c3df53e3d,0xbf1a3eaa3f0cbf46,0xbf553f72bf663f40,0x3f66bf403d863e48,0x3e27bebf3f5cbf73,0xbf803f7bbf273ef1
.quad 0x3f1cbeecbd333e5e,0x3f63bf743f7abf6d,0xbf7f3f79bf503f3b,0xbf153f2fbf693f75,0x3f40bf4e3f6fbf76,0x3e1cbe733ef6bf0e,0xbd063d9cbe533e7e,0x3e9fbe8a3e11bdc9
.quad 0xbf353f35bf353f35,0xbf353f35bf353f35,0x3f80bf7f3f7bbf78,0x3f73bf773f7dbf7f,0xbf293f17beba3e8f,0xbf7d3f79bf603f55,0xbdc93e69bf153f2f,0x3f50bf3b3ed3be95
.quad 0x3f4bbf633f80bf7a,0xbeec3e9a3e5ebec4,0xbf7d3f6ebf023e9f,0x3c333e53bf423f62,0x3f0ebea5bee23f29,0x3ee2bf293f7fbf7b,0x3e69bf023f7ebf7c,0xbf4d3f72bf563f22
.quad 0x3f5ebf7c3f25beaf,0xbf7c3f7cbeaf8000,0xbe693f02bf7e3f7c,0x3f4dbf723f56bf22,0xbf0e3ea53ee2bf29,0xbee23f29bf7f3f7b,0x3f7dbf6e3f02be9f,0xbc33be533f42bf62
.quad 0xbf4b3f63bf803f7a,0x3eecbe9abe5e3ec4,0x3dc9be693f15bf2f,0xbf503f3bbed33e95,0x3f29bf173ebabe8f,0x3f7dbf793f60bf55,0xbf803f7fbf7b3f78,0xbf733f77bf7d3f7f
.quad 0x3f35bf353f35bf35,0x3f35bf353f35bf35,0x3d06bd9c3e53be7e,0xbe9f3e8abe113dc9,0xbf403f4ebf6f3f76,0xbe1c3e73bef63f0e,0x3f7fbf793f50bf3b,0x3f15bf2f3f69bf75
.quad 0xbf1c3eec3d33be5e,0xbf633f74bf7a3f6d,0xbe273ebfbf5c3f73,0x3f80bf7b3f27bef1,0x3f55bf723f66bf40,0xbf663f40bd86be48,0xbf793f5cbdf5be3d,0x3f1abeaabf0c3f46
.quad 0xbf713f443e32bf00,0x3f44bf00bf003f44,0x3f6ebf7f3f2bbed3,0xbf733f50bd06be8a,0xbee23f29bf7f3f7b,0x3f7fbf7b3f0ebea5,0xbe8a3d5f3f11bf3b,0xbf673f79bf693f4d
.quad 0x3f58bf3d3e9abe06,0x3f2dbf4b3f7ebf80,0xbf7d3f80bf703f62,0xbeb43ef1bf463f59,0x3f20bf313f5bbf66,0xbcb3bd863ea5bece,0x3d5fbc33bdf53e27,0x3ec9beb43e69be3d
.quad 0xbf353f35bf353f35,0xbf353f35bf353f35,0x3f80bf803f7ebf7d,0x3f6bbf703f79bf7c,0xbf483f39bf053ee2,0xbf803f7fbf723f6a,0x3e27bd06beb43ef1,0x3f70bf623f22bf07
.quad 0x3f0abf2d3f74bf7e,0xbf3d3f1cbe06bd33,0xbf773f80bf533f2f,0x3eddbe69bed33f1a,0x3f66bf403d863e48,0xbd86be483f55bf72,0xbebf3d9c3f3fbf69,0xbe9f3f15bf803f77
.quad 0x3eafbf253f7cbf5e,0xbf253f5ebf5e3f25,0x3ebfbd9cbf3f3f69,0x3e9fbf153f80bf77,0xbf663f40bd86be48,0x3d863e48bf553f72,0x3f77bf803f53bf2f,0xbedd3e693ed3bf1a
.quad 0xbf0a3f2dbf743f7e,0x3f3dbf1c3e063d33,0xbe273d063eb4bef1,0xbf703f62bf223f07,0x3f48bf393f05bee2,0x3f80bf7f3f72bf6a,0xbf803f80bf7e3f7d,0xbf6b3f70bf793f7c
.quad 0x3f35bf353f35bf35,0x3f35bf353f35bf35,0xbd5f3c333df5be27,0xbec93eb4be693e3d,0xbf203f31bf5b3f66,0x3cb33d86bea53ece,0x3f7dbf803f70bf62,0x3eb4bef13f46bf59
.quad 0xbf583f3dbe9a3e06,0xbf2d3f4bbf7e3f80,0x3e8abd5fbf113f3b,0x3f67bf793f69bf4d,0x3ee2bf293f7fbf7b,0xbf7f3f7bbf0e3ea5,0xbf6e3f7fbf2b3ed3,0x3f73bf503d063e8a
.quad 0x3e32bf003f80bf71,0xbf003f44bf713f44,0x3f17bea5bf0e3f48,0x3d86beba3f76bf80,0xbf7e3f6dbec43e06,0x3ec4be06bf1c3f4b,0x3f48bf663f7bbf6a,0xbf403f173cb3be73
.quad 0xbdb23e85bf353f52,0x3f77bf683f13bed8,0xbf293f0ebe483d86,0xbf7b3f7fbf723f66,0x3f80bf7e3f6dbf63,0x3f4bbf583f74bf7a,0xbf393f40bf553f5b,0xbee23ef6bf173f20
.quad 0xa554248da554248d,0xa554248da554248d,0x3f39bf403f55bf5b,0x3ee2bef63f17bf20,0xbf803f7ebf6d3f63,0xbf4b3f58bf743f7a,0x3f29bf0e3e48bd86,0x3f7bbf7f3f72bf66
.quad 0x3db2be853f35bf52,0xbf773f68bf133ed8,0xbf483f66bf7b3f6a,0x3f40bf17bcb33e73,0x3f7ebf6d3ec4be06,0xbec43e063f1cbf4b,0xbf173ea53f0ebf48,0xbd863ebabf763f80
.quad 0x3f7cbf5e80003eaf,0xbf5e3f253eafbf25,0xbf4e3f72bf553f20,0x3f7fbf6f3e8f3cb3,0x3e06bec43f6dbf7e,0xbf6d3f7ebf4b3f1c,0x3f20bee2be483ece,0x3f29bf4e3f80bf79
.quad 0xbf7f3f77bf353f13,0xbe853ed8bf523f68,0x3f40bf553f7bbf7f,0xbe483d863ea5bee2,0xbd333e06bec43eec,0x3f1cbf0a3e9abe5e,0xbf313f29bf0e3f05,0xbf663f60bf4e3f48
.quad 0x3f80bf803f80bf80,0x3f80bf803f80bf80,0xbf313f29bf0e3f05,0xbf663f60bf4e3f48,0xbd333e06bec43eec,0x3f1cbf0a3e9abe5e,0x3f40bf553f7bbf7f,0xbe483d863ea5bee2
.quad 0xbf7f3f77bf353f13,0xbe853ed8bf523f68,0x3f20bee2be483ece,0x3f29bf4e3f80bf79,0x3e06bec43f6dbf7e,0xbf6d3f7ebf4b3f1c,0xbf4e3f72bf553f20,0x3f7fbf6f3e8f3cb3
.quad 0xbf003e323f44bf71,0x3e323e32bf713f80,0x3f72bf4e3cb33e8f,0xbf053e733f20bf55,0xbf6d3f7ebf4b3f1c,0x3f4bbf1cbe063ec4,0x3ee2bf203f79bf80,0xbf763f60bece3e48
.quad 0x3e85bdb2bed83f13,0x3f7fbf7f3f52bf35,0xbf553f40bee23ea5,0xbf663f72bf7f3f7b,0x3f7ebf803f7abf74,0x3f2dbf3d3f63bf6d,0xbf293f31bf483f4e,0xbeba3ecebf053f0e
.quad 0xa554248da554248d,0xa554248da554248d,0x3f29bf313f48bf4e,0x3ebabece3f05bf0e,0xbf7e3f80bf7a3f74,0xbf2d3f3dbf633f6d,0x3f55bf403ee2bea5,0x3f66bf723f7fbf7b
.quad 0xbe853db23ed8bf13,0xbf7f3f7fbf523f35,0xbee23f20bf793f80,0x3f76bf603ecebe48,0x3f6dbf7e3f4bbf1c,0xbf4b3f1c3e06bec4,0xbf723f4ebcb3be8f,0x3f05be73bf203f55
.quad 0x3f5ebf7c3f25beaf,0xbf7c3f7cbeaf8000,0xbea53f17bf803f76,0x3f5bbf793f48bf0e,0xbec43e063f1cbf4b,0xbf1c3f4bbf7e3f6d,0x3f66bf483e73bcb3,0x3e8fbef63f6abf7b
.quad 0xbf773f7fbf683f52,0x3db23db2bf133f35,0x3f0ebf293f66bf72,0xbee23ea53d86be48,0x3e06bd33be5e3e9a,0x3f3dbf2d3eecbec4,0xbf403f39bf203f17,0xbf6f3f6abf5b3f55
.quad 0x3f80bf803f80bf80,0x3f80bf803f80bf80,0xbf403f39bf203f17,0xbf6f3f6abf5b3f55,0x3e06bd33be5e3e9a,0x3f3dbf2d3eecbec4,0x3f0ebf293f66bf72,0xbee23ea53d86be48
.quad 0xbf773f7fbf683f52,0x3db23db2bf133f35,0x3f66bf483e73bcb3,0x3e8fbef63f6abf7b,0xbec43e063f1cbf4b,0xbf1c3f4bbf7e3f6d,0xbea53f17bf803f76,0x3f5bbf793f48bf0e
.quad 0x3f44bf713f44bf00,0xbf713f80bf003e32,0xbd9c3ebfbf773f80,0x3f33bf623f69bf3f,0xbf293ee23ea5bf0e,0xbea53f0ebf7b3f7f,0x3f80bf773f1abed3,0xbdf5bdc93f2fbf53
.quad 0xbf3d3f58bf803f7e,0x3f0abec4be063e9a,0x3d06be273f07bf22,0xbf593f46bef13eb4,0x3f31bf203ecebea5,0x3f7ebf7b3f66bf5b,0xbf803f80bf7c3f79,0xbf723f75bf7d3f7e
.quad 0x3f35bf353f35bf35,0x3f35bf353f35bf35,0x3c33bd5f3e3dbe69,0xbeaa3e95be273df5,0xbf393f48bf6a3f72,0xbddf3e48bee23f05,0x3f80bf7d3f59bf46,0x3f07bf223f62bf70
.quad 0xbf2d3f0abd33be06,0xbf583f6dbf7e3f74,0xbd5f3e8abf4d3f69,0x3f7ebf7f3f3bbf11,0x3f40bf663f72bf55,0xbf723f55be48bd86,0xbf7f3f6ebe8abd06,0x3f37bef1bed33f2b
.quad 0x3f25beafbf253f5e,0xbeaf80003f5ebf7c,0xbf7f3f6ebe8abd06,0x3f37bef1bed33f2b,0x3f40bf663f72bf55,0xbf723f55be48bd86,0xbd5f3e8abf4d3f69,0x3f7ebf7f3f3bbf11
.quad 0xbf2d3f0abd33be06,0xbf583f6dbf7e3f74,0x3f80bf7d3f59bf46,0x3f07bf223f62bf70,0xbf393f48bf6a3f72,0xbddf3e48bee23f05,0x3c33bd5f3e3dbe69,0xbeaa3e95be273df5
.quad 0x3f35bf353f35bf35,0x3f35bf353f35bf35,0xbf803f80bf7c3f79,0xbf723f75bf7d3f7e,0x3f31bf203ecebea5,0x3f7ebf7b3f66bf5b,0x3d06be273f07bf22,0xbf593f46bef13eb4
.quad 0xbf3d3f58bf803f7e,0x3f0abec4be063e9a,0x3f80bf773f1abed3,0xbdf5bdc93f2fbf53,0xbf293ee23ea5bf0e,0xbea53f0ebf7b3f7f,0xbd9c3ebfbf773f80,0x3f33bf623f69bf3f
.quad 0x3e32bf003f80bf71,0xbf003f44bf713f44,0x3f02be69bf223f56,0x3e27bee73f7cbf7e,0xbf723f55be48bd86,0x3e483d86bf403f66,0x3f6ebf7d3f62bf42,0xbf073eaa3e9fbf02
.quad 0xbeec3f1cbf6d3f7a,0x3f4bbf2d3e5ebd33,0xbe693dc93e95bed3,0xbf753f69bf2f3f15,0x3f4ebf403f0ebef6,0x3f7fbf803f76bf6f,0xbf7f3f80bf7f3f7d,0xbf693f6ebf783f7b
.quad 0x3f35bf353f35bf35,0x3f35bf353f35bf35,0xbd9c3d063dc9be11,0xbed33ebfbe7e3e53,0xbf173f29bf553f60,0x3d863cb3be8f3eba,0x3f79bf7f3f75bf69,0x3e95bed33f3bbf50
.quad 0xbf633f4bbec43e5e,0xbf1c3f3dbf7a3f80,0x3ebfbe27bef13f27,0x3f59bf723f73bf5c,0x3ea5bf0e3f7bbf7f,0xbf7b3f7fbf293ee2,0xbf5c3f79bf463f0c,0x3f7dbf643e3d3df5
.quad 0x3f7cbf5e80003eaf,0xbf5e3f253eafbf25,0xbf5c3f79bf463f0c,0x3f7dbf643e3d3df5,0x3ea5bf0e3f7bbf7f,0xbf7b3f7fbf293ee2,0x3ebfbe27bef13f27,0x3f59bf723f73bf5c
.quad 0xbf633f4bbec43e5e,0xbf1c3f3dbf7a3f80,0x3f79bf7f3f75bf69,0x3e95bed33f3bbf50,0xbf173f29bf553f60,0x3d863cb3be8f3eba,0xbd9c3d063dc9be11,0xbed33ebfbe7e3e53
.quad 0x3f35bf353f35bf35,0x3f35bf353f35bf35,0xbf7f3f80bf7f3f7d,0xbf693f6ebf783f7b,0x3f4ebf403f0ebef6,0x3f7fbf803f76bf6f,0xbe693dc93e95bed3,0xbf753f69bf2f3f15
.quad 0xbeec3f1cbf6d3f7a,0x3f4bbf2d3e5ebd33,0x3f6ebf7d3f62bf42,0xbf073eaa3e9fbf02,0xbf723f55be48bd86,0x3e483d86bf403f66,0x3f02be69bf223f56,0x3e27bee73f7cbf7e
.quad 0xbf003e323f44bf71,0x3e323e32bf713f80,0x3f1cbeafbf0a3f44,0x3d33beaf3f74bf80,0xbf353f003e85bf00,0xbe853f00bf773f80,0x3f4bbf253d333e32,0x3eecbf253f7abf80
.quad 0xbf5e3f44beaf3e32,0xbf253f44bf7c3f80,0x3f6dbf5e3f1cbf00,0x3f4bbf5e3f7ebf80,0xbf773f71bf523f44,0xbf683f71bf7f3f80,0x3f7ebf7c3f74bf71,0x3f7abf7c3f80bf80
.quad 0xbf803f80bf803f80,0xbf803f80bf803f80,0x3f7ebf7c3f74bf71,0x3f7abf7c3f80bf80,0xbf773f71bf523f44,0xbf683f71bf7f3f80,0x3f6dbf5e3f1cbf00,0x3f4bbf5e3f7ebf80
.quad 0xbf5e3f44beaf3e32,0xbf253f44bf7c3f80,0x3f4bbf253d333e32,0x3eecbf253f7abf80,0xbf353f003e85bf00,0xbe853f00bf773f80,0x3f1cbeafbf0a3f44,0x3d33beaf3f74bf80
.quad 0x3f5ebf7c3f25beaf,0xbf7c3f7cbeaf8000,0xbf4b3f71bf583f25,0x3f80bf713e9aa50d,0x3f35bf5e3f77bf5e,0xbf773f5ebe858000,0xbf1c3f44bf803f7c,0x3f63bf443e5ea50d
.quad 0x3f00bf253f71bf7c,0xbf443f25be328000,0xbec43f00bf4b3f5e,0x3f1cbf003e06a50d,0x3e85beaf3f13bf25,0xbed83eafbdb28000,0xbe063e32be9a3eaf,0x3e5ebe323d33a50d
.quad 0xa50d8000a50d8000,0xa50d8000a50d8000,0x3e06be323e9abeaf,0xbe5e3e32bd33a50d,0xbe853eafbf133f25,0x3ed8beaf3db28000,0x3ec4bf003f4bbf5e,0xbf1c3f00be06a50d
.quad 0xbf003f25bf713f7c,0x3f44bf253e328000,0x3f1cbf443f80bf7c,0xbf633f44be5ea50d,0xbf353f5ebf773f5e,0x3f77bf5e3e858000,0x3f4bbf713f58bf25,0xbf803f71be9aa50d
.quad 0xbf713f443e32bf00,0x3f44bf00bf003f44,0x3f74bf523d333e85,0xbf0a3e853f1cbf52,0xbf773f5ebe85248d,0x3e85a554bf353f5e,0x3f7abf683eecbe85,0x3d33be853f4bbf68
.quad 0xbf7c3f71bf253f00,0xbeaf3f00bf5e3f71,0x3f7ebf773f4bbf35,0x3f1cbf353f6dbf77,0xbf7f3f7cbf683f5e,0xbf523f5ebf773f7c,0x3f80bf7f3f7abf77,0x3f74bf773f7ebf7f
.quad 0xbf803f80bf803f80,0xbf803f80bf803f80,0x3f80bf7f3f7abf77,0x3f74bf773f7ebf7f,0xbf7f3f7cbf683f5e,0xbf523f5ebf773f7c,0x3f7ebf773f4bbf35,0x3f1cbf353f6dbf77
.quad 0xbf7c3f71bf253f00,0xbeaf3f00bf5e3f71,0x3f7abf683eecbe85,0x3d33be853f4bbf68,0xbf773f5ebe85a554,0x3e85248dbf353f5e,0x3f74bf523d333e85,0xbf0a3e853f1cbf52
.quad 0x3eafbf253f7cbf5e,0xbf253f5ebf5e3f25,0xbe9a3f13bf803f77,0x3f58bf773f4bbf13,0x3e85bf003f77bf80,0xbf773f80bf353f00,0xbe5e3ed8bf633f77,0x3f80bf773f1cbed8
.quad 0x3e32beaf3f44bf5e,0xbf713f5ebf003eaf,0xbe063e85bf1c3f35,0x3f4bbf353ec4be85,0x3db2be323ed8bf00,0xbf133f00be853e32,0xbd333db2be5e3e85,0x3e9abe853e06bdb2
.quad 0xa50d8000a50d8000,0xa50d8000a50d8000,0x3d33bdb23e5ebe85,0xbe9a3e85be063db2,0xbdb23e32bed83f00,0x3f13bf003e85be32,0x3e06be853f1cbf35,0xbf4b3f35bec43e85
.quad 0xbe323eafbf443f5e,0x3f71bf5e3f00beaf,0x3e5ebed83f63bf77,0xbf803f77bf1c3ed8,0xbe853f00bf773f80,0x3f77bf803f35bf00,0x3e9abf133f80bf77,0xbf583f77bf4b3f13
.quad 0x3e32bf003f80bf71,0xbf003f44bf713f44,0xbd5f3eb4bf753f80,0x3f2fbf5f3f6bbf42,0xbd86be483f55bf72,0xbf553f72bf663f40,0x3e3d3d06bf223f49,0x3f70bf7d3f5fbf3f
.quad 0xbe9a3e063ec4bf0a,0xbf7e3f80bf583f3d,0x3ed3be95bdc93e69,0x3f7fbf793f50bf3b,0xbf053ee2be483ddf,0xbf723f6abf483f39,0x3f1ebf153ef1bedd,0x3f59bf533f3fbf37
.quad 0xbf353f35bf353f35,0xbf353f35bf353f35,0x3f49bf503f62bf67,0x3f07bf113f2bbf33,0xbf5b3f66bf7b3f7e,0xbea53ecebf203f31,0x3f69bf753f7fbf79,0x3dc9be693f15bf2f
.quad 0xbf743f7ebf6d3f58,0x3e063d33bf0a3f2d,0x3f7cbf803f46bf1e,0xbeb43e113efbbf2b,0xbf7f3f7bbf0e3ea5,0x3f0ebea5bee23f29,0x3f80bf703e953c33,0xbf3b3efb3ec9bf27
.quad 0x3f7cbf5e80003eaf,0xbf5e3f253eafbf25,0xbf803f70be95bc33,0x3f3bbefbbec93f27,0x3f7fbf7b3f0ebea5,0xbf0e3ea53ee2bf29,0xbf7c3f80bf463f1e,0x3eb4be11befb3f2b
.quad 0x3f74bf7e3f6dbf58,0xbe06bd333f0abf2d,0xbf693f75bf7f3f79,0xbdc93e69bf153f2f,0x3f5bbf663f7bbf7e,0x3ea5bece3f20bf31,0xbf493f50bf623f67,0xbf073f11bf2b3f33
.quad 0x3f35bf353f35bf35,0x3f35bf353f35bf35,0xbf1e3f15bef13edd,0xbf593f53bf3f3f37,0x3f05bee23e48bddf,0x3f72bf6a3f48bf39,0xbed33e953dc9be69,0xbf7f3f79bf503f3b
.quad 0x3e9abe06bec43f0a,0x3f7ebf803f58bf3d,0xbe3dbd063f22bf49,0xbf703f7dbf5f3f3f,0x3d863e48bf553f72,0x3f55bf723f66bf40,0x3d5fbeb43f75bf80,0xbf2f3f5fbf6b3f42
.quad 0xbf003e323f44bf71,0x3e323e32bf713f80,0x3f07be7ebf1e3f53,0x3e11bedd3f7bbf7f,0xbf0e3ea53ee2bf29,0xbee23f29bf7f3f7b,0x3f15bec9be7e3ee7,0x3f33bf563f7fbf75
.quad 0xbf1c3eec3d33be5e,0xbf633f74bf7a3f6d,0x3f22bf073e27bd06,0x3f7dbf803f70bf62,0xbf293f17beba3e8f,0xbf7d3f79bf603f55,0x3f2fbf273f0cbf02,0x3f64bf5f3f4dbf46
.quad 0xbf353f35bf353f35,0xbf353f35bf353f35,0x3f3bbf423f56bf5c,0x3ee7befb3f1abf22,0xbf403f4ebf6f3f76,0xbe1c3e73bef63f0e,0x3f46bf593f7dbf80,0xbe273d063eb4bef1
.quad 0xbf4b3f63bf803f7a,0x3eecbe9abe5e3ec4,0x3f50bf6b3f78bf64,0xbf373f0c3d9cbe95,0xbf553f72bf663f40,0x3f66bf403d863e48,0x3f59bf783f49bf11,0xbf7d3f67be53bdc9
.quad 0x3f5ebf7c3f25beaf,0xbf7c3f7cbeaf8000,0xbf593f78bf493f11,0x3f7dbf673e533dc9,0x3f55bf723f66bf40,0xbf663f40bd86be48,0xbf503f6bbf783f64,0x3f37bf0cbd9c3e95
.quad 0x3f4bbf633f80bf7a,0xbeec3e9a3e5ebec4,0xbf463f59bf7d3f80,0x3e27bd06beb43ef1,0x3f40bf4e3f6fbf76,0x3e1cbe733ef6bf0e,0xbf3b3f42bf563f5c,0xbee73efbbf1a3f22
.quad 0x3f35bf353f35bf35,0x3f35bf353f35bf35,0xbf2f3f27bf0c3f02,0xbf643f5fbf4d3f46,0x3f29bf173ebabe8f,0x3f7dbf793f60bf55,0xbf223f07be273d06,0xbf7d3f80bf703f62
.quad 0x3f1cbeecbd333e5e,0x3f63bf743f7abf6d,0xbf153ec93e7ebee7,0xbf333f56bf7f3f75,0x3f0ebea5bee23f29,0x3ee2bf293f7fbf7b,0xbf073e7e3f1ebf53,0xbe113eddbf7b3f7f
.quad 0x3f44bf713f44bf00,0xbf713f80bf003e32,0xbf313f60bf6a3f40,0x3f7ebf7b3ee2be1c,0x3f1cbf4b3f7ebf6d,0xbf7e3f6dbec43e06,0xbf053f31bf7d3f7f,0x3f6fbf553ea5bddf
.quad 0x3ed8bf133f68bf77,0xbf523f35be853db2,0xbea53ee2bf403f55,0x3f29bf0e3e48bd86,0x3e5ebe9a3f0abf1c,0xbeec3ec4be063d33,0xbddf3e1cbe8f3ea5,0x3e73be483d86bcb3
.quad 0xa554248da554248d,0xa554248da554248d,0x3ddfbe1c3e8fbea5,0xbe733e48bd863cb3,0xbe5e3e9abf0a3f1c,0x3eecbec43e06bd33,0x3ea5bee23f40bf55,0xbf293f0ebe483d86
.quad 0xbed83f13bf683f77,0x3f52bf353e85bdb2,0x3f05bf313f7dbf7f,0xbf6f3f55bea53ddf,0xbf1c3f4bbf7e3f6d,0x3f7ebf6d3ec4be06,0x3f31bf603f6abf40,0xbf7e3f7bbee23e1c
.quad 0x3f25beafbf253f5e,0xbeaf80003f5ebf7c,0xbf393ef63ecebf29,0x3ddf3e48bf663f7d,0x3f4bbf1cbe063ec4,0x3e06bec43f6dbf7e,0xbf5b3f39be1cbd86,0xbeba3f0ebf723f7e
.quad 0x3f68bf523ed8be85,0x3f13bf353f77bf7f,0xbf723f66bf293f0e,0xbf403f55bf7b3f7f,0x3f7abf743f58bf4b,0x3f63bf6d3f7ebf80,0xbf7e3f7dbf763f72,0xbf793f7bbf7f3f80
.quad 0x3f80bf803f80bf80,0x3f80bf803f80bf80,0xbf7e3f7dbf763f72,0xbf793f7bbf7f3f80,0x3f7abf743f58bf4b,0x3f63bf6d3f7ebf80,0xbf723f66bf293f0e,0xbf403f55bf7b3f7f
.quad 0x3f68bf523ed8be85,0x3f13bf353f77bf7f,0xbf5b3f39be1cbd86,0xbeba3f0ebf723f7e,0x3f4bbf1cbe063ec4,0x3e06bec43f6dbf7e,0xbf393ef63ecebf29,0x3ddf3e48bf663f7d
.quad 0x3e32bf003f80bf71,0xbf003f44bf713f44,0xbe1c3ee2bf7b3f7e,0x3f40bf6a3f60bf31,0x3e06bec43f6dbf7e,0xbf6d3f7ebf4b3f1c,0xbddf3ea5bf553f6f,0x3f7fbf7d3f31bf05
.quad 0x3db2be853f35bf52,0xbf773f68bf133ed8,0xbd863e48bf0e3f29,0x3f55bf403ee2bea5,0x3d33be063ec4beec,0xbf1c3f0abe9a3e5e,0xbcb33d86be483e73,0x3ea5be8f3e1cbddf
.quad 0xa554248da554248d,0xa554248da554248d,0x3cb3bd863e48be73,0xbea53e8fbe1c3ddf,0xbd333e06bec43eec,0x3f1cbf0a3e9abe5e,0x3d86be483f0ebf29,0xbf553f40bee23ea5
.quad 0xbdb23e85bf353f52,0x3f77bf683f13bed8,0x3ddfbea53f55bf6f,0xbf7f3f7dbf313f05,0xbe063ec4bf6d3f7e,0x3f6dbf7e3f4bbf1c,0x3e1cbee23f7bbf7e,0xbf403f6abf603f31
.quad 0x3f7cbf5e80003eaf,0xbf5e3f253eafbf25,0xbf7d3f66be48bddf,0x3f29becebef63f39,0x3f7ebf6d3ec4be06,0xbec43e063f1cbf4b,0xbf7e3f72bf0e3eba,0x3d863e1cbf393f5b
.quad 0x3f7fbf773f35bf13,0x3e85bed83f52bf68,0xbf7f3f7bbf553f40,0xbf0e3f29bf663f72,0x3f80bf7e3f6dbf63,0x3f4bbf583f74bf7a,0xbf803f7fbf7b3f79,0xbf723f76bf7d3f7e
.quad 0x3f80bf803f80bf80,0x3f80bf803f80bf80,0xbf803f7fbf7b3f79,0xbf723f76bf7d3f7e,0x3f80bf7e3f6dbf63,0x3f4bbf583f74bf7a,0xbf7f3f7bbf553f40,0xbf0e3f29bf663f72
.quad 0x3f7fbf773f35bf13,0x3e85bed83f52bf68,0xbf7e3f72bf0e3eba,0x3d863e1cbf393f5b,0x3f7ebf6d3ec4be06,0xbec43e063f1cbf4b,0xbf7d3f66be48bddf,0x3f29becebef63f39
.quad 0x3f80bf713e323e32,0xbf713f443e32bf00,0xbf7f3f7bbedd3e11,0x3f53bf1ebe7e3f07,0x3f7bbf7f3f29bee2,0xbf293ee23ea5bf0e,0xbf753f7fbf563f33,0x3ee7be7ebec93f15
.quad 0x3f6dbf7a3f74bf63,0xbe5e3d333eecbf1c,0xbf623f70bf803f7d,0xbd063e27bf073f22,0x3f55bf603f79bf7d,0x3e8fbeba3f17bf29,0xbf463f4dbf5f3f64,0xbf023f0cbf273f2f
.quad 0x3f35bf353f35bf35,0x3f35bf353f35bf35,0xbf223f1abefb3ee7,0xbf5c3f56bf423f3b,0x3f0ebef63e73be1c,0x3f76bf6f3f4ebf40,0xbef13eb43d06be27,0xbf803f7dbf593f46
.quad 0x3ec4be5ebe9a3eec,0x3f7abf803f63bf4b,0xbe953d9c3f0cbf37,0xbf643f78bf6b3f50,0x3e483d86bf403f66,0x3f40bf663f72bf55,0xbdc9be533f67bf7d,0xbf113f49bf783f59
.quad 0x80003eafbf7c3f7c,0x3eafbf253f7cbf5e,0xbdc9be533f67bf7d,0xbf113f49bf783f59,0x3e483d86bf403f66,0x3f40bf663f72bf55,0xbe953d9c3f0cbf37,0xbf643f78bf6b3f50
.quad 0x3ec4be5ebe9a3eec,0x3f7abf803f63bf4b,0xbef13eb43d06be27,0xbf803f7dbf593f46,0x3f0ebef63e73be1c,0x3f76bf6f3f4ebf40,0xbf223f1abefb3ee7,0xbf5c3f56bf423f3b
.quad 0x3f35bf353f35bf35,0x3f35bf353f35bf35,0xbf463f4dbf5f3f64,0xbf023f0cbf273f2f,0x3f55bf603f79bf7d,0x3e8fbeba3f17bf29,0xbf623f70bf803f7d,0xbd063e27bf073f22
.quad 0x3f6dbf7a3f74bf63,0xbe5e3d333eecbf1c,0xbf753f7fbf563f33,0x3ee7be7ebec93f15,0x3f7bbf7f3f29bee2,0xbf293ee23ea5bf0e,0xbf7f3f7bbedd3e11,0x3f53bf1ebe7e3f07
.quad 0x3f44bf713f44bf00,0xbf713f80bf003e32,0xbf423f6bbf5f3f2f,0x3f80bf753eb4bd5f,0x3f40bf663f72bf55,0xbf723f55be48bd86,0xbf3f3f5fbf7d3f70,0x3f49bf223d063e3d
.quad 0x3f3dbf583f80bf7e,0xbf0a3ec43e06be9a,0xbf3b3f50bf793f7f,0x3e69bdc9be953ed3,0x3f39bf483f6abf72,0x3ddfbe483ee2bf05,0xbf373f3fbf533f59,0xbedd3ef1bf153f1e
.quad 0x3f35bf353f35bf35,0x3f35bf353f35bf35,0xbf333f2bbf113f07,0xbf673f62bf503f49,0x3f31bf203ecebea5,0x3f7ebf7b3f66bf5b,0xbf2f3f15be693dc9,0xbf793f7fbf753f69
.quad 0x3f2dbf0a3d333e06,0x3f58bf6d3f7ebf74,0xbf2b3efb3e11beb4,0xbf1e3f46bf803f7c,0x3f29bee2bea53f0e,0x3ea5bf0e3f7bbf7f,0xbf273ec93efbbf3b,0x3c333e95bf703f80
.quad 0x3f25beafbf253f5e,0xbeaf80003f5ebf7c,0xbf273ec93efbbf3b,0x3c333e95bf703f80,0x3f29bee2bea53f0e,0x3ea5bf0e3f7bbf7f,0xbf2b3efb3e11beb4,0xbf1e3f46bf803f7c
.quad 0x3f2dbf0a3d333e06,0x3f58bf6d3f7ebf74,0xbf2f3f15be693dc9,0xbf793f7fbf753f69,0x3f31bf203ecebea5,0x3f7ebf7b3f66bf5b,0xbf333f2bbf113f07,0xbf673f62bf503f49
.quad 0x3f35bf353f35bf35,0x3f35bf353f35bf35,0xbf373f3fbf533f59,0xbedd3ef1bf153f1e,0x3f39bf483f6abf72,0x3ddfbe483ee2bf05,0xbf3b3f50bf793f7f,0x3e69bdc9be953ed3
.quad 0x3f3dbf583f80bf7e,0xbf0a3ec43e06be9a,0xbf3f3f5fbf7d3f70,0x3f49bf223d063e3d,0x3f40bf663f72bf55,0xbf723f55be48bd86,0xbf423f6bbf5f3f2f,0x3f80bf753eb4bd5f
.quad 0x3e32bf003f80bf71,0xbf003f44bf713f44,0xbf2d3f5ebf6d3f44,0x3f7ebf7c3eecbe32,0x3f77bf803f35bf00,0xbf353f003e85bf00,0xbf743f5ebec43e32,0xbe063eafbf583f71
.quad 0x3f25bf00248d3e32,0x3f5ebf713f7cbf71,0xbe06248d3ec4bf00,0xbf6d3f5ebf1c3f00,0xbed83f00bf353f44,0x3e85be32bdb23e32,0x3f58bf5e3f6dbf71,0x3f1cbf253f3dbf44
.quad 0xbf803f80bf803f80,0xbf803f80bf803f80,0x3f58bf5e3f6dbf71,0x3f1cbf253f3dbf44,0xbed83f00bf353f44,0x3e85be32bdb23e32,0xbe06a5543ec4bf00,0xbf6d3f5ebf1c3f00
.quad 0x3f25bf00a5543e32,0x3f5ebf713f7cbf71,0xbf743f5ebec43e32,0xbe063eafbf583f71,0x3f77bf803f35bf00,0xbf353f003e85bf00,0xbf2d3f5ebf6d3f44,0x3f7ebf7c3eecbe32
.quad 0x3f7cbf5e80003eaf,0xbf5e3f253eafbf25,0xbf3d3f003ec4bf25,0x3e063e32bf633f7c,0x3e85a50dbf353f5e,0x3f35bf5e3f77bf5e,0x3e9abf003f6dbf7c,0xbf7e3f71bf0a3eaf
.quad 0xbf443f5ebf803f7c,0x3f00beafbe323eaf,0x3f7ebf803f6dbf5e,0x3ec4bf003f4bbf5e,0xbf683f5ebf353f25,0xbf773f7cbf7f3f7c,0x3f0abf003ec4beaf,0x3f4bbf443f2dbf25
.quad 0xa50d8000a50d8000,0xa50d8000a50d8000,0xbf0a3f00bec43eaf,0xbf4b3f44bf2d3f25,0x3f68bf5e3f35bf25,0x3f77bf7c3f7fbf7c,0xbf7e3f80bf6d3f5e,0xbec43f00bf4b3f5e
.quad 0x3f44bf5e3f80bf7c,0xbf003eaf3e32beaf,0xbe9a3f00bf6d3f7c,0x3f7ebf713f0abeaf,0xbe85a50d3f35bf5e,0xbf353f5ebf773f5e,0x3f3dbf00bec43f25,0xbe06be323f63bf7c
.quad 0xbf003e323f44bf71,0x3e323e32bf713f80,0xbe063ed8bf7a3f7f,0x3f3dbf683f63bf35,0x3f35bf5e3f77bf5e,0xbf773f5ebe85248d,0xbf7e3f7fbf3d3f13,0x3e9abdb2bf0a3f35
.quad 0x3f5ebf443eafbe32,0x3f25bf443f7cbf80,0xbec43e853e06be85,0xbf7e3f77bf4b3f35,0xbe853eafbf133f25,0x3ed8beaf3db2a554,0x3f4bbf523f63bf68,0x3f0abf133f2dbf35
.quad 0xbf803f80bf803f80,0xbf803f80bf803f80,0x3f4bbf523f63bf68,0x3f0abf133f2dbf35,0xbe853eafbf133f25,0x3ed8beaf3db2248d,0xbec43e853e06be85,0xbf7e3f77bf4b3f35
.quad 0x3f5ebf443eafbe32,0x3f25bf443f7cbf80,0xbf7e3f7fbf3d3f13,0x3e9abdb2bf0a3f35,0x3f35bf5e3f77bf5e,0xbf773f5ebe85a554,0xbe063ed8bf7a3f7f,0x3f3dbf683f63bf35
.quad 0x3f5ebf7c3f25beaf,0xbf7c3f7cbeaf8000,0xbf7e3f68be5ebdb2,0x3f2dbed8beec3f35,0x3f35bf00be853f00,0x3e85bf003f77bf80,0xbe06bdb23f2dbf52,0xbf743f7fbf583f35
.quad 0xbf003f25bf713f7c,0x3f44bf253e32a50d,0x3f6dbf773f7ebf77,0x3e06be853f1cbf35,0xbf773f71bf523f44,0xbf683f71bf7f3f80,0x3f1cbf133eecbed8,0x3f58bf523f3dbf35
.quad 0xa50d8000a50d8000,0xa50d8000a50d8000,0xbf1c3f13beec3ed8,0xbf583f52bf3d3f35,0x3f77bf713f52bf44,0x3f68bf713f7fbf80,0xbf6d3f77bf7e3f77,0xbe063e85bf1c3f35
.quad 0x3f00bf253f71bf7c,0xbf443f25be32a50d,0x3e063db2bf2d3f52,0x3f74bf7f3f58bf35,0xbf353f003e85bf00,0xbe853f00bf773f80,0x3f7ebf683e5e3db2,0xbf2d3ed83eecbf35
.quad 0x3f44bf713f44bf00,0xbf713f80bf003e32,0xbf7e3f7cbee73e27,0x3f56bf22be693f02,0x3f66bf403d863e48,0xbd86be483f55bf72,0xbf023e9f3eaabf07,0xbf423f62bf7d3f6e
.quad 0xbd333e5ebf2d3f4b,0x3f7abf6d3f1cbeec,0x3f15bf2f3f69bf75,0xbed33e953dc9be69,0xbf6f3f76bf803f7f,0xbef63f0ebf403f4e,0x3f7bbf783f6ebf69,0x3f7dbf7f3f80bf7f
.quad 0xbf353f35bf353f35,0xbf353f35bf353f35,0x3e53be7e3ebfbed3,0xbe113dc93d06bd9c,0x3ebabe8f3cb33d86,0x3f60bf553f29bf17,0xbf503f3bbed33e95,0xbf693f75bf7f3f79
.quad 0x3f80bf7a3f3dbf1c,0x3e5ebec43f4bbf63,0xbf5c3f73bf723f59,0x3f27bef1be273ebf,0x3ee2bf293f7fbf7b,0xbf7f3f7bbf0e3ea5,0x3df53e3dbf643f7d,0x3f0cbf463f79bf5c
.quad 0x3f25beafbf253f5e,0xbeaf80003f5ebf7c,0xbdf5be3d3f64bf7d,0xbf0c3f46bf793f5c,0xbee23f29bf7f3f7b,0x3f7fbf7b3f0ebea5,0x3f5cbf733f72bf59,0xbf273ef13e27bebf
.quad 0xbf803f7abf3d3f1c,0xbe5e3ec4bf4b3f63,0x3f50bf3b3ed3be95,0x3f69bf753f7fbf79,0xbeba3e8fbcb3bd86,0xbf603f55bf293f17,0xbe533e7ebebf3ed3,0x3e11bdc9bd063d9c
.quad 0x3f35bf353f35bf35,0x3f35bf353f35bf35,0xbf7b3f78bf6e3f69,0xbf7d3f7fbf803f7f,0x3f6fbf763f80bf7f,0x3ef6bf0e3f40bf4e,0xbf153f2fbf693f75,0x3ed3be95bdc93e69
.quad 0x3d33be5e3f2dbf4b,0xbf7a3f6dbf1c3eec,0x3f02be9fbeaa3f07,0x3f42bf623f7dbf6e,0xbf663f40bd86be48,0x3d863e48bf553f72,0x3f7ebf7c3ee7be27,0xbf563f223e69bf02
.quad 0x3e32bf003f80bf71,0xbf003f44bf713f44,0xbf3f3f69bf623f33,0x3f80bf773ebfbd9c,0x3f7fbf7b3f0ebea5,0xbf0e3ea53ee2bf29,0xbf533f2fbdc9bdf5,0xbed33f1abf773f80
.quad 0x3e9abe06bec43f0a,0x3f7ebf803f58bf3d,0x3eb4bef13f46bf59,0xbf223f07be273d06,0xbf5b3f66bf7b3f7e,0xbea53ecebf203f31,0x3f7ebf7d3f75bf72,0x3f79bf7c3f80bf80
.quad 0xbf353f35bf353f35,0xbf353f35bf353f35,0x3df5be273e95beaa,0xbe693e3dbd5f3c33,0x3f05bee23e48bddf,0x3f72bf6a3f48bf39,0xbf703f62bf223f07,0xbf463f59bf7d3f80
.quad 0x3f74bf7e3f6dbf58,0xbe06bd333f0abf2d,0xbf113f3bbf7f3f7e,0x3f69bf4d3e8abd5f,0xbd86be483f55bf72,0xbf553f72bf663f40,0x3f2bbed3bef13f37,0xbd06be8a3f6ebf7f
.quad 0x3f7cbf5e80003eaf,0xbf5e3f253eafbf25,0xbf2b3ed33ef1bf37,0x3d063e8abf6e3f7f,0x3d863e48bf553f72,0x3f55bf723f66bf40,0x3f11bf3b3f7fbf7e,0xbf693f4dbe8a3d5f
.quad 0xbf743f7ebf6d3f58,0x3e063d33bf0a3f2d,0x3f70bf623f22bf07,0x3f46bf593f7dbf80,0xbf053ee2be483ddf,0xbf723f6abf483f39,0xbdf53e27be953eaa,0x3e69be3d3d5fbc33
.quad 0x3f35bf353f35bf35,0x3f35bf353f35bf35,0xbf7e3f7dbf753f72,0xbf793f7cbf803f80,0x3f5bbf663f7bbf7e,0x3ea5bece3f20bf31,0xbeb43ef1bf463f59,0x3f22bf073e27bd06
.quad 0xbe9a3e063ec4bf0a,0xbf7e3f80bf583f3d,0x3f53bf2f3dc93df5,0x3ed3bf1a3f77bf80,0xbf7f3f7bbf0e3ea5,0x3f0ebea5bee23f29,0x3f3fbf693f62bf33,0xbf803f77bebf3d9c
.quad 0x3f80bf713e323e32,0xbf713f443e32bf00,0xbf553f203e73bf05,0x3e8f3cb3bf4e3f72,0x3ec4be06bf1c3f4b,0x3f1cbf4b3f7ebf6d,0x3e48bece3f60bf76,0xbf803f79bf203ee2
.quad 0xbf353f52bf7f3f7f,0x3f13bed8bdb23e85,0x3f7bbf7f3f72bf66,0x3ea5bee23f40bf55,0xbf6d3f63bf3d3f2d,0xbf743f7abf803f7e,0x3f0ebf053ecebeba,0x3f4ebf483f31bf29
.quad 0xa554248da554248d,0xa554248da554248d,0xbf0e3f05bece3eba,0xbf4e3f48bf313f29,0x3f6dbf633f3dbf2d,0x3f74bf7a3f80bf7e,0xbf7b3f7fbf723f66,0xbea53ee2bf403f55
.quad 0x3f35bf523f7fbf7f,0xbf133ed83db2be85,0xbe483ecebf603f76,0x3f80bf793f20bee2,0xbec43e063f1cbf4b,0xbf1c3f4bbf7e3f6d,0x3f55bf20be733f05,0xbe8fbcb33f4ebf72
.quad 0x80003eafbf7c3f7c,0x3eafbf253f7cbf5e,0x3f0ebf483f79bf5b,0xbf763f80bf173ea5,0xbf6d3f7ebf4b3f1c,0x3f4bbf1cbe063ec4,0x3f7bbf6a3ef6be8f,0x3cb3be733f48bf66
.quad 0xbf353f13bdb2bdb2,0xbf523f68bf7f3f77,0x3e48bd86bea53ee2,0x3f72bf663f29bf0e,0x3ec4beec3f2dbf3d,0xbe9a3e5e3d33be06,0xbf553f5bbf6a3f6f,0xbf173f20bf393f40
.quad 0x3f80bf803f80bf80,0x3f80bf803f80bf80,0xbf553f5bbf6a3f6f,0xbf173f20bf393f40,0x3ec4beec3f2dbf3d,0xbe9a3e5e3d33be06,0x3e48bd86bea53ee2,0x3f72bf663f29bf0e
.quad 0xbf353f13bdb2bdb2,0xbf523f68bf7f3f77,0x3f7bbf6a3ef6be8f,0x3cb3be733f48bf66,0xbf6d3f7ebf4b3f1c,0x3f4bbf1cbe063ec4,0x3f0ebf483f79bf5b,0xbf763f80bf173ea5
.quad 0x3f44bf713f44bf00,0xbf713f80bf003e32,0xbf803f76beba3d86,0x3f48bf0ebea53f17,0x3f4bbf1cbe063ec4,0x3e06bec43f6dbf7e,0xbe733cb33f17bf40,0xbf6a3f7bbf663f48
.quad 0xbed83f13bf683f77,0x3f52bf353e85bdb2,0x3f66bf723f7fbf7b,0x3d86be483f0ebf29,0xbf7a3f74bf583f4b,0xbf633f6dbf7e3f80,0x3f20bf173ef6bee2,0x3f5bbf553f40bf39
.quad 0xa554248da554248d,0xa554248da554248d,0xbf203f17bef63ee2,0xbf5b3f55bf403f39,0x3f7abf743f58bf4b,0x3f63bf6d3f7ebf80,0xbf663f72bf7f3f7b,0xbd863e48bf0e3f29
.quad 0x3ed8bf133f68bf77,0xbf523f35be853db2,0x3e73bcb3bf173f40,0x3f6abf7b3f66bf48,0xbf4b3f1c3e06bec4,0xbe063ec4bf6d3f7e,0x3f80bf763ebabd86,0xbf483f0e3ea5bf17
.quad 0x3f25beafbf253f5e,0xbeaf80003f5ebf7c,0xbcb3be8f3f6fbf7f,0xbf203f55bf723f4e,0xbf1c3f4bbf7e3f6d,0x3f7ebf6d3ec4be06,0x3f79bf803f4ebf29,0xbece3e483ee2bf20
.quad 0xbf683f52bed83e85,0xbf133f35bf773f7f,0x3ee2bea5bd863e48,0x3f7fbf7b3f55bf40,0x3e5ebe9a3f0abf1c,0xbeec3ec4be063d33,0xbf483f4ebf603f66,0xbf053f0ebf293f31
.quad 0x3f80bf803f80bf80,0x3f80bf803f80bf80,0xbf483f4ebf603f66,0xbf053f0ebf293f31,0x3e5ebe9a3f0abf1c,0xbeec3ec4be063d33,0x3ee2bea5bd863e48,0x3f7fbf7b3f55bf40
.quad 0xbf683f52bed83e85,0xbf133f35bf773f7f,0x3f79bf803f4ebf29,0xbece3e483ee2bf20,0xbf1c3f4bbf7e3f6d,0x3f7ebf6d3ec4be06,0xbcb3be8f3f6fbf7f,0xbf203f55bf723f4e
.quad 0x3f44bf00bf003f44,0xbf003e323f44bf71,0xbe8abd063f50bf73,0xbed33f2bbf7f3f6e,0xbea53f0ebf7b3f7f,0x3f7bbf7f3f29bee2,0x3f4dbf693f79bf67,0xbf3b3f113d5fbe8a
.quad 0xbf803f7ebf4b3f2d,0xbe063e9abf3d3f58,0x3f59bf463ef1beb4,0x3f62bf703f80bf7d,0xbece3ea5bd86bcb3,0xbf663f5bbf313f20,0xbe3d3e69beb43ec9,0x3e27bdf5bc333d5f
.quad 0x3f35bf353f35bf35,0x3f35bf353f35bf35,0xbf7c3f79bf703f6b,0xbf7d3f7ebf803f80,0x3f6abf723f7fbf80,0x3ee2bf053f39bf48,0xbf073f22bf623f70,0x3ef1beb4bd063e27
.quad 0xbd33be063f1cbf3d,0xbf7e3f74bf2d3f0a,0x3f1abed3be693edd,0x3f2fbf533f80bf77,0xbf723f55be48bd86,0x3e483d86bf403f66,0x3f77bf803f15be9f,0xbf693f3f3d9cbebf
.quad 0xbf253f5ebf5e3f25,0x3f5ebf7c3f25beaf,0x3f77bf803f15be9f,0xbf693f3f3d9cbebf,0xbf723f55be48bd86,0x3e483d86bf403f66,0x3f1abed3be693edd,0x3f2fbf533f80bf77
.quad 0xbd33be063f1cbf3d,0xbf7e3f74bf2d3f0a,0xbf073f22bf623f70,0x3ef1beb4bd063e27,0x3f6abf723f7fbf80,0x3ee2bf053f39bf48,0xbf7c3f79bf703f6b,0xbf7d3f7ebf803f80
.quad 0x3f35bf353f35bf35,0x3f35bf353f35bf35,0xbe3d3e69beb43ec9,0x3e27bdf5bc333d5f,0xbece3ea5bd86bcb3,0xbf663f5bbf313f20,0x3f59bf463ef1beb4,0x3f62bf703f80bf7d
.quad 0xbf803f7ebf4b3f2d,0xbe063e9abf3d3f58,0x3f4dbf693f79bf67,0xbf3b3f113d5fbe8a,0xbea53f0ebf7b3f7f,0x3f7bbf7f3f29bee2,0xbe8abd063f50bf73,0xbed33f2bbf7f3f6e
.quad 0x3f80bf713e323e32,0xbf713f443e32bf00,0xbf463f0c3eaabf1a,0x3e3d3df5bf5c3f79,0x3e483d86bf403f66,0x3f40bf663f72bf55,0x3ef1bf273f7bbf80,0xbf733f5cbebf3e27
.quad 0xbf6d3f7abf743f63,0x3e5ebd33beec3f1c,0x3f75bf693f2fbf15,0x3f3bbf503f79bf7f,0xbf0e3ef6be733e1c,0xbf763f6fbf4e3f40,0xbdc93e11be8a3e9f,0x3e7ebe533d9cbd06
.quad 0x3f35bf353f35bf35,0x3f35bf353f35bf35,0xbf7f3f7dbf773f73,0xbf783f7bbf7f3f80,0x3f55bf603f79bf7d,0x3e8fbeba3f17bf29,0xbe953ed3bf3b3f50,0x3f2fbf153e69bdc9
.quad 0xbec43e5e3e9abeec,0xbf7a3f80bf633f4b,0x3f62bf423e533c33,0x3e9fbf023f6ebf7d,0xbf7b3f7fbf293ee2,0x3f29bee2bea53f0e,0x3f22bf563f72bf4d,0xbf7c3f7ebf023e69
.quad 0x80003eafbf7c3f7c,0x3eafbf253f7cbf5e,0x3f22bf563f72bf4d,0xbf7c3f7ebf023e69,0xbf7b3f7fbf293ee2,0x3f29bee2bea53f0e,0x3f62bf423e533c33,0x3e9fbf023f6ebf7d
.quad 0xbec43e5e3e9abeec,0xbf7a3f80bf633f4b,0xbe953ed3bf3b3f50,0x3f2fbf153e69bdc9,0x3f55bf603f79bf7d,0x3e8fbeba3f17bf29,0xbf7f3f7dbf773f73,0xbf783f7bbf7f3f80
.quad 0x3f35bf353f35bf35,0x3f35bf353f35bf35,0xbdc93e11be8a3e9f,0x3e7ebe533d9cbd06,0xbf0e3ef6be733e1c,0xbf763f6fbf4e3f40,0x3f75bf693f2fbf15,0x3f3bbf503f79bf7f
.quad 0xbf6d3f7abf743f63,0x3e5ebd33beec3f1c,0x3ef1bf273f7bbf80,0xbf733f5cbebf3e27,0x3e483d86bf403f66,0x3f40bf663f72bf55,0xbf463f0c3eaabf1a,0x3e3d3df5bf5c3f79
.quad 0x3f44bf713f44bf00,0xbf713f80bf003e32,0xbf583f253e5ebf00,0x3e9aa554bf4b3f71,0xbe853f00bf773f80,0x3f77bf803f35bf00,0x3f80bf7c3f2dbf00,0xbe5e248d3f1cbf44
.quad 0xbeaf3e323eafbf00,0xbf7c3f80bf5e3f44,0xbf4b3f5ebf7e3f80,0x3e06a554bec43f00,0x3f52bf443f13bf00,0x3f7fbf803f77bf71,0x3e9abeaf3eecbf00,0xbd33248d3e06be32
.quad 0xbf803f80bf803f80,0xbf803f80bf803f80,0x3e9abeaf3eecbf00,0xbd33a5543e06be32,0x3f52bf443f13bf00,0x3f7fbf803f77bf71,0xbf4b3f5ebf7e3f80,0x3e06248dbec43f00
.quad 0xbeaf3e323eafbf00,0xbf7c3f80bf5e3f44,0x3f80bf7c3f2dbf00,0xbe5ea5543f1cbf44,0xbe853f00bf773f80,0x3f77bf803f35bf00,0xbf583f253e5ebf00,0x3e9a248dbf4b3f71
.quad 0x3f25beafbf253f5e,0xbeaf80003f5ebf7c,0x3f0abf443f7abf5e,0xbf743f80bf1c3eaf,0xbf773f5ebe858000,0x3e85a50dbf353f5e,0x3d333e32bf3d3f5e,0x3f7abf803f4bbf25
.quad 0x3f71bf7c3f71bf5e,0xbe3280003f00bf25,0xbf1c3f00be068000,0xbf7e3f80bf6d3f5e,0xbf133f25bf523f5e,0x3db2a50dbe853eaf,0x3f74bf713f63bf5e,0x3f80bf803f7ebf7c
.quad 0xa50d8000a50d8000,0xa50d8000a50d8000,0xbf743f71bf633f5e,0xbf803f80bf7e3f7c,0x3f13bf253f52bf5e,0xbdb2a50d3e85beaf,0x3f1cbf003e068000,0x3f7ebf803f6dbf5e
.quad 0xbf713f7cbf713f5e,0x3e328000bf003f25,0xbd33be323f3dbf5e,0xbf7a3f80bf4b3f25,0x3f77bf5e3e858000,0xbe85a50d3f35bf5e,0xbf0a3f44bf7a3f5e,0x3f74bf803f1cbeaf
.quad 0x3e32bf003f80bf71,0xbf003f44bf713f44,0xbf803f77bec43db2,0x3f4bbf13be9a3f13,0x3e85a554bf353f5e,0x3f35bf5e3f77bf5e,0x3f63bf773f6dbf52,0xbf1c3ed83e5ebed8
.quad 0xbf253f00a554be32,0xbf5e3f71bf7c3f71,0xbf1c3f35bf6d3f77,0x3ec4be85be063e85,0x3f68bf5e3f35bf25,0x3f77bf7c3f7fbf7c,0x3e5ebe853ec4bed8,0xbe063db23d33bdb2
.quad 0xbf803f80bf803f80,0xbf803f80bf803f80,0x3e5ebe853ec4bed8,0xbe063db23d33bdb2,0x3f68bf5e3f35bf25,0x3f77bf7c3f7fbf7c,0xbf1c3f35bf6d3f77,0x3ec4be85be063e85
.quad 0xbf253f00248dbe32,0xbf5e3f71bf7c3f71,0x3f63bf773f6dbf52,0xbf1c3ed83e5ebed8,0x3e85248dbf353f5e,0x3f35bf5e3f77bf5e,0xbf803f77bec43db2,0x3f4bbf13be9a3f13
.quad 0x3f7cbf5e80003eaf,0xbf5e3f253eafbf25,0xbd33be853f6dbf7f,0xbf1c3f52bf743f52,0xbf773f80bf353f00,0x3f35bf00be853f00,0x3eecbe85bec43f13,0x3f4bbf683f7abf68
.quad 0x3f44bf5e3f80bf7c,0xbf003eaf3e32beaf,0xbf4b3f35bec43e85,0xbf6d3f77bf7e3f77,0xbed83f00bf353f44,0x3e85be32bdb23e32,0x3f7abf773f6dbf68,0x3f7ebf7f3f80bf7f
.quad 0xa50d8000a50d8000,0xa50d8000a50d8000,0xbf7a3f77bf6d3f68,0xbf7e3f7fbf803f7f,0x3ed8bf003f35bf44,0xbe853e323db2be32,0x3f4bbf353ec4be85,0x3f6dbf773f7ebf77
.quad 0xbf443f5ebf803f7c,0x3f00beafbe323eaf,0xbeec3e853ec4bf13,0xbf4b3f68bf7a3f68,0x3f77bf803f35bf00,0xbf353f003e85bf00,0x3d333e85bf6d3f7f,0x3f1cbf523f74bf52
.quad 0x3f80bf713e323e32,0xbf713f443e32bf00,0xbe95bc333f4dbf72,0xbec93f27bf803f70,0xbf553f72bf663f40,0x3f66bf403d863e48,0x3f46bf1e3c333e53,0x3efbbf2b3f7cbf80
.quad 0x3ec4bf0a3f63bf74,0xbf583f3dbe9a3e06,0xbf7f3f79bf503f3b,0xbf153f2fbf693f75,0x3e48bddfbe1c3e73,0x3f48bf393f05bee2,0x3f62bf673f73bf77,0x3f2bbf333f49bf50
.quad 0xbf353f35bf353f35,0xbf353f35bf353f35,0xbef13eddbe9f3e8a,0xbf3f3f37bf1e3f15,0x3f7bbf7e3f7dbf79,0x3f20bf313f5bbf66,0xbdc93e69bf153f2f,0x3f50bf3b3ed3be95
.quad 0xbf6d3f58beec3e9a,0xbf0a3f2dbf743f7e,0x3f22bf493f80bf7b,0xbf5f3f3fbe3dbd06,0x3f0ebea5bee23f29,0x3ee2bf293f7fbf7b,0xbf753f80bf1a3eaa,0x3f6bbf42bd5f3eb4
.quad 0x80003eafbf7c3f7c,0x3eafbf253f7cbf5e,0x3f75bf803f1abeaa,0xbf6b3f423d5fbeb4,0xbf0e3ea53ee2bf29,0xbee23f29bf7f3f7b,0xbf223f49bf803f7b,0x3f5fbf3f3e3d3d06
.quad 0x3f6dbf583eecbe9a,0x3f0abf2d3f74bf7e,0x3dc9be693f15bf2f,0xbf503f3bbed33e95,0xbf7b3f7ebf7d3f79,0xbf203f31bf5b3f66,0x3ef1bedd3e9fbe8a,0x3f3fbf373f1ebf15
.quad 0x3f35bf353f35bf35,0x3f35bf353f35bf35,0xbf623f67bf733f77,0xbf2b3f33bf493f50,0xbe483ddf3e1cbe73,0xbf483f39bf053ee2,0x3f7fbf793f50bf3b,0x3f15bf2f3f69bf75
.quad 0xbec43f0abf633f74,0x3f58bf3d3e9abe06,0xbf463f1ebc33be53,0xbefb3f2bbf7c3f80,0x3f55bf723f66bf40,0xbf663f40bd86be48,0x3e953c33bf4d3f72,0x3ec9bf273f80bf70
.quad 0x3f44bf713f44bf00,0xbf713f80bf003e32,0xbf493f113e9fbf15,0x3e533dc9bf593f78,0xbee23f29bf7f3f7b,0x3f7fbf7b3f0ebea5,0x3f78bf643eddbe69,0x3d9cbe953f50bf6b
.quad 0x3d33be5e3f2dbf4b,0xbf7a3f6dbf1c3eec,0xbf7d3f80bf703f62,0xbeb43ef1bf463f59,0x3ebabe8f3cb33d86,0x3f60bf553f29bf17,0x3f56bf5c3f6bbf70,0x3f1abf223f3bbf42
.quad 0xbf353f35bf353f35,0xbf353f35bf353f35,0xbf0c3f02bec93eb4,0xbf4d3f46bf2f3f27,0x3f6fbf763f80bf7f,0x3ef6bf0e3f40bf4e,0x3e27bd06beb43ef1,0x3f70bf623f22bf07
.quad 0xbf803f7abf3d3f1c,0xbe5e3ec4bf4b3f63,0x3e7ebee73f67bf79,0xbf7f3f75bf153ec9,0x3f66bf403d863e48,0xbd86be483f55bf72,0xbf1e3f53bf733f50,0x3f7bbf7f3f07be7e
.quad 0x3f25beafbf253f5e,0xbeaf80003f5ebf7c,0x3f1ebf533f73bf50,0xbf7b3f7fbf073e7e,0xbf663f40bd86be48,0x3d863e48bf553f72,0xbe7e3ee7bf673f79,0x3f7fbf753f15bec9
.quad 0x3f80bf7a3f3dbf1c,0x3e5ebec43f4bbf63,0xbe273d063eb4bef1,0xbf703f62bf223f07,0xbf6f3f76bf803f7f,0xbef63f0ebf403f4e,0x3f0cbf023ec9beb4,0x3f4dbf463f2fbf27
.quad 0x3f35bf353f35bf35,0x3f35bf353f35bf35,0xbf563f5cbf6b3f70,0xbf1a3f22bf3b3f42,0xbeba3e8fbcb3bd86,0xbf603f55bf293f17,0x3f7dbf803f70bf62,0x3eb4bef13f46bf59
.quad 0xbd333e5ebf2d3f4b,0x3f7abf6d3f1cbeec,0xbf783f64bedd3e69,0xbd9c3e95bf503f6b,0x3ee2bf293f7fbf7b,0xbf7f3f7bbf0e3ea5,0x3f49bf11be9f3f15,0xbe53bdc93f59bf78
.quad 0x3f44bf00bf003f44,0xbf003e323f44bf71,0x3ecebf293f7fbf6f,0xbf663f7dbf393ef6,0xbf7e3f6dbec43e06,0x3ec4be06bf1c3f4b,0x3e1c3d86bf293f4e,0x3f72bf7e3f5bbf39
.quad 0x3f68bf773f77bf68,0xbe853db23ed8bf13,0xbf293f0ebe483d86,0xbf7b3f7fbf723f66,0xbf0a3f1cbf4b3f58,0x3e06bd33be5e3e9a,0x3f76bf723f66bf60,0x3f7fbf803f7ebf7d
.quad 0xa554248da554248d,0xa554248da554248d,0xbf763f72bf663f60,0xbf7f3f80bf7e3f7d,0x3f0abf1c3f4bbf58,0xbe063d333e5ebe9a,0x3f29bf0e3e48bd86,0x3f7bbf7f3f72bf66
.quad 0xbf683f77bf773f68,0x3e85bdb2bed83f13,0xbe1cbd863f29bf4e,0xbf723f7ebf5b3f39,0x3f7ebf6d3ec4be06,0xbec43e063f1cbf4b,0xbece3f29bf7f3f6f,0x3f66bf7d3f39bef6
.quad 0xbf253f5ebf5e3f25,0x3f5ebf7c3f25beaf,0x3f6abf40bd863eba,0xbee23e1c3f31bf60,0x3e06bec43f6dbf7e,0xbf6d3f7ebf4b3f1c,0xbf7d3f7fbf403f17,0x3ea5bddfbf053f31
.quad 0x3ed8be85be853ed8,0x3f77bf7f3f68bf52,0x3f40bf553f7bbf7f,0xbe483d863ea5bee2,0xbf583f4bbf1c3f0a,0xbf7e3f80bf7a3f74,0xbe8f3ea5bee23ef6,0x3d86bcb3bddf3e1c
.quad 0x3f80bf803f80bf80,0x3f80bf803f80bf80,0xbe8f3ea5bee23ef6,0x3d86bcb3bddf3e1c,0xbf583f4bbf1c3f0a,0xbf7e3f80bf7a3f74,0x3f40bf553f7bbf7f,0xbe483d863ea5bee2
.quad 0x3ed8be85be853ed8,0x3f77bf7f3f68bf52,0xbf7d3f7fbf403f17,0x3ea5bddfbf053f31,0x3e06bec43f6dbf7e,0xbf6d3f7ebf4b3f1c,0x3f6abf40bd863eba,0xbee23e1c3f31bf60
.quad 0x3f80bf713e323e32,0xbf713f443e32bf00,0xbe48bddf3f5bbf79,0xbef63f39bf7d3f66,0xbf6d3f7ebf4b3f1c,0x3f4bbf1cbe063ec4,0x3f0ebebabe8f3ef6,0x3f39bf5b3f7ebf72
.quad 0x3f35bf523f7fbf7f,0xbf133ed83db2be85,0xbf553f40bee23ea5,0xbf663f72bf7f3f7b,0xbec43eecbf2d3f3d,0x3e9abe5ebd333e06,0x3f7bbf793f6fbf6a,0x3f7dbf7e3f80bf7f
.quad 0xa554248da554248d,0xa554248da554248d,0xbf7b3f79bf6f3f6a,0xbf7d3f7ebf803f7f,0x3ec4beec3f2dbf3d,0xbe9a3e5e3d33be06,0x3f55bf403ee2bea5,0x3f66bf723f7fbf7b
.quad 0xbf353f52bf7f3f7f,0x3f13bed8bdb23e85,0xbf0e3eba3e8fbef6,0xbf393f5bbf7e3f72,0x3f6dbf7e3f4bbf1c,0xbf4b3f1c3e06bec4,0x3e483ddfbf5b3f79,0x3ef6bf393f7dbf66
.quad 0x80003eafbf7c3f7c,0x3eafbf253f7cbf5e,0x3f7bbf7e3f05be73,0xbf603f313e1cbee2,0xbec43e063f1cbf4b,0xbf1c3f4bbf7e3f6d,0xbf553f6fbf763f60,0x3f31bf05bddf3ea5
.quad 0x3f35bf133db23db2,0x3f52bf683f7fbf77,0x3f0ebf293f66bf72,0xbee23ea53d86be48,0xbf6d3f63bf3d3f2d,0xbf743f7abf803f7e,0xbe483e73beba3ece,0x3e1cbddfbcb33d86
.quad 0x3f80bf803f80bf80,0x3f80bf803f80bf80,0xbe483e73beba3ece,0x3e1cbddfbcb33d86,0xbf6d3f63bf3d3f2d,0xbf743f7abf803f7e,0x3f0ebf293f66bf72,0xbee23ea53d86be48
.quad 0x3f35bf133db23db2,0x3f52bf683f7fbf77,0xbf553f6fbf763f60,0x3f31bf05bddf3ea5,0xbec43e063f1cbf4b,0xbf1c3f4bbf7e3f6d,0x3f7bbf7e3f05be73,0xbf603f313e1cbee2
.quad 0x3e323e32bf713f80,0x3e32bf003f80bf71,0x3f67bf7d3f37bef1,0xbf783f59bdc9be53,0xbf293ee23ea5bf0e,0xbea53f0ebf7b3f7f,0xbf0c3f37bf7e3f7f,0x3f6bbf503e95bd9c
.quad 0x3f74bf633f0abec4,0x3eecbf1c3f6dbf7a,0x3d06be273f07bf22,0xbf593f46bef13eb4,0xbf793f7dbf7e3f7b,0xbf173f29bf553f60,0x3efbbee73eaabe95,0x3f42bf3b3f22bf1a
.quad 0x3f35bf353f35bf35,0x3f35bf353f35bf35,0xbf5f3f64bf723f75,0xbf273f2fbf463f4d,0xbe733e1c3ddfbe48,0xbf4e3f40bf0e3ef6,0x3f80bf7d3f59bf46,0x3f07bf223f62bf70
.quad 0xbe9a3eecbf583f6d,0x3f63bf4b3ec4be5e,0xbf563f33bdf5bdc9,0xbec93f15bf753f7f,0x3f40bf663f72bf55,0xbf723f55be48bd86,0x3eddbe11bf333f62,0x3e7ebf073f7fbf7b
.quad 0xbf7c3f7cbeaf8000,0x3f7cbf5e80003eaf,0x3eddbe11bf333f62,0x3e7ebf073f7fbf7b,0x3f40bf663f72bf55,0xbf723f55be48bd86,0xbf563f33bdf5bdc9,0xbec93f15bf753f7f
.quad 0xbe9a3eecbf583f6d,0x3f63bf4b3ec4be5e,0x3f80bf7d3f59bf46,0x3f07bf223f62bf70,0xbe733e1c3ddfbe48,0xbf4e3f40bf0e3ef6,0xbf5f3f64bf723f75,0xbf273f2fbf463f4d
.quad 0x3f35bf353f35bf35,0x3f35bf353f35bf35,0x3efbbee73eaabe95,0x3f42bf3b3f22bf1a,0xbf793f7dbf7e3f7b,0xbf173f29bf553f60,0x3d06be273f07bf22,0xbf593f46bef13eb4
.quad 0x3f74bf633f0abec4,0x3eecbf1c3f6dbf7a,0xbf0c3f37bf7e3f7f,0x3f6bbf503e95bd9c,0xbf293ee23ea5bf0e,0xbea53f0ebf7b3f7f,0x3f67bf7d3f37bef1,0xbf783f59bdc9be53
.quad 0x3f44bf00bf003f44,0xbf003e323f44bf71,0x3efbbf3b3f7dbf64,0xbf703f80bf273ec9,0xbf723f55be48bd86,0x3e483d86bf403f66,0xbe113eb4bf593f72,0x3f80bf7c3f2bbefb
.quad 0x3f80bf7e3f4bbf2d,0x3e06be9a3f3dbf58,0xbe693dc93e95bed3,0xbf753f69bf2f3f15,0xbf6a3f72bf7f3f80,0xbee23f05bf393f48,0x3f11bf073ed3bebf,0x3f50bf493f33bf2b
.quad 0x3f35bf353f35bf35,0x3f35bf353f35bf35,0xbf533f59bf693f6e,0xbf153f1ebf373f3f,0xbece3ea5bd86bcb3,0xbf663f5bbf313f20,0x3f79bf7f3f75bf69,0x3e95bed33f3bbf50
.quad 0x3d333e06bf1c3f3d,0x3f7ebf743f2dbf0a,0xbf7d3f70bf073eaa,0x3d063e3dbf3f3f5f,0x3ea5bf0e3f7bbf7f,0xbf7b3f7fbf293ee2,0x3f5fbf2fbe273ee7,0xbeb43d5f3f42bf6b
.quad 0xbf253f5ebf5e3f25,0x3f5ebf7c3f25beaf,0x3f5fbf2fbe273ee7,0xbeb43d5f3f42bf6b,0x3ea5bf0e3f7bbf7f,0xbf7b3f7fbf293ee2,0xbf7d3f70bf073eaa,0x3d063e3dbf3f3f5f
.quad 0x3d333e06bf1c3f3d,0x3f7ebf743f2dbf0a,0x3f79bf7f3f75bf69,0x3e95bed33f3bbf50,0xbece3ea5bd86bcb3,0xbf663f5bbf313f20,0xbf533f59bf693f6e,0xbf153f1ebf373f3f
.quad 0x3f35bf353f35bf35,0x3f35bf353f35bf35,0x3f11bf073ed3bebf,0x3f50bf493f33bf2b,0xbf6a3f72bf7f3f80,0xbee23f05bf393f48,0xbe693dc93e95bed3,0xbf753f69bf2f3f15
.quad 0x3f80bf7e3f4bbf2d,0x3e06be9a3f3dbf58,0xbe113eb4bf593f72,0x3f80bf7c3f2bbefb,0xbf723f55be48bd86,0x3e483d86bf403f66,0x3efbbf3b3f7dbf64,0xbf703f80bf273ec9
.quad 0x3f80bf713e323e32,0xbf713f443e32bf00,0x3ec4bf253f80bf71,0xbf633f7cbf3d3f00,0xbf353f003e85bf00,0xbe853f00bf773f80,0xbf6d3f7cbf633f44,0x3f0abeafbe9a3f00
.quad 0x248d3e32bf253f44,0x3f7cbf713f25bf00,0x3f6dbf5e3f1cbf00,0x3f4bbf5e3f7ebf80,0x3f35bf443f68bf71,0x3db2be323ed8bf00,0xbec43eafbe5e3e32,0xbf2d3f25bf0a3f00
.quad 0xbf803f80bf803f80,0xbf803f80bf803f80,0xbec43eafbe5e3e32,0xbf2d3f25bf0a3f00,0x3f35bf443f68bf71,0x3db2be323ed8bf00,0x3f6dbf5e3f1cbf00,0x3f4bbf5e3f7ebf80
.quad 0xa5543e32bf253f44,0x3f7cbf713f25bf00,0xbf6d3f7cbf633f44,0x3f0abeafbe9a3f00,0xbf353f003e85bf00,0xbe853f00bf773f80,0x3ec4bf253f80bf71,0xbf633f7cbf3d3f00
.quad 0x80003eafbf7c3f7c,0x3eafbf253f7cbf5e,0x3f6dbf44bd333eaf,0xbeec3e323f2dbf5e,0x3f35bf5e3f77bf5e,0xbf773f5ebe858000,0xbec43e323eecbf25,0xbf583f71bf743f5e
.quad 0xbf803f7cbf443f25,0xbe323eafbf443f5e,0xbec43f00bf4b3f5e,0x3f1cbf003e06a50d,0x3f35bf253ed8beaf,0x3f7fbf7c3f68bf5e,0x3f6dbf713f7abf7c,0x3f3dbf443f58bf5e
.quad 0xa50d8000a50d8000,0xa50d8000a50d8000,0xbf6d3f71bf7a3f7c,0xbf3d3f44bf583f5e,0xbf353f25bed83eaf,0xbf7f3f7cbf683f5e,0x3ec4bf003f4bbf5e,0xbf1c3f00be06a50d
.quad 0x3f80bf7c3f44bf25,0x3e32beaf3f44bf5e,0x3ec4be32beec3f25,0x3f58bf713f74bf5e,0xbf353f5ebf773f5e,0x3f77bf5e3e858000,0xbf6d3f443d33beaf,0x3eecbe32bf2d3f5e
.quad 0x3f44bf713f44bf00,0xbf713f80bf003e32,0xbe5ebdb23f58bf77,0xbeec3f35bf7e3f68,0xbf773f5ebe85248d,0x3e85a554bf353f5e,0xbf2d3f52bf803f77,0x3f58bf353e063db2
.quad 0x3eafbe32beaf3f00,0x3f7cbf803f5ebf44,0x3f7ebf773f4bbf35,0x3f1cbf353f6dbf77,0x3f13bf253f52bf5e,0xbdb2248d3e85beaf,0xbeec3ed8be9a3e85,0xbf3d3f35bf1c3f13
.quad 0xbf803f80bf803f80,0xbf803f80bf803f80,0xbeec3ed8be9a3e85,0xbf3d3f35bf1c3f13,0x3f13bf253f52bf5e,0xbdb2a5543e85beaf,0x3f7ebf773f4bbf35,0x3f1cbf353f6dbf77
.quad 0x3eafbe32beaf3f00,0x3f7cbf803f5ebf44,0xbf2d3f52bf803f77,0x3f58bf353e063db2,0xbf773f5ebe85a554,0x3e85248dbf353f5e,0xbe5ebdb23f58bf77,0xbeec3f35bf7e3f68
.quad 0x3f25beafbf253f5e,0xbeaf80003f5ebf7c,0x3f7abf7f3f0abe85,0xbf633f353e06bed8,0x3e85bf003f77bf80,0xbf773f80bf353f00,0xbf3d3f133d33be85,0xbf0a3f35bf7e3f7f
.quad 0xbf713f7cbf713f5e,0x3e32a50dbf003f25,0xbe063e85bf1c3f35,0x3f4bbf353ec4be85,0x3f52bf443f13bf00,0x3f7fbf803f77bf71,0x3f63bf683f74bf77,0x3f2dbf353f4bbf52
.quad 0xa50d8000a50d8000,0xa50d8000a50d8000,0xbf633f68bf743f77,0xbf2d3f35bf4b3f52,0xbf523f44bf133f00,0xbf7f3f80bf773f71,0x3e06be853f1cbf35,0xbf4b3f35bec43e85
.quad 0x3f71bf7c3f71bf5e,0xbe32a50d3f00bf25,0x3f3dbf13bd333e85,0x3f0abf353f7ebf7f,0xbe853f00bf773f80,0x3f77bf803f35bf00,0xbf7a3f7fbf0a3e85,0x3f63bf35be063ed8
.quad 0x3f44bf00bf003f44,0xbf003e323f44bf71,0x3f64bf7d3f3bbefb,0xbf793f5cbdf5be3d,0xbd86be483f55bf72,0xbf553f72bf663f40,0xbf723f59beb43e11,0xbe273ebfbf5c3f73
.quad 0xbf2d3f4bbf7e3f80,0x3f1cbeecbd333e5e,0x3ed3be95bdc93e69,0x3f7fbf793f50bf3b,0x3f80bf7f3f72bf6a,0x3f40bf4e3f6fbf76,0x3ebfbed33f07bf11,0x3d06bd9c3e53be7e
.quad 0xbf353f35bf353f35,0xbf353f35bf353f35,0xbf6e3f69bf593f53,0xbf803f7fbf7b3f78,0xbcb3bd863ea5bece,0xbf293f17beba3e8f,0x3f69bf753f7fbf79,0x3dc9be693f15bf2f
.quad 0x3f3dbf1c3e063d33,0x3f4bbf633f80bf7a,0xbeaa3f07bf703f7d,0x3f7dbf6e3f02be9f,0xbf7f3f7bbf0e3ea5,0x3f0ebea5bee23f29,0xbee73e273f2fbf5f,0xbe693f02bf7e3f7c
.quad 0xbf253f5ebf5e3f25,0x3f5ebf7c3f25beaf,0x3ee7be27bf2f3f5f,0x3e69bf023f7ebf7c,0x3f7fbf7b3f0ebea5,0xbf0e3ea53ee2bf29,0x3eaabf073f70bf7d,0xbf7d3f6ebf023e9f
.quad 0xbf3d3f1cbe06bd33,0xbf4b3f63bf803f7a,0xbf693f75bf7f3f79,0xbdc93e69bf153f2f,0x3cb33d86bea53ece,0x3f29bf173ebabe8f,0x3f6ebf693f59bf53,0x3f80bf7f3f7bbf78
.quad 0x3f35bf353f35bf35,0x3f35bf353f35bf35,0xbebf3ed3bf073f11,0xbd063d9cbe533e7e,0xbf803f7fbf723f6a,0xbf403f4ebf6f3f76,0xbed33e953dc9be69,0xbf7f3f79bf503f3b
.quad 0x3f2dbf4b3f7ebf80,0xbf1c3eec3d33be5e,0x3f72bf593eb4be11,0x3e27bebf3f5cbf73,0x3d863e48bf553f72,0x3f55bf723f66bf40,0xbf643f7dbf3b3efb,0x3f79bf5c3df53e3d
.quad 0x3f80bf713e323e32,0xbf713f443e32bf00,0x3ef1bf373f7dbf67,0xbf6e3f7fbf2b3ed3,0xbf0e3ea53ee2bf29,0xbee23f29bf7f3f7b,0xbf7f3f7ebf373f0c,0x3e8abd5fbf113f3b
.quad 0xbec43f0abf633f74,0x3f58bf3d3e9abe06,0x3f22bf073e27bd06,0x3f7dbf803f70bf62,0x3f7bbf7e3f7dbf79,0x3f20bf313f5bbf66,0x3e95beaa3ee7befb,0xbd5f3c333df5be27
.quad 0xbf353f35bf353f35,0xbf353f35bf353f35,0xbf753f72bf643f5f,0xbf803f80bf7e3f7d,0xbe483ddf3e1cbe73,0xbf483f39bf053ee2,0x3f46bf593f7dbf80,0xbe273d063eb4bef1
.quad 0x3f6dbf583eecbe9a,0x3f0abf2d3f74bf7e,0x3dc93df5bf333f56,0x3f77bf803f53bf2f,0xbf553f72bf663f40,0x3f66bf403d863e48,0xbf623f333e11bedd,0x3ebfbd9cbf3f3f69
.quad 0x80003eafbf7c3f7c,0x3eafbf253f7cbf5e,0x3f62bf33be113edd,0xbebf3d9c3f3fbf69,0x3f55bf723f66bf40,0xbf663f40bd86be48,0xbdc9bdf53f33bf56,0xbf773f80bf533f2f
.quad 0xbf6d3f58beec3e9a,0xbf0a3f2dbf743f7e,0xbf463f59bf7d3f80,0x3e27bd06beb43ef1,0x3e48bddfbe1c3e73,0x3f48bf393f05bee2,0x3f75bf723f64bf5f,0x3f80bf803f7ebf7d
.quad 0x3f35bf353f35bf35,0x3f35bf353f35bf35,0xbe953eaabee73efb,0x3d5fbc33bdf53e27,0xbf7b3f7ebf7d3f79,0xbf203f31bf5b3f66,0xbf223f07be273d06,0xbf7d3f80bf703f62
.quad 0x3ec4bf0a3f63bf74,0xbf583f3dbe9a3e06,0x3f7fbf7e3f37bf0c,0xbe8a3d5f3f11bf3b,0x3f0ebea5bee23f29,0x3ee2bf293f7fbf7b,0xbef13f37bf7d3f67,0x3f6ebf7f3f2bbed3
.quad 0x3e323e32bf713f80,0x3e32bf003f80bf71,0x3f79bf5b3ddf3e48,0xbf173ea53f0ebf48,0x3f1cbf4b3f7ebf6d,0xbf7e3f6dbec43e06,0xbef63e8f3ebabf0e,0xbf483f66bf7b3f6a
.quad 0xbf7f3f7fbf523f35,0xbdb23e85bf353f52,0xbea53ee2bf403f55,0x3f29bf0e3e48bd86,0x3f3dbf2d3eecbec4,0x3f80bf7e3f6dbf63,0x3f6abf6f3f79bf7b,0x3f39bf403f55bf5b
.quad 0xa554248da554248d,0xa554248da554248d,0xbf6a3f6fbf793f7b,0xbf393f40bf553f5b,0xbf3d3f2dbeec3ec4,0xbf803f7ebf6d3f63,0x3ea5bee23f40bf55,0xbf293f0ebe483d86
.quad 0x3f7fbf7f3f52bf35,0x3db2be853f35bf52,0x3ef6be8fbeba3f0e,0x3f48bf663f7bbf6a,0xbf1c3f4bbf7e3f6d,0x3f7ebf6d3ec4be06,0xbf793f5bbddfbe48,0x3f17bea5bf0e3f48
.quad 0xbf7c3f7cbeaf8000,0x3f7cbf5e80003eaf,0xbe733f05bf7e3f7b,0x3f4ebf723f55bf20,0x3f4bbf1cbe063ec4,0x3e06bec43f6dbf7e,0x3f60bf763f6fbf55,0xbf203ee23e48bece
.quad 0xbdb2bdb23f13bf35,0xbf7f3f77bf353f13,0xbf723f66bf293f0e,0xbf403f55bf7b3f7f,0xbf2d3f3dbf633f6d,0xbd333e06bec43eec,0x3ecebeba3e73be48,0x3f31bf293f0ebf05
.quad 0x3f80bf803f80bf80,0x3f80bf803f80bf80,0x3ecebeba3e73be48,0x3f31bf293f0ebf05,0xbf2d3f3dbf633f6d,0xbd333e06bec43eec,0xbf723f66bf293f0e,0xbf403f55bf7b3f7f
.quad 0xbdb2bdb23f13bf35,0xbf7f3f77bf353f13,0x3f60bf763f6fbf55,0xbf203ee23e48bece,0x3f4bbf1cbe063ec4,0x3e06bec43f6dbf7e,0xbe733f05bf7e3f7b,0x3f4ebf723f55bf20
.quad 0x3f44bf00bf003f44,0xbf003e323f44bf71,0x3f6fbf7f3f29bece,0xbf723f4ebcb3be8f,0x3e06bec43f6dbf7e,0xbf6d3f7ebf4b3f1c,0xbf4e3f29bd86be1c,0xbee23f20bf793f80
.quad 0xbf683f77bf773f68,0x3e85bdb2bed83f13,0xbd863e48bf0e3f29,0x3f55bf403ee2bea5,0x3f58bf4b3f1cbf0a,0x3f7ebf803f7abf74,0x3f60bf663f72bf76,0x3f29bf313f48bf4e
.quad 0xa554248da554248d,0xa554248da554248d,0xbf603f66bf723f76,0xbf293f31bf483f4e,0xbf583f4bbf1c3f0a,0xbf7e3f80bf7a3f74,0x3d86be483f0ebf29,0xbf553f40bee23ea5
.quad 0x3f68bf773f77bf68,0xbe853db23ed8bf13,0x3f4ebf293d863e1c,0x3ee2bf203f79bf80,0xbe063ec4bf6d3f7e,0x3f6dbf7e3f4bbf1c,0xbf6f3f7fbf293ece,0x3f72bf4e3cb33e8f
.quad 0xbf253f5ebf5e3f25,0x3f5ebf7c3f25beaf,0x3ebabd86bf403f6a,0x3ea5bf173f80bf76,0x3f7ebf6d3ec4be06,0xbec43e063f1cbf4b,0x3f17bf403f7fbf7d,0xbf663f48be733cb3
.quad 0xbed83e853e85bed8,0xbf773f7fbf683f52,0xbf7f3f7bbf553f40,0xbf0e3f29bf663f72,0xbf0a3f1cbf4b3f58,0x3e06bd33be5e3e9a,0x3ef6bee23ea5be8f,0x3f40bf393f20bf17
.quad 0x3f80bf803f80bf80,0x3f80bf803f80bf80,0x3ef6bee23ea5be8f,0x3f40bf393f20bf17,0xbf0a3f1cbf4b3f58,0x3e06bd33be5e3e9a,0xbf7f3f7bbf553f40,0xbf0e3f29bf663f72
.quad 0xbed83e853e85bed8,0xbf773f7fbf683f52,0x3f17bf403f7fbf7d,0xbf663f48be733cb3,0x3f7ebf6d3ec4be06,0xbec43e063f1cbf4b,0x3ebabd86bf403f6a,0x3ea5bf173f80bf76
.quad 0xbf003f44bf713f44,0x3f44bf713f44bf00,0x3f15be9fbf113f49,0x3d9cbebf3f77bf80,0x3f7bbf7f3f29bee2,0xbf293ee23ea5bf0e,0x3e69bedd3f64bf78,0xbf803f77bf1a3ed3
.quad 0xbf4b3f2dbe5e3d33,0xbf3d3f58bf803f7e,0xbf623f70bf803f7d,0xbd063e27bf073f22,0x3d863cb3be8f3eba,0x3f31bf203ecebea5,0x3f70bf6b3f5cbf56,0x3f80bf803f7cbf79
.quad 0x3f35bf353f35bf35,0x3f35bf353f35bf35,0xbeb43ec9bf023f0c,0xbc333d5fbe3d3e69,0xbf7f3f80bf763f6f,0xbf393f48bf6a3f72,0xbef13eb43d06be27,0xbf803f7dbf593f46
.quad 0x3f1cbf3d3f7abf80,0xbf2d3f0abd33be06,0x3f79bf673ee7be7e,0x3d5fbe8a3f4dbf69,0x3e483d86bf403f66,0x3f40bf663f72bf55,0xbf503f73bf533f1e,0x3f7fbf6e3e8a3d06
.quad 0xbf5e3f253eafbf25,0x3f25beafbf253f5e,0xbf503f73bf533f1e,0x3f7fbf6e3e8a3d06,0x3e483d86bf403f66,0x3f40bf663f72bf55,0x3f79bf673ee7be7e,0x3d5fbe8a3f4dbf69
.quad 0x3f1cbf3d3f7abf80,0xbf2d3f0abd33be06,0xbef13eb43d06be27,0xbf803f7dbf593f46,0xbf7f3f80bf763f6f,0xbf393f48bf6a3f72,0xbeb43ec9bf023f0c,0xbc333d5fbe3d3e69
.quad 0x3f35bf353f35bf35,0x3f35bf353f35bf35,0x3f70bf6b3f5cbf56,0x3f80bf803f7cbf79,0x3d863cb3be8f3eba,0x3f31bf203ecebea5,0xbf623f70bf803f7d,0xbd063e27bf073f22
.quad 0xbf4b3f2dbe5e3d33,0xbf3d3f58bf803f7e,0x3e69bedd3f64bf78,0xbf803f77bf1a3ed3,0x3f7bbf7f3f29bee2,0xbf293ee23ea5bf0e,0x3f15be9fbf113f49,0x3d9cbebf3f77bf80
.quad 0x3e323e32bf713f80,0x3e32bf003f80bf71,0x3f72bf4d3c333e95,0xbf023e693f22bf56,0x3f40bf663f72bf55,0xbf723f55be48bd86,0xbe53bc333f1ebf46,0xbf6e3f7dbf623f42
.quad 0xbf743f63bf0a3ec4,0xbeec3f1cbf6d3f7a,0xbf3b3f50bf793f7f,0x3e69bdc9be953ed3,0x3e73be1cbddf3e48,0x3f4ebf403f0ebef6,0x3f77bf733f67bf62,0x3f7fbf803f7fbf7d
.quad 0x3f35bf353f35bf35,0x3f35bf353f35bf35,0xbe8a3e9fbedd3ef1,0x3d9cbd06bdc93e11,0xbf793f7dbf7e3f7b,0xbf173f29bf553f60,0xbf2f3f15be693dc9,0xbf793f7fbf753f69
.quad 0x3e9abeec3f58bf6d,0xbf633f4bbec43e5e,0x3f7bbf803f49bf22,0xbebf3e273ef1bf27,0x3f29bee2bea53f0e,0x3ea5bf0e3f7bbf7f,0xbeaa3f1abf803f75,0x3f5cbf793f46bf0c
.quad 0xbf7c3f7cbeaf8000,0x3f7cbf5e80003eaf,0xbeaa3f1abf803f75,0x3f5cbf793f46bf0c,0x3f29bee2bea53f0e,0x3ea5bf0e3f7bbf7f,0x3f7bbf803f49bf22,0xbebf3e273ef1bf27
.quad 0x3e9abeec3f58bf6d,0xbf633f4bbec43e5e,0xbf2f3f15be693dc9,0xbf793f7fbf753f69,0xbf793f7dbf7e3f7b,0xbf173f29bf553f60,0xbe8a3e9fbedd3ef1,0x3d9cbd06bdc93e11
.quad 0x3f35bf353f35bf35,0x3f35bf353f35bf35,0x3f77bf733f67bf62,0x3f7fbf803f7fbf7d,0x3e73be1cbddf3e48,0x3f4ebf403f0ebef6,0xbf3b3f50bf793f7f,0x3e69bdc9be953ed3
.quad 0xbf743f63bf0a3ec4,0xbeec3f1cbf6d3f7a,0xbe53bc333f1ebf46,0xbf6e3f7dbf623f42,0x3f40bf663f72bf55,0xbf723f55be48bd86,0x3f72bf4d3c333e95,0xbf023e693f22bf56
.quad 0x3f44bf00bf003f44,0xbf003e323f44bf71,0x3f7abf5e3e063e32,0xbf1c3eaf3f0abf44,0x3f77bf803f35bf00,0xbf353f003e85bf00,0x3f3dbf5e3f7ebf71,0xbf4b3f25bd33be32
.quad 0x3eafbf003f5ebf71,0xbf5e3f44beaf3e32,0xbe06248d3ec4bf00,0xbf6d3f5ebf1c3f00,0xbf133f00be853e32,0xbf773f71bf523f44,0xbf633f5ebf4b3f44,0xbf7e3f7cbf743f71
.quad 0xbf803f80bf803f80,0xbf803f80bf803f80,0xbf633f5ebf4b3f44,0xbf7e3f7cbf743f71,0xbf133f00be853e32,0xbf773f71bf523f44,0xbe06a5543ec4bf00,0xbf6d3f5ebf1c3f00
.quad 0x3eafbf003f5ebf71,0xbf5e3f44beaf3e32,0x3f3dbf5e3f7ebf71,0xbf4b3f25bd33be32,0x3f77bf803f35bf00,0xbf353f003e85bf00,0x3f7abf5e3e063e32,0xbf1c3eaf3f0abf44
.quad 0xbf253f5ebf5e3f25,0x3f5ebf7c3f25beaf,0xbe5e3f00bf7e3f7c,0x3f4bbf713f58bf25,0x3e85a50dbf353f5e,0x3f35bf5e3f77bf5e,0x3f2dbf00be063eaf,0x3f1cbf443f80bf7c
.quad 0x3f71bf5e3f00beaf,0x3f00bf253f71bf7c,0x3f7ebf803f6dbf5e,0x3ec4bf003f4bbf5e,0x3f52bf5e3f77bf7c,0x3e85beaf3f13bf25,0x3eecbf003f1cbf25,0x3e06be323e9abeaf
.quad 0xa50d8000a50d8000,0xa50d8000a50d8000,0xbeec3f00bf1c3f25,0xbe063e32be9a3eaf,0xbf523f5ebf773f7c,0xbe853eafbf133f25,0xbf7e3f80bf6d3f5e,0xbec43f00bf4b3f5e
.quad 0xbf713f5ebf003eaf,0xbf003f25bf713f7c,0xbf2d3f003e06beaf,0xbf1c3f44bf803f7c,0xbe85a50d3f35bf5e,0xbf353f5ebf773f5e,0x3e5ebf003f7ebf7c,0xbf4b3f71bf583f25
.quad 0x3f80bf713e323e32,0xbf713f443e32bf00,0x3f6dbf7f3f2dbed8,0xbf743f52bd33be85,0x3f35bf5e3f77bf5e,0xbf773f5ebe85248d,0x3ec4bf133f74bf7f,0xbf7a3f68beec3e85
.quad 0xa554be323f25bf44,0xbf7c3f71bf253f00,0xbec43e853e06be85,0xbf7e3f77bf4b3f35,0xbf353f25bed83eaf,0xbf7f3f7cbf683f5e,0xbf6d3f68bf583f52,0xbf803f7fbf7a3f77
.quad 0xbf803f80bf803f80,0xbf803f80bf803f80,0xbf6d3f68bf583f52,0xbf803f7fbf7a3f77,0xbf353f25bed83eaf,0xbf7f3f7cbf683f5e,0xbec43e853e06be85,0xbf7e3f77bf4b3f35
.quad 0x248dbe323f25bf44,0xbf7c3f71bf253f00,0x3ec4bf133f74bf7f,0xbf7a3f68beec3e85,0x3f35bf5e3f77bf5e,0xbf773f5ebe85a554,0x3f6dbf7f3f2dbed8,0xbf743f52bd33be85
.quad 0x80003eafbf7c3f7c,0x3eafbf253f7cbf5e,0x3ec4bdb2bf3d3f68,0x3e9abf133f80bf77,0x3f35bf00be853f00,0x3e85bf003f77bf80,0x3f6dbf523e9abdb2,0x3e5ebed83f63bf77
.quad 0x3f80bf7c3f44bf25,0x3e32beaf3f44bf5e,0x3f6dbf773f7ebf77,0x3e06be853f1cbf35,0x3f35bf443f68bf71,0x3db2be323ed8bf00,0x3ec4bed83f0abf13,0x3d33bdb23e5ebe85
.quad 0xa50d8000a50d8000,0xa50d8000a50d8000,0xbec43ed8bf0a3f13,0xbd333db2be5e3e85,0xbf353f44bf683f71,0xbdb23e32bed83f00,0xbf6d3f77bf7e3f77,0xbe063e85bf1c3f35
.quad 0xbf803f7cbf443f25,0xbe323eafbf443f5e,0xbf6d3f52be9a3db2,0xbe5e3ed8bf633f77,0xbf353f003e85bf00,0xbe853f00bf773f80,0xbec43db23f3dbf68,0xbe9a3f13bf803f77
.quad 0x3e323e32bf713f80,0x3e32bf003f80bf71,0x3f1abeaabf0c3f46,0x3d5fbeb43f75bf80,0x3f66bf403d863e48,0xbd86be483f55bf72,0x3f80bf7b3f27bef1,0xbe3dbd063f22bf49
.quad 0x3f63bf743f7abf6d,0xbe9a3e063ec4bf0a,0x3f15bf2f3f69bf75,0xbed33e953dc9be69,0x3e1cbe733ef6bf0e,0xbf053ee2be483ddf,0xbe9f3e8abe113dc9,0xbf1e3f15bef13edd
.quad 0xbf353f35bf353f35,0xbf353f35bf353f35,0xbf733f77bf7d3f7f,0xbf493f50bf623f67,0xbf7d3f79bf603f55,0xbf5b3f66bf7b3f7e,0xbf503f3bbed33e95,0xbf693f75bf7f3f79
.quad 0xbeec3e9a3e5ebec4,0xbf743f7ebf6d3f58,0xbc33be533f42bf62,0xbf7c3f80bf463f1e,0x3ee2bf293f7fbf7b,0xbf7f3f7bbf0e3ea5,0x3f4dbf723f56bf22,0xbf803f70be95bc33
.quad 0xbf7c3f7cbeaf8000,0x3f7cbf5e80003eaf,0xbf4d3f72bf563f22,0x3f80bf703e953c33,0xbee23f29bf7f3f7b,0x3f7fbf7b3f0ebea5,0x3c333e53bf423f62,0x3f7cbf803f46bf1e
.quad 0x3eecbe9abe5e3ec4,0x3f74bf7e3f6dbf58,0x3f50bf3b3ed3be95,0x3f69bf753f7fbf79,0x3f7dbf793f60bf55,0x3f5bbf663f7bbf7e,0x3f73bf773f7dbf7f,0x3f49bf503f62bf67
.quad 0x3f35bf353f35bf35,0x3f35bf353f35bf35,0x3e9fbe8a3e11bdc9,0x3f1ebf153ef1bedd,0xbe1c3e73bef63f0e,0x3f05bee23e48bddf,0xbf153f2fbf693f75,0x3ed3be95bdc93e69
.quad 0xbf633f74bf7a3f6d,0x3e9abe06bec43f0a,0xbf803f7bbf273ef1,0x3e3d3d06bf223f49,0xbf663f40bd86be48,0x3d863e48bf553f72,0xbf1a3eaa3f0cbf46,0xbd5f3eb4bf753f80
.quad 0x3f44bf00bf003f44,0xbf003e323f44bf71,0x3f73bf503d063e8a,0xbf073e7e3f1ebf53,0x3f7fbf7b3f0ebea5,0xbf0e3ea53ee2bf29,0x3f67bf793f69bf4d,0xbf153ec93e7ebee7
.quad 0x3f2dbf4b3f7ebf80,0xbf1c3eec3d33be5e,0x3eb4bef13f46bf59,0xbf223f07be273d06,0xbcb3bd863ea5bece,0xbf293f17beba3e8f,0xbec93eb4be693e3d,0xbf2f3f27bf0c3f02
.quad 0xbf353f35bf353f35,0xbf353f35bf353f35,0xbf6b3f70bf793f7c,0xbf3b3f42bf563f5c,0xbf803f7fbf723f6a,0xbf403f4ebf6f3f76,0xbf703f62bf223f07,0xbf463f59bf7d3f80
.quad 0xbf3d3f1cbe06bd33,0xbf4b3f63bf803f7a,0xbedd3e693ed3bf1a,0xbf503f6bbf783f64,0xbd86be483f55bf72,0xbf553f72bf663f40,0x3e9fbf153f80bf77,0xbf593f78bf493f11
.quad 0xbf253f5ebf5e3f25,0x3f5ebf7c3f25beaf,0xbe9f3f15bf803f77,0x3f59bf783f49bf11,0x3d863e48bf553f72,0x3f55bf723f66bf40,0x3eddbe69bed33f1a,0x3f50bf6b3f78bf64
.quad 0x3f3dbf1c3e063d33,0x3f4bbf633f80bf7a,0x3f70bf623f22bf07,0x3f46bf593f7dbf80,0x3f80bf7f3f72bf6a,0x3f40bf4e3f6fbf76,0x3f6bbf703f79bf7c,0x3f3bbf423f56bf5c
.quad 0x3f35bf353f35bf35,0x3f35bf353f35bf35,0x3ec9beb43e69be3d,0x3f2fbf273f0cbf02,0x3cb33d86bea53ece,0x3f29bf173ebabe8f,0xbeb43ef1bf463f59,0x3f22bf073e27bd06
.quad 0xbf2d3f4bbf7e3f80,0x3f1cbeecbd333e5e,0xbf673f79bf693f4d,0x3f15bec9be7e3ee7,0xbf7f3f7bbf0e3ea5,0x3f0ebea5bee23f29,0xbf733f50bd06be8a,0x3f07be7ebf1e3f53
.quad 0xbf003f44bf713f44,0x3f44bf713f44bf00,0xbd863ebabf763f80,0x3f31bf603f6abf40,0x3ec4be06bf1c3f4b,0x3f1cbf4b3f7ebf6d,0x3f40bf17bcb33e73,0x3f05bf313f7dbf7f
.quad 0x3f77bf683f13bed8,0x3ed8bf133f68bf77,0x3f7bbf7f3f72bf66,0x3ea5bee23f40bf55,0x3f4bbf583f74bf7a,0x3e5ebe9a3f0abf1c,0x3ee2bef63f17bf20,0x3ddfbe1c3e8fbea5
.quad 0xa554248da554248d,0xa554248da554248d,0xbee23ef6bf173f20,0xbddf3e1cbe8f3ea5,0xbf4b3f58bf743f7a,0xbe5e3e9abf0a3f1c,0xbf7b3f7fbf723f66,0xbea53ee2bf403f55
.quad 0xbf773f68bf133ed8,0xbed83f13bf683f77,0xbf403f173cb3be73,0xbf053f31bf7d3f7f,0xbec43e063f1cbf4b,0xbf1c3f4bbf7e3f6d,0x3d86beba3f76bf80,0xbf313f60bf6a3f40
.quad 0xbf5e3f253eafbf25,0x3f25beafbf253f5e,0xbf7f3f6fbe8fbcb3,0x3f39bef6bece3f29,0xbf6d3f7ebf4b3f1c,0x3f4bbf1cbe063ec4,0xbf293f4ebf803f79,0x3f5bbf393e1c3d86
.quad 0xbe853ed8bf523f68,0x3f68bf523ed8be85,0x3e48bd86bea53ee2,0x3f72bf663f29bf0e,0x3f1cbf0a3e9abe5e,0x3f7abf743f58bf4b,0x3f66bf603f4ebf48,0x3f7ebf7d3f76bf72
.quad 0x3f80bf803f80bf80,0x3f80bf803f80bf80,0x3f66bf603f4ebf48,0x3f7ebf7d3f76bf72,0x3f1cbf0a3e9abe5e,0x3f7abf743f58bf4b,0x3e48bd86bea53ee2,0x3f72bf663f29bf0e
.quad 0xbe853ed8bf523f68,0x3f68bf523ed8be85,0xbf293f4ebf803f79,0x3f5bbf393e1c3d86,0xbf6d3f7ebf4b3f1c,0x3f4bbf1cbe063ec4,0xbf7f3f6fbe8fbcb3,0x3f39bef6bece3f29
.quad 0x3e323e32bf713f80,0x3e32bf003f80bf71,0x3f05be73bf203f55,0x3e1cbee23f7bbf7e,0x3f4bbf1cbe063ec4,0x3e06bec43f6dbf7e,0x3f76bf603ecebe48,0x3ddfbea53f55bf6f
.quad 0x3f7fbf7f3f52bf35,0x3db2be853f35bf52,0x3f66bf723f7fbf7b,0x3d86be483f0ebf29,0x3f2dbf3d3f63bf6d,0x3d33be063ec4beec,0x3ebabece3f05bf0e,0x3cb3bd863e48be73
.quad 0xa554248da554248d,0xa554248da554248d,0xbeba3ecebf053f0e,0xbcb33d86be483e73,0xbf2d3f3dbf633f6d,0xbd333e06bec43eec,0xbf663f72bf7f3f7b,0xbd863e48bf0e3f29
.quad 0xbf7f3f7fbf523f35,0xbdb23e85bf353f52,0xbf763f60bece3e48,0xbddf3ea5bf553f6f,0xbf4b3f1c3e06bec4,0xbe063ec4bf6d3f7e,0xbf053e733f20bf55,0xbe1c3ee2bf7b3f7e
.quad 0xbf7c3f7cbeaf8000,0x3f7cbf5e80003eaf,0xbf5b3f79bf483f0e,0x3f7dbf663e483ddf,0xbf1c3f4bbf7e3f6d,0x3f7ebf6d3ec4be06,0xbe8f3ef6bf6a3f7b,0x3f7ebf723f0ebeba
.quad 0x3db23db2bf133f35,0x3f7fbf773f35bf13,0x3ee2bea5bd863e48,0x3f7fbf7b3f55bf40,0x3f3dbf2d3eecbec4,0x3f80bf7e3f6dbf63,0x3f6fbf6a3f5bbf55,0x3f80bf7f3f7bbf79
.quad 0x3f80bf803f80bf80,0x3f80bf803f80bf80,0x3f6fbf6a3f5bbf55,0x3f80bf7f3f7bbf79,0x3f3dbf2d3eecbec4,0x3f80bf7e3f6dbf63,0x3ee2bea5bd863e48,0x3f7fbf7b3f55bf40
.quad 0x3db23db2bf133f35,0x3f7fbf773f35bf13,0xbe8f3ef6bf6a3f7b,0x3f7ebf723f0ebeba,0xbf1c3f4bbf7e3f6d,0x3f7ebf6d3ec4be06,0xbf5b3f79bf483f0e,0x3f7dbf663e483ddf
.quad 0xbf713f80bf003e32,0x3f80bf713e323e32,0xbf333f62bf693f3f,0x3f7fbf7b3eddbe11,0xbea53f0ebf7b3f7f,0x3f7bbf7f3f29bee2,0x3df53dc9bf2f3f53,0x3f75bf7f3f56bf33
.quad 0x3f0abec4be063e9a,0x3f6dbf7a3f74bf63,0x3f59bf463ef1beb4,0x3f62bf703f80bf7d,0x3f7ebf7b3f66bf5b,0x3f55bf603f79bf7d,0x3f72bf753f7dbf7e,0x3f46bf4d3f5fbf64
.quad 0x3f35bf353f35bf35,0x3f35bf353f35bf35,0x3eaabe953e27bdf5,0x3f22bf1a3efbbee7,0xbddf3e48bee23f05,0x3f0ebef63e73be1c,0xbf073f22bf623f70,0x3ef1beb4bd063e27
.quad 0xbf583f6dbf7e3f74,0x3ec4be5ebe9a3eec,0xbf7e3f7fbf3b3f11,0x3e95bd9cbf0c3f37,0xbf723f55be48bd86,0x3e483d86bf403f66,0xbf373ef13ed3bf2b,0x3dc93e53bf673f7d
.quad 0xbeaf80003f5ebf7c,0x80003eafbf7c3f7c,0xbf373ef13ed3bf2b,0x3dc93e53bf673f7d,0xbf723f55be48bd86,0x3e483d86bf403f66,0xbf7e3f7fbf3b3f11,0x3e95bd9cbf0c3f37
.quad 0xbf583f6dbf7e3f74,0x3ec4be5ebe9a3eec,0xbf073f22bf623f70,0x3ef1beb4bd063e27,0xbddf3e48bee23f05,0x3f0ebef63e73be1c,0x3eaabe953e27bdf5,0x3f22bf1a3efbbee7
.quad 0x3f35bf353f35bf35,0x3f35bf353f35bf35,0x3f72bf753f7dbf7e,0x3f46bf4d3f5fbf64,0x3f7ebf7b3f66bf5b,0x3f55bf603f79bf7d,0x3f59bf463ef1beb4,0x3f62bf703f80bf7d
.quad 0x3f0abec4be063e9a,0x3f6dbf7a3f74bf63,0x3df53dc9bf2f3f53,0x3f75bf7f3f56bf33,0xbea53f0ebf7b3f7f,0x3f7bbf7f3f29bee2,0xbf333f62bf693f3f,0x3f7fbf7b3eddbe11
.quad 0xbf003f44bf713f44,0x3f44bf713f44bf00,0xbe273ee7bf7c3f7e,0x3f42bf6b3f5fbf2f,0x3e483d86bf403f66,0x3f40bf663f72bf55,0x3f07beaabe9f3f02,0x3f3fbf5f3f7dbf70
.quad 0x3f4bbf2d3e5ebd33,0x3f3dbf583f80bf7e,0x3f75bf693f2fbf15,0x3f3bbf503f79bf7f,0x3f7fbf803f76bf6f,0x3f39bf483f6abf72,0x3f69bf6e3f78bf7b,0x3f37bf3f3f53bf59
.quad 0x3f35bf353f35bf35,0x3f35bf353f35bf35,0x3ed3bebf3e7ebe53,0x3f33bf2b3f11bf07,0x3d863cb3be8f3eba,0x3f31bf203ecebea5,0xbe953ed3bf3b3f50,0x3f2fbf153e69bdc9
.quad 0xbf1c3f3dbf7a3f80,0x3f2dbf0a3d333e06,0xbf593f72bf733f5c,0x3f2bbefbbe113eb4,0xbf7b3f7fbf293ee2,0x3f29bee2bea53f0e,0xbf7d3f64be3dbdf5,0x3f27bec9befb3f3b
.quad 0xbf5e3f253eafbf25,0x3f25beafbf253f5e,0xbf7d3f64be3dbdf5,0x3f27bec9befb3f3b,0xbf7b3f7fbf293ee2,0x3f29bee2bea53f0e,0xbf593f72bf733f5c,0x3f2bbefbbe113eb4
.quad 0xbf1c3f3dbf7a3f80,0x3f2dbf0a3d333e06,0xbe953ed3bf3b3f50,0x3f2fbf153e69bdc9,0x3d863cb3be8f3eba,0x3f31bf203ecebea5,0x3ed3bebf3e7ebe53,0x3f33bf2b3f11bf07
.quad 0x3f35bf353f35bf35,0x3f35bf353f35bf35,0x3f69bf6e3f78bf7b,0x3f37bf3f3f53bf59,0x3f7fbf803f76bf6f,0x3f39bf483f6abf72,0x3f75bf693f2fbf15,0x3f3bbf503f79bf7f
.quad 0x3f4bbf2d3e5ebd33,0x3f3dbf583f80bf7e,0x3f07beaabe9f3f02,0x3f3fbf5f3f7dbf70,0x3e483d86bf403f66,0x3f40bf663f72bf55,0xbe273ee7bf7c3f7e,0x3f42bf6b3f5fbf2f
```
